```python
import torch

def _softmax(x, axis=-1):
    return torch.softmax(x, dim=axis)
def _gelu(x):
    return torch.nn.functional.gelu(x, approximate="tanh")
def _silu(x):
    return torch.nn.functional.silu(x)
def _sigmoid(x):
    return torch.sigmoid(x)
def _layernorm(x, axis=-1, eps=1e-5):
    m = x.mean(dim=axis, keepdim=True)
    v = x.var(dim=axis, keepdim=True, unbiased=False)
    return (x - m) / torch.sqrt(v + eps)
def _scatter_add(tgt, idx, src, axis=0):
    return tgt.clone().index_add_(axis, idx, src)
def _segment_sum(src, seg, n):
    out = torch.zeros((n,) + src.shape[1:], dtype=src.dtype)
    return out.index_add_(0, seg, src)
def _pad(x, pw):
    flat = tuple(v for pair in reversed(pw) for v in pair)
    return torch.nn.functional.pad(x, flat)

kernel_name = 'concat_heads__softmax_full_mha__compressed_kv_cla__prompt'

def setup_inputs():

    _w = (lambda a: (lambda t: t.to(torch.bfloat16) if t.is_floating_point() else t)(torch.as_tensor(a)))
    def _A_setup():
        B, S, D = 1, 2048, 576
        return {
            "x": _w((lambda *s: torch.randn(*s, dtype=torch.bfloat16) * 0.2)(B, S, D)),
            "wqkv": _w((lambda *s: torch.randn(*s, dtype=torch.bfloat16) * 0.2)(D, 3 * D)),
            "wo": _w((lambda *s: torch.randn(*s, dtype=torch.bfloat16) * 0.05)(D, D)),
        }
    _A_in = _A_setup()

    def _B_setup():
        B, H, Sq, Sk, D, M = 1, 32, 2048, 2048, 128, 576
        Dc = 4 * D
        return {
            "x": _w((lambda *s: torch.randn(*s, dtype=torch.bfloat16) * 0.4)(B, Sq, M)),
            "c_kv": _w((lambda *s: torch.randn(*s, dtype=torch.bfloat16) * 0.4)(B, Sk, Dc)),
            "w_q": _w((lambda *s: torch.randn(*s, dtype=torch.bfloat16) * 3.2)(M, H, D) * (M ** -0.5)),
            "w_uk": _w((lambda *s: torch.randn(*s, dtype=torch.bfloat16) * 3.2)(Dc, H, D) * (Dc ** -0.5)),
            "w_uv": _w((lambda *s: torch.randn(*s, dtype=torch.bfloat16) * 0.4)(Dc, H, D) * (Dc ** -0.5)),
            "w_o": _w((lambda *s: torch.randn(*s, dtype=torch.bfloat16) * 0.4)(H, D, M) * ((H * D) ** -0.5)),
        }
    _B_in = _B_setup()

    return {
        "A_x": _A_in["x"],
        "A_wqkv": _A_in["wqkv"],
        "A_wo": _A_in["wo"],
        "B_x": _B_in["x"],
        "B_c_kv": _B_in["c_kv"],
        "B_w_q": _B_in["w_q"],
        "B_w_uk": _B_in["w_uk"],
        "B_w_uv": _B_in["w_uv"],
        "B_w_o": _B_in["w_o"],
    }

def reference(A_x, A_wqkv, A_wo, B_x, B_c_kv, B_w_q, B_w_uk, B_w_uv, B_w_o):
    def _A_ref(x, wqkv, wo):
        B, S, D = x.shape
        H = 32; Dh = D // H
        qkv = (lambda x, *d: x.permute(*d))((x @ wqkv).reshape(B, S, 3, H, Dh), 2, 0, 3, 1, 4)
        q, k, v = qkv[0], qkv[1], qkv[2]
        scale = Dh ** -0.5
        scores = torch.einsum("bhqd,bhkd->bhqk", q, k) * scale
        p = _softmax(scores, axis=-1)
        o = torch.einsum("bhqk,bhkd->bhqd", p, v)
        return (lambda x, *d: x.permute(*d))(o, 0, 2, 1, 3).reshape(B, S, D) @ wo

    def _B_ref(x, c_kv, w_q, w_uk, w_uv, w_o):
        B, Sq, M = x.shape[0], x.shape[1], x.shape[2]
        Sk = c_kv.shape[1]
        H, D = w_q.shape[1], w_q.shape[2]
        q = torch.einsum("bqm,mhd->bhqd", x, w_q)
        k = torch.einsum("bkc,chd->bhkd", c_kv, w_uk)
        v = torch.einsum("bkc,chd->bhkd", c_kv, w_uv)
        scores = torch.einsum("bhqd,bhkd->bhqk", q, k) * (D ** -0.5)
        off = Sk - Sq
        qi = torch.arange(Sq)[:, None]
        kj = torch.arange(Sk)[None, :]
        cmask = kj <= (qi + off)
        scores = torch.where(cmask[None, None], scores, -1e9)
        p = _softmax(scores, axis=-1)
        ctx = torch.einsum("bhqk,bhkd->bhqd", p, v)
        return torch.einsum("bhqd,hdm->bqm", ctx, w_o)

    a = _A_ref(A_x, A_wqkv, A_wo)
    b = _B_ref(B_x, B_c_kv, B_w_q, B_w_uk, B_w_uv, B_w_o)
    return torch.concatenate([a, b], axis=-1)
```

```asm
; @launch kernel=proj_kernel grid=(256,1,1) block=(256,1,1) lds=163840
; @launch kernel=attn_kernel grid=(256,1,1) block=(256,1,1) lds=163840
; @launch kernel=oproj_kernel grid=(256,1,1) block=(256,1,1) lds=163840
.amdgcn_target "amdgcn-amd-amdhsa--gfx950"
.text
.globl proj_kernel
.p2align 8
.type proj_kernel,@function
proj_kernel:
s_cmp_lt_u32 s2,256
s_cbranch_scc1 k1_go
s_endpgm
k1_go:
s_load_dwordx16 s[52:67],s[0:1],0
s_load_dwordx8 s[68:75],s[0:1],64
v_and_b32 v1,63,v0
v_lshrrev_b32 v2,6,v0
s_and_b32 s36,s2,7
s_lshr_b32 s37,s2,3
v_readfirstlane_b32 s24,v2
s_lshr_b32 s25,s37,3
s_and_b32 s37,s37,7
s_lshr_b32 s26,s36,1
s_lshl_b32 s26,s26,3
s_add_u32 s26,s26,s37
s_and_b32 s36,s36,1
s_lshl_b32 s36,s36,2
s_add_u32 s25,s25,s36
s_lshl_b32 s49,s25,3
s_lshl_b32 s36,s24,1
s_add_u32 s49,s49,s36
v_lshrrev_b32 v2,4,v1
v_lshlrev_b32 v19,9,v2
v_bfe_u32 v3,v1,2,2
v_lshl_add_u32 v19,v3,6,v19
v_and_b32 v3,1,v2
v_lshl_add_u32 v19,v3,5,v19
v_and_b32 v3,3,v1
v_lshl_add_u32 v19,v3,3,v19
v_bfe_u32 v4,v1,1,3
v_xor_b32 v4,v4,v2
v_and_b32 v3,15,v1
v_lshlrev_b32 v3,7,v3
v_lshl_add_u32 v26,v4,4,v3
v_lshlrev_b32 v5,4,v1
s_getpc_b64 s[36:37]
proj_kernel_pc:
s_lshr_b32 s38,s2,3
s_lshl_b32 s38,s38,2
s_add_u32 s38,s38,s24
s_lshl_b32 s38,s38,10
v_add_u32 v5,s38,v5
v_min_u32 v5,code_end-proj_kernel_pc-16,v5
v_and_b32 v5,-4,v5
global_load_dwordx4 v[252:255],v5,s[36:37]
s_mov_b32 s35,1.0
s_mov_b32 s31,64
s_mov_b32 s76,0
s_mov_b32 s78,0
s_mov_b32 s79,0
s_mov_b32 s80,-1
s_mov_b32 s34,2048
v_and_b32 v6,3,v1
v_lshrrev_b32 v7,5,v1
v_lshlrev_b32 v7,1,v7
v_xor_b32 v5,v6,v7
v_lshlrev_b32 v6,4,v5
v_lshrrev_b32 v7,2,v1
s_cmp_ge_u32 s26,26
s_cbranch_scc1 k1_typeA
s_cmp_ge_u32 s26,16
s_cbranch_scc1 k1_typeQ
s_mov_b32 s45,8192
s_mul_i32 s46,s49,32768
s_mov_b32 s29,131072
s_mul_i32 s30,s24,1048576
s_mul_i32 s41,s24,8192
v_mul_u32_u24 v16,8192,v7
v_add_u32_e64 v16,v16,v6
v_lshrrev_b32 v8,3,v1
v_mul_u32_u24 v8,1024,v8
v_and_b32 v9,7,v1
v_lshrrev_b32 v2,4,v1
v_xor_b32 v9,v9,v2
v_lshl_add_u32 v24,v9,4,v8
v_xor_b32 v9,4,v9
v_lshl_add_u32 v25,v9,4,v8
s_and_b32 s27,s26,7
s_lshl_b32 s27,s27,4
s_add_u32 s28,s27,16
s_mov_b32 s47,s27
s_mov_b32 s79,s27
s_mov_b32 s80,15
s_and_b32 s78,s26,3
s_lshl_b32 s78,s78,2
s_mov_b32 s44,4194304
s_mov_b32 s33,1048576
s_lshl_b32 s32,s49,14
s_add_u32 s32,s32,16777216
s_cmp_ge_u32 s26,8
s_cbranch_scc1 k1_typeV
v_and_b32 v2,15,v1
v_lshlrev_b32 v2,4,v2
v_bfe_u32 v3,v1,4,1
v_lshrrev_b32 v4,5,v1
s_mov_b32 s38,1024
v_mul_lo_u32 v3,v3,s38
v_lshl_add_u32 v9,v4,9,v3
v_add_u32_e64 v20,v2,v9
v_add_u32 v21,256,v20
v_add_u32 v22,16384,v20
v_add_u32 v23,16384,v21
s_waitcnt lgkmcnt(0)
s_mov_b32 s12,s64
s_mov_b32 s13,s65
s_mov_b32 s14,4194304
s_mov_b32 s15,0x20000
s_mov_b32 s8,s60
s_mov_b32 s9,s61
s_mov_b32 s10,2097152
s_mov_b32 s11,0x20000
s_mov_b32 s16,s74
s_mov_b32 s17,s75
s_mov_b32 s18,268435456
s_mov_b32 s19,0x20000
s_mov_b32 s20,s74
s_mov_b32 s21,s75
s_mov_b32 s22,268435456
s_mov_b32 s23,0x20000
k1_K:
s_mul_i32 s39,s24,24576
s_add_u32 s39,s39,65536
s_add_u32 s42,s47,s78
s_and_b32 s42,s42,s80
s_or_b32 s42,s42,s79
s_mul_i32 s42,s42,s31
s_add_u32 s42,s42,s30
s_cmp_lt_u32 s47,s28
s_cselect_b32 s14,s44,0
s_add_u32 s47,s47,1
s_add_u32 m0,s41,0
s_nop 0
buffer_load_dwordx4 v16,s[12:15],s42 offen lds
s_add_u32 m0,s41,1024
s_add_u32 s42,s42,s29
buffer_load_dwordx4 v16,s[12:15],s42 offen lds
s_add_u32 m0,s41,2048
s_add_u32 s42,s42,s29
buffer_load_dwordx4 v16,s[12:15],s42 offen lds
s_add_u32 m0,s41,3072
s_add_u32 s42,s42,s29
buffer_load_dwordx4 v16,s[12:15],s42 offen lds
s_add_u32 m0,s41,4096
s_add_u32 s42,s42,s29
buffer_load_dwordx4 v16,s[12:15],s42 offen lds
s_add_u32 m0,s41,5120
s_add_u32 s42,s42,s29
buffer_load_dwordx4 v16,s[12:15],s42 offen lds
s_add_u32 m0,s41,6144
s_add_u32 s42,s42,s29
buffer_load_dwordx4 v16,s[12:15],s42 offen lds
s_add_u32 m0,s41,7168
s_add_u32 s42,s42,s29
buffer_load_dwordx4 v16,s[12:15],s42 offen lds
s_add_u32 s41,s41,32768
s_sub_u32 s36,s41,131072
s_cmp_ge_u32 s41,131072
s_cselect_b32 s41,s36,s41
s_lshr_b32 s37,s2,3
s_and_b32 s37,s37,7
s_lshl_b32 s37,s37,2
s_add_u32 s37,s37,s24
s_lshl_b32 s38,s25,5
s_add_u32 s37,s37,s38
s_mul_i32 s37,s37,8192
v_lshlrev_b32 v2,4,v1
buffer_load_dwordx4 v[180:183],v2,s[8:11],s37 offen offset:0
buffer_load_dwordx4 v[184:187],v2,s[8:11],s37 offen offset:1024
buffer_load_dwordx4 v[188:191],v2,s[8:11],s37 offen offset:2048
buffer_load_dwordx4 v[192:195],v2,s[8:11],s37 offen offset:3072
s_add_u32 s37,s37,4096
buffer_load_dwordx4 v[196:199],v2,s[8:11],s37 offen offset:0
buffer_load_dwordx4 v[200:203],v2,s[8:11],s37 offen offset:1024
buffer_load_dwordx4 v[204:207],v2,s[8:11],s37 offen offset:2048
buffer_load_dwordx4 v[208:211],v2,s[8:11],s37 offen offset:3072
s_add_u32 s37,s37,4096
s_add_u32 s36,s46,0
s_add_u32 m0,s39,0
s_nop 0
buffer_load_dwordx4 v24,s[8:11],s36 offen lds
s_add_u32 m0,s39,1024
s_add_u32 s36,s36,s45
buffer_load_dwordx4 v25,s[8:11],s36 offen lds
s_add_u32 m0,s39,2048
s_add_u32 s36,s36,s45
buffer_load_dwordx4 v25,s[8:11],s36 offen lds
s_add_u32 m0,s39,3072
s_add_u32 s36,s36,s45
buffer_load_dwordx4 v24,s[8:11],s36 offen lds
s_add_u32 m0,s39,4096
s_add_u32 s36,s36,s45
buffer_load_dwordx4 v24,s[8:11],s36 offen lds
s_add_u32 m0,s39,5120
s_add_u32 s36,s36,s45
buffer_load_dwordx4 v25,s[8:11],s36 offen lds
s_add_u32 m0,s39,6144
s_add_u32 s36,s36,s45
buffer_load_dwordx4 v25,s[8:11],s36 offen lds
s_add_u32 m0,s39,7168
s_add_u32 s36,s36,s45
buffer_load_dwordx4 v24,s[8:11],s36 offen lds
s_add_u32 s36,s46,128
s_add_u32 m0,s39,8192
s_nop 0
buffer_load_dwordx4 v24,s[8:11],s36 offen lds
s_add_u32 m0,s39,9216
s_add_u32 s36,s36,s45
buffer_load_dwordx4 v25,s[8:11],s36 offen lds
s_add_u32 m0,s39,10240
s_add_u32 s36,s36,s45
buffer_load_dwordx4 v25,s[8:11],s36 offen lds
s_add_u32 m0,s39,11264
s_add_u32 s36,s36,s45
buffer_load_dwordx4 v24,s[8:11],s36 offen lds
s_add_u32 m0,s39,12288
s_add_u32 s36,s36,s45
buffer_load_dwordx4 v24,s[8:11],s36 offen lds
s_add_u32 m0,s39,13312
s_add_u32 s36,s36,s45
buffer_load_dwordx4 v25,s[8:11],s36 offen lds
s_add_u32 m0,s39,14336
s_add_u32 s36,s36,s45
buffer_load_dwordx4 v25,s[8:11],s36 offen lds
s_add_u32 m0,s39,15360
s_add_u32 s36,s36,s45
buffer_load_dwordx4 v24,s[8:11],s36 offen lds
s_add_u32 s36,s46,256
s_add_u32 m0,s39,16384
s_nop 0
buffer_load_dwordx4 v24,s[8:11],s36 offen lds
s_add_u32 m0,s39,17408
s_add_u32 s36,s36,s45
buffer_load_dwordx4 v25,s[8:11],s36 offen lds
s_add_u32 m0,s39,18432
s_add_u32 s36,s36,s45
buffer_load_dwordx4 v25,s[8:11],s36 offen lds
s_add_u32 m0,s39,19456
s_add_u32 s36,s36,s45
buffer_load_dwordx4 v24,s[8:11],s36 offen lds
s_add_u32 m0,s39,20480
s_add_u32 s36,s36,s45
buffer_load_dwordx4 v24,s[8:11],s36 offen lds
s_add_u32 m0,s39,21504
s_add_u32 s36,s36,s45
buffer_load_dwordx4 v25,s[8:11],s36 offen lds
s_add_u32 m0,s39,22528
s_add_u32 s36,s36,s45
buffer_load_dwordx4 v25,s[8:11],s36 offen lds
s_add_u32 m0,s39,23552
s_add_u32 s36,s36,s45
buffer_load_dwordx4 v24,s[8:11],s36 offen lds
v_add_u32_e64 v26,s39,v26
v_xor_b32 v27,64,v26
s_lshr_b32 s81,s29,4
s_lshr_b32 s94,s29,2
s_lshr_b32 s51,s49,1
s_mul_i32 s51,s51,16
s_mul_i32 s51,s51,s81
s_mul_i32 s37,s27,s31
s_add_u32 s51,s51,s37
s_add_u32 s51,s51,s76
s_mov_b32 s84,s12
s_mov_b32 s85,s13
s_mov_b32 s86,s44
s_mov_b32 s87,0x20000
s_sub_u32 s82,s28,s27
s_mul_i32 s82,s82,s31
s_add_u32 s82,s82,-130
s_lshr_b32 s82,s82,8
s_min_u32 s82,s82,2
s_lshl_b32 s37,s78,6
s_lshl_b32 s92,s80,6
s_or_b32 s92,s92,63
s_add_u32 s83,s37,256
v_and_b32 v2,31,v1
v_lshlrev_b32 v2,4,v2
v_add_u32 v2,s37,v2
v_and_b32 v2,s92,v2
v_lshrrev_b32 v3,5,v1
v_mul_lo_u32 v3,v3,s81
v_add_u32 v31,v2,v3
v_and_b32 v2,15,v1
v_lshlrev_b32 v2,4,v2
v_lshrrev_b32 v3,4,v1
v_mul_lo_u32 v3,v3,s81
v_add_u32 v30,v2,v3
v_mov_b32_e64 v176,v19
v_xor_b32 v177,32,v19
s_mov_b32 s40,32768
v_add_u32 v178,s40,v19
v_xor_b32 v179,32,v178
s_lshl_b32 s37,s78,6
s_add_u32 s37,s37,0
s_and_b32 s37,s37,s92
s_add_u32 s93,s51,s37
buffer_load_dwordx4 v[180:183],v30,s[84:87],s93 offen
s_add_u32 s93,s93,s94
buffer_load_dwordx4 v[184:187],v30,s[84:87],s93 offen
s_add_u32 s93,s93,s94
buffer_load_dwordx4 v[188:191],v30,s[84:87],s93 offen
s_add_u32 s93,s93,s94
buffer_load_dwordx4 v[192:195],v30,s[84:87],s93 offen
s_add_u32 s93,s93,s94
s_waitcnt vmcnt(20)
s_barrier
ds_read_b128 a[0:3],v26 offset:0
ds_read_b128 a[4:7],v27 offset:2048
ds_read_b128 a[8:11],v26 offset:4096
ds_read_b128 a[12:15],v27 offset:6144
ds_read_b128 a[16:19],v27 offset:0
ds_read_b128 a[20:23],v26 offset:2048
ds_read_b128 a[24:27],v27 offset:4096
ds_read_b128 a[28:31],v26 offset:6144
s_waitcnt lgkmcnt(6)
ds_read_b64_tr_b16 v[32:33],v176 offset:0
ds_read_b64_tr_b16 v[34:35],v176 offset:256
ds_read_b64_tr_b16 v[36:37],v177 offset:0
ds_read_b64_tr_b16 v[38:39],v177 offset:256
ds_read_b64_tr_b16 v[40:41],v176 offset:2048
ds_read_b64_tr_b16 v[42:43],v176 offset:2304
ds_read_b64_tr_b16 v[44:45],v177 offset:2048
ds_read_b64_tr_b16 v[46:47],v177 offset:2304
s_waitcnt lgkmcnt(8)
s_add_u32 s36,s46,384
s_add_u32 m0,s39,0
s_nop 0
buffer_load_dwordx4 v24,s[8:11],s36 offen lds
s_add_u32 m0,s39,1024
s_add_u32 s36,s36,s45
buffer_load_dwordx4 v25,s[8:11],s36 offen lds
s_add_u32 m0,s39,2048
s_add_u32 s36,s36,s45
buffer_load_dwordx4 v25,s[8:11],s36 offen lds
s_add_u32 m0,s39,3072
s_add_u32 s36,s36,s45
buffer_load_dwordx4 v24,s[8:11],s36 offen lds
s_add_u32 m0,s39,4096
s_add_u32 s36,s36,s45
buffer_load_dwordx4 v24,s[8:11],s36 offen lds
s_add_u32 m0,s39,5120
s_add_u32 s36,s36,s45
buffer_load_dwordx4 v25,s[8:11],s36 offen lds
s_add_u32 m0,s39,6144
s_add_u32 s36,s36,s45
buffer_load_dwordx4 v25,s[8:11],s36 offen lds
s_add_u32 m0,s39,7168
s_add_u32 s36,s36,s45
buffer_load_dwordx4 v24,s[8:11],s36 offen lds
s_waitcnt lgkmcnt(0)
v_mfma_f32_16x16x32_bf16 v[64:67],v[32:35],a[0:3],0
v_mfma_f32_16x16x32_bf16 v[72:75],v[32:35],a[4:7],0
v_mfma_f32_16x16x32_bf16 v[80:83],v[32:35],a[8:11],0
v_mfma_f32_16x16x32_bf16 v[88:91],v[32:35],a[12:15],0
v_mfma_f32_16x16x32_bf16 v[68:71],v[36:39],a[0:3],0
v_mfma_f32_16x16x32_bf16 v[76:79],v[36:39],a[4:7],0
v_mfma_f32_16x16x32_bf16 v[84:87],v[36:39],a[8:11],0
v_mfma_f32_16x16x32_bf16 v[92:95],v[36:39],a[12:15],0
v_mfma_f32_16x16x32_bf16 v[64:67],v[40:43],a[16:19],v[64:67]
v_mfma_f32_16x16x32_bf16 v[72:75],v[40:43],a[20:23],v[72:75]
v_mfma_f32_16x16x32_bf16 v[80:83],v[40:43],a[24:27],v[80:83]
v_mfma_f32_16x16x32_bf16 v[88:91],v[40:43],a[28:31],v[88:91]
v_mfma_f32_16x16x32_bf16 v[68:71],v[44:47],a[16:19],v[68:71]
v_mfma_f32_16x16x32_bf16 v[76:79],v[44:47],a[20:23],v[76:79]
v_mfma_f32_16x16x32_bf16 v[84:87],v[44:47],a[24:27],v[84:87]
v_mfma_f32_16x16x32_bf16 v[92:95],v[44:47],a[28:31],v[92:95]
s_waitcnt vmcnt(20)
ds_read_b128 a[32:35],v26 offset:8192
ds_read_b128 a[36:39],v27 offset:10240
ds_read_b128 a[40:43],v26 offset:12288
ds_read_b128 a[44:47],v27 offset:14336
ds_read_b128 a[48:51],v27 offset:8192
ds_read_b128 a[52:55],v26 offset:10240
ds_read_b128 a[56:59],v27 offset:12288
ds_read_b128 a[60:63],v26 offset:14336
s_waitcnt lgkmcnt(6)
ds_read_b64_tr_b16 v[32:33],v176 offset:4096
ds_read_b64_tr_b16 v[34:35],v176 offset:4352
ds_read_b64_tr_b16 v[36:37],v177 offset:4096
ds_read_b64_tr_b16 v[38:39],v177 offset:4352
ds_read_b64_tr_b16 v[40:41],v176 offset:6144
ds_read_b64_tr_b16 v[42:43],v176 offset:6400
ds_read_b64_tr_b16 v[44:45],v177 offset:6144
ds_read_b64_tr_b16 v[46:47],v177 offset:6400
s_waitcnt lgkmcnt(8)
s_add_u32 s36,s46,512
s_add_u32 m0,s39,8192
s_nop 0
buffer_load_dwordx4 v24,s[8:11],s36 offen lds
s_add_u32 m0,s39,9216
s_add_u32 s36,s36,s45
buffer_load_dwordx4 v25,s[8:11],s36 offen lds
s_add_u32 m0,s39,10240
s_add_u32 s36,s36,s45
buffer_load_dwordx4 v25,s[8:11],s36 offen lds
s_add_u32 m0,s39,11264
s_add_u32 s36,s36,s45
buffer_load_dwordx4 v24,s[8:11],s36 offen lds
s_add_u32 m0,s39,12288
s_add_u32 s36,s36,s45
buffer_load_dwordx4 v24,s[8:11],s36 offen lds
s_add_u32 m0,s39,13312
s_add_u32 s36,s36,s45
buffer_load_dwordx4 v25,s[8:11],s36 offen lds
s_add_u32 m0,s39,14336
s_add_u32 s36,s36,s45
buffer_load_dwordx4 v25,s[8:11],s36 offen lds
s_add_u32 m0,s39,15360
s_add_u32 s36,s36,s45
buffer_load_dwordx4 v24,s[8:11],s36 offen lds
s_waitcnt lgkmcnt(0)
v_mfma_f32_16x16x32_bf16 v[64:67],v[32:35],a[32:35],v[64:67]
v_mfma_f32_16x16x32_bf16 v[72:75],v[32:35],a[36:39],v[72:75]
v_mfma_f32_16x16x32_bf16 v[80:83],v[32:35],a[40:43],v[80:83]
v_mfma_f32_16x16x32_bf16 v[88:91],v[32:35],a[44:47],v[88:91]
v_mfma_f32_16x16x32_bf16 v[68:71],v[36:39],a[32:35],v[68:71]
v_mfma_f32_16x16x32_bf16 v[76:79],v[36:39],a[36:39],v[76:79]
v_mfma_f32_16x16x32_bf16 v[84:87],v[36:39],a[40:43],v[84:87]
v_mfma_f32_16x16x32_bf16 v[92:95],v[36:39],a[44:47],v[92:95]
v_mfma_f32_16x16x32_bf16 v[64:67],v[40:43],a[48:51],v[64:67]
v_mfma_f32_16x16x32_bf16 v[72:75],v[40:43],a[52:55],v[72:75]
v_mfma_f32_16x16x32_bf16 v[80:83],v[40:43],a[56:59],v[80:83]
v_mfma_f32_16x16x32_bf16 v[88:91],v[40:43],a[60:63],v[88:91]
v_mfma_f32_16x16x32_bf16 v[68:71],v[44:47],a[48:51],v[68:71]
v_mfma_f32_16x16x32_bf16 v[76:79],v[44:47],a[52:55],v[76:79]
v_mfma_f32_16x16x32_bf16 v[84:87],v[44:47],a[56:59],v[84:87]
v_mfma_f32_16x16x32_bf16 v[92:95],v[44:47],a[60:63],v[92:95]
s_waitcnt vmcnt(20)
ds_read_b128 a[64:67],v26 offset:16384
ds_read_b128 a[68:71],v27 offset:18432
ds_read_b128 a[72:75],v26 offset:20480
ds_read_b128 a[76:79],v27 offset:22528
ds_read_b128 a[80:83],v27 offset:16384
ds_read_b128 a[84:87],v26 offset:18432
ds_read_b128 a[88:91],v27 offset:20480
ds_read_b128 a[92:95],v26 offset:22528
s_waitcnt lgkmcnt(6)
ds_read_b64_tr_b16 v[32:33],v176 offset:8192
ds_read_b64_tr_b16 v[34:35],v176 offset:8448
ds_read_b64_tr_b16 v[36:37],v177 offset:8192
ds_read_b64_tr_b16 v[38:39],v177 offset:8448
ds_read_b64_tr_b16 v[40:41],v176 offset:10240
ds_read_b64_tr_b16 v[42:43],v176 offset:10496
ds_read_b64_tr_b16 v[44:45],v177 offset:10240
ds_read_b64_tr_b16 v[46:47],v177 offset:10496
s_waitcnt lgkmcnt(8)
s_add_u32 s36,s46,640
s_add_u32 m0,s39,16384
s_nop 0
buffer_load_dwordx4 v24,s[8:11],s36 offen lds
s_add_u32 m0,s39,17408
s_add_u32 s36,s36,s45
buffer_load_dwordx4 v25,s[8:11],s36 offen lds
s_add_u32 m0,s39,18432
s_add_u32 s36,s36,s45
buffer_load_dwordx4 v25,s[8:11],s36 offen lds
s_add_u32 m0,s39,19456
s_add_u32 s36,s36,s45
buffer_load_dwordx4 v24,s[8:11],s36 offen lds
s_add_u32 m0,s39,20480
s_add_u32 s36,s36,s45
buffer_load_dwordx4 v24,s[8:11],s36 offen lds
s_add_u32 m0,s39,21504
s_add_u32 s36,s36,s45
buffer_load_dwordx4 v25,s[8:11],s36 offen lds
s_add_u32 m0,s39,22528
s_add_u32 s36,s36,s45
buffer_load_dwordx4 v25,s[8:11],s36 offen lds
s_add_u32 m0,s39,23552
s_add_u32 s36,s36,s45
buffer_load_dwordx4 v24,s[8:11],s36 offen lds
s_waitcnt lgkmcnt(0)
v_mfma_f32_16x16x32_bf16 v[64:67],v[32:35],a[64:67],v[64:67]
v_mfma_f32_16x16x32_bf16 v[72:75],v[32:35],a[68:71],v[72:75]
v_mfma_f32_16x16x32_bf16 v[80:83],v[32:35],a[72:75],v[80:83]
v_mfma_f32_16x16x32_bf16 v[88:91],v[32:35],a[76:79],v[88:91]
v_mfma_f32_16x16x32_bf16 v[68:71],v[36:39],a[64:67],v[68:71]
v_mfma_f32_16x16x32_bf16 v[76:79],v[36:39],a[68:71],v[76:79]
v_mfma_f32_16x16x32_bf16 v[84:87],v[36:39],a[72:75],v[84:87]
v_mfma_f32_16x16x32_bf16 v[92:95],v[36:39],a[76:79],v[92:95]
v_mfma_f32_16x16x32_bf16 v[64:67],v[40:43],a[80:83],v[64:67]
v_mfma_f32_16x16x32_bf16 v[72:75],v[40:43],a[84:87],v[72:75]
v_mfma_f32_16x16x32_bf16 v[80:83],v[40:43],a[88:91],v[80:83]
v_mfma_f32_16x16x32_bf16 v[88:91],v[40:43],a[92:95],v[88:91]
v_mfma_f32_16x16x32_bf16 v[68:71],v[44:47],a[80:83],v[68:71]
v_mfma_f32_16x16x32_bf16 v[76:79],v[44:47],a[84:87],v[76:79]
v_mfma_f32_16x16x32_bf16 v[84:87],v[44:47],a[88:91],v[84:87]
v_mfma_f32_16x16x32_bf16 v[92:95],v[44:47],a[92:95],v[92:95]
s_waitcnt vmcnt(16)
ds_read_b128 a[96:99],v26 offset:0
ds_read_b128 a[100:103],v27 offset:2048
ds_read_b128 a[104:107],v26 offset:4096
ds_read_b128 a[108:111],v27 offset:6144
ds_read_b128 a[112:115],v27 offset:0
ds_read_b128 a[116:119],v26 offset:2048
ds_read_b128 a[120:123],v27 offset:4096
ds_read_b128 a[124:127],v26 offset:6144
s_waitcnt lgkmcnt(6)
ds_read_b64_tr_b16 v[32:33],v176 offset:12288
ds_read_b64_tr_b16 v[34:35],v176 offset:12544
ds_read_b64_tr_b16 v[36:37],v177 offset:12288
ds_read_b64_tr_b16 v[38:39],v177 offset:12544
ds_read_b64_tr_b16 v[40:41],v176 offset:14336
ds_read_b64_tr_b16 v[42:43],v176 offset:14592
ds_read_b64_tr_b16 v[44:45],v177 offset:14336
ds_read_b64_tr_b16 v[46:47],v177 offset:14592
s_waitcnt lgkmcnt(8)
s_add_u32 s36,s46,768
s_add_u32 m0,s39,0
s_nop 0
buffer_load_dwordx4 v24,s[8:11],s36 offen lds
s_add_u32 m0,s39,1024
s_add_u32 s36,s36,s45
buffer_load_dwordx4 v25,s[8:11],s36 offen lds
s_add_u32 m0,s39,2048
s_add_u32 s36,s36,s45
buffer_load_dwordx4 v25,s[8:11],s36 offen lds
s_add_u32 m0,s39,3072
s_add_u32 s36,s36,s45
buffer_load_dwordx4 v24,s[8:11],s36 offen lds
s_add_u32 m0,s39,4096
s_add_u32 s36,s36,s45
buffer_load_dwordx4 v24,s[8:11],s36 offen lds
s_add_u32 m0,s39,5120
s_add_u32 s36,s36,s45
buffer_load_dwordx4 v25,s[8:11],s36 offen lds
s_add_u32 m0,s39,6144
s_add_u32 s36,s36,s45
buffer_load_dwordx4 v25,s[8:11],s36 offen lds
s_add_u32 m0,s39,7168
s_add_u32 s36,s36,s45
buffer_load_dwordx4 v24,s[8:11],s36 offen lds
s_add_u32 s42,s47,s78
s_and_b32 s42,s42,s80
s_or_b32 s42,s42,s79
s_mul_i32 s42,s42,s31
s_add_u32 s42,s42,s30
s_cmp_lt_u32 s47,s28
s_cselect_b32 s14,s44,0
s_add_u32 s47,s47,1
s_add_u32 m0,s41,0
s_nop 0
buffer_load_dwordx4 v16,s[12:15],s42 offen lds
s_add_u32 m0,s41,1024
s_add_u32 s42,s42,s29
buffer_load_dwordx4 v16,s[12:15],s42 offen lds
s_add_u32 m0,s41,2048
s_add_u32 s42,s42,s29
buffer_load_dwordx4 v16,s[12:15],s42 offen lds
s_add_u32 m0,s41,3072
s_add_u32 s42,s42,s29
buffer_load_dwordx4 v16,s[12:15],s42 offen lds
s_add_u32 m0,s41,4096
s_add_u32 s42,s42,s29
buffer_load_dwordx4 v16,s[12:15],s42 offen lds
s_add_u32 m0,s41,5120
s_add_u32 s42,s42,s29
buffer_load_dwordx4 v16,s[12:15],s42 offen lds
s_add_u32 m0,s41,6144
s_add_u32 s42,s42,s29
buffer_load_dwordx4 v16,s[12:15],s42 offen lds
s_add_u32 m0,s41,7168
s_add_u32 s42,s42,s29
buffer_load_dwordx4 v16,s[12:15],s42 offen lds
s_add_u32 s41,s41,32768
s_sub_u32 s36,s41,131072
s_cmp_ge_u32 s41,131072
s_cselect_b32 s41,s36,s41
s_waitcnt lgkmcnt(0)
v_mfma_f32_16x16x32_bf16 v[64:67],v[32:35],a[96:99],v[64:67]
s_nop 0
v_mfma_f32_16x16x32_bf16 v[72:75],v[32:35],a[100:103],v[72:75]
v_mfma_f32_16x16x32_bf16 v[80:83],v[32:35],a[104:107],v[80:83]
v_mfma_f32_16x16x32_bf16 v[88:91],v[32:35],a[108:111],v[88:91]
v_mfma_f32_16x16x32_bf16 v[68:71],v[36:39],a[96:99],v[68:71]
v_mfma_f32_16x16x32_bf16 v[76:79],v[36:39],a[100:103],v[76:79]
v_mfma_f32_16x16x32_bf16 v[84:87],v[36:39],a[104:107],v[84:87]
v_mfma_f32_16x16x32_bf16 v[92:95],v[36:39],a[108:111],v[92:95]
v_mfma_f32_16x16x32_bf16 v[64:67],v[40:43],a[112:115],v[64:67]
v_mfma_f32_16x16x32_bf16 v[72:75],v[40:43],a[116:119],v[72:75]
v_mfma_f32_16x16x32_bf16 v[80:83],v[40:43],a[120:123],v[80:83]
v_mfma_f32_16x16x32_bf16 v[88:91],v[40:43],a[124:127],v[88:91]
v_mfma_f32_16x16x32_bf16 v[68:71],v[44:47],a[112:115],v[68:71]
v_mfma_f32_16x16x32_bf16 v[76:79],v[44:47],a[116:119],v[76:79]
v_mfma_f32_16x16x32_bf16 v[84:87],v[44:47],a[120:123],v[84:87]
v_mfma_f32_16x16x32_bf16 v[92:95],v[44:47],a[124:127],v[92:95]
s_waitcnt vmcnt(24)
ds_read_b128 a[128:131],v26 offset:8192
ds_read_b128 a[132:135],v27 offset:10240
ds_read_b128 a[136:139],v26 offset:12288
ds_read_b128 a[140:143],v27 offset:14336
ds_read_b128 a[144:147],v27 offset:8192
ds_read_b128 a[148:151],v26 offset:10240
ds_read_b128 a[152:155],v27 offset:12288
ds_read_b128 a[156:159],v26 offset:14336
s_waitcnt lgkmcnt(6)
ds_read_b64_tr_b16 v[32:33],v176 offset:16384
ds_read_b64_tr_b16 v[34:35],v176 offset:16640
ds_read_b64_tr_b16 v[36:37],v177 offset:16384
ds_read_b64_tr_b16 v[38:39],v177 offset:16640
ds_read_b64_tr_b16 v[40:41],v176 offset:18432
ds_read_b64_tr_b16 v[42:43],v176 offset:18688
ds_read_b64_tr_b16 v[44:45],v177 offset:18432
ds_read_b64_tr_b16 v[46:47],v177 offset:18688
s_waitcnt lgkmcnt(8)
s_add_u32 s36,s46,896
s_add_u32 m0,s39,8192
s_nop 0
buffer_load_dwordx4 v24,s[8:11],s36 offen lds
s_add_u32 m0,s39,9216
s_add_u32 s36,s36,s45
buffer_load_dwordx4 v25,s[8:11],s36 offen lds
s_add_u32 m0,s39,10240
s_add_u32 s36,s36,s45
buffer_load_dwordx4 v25,s[8:11],s36 offen lds
s_add_u32 m0,s39,11264
s_add_u32 s36,s36,s45
buffer_load_dwordx4 v24,s[8:11],s36 offen lds
s_add_u32 m0,s39,12288
s_add_u32 s36,s36,s45
buffer_load_dwordx4 v24,s[8:11],s36 offen lds
s_add_u32 m0,s39,13312
s_add_u32 s36,s36,s45
buffer_load_dwordx4 v25,s[8:11],s36 offen lds
s_add_u32 m0,s39,14336
s_add_u32 s36,s36,s45
buffer_load_dwordx4 v25,s[8:11],s36 offen lds
s_add_u32 m0,s39,15360
s_add_u32 s36,s36,s45
buffer_load_dwordx4 v24,s[8:11],s36 offen lds
s_waitcnt lgkmcnt(0)
v_mfma_f32_16x16x32_bf16 v[64:67],v[32:35],a[128:131],v[64:67]
v_mfma_f32_16x16x32_bf16 v[72:75],v[32:35],a[132:135],v[72:75]
v_mfma_f32_16x16x32_bf16 v[80:83],v[32:35],a[136:139],v[80:83]
v_mfma_f32_16x16x32_bf16 v[88:91],v[32:35],a[140:143],v[88:91]
v_mfma_f32_16x16x32_bf16 v[68:71],v[36:39],a[128:131],v[68:71]
v_mfma_f32_16x16x32_bf16 v[76:79],v[36:39],a[132:135],v[76:79]
v_mfma_f32_16x16x32_bf16 v[84:87],v[36:39],a[136:139],v[84:87]
v_mfma_f32_16x16x32_bf16 v[92:95],v[36:39],a[140:143],v[92:95]
v_mfma_f32_16x16x32_bf16 v[64:67],v[40:43],a[144:147],v[64:67]
v_mfma_f32_16x16x32_bf16 v[72:75],v[40:43],a[148:151],v[72:75]
v_mfma_f32_16x16x32_bf16 v[80:83],v[40:43],a[152:155],v[80:83]
v_mfma_f32_16x16x32_bf16 v[88:91],v[40:43],a[156:159],v[88:91]
v_mfma_f32_16x16x32_bf16 v[68:71],v[44:47],a[144:147],v[68:71]
v_mfma_f32_16x16x32_bf16 v[76:79],v[44:47],a[148:151],v[76:79]
v_mfma_f32_16x16x32_bf16 v[84:87],v[44:47],a[152:155],v[84:87]
v_mfma_f32_16x16x32_bf16 v[92:95],v[44:47],a[156:159],v[92:95]
s_waitcnt vmcnt(24)
ds_read_b128 a[160:163],v26 offset:16384
ds_read_b128 a[164:167],v27 offset:18432
ds_read_b128 a[168:171],v26 offset:20480
ds_read_b128 a[172:175],v27 offset:22528
ds_read_b128 a[176:179],v27 offset:16384
ds_read_b128 a[180:183],v26 offset:18432
ds_read_b128 a[184:187],v27 offset:20480
ds_read_b128 a[188:191],v26 offset:22528
s_waitcnt lgkmcnt(6)
ds_read_b64_tr_b16 v[32:33],v176 offset:20480
ds_read_b64_tr_b16 v[34:35],v176 offset:20736
ds_read_b64_tr_b16 v[36:37],v177 offset:20480
ds_read_b64_tr_b16 v[38:39],v177 offset:20736
ds_read_b64_tr_b16 v[40:41],v176 offset:22528
ds_read_b64_tr_b16 v[42:43],v176 offset:22784
ds_read_b64_tr_b16 v[44:45],v177 offset:22528
ds_read_b64_tr_b16 v[46:47],v177 offset:22784
s_waitcnt lgkmcnt(8)
s_waitcnt lgkmcnt(0)
v_mfma_f32_16x16x32_bf16 v[64:67],v[32:35],a[160:163],v[64:67]
v_mfma_f32_16x16x32_bf16 v[72:75],v[32:35],a[164:167],v[72:75]
v_mfma_f32_16x16x32_bf16 v[80:83],v[32:35],a[168:171],v[80:83]
v_mfma_f32_16x16x32_bf16 v[88:91],v[32:35],a[172:175],v[88:91]
v_mfma_f32_16x16x32_bf16 v[68:71],v[36:39],a[160:163],v[68:71]
v_mfma_f32_16x16x32_bf16 v[76:79],v[36:39],a[164:167],v[76:79]
v_mfma_f32_16x16x32_bf16 v[84:87],v[36:39],a[168:171],v[84:87]
v_mfma_f32_16x16x32_bf16 v[92:95],v[36:39],a[172:175],v[92:95]
v_mfma_f32_16x16x32_bf16 v[64:67],v[40:43],a[176:179],v[64:67]
v_mfma_f32_16x16x32_bf16 v[72:75],v[40:43],a[180:183],v[72:75]
v_mfma_f32_16x16x32_bf16 v[80:83],v[40:43],a[184:187],v[80:83]
v_mfma_f32_16x16x32_bf16 v[88:91],v[40:43],a[188:191],v[88:91]
v_mfma_f32_16x16x32_bf16 v[68:71],v[44:47],a[176:179],v[68:71]
v_mfma_f32_16x16x32_bf16 v[76:79],v[44:47],a[180:183],v[76:79]
v_mfma_f32_16x16x32_bf16 v[84:87],v[44:47],a[184:187],v[84:87]
v_mfma_f32_16x16x32_bf16 v[92:95],v[44:47],a[188:191],v[92:95]
s_waitcnt vmcnt(16)
ds_read_b128 a[192:195],v26 offset:0
ds_read_b128 a[196:199],v27 offset:2048
ds_read_b128 a[200:203],v26 offset:4096
ds_read_b128 a[204:207],v27 offset:6144
ds_read_b128 a[208:211],v27 offset:0
ds_read_b128 a[212:215],v26 offset:2048
ds_read_b128 a[216:219],v27 offset:4096
ds_read_b128 a[220:223],v26 offset:6144
s_waitcnt lgkmcnt(6)
ds_read_b64_tr_b16 v[32:33],v176 offset:24576
ds_read_b64_tr_b16 v[34:35],v176 offset:24832
ds_read_b64_tr_b16 v[36:37],v177 offset:24576
ds_read_b64_tr_b16 v[38:39],v177 offset:24832
ds_read_b64_tr_b16 v[40:41],v176 offset:26624
ds_read_b64_tr_b16 v[42:43],v176 offset:26880
ds_read_b64_tr_b16 v[44:45],v177 offset:26624
ds_read_b64_tr_b16 v[46:47],v177 offset:26880
s_waitcnt lgkmcnt(8)
s_waitcnt lgkmcnt(0)
v_mfma_f32_16x16x32_bf16 v[64:67],v[32:35],a[192:195],v[64:67]
v_mfma_f32_16x16x32_bf16 v[72:75],v[32:35],a[196:199],v[72:75]
v_mfma_f32_16x16x32_bf16 v[80:83],v[32:35],a[200:203],v[80:83]
v_mfma_f32_16x16x32_bf16 v[88:91],v[32:35],a[204:207],v[88:91]
v_mfma_f32_16x16x32_bf16 v[68:71],v[36:39],a[192:195],v[68:71]
v_mfma_f32_16x16x32_bf16 v[76:79],v[36:39],a[196:199],v[76:79]
v_mfma_f32_16x16x32_bf16 v[84:87],v[36:39],a[200:203],v[84:87]
v_mfma_f32_16x16x32_bf16 v[92:95],v[36:39],a[204:207],v[92:95]
v_mfma_f32_16x16x32_bf16 v[64:67],v[40:43],a[208:211],v[64:67]
v_mfma_f32_16x16x32_bf16 v[72:75],v[40:43],a[212:215],v[72:75]
v_mfma_f32_16x16x32_bf16 v[80:83],v[40:43],a[216:219],v[80:83]
v_mfma_f32_16x16x32_bf16 v[88:91],v[40:43],a[220:223],v[88:91]
v_mfma_f32_16x16x32_bf16 v[68:71],v[44:47],a[208:211],v[68:71]
v_mfma_f32_16x16x32_bf16 v[76:79],v[44:47],a[212:215],v[76:79]
v_mfma_f32_16x16x32_bf16 v[84:87],v[44:47],a[216:219],v[84:87]
v_mfma_f32_16x16x32_bf16 v[92:95],v[44:47],a[220:223],v[92:95]
s_waitcnt vmcnt(0)
ds_read_b128 a[224:227],v26 offset:8192
ds_read_b128 a[228:231],v27 offset:10240
ds_read_b128 a[232:235],v26 offset:12288
ds_read_b128 a[236:239],v27 offset:14336
ds_read_b128 a[240:243],v27 offset:8192
ds_read_b128 a[244:247],v26 offset:10240
ds_read_b128 a[248:251],v27 offset:12288
ds_read_b128 a[252:255],v26 offset:14336
s_waitcnt lgkmcnt(6)
ds_read_b64_tr_b16 v[32:33],v176 offset:28672
ds_read_b64_tr_b16 v[34:35],v176 offset:28928
ds_read_b64_tr_b16 v[36:37],v177 offset:28672
ds_read_b64_tr_b16 v[38:39],v177 offset:28928
ds_read_b64_tr_b16 v[40:41],v176 offset:30720
ds_read_b64_tr_b16 v[42:43],v176 offset:30976
ds_read_b64_tr_b16 v[44:45],v177 offset:30720
ds_read_b64_tr_b16 v[46:47],v177 offset:30976
s_waitcnt lgkmcnt(8)
s_waitcnt lgkmcnt(0)
v_mfma_f32_16x16x32_bf16 v[64:67],v[32:35],a[224:227],v[64:67]
v_mfma_f32_16x16x32_bf16 v[72:75],v[32:35],a[228:231],v[72:75]
v_mfma_f32_16x16x32_bf16 v[80:83],v[32:35],a[232:235],v[80:83]
v_mfma_f32_16x16x32_bf16 v[88:91],v[32:35],a[236:239],v[88:91]
v_mfma_f32_16x16x32_bf16 v[68:71],v[36:39],a[224:227],v[68:71]
v_mfma_f32_16x16x32_bf16 v[76:79],v[36:39],a[228:231],v[76:79]
v_mfma_f32_16x16x32_bf16 v[84:87],v[36:39],a[232:235],v[84:87]
v_mfma_f32_16x16x32_bf16 v[92:95],v[36:39],a[236:239],v[92:95]
v_mfma_f32_16x16x32_bf16 v[64:67],v[40:43],a[240:243],v[64:67]
v_mfma_f32_16x16x32_bf16 v[72:75],v[40:43],a[244:247],v[72:75]
v_mfma_f32_16x16x32_bf16 v[80:83],v[40:43],a[248:251],v[80:83]
v_mfma_f32_16x16x32_bf16 v[88:91],v[40:43],a[252:255],v[88:91]
v_mfma_f32_16x16x32_bf16 v[68:71],v[44:47],a[240:243],v[68:71]
v_mfma_f32_16x16x32_bf16 v[76:79],v[44:47],a[244:247],v[76:79]
v_mfma_f32_16x16x32_bf16 v[84:87],v[44:47],a[248:251],v[84:87]
v_mfma_f32_16x16x32_bf16 v[92:95],v[44:47],a[252:255],v[92:95]
s_barrier
ds_read_b64_tr_b16 v[32:33],v178 offset:0
ds_read_b64_tr_b16 v[34:35],v178 offset:256
ds_read_b64_tr_b16 v[36:37],v179 offset:0
ds_read_b64_tr_b16 v[38:39],v179 offset:256
ds_read_b64_tr_b16 v[40:41],v178 offset:2048
ds_read_b64_tr_b16 v[42:43],v178 offset:2304
ds_read_b64_tr_b16 v[44:45],v179 offset:2048
ds_read_b64_tr_b16 v[46:47],v179 offset:2304
s_add_u32 s42,s47,s78
s_and_b32 s42,s42,s80
s_or_b32 s42,s42,s79
s_mul_i32 s42,s42,s31
s_add_u32 s42,s42,s30
s_cmp_lt_u32 s47,s28
s_cselect_b32 s14,s44,0
s_add_u32 s47,s47,1
s_add_u32 m0,s41,0
s_nop 0
buffer_load_dwordx4 v16,s[12:15],s42 offen lds
s_add_u32 m0,s41,1024
s_add_u32 s42,s42,s29
buffer_load_dwordx4 v16,s[12:15],s42 offen lds
s_add_u32 m0,s41,2048
s_add_u32 s42,s42,s29
buffer_load_dwordx4 v16,s[12:15],s42 offen lds
s_add_u32 m0,s41,3072
s_add_u32 s42,s42,s29
buffer_load_dwordx4 v16,s[12:15],s42 offen lds
s_add_u32 m0,s41,4096
s_add_u32 s42,s42,s29
buffer_load_dwordx4 v16,s[12:15],s42 offen lds
s_add_u32 m0,s41,5120
s_add_u32 s42,s42,s29
buffer_load_dwordx4 v16,s[12:15],s42 offen lds
s_add_u32 m0,s41,6144
s_add_u32 s42,s42,s29
buffer_load_dwordx4 v16,s[12:15],s42 offen lds
s_add_u32 m0,s41,7168
s_add_u32 s42,s42,s29
buffer_load_dwordx4 v16,s[12:15],s42 offen lds
s_add_u32 s41,s41,32768
s_sub_u32 s36,s41,131072
s_cmp_ge_u32 s41,131072
s_cselect_b32 s41,s36,s41
s_lshl_b32 s37,s78,6
s_add_u32 s37,s37,256
s_and_b32 s37,s37,s92
s_add_u32 s93,s51,s37
buffer_load_dwordx4 v[180:183],v30,s[84:87],s93 offen
s_add_u32 s93,s93,s94
buffer_load_dwordx4 v[184:187],v30,s[84:87],s93 offen
s_add_u32 s93,s93,s94
buffer_load_dwordx4 v[188:191],v30,s[84:87],s93 offen
s_add_u32 s93,s93,s94
buffer_load_dwordx4 v[192:195],v30,s[84:87],s93 offen
s_add_u32 s93,s93,s94
s_mov_b32 s88,s12
s_mov_b32 s89,s13
s_mov_b32 s90,0
s_mov_b32 s91,0x20000
buffer_load_dword v204,v30,s[88:91],0 offen
buffer_load_dword v204,v30,s[88:91],0 offen
s_add_u32 s27,s27,1
k1_K_l1:
s_waitcnt lgkmcnt(4)
v_mfma_f32_16x16x32_bf16 v[96:99],v[32:35],a[0:3],0
ds_read_b64_tr_b16 v[48:49],v178 offset:4096
s_add_u32 s42,s47,s78
v_mfma_f32_16x16x32_bf16 v[104:107],v[32:35],a[4:7],0
ds_read_b64_tr_b16 v[50:51],v178 offset:4352
s_and_b32 s42,s42,s80
v_mfma_f32_16x16x32_bf16 v[112:115],v[32:35],a[8:11],0
ds_read_b64_tr_b16 v[52:53],v179 offset:4096
s_or_b32 s42,s42,s79
v_mfma_f32_16x16x32_bf16 v[120:123],v[32:35],a[12:15],0
ds_read_b64_tr_b16 v[54:55],v179 offset:4352
s_mul_i32 s42,s42,s31
v_mfma_f32_16x16x32_bf16 v[100:103],v[36:39],a[0:3],0
s_add_u32 s42,s42,s30
s_cmp_lt_u32 s47,s28
s_cselect_b32 s14,s44,0
v_mfma_f32_16x16x32_bf16 v[108:111],v[36:39],a[4:7],0
s_add_u32 s47,s47,1
s_add_u32 m0,s41,0
v_mfma_f32_16x16x32_bf16 v[116:119],v[36:39],a[8:11],0
v_mfma_f32_16x16x32_bf16 v[124:127],v[36:39],a[12:15],0
s_waitcnt lgkmcnt(4)
s_nop 0
v_mfma_f32_16x16x32_bf16 v[96:99],v[40:43],a[16:19],v[96:99]
ds_read_b64_tr_b16 v[56:57],v178 offset:6144
s_sub_u32 s37,s27,1
v_mfma_f32_16x16x32_bf16 v[104:107],v[40:43],a[20:23],v[104:107]
ds_read_b64_tr_b16 v[58:59],v178 offset:6400
s_add_u32 s37,s37,s78
v_mfma_f32_16x16x32_bf16 v[112:115],v[40:43],a[24:27],v[112:115]
ds_read_b64_tr_b16 v[60:61],v179 offset:6144
s_and_b32 s37,s37,s80
v_mfma_f32_16x16x32_bf16 v[120:123],v[40:43],a[28:31],v[120:123]
ds_read_b64_tr_b16 v[62:63],v179 offset:6400
s_or_b32 s37,s37,s79
v_mfma_f32_16x16x32_bf16 v[100:103],v[44:47],a[16:19],v[100:103]
buffer_load_dwordx4 v16,s[12:15],s42 offen lds
v_mfma_f32_16x16x32_bf16 v[108:111],v[44:47],a[20:23],v[108:111]
s_add_u32 m0,s41,1024
s_add_u32 s42,s42,s29
v_mfma_f32_16x16x32_bf16 v[116:119],v[44:47],a[24:27],v[116:119]
s_lshr_b32 s38,s37,2
s_mul_i32 s38,s38,s33
v_mfma_f32_16x16x32_bf16 v[124:127],v[44:47],a[28:31],v[124:127]
s_and_b32 s37,s37,3
s_waitcnt lgkmcnt(4)
v_mfma_f32_16x16x32_bf16 v[96:99],v[48:51],a[32:35],v[96:99]
ds_read_b64_tr_b16 v[32:33],v178 offset:8192
s_mul_i32 s37,s37,s34
v_mfma_f32_16x16x32_bf16 v[104:107],v[48:51],a[36:39],v[104:107]
ds_read_b64_tr_b16 v[34:35],v178 offset:8448
s_add_u32 s43,s37,s38
v_mfma_f32_16x16x32_bf16 v[112:115],v[48:51],a[40:43],v[112:115]
ds_read_b64_tr_b16 v[36:37],v179 offset:8192
s_add_u32 s43,s43,s32
v_mfma_f32_16x16x32_bf16 v[120:123],v[48:51],a[44:47],v[120:123]
ds_read_b64_tr_b16 v[38:39],v179 offset:8448
v_cvt_pk_bf16_f32 v128,v64,v65
v_mfma_f32_16x16x32_bf16 v[100:103],v[52:55],a[32:35],v[100:103]
buffer_load_dwordx4 v16,s[12:15],s42 offen lds
v_mfma_f32_16x16x32_bf16 v[108:111],v[52:55],a[36:39],v[108:111]
s_add_u32 m0,s41,2048
s_add_u32 s42,s42,s29
v_mfma_f32_16x16x32_bf16 v[116:119],v[52:55],a[40:43],v[116:119]
v_cvt_pk_bf16_f32 v129,v66,v67
v_cvt_pk_bf16_f32 v130,v68,v69
v_mfma_f32_16x16x32_bf16 v[124:127],v[52:55],a[44:47],v[124:127]
v_cvt_pk_bf16_f32 v131,v70,v71
s_waitcnt lgkmcnt(4)
v_mfma_f32_16x16x32_bf16 v[96:99],v[56:59],a[48:51],v[96:99]
ds_read_b64_tr_b16 v[40:41],v178 offset:10240
v_cvt_pk_bf16_f32 v132,v72,v73
v_mfma_f32_16x16x32_bf16 v[104:107],v[56:59],a[52:55],v[104:107]
ds_read_b64_tr_b16 v[42:43],v178 offset:10496
v_cvt_pk_bf16_f32 v133,v74,v75
v_mfma_f32_16x16x32_bf16 v[112:115],v[56:59],a[56:59],v[112:115]
ds_read_b64_tr_b16 v[44:45],v179 offset:10240
v_cvt_pk_bf16_f32 v134,v76,v77
v_mfma_f32_16x16x32_bf16 v[120:123],v[56:59],a[60:63],v[120:123]
ds_read_b64_tr_b16 v[46:47],v179 offset:10496
v_cvt_pk_bf16_f32 v135,v78,v79
v_mfma_f32_16x16x32_bf16 v[100:103],v[60:63],a[48:51],v[100:103]
buffer_load_dwordx4 v16,s[12:15],s42 offen lds
v_mfma_f32_16x16x32_bf16 v[108:111],v[60:63],a[52:55],v[108:111]
s_add_u32 m0,s41,3072
s_add_u32 s42,s42,s29
v_mfma_f32_16x16x32_bf16 v[116:119],v[60:63],a[56:59],v[116:119]
v_permlane16_swap_b32 v128,v130
v_permlane16_swap_b32 v129,v131
v_mfma_f32_16x16x32_bf16 v[124:127],v[60:63],a[60:63],v[124:127]
v_cvt_pk_bf16_f32 v136,v80,v81
s_waitcnt lgkmcnt(4)
v_mfma_f32_16x16x32_bf16 v[96:99],v[32:35],a[64:67],v[96:99]
ds_read_b64_tr_b16 v[48:49],v178 offset:12288
v_cvt_pk_bf16_f32 v137,v82,v83
v_mfma_f32_16x16x32_bf16 v[104:107],v[32:35],a[68:71],v[104:107]
ds_read_b64_tr_b16 v[50:51],v178 offset:12544
v_cvt_pk_bf16_f32 v138,v84,v85
v_mfma_f32_16x16x32_bf16 v[112:115],v[32:35],a[72:75],v[112:115]
ds_read_b64_tr_b16 v[52:53],v179 offset:12288
v_cvt_pk_bf16_f32 v139,v86,v87
v_mfma_f32_16x16x32_bf16 v[120:123],v[32:35],a[76:79],v[120:123]
ds_read_b64_tr_b16 v[54:55],v179 offset:12544
v_permlane16_swap_b32 v132,v134
v_mfma_f32_16x16x32_bf16 v[100:103],v[36:39],a[64:67],v[100:103]
buffer_load_dwordx4 v16,s[12:15],s42 offen lds
v_mfma_f32_16x16x32_bf16 v[108:111],v[36:39],a[68:71],v[108:111]
s_add_u32 m0,s41,4096
s_add_u32 s42,s42,s29
v_mfma_f32_16x16x32_bf16 v[116:119],v[36:39],a[72:75],v[116:119]
v_permlane16_swap_b32 v133,v135
v_cvt_pk_bf16_f32 v140,v88,v89
v_mfma_f32_16x16x32_bf16 v[124:127],v[36:39],a[76:79],v[124:127]
v_cvt_pk_bf16_f32 v141,v90,v91
s_waitcnt lgkmcnt(4)
v_mfma_f32_16x16x32_bf16 v[96:99],v[40:43],a[80:83],v[96:99]
ds_read_b64_tr_b16 v[56:57],v178 offset:14336
v_cvt_pk_bf16_f32 v142,v92,v93
v_mfma_f32_16x16x32_bf16 v[104:107],v[40:43],a[84:87],v[104:107]
ds_read_b64_tr_b16 v[58:59],v178 offset:14592
v_cvt_pk_bf16_f32 v143,v94,v95
v_mfma_f32_16x16x32_bf16 v[112:115],v[40:43],a[88:91],v[112:115]
ds_read_b64_tr_b16 v[60:61],v179 offset:14336
v_permlane16_swap_b32 v136,v138
v_mfma_f32_16x16x32_bf16 v[120:123],v[40:43],a[92:95],v[120:123]
ds_read_b64_tr_b16 v[62:63],v179 offset:14592
v_permlane16_swap_b32 v137,v139
v_mfma_f32_16x16x32_bf16 v[100:103],v[44:47],a[80:83],v[100:103]
buffer_load_dwordx4 v16,s[12:15],s42 offen lds
v_mfma_f32_16x16x32_bf16 v[108:111],v[44:47],a[84:87],v[108:111]
s_add_u32 m0,s41,5120
s_add_u32 s42,s42,s29
v_mfma_f32_16x16x32_bf16 v[116:119],v[44:47],a[88:91],v[116:119]
s_nop 1
v_permlane16_swap_b32 v140,v142
v_mfma_f32_16x16x32_bf16 v[124:127],v[44:47],a[92:95],v[124:127]
v_permlane16_swap_b32 v141,v143
s_waitcnt lgkmcnt(4)
v_mfma_f32_16x16x32_bf16 v[96:99],v[48:51],a[96:99],v[96:99]
ds_read_b64_tr_b16 v[32:33],v178 offset:16384
s_nop 0
v_mfma_f32_16x16x32_bf16 v[104:107],v[48:51],a[100:103],v[104:107]
ds_read_b64_tr_b16 v[34:35],v178 offset:16640
v_mfma_f32_16x16x32_bf16 v[112:115],v[48:51],a[104:107],v[112:115]
ds_read_b64_tr_b16 v[36:37],v179 offset:16384
v_mfma_f32_16x16x32_bf16 v[120:123],v[48:51],a[108:111],v[120:123]
ds_read_b64_tr_b16 v[38:39],v179 offset:16640
v_mfma_f32_16x16x32_bf16 v[100:103],v[52:55],a[96:99],v[100:103]
buffer_load_dwordx4 v16,s[12:15],s42 offen lds
v_mfma_f32_16x16x32_bf16 v[108:111],v[52:55],a[100:103],v[108:111]
s_add_u32 m0,s41,6144
s_add_u32 s42,s42,s29
v_mfma_f32_16x16x32_bf16 v[116:119],v[52:55],a[104:107],v[116:119]
s_nop 0
v_mfma_f32_16x16x32_bf16 v[124:127],v[52:55],a[108:111],v[124:127]
s_waitcnt lgkmcnt(4)
s_nop 0
v_mfma_f32_16x16x32_bf16 v[96:99],v[56:59],a[112:115],v[96:99]
ds_read_b64_tr_b16 v[40:41],v178 offset:18432
v_mfma_f32_16x16x32_bf16 v[104:107],v[56:59],a[116:119],v[104:107]
ds_read_b64_tr_b16 v[42:43],v178 offset:18688
v_mfma_f32_16x16x32_bf16 v[112:115],v[56:59],a[120:123],v[112:115]
ds_read_b64_tr_b16 v[44:45],v179 offset:18432
v_mfma_f32_16x16x32_bf16 v[120:123],v[56:59],a[124:127],v[120:123]
ds_read_b64_tr_b16 v[46:47],v179 offset:18688
v_mfma_f32_16x16x32_bf16 v[100:103],v[60:63],a[112:115],v[100:103]
buffer_load_dwordx4 v16,s[12:15],s42 offen lds
v_mfma_f32_16x16x32_bf16 v[108:111],v[60:63],a[116:119],v[108:111]
s_add_u32 m0,s41,7168
s_add_u32 s42,s42,s29
v_mfma_f32_16x16x32_bf16 v[116:119],v[60:63],a[120:123],v[116:119]
s_nop 0
v_mfma_f32_16x16x32_bf16 v[124:127],v[60:63],a[124:127],v[124:127]
s_waitcnt lgkmcnt(4)
s_nop 0
v_mfma_f32_16x16x32_bf16 v[96:99],v[32:35],a[128:131],v[96:99]
ds_read_b64_tr_b16 v[48:49],v178 offset:20480
v_mfma_f32_16x16x32_bf16 v[104:107],v[32:35],a[132:135],v[104:107]
ds_read_b64_tr_b16 v[50:51],v178 offset:20736
v_mfma_f32_16x16x32_bf16 v[112:115],v[32:35],a[136:139],v[112:115]
ds_read_b64_tr_b16 v[52:53],v179 offset:20480
v_mfma_f32_16x16x32_bf16 v[120:123],v[32:35],a[140:143],v[120:123]
ds_read_b64_tr_b16 v[54:55],v179 offset:20736
v_mfma_f32_16x16x32_bf16 v[100:103],v[36:39],a[128:131],v[100:103]
buffer_load_dwordx4 v16,s[12:15],s42 offen lds
v_mfma_f32_16x16x32_bf16 v[108:111],v[36:39],a[132:135],v[108:111]
s_add_u32 s41,s41,32768
s_sub_u32 s36,s41,131072
v_mfma_f32_16x16x32_bf16 v[116:119],v[36:39],a[136:139],v[116:119]
s_cmp_ge_u32 s41,131072
s_cselect_b32 s41,s36,s41
v_mfma_f32_16x16x32_bf16 v[124:127],v[36:39],a[140:143],v[124:127]
s_add_u32 s83,s83,256
s_waitcnt lgkmcnt(4)
v_mfma_f32_16x16x32_bf16 v[96:99],v[40:43],a[144:147],v[96:99]
ds_read_b64_tr_b16 v[56:57],v178 offset:22528
s_and_b32 s83,s83,s92
v_mfma_f32_16x16x32_bf16 v[104:107],v[40:43],a[148:151],v[104:107]
ds_read_b64_tr_b16 v[58:59],v178 offset:22784
s_sub_u32 s82,s82,1
v_mfma_f32_16x16x32_bf16 v[112:115],v[40:43],a[152:155],v[112:115]
ds_read_b64_tr_b16 v[60:61],v179 offset:22528
s_cmp_ge_i32 s82,0
s_cselect_b32 s86,s44,0
v_mfma_f32_16x16x32_bf16 v[120:123],v[40:43],a[156:159],v[120:123]
ds_read_b64_tr_b16 v[62:63],v179 offset:22784
s_add_u32 s93,s51,s83
v_mfma_f32_16x16x32_bf16 v[100:103],v[44:47],a[144:147],v[100:103]
buffer_load_dwordx4 v[180:183],v30,s[84:87],s93 offen
v_mfma_f32_16x16x32_bf16 v[108:111],v[44:47],a[148:151],v[108:111]
s_add_u32 s93,s93,s94
v_mfma_f32_16x16x32_bf16 v[116:119],v[44:47],a[152:155],v[116:119]
v_mfma_f32_16x16x32_bf16 v[124:127],v[44:47],a[156:159],v[124:127]
s_waitcnt lgkmcnt(4)
s_nop 0
v_mfma_f32_16x16x32_bf16 v[96:99],v[48:51],a[160:163],v[96:99]
ds_read_b64_tr_b16 v[32:33],v178 offset:24576
v_mfma_f32_16x16x32_bf16 v[104:107],v[48:51],a[164:167],v[104:107]
ds_read_b64_tr_b16 v[34:35],v178 offset:24832
v_mfma_f32_16x16x32_bf16 v[112:115],v[48:51],a[168:171],v[112:115]
ds_read_b64_tr_b16 v[36:37],v179 offset:24576
v_mfma_f32_16x16x32_bf16 v[120:123],v[48:51],a[172:175],v[120:123]
ds_read_b64_tr_b16 v[38:39],v179 offset:24832
v_mfma_f32_16x16x32_bf16 v[100:103],v[52:55],a[160:163],v[100:103]
buffer_load_dwordx4 v[184:187],v30,s[84:87],s93 offen
v_mfma_f32_16x16x32_bf16 v[108:111],v[52:55],a[164:167],v[108:111]
v_mfma_f32_16x16x32_bf16 v[116:119],v[52:55],a[168:171],v[116:119]
v_mfma_f32_16x16x32_bf16 v[124:127],v[52:55],a[172:175],v[124:127]
s_waitcnt lgkmcnt(4)
s_nop 0
v_mfma_f32_16x16x32_bf16 v[96:99],v[56:59],a[176:179],v[96:99]
ds_read_b64_tr_b16 v[40:41],v178 offset:26624
s_add_u32 s40,s40,32768
v_mfma_f32_16x16x32_bf16 v[104:107],v[56:59],a[180:183],v[104:107]
ds_read_b64_tr_b16 v[42:43],v178 offset:26880
s_cmp_ge_u32 s40,131072
s_cselect_b32 s40,0,s40
v_mfma_f32_16x16x32_bf16 v[112:115],v[56:59],a[184:187],v[112:115]
ds_read_b64_tr_b16 v[44:45],v179 offset:26624
v_add_u32 v176,s40,v19
v_mfma_f32_16x16x32_bf16 v[120:123],v[56:59],a[188:191],v[120:123]
ds_read_b64_tr_b16 v[46:47],v179 offset:26880
v_xor_b32 v177,32,v176
v_mfma_f32_16x16x32_bf16 v[100:103],v[60:63],a[176:179],v[100:103]
buffer_store_dwordx4 v[128:131],v20,s[20:23],s43 offen sc1
v_mfma_f32_16x16x32_bf16 v[108:111],v[60:63],a[180:183],v[108:111]
s_nop 0
v_mfma_f32_16x16x32_bf16 v[116:119],v[60:63],a[184:187],v[116:119]
v_mfma_f32_16x16x32_bf16 v[124:127],v[60:63],a[188:191],v[124:127]
s_waitcnt lgkmcnt(4)
s_nop 0
v_mfma_f32_16x16x32_bf16 v[96:99],v[32:35],a[192:195],v[96:99]
ds_read_b64_tr_b16 v[48:49],v178 offset:28672
v_mfma_f32_16x16x32_bf16 v[104:107],v[32:35],a[196:199],v[104:107]
ds_read_b64_tr_b16 v[50:51],v178 offset:28928
v_mfma_f32_16x16x32_bf16 v[112:115],v[32:35],a[200:203],v[112:115]
ds_read_b64_tr_b16 v[52:53],v179 offset:28672
v_mfma_f32_16x16x32_bf16 v[120:123],v[32:35],a[204:207],v[120:123]
ds_read_b64_tr_b16 v[54:55],v179 offset:28928
v_mfma_f32_16x16x32_bf16 v[100:103],v[36:39],a[192:195],v[100:103]
buffer_store_dwordx4 v[132:135],v21,s[20:23],s43 offen sc1
v_mfma_f32_16x16x32_bf16 v[108:111],v[36:39],a[196:199],v[108:111]
v_mfma_f32_16x16x32_bf16 v[116:119],v[36:39],a[200:203],v[116:119]
v_mfma_f32_16x16x32_bf16 v[124:127],v[36:39],a[204:207],v[124:127]
s_waitcnt lgkmcnt(4)
s_nop 0
v_mfma_f32_16x16x32_bf16 v[96:99],v[40:43],a[208:211],v[96:99]
ds_read_b64_tr_b16 v[56:57],v178 offset:30720
v_mfma_f32_16x16x32_bf16 v[104:107],v[40:43],a[212:215],v[104:107]
ds_read_b64_tr_b16 v[58:59],v178 offset:30976
v_mfma_f32_16x16x32_bf16 v[112:115],v[40:43],a[216:219],v[112:115]
ds_read_b64_tr_b16 v[60:61],v179 offset:30720
v_mfma_f32_16x16x32_bf16 v[120:123],v[40:43],a[220:223],v[120:123]
ds_read_b64_tr_b16 v[62:63],v179 offset:30976
v_mfma_f32_16x16x32_bf16 v[100:103],v[44:47],a[208:211],v[100:103]
buffer_store_dwordx4 v[136:139],v22,s[20:23],s43 offen sc1
v_mfma_f32_16x16x32_bf16 v[108:111],v[44:47],a[212:215],v[108:111]
v_mfma_f32_16x16x32_bf16 v[116:119],v[44:47],a[216:219],v[116:119]
v_mfma_f32_16x16x32_bf16 v[124:127],v[44:47],a[220:223],v[124:127]
s_waitcnt lgkmcnt(4)
s_nop 0
v_mfma_f32_16x16x32_bf16 v[96:99],v[48:51],a[224:227],v[96:99]
s_waitcnt vmcnt(19)
s_barrier
ds_read_b64_tr_b16 v[32:33],v176 offset:0
v_mfma_f32_16x16x32_bf16 v[104:107],v[48:51],a[228:231],v[104:107]
ds_read_b64_tr_b16 v[34:35],v176 offset:256
v_mfma_f32_16x16x32_bf16 v[112:115],v[48:51],a[232:235],v[112:115]
ds_read_b64_tr_b16 v[36:37],v177 offset:0
v_mfma_f32_16x16x32_bf16 v[120:123],v[48:51],a[236:239],v[120:123]
ds_read_b64_tr_b16 v[38:39],v177 offset:256
v_mfma_f32_16x16x32_bf16 v[100:103],v[52:55],a[224:227],v[100:103]
buffer_store_dwordx4 v[140:143],v23,s[20:23],s43 offen sc1
v_mfma_f32_16x16x32_bf16 v[108:111],v[52:55],a[228:231],v[108:111]
v_mfma_f32_16x16x32_bf16 v[116:119],v[52:55],a[232:235],v[116:119]
v_mfma_f32_16x16x32_bf16 v[124:127],v[52:55],a[236:239],v[124:127]
s_waitcnt lgkmcnt(4)
s_nop 0
v_mfma_f32_16x16x32_bf16 v[96:99],v[56:59],a[240:243],v[96:99]
ds_read_b64_tr_b16 v[40:41],v176 offset:2048
v_mfma_f32_16x16x32_bf16 v[104:107],v[56:59],a[244:247],v[104:107]
ds_read_b64_tr_b16 v[42:43],v176 offset:2304
v_mfma_f32_16x16x32_bf16 v[112:115],v[56:59],a[248:251],v[112:115]
ds_read_b64_tr_b16 v[44:45],v177 offset:2048
v_mfma_f32_16x16x32_bf16 v[120:123],v[56:59],a[252:255],v[120:123]
ds_read_b64_tr_b16 v[46:47],v177 offset:2304
v_mfma_f32_16x16x32_bf16 v[100:103],v[60:63],a[240:243],v[100:103]
v_mfma_f32_16x16x32_bf16 v[108:111],v[60:63],a[244:247],v[108:111]
v_mfma_f32_16x16x32_bf16 v[116:119],v[60:63],a[248:251],v[116:119]
v_mfma_f32_16x16x32_bf16 v[124:127],v[60:63],a[252:255],v[124:127]
s_add_u32 s27,s27,1
s_cmp_ge_u32 s27,s28
s_cbranch_scc1 k1_K_t1
s_waitcnt lgkmcnt(4)
v_mfma_f32_16x16x32_bf16 v[64:67],v[32:35],a[0:3],0
ds_read_b64_tr_b16 v[48:49],v176 offset:4096
s_add_u32 s42,s47,s78
v_mfma_f32_16x16x32_bf16 v[72:75],v[32:35],a[4:7],0
ds_read_b64_tr_b16 v[50:51],v176 offset:4352
s_and_b32 s42,s42,s80
v_mfma_f32_16x16x32_bf16 v[80:83],v[32:35],a[8:11],0
ds_read_b64_tr_b16 v[52:53],v177 offset:4096
s_or_b32 s42,s42,s79
v_mfma_f32_16x16x32_bf16 v[88:91],v[32:35],a[12:15],0
ds_read_b64_tr_b16 v[54:55],v177 offset:4352
s_mul_i32 s42,s42,s31
v_mfma_f32_16x16x32_bf16 v[68:71],v[36:39],a[0:3],0
s_add_u32 s42,s42,s30
s_cmp_lt_u32 s47,s28
s_cselect_b32 s14,s44,0
v_mfma_f32_16x16x32_bf16 v[76:79],v[36:39],a[4:7],0
s_add_u32 s47,s47,1
s_add_u32 m0,s41,0
v_mfma_f32_16x16x32_bf16 v[84:87],v[36:39],a[8:11],0
s_nop 0
v_mfma_f32_16x16x32_bf16 v[92:95],v[36:39],a[12:15],0
s_waitcnt lgkmcnt(4)
s_nop 0
v_mfma_f32_16x16x32_bf16 v[64:67],v[40:43],a[16:19],v[64:67]
ds_read_b64_tr_b16 v[56:57],v176 offset:6144
s_sub_u32 s37,s27,1
v_mfma_f32_16x16x32_bf16 v[72:75],v[40:43],a[20:23],v[72:75]
ds_read_b64_tr_b16 v[58:59],v176 offset:6400
s_add_u32 s37,s37,s78
v_mfma_f32_16x16x32_bf16 v[80:83],v[40:43],a[24:27],v[80:83]
ds_read_b64_tr_b16 v[60:61],v177 offset:6144
s_and_b32 s37,s37,s80
v_mfma_f32_16x16x32_bf16 v[88:91],v[40:43],a[28:31],v[88:91]
ds_read_b64_tr_b16 v[62:63],v177 offset:6400
s_or_b32 s37,s37,s79
v_mfma_f32_16x16x32_bf16 v[68:71],v[44:47],a[16:19],v[68:71]
buffer_load_dwordx4 v16,s[12:15],s42 offen lds
v_mfma_f32_16x16x32_bf16 v[76:79],v[44:47],a[20:23],v[76:79]
s_add_u32 m0,s41,1024
s_add_u32 s42,s42,s29
v_mfma_f32_16x16x32_bf16 v[84:87],v[44:47],a[24:27],v[84:87]
s_lshr_b32 s38,s37,2
s_mul_i32 s38,s38,s33
v_mfma_f32_16x16x32_bf16 v[92:95],v[44:47],a[28:31],v[92:95]
s_and_b32 s37,s37,3
s_waitcnt lgkmcnt(4)
v_mfma_f32_16x16x32_bf16 v[64:67],v[48:51],a[32:35],v[64:67]
ds_read_b64_tr_b16 v[32:33],v176 offset:8192
s_mul_i32 s37,s37,s34
v_mfma_f32_16x16x32_bf16 v[72:75],v[48:51],a[36:39],v[72:75]
ds_read_b64_tr_b16 v[34:35],v176 offset:8448
s_add_u32 s43,s37,s38
v_mfma_f32_16x16x32_bf16 v[80:83],v[48:51],a[40:43],v[80:83]
ds_read_b64_tr_b16 v[36:37],v177 offset:8192
s_add_u32 s43,s43,s32
v_mfma_f32_16x16x32_bf16 v[88:91],v[48:51],a[44:47],v[88:91]
ds_read_b64_tr_b16 v[38:39],v177 offset:8448
v_cvt_pk_bf16_f32 v128,v96,v97
v_mfma_f32_16x16x32_bf16 v[68:71],v[52:55],a[32:35],v[68:71]
buffer_load_dwordx4 v16,s[12:15],s42 offen lds
v_mfma_f32_16x16x32_bf16 v[76:79],v[52:55],a[36:39],v[76:79]
s_add_u32 m0,s41,2048
s_add_u32 s42,s42,s29
v_mfma_f32_16x16x32_bf16 v[84:87],v[52:55],a[40:43],v[84:87]
v_cvt_pk_bf16_f32 v129,v98,v99
v_cvt_pk_bf16_f32 v130,v100,v101
v_mfma_f32_16x16x32_bf16 v[92:95],v[52:55],a[44:47],v[92:95]
v_cvt_pk_bf16_f32 v131,v102,v103
s_waitcnt lgkmcnt(4)
v_mfma_f32_16x16x32_bf16 v[64:67],v[56:59],a[48:51],v[64:67]
ds_read_b64_tr_b16 v[40:41],v176 offset:10240
v_cvt_pk_bf16_f32 v132,v104,v105
v_mfma_f32_16x16x32_bf16 v[72:75],v[56:59],a[52:55],v[72:75]
ds_read_b64_tr_b16 v[42:43],v176 offset:10496
v_cvt_pk_bf16_f32 v133,v106,v107
v_mfma_f32_16x16x32_bf16 v[80:83],v[56:59],a[56:59],v[80:83]
ds_read_b64_tr_b16 v[44:45],v177 offset:10240
v_cvt_pk_bf16_f32 v134,v108,v109
v_mfma_f32_16x16x32_bf16 v[88:91],v[56:59],a[60:63],v[88:91]
ds_read_b64_tr_b16 v[46:47],v177 offset:10496
v_cvt_pk_bf16_f32 v135,v110,v111
v_mfma_f32_16x16x32_bf16 v[68:71],v[60:63],a[48:51],v[68:71]
buffer_load_dwordx4 v16,s[12:15],s42 offen lds
v_mfma_f32_16x16x32_bf16 v[76:79],v[60:63],a[52:55],v[76:79]
s_add_u32 m0,s41,3072
s_add_u32 s42,s42,s29
v_mfma_f32_16x16x32_bf16 v[84:87],v[60:63],a[56:59],v[84:87]
v_permlane16_swap_b32 v128,v130
v_permlane16_swap_b32 v129,v131
v_mfma_f32_16x16x32_bf16 v[92:95],v[60:63],a[60:63],v[92:95]
v_cvt_pk_bf16_f32 v136,v112,v113
s_waitcnt lgkmcnt(4)
v_mfma_f32_16x16x32_bf16 v[64:67],v[32:35],a[64:67],v[64:67]
ds_read_b64_tr_b16 v[48:49],v176 offset:12288
v_cvt_pk_bf16_f32 v137,v114,v115
v_mfma_f32_16x16x32_bf16 v[72:75],v[32:35],a[68:71],v[72:75]
ds_read_b64_tr_b16 v[50:51],v176 offset:12544
v_cvt_pk_bf16_f32 v138,v116,v117
v_mfma_f32_16x16x32_bf16 v[80:83],v[32:35],a[72:75],v[80:83]
ds_read_b64_tr_b16 v[52:53],v177 offset:12288
v_cvt_pk_bf16_f32 v139,v118,v119
v_mfma_f32_16x16x32_bf16 v[88:91],v[32:35],a[76:79],v[88:91]
ds_read_b64_tr_b16 v[54:55],v177 offset:12544
v_permlane16_swap_b32 v132,v134
v_mfma_f32_16x16x32_bf16 v[68:71],v[36:39],a[64:67],v[68:71]
buffer_load_dwordx4 v16,s[12:15],s42 offen lds
v_mfma_f32_16x16x32_bf16 v[76:79],v[36:39],a[68:71],v[76:79]
s_add_u32 m0,s41,4096
s_add_u32 s42,s42,s29
v_mfma_f32_16x16x32_bf16 v[84:87],v[36:39],a[72:75],v[84:87]
v_permlane16_swap_b32 v133,v135
v_cvt_pk_bf16_f32 v140,v120,v121
v_mfma_f32_16x16x32_bf16 v[92:95],v[36:39],a[76:79],v[92:95]
v_cvt_pk_bf16_f32 v141,v122,v123
s_waitcnt lgkmcnt(4)
v_mfma_f32_16x16x32_bf16 v[64:67],v[40:43],a[80:83],v[64:67]
ds_read_b64_tr_b16 v[56:57],v176 offset:14336
v_cvt_pk_bf16_f32 v142,v124,v125
v_mfma_f32_16x16x32_bf16 v[72:75],v[40:43],a[84:87],v[72:75]
ds_read_b64_tr_b16 v[58:59],v176 offset:14592
v_cvt_pk_bf16_f32 v143,v126,v127
v_mfma_f32_16x16x32_bf16 v[80:83],v[40:43],a[88:91],v[80:83]
ds_read_b64_tr_b16 v[60:61],v177 offset:14336
v_permlane16_swap_b32 v136,v138
v_mfma_f32_16x16x32_bf16 v[88:91],v[40:43],a[92:95],v[88:91]
ds_read_b64_tr_b16 v[62:63],v177 offset:14592
v_permlane16_swap_b32 v137,v139
v_mfma_f32_16x16x32_bf16 v[68:71],v[44:47],a[80:83],v[68:71]
buffer_load_dwordx4 v16,s[12:15],s42 offen lds
v_mfma_f32_16x16x32_bf16 v[76:79],v[44:47],a[84:87],v[76:79]
s_add_u32 m0,s41,5120
s_add_u32 s42,s42,s29
v_mfma_f32_16x16x32_bf16 v[84:87],v[44:47],a[88:91],v[84:87]
s_nop 1
v_permlane16_swap_b32 v140,v142
v_mfma_f32_16x16x32_bf16 v[92:95],v[44:47],a[92:95],v[92:95]
v_permlane16_swap_b32 v141,v143
s_waitcnt lgkmcnt(4)
v_mfma_f32_16x16x32_bf16 v[64:67],v[48:51],a[96:99],v[64:67]
ds_read_b64_tr_b16 v[32:33],v176 offset:16384
s_nop 0
v_mfma_f32_16x16x32_bf16 v[72:75],v[48:51],a[100:103],v[72:75]
ds_read_b64_tr_b16 v[34:35],v176 offset:16640
v_mfma_f32_16x16x32_bf16 v[80:83],v[48:51],a[104:107],v[80:83]
ds_read_b64_tr_b16 v[36:37],v177 offset:16384
v_mfma_f32_16x16x32_bf16 v[88:91],v[48:51],a[108:111],v[88:91]
ds_read_b64_tr_b16 v[38:39],v177 offset:16640
v_mfma_f32_16x16x32_bf16 v[68:71],v[52:55],a[96:99],v[68:71]
buffer_load_dwordx4 v16,s[12:15],s42 offen lds
v_mfma_f32_16x16x32_bf16 v[76:79],v[52:55],a[100:103],v[76:79]
s_add_u32 m0,s41,6144
s_add_u32 s42,s42,s29
v_mfma_f32_16x16x32_bf16 v[84:87],v[52:55],a[104:107],v[84:87]
s_nop 0
v_mfma_f32_16x16x32_bf16 v[92:95],v[52:55],a[108:111],v[92:95]
s_waitcnt lgkmcnt(4)
s_nop 0
v_mfma_f32_16x16x32_bf16 v[64:67],v[56:59],a[112:115],v[64:67]
ds_read_b64_tr_b16 v[40:41],v176 offset:18432
v_mfma_f32_16x16x32_bf16 v[72:75],v[56:59],a[116:119],v[72:75]
ds_read_b64_tr_b16 v[42:43],v176 offset:18688
v_mfma_f32_16x16x32_bf16 v[80:83],v[56:59],a[120:123],v[80:83]
ds_read_b64_tr_b16 v[44:45],v177 offset:18432
v_mfma_f32_16x16x32_bf16 v[88:91],v[56:59],a[124:127],v[88:91]
ds_read_b64_tr_b16 v[46:47],v177 offset:18688
v_mfma_f32_16x16x32_bf16 v[68:71],v[60:63],a[112:115],v[68:71]
buffer_load_dwordx4 v16,s[12:15],s42 offen lds
v_mfma_f32_16x16x32_bf16 v[76:79],v[60:63],a[116:119],v[76:79]
s_add_u32 m0,s41,7168
s_add_u32 s42,s42,s29
v_mfma_f32_16x16x32_bf16 v[84:87],v[60:63],a[120:123],v[84:87]
s_nop 0
v_mfma_f32_16x16x32_bf16 v[92:95],v[60:63],a[124:127],v[92:95]
s_waitcnt lgkmcnt(4)
s_nop 0
v_mfma_f32_16x16x32_bf16 v[64:67],v[32:35],a[128:131],v[64:67]
ds_read_b64_tr_b16 v[48:49],v176 offset:20480
v_mfma_f32_16x16x32_bf16 v[72:75],v[32:35],a[132:135],v[72:75]
ds_read_b64_tr_b16 v[50:51],v176 offset:20736
v_mfma_f32_16x16x32_bf16 v[80:83],v[32:35],a[136:139],v[80:83]
ds_read_b64_tr_b16 v[52:53],v177 offset:20480
v_mfma_f32_16x16x32_bf16 v[88:91],v[32:35],a[140:143],v[88:91]
ds_read_b64_tr_b16 v[54:55],v177 offset:20736
v_mfma_f32_16x16x32_bf16 v[68:71],v[36:39],a[128:131],v[68:71]
buffer_load_dwordx4 v16,s[12:15],s42 offen lds
v_mfma_f32_16x16x32_bf16 v[76:79],v[36:39],a[132:135],v[76:79]
s_add_u32 s41,s41,32768
s_sub_u32 s36,s41,131072
v_mfma_f32_16x16x32_bf16 v[84:87],v[36:39],a[136:139],v[84:87]
s_cmp_ge_u32 s41,131072
s_cselect_b32 s41,s36,s41
v_mfma_f32_16x16x32_bf16 v[92:95],v[36:39],a[140:143],v[92:95]
s_add_u32 s93,s93,s94
s_waitcnt lgkmcnt(4)
v_mfma_f32_16x16x32_bf16 v[64:67],v[40:43],a[144:147],v[64:67]
ds_read_b64_tr_b16 v[56:57],v176 offset:22528
s_nop 0
v_mfma_f32_16x16x32_bf16 v[72:75],v[40:43],a[148:151],v[72:75]
ds_read_b64_tr_b16 v[58:59],v176 offset:22784
v_mfma_f32_16x16x32_bf16 v[80:83],v[40:43],a[152:155],v[80:83]
ds_read_b64_tr_b16 v[60:61],v177 offset:22528
v_mfma_f32_16x16x32_bf16 v[88:91],v[40:43],a[156:159],v[88:91]
ds_read_b64_tr_b16 v[62:63],v177 offset:22784
v_mfma_f32_16x16x32_bf16 v[68:71],v[44:47],a[144:147],v[68:71]
buffer_load_dwordx4 v[180:183],v30,s[84:87],s93 offen
v_mfma_f32_16x16x32_bf16 v[76:79],v[44:47],a[148:151],v[76:79]
s_add_u32 s93,s93,s94
s_nop 0
v_mfma_f32_16x16x32_bf16 v[84:87],v[44:47],a[152:155],v[84:87]
v_mfma_f32_16x16x32_bf16 v[92:95],v[44:47],a[156:159],v[92:95]
s_waitcnt lgkmcnt(4)
s_nop 0
v_mfma_f32_16x16x32_bf16 v[64:67],v[48:51],a[160:163],v[64:67]
ds_read_b64_tr_b16 v[32:33],v176 offset:24576
v_mfma_f32_16x16x32_bf16 v[72:75],v[48:51],a[164:167],v[72:75]
ds_read_b64_tr_b16 v[34:35],v176 offset:24832
v_mfma_f32_16x16x32_bf16 v[80:83],v[48:51],a[168:171],v[80:83]
ds_read_b64_tr_b16 v[36:37],v177 offset:24576
v_mfma_f32_16x16x32_bf16 v[88:91],v[48:51],a[172:175],v[88:91]
ds_read_b64_tr_b16 v[38:39],v177 offset:24832
v_mfma_f32_16x16x32_bf16 v[68:71],v[52:55],a[160:163],v[68:71]
buffer_load_dwordx4 v[184:187],v30,s[84:87],s93 offen
v_mfma_f32_16x16x32_bf16 v[76:79],v[52:55],a[164:167],v[76:79]
v_mfma_f32_16x16x32_bf16 v[84:87],v[52:55],a[168:171],v[84:87]
v_mfma_f32_16x16x32_bf16 v[92:95],v[52:55],a[172:175],v[92:95]
s_waitcnt lgkmcnt(4)
s_nop 0
v_mfma_f32_16x16x32_bf16 v[64:67],v[56:59],a[176:179],v[64:67]
ds_read_b64_tr_b16 v[40:41],v176 offset:26624
s_add_u32 s40,s40,32768
v_mfma_f32_16x16x32_bf16 v[72:75],v[56:59],a[180:183],v[72:75]
ds_read_b64_tr_b16 v[42:43],v176 offset:26880
s_cmp_ge_u32 s40,131072
s_cselect_b32 s40,0,s40
v_mfma_f32_16x16x32_bf16 v[80:83],v[56:59],a[184:187],v[80:83]
ds_read_b64_tr_b16 v[44:45],v177 offset:26624
v_add_u32 v178,s40,v19
v_mfma_f32_16x16x32_bf16 v[88:91],v[56:59],a[188:191],v[88:91]
ds_read_b64_tr_b16 v[46:47],v177 offset:26880
v_xor_b32 v179,32,v178
v_mfma_f32_16x16x32_bf16 v[68:71],v[60:63],a[176:179],v[68:71]
buffer_store_dwordx4 v[128:131],v20,s[20:23],s43 offen sc1
v_mfma_f32_16x16x32_bf16 v[76:79],v[60:63],a[180:183],v[76:79]
s_nop 0
v_mfma_f32_16x16x32_bf16 v[84:87],v[60:63],a[184:187],v[84:87]
v_mfma_f32_16x16x32_bf16 v[92:95],v[60:63],a[188:191],v[92:95]
s_waitcnt lgkmcnt(4)
s_nop 0
v_mfma_f32_16x16x32_bf16 v[64:67],v[32:35],a[192:195],v[64:67]
ds_read_b64_tr_b16 v[48:49],v176 offset:28672
v_mfma_f32_16x16x32_bf16 v[72:75],v[32:35],a[196:199],v[72:75]
ds_read_b64_tr_b16 v[50:51],v176 offset:28928
v_mfma_f32_16x16x32_bf16 v[80:83],v[32:35],a[200:203],v[80:83]
ds_read_b64_tr_b16 v[52:53],v177 offset:28672
v_mfma_f32_16x16x32_bf16 v[88:91],v[32:35],a[204:207],v[88:91]
ds_read_b64_tr_b16 v[54:55],v177 offset:28928
v_mfma_f32_16x16x32_bf16 v[68:71],v[36:39],a[192:195],v[68:71]
buffer_store_dwordx4 v[132:135],v21,s[20:23],s43 offen sc1
v_mfma_f32_16x16x32_bf16 v[76:79],v[36:39],a[196:199],v[76:79]
v_mfma_f32_16x16x32_bf16 v[84:87],v[36:39],a[200:203],v[84:87]
v_mfma_f32_16x16x32_bf16 v[92:95],v[36:39],a[204:207],v[92:95]
s_waitcnt lgkmcnt(4)
s_nop 0
v_mfma_f32_16x16x32_bf16 v[64:67],v[40:43],a[208:211],v[64:67]
ds_read_b64_tr_b16 v[56:57],v176 offset:30720
v_mfma_f32_16x16x32_bf16 v[72:75],v[40:43],a[212:215],v[72:75]
ds_read_b64_tr_b16 v[58:59],v176 offset:30976
v_mfma_f32_16x16x32_bf16 v[80:83],v[40:43],a[216:219],v[80:83]
ds_read_b64_tr_b16 v[60:61],v177 offset:30720
v_mfma_f32_16x16x32_bf16 v[88:91],v[40:43],a[220:223],v[88:91]
ds_read_b64_tr_b16 v[62:63],v177 offset:30976
v_mfma_f32_16x16x32_bf16 v[68:71],v[44:47],a[208:211],v[68:71]
buffer_store_dwordx4 v[136:139],v22,s[20:23],s43 offen sc1
v_mfma_f32_16x16x32_bf16 v[76:79],v[44:47],a[212:215],v[76:79]
v_mfma_f32_16x16x32_bf16 v[84:87],v[44:47],a[216:219],v[84:87]
v_mfma_f32_16x16x32_bf16 v[92:95],v[44:47],a[220:223],v[92:95]
s_waitcnt lgkmcnt(4)
s_nop 0
v_mfma_f32_16x16x32_bf16 v[64:67],v[48:51],a[224:227],v[64:67]
s_waitcnt vmcnt(19)
s_barrier
ds_read_b64_tr_b16 v[32:33],v178 offset:0
v_mfma_f32_16x16x32_bf16 v[72:75],v[48:51],a[228:231],v[72:75]
ds_read_b64_tr_b16 v[34:35],v178 offset:256
v_mfma_f32_16x16x32_bf16 v[80:83],v[48:51],a[232:235],v[80:83]
ds_read_b64_tr_b16 v[36:37],v179 offset:0
v_mfma_f32_16x16x32_bf16 v[88:91],v[48:51],a[236:239],v[88:91]
ds_read_b64_tr_b16 v[38:39],v179 offset:256
v_mfma_f32_16x16x32_bf16 v[68:71],v[52:55],a[224:227],v[68:71]
buffer_store_dwordx4 v[140:143],v23,s[20:23],s43 offen sc1
v_mfma_f32_16x16x32_bf16 v[76:79],v[52:55],a[228:231],v[76:79]
v_mfma_f32_16x16x32_bf16 v[84:87],v[52:55],a[232:235],v[84:87]
v_mfma_f32_16x16x32_bf16 v[92:95],v[52:55],a[236:239],v[92:95]
s_waitcnt lgkmcnt(4)
s_nop 0
v_mfma_f32_16x16x32_bf16 v[64:67],v[56:59],a[240:243],v[64:67]
ds_read_b64_tr_b16 v[40:41],v178 offset:2048
v_mfma_f32_16x16x32_bf16 v[72:75],v[56:59],a[244:247],v[72:75]
ds_read_b64_tr_b16 v[42:43],v178 offset:2304
v_mfma_f32_16x16x32_bf16 v[80:83],v[56:59],a[248:251],v[80:83]
ds_read_b64_tr_b16 v[44:45],v179 offset:2048
v_mfma_f32_16x16x32_bf16 v[88:91],v[56:59],a[252:255],v[88:91]
ds_read_b64_tr_b16 v[46:47],v179 offset:2304
v_mfma_f32_16x16x32_bf16 v[68:71],v[60:63],a[240:243],v[68:71]
v_mfma_f32_16x16x32_bf16 v[76:79],v[60:63],a[244:247],v[76:79]
v_mfma_f32_16x16x32_bf16 v[84:87],v[60:63],a[248:251],v[84:87]
v_mfma_f32_16x16x32_bf16 v[92:95],v[60:63],a[252:255],v[92:95]
s_add_u32 s27,s27,1
s_cmp_lt_u32 s27,s28
s_cbranch_scc1 k1_K_l1
s_waitcnt lgkmcnt(0)
s_nop 7
s_sub_u32 s37,s27,1
s_add_u32 s37,s37,s78
s_and_b32 s37,s37,s80
s_or_b32 s37,s37,s79
s_lshr_b32 s38,s37,2
s_mul_i32 s38,s38,s33
s_and_b32 s37,s37,3
s_mul_i32 s37,s37,s34
s_add_u32 s43,s37,s38
s_add_u32 s43,s43,s32
v_cvt_pk_bf16_f32 v128,v64,v65
v_cvt_pk_bf16_f32 v129,v66,v67
v_cvt_pk_bf16_f32 v130,v68,v69
v_cvt_pk_bf16_f32 v131,v70,v71
v_cvt_pk_bf16_f32 v132,v72,v73
v_cvt_pk_bf16_f32 v133,v74,v75
v_cvt_pk_bf16_f32 v134,v76,v77
v_cvt_pk_bf16_f32 v135,v78,v79
v_permlane16_swap_b32 v128,v130
v_permlane16_swap_b32 v129,v131
v_cvt_pk_bf16_f32 v136,v80,v81
v_cvt_pk_bf16_f32 v137,v82,v83
v_cvt_pk_bf16_f32 v138,v84,v85
v_cvt_pk_bf16_f32 v139,v86,v87
v_permlane16_swap_b32 v132,v134
v_permlane16_swap_b32 v133,v135
v_cvt_pk_bf16_f32 v140,v88,v89
v_cvt_pk_bf16_f32 v141,v90,v91
v_cvt_pk_bf16_f32 v142,v92,v93
v_cvt_pk_bf16_f32 v143,v94,v95
v_permlane16_swap_b32 v136,v138
v_permlane16_swap_b32 v137,v139
s_nop 1
v_permlane16_swap_b32 v140,v142
v_permlane16_swap_b32 v141,v143
buffer_store_dwordx4 v[128:131],v20,s[20:23],s43 offen sc1
buffer_store_dwordx4 v[132:135],v21,s[20:23],s43 offen sc1
buffer_store_dwordx4 v[136:139],v22,s[20:23],s43 offen sc1
buffer_store_dwordx4 v[140:143],v23,s[20:23],s43 offen sc1
s_branch k1_end
k1_K_t1:
s_waitcnt lgkmcnt(0)
s_nop 7
s_sub_u32 s37,s27,1
s_add_u32 s37,s37,s78
s_and_b32 s37,s37,s80
s_or_b32 s37,s37,s79
s_lshr_b32 s38,s37,2
s_mul_i32 s38,s38,s33
s_and_b32 s37,s37,3
s_mul_i32 s37,s37,s34
s_add_u32 s43,s37,s38
s_add_u32 s43,s43,s32
v_cvt_pk_bf16_f32 v128,v96,v97
v_cvt_pk_bf16_f32 v129,v98,v99
v_cvt_pk_bf16_f32 v130,v100,v101
v_cvt_pk_bf16_f32 v131,v102,v103
v_cvt_pk_bf16_f32 v132,v104,v105
v_cvt_pk_bf16_f32 v133,v106,v107
v_cvt_pk_bf16_f32 v134,v108,v109
v_cvt_pk_bf16_f32 v135,v110,v111
v_permlane16_swap_b32 v128,v130
v_permlane16_swap_b32 v129,v131
v_cvt_pk_bf16_f32 v136,v112,v113
v_cvt_pk_bf16_f32 v137,v114,v115
v_cvt_pk_bf16_f32 v138,v116,v117
v_cvt_pk_bf16_f32 v139,v118,v119
v_permlane16_swap_b32 v132,v134
v_permlane16_swap_b32 v133,v135
v_cvt_pk_bf16_f32 v140,v120,v121
v_cvt_pk_bf16_f32 v141,v122,v123
v_cvt_pk_bf16_f32 v142,v124,v125
v_cvt_pk_bf16_f32 v143,v126,v127
v_permlane16_swap_b32 v136,v138
v_permlane16_swap_b32 v137,v139
s_nop 1
v_permlane16_swap_b32 v140,v142
v_permlane16_swap_b32 v141,v143
buffer_store_dwordx4 v[128:131],v20,s[20:23],s43 offen sc1
buffer_store_dwordx4 v[132:135],v21,s[20:23],s43 offen sc1
buffer_store_dwordx4 v[136:139],v22,s[20:23],s43 offen sc1
buffer_store_dwordx4 v[140:143],v23,s[20:23],s43 offen sc1
s_branch k1_end
k1_typeV:
v_and_b32 v2,15,v1
v_lshlrev_b32 v2,4,v2
v_bfe_u32 v3,v1,4,1
v_lshrrev_b32 v4,5,v1
v_lshlrev_b32 v3,9,v3
v_lshl_add_u32 v9,v4,10,v3
v_add_u32 v20,v2,v9
v_add_u32 v21,256,v20
v_add_u32 v22,16384,v20
v_add_u32 v23,16384,v21
s_add_u32 s32,s32,8192
s_waitcnt lgkmcnt(0)
s_mov_b32 s12,s66
s_mov_b32 s13,s67
s_mov_b32 s14,4194304
s_mov_b32 s15,0x20000
s_mov_b32 s8,s60
s_mov_b32 s9,s61
s_mov_b32 s10,2097152
s_mov_b32 s11,0x20000
s_mov_b32 s16,s74
s_mov_b32 s17,s75
s_mov_b32 s18,268435456
s_mov_b32 s19,0x20000
s_mov_b32 s20,s74
s_mov_b32 s21,s75
s_mov_b32 s22,268435456
s_mov_b32 s23,0x20000
k1_V:
s_mul_i32 s39,s24,24576
s_add_u32 s39,s39,65536
s_add_u32 s42,s47,s78
s_and_b32 s42,s42,s80
s_or_b32 s42,s42,s79
s_mul_i32 s42,s42,s31
s_add_u32 s42,s42,s30
s_cmp_lt_u32 s47,s28
s_cselect_b32 s14,s44,0
s_add_u32 s47,s47,1
s_add_u32 m0,s41,0
s_nop 0
buffer_load_dwordx4 v16,s[12:15],s42 offen lds
s_add_u32 m0,s41,1024
s_add_u32 s42,s42,s29
buffer_load_dwordx4 v16,s[12:15],s42 offen lds
s_add_u32 m0,s41,2048
s_add_u32 s42,s42,s29
buffer_load_dwordx4 v16,s[12:15],s42 offen lds
s_add_u32 m0,s41,3072
s_add_u32 s42,s42,s29
buffer_load_dwordx4 v16,s[12:15],s42 offen lds
s_add_u32 m0,s41,4096
s_add_u32 s42,s42,s29
buffer_load_dwordx4 v16,s[12:15],s42 offen lds
s_add_u32 m0,s41,5120
s_add_u32 s42,s42,s29
buffer_load_dwordx4 v16,s[12:15],s42 offen lds
s_add_u32 m0,s41,6144
s_add_u32 s42,s42,s29
buffer_load_dwordx4 v16,s[12:15],s42 offen lds
s_add_u32 m0,s41,7168
s_add_u32 s42,s42,s29
buffer_load_dwordx4 v16,s[12:15],s42 offen lds
s_add_u32 s41,s41,32768
s_sub_u32 s36,s41,131072
s_cmp_ge_u32 s41,131072
s_cselect_b32 s41,s36,s41
s_lshr_b32 s37,s2,3
s_and_b32 s37,s37,7
s_lshl_b32 s37,s37,2
s_add_u32 s37,s37,s24
s_lshl_b32 s38,s25,5
s_add_u32 s37,s37,s38
s_mul_i32 s37,s37,8192
v_lshlrev_b32 v2,4,v1
buffer_load_dwordx4 v[180:183],v2,s[8:11],s37 offen offset:0
buffer_load_dwordx4 v[184:187],v2,s[8:11],s37 offen offset:1024
buffer_load_dwordx4 v[188:191],v2,s[8:11],s37 offen offset:2048
buffer_load_dwordx4 v[192:195],v2,s[8:11],s37 offen offset:3072
s_add_u32 s37,s37,4096
buffer_load_dwordx4 v[196:199],v2,s[8:11],s37 offen offset:0
buffer_load_dwordx4 v[200:203],v2,s[8:11],s37 offen offset:1024
buffer_load_dwordx4 v[204:207],v2,s[8:11],s37 offen offset:2048
buffer_load_dwordx4 v[208:211],v2,s[8:11],s37 offen offset:3072
s_add_u32 s37,s37,4096
s_add_u32 s36,s46,0
s_add_u32 m0,s39,0
s_nop 0
buffer_load_dwordx4 v24,s[8:11],s36 offen lds
s_add_u32 m0,s39,1024
s_add_u32 s36,s36,s45
buffer_load_dwordx4 v25,s[8:11],s36 offen lds
s_add_u32 m0,s39,2048
s_add_u32 s36,s36,s45
buffer_load_dwordx4 v25,s[8:11],s36 offen lds
s_add_u32 m0,s39,3072
s_add_u32 s36,s36,s45
buffer_load_dwordx4 v24,s[8:11],s36 offen lds
s_add_u32 m0,s39,4096
s_add_u32 s36,s36,s45
buffer_load_dwordx4 v24,s[8:11],s36 offen lds
s_add_u32 m0,s39,5120
s_add_u32 s36,s36,s45
buffer_load_dwordx4 v25,s[8:11],s36 offen lds
s_add_u32 m0,s39,6144
s_add_u32 s36,s36,s45
buffer_load_dwordx4 v25,s[8:11],s36 offen lds
s_add_u32 m0,s39,7168
s_add_u32 s36,s36,s45
buffer_load_dwordx4 v24,s[8:11],s36 offen lds
s_add_u32 s36,s46,128
s_add_u32 m0,s39,8192
s_nop 0
buffer_load_dwordx4 v24,s[8:11],s36 offen lds
s_add_u32 m0,s39,9216
s_add_u32 s36,s36,s45
buffer_load_dwordx4 v25,s[8:11],s36 offen lds
s_add_u32 m0,s39,10240
s_add_u32 s36,s36,s45
buffer_load_dwordx4 v25,s[8:11],s36 offen lds
s_add_u32 m0,s39,11264
s_add_u32 s36,s36,s45
buffer_load_dwordx4 v24,s[8:11],s36 offen lds
s_add_u32 m0,s39,12288
s_add_u32 s36,s36,s45
buffer_load_dwordx4 v24,s[8:11],s36 offen lds
s_add_u32 m0,s39,13312
s_add_u32 s36,s36,s45
buffer_load_dwordx4 v25,s[8:11],s36 offen lds
s_add_u32 m0,s39,14336
s_add_u32 s36,s36,s45
buffer_load_dwordx4 v25,s[8:11],s36 offen lds
s_add_u32 m0,s39,15360
s_add_u32 s36,s36,s45
buffer_load_dwordx4 v24,s[8:11],s36 offen lds
s_add_u32 s36,s46,256
s_add_u32 m0,s39,16384
s_nop 0
buffer_load_dwordx4 v24,s[8:11],s36 offen lds
s_add_u32 m0,s39,17408
s_add_u32 s36,s36,s45
buffer_load_dwordx4 v25,s[8:11],s36 offen lds
s_add_u32 m0,s39,18432
s_add_u32 s36,s36,s45
buffer_load_dwordx4 v25,s[8:11],s36 offen lds
s_add_u32 m0,s39,19456
s_add_u32 s36,s36,s45
buffer_load_dwordx4 v24,s[8:11],s36 offen lds
s_add_u32 m0,s39,20480
s_add_u32 s36,s36,s45
buffer_load_dwordx4 v24,s[8:11],s36 offen lds
s_add_u32 m0,s39,21504
s_add_u32 s36,s36,s45
buffer_load_dwordx4 v25,s[8:11],s36 offen lds
s_add_u32 m0,s39,22528
s_add_u32 s36,s36,s45
buffer_load_dwordx4 v25,s[8:11],s36 offen lds
s_add_u32 m0,s39,23552
s_add_u32 s36,s36,s45
buffer_load_dwordx4 v24,s[8:11],s36 offen lds
v_bfe_u32 v2,v1,3,1
v_lshlrev_b32 v2,10,v2
v_add_u32 v26,v2,v26
v_add_u32_e64 v26,s39,v26
v_xor_b32 v27,64,v26
s_lshr_b32 s81,s29,4
s_lshr_b32 s94,s29,2
s_lshr_b32 s51,s49,1
s_mul_i32 s51,s51,16
s_mul_i32 s51,s51,s81
s_mul_i32 s37,s27,s31
s_add_u32 s51,s51,s37
s_add_u32 s51,s51,s76
s_mov_b32 s84,s12
s_mov_b32 s85,s13
s_mov_b32 s86,s44
s_mov_b32 s87,0x20000
s_sub_u32 s82,s28,s27
s_mul_i32 s82,s82,s31
s_add_u32 s82,s82,-130
s_lshr_b32 s82,s82,8
s_min_u32 s82,s82,2
s_lshl_b32 s37,s78,6
s_lshl_b32 s92,s80,6
s_or_b32 s92,s92,63
s_add_u32 s83,s37,256
v_and_b32 v2,31,v1
v_lshlrev_b32 v2,4,v2
v_add_u32 v2,s37,v2
v_and_b32 v2,s92,v2
v_lshrrev_b32 v3,5,v1
v_mul_lo_u32 v3,v3,s81
v_add_u32 v31,v2,v3
v_and_b32 v2,15,v1
v_lshlrev_b32 v2,4,v2
v_lshrrev_b32 v3,4,v1
v_mul_lo_u32 v3,v3,s81
v_add_u32 v30,v2,v3
v_mov_b32_e64 v176,v19
v_xor_b32 v177,32,v19
s_mov_b32 s40,32768
v_add_u32 v178,s40,v19
v_xor_b32 v179,32,v178
s_lshl_b32 s37,s78,6
s_add_u32 s37,s37,0
s_and_b32 s37,s37,s92
s_add_u32 s93,s51,s37
buffer_load_dwordx4 v[180:183],v30,s[84:87],s93 offen
s_add_u32 s93,s93,s94
buffer_load_dwordx4 v[184:187],v30,s[84:87],s93 offen
s_add_u32 s93,s93,s94
buffer_load_dwordx4 v[188:191],v30,s[84:87],s93 offen
s_add_u32 s93,s93,s94
buffer_load_dwordx4 v[192:195],v30,s[84:87],s93 offen
s_add_u32 s93,s93,s94
s_waitcnt vmcnt(20)
s_barrier
ds_read_b128 a[0:3],v26 offset:0
ds_read_b128 a[4:7],v27 offset:1024
ds_read_b128 a[8:11],v26 offset:4096
ds_read_b128 a[12:15],v27 offset:5120
ds_read_b128 a[16:19],v27 offset:0
ds_read_b128 a[20:23],v26 offset:1024
ds_read_b128 a[24:27],v27 offset:4096
ds_read_b128 a[28:31],v26 offset:5120
s_waitcnt lgkmcnt(6)
ds_read_b64_tr_b16 v[32:33],v176 offset:0
ds_read_b64_tr_b16 v[34:35],v176 offset:256
ds_read_b64_tr_b16 v[36:37],v177 offset:0
ds_read_b64_tr_b16 v[38:39],v177 offset:256
ds_read_b64_tr_b16 v[40:41],v176 offset:2048
ds_read_b64_tr_b16 v[42:43],v176 offset:2304
ds_read_b64_tr_b16 v[44:45],v177 offset:2048
ds_read_b64_tr_b16 v[46:47],v177 offset:2304
s_waitcnt lgkmcnt(8)
s_add_u32 s36,s46,384
s_add_u32 m0,s39,0
s_nop 0
buffer_load_dwordx4 v24,s[8:11],s36 offen lds
s_add_u32 m0,s39,1024
s_add_u32 s36,s36,s45
buffer_load_dwordx4 v25,s[8:11],s36 offen lds
s_add_u32 m0,s39,2048
s_add_u32 s36,s36,s45
buffer_load_dwordx4 v25,s[8:11],s36 offen lds
s_add_u32 m0,s39,3072
s_add_u32 s36,s36,s45
buffer_load_dwordx4 v24,s[8:11],s36 offen lds
s_add_u32 m0,s39,4096
s_add_u32 s36,s36,s45
buffer_load_dwordx4 v24,s[8:11],s36 offen lds
s_add_u32 m0,s39,5120
s_add_u32 s36,s36,s45
buffer_load_dwordx4 v25,s[8:11],s36 offen lds
s_add_u32 m0,s39,6144
s_add_u32 s36,s36,s45
buffer_load_dwordx4 v25,s[8:11],s36 offen lds
s_add_u32 m0,s39,7168
s_add_u32 s36,s36,s45
buffer_load_dwordx4 v24,s[8:11],s36 offen lds
s_waitcnt lgkmcnt(0)
v_mfma_f32_16x16x32_bf16 v[64:67],a[0:3],v[32:35],0
v_mfma_f32_16x16x32_bf16 v[72:75],a[4:7],v[32:35],0
v_mfma_f32_16x16x32_bf16 v[80:83],a[8:11],v[32:35],0
v_mfma_f32_16x16x32_bf16 v[88:91],a[12:15],v[32:35],0
v_mfma_f32_16x16x32_bf16 v[68:71],a[0:3],v[36:39],0
v_mfma_f32_16x16x32_bf16 v[76:79],a[4:7],v[36:39],0
v_mfma_f32_16x16x32_bf16 v[84:87],a[8:11],v[36:39],0
v_mfma_f32_16x16x32_bf16 v[92:95],a[12:15],v[36:39],0
v_mfma_f32_16x16x32_bf16 v[64:67],a[16:19],v[40:43],v[64:67]
v_mfma_f32_16x16x32_bf16 v[72:75],a[20:23],v[40:43],v[72:75]
v_mfma_f32_16x16x32_bf16 v[80:83],a[24:27],v[40:43],v[80:83]
v_mfma_f32_16x16x32_bf16 v[88:91],a[28:31],v[40:43],v[88:91]
v_mfma_f32_16x16x32_bf16 v[68:71],a[16:19],v[44:47],v[68:71]
v_mfma_f32_16x16x32_bf16 v[76:79],a[20:23],v[44:47],v[76:79]
v_mfma_f32_16x16x32_bf16 v[84:87],a[24:27],v[44:47],v[84:87]
v_mfma_f32_16x16x32_bf16 v[92:95],a[28:31],v[44:47],v[92:95]
s_waitcnt vmcnt(20)
ds_read_b128 a[32:35],v26 offset:8192
ds_read_b128 a[36:39],v27 offset:9216
ds_read_b128 a[40:43],v26 offset:12288
ds_read_b128 a[44:47],v27 offset:13312
ds_read_b128 a[48:51],v27 offset:8192
ds_read_b128 a[52:55],v26 offset:9216
ds_read_b128 a[56:59],v27 offset:12288
ds_read_b128 a[60:63],v26 offset:13312
s_waitcnt lgkmcnt(6)
ds_read_b64_tr_b16 v[32:33],v176 offset:4096
ds_read_b64_tr_b16 v[34:35],v176 offset:4352
ds_read_b64_tr_b16 v[36:37],v177 offset:4096
ds_read_b64_tr_b16 v[38:39],v177 offset:4352
ds_read_b64_tr_b16 v[40:41],v176 offset:6144
ds_read_b64_tr_b16 v[42:43],v176 offset:6400
ds_read_b64_tr_b16 v[44:45],v177 offset:6144
ds_read_b64_tr_b16 v[46:47],v177 offset:6400
s_waitcnt lgkmcnt(8)
s_add_u32 s36,s46,512
s_add_u32 m0,s39,8192
s_nop 0
buffer_load_dwordx4 v24,s[8:11],s36 offen lds
s_add_u32 m0,s39,9216
s_add_u32 s36,s36,s45
buffer_load_dwordx4 v25,s[8:11],s36 offen lds
s_add_u32 m0,s39,10240
s_add_u32 s36,s36,s45
buffer_load_dwordx4 v25,s[8:11],s36 offen lds
s_add_u32 m0,s39,11264
s_add_u32 s36,s36,s45
buffer_load_dwordx4 v24,s[8:11],s36 offen lds
s_add_u32 m0,s39,12288
s_add_u32 s36,s36,s45
buffer_load_dwordx4 v24,s[8:11],s36 offen lds
s_add_u32 m0,s39,13312
s_add_u32 s36,s36,s45
buffer_load_dwordx4 v25,s[8:11],s36 offen lds
s_add_u32 m0,s39,14336
s_add_u32 s36,s36,s45
buffer_load_dwordx4 v25,s[8:11],s36 offen lds
s_add_u32 m0,s39,15360
s_add_u32 s36,s36,s45
buffer_load_dwordx4 v24,s[8:11],s36 offen lds
s_waitcnt lgkmcnt(0)
v_mfma_f32_16x16x32_bf16 v[64:67],a[32:35],v[32:35],v[64:67]
v_mfma_f32_16x16x32_bf16 v[72:75],a[36:39],v[32:35],v[72:75]
v_mfma_f32_16x16x32_bf16 v[80:83],a[40:43],v[32:35],v[80:83]
v_mfma_f32_16x16x32_bf16 v[88:91],a[44:47],v[32:35],v[88:91]
v_mfma_f32_16x16x32_bf16 v[68:71],a[32:35],v[36:39],v[68:71]
v_mfma_f32_16x16x32_bf16 v[76:79],a[36:39],v[36:39],v[76:79]
v_mfma_f32_16x16x32_bf16 v[84:87],a[40:43],v[36:39],v[84:87]
v_mfma_f32_16x16x32_bf16 v[92:95],a[44:47],v[36:39],v[92:95]
v_mfma_f32_16x16x32_bf16 v[64:67],a[48:51],v[40:43],v[64:67]
v_mfma_f32_16x16x32_bf16 v[72:75],a[52:55],v[40:43],v[72:75]
v_mfma_f32_16x16x32_bf16 v[80:83],a[56:59],v[40:43],v[80:83]
v_mfma_f32_16x16x32_bf16 v[88:91],a[60:63],v[40:43],v[88:91]
v_mfma_f32_16x16x32_bf16 v[68:71],a[48:51],v[44:47],v[68:71]
v_mfma_f32_16x16x32_bf16 v[76:79],a[52:55],v[44:47],v[76:79]
v_mfma_f32_16x16x32_bf16 v[84:87],a[56:59],v[44:47],v[84:87]
v_mfma_f32_16x16x32_bf16 v[92:95],a[60:63],v[44:47],v[92:95]
s_waitcnt vmcnt(20)
ds_read_b128 a[64:67],v26 offset:16384
ds_read_b128 a[68:71],v27 offset:17408
ds_read_b128 a[72:75],v26 offset:20480
ds_read_b128 a[76:79],v27 offset:21504
ds_read_b128 a[80:83],v27 offset:16384
ds_read_b128 a[84:87],v26 offset:17408
ds_read_b128 a[88:91],v27 offset:20480
ds_read_b128 a[92:95],v26 offset:21504
s_waitcnt lgkmcnt(6)
ds_read_b64_tr_b16 v[32:33],v176 offset:8192
ds_read_b64_tr_b16 v[34:35],v176 offset:8448
ds_read_b64_tr_b16 v[36:37],v177 offset:8192
ds_read_b64_tr_b16 v[38:39],v177 offset:8448
ds_read_b64_tr_b16 v[40:41],v176 offset:10240
ds_read_b64_tr_b16 v[42:43],v176 offset:10496
ds_read_b64_tr_b16 v[44:45],v177 offset:10240
ds_read_b64_tr_b16 v[46:47],v177 offset:10496
s_waitcnt lgkmcnt(8)
s_add_u32 s36,s46,640
s_add_u32 m0,s39,16384
s_nop 0
buffer_load_dwordx4 v24,s[8:11],s36 offen lds
s_add_u32 m0,s39,17408
s_add_u32 s36,s36,s45
buffer_load_dwordx4 v25,s[8:11],s36 offen lds
s_add_u32 m0,s39,18432
s_add_u32 s36,s36,s45
buffer_load_dwordx4 v25,s[8:11],s36 offen lds
s_add_u32 m0,s39,19456
s_add_u32 s36,s36,s45
buffer_load_dwordx4 v24,s[8:11],s36 offen lds
s_add_u32 m0,s39,20480
s_add_u32 s36,s36,s45
buffer_load_dwordx4 v24,s[8:11],s36 offen lds
s_add_u32 m0,s39,21504
s_add_u32 s36,s36,s45
buffer_load_dwordx4 v25,s[8:11],s36 offen lds
s_add_u32 m0,s39,22528
s_add_u32 s36,s36,s45
buffer_load_dwordx4 v25,s[8:11],s36 offen lds
s_add_u32 m0,s39,23552
s_add_u32 s36,s36,s45
buffer_load_dwordx4 v24,s[8:11],s36 offen lds
s_waitcnt lgkmcnt(0)
v_mfma_f32_16x16x32_bf16 v[64:67],a[64:67],v[32:35],v[64:67]
v_mfma_f32_16x16x32_bf16 v[72:75],a[68:71],v[32:35],v[72:75]
v_mfma_f32_16x16x32_bf16 v[80:83],a[72:75],v[32:35],v[80:83]
v_mfma_f32_16x16x32_bf16 v[88:91],a[76:79],v[32:35],v[88:91]
v_mfma_f32_16x16x32_bf16 v[68:71],a[64:67],v[36:39],v[68:71]
v_mfma_f32_16x16x32_bf16 v[76:79],a[68:71],v[36:39],v[76:79]
v_mfma_f32_16x16x32_bf16 v[84:87],a[72:75],v[36:39],v[84:87]
v_mfma_f32_16x16x32_bf16 v[92:95],a[76:79],v[36:39],v[92:95]
v_mfma_f32_16x16x32_bf16 v[64:67],a[80:83],v[40:43],v[64:67]
v_mfma_f32_16x16x32_bf16 v[72:75],a[84:87],v[40:43],v[72:75]
v_mfma_f32_16x16x32_bf16 v[80:83],a[88:91],v[40:43],v[80:83]
v_mfma_f32_16x16x32_bf16 v[88:91],a[92:95],v[40:43],v[88:91]
v_mfma_f32_16x16x32_bf16 v[68:71],a[80:83],v[44:47],v[68:71]
v_mfma_f32_16x16x32_bf16 v[76:79],a[84:87],v[44:47],v[76:79]
v_mfma_f32_16x16x32_bf16 v[84:87],a[88:91],v[44:47],v[84:87]
v_mfma_f32_16x16x32_bf16 v[92:95],a[92:95],v[44:47],v[92:95]
s_waitcnt vmcnt(16)
ds_read_b128 a[96:99],v26 offset:0
ds_read_b128 a[100:103],v27 offset:1024
ds_read_b128 a[104:107],v26 offset:4096
ds_read_b128 a[108:111],v27 offset:5120
ds_read_b128 a[112:115],v27 offset:0
ds_read_b128 a[116:119],v26 offset:1024
ds_read_b128 a[120:123],v27 offset:4096
ds_read_b128 a[124:127],v26 offset:5120
s_waitcnt lgkmcnt(6)
ds_read_b64_tr_b16 v[32:33],v176 offset:12288
ds_read_b64_tr_b16 v[34:35],v176 offset:12544
ds_read_b64_tr_b16 v[36:37],v177 offset:12288
ds_read_b64_tr_b16 v[38:39],v177 offset:12544
ds_read_b64_tr_b16 v[40:41],v176 offset:14336
ds_read_b64_tr_b16 v[42:43],v176 offset:14592
ds_read_b64_tr_b16 v[44:45],v177 offset:14336
ds_read_b64_tr_b16 v[46:47],v177 offset:14592
s_waitcnt lgkmcnt(8)
s_add_u32 s36,s46,768
s_add_u32 m0,s39,0
s_nop 0
buffer_load_dwordx4 v24,s[8:11],s36 offen lds
s_add_u32 m0,s39,1024
s_add_u32 s36,s36,s45
buffer_load_dwordx4 v25,s[8:11],s36 offen lds
s_add_u32 m0,s39,2048
s_add_u32 s36,s36,s45
buffer_load_dwordx4 v25,s[8:11],s36 offen lds
s_add_u32 m0,s39,3072
s_add_u32 s36,s36,s45
buffer_load_dwordx4 v24,s[8:11],s36 offen lds
s_add_u32 m0,s39,4096
s_add_u32 s36,s36,s45
buffer_load_dwordx4 v24,s[8:11],s36 offen lds
s_add_u32 m0,s39,5120
s_add_u32 s36,s36,s45
buffer_load_dwordx4 v25,s[8:11],s36 offen lds
s_add_u32 m0,s39,6144
s_add_u32 s36,s36,s45
buffer_load_dwordx4 v25,s[8:11],s36 offen lds
s_add_u32 m0,s39,7168
s_add_u32 s36,s36,s45
buffer_load_dwordx4 v24,s[8:11],s36 offen lds
s_add_u32 s42,s47,s78
s_and_b32 s42,s42,s80
s_or_b32 s42,s42,s79
s_mul_i32 s42,s42,s31
s_add_u32 s42,s42,s30
s_cmp_lt_u32 s47,s28
s_cselect_b32 s14,s44,0
s_add_u32 s47,s47,1
s_add_u32 m0,s41,0
s_nop 0
buffer_load_dwordx4 v16,s[12:15],s42 offen lds
s_add_u32 m0,s41,1024
s_add_u32 s42,s42,s29
buffer_load_dwordx4 v16,s[12:15],s42 offen lds
s_add_u32 m0,s41,2048
s_add_u32 s42,s42,s29
buffer_load_dwordx4 v16,s[12:15],s42 offen lds
s_add_u32 m0,s41,3072
s_add_u32 s42,s42,s29
buffer_load_dwordx4 v16,s[12:15],s42 offen lds
s_add_u32 m0,s41,4096
s_add_u32 s42,s42,s29
buffer_load_dwordx4 v16,s[12:15],s42 offen lds
s_add_u32 m0,s41,5120
s_add_u32 s42,s42,s29
buffer_load_dwordx4 v16,s[12:15],s42 offen lds
s_add_u32 m0,s41,6144
s_add_u32 s42,s42,s29
buffer_load_dwordx4 v16,s[12:15],s42 offen lds
s_add_u32 m0,s41,7168
s_add_u32 s42,s42,s29
buffer_load_dwordx4 v16,s[12:15],s42 offen lds
s_add_u32 s41,s41,32768
s_sub_u32 s36,s41,131072
s_cmp_ge_u32 s41,131072
s_cselect_b32 s41,s36,s41
s_waitcnt lgkmcnt(0)
v_mfma_f32_16x16x32_bf16 v[64:67],a[96:99],v[32:35],v[64:67]
s_nop 0
v_mfma_f32_16x16x32_bf16 v[72:75],a[100:103],v[32:35],v[72:75]
v_mfma_f32_16x16x32_bf16 v[80:83],a[104:107],v[32:35],v[80:83]
v_mfma_f32_16x16x32_bf16 v[88:91],a[108:111],v[32:35],v[88:91]
v_mfma_f32_16x16x32_bf16 v[68:71],a[96:99],v[36:39],v[68:71]
v_mfma_f32_16x16x32_bf16 v[76:79],a[100:103],v[36:39],v[76:79]
v_mfma_f32_16x16x32_bf16 v[84:87],a[104:107],v[36:39],v[84:87]
v_mfma_f32_16x16x32_bf16 v[92:95],a[108:111],v[36:39],v[92:95]
v_mfma_f32_16x16x32_bf16 v[64:67],a[112:115],v[40:43],v[64:67]
v_mfma_f32_16x16x32_bf16 v[72:75],a[116:119],v[40:43],v[72:75]
v_mfma_f32_16x16x32_bf16 v[80:83],a[120:123],v[40:43],v[80:83]
v_mfma_f32_16x16x32_bf16 v[88:91],a[124:127],v[40:43],v[88:91]
v_mfma_f32_16x16x32_bf16 v[68:71],a[112:115],v[44:47],v[68:71]
v_mfma_f32_16x16x32_bf16 v[76:79],a[116:119],v[44:47],v[76:79]
v_mfma_f32_16x16x32_bf16 v[84:87],a[120:123],v[44:47],v[84:87]
v_mfma_f32_16x16x32_bf16 v[92:95],a[124:127],v[44:47],v[92:95]
s_waitcnt vmcnt(24)
ds_read_b128 a[128:131],v26 offset:8192
ds_read_b128 a[132:135],v27 offset:9216
ds_read_b128 a[136:139],v26 offset:12288
ds_read_b128 a[140:143],v27 offset:13312
ds_read_b128 a[144:147],v27 offset:8192
ds_read_b128 a[148:151],v26 offset:9216
ds_read_b128 a[152:155],v27 offset:12288
ds_read_b128 a[156:159],v26 offset:13312
s_waitcnt lgkmcnt(6)
ds_read_b64_tr_b16 v[32:33],v176 offset:16384
ds_read_b64_tr_b16 v[34:35],v176 offset:16640
ds_read_b64_tr_b16 v[36:37],v177 offset:16384
ds_read_b64_tr_b16 v[38:39],v177 offset:16640
ds_read_b64_tr_b16 v[40:41],v176 offset:18432
ds_read_b64_tr_b16 v[42:43],v176 offset:18688
ds_read_b64_tr_b16 v[44:45],v177 offset:18432
ds_read_b64_tr_b16 v[46:47],v177 offset:18688
s_waitcnt lgkmcnt(8)
s_add_u32 s36,s46,896
s_add_u32 m0,s39,8192
s_nop 0
buffer_load_dwordx4 v24,s[8:11],s36 offen lds
s_add_u32 m0,s39,9216
s_add_u32 s36,s36,s45
buffer_load_dwordx4 v25,s[8:11],s36 offen lds
s_add_u32 m0,s39,10240
s_add_u32 s36,s36,s45
buffer_load_dwordx4 v25,s[8:11],s36 offen lds
s_add_u32 m0,s39,11264
s_add_u32 s36,s36,s45
buffer_load_dwordx4 v24,s[8:11],s36 offen lds
s_add_u32 m0,s39,12288
s_add_u32 s36,s36,s45
buffer_load_dwordx4 v24,s[8:11],s36 offen lds
s_add_u32 m0,s39,13312
s_add_u32 s36,s36,s45
buffer_load_dwordx4 v25,s[8:11],s36 offen lds
s_add_u32 m0,s39,14336
s_add_u32 s36,s36,s45
buffer_load_dwordx4 v25,s[8:11],s36 offen lds
s_add_u32 m0,s39,15360
s_add_u32 s36,s36,s45
buffer_load_dwordx4 v24,s[8:11],s36 offen lds
s_waitcnt lgkmcnt(0)
v_mfma_f32_16x16x32_bf16 v[64:67],a[128:131],v[32:35],v[64:67]
v_mfma_f32_16x16x32_bf16 v[72:75],a[132:135],v[32:35],v[72:75]
v_mfma_f32_16x16x32_bf16 v[80:83],a[136:139],v[32:35],v[80:83]
v_mfma_f32_16x16x32_bf16 v[88:91],a[140:143],v[32:35],v[88:91]
v_mfma_f32_16x16x32_bf16 v[68:71],a[128:131],v[36:39],v[68:71]
v_mfma_f32_16x16x32_bf16 v[76:79],a[132:135],v[36:39],v[76:79]
v_mfma_f32_16x16x32_bf16 v[84:87],a[136:139],v[36:39],v[84:87]
v_mfma_f32_16x16x32_bf16 v[92:95],a[140:143],v[36:39],v[92:95]
v_mfma_f32_16x16x32_bf16 v[64:67],a[144:147],v[40:43],v[64:67]
v_mfma_f32_16x16x32_bf16 v[72:75],a[148:151],v[40:43],v[72:75]
v_mfma_f32_16x16x32_bf16 v[80:83],a[152:155],v[40:43],v[80:83]
v_mfma_f32_16x16x32_bf16 v[88:91],a[156:159],v[40:43],v[88:91]
v_mfma_f32_16x16x32_bf16 v[68:71],a[144:147],v[44:47],v[68:71]
v_mfma_f32_16x16x32_bf16 v[76:79],a[148:151],v[44:47],v[76:79]
v_mfma_f32_16x16x32_bf16 v[84:87],a[152:155],v[44:47],v[84:87]
v_mfma_f32_16x16x32_bf16 v[92:95],a[156:159],v[44:47],v[92:95]
s_waitcnt vmcnt(24)
ds_read_b128 a[160:163],v26 offset:16384
ds_read_b128 a[164:167],v27 offset:17408
ds_read_b128 a[168:171],v26 offset:20480
ds_read_b128 a[172:175],v27 offset:21504
ds_read_b128 a[176:179],v27 offset:16384
ds_read_b128 a[180:183],v26 offset:17408
ds_read_b128 a[184:187],v27 offset:20480
ds_read_b128 a[188:191],v26 offset:21504
s_waitcnt lgkmcnt(6)
ds_read_b64_tr_b16 v[32:33],v176 offset:20480
ds_read_b64_tr_b16 v[34:35],v176 offset:20736
ds_read_b64_tr_b16 v[36:37],v177 offset:20480
ds_read_b64_tr_b16 v[38:39],v177 offset:20736
ds_read_b64_tr_b16 v[40:41],v176 offset:22528
ds_read_b64_tr_b16 v[42:43],v176 offset:22784
ds_read_b64_tr_b16 v[44:45],v177 offset:22528
ds_read_b64_tr_b16 v[46:47],v177 offset:22784
s_waitcnt lgkmcnt(8)
s_waitcnt lgkmcnt(0)
v_mfma_f32_16x16x32_bf16 v[64:67],a[160:163],v[32:35],v[64:67]
v_mfma_f32_16x16x32_bf16 v[72:75],a[164:167],v[32:35],v[72:75]
v_mfma_f32_16x16x32_bf16 v[80:83],a[168:171],v[32:35],v[80:83]
v_mfma_f32_16x16x32_bf16 v[88:91],a[172:175],v[32:35],v[88:91]
v_mfma_f32_16x16x32_bf16 v[68:71],a[160:163],v[36:39],v[68:71]
v_mfma_f32_16x16x32_bf16 v[76:79],a[164:167],v[36:39],v[76:79]
v_mfma_f32_16x16x32_bf16 v[84:87],a[168:171],v[36:39],v[84:87]
v_mfma_f32_16x16x32_bf16 v[92:95],a[172:175],v[36:39],v[92:95]
v_mfma_f32_16x16x32_bf16 v[64:67],a[176:179],v[40:43],v[64:67]
v_mfma_f32_16x16x32_bf16 v[72:75],a[180:183],v[40:43],v[72:75]
v_mfma_f32_16x16x32_bf16 v[80:83],a[184:187],v[40:43],v[80:83]
v_mfma_f32_16x16x32_bf16 v[88:91],a[188:191],v[40:43],v[88:91]
v_mfma_f32_16x16x32_bf16 v[68:71],a[176:179],v[44:47],v[68:71]
v_mfma_f32_16x16x32_bf16 v[76:79],a[180:183],v[44:47],v[76:79]
v_mfma_f32_16x16x32_bf16 v[84:87],a[184:187],v[44:47],v[84:87]
v_mfma_f32_16x16x32_bf16 v[92:95],a[188:191],v[44:47],v[92:95]
s_waitcnt vmcnt(16)
ds_read_b128 a[192:195],v26 offset:0
ds_read_b128 a[196:199],v27 offset:1024
ds_read_b128 a[200:203],v26 offset:4096
ds_read_b128 a[204:207],v27 offset:5120
ds_read_b128 a[208:211],v27 offset:0
ds_read_b128 a[212:215],v26 offset:1024
ds_read_b128 a[216:219],v27 offset:4096
ds_read_b128 a[220:223],v26 offset:5120
s_waitcnt lgkmcnt(6)
ds_read_b64_tr_b16 v[32:33],v176 offset:24576
ds_read_b64_tr_b16 v[34:35],v176 offset:24832
ds_read_b64_tr_b16 v[36:37],v177 offset:24576
ds_read_b64_tr_b16 v[38:39],v177 offset:24832
ds_read_b64_tr_b16 v[40:41],v176 offset:26624
ds_read_b64_tr_b16 v[42:43],v176 offset:26880
ds_read_b64_tr_b16 v[44:45],v177 offset:26624
ds_read_b64_tr_b16 v[46:47],v177 offset:26880
s_waitcnt lgkmcnt(8)
s_waitcnt lgkmcnt(0)
v_mfma_f32_16x16x32_bf16 v[64:67],a[192:195],v[32:35],v[64:67]
v_mfma_f32_16x16x32_bf16 v[72:75],a[196:199],v[32:35],v[72:75]
v_mfma_f32_16x16x32_bf16 v[80:83],a[200:203],v[32:35],v[80:83]
v_mfma_f32_16x16x32_bf16 v[88:91],a[204:207],v[32:35],v[88:91]
v_mfma_f32_16x16x32_bf16 v[68:71],a[192:195],v[36:39],v[68:71]
v_mfma_f32_16x16x32_bf16 v[76:79],a[196:199],v[36:39],v[76:79]
v_mfma_f32_16x16x32_bf16 v[84:87],a[200:203],v[36:39],v[84:87]
v_mfma_f32_16x16x32_bf16 v[92:95],a[204:207],v[36:39],v[92:95]
v_mfma_f32_16x16x32_bf16 v[64:67],a[208:211],v[40:43],v[64:67]
v_mfma_f32_16x16x32_bf16 v[72:75],a[212:215],v[40:43],v[72:75]
v_mfma_f32_16x16x32_bf16 v[80:83],a[216:219],v[40:43],v[80:83]
v_mfma_f32_16x16x32_bf16 v[88:91],a[220:223],v[40:43],v[88:91]
v_mfma_f32_16x16x32_bf16 v[68:71],a[208:211],v[44:47],v[68:71]
v_mfma_f32_16x16x32_bf16 v[76:79],a[212:215],v[44:47],v[76:79]
v_mfma_f32_16x16x32_bf16 v[84:87],a[216:219],v[44:47],v[84:87]
v_mfma_f32_16x16x32_bf16 v[92:95],a[220:223],v[44:47],v[92:95]
s_waitcnt vmcnt(0)
ds_read_b128 a[224:227],v26 offset:8192
ds_read_b128 a[228:231],v27 offset:9216
ds_read_b128 a[232:235],v26 offset:12288
ds_read_b128 a[236:239],v27 offset:13312
ds_read_b128 a[240:243],v27 offset:8192
ds_read_b128 a[244:247],v26 offset:9216
ds_read_b128 a[248:251],v27 offset:12288
ds_read_b128 a[252:255],v26 offset:13312
s_waitcnt lgkmcnt(6)
ds_read_b64_tr_b16 v[32:33],v176 offset:28672
ds_read_b64_tr_b16 v[34:35],v176 offset:28928
ds_read_b64_tr_b16 v[36:37],v177 offset:28672
ds_read_b64_tr_b16 v[38:39],v177 offset:28928
ds_read_b64_tr_b16 v[40:41],v176 offset:30720
ds_read_b64_tr_b16 v[42:43],v176 offset:30976
ds_read_b64_tr_b16 v[44:45],v177 offset:30720
ds_read_b64_tr_b16 v[46:47],v177 offset:30976
s_waitcnt lgkmcnt(8)
s_waitcnt lgkmcnt(0)
v_mfma_f32_16x16x32_bf16 v[64:67],a[224:227],v[32:35],v[64:67]
v_mfma_f32_16x16x32_bf16 v[72:75],a[228:231],v[32:35],v[72:75]
v_mfma_f32_16x16x32_bf16 v[80:83],a[232:235],v[32:35],v[80:83]
v_mfma_f32_16x16x32_bf16 v[88:91],a[236:239],v[32:35],v[88:91]
v_mfma_f32_16x16x32_bf16 v[68:71],a[224:227],v[36:39],v[68:71]
v_mfma_f32_16x16x32_bf16 v[76:79],a[228:231],v[36:39],v[76:79]
v_mfma_f32_16x16x32_bf16 v[84:87],a[232:235],v[36:39],v[84:87]
v_mfma_f32_16x16x32_bf16 v[92:95],a[236:239],v[36:39],v[92:95]
v_mfma_f32_16x16x32_bf16 v[64:67],a[240:243],v[40:43],v[64:67]
v_mfma_f32_16x16x32_bf16 v[72:75],a[244:247],v[40:43],v[72:75]
v_mfma_f32_16x16x32_bf16 v[80:83],a[248:251],v[40:43],v[80:83]
v_mfma_f32_16x16x32_bf16 v[88:91],a[252:255],v[40:43],v[88:91]
v_mfma_f32_16x16x32_bf16 v[68:71],a[240:243],v[44:47],v[68:71]
v_mfma_f32_16x16x32_bf16 v[76:79],a[244:247],v[44:47],v[76:79]
v_mfma_f32_16x16x32_bf16 v[84:87],a[248:251],v[44:47],v[84:87]
v_mfma_f32_16x16x32_bf16 v[92:95],a[252:255],v[44:47],v[92:95]
s_barrier
ds_read_b64_tr_b16 v[32:33],v178 offset:0
ds_read_b64_tr_b16 v[34:35],v178 offset:256
ds_read_b64_tr_b16 v[36:37],v179 offset:0
ds_read_b64_tr_b16 v[38:39],v179 offset:256
ds_read_b64_tr_b16 v[40:41],v178 offset:2048
ds_read_b64_tr_b16 v[42:43],v178 offset:2304
ds_read_b64_tr_b16 v[44:45],v179 offset:2048
ds_read_b64_tr_b16 v[46:47],v179 offset:2304
s_add_u32 s42,s47,s78
s_and_b32 s42,s42,s80
s_or_b32 s42,s42,s79
s_mul_i32 s42,s42,s31
s_add_u32 s42,s42,s30
s_cmp_lt_u32 s47,s28
s_cselect_b32 s14,s44,0
s_add_u32 s47,s47,1
s_add_u32 m0,s41,0
s_nop 0
buffer_load_dwordx4 v16,s[12:15],s42 offen lds
s_add_u32 m0,s41,1024
s_add_u32 s42,s42,s29
buffer_load_dwordx4 v16,s[12:15],s42 offen lds
s_add_u32 m0,s41,2048
s_add_u32 s42,s42,s29
buffer_load_dwordx4 v16,s[12:15],s42 offen lds
s_add_u32 m0,s41,3072
s_add_u32 s42,s42,s29
buffer_load_dwordx4 v16,s[12:15],s42 offen lds
s_add_u32 m0,s41,4096
s_add_u32 s42,s42,s29
buffer_load_dwordx4 v16,s[12:15],s42 offen lds
s_add_u32 m0,s41,5120
s_add_u32 s42,s42,s29
buffer_load_dwordx4 v16,s[12:15],s42 offen lds
s_add_u32 m0,s41,6144
s_add_u32 s42,s42,s29
buffer_load_dwordx4 v16,s[12:15],s42 offen lds
s_add_u32 m0,s41,7168
s_add_u32 s42,s42,s29
buffer_load_dwordx4 v16,s[12:15],s42 offen lds
s_add_u32 s41,s41,32768
s_sub_u32 s36,s41,131072
s_cmp_ge_u32 s41,131072
s_cselect_b32 s41,s36,s41
s_lshl_b32 s37,s78,6
s_add_u32 s37,s37,256
s_and_b32 s37,s37,s92
s_add_u32 s93,s51,s37
buffer_load_dwordx4 v[180:183],v30,s[84:87],s93 offen
s_add_u32 s93,s93,s94
buffer_load_dwordx4 v[184:187],v30,s[84:87],s93 offen
s_add_u32 s93,s93,s94
buffer_load_dwordx4 v[188:191],v30,s[84:87],s93 offen
s_add_u32 s93,s93,s94
buffer_load_dwordx4 v[192:195],v30,s[84:87],s93 offen
s_add_u32 s93,s93,s94
s_mov_b32 s88,s12
s_mov_b32 s89,s13
s_mov_b32 s90,0
s_mov_b32 s91,0x20000
buffer_load_dword v204,v30,s[88:91],0 offen
buffer_load_dword v204,v30,s[88:91],0 offen
s_add_u32 s27,s27,1
k1_V_l1:
s_waitcnt lgkmcnt(4)
v_mfma_f32_16x16x32_bf16 v[96:99],a[0:3],v[32:35],0
ds_read_b64_tr_b16 v[48:49],v178 offset:4096
s_add_u32 s42,s47,s78
v_mfma_f32_16x16x32_bf16 v[104:107],a[4:7],v[32:35],0
ds_read_b64_tr_b16 v[50:51],v178 offset:4352
s_and_b32 s42,s42,s80
v_mfma_f32_16x16x32_bf16 v[112:115],a[8:11],v[32:35],0
ds_read_b64_tr_b16 v[52:53],v179 offset:4096
s_or_b32 s42,s42,s79
v_mfma_f32_16x16x32_bf16 v[120:123],a[12:15],v[32:35],0
ds_read_b64_tr_b16 v[54:55],v179 offset:4352
s_mul_i32 s42,s42,s31
v_mfma_f32_16x16x32_bf16 v[100:103],a[0:3],v[36:39],0
s_add_u32 s42,s42,s30
s_cmp_lt_u32 s47,s28
s_cselect_b32 s14,s44,0
v_mfma_f32_16x16x32_bf16 v[108:111],a[4:7],v[36:39],0
s_add_u32 s47,s47,1
s_add_u32 m0,s41,0
v_mfma_f32_16x16x32_bf16 v[116:119],a[8:11],v[36:39],0
v_mfma_f32_16x16x32_bf16 v[124:127],a[12:15],v[36:39],0
s_waitcnt lgkmcnt(4)
s_nop 0
v_mfma_f32_16x16x32_bf16 v[96:99],a[16:19],v[40:43],v[96:99]
ds_read_b64_tr_b16 v[56:57],v178 offset:6144
s_sub_u32 s37,s27,1
v_mfma_f32_16x16x32_bf16 v[104:107],a[20:23],v[40:43],v[104:107]
ds_read_b64_tr_b16 v[58:59],v178 offset:6400
s_add_u32 s37,s37,s78
v_mfma_f32_16x16x32_bf16 v[112:115],a[24:27],v[40:43],v[112:115]
ds_read_b64_tr_b16 v[60:61],v179 offset:6144
s_and_b32 s37,s37,s80
v_mfma_f32_16x16x32_bf16 v[120:123],a[28:31],v[40:43],v[120:123]
ds_read_b64_tr_b16 v[62:63],v179 offset:6400
s_or_b32 s37,s37,s79
v_mfma_f32_16x16x32_bf16 v[100:103],a[16:19],v[44:47],v[100:103]
buffer_load_dwordx4 v16,s[12:15],s42 offen lds
v_mfma_f32_16x16x32_bf16 v[108:111],a[20:23],v[44:47],v[108:111]
s_add_u32 m0,s41,1024
s_add_u32 s42,s42,s29
v_mfma_f32_16x16x32_bf16 v[116:119],a[24:27],v[44:47],v[116:119]
s_lshr_b32 s38,s37,2
s_mul_i32 s38,s38,s33
v_mfma_f32_16x16x32_bf16 v[124:127],a[28:31],v[44:47],v[124:127]
s_and_b32 s37,s37,3
s_waitcnt lgkmcnt(4)
v_mfma_f32_16x16x32_bf16 v[96:99],a[32:35],v[48:51],v[96:99]
ds_read_b64_tr_b16 v[32:33],v178 offset:8192
s_mul_i32 s37,s37,s34
v_mfma_f32_16x16x32_bf16 v[104:107],a[36:39],v[48:51],v[104:107]
ds_read_b64_tr_b16 v[34:35],v178 offset:8448
s_add_u32 s43,s37,s38
v_mfma_f32_16x16x32_bf16 v[112:115],a[40:43],v[48:51],v[112:115]
ds_read_b64_tr_b16 v[36:37],v179 offset:8192
s_add_u32 s43,s43,s32
v_mfma_f32_16x16x32_bf16 v[120:123],a[44:47],v[48:51],v[120:123]
ds_read_b64_tr_b16 v[38:39],v179 offset:8448
v_cvt_pk_bf16_f32 v128,v64,v65
v_mfma_f32_16x16x32_bf16 v[100:103],a[32:35],v[52:55],v[100:103]
buffer_load_dwordx4 v16,s[12:15],s42 offen lds
v_mfma_f32_16x16x32_bf16 v[108:111],a[36:39],v[52:55],v[108:111]
s_add_u32 m0,s41,2048
s_add_u32 s42,s42,s29
v_mfma_f32_16x16x32_bf16 v[116:119],a[40:43],v[52:55],v[116:119]
v_cvt_pk_bf16_f32 v129,v66,v67
v_cvt_pk_bf16_f32 v130,v72,v73
v_mfma_f32_16x16x32_bf16 v[124:127],a[44:47],v[52:55],v[124:127]
v_cvt_pk_bf16_f32 v131,v74,v75
s_waitcnt lgkmcnt(4)
v_mfma_f32_16x16x32_bf16 v[96:99],a[48:51],v[56:59],v[96:99]
ds_read_b64_tr_b16 v[40:41],v178 offset:10240
v_cvt_pk_bf16_f32 v132,v68,v69
v_mfma_f32_16x16x32_bf16 v[104:107],a[52:55],v[56:59],v[104:107]
ds_read_b64_tr_b16 v[42:43],v178 offset:10496
v_cvt_pk_bf16_f32 v133,v70,v71
v_mfma_f32_16x16x32_bf16 v[112:115],a[56:59],v[56:59],v[112:115]
ds_read_b64_tr_b16 v[44:45],v179 offset:10240
v_cvt_pk_bf16_f32 v134,v76,v77
v_mfma_f32_16x16x32_bf16 v[120:123],a[60:63],v[56:59],v[120:123]
ds_read_b64_tr_b16 v[46:47],v179 offset:10496
v_cvt_pk_bf16_f32 v135,v78,v79
v_mfma_f32_16x16x32_bf16 v[100:103],a[48:51],v[60:63],v[100:103]
buffer_load_dwordx4 v16,s[12:15],s42 offen lds
v_mfma_f32_16x16x32_bf16 v[108:111],a[52:55],v[60:63],v[108:111]
s_add_u32 m0,s41,3072
s_add_u32 s42,s42,s29
v_mfma_f32_16x16x32_bf16 v[116:119],a[56:59],v[60:63],v[116:119]
v_cvt_pk_bf16_f32 v136,v80,v81
v_cvt_pk_bf16_f32 v137,v82,v83
v_mfma_f32_16x16x32_bf16 v[124:127],a[60:63],v[60:63],v[124:127]
v_cvt_pk_bf16_f32 v138,v88,v89
s_waitcnt lgkmcnt(4)
v_mfma_f32_16x16x32_bf16 v[96:99],a[64:67],v[32:35],v[96:99]
ds_read_b64_tr_b16 v[48:49],v178 offset:12288
v_cvt_pk_bf16_f32 v139,v90,v91
v_mfma_f32_16x16x32_bf16 v[104:107],a[68:71],v[32:35],v[104:107]
ds_read_b64_tr_b16 v[50:51],v178 offset:12544
v_cvt_pk_bf16_f32 v140,v84,v85
v_mfma_f32_16x16x32_bf16 v[112:115],a[72:75],v[32:35],v[112:115]
ds_read_b64_tr_b16 v[52:53],v179 offset:12288
v_cvt_pk_bf16_f32 v141,v86,v87
v_mfma_f32_16x16x32_bf16 v[120:123],a[76:79],v[32:35],v[120:123]
ds_read_b64_tr_b16 v[54:55],v179 offset:12544
v_cvt_pk_bf16_f32 v142,v92,v93
v_mfma_f32_16x16x32_bf16 v[100:103],a[64:67],v[36:39],v[100:103]
buffer_load_dwordx4 v16,s[12:15],s42 offen lds
v_mfma_f32_16x16x32_bf16 v[108:111],a[68:71],v[36:39],v[108:111]
s_add_u32 m0,s41,4096
s_add_u32 s42,s42,s29
v_mfma_f32_16x16x32_bf16 v[116:119],a[72:75],v[36:39],v[116:119]
v_cvt_pk_bf16_f32 v143,v94,v95
s_nop 0
v_mfma_f32_16x16x32_bf16 v[124:127],a[76:79],v[36:39],v[124:127]
s_waitcnt lgkmcnt(4)
s_nop 0
v_mfma_f32_16x16x32_bf16 v[96:99],a[80:83],v[40:43],v[96:99]
ds_read_b64_tr_b16 v[56:57],v178 offset:14336
v_mfma_f32_16x16x32_bf16 v[104:107],a[84:87],v[40:43],v[104:107]
ds_read_b64_tr_b16 v[58:59],v178 offset:14592
v_mfma_f32_16x16x32_bf16 v[112:115],a[88:91],v[40:43],v[112:115]
ds_read_b64_tr_b16 v[60:61],v179 offset:14336
v_mfma_f32_16x16x32_bf16 v[120:123],a[92:95],v[40:43],v[120:123]
ds_read_b64_tr_b16 v[62:63],v179 offset:14592
v_mfma_f32_16x16x32_bf16 v[100:103],a[80:83],v[44:47],v[100:103]
buffer_load_dwordx4 v16,s[12:15],s42 offen lds
v_mfma_f32_16x16x32_bf16 v[108:111],a[84:87],v[44:47],v[108:111]
s_add_u32 m0,s41,5120
s_add_u32 s42,s42,s29
v_mfma_f32_16x16x32_bf16 v[116:119],a[88:91],v[44:47],v[116:119]
s_nop 0
v_mfma_f32_16x16x32_bf16 v[124:127],a[92:95],v[44:47],v[124:127]
s_waitcnt lgkmcnt(4)
s_nop 0
v_mfma_f32_16x16x32_bf16 v[96:99],a[96:99],v[48:51],v[96:99]
ds_read_b64_tr_b16 v[32:33],v178 offset:16384
v_mfma_f32_16x16x32_bf16 v[104:107],a[100:103],v[48:51],v[104:107]
ds_read_b64_tr_b16 v[34:35],v178 offset:16640
v_mfma_f32_16x16x32_bf16 v[112:115],a[104:107],v[48:51],v[112:115]
ds_read_b64_tr_b16 v[36:37],v179 offset:16384
v_mfma_f32_16x16x32_bf16 v[120:123],a[108:111],v[48:51],v[120:123]
ds_read_b64_tr_b16 v[38:39],v179 offset:16640
v_mfma_f32_16x16x32_bf16 v[100:103],a[96:99],v[52:55],v[100:103]
buffer_load_dwordx4 v16,s[12:15],s42 offen lds
v_mfma_f32_16x16x32_bf16 v[108:111],a[100:103],v[52:55],v[108:111]
s_add_u32 m0,s41,6144
s_add_u32 s42,s42,s29
v_mfma_f32_16x16x32_bf16 v[116:119],a[104:107],v[52:55],v[116:119]
s_nop 0
v_mfma_f32_16x16x32_bf16 v[124:127],a[108:111],v[52:55],v[124:127]
s_waitcnt lgkmcnt(4)
s_nop 0
v_mfma_f32_16x16x32_bf16 v[96:99],a[112:115],v[56:59],v[96:99]
ds_read_b64_tr_b16 v[40:41],v178 offset:18432
v_mfma_f32_16x16x32_bf16 v[104:107],a[116:119],v[56:59],v[104:107]
ds_read_b64_tr_b16 v[42:43],v178 offset:18688
v_mfma_f32_16x16x32_bf16 v[112:115],a[120:123],v[56:59],v[112:115]
ds_read_b64_tr_b16 v[44:45],v179 offset:18432
v_mfma_f32_16x16x32_bf16 v[120:123],a[124:127],v[56:59],v[120:123]
ds_read_b64_tr_b16 v[46:47],v179 offset:18688
v_mfma_f32_16x16x32_bf16 v[100:103],a[112:115],v[60:63],v[100:103]
buffer_load_dwordx4 v16,s[12:15],s42 offen lds
v_mfma_f32_16x16x32_bf16 v[108:111],a[116:119],v[60:63],v[108:111]
s_add_u32 m0,s41,7168
s_add_u32 s42,s42,s29
v_mfma_f32_16x16x32_bf16 v[116:119],a[120:123],v[60:63],v[116:119]
s_nop 0
v_mfma_f32_16x16x32_bf16 v[124:127],a[124:127],v[60:63],v[124:127]
s_waitcnt lgkmcnt(4)
s_nop 0
v_mfma_f32_16x16x32_bf16 v[96:99],a[128:131],v[32:35],v[96:99]
ds_read_b64_tr_b16 v[48:49],v178 offset:20480
v_mfma_f32_16x16x32_bf16 v[104:107],a[132:135],v[32:35],v[104:107]
ds_read_b64_tr_b16 v[50:51],v178 offset:20736
v_mfma_f32_16x16x32_bf16 v[112:115],a[136:139],v[32:35],v[112:115]
ds_read_b64_tr_b16 v[52:53],v179 offset:20480
v_mfma_f32_16x16x32_bf16 v[120:123],a[140:143],v[32:35],v[120:123]
ds_read_b64_tr_b16 v[54:55],v179 offset:20736
v_mfma_f32_16x16x32_bf16 v[100:103],a[128:131],v[36:39],v[100:103]
buffer_load_dwordx4 v16,s[12:15],s42 offen lds
v_mfma_f32_16x16x32_bf16 v[108:111],a[132:135],v[36:39],v[108:111]
s_add_u32 s41,s41,32768
s_sub_u32 s36,s41,131072
v_mfma_f32_16x16x32_bf16 v[116:119],a[136:139],v[36:39],v[116:119]
s_cmp_ge_u32 s41,131072
s_cselect_b32 s41,s36,s41
v_mfma_f32_16x16x32_bf16 v[124:127],a[140:143],v[36:39],v[124:127]
s_add_u32 s83,s83,256
s_waitcnt lgkmcnt(4)
v_mfma_f32_16x16x32_bf16 v[96:99],a[144:147],v[40:43],v[96:99]
ds_read_b64_tr_b16 v[56:57],v178 offset:22528
s_and_b32 s83,s83,s92
v_mfma_f32_16x16x32_bf16 v[104:107],a[148:151],v[40:43],v[104:107]
ds_read_b64_tr_b16 v[58:59],v178 offset:22784
s_sub_u32 s82,s82,1
v_mfma_f32_16x16x32_bf16 v[112:115],a[152:155],v[40:43],v[112:115]
ds_read_b64_tr_b16 v[60:61],v179 offset:22528
s_cmp_ge_i32 s82,0
s_cselect_b32 s86,s44,0
v_mfma_f32_16x16x32_bf16 v[120:123],a[156:159],v[40:43],v[120:123]
ds_read_b64_tr_b16 v[62:63],v179 offset:22784
s_add_u32 s93,s51,s83
v_mfma_f32_16x16x32_bf16 v[100:103],a[144:147],v[44:47],v[100:103]
buffer_load_dwordx4 v[180:183],v30,s[84:87],s93 offen
v_mfma_f32_16x16x32_bf16 v[108:111],a[148:151],v[44:47],v[108:111]
s_add_u32 s93,s93,s94
v_mfma_f32_16x16x32_bf16 v[116:119],a[152:155],v[44:47],v[116:119]
v_mfma_f32_16x16x32_bf16 v[124:127],a[156:159],v[44:47],v[124:127]
s_waitcnt lgkmcnt(4)
s_nop 0
v_mfma_f32_16x16x32_bf16 v[96:99],a[160:163],v[48:51],v[96:99]
ds_read_b64_tr_b16 v[32:33],v178 offset:24576
v_mfma_f32_16x16x32_bf16 v[104:107],a[164:167],v[48:51],v[104:107]
ds_read_b64_tr_b16 v[34:35],v178 offset:24832
v_mfma_f32_16x16x32_bf16 v[112:115],a[168:171],v[48:51],v[112:115]
ds_read_b64_tr_b16 v[36:37],v179 offset:24576
v_mfma_f32_16x16x32_bf16 v[120:123],a[172:175],v[48:51],v[120:123]
ds_read_b64_tr_b16 v[38:39],v179 offset:24832
v_mfma_f32_16x16x32_bf16 v[100:103],a[160:163],v[52:55],v[100:103]
buffer_load_dwordx4 v[184:187],v30,s[84:87],s93 offen
v_mfma_f32_16x16x32_bf16 v[108:111],a[164:167],v[52:55],v[108:111]
v_mfma_f32_16x16x32_bf16 v[116:119],a[168:171],v[52:55],v[116:119]
v_mfma_f32_16x16x32_bf16 v[124:127],a[172:175],v[52:55],v[124:127]
s_waitcnt lgkmcnt(4)
s_nop 0
v_mfma_f32_16x16x32_bf16 v[96:99],a[176:179],v[56:59],v[96:99]
ds_read_b64_tr_b16 v[40:41],v178 offset:26624
s_add_u32 s40,s40,32768
v_mfma_f32_16x16x32_bf16 v[104:107],a[180:183],v[56:59],v[104:107]
ds_read_b64_tr_b16 v[42:43],v178 offset:26880
s_cmp_ge_u32 s40,131072
s_cselect_b32 s40,0,s40
v_mfma_f32_16x16x32_bf16 v[112:115],a[184:187],v[56:59],v[112:115]
ds_read_b64_tr_b16 v[44:45],v179 offset:26624
v_add_u32 v176,s40,v19
v_mfma_f32_16x16x32_bf16 v[120:123],a[188:191],v[56:59],v[120:123]
ds_read_b64_tr_b16 v[46:47],v179 offset:26880
v_xor_b32 v177,32,v176
v_mfma_f32_16x16x32_bf16 v[100:103],a[176:179],v[60:63],v[100:103]
buffer_store_dwordx4 v[128:131],v20,s[20:23],s43 offen sc1
v_mfma_f32_16x16x32_bf16 v[108:111],a[180:183],v[60:63],v[108:111]
s_nop 0
v_mfma_f32_16x16x32_bf16 v[116:119],a[184:187],v[60:63],v[116:119]
v_mfma_f32_16x16x32_bf16 v[124:127],a[188:191],v[60:63],v[124:127]
s_waitcnt lgkmcnt(4)
s_nop 0
v_mfma_f32_16x16x32_bf16 v[96:99],a[192:195],v[32:35],v[96:99]
ds_read_b64_tr_b16 v[48:49],v178 offset:28672
v_mfma_f32_16x16x32_bf16 v[104:107],a[196:199],v[32:35],v[104:107]
ds_read_b64_tr_b16 v[50:51],v178 offset:28928
v_mfma_f32_16x16x32_bf16 v[112:115],a[200:203],v[32:35],v[112:115]
ds_read_b64_tr_b16 v[52:53],v179 offset:28672
v_mfma_f32_16x16x32_bf16 v[120:123],a[204:207],v[32:35],v[120:123]
ds_read_b64_tr_b16 v[54:55],v179 offset:28928
v_mfma_f32_16x16x32_bf16 v[100:103],a[192:195],v[36:39],v[100:103]
buffer_store_dwordx4 v[132:135],v21,s[20:23],s43 offen sc1
v_mfma_f32_16x16x32_bf16 v[108:111],a[196:199],v[36:39],v[108:111]
v_mfma_f32_16x16x32_bf16 v[116:119],a[200:203],v[36:39],v[116:119]
v_mfma_f32_16x16x32_bf16 v[124:127],a[204:207],v[36:39],v[124:127]
s_waitcnt lgkmcnt(4)
s_nop 0
v_mfma_f32_16x16x32_bf16 v[96:99],a[208:211],v[40:43],v[96:99]
ds_read_b64_tr_b16 v[56:57],v178 offset:30720
v_mfma_f32_16x16x32_bf16 v[104:107],a[212:215],v[40:43],v[104:107]
ds_read_b64_tr_b16 v[58:59],v178 offset:30976
v_mfma_f32_16x16x32_bf16 v[112:115],a[216:219],v[40:43],v[112:115]
ds_read_b64_tr_b16 v[60:61],v179 offset:30720
v_mfma_f32_16x16x32_bf16 v[120:123],a[220:223],v[40:43],v[120:123]
ds_read_b64_tr_b16 v[62:63],v179 offset:30976
v_mfma_f32_16x16x32_bf16 v[100:103],a[208:211],v[44:47],v[100:103]
buffer_store_dwordx4 v[136:139],v22,s[20:23],s43 offen sc1
v_mfma_f32_16x16x32_bf16 v[108:111],a[212:215],v[44:47],v[108:111]
v_mfma_f32_16x16x32_bf16 v[116:119],a[216:219],v[44:47],v[116:119]
v_mfma_f32_16x16x32_bf16 v[124:127],a[220:223],v[44:47],v[124:127]
s_waitcnt lgkmcnt(4)
s_nop 0
v_mfma_f32_16x16x32_bf16 v[96:99],a[224:227],v[48:51],v[96:99]
s_waitcnt vmcnt(19)
s_barrier
ds_read_b64_tr_b16 v[32:33],v176 offset:0
v_mfma_f32_16x16x32_bf16 v[104:107],a[228:231],v[48:51],v[104:107]
ds_read_b64_tr_b16 v[34:35],v176 offset:256
v_mfma_f32_16x16x32_bf16 v[112:115],a[232:235],v[48:51],v[112:115]
ds_read_b64_tr_b16 v[36:37],v177 offset:0
v_mfma_f32_16x16x32_bf16 v[120:123],a[236:239],v[48:51],v[120:123]
ds_read_b64_tr_b16 v[38:39],v177 offset:256
v_mfma_f32_16x16x32_bf16 v[100:103],a[224:227],v[52:55],v[100:103]
buffer_store_dwordx4 v[140:143],v23,s[20:23],s43 offen sc1
v_mfma_f32_16x16x32_bf16 v[108:111],a[228:231],v[52:55],v[108:111]
v_mfma_f32_16x16x32_bf16 v[116:119],a[232:235],v[52:55],v[116:119]
v_mfma_f32_16x16x32_bf16 v[124:127],a[236:239],v[52:55],v[124:127]
s_waitcnt lgkmcnt(4)
s_nop 0
v_mfma_f32_16x16x32_bf16 v[96:99],a[240:243],v[56:59],v[96:99]
ds_read_b64_tr_b16 v[40:41],v176 offset:2048
v_mfma_f32_16x16x32_bf16 v[104:107],a[244:247],v[56:59],v[104:107]
ds_read_b64_tr_b16 v[42:43],v176 offset:2304
v_mfma_f32_16x16x32_bf16 v[112:115],a[248:251],v[56:59],v[112:115]
ds_read_b64_tr_b16 v[44:45],v177 offset:2048
v_mfma_f32_16x16x32_bf16 v[120:123],a[252:255],v[56:59],v[120:123]
ds_read_b64_tr_b16 v[46:47],v177 offset:2304
v_mfma_f32_16x16x32_bf16 v[100:103],a[240:243],v[60:63],v[100:103]
v_mfma_f32_16x16x32_bf16 v[108:111],a[244:247],v[60:63],v[108:111]
v_mfma_f32_16x16x32_bf16 v[116:119],a[248:251],v[60:63],v[116:119]
v_mfma_f32_16x16x32_bf16 v[124:127],a[252:255],v[60:63],v[124:127]
s_add_u32 s27,s27,1
s_cmp_ge_u32 s27,s28
s_cbranch_scc1 k1_V_t1
s_waitcnt lgkmcnt(4)
v_mfma_f32_16x16x32_bf16 v[64:67],a[0:3],v[32:35],0
ds_read_b64_tr_b16 v[48:49],v176 offset:4096
s_add_u32 s42,s47,s78
v_mfma_f32_16x16x32_bf16 v[72:75],a[4:7],v[32:35],0
ds_read_b64_tr_b16 v[50:51],v176 offset:4352
s_and_b32 s42,s42,s80
v_mfma_f32_16x16x32_bf16 v[80:83],a[8:11],v[32:35],0
ds_read_b64_tr_b16 v[52:53],v177 offset:4096
s_or_b32 s42,s42,s79
v_mfma_f32_16x16x32_bf16 v[88:91],a[12:15],v[32:35],0
ds_read_b64_tr_b16 v[54:55],v177 offset:4352
s_mul_i32 s42,s42,s31
v_mfma_f32_16x16x32_bf16 v[68:71],a[0:3],v[36:39],0
s_add_u32 s42,s42,s30
s_cmp_lt_u32 s47,s28
s_cselect_b32 s14,s44,0
v_mfma_f32_16x16x32_bf16 v[76:79],a[4:7],v[36:39],0
s_add_u32 s47,s47,1
s_add_u32 m0,s41,0
v_mfma_f32_16x16x32_bf16 v[84:87],a[8:11],v[36:39],0
s_nop 0
v_mfma_f32_16x16x32_bf16 v[92:95],a[12:15],v[36:39],0
s_waitcnt lgkmcnt(4)
s_nop 0
v_mfma_f32_16x16x32_bf16 v[64:67],a[16:19],v[40:43],v[64:67]
ds_read_b64_tr_b16 v[56:57],v176 offset:6144
s_sub_u32 s37,s27,1
v_mfma_f32_16x16x32_bf16 v[72:75],a[20:23],v[40:43],v[72:75]
ds_read_b64_tr_b16 v[58:59],v176 offset:6400
s_add_u32 s37,s37,s78
v_mfma_f32_16x16x32_bf16 v[80:83],a[24:27],v[40:43],v[80:83]
ds_read_b64_tr_b16 v[60:61],v177 offset:6144
s_and_b32 s37,s37,s80
v_mfma_f32_16x16x32_bf16 v[88:91],a[28:31],v[40:43],v[88:91]
ds_read_b64_tr_b16 v[62:63],v177 offset:6400
s_or_b32 s37,s37,s79
v_mfma_f32_16x16x32_bf16 v[68:71],a[16:19],v[44:47],v[68:71]
buffer_load_dwordx4 v16,s[12:15],s42 offen lds
v_mfma_f32_16x16x32_bf16 v[76:79],a[20:23],v[44:47],v[76:79]
s_add_u32 m0,s41,1024
s_add_u32 s42,s42,s29
v_mfma_f32_16x16x32_bf16 v[84:87],a[24:27],v[44:47],v[84:87]
s_lshr_b32 s38,s37,2
s_mul_i32 s38,s38,s33
v_mfma_f32_16x16x32_bf16 v[92:95],a[28:31],v[44:47],v[92:95]
s_and_b32 s37,s37,3
s_waitcnt lgkmcnt(4)
v_mfma_f32_16x16x32_bf16 v[64:67],a[32:35],v[48:51],v[64:67]
ds_read_b64_tr_b16 v[32:33],v176 offset:8192
s_mul_i32 s37,s37,s34
v_mfma_f32_16x16x32_bf16 v[72:75],a[36:39],v[48:51],v[72:75]
ds_read_b64_tr_b16 v[34:35],v176 offset:8448
s_add_u32 s43,s37,s38
v_mfma_f32_16x16x32_bf16 v[80:83],a[40:43],v[48:51],v[80:83]
ds_read_b64_tr_b16 v[36:37],v177 offset:8192
s_add_u32 s43,s43,s32
v_mfma_f32_16x16x32_bf16 v[88:91],a[44:47],v[48:51],v[88:91]
ds_read_b64_tr_b16 v[38:39],v177 offset:8448
v_cvt_pk_bf16_f32 v128,v96,v97
v_mfma_f32_16x16x32_bf16 v[68:71],a[32:35],v[52:55],v[68:71]
buffer_load_dwordx4 v16,s[12:15],s42 offen lds
v_mfma_f32_16x16x32_bf16 v[76:79],a[36:39],v[52:55],v[76:79]
s_add_u32 m0,s41,2048
s_add_u32 s42,s42,s29
v_mfma_f32_16x16x32_bf16 v[84:87],a[40:43],v[52:55],v[84:87]
v_cvt_pk_bf16_f32 v129,v98,v99
v_cvt_pk_bf16_f32 v130,v104,v105
v_mfma_f32_16x16x32_bf16 v[92:95],a[44:47],v[52:55],v[92:95]
v_cvt_pk_bf16_f32 v131,v106,v107
s_waitcnt lgkmcnt(4)
v_mfma_f32_16x16x32_bf16 v[64:67],a[48:51],v[56:59],v[64:67]
ds_read_b64_tr_b16 v[40:41],v176 offset:10240
v_cvt_pk_bf16_f32 v132,v100,v101
v_mfma_f32_16x16x32_bf16 v[72:75],a[52:55],v[56:59],v[72:75]
ds_read_b64_tr_b16 v[42:43],v176 offset:10496
v_cvt_pk_bf16_f32 v133,v102,v103
v_mfma_f32_16x16x32_bf16 v[80:83],a[56:59],v[56:59],v[80:83]
ds_read_b64_tr_b16 v[44:45],v177 offset:10240
v_cvt_pk_bf16_f32 v134,v108,v109
v_mfma_f32_16x16x32_bf16 v[88:91],a[60:63],v[56:59],v[88:91]
ds_read_b64_tr_b16 v[46:47],v177 offset:10496
v_cvt_pk_bf16_f32 v135,v110,v111
v_mfma_f32_16x16x32_bf16 v[68:71],a[48:51],v[60:63],v[68:71]
buffer_load_dwordx4 v16,s[12:15],s42 offen lds
v_mfma_f32_16x16x32_bf16 v[76:79],a[52:55],v[60:63],v[76:79]
s_add_u32 m0,s41,3072
s_add_u32 s42,s42,s29
v_mfma_f32_16x16x32_bf16 v[84:87],a[56:59],v[60:63],v[84:87]
v_cvt_pk_bf16_f32 v136,v112,v113
v_cvt_pk_bf16_f32 v137,v114,v115
v_mfma_f32_16x16x32_bf16 v[92:95],a[60:63],v[60:63],v[92:95]
v_cvt_pk_bf16_f32 v138,v120,v121
s_waitcnt lgkmcnt(4)
v_mfma_f32_16x16x32_bf16 v[64:67],a[64:67],v[32:35],v[64:67]
ds_read_b64_tr_b16 v[48:49],v176 offset:12288
v_cvt_pk_bf16_f32 v139,v122,v123
v_mfma_f32_16x16x32_bf16 v[72:75],a[68:71],v[32:35],v[72:75]
ds_read_b64_tr_b16 v[50:51],v176 offset:12544
v_cvt_pk_bf16_f32 v140,v116,v117
v_mfma_f32_16x16x32_bf16 v[80:83],a[72:75],v[32:35],v[80:83]
ds_read_b64_tr_b16 v[52:53],v177 offset:12288
v_cvt_pk_bf16_f32 v141,v118,v119
v_mfma_f32_16x16x32_bf16 v[88:91],a[76:79],v[32:35],v[88:91]
ds_read_b64_tr_b16 v[54:55],v177 offset:12544
v_cvt_pk_bf16_f32 v142,v124,v125
v_mfma_f32_16x16x32_bf16 v[68:71],a[64:67],v[36:39],v[68:71]
buffer_load_dwordx4 v16,s[12:15],s42 offen lds
v_mfma_f32_16x16x32_bf16 v[76:79],a[68:71],v[36:39],v[76:79]
s_add_u32 m0,s41,4096
s_add_u32 s42,s42,s29
v_mfma_f32_16x16x32_bf16 v[84:87],a[72:75],v[36:39],v[84:87]
v_cvt_pk_bf16_f32 v143,v126,v127
s_nop 0
v_mfma_f32_16x16x32_bf16 v[92:95],a[76:79],v[36:39],v[92:95]
s_waitcnt lgkmcnt(4)
s_nop 0
v_mfma_f32_16x16x32_bf16 v[64:67],a[80:83],v[40:43],v[64:67]
ds_read_b64_tr_b16 v[56:57],v176 offset:14336
v_mfma_f32_16x16x32_bf16 v[72:75],a[84:87],v[40:43],v[72:75]
ds_read_b64_tr_b16 v[58:59],v176 offset:14592
v_mfma_f32_16x16x32_bf16 v[80:83],a[88:91],v[40:43],v[80:83]
ds_read_b64_tr_b16 v[60:61],v177 offset:14336
v_mfma_f32_16x16x32_bf16 v[88:91],a[92:95],v[40:43],v[88:91]
ds_read_b64_tr_b16 v[62:63],v177 offset:14592
v_mfma_f32_16x16x32_bf16 v[68:71],a[80:83],v[44:47],v[68:71]
buffer_load_dwordx4 v16,s[12:15],s42 offen lds
v_mfma_f32_16x16x32_bf16 v[76:79],a[84:87],v[44:47],v[76:79]
s_add_u32 m0,s41,5120
s_add_u32 s42,s42,s29
v_mfma_f32_16x16x32_bf16 v[84:87],a[88:91],v[44:47],v[84:87]
s_nop 0
v_mfma_f32_16x16x32_bf16 v[92:95],a[92:95],v[44:47],v[92:95]
s_waitcnt lgkmcnt(4)
s_nop 0
v_mfma_f32_16x16x32_bf16 v[64:67],a[96:99],v[48:51],v[64:67]
ds_read_b64_tr_b16 v[32:33],v176 offset:16384
v_mfma_f32_16x16x32_bf16 v[72:75],a[100:103],v[48:51],v[72:75]
ds_read_b64_tr_b16 v[34:35],v176 offset:16640
v_mfma_f32_16x16x32_bf16 v[80:83],a[104:107],v[48:51],v[80:83]
ds_read_b64_tr_b16 v[36:37],v177 offset:16384
v_mfma_f32_16x16x32_bf16 v[88:91],a[108:111],v[48:51],v[88:91]
ds_read_b64_tr_b16 v[38:39],v177 offset:16640
v_mfma_f32_16x16x32_bf16 v[68:71],a[96:99],v[52:55],v[68:71]
buffer_load_dwordx4 v16,s[12:15],s42 offen lds
v_mfma_f32_16x16x32_bf16 v[76:79],a[100:103],v[52:55],v[76:79]
s_add_u32 m0,s41,6144
s_add_u32 s42,s42,s29
v_mfma_f32_16x16x32_bf16 v[84:87],a[104:107],v[52:55],v[84:87]
s_nop 0
v_mfma_f32_16x16x32_bf16 v[92:95],a[108:111],v[52:55],v[92:95]
s_waitcnt lgkmcnt(4)
s_nop 0
v_mfma_f32_16x16x32_bf16 v[64:67],a[112:115],v[56:59],v[64:67]
ds_read_b64_tr_b16 v[40:41],v176 offset:18432
v_mfma_f32_16x16x32_bf16 v[72:75],a[116:119],v[56:59],v[72:75]
ds_read_b64_tr_b16 v[42:43],v176 offset:18688
v_mfma_f32_16x16x32_bf16 v[80:83],a[120:123],v[56:59],v[80:83]
ds_read_b64_tr_b16 v[44:45],v177 offset:18432
v_mfma_f32_16x16x32_bf16 v[88:91],a[124:127],v[56:59],v[88:91]
ds_read_b64_tr_b16 v[46:47],v177 offset:18688
v_mfma_f32_16x16x32_bf16 v[68:71],a[112:115],v[60:63],v[68:71]
buffer_load_dwordx4 v16,s[12:15],s42 offen lds
v_mfma_f32_16x16x32_bf16 v[76:79],a[116:119],v[60:63],v[76:79]
s_add_u32 m0,s41,7168
s_add_u32 s42,s42,s29
v_mfma_f32_16x16x32_bf16 v[84:87],a[120:123],v[60:63],v[84:87]
s_nop 0
v_mfma_f32_16x16x32_bf16 v[92:95],a[124:127],v[60:63],v[92:95]
s_waitcnt lgkmcnt(4)
s_nop 0
v_mfma_f32_16x16x32_bf16 v[64:67],a[128:131],v[32:35],v[64:67]
ds_read_b64_tr_b16 v[48:49],v176 offset:20480
v_mfma_f32_16x16x32_bf16 v[72:75],a[132:135],v[32:35],v[72:75]
ds_read_b64_tr_b16 v[50:51],v176 offset:20736
v_mfma_f32_16x16x32_bf16 v[80:83],a[136:139],v[32:35],v[80:83]
ds_read_b64_tr_b16 v[52:53],v177 offset:20480
v_mfma_f32_16x16x32_bf16 v[88:91],a[140:143],v[32:35],v[88:91]
ds_read_b64_tr_b16 v[54:55],v177 offset:20736
v_mfma_f32_16x16x32_bf16 v[68:71],a[128:131],v[36:39],v[68:71]
buffer_load_dwordx4 v16,s[12:15],s42 offen lds
v_mfma_f32_16x16x32_bf16 v[76:79],a[132:135],v[36:39],v[76:79]
s_add_u32 s41,s41,32768
s_sub_u32 s36,s41,131072
v_mfma_f32_16x16x32_bf16 v[84:87],a[136:139],v[36:39],v[84:87]
s_cmp_ge_u32 s41,131072
s_cselect_b32 s41,s36,s41
v_mfma_f32_16x16x32_bf16 v[92:95],a[140:143],v[36:39],v[92:95]
s_add_u32 s93,s93,s94
s_waitcnt lgkmcnt(4)
v_mfma_f32_16x16x32_bf16 v[64:67],a[144:147],v[40:43],v[64:67]
ds_read_b64_tr_b16 v[56:57],v176 offset:22528
s_nop 0
v_mfma_f32_16x16x32_bf16 v[72:75],a[148:151],v[40:43],v[72:75]
ds_read_b64_tr_b16 v[58:59],v176 offset:22784
v_mfma_f32_16x16x32_bf16 v[80:83],a[152:155],v[40:43],v[80:83]
ds_read_b64_tr_b16 v[60:61],v177 offset:22528
v_mfma_f32_16x16x32_bf16 v[88:91],a[156:159],v[40:43],v[88:91]
ds_read_b64_tr_b16 v[62:63],v177 offset:22784
v_mfma_f32_16x16x32_bf16 v[68:71],a[144:147],v[44:47],v[68:71]
buffer_load_dwordx4 v[180:183],v30,s[84:87],s93 offen
v_mfma_f32_16x16x32_bf16 v[76:79],a[148:151],v[44:47],v[76:79]
s_add_u32 s93,s93,s94
s_nop 0
v_mfma_f32_16x16x32_bf16 v[84:87],a[152:155],v[44:47],v[84:87]
v_mfma_f32_16x16x32_bf16 v[92:95],a[156:159],v[44:47],v[92:95]
s_waitcnt lgkmcnt(4)
s_nop 0
v_mfma_f32_16x16x32_bf16 v[64:67],a[160:163],v[48:51],v[64:67]
ds_read_b64_tr_b16 v[32:33],v176 offset:24576
v_mfma_f32_16x16x32_bf16 v[72:75],a[164:167],v[48:51],v[72:75]
ds_read_b64_tr_b16 v[34:35],v176 offset:24832
v_mfma_f32_16x16x32_bf16 v[80:83],a[168:171],v[48:51],v[80:83]
ds_read_b64_tr_b16 v[36:37],v177 offset:24576
v_mfma_f32_16x16x32_bf16 v[88:91],a[172:175],v[48:51],v[88:91]
ds_read_b64_tr_b16 v[38:39],v177 offset:24832
v_mfma_f32_16x16x32_bf16 v[68:71],a[160:163],v[52:55],v[68:71]
buffer_load_dwordx4 v[184:187],v30,s[84:87],s93 offen
v_mfma_f32_16x16x32_bf16 v[76:79],a[164:167],v[52:55],v[76:79]
v_mfma_f32_16x16x32_bf16 v[84:87],a[168:171],v[52:55],v[84:87]
v_mfma_f32_16x16x32_bf16 v[92:95],a[172:175],v[52:55],v[92:95]
s_waitcnt lgkmcnt(4)
s_nop 0
v_mfma_f32_16x16x32_bf16 v[64:67],a[176:179],v[56:59],v[64:67]
ds_read_b64_tr_b16 v[40:41],v176 offset:26624
s_add_u32 s40,s40,32768
v_mfma_f32_16x16x32_bf16 v[72:75],a[180:183],v[56:59],v[72:75]
ds_read_b64_tr_b16 v[42:43],v176 offset:26880
s_cmp_ge_u32 s40,131072
s_cselect_b32 s40,0,s40
v_mfma_f32_16x16x32_bf16 v[80:83],a[184:187],v[56:59],v[80:83]
ds_read_b64_tr_b16 v[44:45],v177 offset:26624
v_add_u32 v178,s40,v19
v_mfma_f32_16x16x32_bf16 v[88:91],a[188:191],v[56:59],v[88:91]
ds_read_b64_tr_b16 v[46:47],v177 offset:26880
v_xor_b32 v179,32,v178
v_mfma_f32_16x16x32_bf16 v[68:71],a[176:179],v[60:63],v[68:71]
buffer_store_dwordx4 v[128:131],v20,s[20:23],s43 offen sc1
v_mfma_f32_16x16x32_bf16 v[76:79],a[180:183],v[60:63],v[76:79]
s_nop 0
v_mfma_f32_16x16x32_bf16 v[84:87],a[184:187],v[60:63],v[84:87]
v_mfma_f32_16x16x32_bf16 v[92:95],a[188:191],v[60:63],v[92:95]
s_waitcnt lgkmcnt(4)
s_nop 0
v_mfma_f32_16x16x32_bf16 v[64:67],a[192:195],v[32:35],v[64:67]
ds_read_b64_tr_b16 v[48:49],v176 offset:28672
v_mfma_f32_16x16x32_bf16 v[72:75],a[196:199],v[32:35],v[72:75]
ds_read_b64_tr_b16 v[50:51],v176 offset:28928
v_mfma_f32_16x16x32_bf16 v[80:83],a[200:203],v[32:35],v[80:83]
ds_read_b64_tr_b16 v[52:53],v177 offset:28672
v_mfma_f32_16x16x32_bf16 v[88:91],a[204:207],v[32:35],v[88:91]
ds_read_b64_tr_b16 v[54:55],v177 offset:28928
v_mfma_f32_16x16x32_bf16 v[68:71],a[192:195],v[36:39],v[68:71]
buffer_store_dwordx4 v[132:135],v21,s[20:23],s43 offen sc1
v_mfma_f32_16x16x32_bf16 v[76:79],a[196:199],v[36:39],v[76:79]
v_mfma_f32_16x16x32_bf16 v[84:87],a[200:203],v[36:39],v[84:87]
v_mfma_f32_16x16x32_bf16 v[92:95],a[204:207],v[36:39],v[92:95]
s_waitcnt lgkmcnt(4)
s_nop 0
v_mfma_f32_16x16x32_bf16 v[64:67],a[208:211],v[40:43],v[64:67]
ds_read_b64_tr_b16 v[56:57],v176 offset:30720
v_mfma_f32_16x16x32_bf16 v[72:75],a[212:215],v[40:43],v[72:75]
ds_read_b64_tr_b16 v[58:59],v176 offset:30976
v_mfma_f32_16x16x32_bf16 v[80:83],a[216:219],v[40:43],v[80:83]
ds_read_b64_tr_b16 v[60:61],v177 offset:30720
v_mfma_f32_16x16x32_bf16 v[88:91],a[220:223],v[40:43],v[88:91]
ds_read_b64_tr_b16 v[62:63],v177 offset:30976
v_mfma_f32_16x16x32_bf16 v[68:71],a[208:211],v[44:47],v[68:71]
buffer_store_dwordx4 v[136:139],v22,s[20:23],s43 offen sc1
v_mfma_f32_16x16x32_bf16 v[76:79],a[212:215],v[44:47],v[76:79]
v_mfma_f32_16x16x32_bf16 v[84:87],a[216:219],v[44:47],v[84:87]
v_mfma_f32_16x16x32_bf16 v[92:95],a[220:223],v[44:47],v[92:95]
s_waitcnt lgkmcnt(4)
s_nop 0
v_mfma_f32_16x16x32_bf16 v[64:67],a[224:227],v[48:51],v[64:67]
s_waitcnt vmcnt(19)
s_barrier
ds_read_b64_tr_b16 v[32:33],v178 offset:0
v_mfma_f32_16x16x32_bf16 v[72:75],a[228:231],v[48:51],v[72:75]
ds_read_b64_tr_b16 v[34:35],v178 offset:256
v_mfma_f32_16x16x32_bf16 v[80:83],a[232:235],v[48:51],v[80:83]
ds_read_b64_tr_b16 v[36:37],v179 offset:0
v_mfma_f32_16x16x32_bf16 v[88:91],a[236:239],v[48:51],v[88:91]
ds_read_b64_tr_b16 v[38:39],v179 offset:256
v_mfma_f32_16x16x32_bf16 v[68:71],a[224:227],v[52:55],v[68:71]
buffer_store_dwordx4 v[140:143],v23,s[20:23],s43 offen sc1
v_mfma_f32_16x16x32_bf16 v[76:79],a[228:231],v[52:55],v[76:79]
v_mfma_f32_16x16x32_bf16 v[84:87],a[232:235],v[52:55],v[84:87]
v_mfma_f32_16x16x32_bf16 v[92:95],a[236:239],v[52:55],v[92:95]
s_waitcnt lgkmcnt(4)
s_nop 0
v_mfma_f32_16x16x32_bf16 v[64:67],a[240:243],v[56:59],v[64:67]
ds_read_b64_tr_b16 v[40:41],v178 offset:2048
v_mfma_f32_16x16x32_bf16 v[72:75],a[244:247],v[56:59],v[72:75]
ds_read_b64_tr_b16 v[42:43],v178 offset:2304
v_mfma_f32_16x16x32_bf16 v[80:83],a[248:251],v[56:59],v[80:83]
ds_read_b64_tr_b16 v[44:45],v179 offset:2048
v_mfma_f32_16x16x32_bf16 v[88:91],a[252:255],v[56:59],v[88:91]
ds_read_b64_tr_b16 v[46:47],v179 offset:2304
v_mfma_f32_16x16x32_bf16 v[68:71],a[240:243],v[60:63],v[68:71]
v_mfma_f32_16x16x32_bf16 v[76:79],a[244:247],v[60:63],v[76:79]
v_mfma_f32_16x16x32_bf16 v[84:87],a[248:251],v[60:63],v[84:87]
v_mfma_f32_16x16x32_bf16 v[92:95],a[252:255],v[60:63],v[92:95]
s_add_u32 s27,s27,1
s_cmp_lt_u32 s27,s28
s_cbranch_scc1 k1_V_l1
s_waitcnt lgkmcnt(0)
s_nop 7
s_sub_u32 s37,s27,1
s_add_u32 s37,s37,s78
s_and_b32 s37,s37,s80
s_or_b32 s37,s37,s79
s_lshr_b32 s38,s37,2
s_mul_i32 s38,s38,s33
s_and_b32 s37,s37,3
s_mul_i32 s37,s37,s34
s_add_u32 s43,s37,s38
s_add_u32 s43,s43,s32
v_cvt_pk_bf16_f32 v128,v64,v65
v_cvt_pk_bf16_f32 v129,v66,v67
v_cvt_pk_bf16_f32 v130,v72,v73
v_cvt_pk_bf16_f32 v131,v74,v75
v_cvt_pk_bf16_f32 v132,v68,v69
v_cvt_pk_bf16_f32 v133,v70,v71
v_cvt_pk_bf16_f32 v134,v76,v77
v_cvt_pk_bf16_f32 v135,v78,v79
v_cvt_pk_bf16_f32 v136,v80,v81
v_cvt_pk_bf16_f32 v137,v82,v83
v_cvt_pk_bf16_f32 v138,v88,v89
v_cvt_pk_bf16_f32 v139,v90,v91
v_cvt_pk_bf16_f32 v140,v84,v85
v_cvt_pk_bf16_f32 v141,v86,v87
v_cvt_pk_bf16_f32 v142,v92,v93
v_cvt_pk_bf16_f32 v143,v94,v95
buffer_store_dwordx4 v[128:131],v20,s[20:23],s43 offen sc1
buffer_store_dwordx4 v[132:135],v21,s[20:23],s43 offen sc1
buffer_store_dwordx4 v[136:139],v22,s[20:23],s43 offen sc1
buffer_store_dwordx4 v[140:143],v23,s[20:23],s43 offen sc1
s_branch k1_end
k1_V_t1:
s_waitcnt lgkmcnt(0)
s_nop 7
s_sub_u32 s37,s27,1
s_add_u32 s37,s37,s78
s_and_b32 s37,s37,s80
s_or_b32 s37,s37,s79
s_lshr_b32 s38,s37,2
s_mul_i32 s38,s38,s33
s_and_b32 s37,s37,3
s_mul_i32 s37,s37,s34
s_add_u32 s43,s37,s38
s_add_u32 s43,s43,s32
v_cvt_pk_bf16_f32 v128,v96,v97
v_cvt_pk_bf16_f32 v129,v98,v99
v_cvt_pk_bf16_f32 v130,v104,v105
v_cvt_pk_bf16_f32 v131,v106,v107
v_cvt_pk_bf16_f32 v132,v100,v101
v_cvt_pk_bf16_f32 v133,v102,v103
v_cvt_pk_bf16_f32 v134,v108,v109
v_cvt_pk_bf16_f32 v135,v110,v111
v_cvt_pk_bf16_f32 v136,v112,v113
v_cvt_pk_bf16_f32 v137,v114,v115
v_cvt_pk_bf16_f32 v138,v120,v121
v_cvt_pk_bf16_f32 v139,v122,v123
v_cvt_pk_bf16_f32 v140,v116,v117
v_cvt_pk_bf16_f32 v141,v118,v119
v_cvt_pk_bf16_f32 v142,v124,v125
v_cvt_pk_bf16_f32 v143,v126,v127
buffer_store_dwordx4 v[128:131],v20,s[20:23],s43 offen sc1
buffer_store_dwordx4 v[132:135],v21,s[20:23],s43 offen sc1
buffer_store_dwordx4 v[136:139],v22,s[20:23],s43 offen sc1
buffer_store_dwordx4 v[140:143],v23,s[20:23],s43 offen sc1
s_branch k1_end
k1_typeQ:
s_mov_b32 s45,9216
s_mul_i32 s46,s49,36864
s_mov_b32 s29,131072
s_mul_i32 s30,s24,1179648
s_mul_i32 s41,s24,9216
v_mul_u32_u24 v16,8192,v7
v_add_u32_e64 v16,v16,v6
v_lshrrev_b32 v8,3,v1
v_mul_u32_u24 v8,1152,v8
v_and_b32 v9,7,v1
v_lshrrev_b32 v2,4,v1
v_xor_b32 v9,v9,v2
v_lshl_add_u32 v24,v9,4,v8
v_xor_b32 v9,4,v9
v_lshl_add_u32 v25,v9,4,v8
v_and_b32 v2,15,v1
v_lshlrev_b32 v2,4,v2
v_bfe_u32 v3,v1,4,1
v_lshrrev_b32 v4,5,v1
s_mov_b32 s38,1024
v_mul_lo_u32 v3,v3,s38
v_lshl_add_u32 v9,v4,9,v3
v_add_u32 v20,v2,v9
v_add_u32 v21,256,v20
v_add_u32 v22,8192,v20
v_add_u32 v23,8192,v21
s_sub_u32 s36,s26,16
s_mul_i32 s27,s36,12
s_min_u32 s37,s36,8
s_add_u32 s27,s27,s37
s_cmp_lt_u32 s36,8
s_cselect_b32 s28,13,12
s_add_u32 s28,s28,s27
s_mov_b32 s47,s27
s_mov_b32 s44,4718592
s_mov_b32 s33,524288
s_mov_b32 s35,1040356334
s_lshl_b32 s32,s49,13
s_add_u32 s32,s32,0
s_waitcnt lgkmcnt(0)
s_mov_b32 s12,s62
s_mov_b32 s13,s63
s_mov_b32 s14,4718592
s_mov_b32 s15,0x20000
s_mov_b32 s8,s58
s_mov_b32 s9,s59
s_mov_b32 s10,2359296
s_mov_b32 s11,0x20000
s_mov_b32 s16,s74
s_mov_b32 s17,s75
s_mov_b32 s18,268435456
s_mov_b32 s19,0x20000
s_mov_b32 s20,s74
s_mov_b32 s21,s75
s_mov_b32 s22,268435456
s_mov_b32 s23,0x20000
k1_T576:
s_mul_i32 s39,s24,16384
s_add_u32 s39,s39,73728
s_add_u32 s42,s47,s78
s_and_b32 s42,s42,s80
s_or_b32 s42,s42,s79
s_mul_i32 s42,s42,s31
s_add_u32 s42,s42,s30
s_cmp_lt_u32 s47,s28
s_cselect_b32 s14,s44,0
s_add_u32 s47,s47,1
s_add_u32 m0,s41,0
s_nop 0
buffer_load_dwordx4 v16,s[12:15],s42 offen lds
s_add_u32 m0,s41,1024
s_add_u32 s42,s42,s29
buffer_load_dwordx4 v16,s[12:15],s42 offen lds
s_add_u32 m0,s41,2048
s_add_u32 s42,s42,s29
buffer_load_dwordx4 v16,s[12:15],s42 offen lds
s_add_u32 m0,s41,3072
s_add_u32 s42,s42,s29
buffer_load_dwordx4 v16,s[12:15],s42 offen lds
s_add_u32 m0,s41,4096
s_add_u32 s42,s42,s29
buffer_load_dwordx4 v16,s[12:15],s42 offen lds
s_add_u32 m0,s41,5120
s_add_u32 s42,s42,s29
buffer_load_dwordx4 v16,s[12:15],s42 offen lds
s_add_u32 m0,s41,6144
s_add_u32 s42,s42,s29
buffer_load_dwordx4 v16,s[12:15],s42 offen lds
s_add_u32 m0,s41,7168
s_add_u32 s42,s42,s29
buffer_load_dwordx4 v16,s[12:15],s42 offen lds
s_add_u32 m0,s41,8192
s_add_u32 s42,s42,s29
buffer_load_dwordx4 v16,s[12:15],s42 offen lds
s_add_u32 s41,s41,36864
s_sub_u32 s36,s41,147456
s_cmp_ge_u32 s41,147456
s_cselect_b32 s41,s36,s41
s_lshr_b32 s37,s2,3
s_and_b32 s37,s37,7
s_lshl_b32 s37,s37,2
s_add_u32 s37,s37,s24
s_lshl_b32 s38,s25,5
s_add_u32 s37,s37,s38
s_mul_i32 s37,s37,9216
v_lshlrev_b32 v2,4,v1
buffer_load_dwordx4 v[180:183],v2,s[8:11],s37 offen offset:0
buffer_load_dwordx4 v[184:187],v2,s[8:11],s37 offen offset:1024
buffer_load_dwordx4 v[188:191],v2,s[8:11],s37 offen offset:2048
buffer_load_dwordx4 v[192:195],v2,s[8:11],s37 offen offset:3072
s_add_u32 s37,s37,4096
buffer_load_dwordx4 v[196:199],v2,s[8:11],s37 offen offset:0
buffer_load_dwordx4 v[200:203],v2,s[8:11],s37 offen offset:1024
buffer_load_dwordx4 v[204:207],v2,s[8:11],s37 offen offset:2048
buffer_load_dwordx4 v[208:211],v2,s[8:11],s37 offen offset:3072
s_add_u32 s37,s37,4096
buffer_load_dwordx4 v[212:215],v2,s[8:11],s37 offen offset:0
s_add_u32 s36,s46,0
s_add_u32 m0,s39,0
s_nop 0
buffer_load_dwordx4 v24,s[8:11],s36 offen lds
s_add_u32 m0,s39,1024
s_add_u32 s36,s36,s45
buffer_load_dwordx4 v25,s[8:11],s36 offen lds
s_add_u32 m0,s39,2048
s_add_u32 s36,s36,s45
buffer_load_dwordx4 v25,s[8:11],s36 offen lds
s_add_u32 m0,s39,3072
s_add_u32 s36,s36,s45
buffer_load_dwordx4 v24,s[8:11],s36 offen lds
s_add_u32 m0,s39,4096
s_add_u32 s36,s36,s45
buffer_load_dwordx4 v24,s[8:11],s36 offen lds
s_add_u32 m0,s39,5120
s_add_u32 s36,s36,s45
buffer_load_dwordx4 v25,s[8:11],s36 offen lds
s_add_u32 m0,s39,6144
s_add_u32 s36,s36,s45
buffer_load_dwordx4 v25,s[8:11],s36 offen lds
s_add_u32 m0,s39,7168
s_add_u32 s36,s36,s45
buffer_load_dwordx4 v24,s[8:11],s36 offen lds
s_add_u32 s36,s46,128
s_add_u32 m0,s39,8192
s_nop 0
buffer_load_dwordx4 v24,s[8:11],s36 offen lds
s_add_u32 m0,s39,9216
s_add_u32 s36,s36,s45
buffer_load_dwordx4 v25,s[8:11],s36 offen lds
s_add_u32 m0,s39,10240
s_add_u32 s36,s36,s45
buffer_load_dwordx4 v25,s[8:11],s36 offen lds
s_add_u32 m0,s39,11264
s_add_u32 s36,s36,s45
buffer_load_dwordx4 v24,s[8:11],s36 offen lds
s_add_u32 m0,s39,12288
s_add_u32 s36,s36,s45
buffer_load_dwordx4 v24,s[8:11],s36 offen lds
s_add_u32 m0,s39,13312
s_add_u32 s36,s36,s45
buffer_load_dwordx4 v25,s[8:11],s36 offen lds
s_add_u32 m0,s39,14336
s_add_u32 s36,s36,s45
buffer_load_dwordx4 v25,s[8:11],s36 offen lds
s_add_u32 m0,s39,15360
s_add_u32 s36,s36,s45
buffer_load_dwordx4 v24,s[8:11],s36 offen lds
v_add_u32 v26,s39,v26
v_xor_b32 v27,64,v26
s_lshr_b32 s81,s29,4
s_lshr_b32 s94,s29,2
s_lshr_b32 s51,s49,1
s_mul_i32 s51,s51,18
s_mul_i32 s51,s51,s81
s_mul_i32 s37,s27,s31
s_add_u32 s51,s51,s37
s_add_u32 s51,s51,s76
s_mov_b32 s84,s12
s_mov_b32 s85,s13
s_mov_b32 s86,s44
s_mov_b32 s87,0x20000
s_sub_u32 s82,s28,s27
s_mul_i32 s82,s82,s31
s_add_u32 s82,s82,-130
s_lshr_b32 s82,s82,8
s_min_u32 s82,s82,2
s_lshl_b32 s37,s78,6
s_lshl_b32 s92,s80,6
s_or_b32 s92,s92,63
s_add_u32 s83,s37,256
v_and_b32 v2,31,v1
v_lshlrev_b32 v2,4,v2
v_add_u32 v2,s37,v2
v_and_b32 v2,s92,v2
v_lshrrev_b32 v3,5,v1
v_mul_lo_u32 v3,v3,s81
v_add_u32 v31,v2,v3
v_and_b32 v2,15,v1
v_lshlrev_b32 v2,4,v2
v_lshrrev_b32 v3,4,v1
v_mul_lo_u32 v3,v3,s81
v_add_u32 v30,v2,v3
v_mov_b32_e64 v176,v19
v_xor_b32 v177,32,v19
s_mov_b32 s40,36864
v_add_u32 v178,s40,v19
v_xor_b32 v179,32,v178
s_lshl_b32 s37,s78,6
s_add_u32 s37,s37,0
s_and_b32 s37,s37,s92
s_add_u32 s93,s51,s37
buffer_load_dwordx4 v[180:183],v30,s[84:87],s93 offen
s_add_u32 s93,s93,s94
buffer_load_dwordx4 v[184:187],v30,s[84:87],s93 offen
s_add_u32 s93,s93,s94
buffer_load_dwordx4 v[188:191],v30,s[84:87],s93 offen
s_add_u32 s93,s93,s94
buffer_load_dwordx4 v[192:195],v30,s[84:87],s93 offen
s_add_u32 s93,s93,s94
buffer_load_dwordx4 v[196:199],v30,s[84:87],s93 offen
s_add_u32 s93,s93,s94
s_waitcnt vmcnt(13)
s_barrier
ds_read_b128 a[0:3],v26 offset:0
ds_read_b128 a[4:7],v27 offset:2048
ds_read_b128 a[8:11],v26 offset:4096
ds_read_b128 a[12:15],v27 offset:6144
ds_read_b128 a[16:19],v27 offset:0
ds_read_b128 a[20:23],v26 offset:2048
ds_read_b128 a[24:27],v27 offset:4096
ds_read_b128 a[28:31],v26 offset:6144
s_waitcnt lgkmcnt(6)
ds_read_b64_tr_b16 v[32:33],v176 offset:0
ds_read_b64_tr_b16 v[34:35],v176 offset:256
ds_read_b64_tr_b16 v[36:37],v177 offset:0
ds_read_b64_tr_b16 v[38:39],v177 offset:256
ds_read_b64_tr_b16 v[40:41],v176 offset:2048
ds_read_b64_tr_b16 v[42:43],v176 offset:2304
ds_read_b64_tr_b16 v[44:45],v177 offset:2048
ds_read_b64_tr_b16 v[46:47],v177 offset:2304
s_waitcnt lgkmcnt(8)
s_add_u32 s36,s46,256
s_add_u32 m0,s39,0
s_nop 0
buffer_load_dwordx4 v24,s[8:11],s36 offen lds
s_add_u32 m0,s39,1024
s_add_u32 s36,s36,s45
buffer_load_dwordx4 v25,s[8:11],s36 offen lds
s_add_u32 m0,s39,2048
s_add_u32 s36,s36,s45
buffer_load_dwordx4 v25,s[8:11],s36 offen lds
s_add_u32 m0,s39,3072
s_add_u32 s36,s36,s45
buffer_load_dwordx4 v24,s[8:11],s36 offen lds
s_add_u32 m0,s39,4096
s_add_u32 s36,s36,s45
buffer_load_dwordx4 v24,s[8:11],s36 offen lds
s_add_u32 m0,s39,5120
s_add_u32 s36,s36,s45
buffer_load_dwordx4 v25,s[8:11],s36 offen lds
s_add_u32 m0,s39,6144
s_add_u32 s36,s36,s45
buffer_load_dwordx4 v25,s[8:11],s36 offen lds
s_add_u32 m0,s39,7168
s_add_u32 s36,s36,s45
buffer_load_dwordx4 v24,s[8:11],s36 offen lds
s_waitcnt lgkmcnt(0)
v_mfma_f32_16x16x32_bf16 v[64:67],v[32:35],a[0:3],0
s_nop 0
v_mfma_f32_16x16x32_bf16 v[72:75],v[32:35],a[4:7],0
v_mfma_f32_16x16x32_bf16 v[80:83],v[32:35],a[8:11],0
v_mfma_f32_16x16x32_bf16 v[88:91],v[32:35],a[12:15],0
v_mfma_f32_16x16x32_bf16 v[68:71],v[36:39],a[0:3],0
v_mfma_f32_16x16x32_bf16 v[76:79],v[36:39],a[4:7],0
v_mfma_f32_16x16x32_bf16 v[84:87],v[36:39],a[8:11],0
v_mfma_f32_16x16x32_bf16 v[92:95],v[36:39],a[12:15],0
v_mfma_f32_16x16x32_bf16 v[64:67],v[40:43],a[16:19],v[64:67]
v_mfma_f32_16x16x32_bf16 v[72:75],v[40:43],a[20:23],v[72:75]
v_mfma_f32_16x16x32_bf16 v[80:83],v[40:43],a[24:27],v[80:83]
v_mfma_f32_16x16x32_bf16 v[88:91],v[40:43],a[28:31],v[88:91]
v_mfma_f32_16x16x32_bf16 v[68:71],v[44:47],a[16:19],v[68:71]
v_mfma_f32_16x16x32_bf16 v[76:79],v[44:47],a[20:23],v[76:79]
v_mfma_f32_16x16x32_bf16 v[84:87],v[44:47],a[24:27],v[84:87]
v_mfma_f32_16x16x32_bf16 v[92:95],v[44:47],a[28:31],v[92:95]
s_waitcnt vmcnt(13)
ds_read_b128 a[32:35],v26 offset:8192
ds_read_b128 a[36:39],v27 offset:10240
ds_read_b128 a[40:43],v26 offset:12288
ds_read_b128 a[44:47],v27 offset:14336
ds_read_b128 a[48:51],v27 offset:8192
ds_read_b128 a[52:55],v26 offset:10240
ds_read_b128 a[56:59],v27 offset:12288
ds_read_b128 a[60:63],v26 offset:14336
s_waitcnt lgkmcnt(6)
ds_read_b64_tr_b16 v[32:33],v176 offset:4096
ds_read_b64_tr_b16 v[34:35],v176 offset:4352
ds_read_b64_tr_b16 v[36:37],v177 offset:4096
ds_read_b64_tr_b16 v[38:39],v177 offset:4352
ds_read_b64_tr_b16 v[40:41],v176 offset:6144
ds_read_b64_tr_b16 v[42:43],v176 offset:6400
ds_read_b64_tr_b16 v[44:45],v177 offset:6144
ds_read_b64_tr_b16 v[46:47],v177 offset:6400
s_waitcnt lgkmcnt(8)
s_add_u32 s36,s46,384
s_add_u32 m0,s39,8192
s_nop 0
buffer_load_dwordx4 v24,s[8:11],s36 offen lds
s_add_u32 m0,s39,9216
s_add_u32 s36,s36,s45
buffer_load_dwordx4 v25,s[8:11],s36 offen lds
s_add_u32 m0,s39,10240
s_add_u32 s36,s36,s45
buffer_load_dwordx4 v25,s[8:11],s36 offen lds
s_add_u32 m0,s39,11264
s_add_u32 s36,s36,s45
buffer_load_dwordx4 v24,s[8:11],s36 offen lds
s_add_u32 m0,s39,12288
s_add_u32 s36,s36,s45
buffer_load_dwordx4 v24,s[8:11],s36 offen lds
s_add_u32 m0,s39,13312
s_add_u32 s36,s36,s45
buffer_load_dwordx4 v25,s[8:11],s36 offen lds
s_add_u32 m0,s39,14336
s_add_u32 s36,s36,s45
buffer_load_dwordx4 v25,s[8:11],s36 offen lds
s_add_u32 m0,s39,15360
s_add_u32 s36,s36,s45
buffer_load_dwordx4 v24,s[8:11],s36 offen lds
s_waitcnt lgkmcnt(0)
v_mfma_f32_16x16x32_bf16 v[64:67],v[32:35],a[32:35],v[64:67]
v_mfma_f32_16x16x32_bf16 v[72:75],v[32:35],a[36:39],v[72:75]
v_mfma_f32_16x16x32_bf16 v[80:83],v[32:35],a[40:43],v[80:83]
v_mfma_f32_16x16x32_bf16 v[88:91],v[32:35],a[44:47],v[88:91]
v_mfma_f32_16x16x32_bf16 v[68:71],v[36:39],a[32:35],v[68:71]
v_mfma_f32_16x16x32_bf16 v[76:79],v[36:39],a[36:39],v[76:79]
v_mfma_f32_16x16x32_bf16 v[84:87],v[36:39],a[40:43],v[84:87]
v_mfma_f32_16x16x32_bf16 v[92:95],v[36:39],a[44:47],v[92:95]
v_mfma_f32_16x16x32_bf16 v[64:67],v[40:43],a[48:51],v[64:67]
v_mfma_f32_16x16x32_bf16 v[72:75],v[40:43],a[52:55],v[72:75]
v_mfma_f32_16x16x32_bf16 v[80:83],v[40:43],a[56:59],v[80:83]
v_mfma_f32_16x16x32_bf16 v[88:91],v[40:43],a[60:63],v[88:91]
v_mfma_f32_16x16x32_bf16 v[68:71],v[44:47],a[48:51],v[68:71]
v_mfma_f32_16x16x32_bf16 v[76:79],v[44:47],a[52:55],v[76:79]
v_mfma_f32_16x16x32_bf16 v[84:87],v[44:47],a[56:59],v[84:87]
v_mfma_f32_16x16x32_bf16 v[92:95],v[44:47],a[60:63],v[92:95]
s_waitcnt vmcnt(8)
ds_read_b128 a[64:67],v26 offset:0
ds_read_b128 a[68:71],v27 offset:2048
ds_read_b128 a[72:75],v26 offset:4096
ds_read_b128 a[76:79],v27 offset:6144
ds_read_b128 a[80:83],v27 offset:0
ds_read_b128 a[84:87],v26 offset:2048
ds_read_b128 a[88:91],v27 offset:4096
ds_read_b128 a[92:95],v26 offset:6144
s_waitcnt lgkmcnt(6)
ds_read_b64_tr_b16 v[32:33],v176 offset:8192
ds_read_b64_tr_b16 v[34:35],v176 offset:8448
ds_read_b64_tr_b16 v[36:37],v177 offset:8192
ds_read_b64_tr_b16 v[38:39],v177 offset:8448
ds_read_b64_tr_b16 v[40:41],v176 offset:10240
ds_read_b64_tr_b16 v[42:43],v176 offset:10496
ds_read_b64_tr_b16 v[44:45],v177 offset:10240
ds_read_b64_tr_b16 v[46:47],v177 offset:10496
s_waitcnt lgkmcnt(8)
s_add_u32 s36,s46,512
s_add_u32 m0,s39,0
s_nop 0
buffer_load_dwordx4 v24,s[8:11],s36 offen lds
s_add_u32 m0,s39,1024
s_add_u32 s36,s36,s45
buffer_load_dwordx4 v25,s[8:11],s36 offen lds
s_add_u32 m0,s39,2048
s_add_u32 s36,s36,s45
buffer_load_dwordx4 v25,s[8:11],s36 offen lds
s_add_u32 m0,s39,3072
s_add_u32 s36,s36,s45
buffer_load_dwordx4 v24,s[8:11],s36 offen lds
s_add_u32 m0,s39,4096
s_add_u32 s36,s36,s45
buffer_load_dwordx4 v24,s[8:11],s36 offen lds
s_add_u32 m0,s39,5120
s_add_u32 s36,s36,s45
buffer_load_dwordx4 v25,s[8:11],s36 offen lds
s_add_u32 m0,s39,6144
s_add_u32 s36,s36,s45
buffer_load_dwordx4 v25,s[8:11],s36 offen lds
s_add_u32 m0,s39,7168
s_add_u32 s36,s36,s45
buffer_load_dwordx4 v24,s[8:11],s36 offen lds
s_waitcnt lgkmcnt(0)
v_mfma_f32_16x16x32_bf16 v[64:67],v[32:35],a[64:67],v[64:67]
s_nop 0
v_mfma_f32_16x16x32_bf16 v[72:75],v[32:35],a[68:71],v[72:75]
v_mfma_f32_16x16x32_bf16 v[80:83],v[32:35],a[72:75],v[80:83]
v_mfma_f32_16x16x32_bf16 v[88:91],v[32:35],a[76:79],v[88:91]
v_mfma_f32_16x16x32_bf16 v[68:71],v[36:39],a[64:67],v[68:71]
v_mfma_f32_16x16x32_bf16 v[76:79],v[36:39],a[68:71],v[76:79]
v_mfma_f32_16x16x32_bf16 v[84:87],v[36:39],a[72:75],v[84:87]
v_mfma_f32_16x16x32_bf16 v[92:95],v[36:39],a[76:79],v[92:95]
v_mfma_f32_16x16x32_bf16 v[64:67],v[40:43],a[80:83],v[64:67]
v_mfma_f32_16x16x32_bf16 v[72:75],v[40:43],a[84:87],v[72:75]
v_mfma_f32_16x16x32_bf16 v[80:83],v[40:43],a[88:91],v[80:83]
v_mfma_f32_16x16x32_bf16 v[88:91],v[40:43],a[92:95],v[88:91]
v_mfma_f32_16x16x32_bf16 v[68:71],v[44:47],a[80:83],v[68:71]
v_mfma_f32_16x16x32_bf16 v[76:79],v[44:47],a[84:87],v[76:79]
v_mfma_f32_16x16x32_bf16 v[84:87],v[44:47],a[88:91],v[84:87]
v_mfma_f32_16x16x32_bf16 v[92:95],v[44:47],a[92:95],v[92:95]
s_waitcnt vmcnt(8)
ds_read_b128 a[96:99],v26 offset:8192
ds_read_b128 a[100:103],v27 offset:10240
ds_read_b128 a[104:107],v26 offset:12288
ds_read_b128 a[108:111],v27 offset:14336
ds_read_b128 a[112:115],v27 offset:8192
ds_read_b128 a[116:119],v26 offset:10240
ds_read_b128 a[120:123],v27 offset:12288
ds_read_b128 a[124:127],v26 offset:14336
s_waitcnt lgkmcnt(6)
ds_read_b64_tr_b16 v[32:33],v176 offset:12288
ds_read_b64_tr_b16 v[34:35],v176 offset:12544
ds_read_b64_tr_b16 v[36:37],v177 offset:12288
ds_read_b64_tr_b16 v[38:39],v177 offset:12544
ds_read_b64_tr_b16 v[40:41],v176 offset:14336
ds_read_b64_tr_b16 v[42:43],v176 offset:14592
ds_read_b64_tr_b16 v[44:45],v177 offset:14336
ds_read_b64_tr_b16 v[46:47],v177 offset:14592
s_waitcnt lgkmcnt(8)
s_add_u32 s36,s46,640
s_add_u32 m0,s39,8192
s_nop 0
buffer_load_dwordx4 v24,s[8:11],s36 offen lds
s_add_u32 m0,s39,9216
s_add_u32 s36,s36,s45
buffer_load_dwordx4 v25,s[8:11],s36 offen lds
s_add_u32 m0,s39,10240
s_add_u32 s36,s36,s45
buffer_load_dwordx4 v25,s[8:11],s36 offen lds
s_add_u32 m0,s39,11264
s_add_u32 s36,s36,s45
buffer_load_dwordx4 v24,s[8:11],s36 offen lds
s_add_u32 m0,s39,12288
s_add_u32 s36,s36,s45
buffer_load_dwordx4 v24,s[8:11],s36 offen lds
s_add_u32 m0,s39,13312
s_add_u32 s36,s36,s45
buffer_load_dwordx4 v25,s[8:11],s36 offen lds
s_add_u32 m0,s39,14336
s_add_u32 s36,s36,s45
buffer_load_dwordx4 v25,s[8:11],s36 offen lds
s_add_u32 m0,s39,15360
s_add_u32 s36,s36,s45
buffer_load_dwordx4 v24,s[8:11],s36 offen lds
s_waitcnt lgkmcnt(0)
v_mfma_f32_16x16x32_bf16 v[64:67],v[32:35],a[96:99],v[64:67]
v_mfma_f32_16x16x32_bf16 v[72:75],v[32:35],a[100:103],v[72:75]
v_mfma_f32_16x16x32_bf16 v[80:83],v[32:35],a[104:107],v[80:83]
v_mfma_f32_16x16x32_bf16 v[88:91],v[32:35],a[108:111],v[88:91]
v_mfma_f32_16x16x32_bf16 v[68:71],v[36:39],a[96:99],v[68:71]
v_mfma_f32_16x16x32_bf16 v[76:79],v[36:39],a[100:103],v[76:79]
v_mfma_f32_16x16x32_bf16 v[84:87],v[36:39],a[104:107],v[84:87]
v_mfma_f32_16x16x32_bf16 v[92:95],v[36:39],a[108:111],v[92:95]
v_mfma_f32_16x16x32_bf16 v[64:67],v[40:43],a[112:115],v[64:67]
v_mfma_f32_16x16x32_bf16 v[72:75],v[40:43],a[116:119],v[72:75]
v_mfma_f32_16x16x32_bf16 v[80:83],v[40:43],a[120:123],v[80:83]
v_mfma_f32_16x16x32_bf16 v[88:91],v[40:43],a[124:127],v[88:91]
v_mfma_f32_16x16x32_bf16 v[68:71],v[44:47],a[112:115],v[68:71]
v_mfma_f32_16x16x32_bf16 v[76:79],v[44:47],a[116:119],v[76:79]
v_mfma_f32_16x16x32_bf16 v[84:87],v[44:47],a[120:123],v[84:87]
v_mfma_f32_16x16x32_bf16 v[92:95],v[44:47],a[124:127],v[92:95]
s_waitcnt vmcnt(8)
ds_read_b128 a[128:131],v26 offset:0
ds_read_b128 a[132:135],v27 offset:2048
ds_read_b128 a[136:139],v26 offset:4096
ds_read_b128 a[140:143],v27 offset:6144
ds_read_b128 a[144:147],v27 offset:0
ds_read_b128 a[148:151],v26 offset:2048
ds_read_b128 a[152:155],v27 offset:4096
ds_read_b128 a[156:159],v26 offset:6144
s_waitcnt lgkmcnt(6)
ds_read_b64_tr_b16 v[32:33],v176 offset:16384
ds_read_b64_tr_b16 v[34:35],v176 offset:16640
ds_read_b64_tr_b16 v[36:37],v177 offset:16384
ds_read_b64_tr_b16 v[38:39],v177 offset:16640
ds_read_b64_tr_b16 v[40:41],v176 offset:18432
ds_read_b64_tr_b16 v[42:43],v176 offset:18688
ds_read_b64_tr_b16 v[44:45],v177 offset:18432
ds_read_b64_tr_b16 v[46:47],v177 offset:18688
s_waitcnt lgkmcnt(8)
s_add_u32 s36,s46,768
s_add_u32 m0,s39,0
s_nop 0
buffer_load_dwordx4 v24,s[8:11],s36 offen lds
s_add_u32 m0,s39,1024
s_add_u32 s36,s36,s45
buffer_load_dwordx4 v25,s[8:11],s36 offen lds
s_add_u32 m0,s39,2048
s_add_u32 s36,s36,s45
buffer_load_dwordx4 v25,s[8:11],s36 offen lds
s_add_u32 m0,s39,3072
s_add_u32 s36,s36,s45
buffer_load_dwordx4 v24,s[8:11],s36 offen lds
s_add_u32 m0,s39,4096
s_add_u32 s36,s36,s45
buffer_load_dwordx4 v24,s[8:11],s36 offen lds
s_add_u32 m0,s39,5120
s_add_u32 s36,s36,s45
buffer_load_dwordx4 v25,s[8:11],s36 offen lds
s_add_u32 m0,s39,6144
s_add_u32 s36,s36,s45
buffer_load_dwordx4 v25,s[8:11],s36 offen lds
s_add_u32 m0,s39,7168
s_add_u32 s36,s36,s45
buffer_load_dwordx4 v24,s[8:11],s36 offen lds
s_waitcnt lgkmcnt(0)
v_mfma_f32_16x16x32_bf16 v[64:67],v[32:35],a[128:131],v[64:67]
s_nop 0
v_mfma_f32_16x16x32_bf16 v[72:75],v[32:35],a[132:135],v[72:75]
v_mfma_f32_16x16x32_bf16 v[80:83],v[32:35],a[136:139],v[80:83]
v_mfma_f32_16x16x32_bf16 v[88:91],v[32:35],a[140:143],v[88:91]
v_mfma_f32_16x16x32_bf16 v[68:71],v[36:39],a[128:131],v[68:71]
v_mfma_f32_16x16x32_bf16 v[76:79],v[36:39],a[132:135],v[76:79]
v_mfma_f32_16x16x32_bf16 v[84:87],v[36:39],a[136:139],v[84:87]
v_mfma_f32_16x16x32_bf16 v[92:95],v[36:39],a[140:143],v[92:95]
v_mfma_f32_16x16x32_bf16 v[64:67],v[40:43],a[144:147],v[64:67]
v_mfma_f32_16x16x32_bf16 v[72:75],v[40:43],a[148:151],v[72:75]
v_mfma_f32_16x16x32_bf16 v[80:83],v[40:43],a[152:155],v[80:83]
v_mfma_f32_16x16x32_bf16 v[88:91],v[40:43],a[156:159],v[88:91]
v_mfma_f32_16x16x32_bf16 v[68:71],v[44:47],a[144:147],v[68:71]
v_mfma_f32_16x16x32_bf16 v[76:79],v[44:47],a[148:151],v[76:79]
v_mfma_f32_16x16x32_bf16 v[84:87],v[44:47],a[152:155],v[84:87]
v_mfma_f32_16x16x32_bf16 v[92:95],v[44:47],a[156:159],v[92:95]
s_waitcnt vmcnt(8)
ds_read_b128 a[160:163],v26 offset:8192
ds_read_b128 a[164:167],v27 offset:10240
ds_read_b128 a[168:171],v26 offset:12288
ds_read_b128 a[172:175],v27 offset:14336
ds_read_b128 a[176:179],v27 offset:8192
ds_read_b128 a[180:183],v26 offset:10240
ds_read_b128 a[184:187],v27 offset:12288
ds_read_b128 a[188:191],v26 offset:14336
s_waitcnt lgkmcnt(6)
ds_read_b64_tr_b16 v[32:33],v176 offset:20480
ds_read_b64_tr_b16 v[34:35],v176 offset:20736
ds_read_b64_tr_b16 v[36:37],v177 offset:20480
ds_read_b64_tr_b16 v[38:39],v177 offset:20736
ds_read_b64_tr_b16 v[40:41],v176 offset:22528
ds_read_b64_tr_b16 v[42:43],v176 offset:22784
ds_read_b64_tr_b16 v[44:45],v177 offset:22528
ds_read_b64_tr_b16 v[46:47],v177 offset:22784
s_waitcnt lgkmcnt(8)
s_add_u32 s36,s46,896
s_add_u32 m0,s39,8192
s_nop 0
buffer_load_dwordx4 v24,s[8:11],s36 offen lds
s_add_u32 m0,s39,9216
s_add_u32 s36,s36,s45
buffer_load_dwordx4 v25,s[8:11],s36 offen lds
s_add_u32 m0,s39,10240
s_add_u32 s36,s36,s45
buffer_load_dwordx4 v25,s[8:11],s36 offen lds
s_add_u32 m0,s39,11264
s_add_u32 s36,s36,s45
buffer_load_dwordx4 v24,s[8:11],s36 offen lds
s_add_u32 m0,s39,12288
s_add_u32 s36,s36,s45
buffer_load_dwordx4 v24,s[8:11],s36 offen lds
s_add_u32 m0,s39,13312
s_add_u32 s36,s36,s45
buffer_load_dwordx4 v25,s[8:11],s36 offen lds
s_add_u32 m0,s39,14336
s_add_u32 s36,s36,s45
buffer_load_dwordx4 v25,s[8:11],s36 offen lds
s_add_u32 m0,s39,15360
s_add_u32 s36,s36,s45
buffer_load_dwordx4 v24,s[8:11],s36 offen lds
s_add_u32 s42,s47,s78
s_and_b32 s42,s42,s80
s_or_b32 s42,s42,s79
s_mul_i32 s42,s42,s31
s_add_u32 s42,s42,s30
s_cmp_lt_u32 s47,s28
s_cselect_b32 s14,s44,0
s_add_u32 s47,s47,1
s_add_u32 m0,s41,0
s_nop 0
buffer_load_dwordx4 v16,s[12:15],s42 offen lds
s_add_u32 m0,s41,1024
s_add_u32 s42,s42,s29
buffer_load_dwordx4 v16,s[12:15],s42 offen lds
s_add_u32 m0,s41,2048
s_add_u32 s42,s42,s29
buffer_load_dwordx4 v16,s[12:15],s42 offen lds
s_add_u32 m0,s41,3072
s_add_u32 s42,s42,s29
buffer_load_dwordx4 v16,s[12:15],s42 offen lds
s_add_u32 m0,s41,4096
s_add_u32 s42,s42,s29
buffer_load_dwordx4 v16,s[12:15],s42 offen lds
s_add_u32 m0,s41,5120
s_add_u32 s42,s42,s29
buffer_load_dwordx4 v16,s[12:15],s42 offen lds
s_add_u32 m0,s41,6144
s_add_u32 s42,s42,s29
buffer_load_dwordx4 v16,s[12:15],s42 offen lds
s_add_u32 m0,s41,7168
s_add_u32 s42,s42,s29
buffer_load_dwordx4 v16,s[12:15],s42 offen lds
s_add_u32 m0,s41,8192
s_add_u32 s42,s42,s29
buffer_load_dwordx4 v16,s[12:15],s42 offen lds
s_add_u32 s41,s41,36864
s_sub_u32 s36,s41,147456
s_cmp_ge_u32 s41,147456
s_cselect_b32 s41,s36,s41
s_waitcnt lgkmcnt(0)
v_mfma_f32_16x16x32_bf16 v[64:67],v[32:35],a[160:163],v[64:67]
s_nop 0
v_mfma_f32_16x16x32_bf16 v[72:75],v[32:35],a[164:167],v[72:75]
v_mfma_f32_16x16x32_bf16 v[80:83],v[32:35],a[168:171],v[80:83]
v_mfma_f32_16x16x32_bf16 v[88:91],v[32:35],a[172:175],v[88:91]
v_mfma_f32_16x16x32_bf16 v[68:71],v[36:39],a[160:163],v[68:71]
v_mfma_f32_16x16x32_bf16 v[76:79],v[36:39],a[164:167],v[76:79]
v_mfma_f32_16x16x32_bf16 v[84:87],v[36:39],a[168:171],v[84:87]
v_mfma_f32_16x16x32_bf16 v[92:95],v[36:39],a[172:175],v[92:95]
v_mfma_f32_16x16x32_bf16 v[64:67],v[40:43],a[176:179],v[64:67]
v_mfma_f32_16x16x32_bf16 v[72:75],v[40:43],a[180:183],v[72:75]
v_mfma_f32_16x16x32_bf16 v[80:83],v[40:43],a[184:187],v[80:83]
v_mfma_f32_16x16x32_bf16 v[88:91],v[40:43],a[188:191],v[88:91]
v_mfma_f32_16x16x32_bf16 v[68:71],v[44:47],a[176:179],v[68:71]
v_mfma_f32_16x16x32_bf16 v[76:79],v[44:47],a[180:183],v[76:79]
v_mfma_f32_16x16x32_bf16 v[84:87],v[44:47],a[184:187],v[84:87]
v_mfma_f32_16x16x32_bf16 v[92:95],v[44:47],a[188:191],v[92:95]
s_waitcnt vmcnt(17)
ds_read_b128 a[192:195],v26 offset:0
ds_read_b128 a[196:199],v27 offset:2048
ds_read_b128 a[200:203],v26 offset:4096
ds_read_b128 a[204:207],v27 offset:6144
ds_read_b128 a[208:211],v27 offset:0
ds_read_b128 a[212:215],v26 offset:2048
ds_read_b128 a[216:219],v27 offset:4096
ds_read_b128 a[220:223],v26 offset:6144
s_waitcnt lgkmcnt(6)
ds_read_b64_tr_b16 v[32:33],v176 offset:24576
ds_read_b64_tr_b16 v[34:35],v176 offset:24832
ds_read_b64_tr_b16 v[36:37],v177 offset:24576
ds_read_b64_tr_b16 v[38:39],v177 offset:24832
ds_read_b64_tr_b16 v[40:41],v176 offset:26624
ds_read_b64_tr_b16 v[42:43],v176 offset:26880
ds_read_b64_tr_b16 v[44:45],v177 offset:26624
ds_read_b64_tr_b16 v[46:47],v177 offset:26880
s_waitcnt lgkmcnt(8)
s_add_u32 s36,s46,1024
s_add_u32 m0,s39,0
s_nop 0
buffer_load_dwordx4 v24,s[8:11],s36 offen lds
s_add_u32 m0,s39,1024
s_add_u32 s36,s36,s45
buffer_load_dwordx4 v25,s[8:11],s36 offen lds
s_add_u32 m0,s39,2048
s_add_u32 s36,s36,s45
buffer_load_dwordx4 v25,s[8:11],s36 offen lds
s_add_u32 m0,s39,3072
s_add_u32 s36,s36,s45
buffer_load_dwordx4 v24,s[8:11],s36 offen lds
s_add_u32 m0,s39,4096
s_add_u32 s36,s36,s45
buffer_load_dwordx4 v24,s[8:11],s36 offen lds
s_add_u32 m0,s39,5120
s_add_u32 s36,s36,s45
buffer_load_dwordx4 v25,s[8:11],s36 offen lds
s_add_u32 m0,s39,6144
s_add_u32 s36,s36,s45
buffer_load_dwordx4 v25,s[8:11],s36 offen lds
s_add_u32 m0,s39,7168
s_add_u32 s36,s36,s45
buffer_load_dwordx4 v24,s[8:11],s36 offen lds
s_waitcnt lgkmcnt(0)
v_mfma_f32_16x16x32_bf16 v[64:67],v[32:35],a[192:195],v[64:67]
s_nop 0
v_mfma_f32_16x16x32_bf16 v[72:75],v[32:35],a[196:199],v[72:75]
v_mfma_f32_16x16x32_bf16 v[80:83],v[32:35],a[200:203],v[80:83]
v_mfma_f32_16x16x32_bf16 v[88:91],v[32:35],a[204:207],v[88:91]
v_mfma_f32_16x16x32_bf16 v[68:71],v[36:39],a[192:195],v[68:71]
v_mfma_f32_16x16x32_bf16 v[76:79],v[36:39],a[196:199],v[76:79]
v_mfma_f32_16x16x32_bf16 v[84:87],v[36:39],a[200:203],v[84:87]
v_mfma_f32_16x16x32_bf16 v[92:95],v[36:39],a[204:207],v[92:95]
v_mfma_f32_16x16x32_bf16 v[64:67],v[40:43],a[208:211],v[64:67]
v_mfma_f32_16x16x32_bf16 v[72:75],v[40:43],a[212:215],v[72:75]
v_mfma_f32_16x16x32_bf16 v[80:83],v[40:43],a[216:219],v[80:83]
v_mfma_f32_16x16x32_bf16 v[88:91],v[40:43],a[220:223],v[88:91]
v_mfma_f32_16x16x32_bf16 v[68:71],v[44:47],a[208:211],v[68:71]
v_mfma_f32_16x16x32_bf16 v[76:79],v[44:47],a[212:215],v[76:79]
v_mfma_f32_16x16x32_bf16 v[84:87],v[44:47],a[216:219],v[84:87]
v_mfma_f32_16x16x32_bf16 v[92:95],v[44:47],a[220:223],v[92:95]
s_waitcnt vmcnt(17)
ds_read_b128 a[224:227],v26 offset:8192
ds_read_b128 a[228:231],v27 offset:10240
ds_read_b128 a[232:235],v26 offset:12288
ds_read_b128 a[236:239],v27 offset:14336
ds_read_b128 a[240:243],v27 offset:8192
ds_read_b128 a[244:247],v26 offset:10240
ds_read_b128 a[248:251],v27 offset:12288
ds_read_b128 a[252:255],v26 offset:14336
s_waitcnt lgkmcnt(6)
ds_read_b64_tr_b16 v[32:33],v176 offset:28672
ds_read_b64_tr_b16 v[34:35],v176 offset:28928
ds_read_b64_tr_b16 v[36:37],v177 offset:28672
ds_read_b64_tr_b16 v[38:39],v177 offset:28928
ds_read_b64_tr_b16 v[40:41],v176 offset:30720
ds_read_b64_tr_b16 v[42:43],v176 offset:30976
ds_read_b64_tr_b16 v[44:45],v177 offset:30720
ds_read_b64_tr_b16 v[46:47],v177 offset:30976
s_waitcnt lgkmcnt(8)
s_waitcnt lgkmcnt(0)
v_mfma_f32_16x16x32_bf16 v[64:67],v[32:35],a[224:227],v[64:67]
v_mfma_f32_16x16x32_bf16 v[72:75],v[32:35],a[228:231],v[72:75]
v_mfma_f32_16x16x32_bf16 v[80:83],v[32:35],a[232:235],v[80:83]
v_mfma_f32_16x16x32_bf16 v[88:91],v[32:35],a[236:239],v[88:91]
v_mfma_f32_16x16x32_bf16 v[68:71],v[36:39],a[224:227],v[68:71]
v_mfma_f32_16x16x32_bf16 v[76:79],v[36:39],a[228:231],v[76:79]
v_mfma_f32_16x16x32_bf16 v[84:87],v[36:39],a[232:235],v[84:87]
v_mfma_f32_16x16x32_bf16 v[92:95],v[36:39],a[236:239],v[92:95]
v_mfma_f32_16x16x32_bf16 v[64:67],v[40:43],a[240:243],v[64:67]
v_mfma_f32_16x16x32_bf16 v[72:75],v[40:43],a[244:247],v[72:75]
v_mfma_f32_16x16x32_bf16 v[80:83],v[40:43],a[248:251],v[80:83]
v_mfma_f32_16x16x32_bf16 v[88:91],v[40:43],a[252:255],v[88:91]
v_mfma_f32_16x16x32_bf16 v[68:71],v[44:47],a[240:243],v[68:71]
v_mfma_f32_16x16x32_bf16 v[76:79],v[44:47],a[244:247],v[76:79]
v_mfma_f32_16x16x32_bf16 v[84:87],v[44:47],a[248:251],v[84:87]
v_mfma_f32_16x16x32_bf16 v[92:95],v[44:47],a[252:255],v[92:95]
s_waitcnt vmcnt(0)
ds_read_b128 v[144:147],v26 offset:0
ds_read_b128 v[148:151],v27 offset:2048
ds_read_b128 v[152:155],v26 offset:4096
ds_read_b128 v[156:159],v27 offset:6144
ds_read_b128 v[160:163],v27 offset:0
ds_read_b128 v[164:167],v26 offset:2048
ds_read_b128 v[168:171],v27 offset:4096
ds_read_b128 v[172:175],v26 offset:6144
s_waitcnt lgkmcnt(6)
ds_read_b64_tr_b16 v[32:33],v176 offset:32768
ds_read_b64_tr_b16 v[34:35],v176 offset:33024
ds_read_b64_tr_b16 v[36:37],v177 offset:32768
ds_read_b64_tr_b16 v[38:39],v177 offset:33024
ds_read_b64_tr_b16 v[40:41],v176 offset:34816
ds_read_b64_tr_b16 v[42:43],v176 offset:35072
ds_read_b64_tr_b16 v[44:45],v177 offset:34816
ds_read_b64_tr_b16 v[46:47],v177 offset:35072
s_waitcnt lgkmcnt(8)
s_waitcnt lgkmcnt(0)
v_mfma_f32_16x16x32_bf16 v[64:67],v[32:35],v[144:147],v[64:67]
v_mfma_f32_16x16x32_bf16 v[72:75],v[32:35],v[148:151],v[72:75]
v_mfma_f32_16x16x32_bf16 v[80:83],v[32:35],v[152:155],v[80:83]
v_mfma_f32_16x16x32_bf16 v[88:91],v[32:35],v[156:159],v[88:91]
v_mfma_f32_16x16x32_bf16 v[68:71],v[36:39],v[144:147],v[68:71]
v_mfma_f32_16x16x32_bf16 v[76:79],v[36:39],v[148:151],v[76:79]
v_mfma_f32_16x16x32_bf16 v[84:87],v[36:39],v[152:155],v[84:87]
v_mfma_f32_16x16x32_bf16 v[92:95],v[36:39],v[156:159],v[92:95]
v_mfma_f32_16x16x32_bf16 v[64:67],v[40:43],v[160:163],v[64:67]
v_mfma_f32_16x16x32_bf16 v[72:75],v[40:43],v[164:167],v[72:75]
v_mfma_f32_16x16x32_bf16 v[80:83],v[40:43],v[168:171],v[80:83]
v_mfma_f32_16x16x32_bf16 v[88:91],v[40:43],v[172:175],v[88:91]
v_mfma_f32_16x16x32_bf16 v[68:71],v[44:47],v[160:163],v[68:71]
v_mfma_f32_16x16x32_bf16 v[76:79],v[44:47],v[164:167],v[76:79]
v_mfma_f32_16x16x32_bf16 v[84:87],v[44:47],v[168:171],v[84:87]
v_mfma_f32_16x16x32_bf16 v[92:95],v[44:47],v[172:175],v[92:95]
s_barrier
ds_read_b64_tr_b16 v[48:49],v178 offset:0
ds_read_b64_tr_b16 v[50:51],v178 offset:256
ds_read_b64_tr_b16 v[52:53],v179 offset:0
ds_read_b64_tr_b16 v[54:55],v179 offset:256
ds_read_b64_tr_b16 v[56:57],v178 offset:2048
ds_read_b64_tr_b16 v[58:59],v178 offset:2304
ds_read_b64_tr_b16 v[60:61],v179 offset:2048
ds_read_b64_tr_b16 v[62:63],v179 offset:2304
s_add_u32 s42,s47,s78
s_and_b32 s42,s42,s80
s_or_b32 s42,s42,s79
s_mul_i32 s42,s42,s31
s_add_u32 s42,s42,s30
s_cmp_lt_u32 s47,s28
s_cselect_b32 s14,s44,0
s_add_u32 s47,s47,1
s_add_u32 m0,s41,0
s_nop 0
buffer_load_dwordx4 v16,s[12:15],s42 offen lds
s_add_u32 m0,s41,1024
s_add_u32 s42,s42,s29
buffer_load_dwordx4 v16,s[12:15],s42 offen lds
s_add_u32 m0,s41,2048
s_add_u32 s42,s42,s29
buffer_load_dwordx4 v16,s[12:15],s42 offen lds
s_add_u32 m0,s41,3072
s_add_u32 s42,s42,s29
buffer_load_dwordx4 v16,s[12:15],s42 offen lds
s_add_u32 m0,s41,4096
s_add_u32 s42,s42,s29
buffer_load_dwordx4 v16,s[12:15],s42 offen lds
s_add_u32 m0,s41,5120
s_add_u32 s42,s42,s29
buffer_load_dwordx4 v16,s[12:15],s42 offen lds
s_add_u32 m0,s41,6144
s_add_u32 s42,s42,s29
buffer_load_dwordx4 v16,s[12:15],s42 offen lds
s_add_u32 m0,s41,7168
s_add_u32 s42,s42,s29
buffer_load_dwordx4 v16,s[12:15],s42 offen lds
s_add_u32 m0,s41,8192
s_add_u32 s42,s42,s29
buffer_load_dwordx4 v16,s[12:15],s42 offen lds
s_add_u32 s41,s41,36864
s_sub_u32 s36,s41,147456
s_cmp_ge_u32 s41,147456
s_cselect_b32 s41,s36,s41
s_lshl_b32 s37,s78,6
s_add_u32 s37,s37,256
s_and_b32 s37,s37,s92
s_add_u32 s93,s51,s37
buffer_load_dwordx4 v[180:183],v30,s[84:87],s93 offen
s_add_u32 s93,s93,s94
buffer_load_dwordx4 v[184:187],v30,s[84:87],s93 offen
s_add_u32 s93,s93,s94
buffer_load_dwordx4 v[188:191],v30,s[84:87],s93 offen
s_add_u32 s93,s93,s94
buffer_load_dwordx4 v[192:195],v30,s[84:87],s93 offen
s_add_u32 s93,s93,s94
buffer_load_dwordx4 v[196:199],v30,s[84:87],s93 offen
s_add_u32 s93,s93,s94
s_mov_b32 s88,s12
s_mov_b32 s89,s13
s_mov_b32 s90,0
s_mov_b32 s91,0x20000
buffer_load_dword v204,v30,s[88:91],0 offen
buffer_load_dword v204,v30,s[88:91],0 offen
s_add_u32 s27,s27,1
k1_T576_l1:
s_waitcnt lgkmcnt(4)
v_mfma_f32_16x16x32_bf16 v[96:99],v[48:51],a[0:3],0
ds_read_b64_tr_b16 v[32:33],v178 offset:4096
s_add_u32 s42,s47,s78
v_mfma_f32_16x16x32_bf16 v[104:107],v[48:51],a[4:7],0
ds_read_b64_tr_b16 v[34:35],v178 offset:4352
s_and_b32 s42,s42,s80
v_mfma_f32_16x16x32_bf16 v[112:115],v[48:51],a[8:11],0
ds_read_b64_tr_b16 v[36:37],v179 offset:4096
s_or_b32 s42,s42,s79
v_mfma_f32_16x16x32_bf16 v[120:123],v[48:51],a[12:15],0
ds_read_b64_tr_b16 v[38:39],v179 offset:4352
s_mul_i32 s42,s42,s31
v_mfma_f32_16x16x32_bf16 v[100:103],v[52:55],a[0:3],0
s_add_u32 s42,s42,s30
s_cmp_lt_u32 s47,s28
s_cselect_b32 s14,s44,0
v_mfma_f32_16x16x32_bf16 v[108:111],v[52:55],a[4:7],0
s_add_u32 s47,s47,1
s_add_u32 m0,s41,0
v_mfma_f32_16x16x32_bf16 v[116:119],v[52:55],a[8:11],0
v_mfma_f32_16x16x32_bf16 v[124:127],v[52:55],a[12:15],0
s_waitcnt lgkmcnt(4)
s_nop 0
v_mfma_f32_16x16x32_bf16 v[96:99],v[56:59],a[16:19],v[96:99]
ds_read_b64_tr_b16 v[40:41],v178 offset:6144
s_sub_u32 s37,s27,1
v_mfma_f32_16x16x32_bf16 v[104:107],v[56:59],a[20:23],v[104:107]
ds_read_b64_tr_b16 v[42:43],v178 offset:6400
s_add_u32 s37,s37,s78
v_mfma_f32_16x16x32_bf16 v[112:115],v[56:59],a[24:27],v[112:115]
ds_read_b64_tr_b16 v[44:45],v179 offset:6144
s_and_b32 s37,s37,s80
v_mfma_f32_16x16x32_bf16 v[120:123],v[56:59],a[28:31],v[120:123]
ds_read_b64_tr_b16 v[46:47],v179 offset:6400
s_or_b32 s37,s37,s79
v_mfma_f32_16x16x32_bf16 v[100:103],v[60:63],a[16:19],v[100:103]
buffer_load_dwordx4 v16,s[12:15],s42 offen lds
v_mfma_f32_16x16x32_bf16 v[108:111],v[60:63],a[20:23],v[108:111]
s_add_u32 m0,s41,1024
s_add_u32 s42,s42,s29
v_mfma_f32_16x16x32_bf16 v[116:119],v[60:63],a[24:27],v[116:119]
s_lshr_b32 s38,s37,2
s_mul_i32 s38,s38,s33
v_mfma_f32_16x16x32_bf16 v[124:127],v[60:63],a[28:31],v[124:127]
s_and_b32 s37,s37,3
s_waitcnt lgkmcnt(4)
v_mfma_f32_16x16x32_bf16 v[96:99],v[32:35],a[32:35],v[96:99]
ds_read_b64_tr_b16 v[48:49],v178 offset:8192
s_mul_i32 s37,s37,s34
v_mfma_f32_16x16x32_bf16 v[104:107],v[32:35],a[36:39],v[104:107]
ds_read_b64_tr_b16 v[50:51],v178 offset:8448
s_add_u32 s43,s37,s38
v_mfma_f32_16x16x32_bf16 v[112:115],v[32:35],a[40:43],v[112:115]
ds_read_b64_tr_b16 v[52:53],v179 offset:8192
s_add_u32 s43,s43,s32
v_mfma_f32_16x16x32_bf16 v[120:123],v[32:35],a[44:47],v[120:123]
ds_read_b64_tr_b16 v[54:55],v179 offset:8448
v_mul_f32_e64 v64,s35,v64
v_mfma_f32_16x16x32_bf16 v[100:103],v[36:39],a[32:35],v[100:103]
buffer_load_dwordx4 v16,s[12:15],s42 offen lds
v_mfma_f32_16x16x32_bf16 v[108:111],v[36:39],a[36:39],v[108:111]
s_add_u32 m0,s41,2048
s_add_u32 s42,s42,s29
v_mfma_f32_16x16x32_bf16 v[116:119],v[36:39],a[40:43],v[116:119]
v_mul_f32 v65,s35,v65
v_mul_f32_e64 v66,s35,v66
v_mfma_f32_16x16x32_bf16 v[124:127],v[36:39],a[44:47],v[124:127]
v_mul_f32 v67,s35,v67
s_waitcnt lgkmcnt(4)
v_mfma_f32_16x16x32_bf16 v[96:99],v[40:43],a[48:51],v[96:99]
ds_read_b64_tr_b16 v[56:57],v178 offset:10240
v_cvt_pk_bf16_f32 v128,v64,v65
v_mfma_f32_16x16x32_bf16 v[104:107],v[40:43],a[52:55],v[104:107]
ds_read_b64_tr_b16 v[58:59],v178 offset:10496
v_cvt_pk_bf16_f32 v129,v66,v67
v_mfma_f32_16x16x32_bf16 v[112:115],v[40:43],a[56:59],v[112:115]
ds_read_b64_tr_b16 v[60:61],v179 offset:10240
v_mul_f32_e64 v68,s35,v68
v_mfma_f32_16x16x32_bf16 v[120:123],v[40:43],a[60:63],v[120:123]
ds_read_b64_tr_b16 v[62:63],v179 offset:10496
v_mul_f32_e64 v69,s35,v69
v_mfma_f32_16x16x32_bf16 v[100:103],v[44:47],a[48:51],v[100:103]
buffer_load_dwordx4 v16,s[12:15],s42 offen lds
v_mfma_f32_16x16x32_bf16 v[108:111],v[44:47],a[52:55],v[108:111]
s_add_u32 m0,s41,3072
s_add_u32 s42,s42,s29
v_mfma_f32_16x16x32_bf16 v[116:119],v[44:47],a[56:59],v[116:119]
v_mul_f32 v70,s35,v70
v_mul_f32_e64 v71,s35,v71
v_mfma_f32_16x16x32_bf16 v[124:127],v[44:47],a[60:63],v[124:127]
v_cvt_pk_bf16_f32 v130,v68,v69
s_waitcnt lgkmcnt(4)
v_mfma_f32_16x16x32_bf16 v[96:99],v[48:51],a[64:67],v[96:99]
ds_read_b64_tr_b16 v[32:33],v178 offset:12288
v_cvt_pk_bf16_f32 v131,v70,v71
v_mfma_f32_16x16x32_bf16 v[104:107],v[48:51],a[68:71],v[104:107]
ds_read_b64_tr_b16 v[34:35],v178 offset:12544
v_mul_f32 v72,s35,v72
v_mfma_f32_16x16x32_bf16 v[112:115],v[48:51],a[72:75],v[112:115]
ds_read_b64_tr_b16 v[36:37],v179 offset:12288
v_mul_f32_e64 v73,s35,v73
v_mfma_f32_16x16x32_bf16 v[120:123],v[48:51],a[76:79],v[120:123]
ds_read_b64_tr_b16 v[38:39],v179 offset:12544
v_mul_f32_e64 v74,s35,v74
v_mfma_f32_16x16x32_bf16 v[100:103],v[52:55],a[64:67],v[100:103]
buffer_load_dwordx4 v16,s[12:15],s42 offen lds
v_mfma_f32_16x16x32_bf16 v[108:111],v[52:55],a[68:71],v[108:111]
s_add_u32 m0,s41,4096
s_add_u32 s42,s42,s29
v_mfma_f32_16x16x32_bf16 v[116:119],v[52:55],a[72:75],v[116:119]
v_mul_f32 v75,s35,v75
v_cvt_pk_bf16_f32 v132,v72,v73
v_mfma_f32_16x16x32_bf16 v[124:127],v[52:55],a[76:79],v[124:127]
v_cvt_pk_bf16_f32 v133,v74,v75
s_waitcnt lgkmcnt(4)
v_mfma_f32_16x16x32_bf16 v[96:99],v[56:59],a[80:83],v[96:99]
ds_read_b64_tr_b16 v[40:41],v178 offset:14336
v_mul_f32 v76,s35,v76
v_mfma_f32_16x16x32_bf16 v[104:107],v[56:59],a[84:87],v[104:107]
ds_read_b64_tr_b16 v[42:43],v178 offset:14592
v_mul_f32_e64 v77,s35,v77
v_mfma_f32_16x16x32_bf16 v[112:115],v[56:59],a[88:91],v[112:115]
ds_read_b64_tr_b16 v[44:45],v179 offset:14336
v_mul_f32_e64 v78,s35,v78
v_mfma_f32_16x16x32_bf16 v[120:123],v[56:59],a[92:95],v[120:123]
ds_read_b64_tr_b16 v[46:47],v179 offset:14592
v_mul_f32_e64 v79,s35,v79
v_mfma_f32_16x16x32_bf16 v[100:103],v[60:63],a[80:83],v[100:103]
buffer_load_dwordx4 v16,s[12:15],s42 offen lds
v_mfma_f32_16x16x32_bf16 v[108:111],v[60:63],a[84:87],v[108:111]
s_add_u32 m0,s41,5120
s_add_u32 s42,s42,s29
v_mfma_f32_16x16x32_bf16 v[116:119],v[60:63],a[88:91],v[116:119]
v_cvt_pk_bf16_f32 v134,v76,v77
v_cvt_pk_bf16_f32 v135,v78,v79
v_mfma_f32_16x16x32_bf16 v[124:127],v[60:63],a[92:95],v[124:127]
v_permlane16_swap_b32 v128,v130
s_waitcnt lgkmcnt(4)
v_mfma_f32_16x16x32_bf16 v[96:99],v[32:35],a[96:99],v[96:99]
ds_read_b64_tr_b16 v[48:49],v178 offset:16384
v_permlane16_swap_b32 v129,v131
v_mfma_f32_16x16x32_bf16 v[104:107],v[32:35],a[100:103],v[104:107]
ds_read_b64_tr_b16 v[50:51],v178 offset:16640
v_mul_f32_e64 v80,s35,v80
v_mfma_f32_16x16x32_bf16 v[112:115],v[32:35],a[104:107],v[112:115]
ds_read_b64_tr_b16 v[52:53],v179 offset:16384
v_mul_f32_e64 v81,s35,v81
v_mfma_f32_16x16x32_bf16 v[120:123],v[32:35],a[108:111],v[120:123]
ds_read_b64_tr_b16 v[54:55],v179 offset:16640
v_mul_f32_e64 v82,s35,v82
v_mfma_f32_16x16x32_bf16 v[100:103],v[36:39],a[96:99],v[100:103]
buffer_load_dwordx4 v16,s[12:15],s42 offen lds
v_mfma_f32_16x16x32_bf16 v[108:111],v[36:39],a[100:103],v[108:111]
s_add_u32 m0,s41,6144
s_add_u32 s42,s42,s29
v_mfma_f32_16x16x32_bf16 v[116:119],v[36:39],a[104:107],v[116:119]
v_mul_f32 v83,s35,v83
v_cvt_pk_bf16_f32 v136,v80,v81
v_mfma_f32_16x16x32_bf16 v[124:127],v[36:39],a[108:111],v[124:127]
v_cvt_pk_bf16_f32 v137,v82,v83
s_waitcnt lgkmcnt(4)
v_mfma_f32_16x16x32_bf16 v[96:99],v[40:43],a[112:115],v[96:99]
ds_read_b64_tr_b16 v[56:57],v178 offset:18432
v_mul_f32 v84,s35,v84
v_mfma_f32_16x16x32_bf16 v[104:107],v[40:43],a[116:119],v[104:107]
ds_read_b64_tr_b16 v[58:59],v178 offset:18688
v_mul_f32_e64 v85,s35,v85
v_mfma_f32_16x16x32_bf16 v[112:115],v[40:43],a[120:123],v[112:115]
ds_read_b64_tr_b16 v[60:61],v179 offset:18432
v_mul_f32_e64 v86,s35,v86
v_mfma_f32_16x16x32_bf16 v[120:123],v[40:43],a[124:127],v[120:123]
ds_read_b64_tr_b16 v[62:63],v179 offset:18688
v_mul_f32_e64 v87,s35,v87
v_mfma_f32_16x16x32_bf16 v[100:103],v[44:47],a[112:115],v[100:103]
buffer_load_dwordx4 v16,s[12:15],s42 offen lds
v_mfma_f32_16x16x32_bf16 v[108:111],v[44:47],a[116:119],v[108:111]
s_add_u32 m0,s41,7168
s_add_u32 s42,s42,s29
v_mfma_f32_16x16x32_bf16 v[116:119],v[44:47],a[120:123],v[116:119]
v_cvt_pk_bf16_f32 v138,v84,v85
v_cvt_pk_bf16_f32 v139,v86,v87
v_mfma_f32_16x16x32_bf16 v[124:127],v[44:47],a[124:127],v[124:127]
v_permlane16_swap_b32 v132,v134
s_waitcnt lgkmcnt(4)
v_mfma_f32_16x16x32_bf16 v[96:99],v[48:51],a[128:131],v[96:99]
ds_read_b64_tr_b16 v[32:33],v178 offset:20480
v_permlane16_swap_b32 v133,v135
v_mfma_f32_16x16x32_bf16 v[104:107],v[48:51],a[132:135],v[104:107]
ds_read_b64_tr_b16 v[34:35],v178 offset:20736
v_mul_f32_e64 v88,s35,v88
v_mfma_f32_16x16x32_bf16 v[112:115],v[48:51],a[136:139],v[112:115]
ds_read_b64_tr_b16 v[36:37],v179 offset:20480
v_mul_f32_e64 v89,s35,v89
v_mfma_f32_16x16x32_bf16 v[120:123],v[48:51],a[140:143],v[120:123]
ds_read_b64_tr_b16 v[38:39],v179 offset:20736
v_mul_f32_e64 v90,s35,v90
v_mfma_f32_16x16x32_bf16 v[100:103],v[52:55],a[128:131],v[100:103]
buffer_load_dwordx4 v16,s[12:15],s42 offen lds
v_mfma_f32_16x16x32_bf16 v[108:111],v[52:55],a[132:135],v[108:111]
s_add_u32 m0,s41,8192
s_add_u32 s42,s42,s29
v_mfma_f32_16x16x32_bf16 v[116:119],v[52:55],a[136:139],v[116:119]
v_mul_f32 v91,s35,v91
v_cvt_pk_bf16_f32 v140,v88,v89
v_mfma_f32_16x16x32_bf16 v[124:127],v[52:55],a[140:143],v[124:127]
v_cvt_pk_bf16_f32 v141,v90,v91
s_waitcnt lgkmcnt(4)
v_mfma_f32_16x16x32_bf16 v[96:99],v[56:59],a[144:147],v[96:99]
ds_read_b64_tr_b16 v[40:41],v178 offset:22528
v_mul_f32 v92,s35,v92
v_mfma_f32_16x16x32_bf16 v[104:107],v[56:59],a[148:151],v[104:107]
ds_read_b64_tr_b16 v[42:43],v178 offset:22784
v_mul_f32_e64 v93,s35,v93
v_mfma_f32_16x16x32_bf16 v[112:115],v[56:59],a[152:155],v[112:115]
ds_read_b64_tr_b16 v[44:45],v179 offset:22528
v_mul_f32_e64 v94,s35,v94
v_mfma_f32_16x16x32_bf16 v[120:123],v[56:59],a[156:159],v[120:123]
ds_read_b64_tr_b16 v[46:47],v179 offset:22784
v_mul_f32_e64 v95,s35,v95
v_mfma_f32_16x16x32_bf16 v[100:103],v[60:63],a[144:147],v[100:103]
buffer_load_dwordx4 v16,s[12:15],s42 offen lds
v_mfma_f32_16x16x32_bf16 v[108:111],v[60:63],a[148:151],v[108:111]
s_add_u32 s41,s41,36864
s_sub_u32 s36,s41,147456
v_mfma_f32_16x16x32_bf16 v[116:119],v[60:63],a[152:155],v[116:119]
s_cmp_ge_u32 s41,147456
s_cselect_b32 s41,s36,s41
v_mfma_f32_16x16x32_bf16 v[124:127],v[60:63],a[156:159],v[124:127]
s_add_u32 s83,s83,256
s_waitcnt lgkmcnt(4)
v_mfma_f32_16x16x32_bf16 v[96:99],v[32:35],a[160:163],v[96:99]
ds_read_b64_tr_b16 v[48:49],v178 offset:24576
s_and_b32 s83,s83,s92
v_mfma_f32_16x16x32_bf16 v[104:107],v[32:35],a[164:167],v[104:107]
ds_read_b64_tr_b16 v[50:51],v178 offset:24832
s_sub_u32 s82,s82,1
v_mfma_f32_16x16x32_bf16 v[112:115],v[32:35],a[168:171],v[112:115]
ds_read_b64_tr_b16 v[52:53],v179 offset:24576
s_cmp_ge_i32 s82,0
s_cselect_b32 s86,s44,0
v_mfma_f32_16x16x32_bf16 v[120:123],v[32:35],a[172:175],v[120:123]
ds_read_b64_tr_b16 v[54:55],v179 offset:24832
s_add_u32 s93,s51,s83
v_mfma_f32_16x16x32_bf16 v[100:103],v[36:39],a[160:163],v[100:103]
buffer_load_dwordx4 v[180:183],v30,s[84:87],s93 offen
v_mfma_f32_16x16x32_bf16 v[108:111],v[36:39],a[164:167],v[108:111]
s_add_u32 s93,s93,s94
v_cvt_pk_bf16_f32 v142,v92,v93
v_mfma_f32_16x16x32_bf16 v[116:119],v[36:39],a[168:171],v[116:119]
v_cvt_pk_bf16_f32 v143,v94,v95
v_permlane16_swap_b32 v136,v138
v_mfma_f32_16x16x32_bf16 v[124:127],v[36:39],a[172:175],v[124:127]
v_permlane16_swap_b32 v137,v139
s_waitcnt lgkmcnt(4)
v_mfma_f32_16x16x32_bf16 v[96:99],v[40:43],a[176:179],v[96:99]
ds_read_b64_tr_b16 v[56:57],v178 offset:26624
s_nop 1
v_mfma_f32_16x16x32_bf16 v[104:107],v[40:43],a[180:183],v[104:107]
ds_read_b64_tr_b16 v[58:59],v178 offset:26880
v_permlane16_swap_b32 v140,v142
v_mfma_f32_16x16x32_bf16 v[112:115],v[40:43],a[184:187],v[112:115]
ds_read_b64_tr_b16 v[60:61],v179 offset:26624
v_permlane16_swap_b32 v141,v143
v_mfma_f32_16x16x32_bf16 v[120:123],v[40:43],a[188:191],v[120:123]
ds_read_b64_tr_b16 v[62:63],v179 offset:26880
v_mfma_f32_16x16x32_bf16 v[100:103],v[44:47],a[176:179],v[100:103]
buffer_load_dwordx4 v[184:187],v30,s[84:87],s93 offen
v_mfma_f32_16x16x32_bf16 v[108:111],v[44:47],a[180:183],v[108:111]
s_add_u32 s93,s93,s94
s_nop 0
v_mfma_f32_16x16x32_bf16 v[116:119],v[44:47],a[184:187],v[116:119]
v_mfma_f32_16x16x32_bf16 v[124:127],v[44:47],a[188:191],v[124:127]
s_waitcnt lgkmcnt(4)
s_nop 0
v_mfma_f32_16x16x32_bf16 v[96:99],v[48:51],a[192:195],v[96:99]
ds_read_b64_tr_b16 v[32:33],v178 offset:28672
v_mfma_f32_16x16x32_bf16 v[104:107],v[48:51],a[196:199],v[104:107]
ds_read_b64_tr_b16 v[34:35],v178 offset:28928
v_mfma_f32_16x16x32_bf16 v[112:115],v[48:51],a[200:203],v[112:115]
ds_read_b64_tr_b16 v[36:37],v179 offset:28672
v_mfma_f32_16x16x32_bf16 v[120:123],v[48:51],a[204:207],v[120:123]
ds_read_b64_tr_b16 v[38:39],v179 offset:28928
v_mfma_f32_16x16x32_bf16 v[100:103],v[52:55],a[192:195],v[100:103]
buffer_load_dwordx4 v[188:191],v30,s[84:87],s93 offen
v_mfma_f32_16x16x32_bf16 v[108:111],v[52:55],a[196:199],v[108:111]
v_mfma_f32_16x16x32_bf16 v[116:119],v[52:55],a[200:203],v[116:119]
v_mfma_f32_16x16x32_bf16 v[124:127],v[52:55],a[204:207],v[124:127]
s_waitcnt lgkmcnt(4)
s_nop 0
v_mfma_f32_16x16x32_bf16 v[96:99],v[56:59],a[208:211],v[96:99]
ds_read_b64_tr_b16 v[40:41],v178 offset:30720
s_add_u32 s40,s40,36864
v_mfma_f32_16x16x32_bf16 v[104:107],v[56:59],a[212:215],v[104:107]
ds_read_b64_tr_b16 v[42:43],v178 offset:30976
s_cmp_ge_u32 s40,147456
s_cselect_b32 s40,0,s40
v_mfma_f32_16x16x32_bf16 v[112:115],v[56:59],a[216:219],v[112:115]
ds_read_b64_tr_b16 v[44:45],v179 offset:30720
v_add_u32 v176,s40,v19
v_mfma_f32_16x16x32_bf16 v[120:123],v[56:59],a[220:223],v[120:123]
ds_read_b64_tr_b16 v[46:47],v179 offset:30976
v_xor_b32 v177,32,v176
v_mfma_f32_16x16x32_bf16 v[100:103],v[60:63],a[208:211],v[100:103]
buffer_store_dwordx4 v[128:131],v20,s[20:23],s43 offen sc1
v_mfma_f32_16x16x32_bf16 v[108:111],v[60:63],a[212:215],v[108:111]
s_nop 0
v_mfma_f32_16x16x32_bf16 v[116:119],v[60:63],a[216:219],v[116:119]
v_mfma_f32_16x16x32_bf16 v[124:127],v[60:63],a[220:223],v[124:127]
s_waitcnt lgkmcnt(4)
s_nop 0
v_mfma_f32_16x16x32_bf16 v[96:99],v[32:35],a[224:227],v[96:99]
ds_read_b64_tr_b16 v[48:49],v178 offset:32768
v_mfma_f32_16x16x32_bf16 v[104:107],v[32:35],a[228:231],v[104:107]
ds_read_b64_tr_b16 v[50:51],v178 offset:33024
v_mfma_f32_16x16x32_bf16 v[112:115],v[32:35],a[232:235],v[112:115]
ds_read_b64_tr_b16 v[52:53],v179 offset:32768
v_mfma_f32_16x16x32_bf16 v[120:123],v[32:35],a[236:239],v[120:123]
ds_read_b64_tr_b16 v[54:55],v179 offset:33024
v_mfma_f32_16x16x32_bf16 v[100:103],v[36:39],a[224:227],v[100:103]
buffer_store_dwordx4 v[132:135],v21,s[20:23],s43 offen sc1
v_mfma_f32_16x16x32_bf16 v[108:111],v[36:39],a[228:231],v[108:111]
v_mfma_f32_16x16x32_bf16 v[116:119],v[36:39],a[232:235],v[116:119]
v_mfma_f32_16x16x32_bf16 v[124:127],v[36:39],a[236:239],v[124:127]
s_waitcnt lgkmcnt(4)
s_nop 0
v_mfma_f32_16x16x32_bf16 v[96:99],v[40:43],a[240:243],v[96:99]
ds_read_b64_tr_b16 v[56:57],v178 offset:34816
v_mfma_f32_16x16x32_bf16 v[104:107],v[40:43],a[244:247],v[104:107]
ds_read_b64_tr_b16 v[58:59],v178 offset:35072
v_mfma_f32_16x16x32_bf16 v[112:115],v[40:43],a[248:251],v[112:115]
ds_read_b64_tr_b16 v[60:61],v179 offset:34816
v_mfma_f32_16x16x32_bf16 v[120:123],v[40:43],a[252:255],v[120:123]
ds_read_b64_tr_b16 v[62:63],v179 offset:35072
v_mfma_f32_16x16x32_bf16 v[100:103],v[44:47],a[240:243],v[100:103]
buffer_store_dwordx4 v[136:139],v22,s[20:23],s43 offen sc1
v_mfma_f32_16x16x32_bf16 v[108:111],v[44:47],a[244:247],v[108:111]
v_mfma_f32_16x16x32_bf16 v[116:119],v[44:47],a[248:251],v[116:119]
v_mfma_f32_16x16x32_bf16 v[124:127],v[44:47],a[252:255],v[124:127]
s_waitcnt lgkmcnt(4)
s_nop 0
v_mfma_f32_16x16x32_bf16 v[96:99],v[48:51],v[144:147],v[96:99]
s_waitcnt vmcnt(22)
s_barrier
ds_read_b64_tr_b16 v[32:33],v176 offset:0
v_mfma_f32_16x16x32_bf16 v[104:107],v[48:51],v[148:151],v[104:107]
ds_read_b64_tr_b16 v[34:35],v176 offset:256
v_mfma_f32_16x16x32_bf16 v[112:115],v[48:51],v[152:155],v[112:115]
ds_read_b64_tr_b16 v[36:37],v177 offset:0
v_mfma_f32_16x16x32_bf16 v[120:123],v[48:51],v[156:159],v[120:123]
ds_read_b64_tr_b16 v[38:39],v177 offset:256
v_mfma_f32_16x16x32_bf16 v[100:103],v[52:55],v[144:147],v[100:103]
buffer_store_dwordx4 v[140:143],v23,s[20:23],s43 offen sc1
v_mfma_f32_16x16x32_bf16 v[108:111],v[52:55],v[148:151],v[108:111]
v_mfma_f32_16x16x32_bf16 v[116:119],v[52:55],v[152:155],v[116:119]
v_mfma_f32_16x16x32_bf16 v[124:127],v[52:55],v[156:159],v[124:127]
s_waitcnt lgkmcnt(4)
s_nop 0
v_mfma_f32_16x16x32_bf16 v[96:99],v[56:59],v[160:163],v[96:99]
ds_read_b64_tr_b16 v[40:41],v176 offset:2048
v_mfma_f32_16x16x32_bf16 v[104:107],v[56:59],v[164:167],v[104:107]
ds_read_b64_tr_b16 v[42:43],v176 offset:2304
v_mfma_f32_16x16x32_bf16 v[112:115],v[56:59],v[168:171],v[112:115]
ds_read_b64_tr_b16 v[44:45],v177 offset:2048
v_mfma_f32_16x16x32_bf16 v[120:123],v[56:59],v[172:175],v[120:123]
ds_read_b64_tr_b16 v[46:47],v177 offset:2304
v_mfma_f32_16x16x32_bf16 v[100:103],v[60:63],v[160:163],v[100:103]
v_mfma_f32_16x16x32_bf16 v[108:111],v[60:63],v[164:167],v[108:111]
v_mfma_f32_16x16x32_bf16 v[116:119],v[60:63],v[168:171],v[116:119]
v_mfma_f32_16x16x32_bf16 v[124:127],v[60:63],v[172:175],v[124:127]
s_add_u32 s27,s27,1
s_cmp_ge_u32 s27,s28
s_cbranch_scc1 k1_T576_t1
s_waitcnt lgkmcnt(4)
v_mfma_f32_16x16x32_bf16 v[64:67],v[32:35],a[0:3],0
ds_read_b64_tr_b16 v[48:49],v176 offset:4096
s_add_u32 s42,s47,s78
v_mfma_f32_16x16x32_bf16 v[72:75],v[32:35],a[4:7],0
ds_read_b64_tr_b16 v[50:51],v176 offset:4352
s_and_b32 s42,s42,s80
v_mfma_f32_16x16x32_bf16 v[80:83],v[32:35],a[8:11],0
ds_read_b64_tr_b16 v[52:53],v177 offset:4096
s_or_b32 s42,s42,s79
v_mfma_f32_16x16x32_bf16 v[88:91],v[32:35],a[12:15],0
ds_read_b64_tr_b16 v[54:55],v177 offset:4352
s_mul_i32 s42,s42,s31
v_mfma_f32_16x16x32_bf16 v[68:71],v[36:39],a[0:3],0
s_add_u32 s42,s42,s30
s_cmp_lt_u32 s47,s28
s_cselect_b32 s14,s44,0
v_mfma_f32_16x16x32_bf16 v[76:79],v[36:39],a[4:7],0
s_add_u32 s47,s47,1
s_add_u32 m0,s41,0
v_mfma_f32_16x16x32_bf16 v[84:87],v[36:39],a[8:11],0
s_nop 0
v_mfma_f32_16x16x32_bf16 v[92:95],v[36:39],a[12:15],0
s_waitcnt lgkmcnt(4)
s_nop 0
v_mfma_f32_16x16x32_bf16 v[64:67],v[40:43],a[16:19],v[64:67]
ds_read_b64_tr_b16 v[56:57],v176 offset:6144
s_sub_u32 s37,s27,1
v_mfma_f32_16x16x32_bf16 v[72:75],v[40:43],a[20:23],v[72:75]
ds_read_b64_tr_b16 v[58:59],v176 offset:6400
s_add_u32 s37,s37,s78
v_mfma_f32_16x16x32_bf16 v[80:83],v[40:43],a[24:27],v[80:83]
ds_read_b64_tr_b16 v[60:61],v177 offset:6144
s_and_b32 s37,s37,s80
v_mfma_f32_16x16x32_bf16 v[88:91],v[40:43],a[28:31],v[88:91]
ds_read_b64_tr_b16 v[62:63],v177 offset:6400
s_or_b32 s37,s37,s79
v_mfma_f32_16x16x32_bf16 v[68:71],v[44:47],a[16:19],v[68:71]
buffer_load_dwordx4 v16,s[12:15],s42 offen lds
v_mfma_f32_16x16x32_bf16 v[76:79],v[44:47],a[20:23],v[76:79]
s_add_u32 m0,s41,1024
s_add_u32 s42,s42,s29
v_mfma_f32_16x16x32_bf16 v[84:87],v[44:47],a[24:27],v[84:87]
s_lshr_b32 s38,s37,2
s_mul_i32 s38,s38,s33
v_mfma_f32_16x16x32_bf16 v[92:95],v[44:47],a[28:31],v[92:95]
s_and_b32 s37,s37,3
s_waitcnt lgkmcnt(4)
v_mfma_f32_16x16x32_bf16 v[64:67],v[48:51],a[32:35],v[64:67]
ds_read_b64_tr_b16 v[32:33],v176 offset:8192
s_mul_i32 s37,s37,s34
v_mfma_f32_16x16x32_bf16 v[72:75],v[48:51],a[36:39],v[72:75]
ds_read_b64_tr_b16 v[34:35],v176 offset:8448
s_add_u32 s43,s37,s38
v_mfma_f32_16x16x32_bf16 v[80:83],v[48:51],a[40:43],v[80:83]
ds_read_b64_tr_b16 v[36:37],v177 offset:8192
s_add_u32 s43,s43,s32
v_mfma_f32_16x16x32_bf16 v[88:91],v[48:51],a[44:47],v[88:91]
ds_read_b64_tr_b16 v[38:39],v177 offset:8448
v_mul_f32_e64 v96,s35,v96
v_mfma_f32_16x16x32_bf16 v[68:71],v[52:55],a[32:35],v[68:71]
buffer_load_dwordx4 v16,s[12:15],s42 offen lds
v_mfma_f32_16x16x32_bf16 v[76:79],v[52:55],a[36:39],v[76:79]
s_add_u32 m0,s41,2048
s_add_u32 s42,s42,s29
v_mfma_f32_16x16x32_bf16 v[84:87],v[52:55],a[40:43],v[84:87]
v_mul_f32 v97,s35,v97
v_mul_f32_e64 v98,s35,v98
v_mfma_f32_16x16x32_bf16 v[92:95],v[52:55],a[44:47],v[92:95]
v_mul_f32 v99,s35,v99
s_waitcnt lgkmcnt(4)
v_mfma_f32_16x16x32_bf16 v[64:67],v[56:59],a[48:51],v[64:67]
ds_read_b64_tr_b16 v[40:41],v176 offset:10240
v_cvt_pk_bf16_f32 v128,v96,v97
v_mfma_f32_16x16x32_bf16 v[72:75],v[56:59],a[52:55],v[72:75]
ds_read_b64_tr_b16 v[42:43],v176 offset:10496
v_cvt_pk_bf16_f32 v129,v98,v99
v_mfma_f32_16x16x32_bf16 v[80:83],v[56:59],a[56:59],v[80:83]
ds_read_b64_tr_b16 v[44:45],v177 offset:10240
v_mul_f32_e64 v100,s35,v100
v_mfma_f32_16x16x32_bf16 v[88:91],v[56:59],a[60:63],v[88:91]
ds_read_b64_tr_b16 v[46:47],v177 offset:10496
v_mul_f32_e64 v101,s35,v101
v_mfma_f32_16x16x32_bf16 v[68:71],v[60:63],a[48:51],v[68:71]
buffer_load_dwordx4 v16,s[12:15],s42 offen lds
v_mfma_f32_16x16x32_bf16 v[76:79],v[60:63],a[52:55],v[76:79]
s_add_u32 m0,s41,3072
s_add_u32 s42,s42,s29
v_mfma_f32_16x16x32_bf16 v[84:87],v[60:63],a[56:59],v[84:87]
v_mul_f32 v102,s35,v102
v_mul_f32_e64 v103,s35,v103
v_mfma_f32_16x16x32_bf16 v[92:95],v[60:63],a[60:63],v[92:95]
v_cvt_pk_bf16_f32 v130,v100,v101
s_waitcnt lgkmcnt(4)
v_mfma_f32_16x16x32_bf16 v[64:67],v[32:35],a[64:67],v[64:67]
ds_read_b64_tr_b16 v[48:49],v176 offset:12288
v_cvt_pk_bf16_f32 v131,v102,v103
v_mfma_f32_16x16x32_bf16 v[72:75],v[32:35],a[68:71],v[72:75]
ds_read_b64_tr_b16 v[50:51],v176 offset:12544
v_mul_f32 v104,s35,v104
v_mfma_f32_16x16x32_bf16 v[80:83],v[32:35],a[72:75],v[80:83]
ds_read_b64_tr_b16 v[52:53],v177 offset:12288
v_mul_f32_e64 v105,s35,v105
v_mfma_f32_16x16x32_bf16 v[88:91],v[32:35],a[76:79],v[88:91]
ds_read_b64_tr_b16 v[54:55],v177 offset:12544
v_mul_f32_e64 v106,s35,v106
v_mfma_f32_16x16x32_bf16 v[68:71],v[36:39],a[64:67],v[68:71]
buffer_load_dwordx4 v16,s[12:15],s42 offen lds
v_mfma_f32_16x16x32_bf16 v[76:79],v[36:39],a[68:71],v[76:79]
s_add_u32 m0,s41,4096
s_add_u32 s42,s42,s29
v_mfma_f32_16x16x32_bf16 v[84:87],v[36:39],a[72:75],v[84:87]
v_mul_f32 v107,s35,v107
v_cvt_pk_bf16_f32 v132,v104,v105
v_mfma_f32_16x16x32_bf16 v[92:95],v[36:39],a[76:79],v[92:95]
v_cvt_pk_bf16_f32 v133,v106,v107
s_waitcnt lgkmcnt(4)
v_mfma_f32_16x16x32_bf16 v[64:67],v[40:43],a[80:83],v[64:67]
ds_read_b64_tr_b16 v[56:57],v176 offset:14336
v_mul_f32 v108,s35,v108
v_mfma_f32_16x16x32_bf16 v[72:75],v[40:43],a[84:87],v[72:75]
ds_read_b64_tr_b16 v[58:59],v176 offset:14592
v_mul_f32_e64 v109,s35,v109
v_mfma_f32_16x16x32_bf16 v[80:83],v[40:43],a[88:91],v[80:83]
ds_read_b64_tr_b16 v[60:61],v177 offset:14336
v_mul_f32_e64 v110,s35,v110
v_mfma_f32_16x16x32_bf16 v[88:91],v[40:43],a[92:95],v[88:91]
ds_read_b64_tr_b16 v[62:63],v177 offset:14592
v_mul_f32_e64 v111,s35,v111
v_mfma_f32_16x16x32_bf16 v[68:71],v[44:47],a[80:83],v[68:71]
buffer_load_dwordx4 v16,s[12:15],s42 offen lds
v_mfma_f32_16x16x32_bf16 v[76:79],v[44:47],a[84:87],v[76:79]
s_add_u32 m0,s41,5120
s_add_u32 s42,s42,s29
v_mfma_f32_16x16x32_bf16 v[84:87],v[44:47],a[88:91],v[84:87]
v_cvt_pk_bf16_f32 v134,v108,v109
v_cvt_pk_bf16_f32 v135,v110,v111
v_mfma_f32_16x16x32_bf16 v[92:95],v[44:47],a[92:95],v[92:95]
v_permlane16_swap_b32 v128,v130
s_waitcnt lgkmcnt(4)
v_mfma_f32_16x16x32_bf16 v[64:67],v[48:51],a[96:99],v[64:67]
ds_read_b64_tr_b16 v[32:33],v176 offset:16384
v_permlane16_swap_b32 v129,v131
v_mfma_f32_16x16x32_bf16 v[72:75],v[48:51],a[100:103],v[72:75]
ds_read_b64_tr_b16 v[34:35],v176 offset:16640
v_mul_f32_e64 v112,s35,v112
v_mfma_f32_16x16x32_bf16 v[80:83],v[48:51],a[104:107],v[80:83]
ds_read_b64_tr_b16 v[36:37],v177 offset:16384
v_mul_f32_e64 v113,s35,v113
v_mfma_f32_16x16x32_bf16 v[88:91],v[48:51],a[108:111],v[88:91]
ds_read_b64_tr_b16 v[38:39],v177 offset:16640
v_mul_f32_e64 v114,s35,v114
v_mfma_f32_16x16x32_bf16 v[68:71],v[52:55],a[96:99],v[68:71]
buffer_load_dwordx4 v16,s[12:15],s42 offen lds
v_mfma_f32_16x16x32_bf16 v[76:79],v[52:55],a[100:103],v[76:79]
s_add_u32 m0,s41,6144
s_add_u32 s42,s42,s29
v_mfma_f32_16x16x32_bf16 v[84:87],v[52:55],a[104:107],v[84:87]
v_mul_f32 v115,s35,v115
v_cvt_pk_bf16_f32 v136,v112,v113
v_mfma_f32_16x16x32_bf16 v[92:95],v[52:55],a[108:111],v[92:95]
v_cvt_pk_bf16_f32 v137,v114,v115
s_waitcnt lgkmcnt(4)
v_mfma_f32_16x16x32_bf16 v[64:67],v[56:59],a[112:115],v[64:67]
ds_read_b64_tr_b16 v[40:41],v176 offset:18432
v_mul_f32 v116,s35,v116
v_mfma_f32_16x16x32_bf16 v[72:75],v[56:59],a[116:119],v[72:75]
ds_read_b64_tr_b16 v[42:43],v176 offset:18688
v_mul_f32_e64 v117,s35,v117
v_mfma_f32_16x16x32_bf16 v[80:83],v[56:59],a[120:123],v[80:83]
ds_read_b64_tr_b16 v[44:45],v177 offset:18432
v_mul_f32_e64 v118,s35,v118
v_mfma_f32_16x16x32_bf16 v[88:91],v[56:59],a[124:127],v[88:91]
ds_read_b64_tr_b16 v[46:47],v177 offset:18688
v_mul_f32_e64 v119,s35,v119
v_mfma_f32_16x16x32_bf16 v[68:71],v[60:63],a[112:115],v[68:71]
buffer_load_dwordx4 v16,s[12:15],s42 offen lds
v_mfma_f32_16x16x32_bf16 v[76:79],v[60:63],a[116:119],v[76:79]
s_add_u32 m0,s41,7168
s_add_u32 s42,s42,s29
v_mfma_f32_16x16x32_bf16 v[84:87],v[60:63],a[120:123],v[84:87]
v_cvt_pk_bf16_f32 v138,v116,v117
v_cvt_pk_bf16_f32 v139,v118,v119
v_mfma_f32_16x16x32_bf16 v[92:95],v[60:63],a[124:127],v[92:95]
v_permlane16_swap_b32 v132,v134
s_waitcnt lgkmcnt(4)
v_mfma_f32_16x16x32_bf16 v[64:67],v[32:35],a[128:131],v[64:67]
ds_read_b64_tr_b16 v[48:49],v176 offset:20480
v_permlane16_swap_b32 v133,v135
v_mfma_f32_16x16x32_bf16 v[72:75],v[32:35],a[132:135],v[72:75]
ds_read_b64_tr_b16 v[50:51],v176 offset:20736
v_mul_f32_e64 v120,s35,v120
v_mfma_f32_16x16x32_bf16 v[80:83],v[32:35],a[136:139],v[80:83]
ds_read_b64_tr_b16 v[52:53],v177 offset:20480
v_mul_f32_e64 v121,s35,v121
v_mfma_f32_16x16x32_bf16 v[88:91],v[32:35],a[140:143],v[88:91]
ds_read_b64_tr_b16 v[54:55],v177 offset:20736
v_mul_f32_e64 v122,s35,v122
v_mfma_f32_16x16x32_bf16 v[68:71],v[36:39],a[128:131],v[68:71]
buffer_load_dwordx4 v16,s[12:15],s42 offen lds
v_mfma_f32_16x16x32_bf16 v[76:79],v[36:39],a[132:135],v[76:79]
s_add_u32 m0,s41,8192
s_add_u32 s42,s42,s29
v_mfma_f32_16x16x32_bf16 v[84:87],v[36:39],a[136:139],v[84:87]
v_mul_f32 v123,s35,v123
v_cvt_pk_bf16_f32 v140,v120,v121
v_mfma_f32_16x16x32_bf16 v[92:95],v[36:39],a[140:143],v[92:95]
v_cvt_pk_bf16_f32 v141,v122,v123
s_waitcnt lgkmcnt(4)
v_mfma_f32_16x16x32_bf16 v[64:67],v[40:43],a[144:147],v[64:67]
ds_read_b64_tr_b16 v[56:57],v176 offset:22528
v_mul_f32 v124,s35,v124
v_mfma_f32_16x16x32_bf16 v[72:75],v[40:43],a[148:151],v[72:75]
ds_read_b64_tr_b16 v[58:59],v176 offset:22784
v_mul_f32_e64 v125,s35,v125
v_mfma_f32_16x16x32_bf16 v[80:83],v[40:43],a[152:155],v[80:83]
ds_read_b64_tr_b16 v[60:61],v177 offset:22528
v_mul_f32_e64 v126,s35,v126
v_mfma_f32_16x16x32_bf16 v[88:91],v[40:43],a[156:159],v[88:91]
ds_read_b64_tr_b16 v[62:63],v177 offset:22784
v_mul_f32_e64 v127,s35,v127
v_mfma_f32_16x16x32_bf16 v[68:71],v[44:47],a[144:147],v[68:71]
buffer_load_dwordx4 v16,s[12:15],s42 offen lds
v_mfma_f32_16x16x32_bf16 v[76:79],v[44:47],a[148:151],v[76:79]
s_add_u32 s41,s41,36864
s_sub_u32 s36,s41,147456
v_mfma_f32_16x16x32_bf16 v[84:87],v[44:47],a[152:155],v[84:87]
s_cmp_ge_u32 s41,147456
s_cselect_b32 s41,s36,s41
v_mfma_f32_16x16x32_bf16 v[92:95],v[44:47],a[156:159],v[92:95]
s_add_u32 s93,s93,s81
s_waitcnt lgkmcnt(4)
v_mfma_f32_16x16x32_bf16 v[64:67],v[48:51],a[160:163],v[64:67]
ds_read_b64_tr_b16 v[32:33],v176 offset:24576
v_cvt_pk_bf16_f32 v142,v124,v125
v_mfma_f32_16x16x32_bf16 v[72:75],v[48:51],a[164:167],v[72:75]
ds_read_b64_tr_b16 v[34:35],v176 offset:24832
v_cvt_pk_bf16_f32 v143,v126,v127
v_mfma_f32_16x16x32_bf16 v[80:83],v[48:51],a[168:171],v[80:83]
ds_read_b64_tr_b16 v[36:37],v177 offset:24576
v_permlane16_swap_b32 v136,v138
v_mfma_f32_16x16x32_bf16 v[88:91],v[48:51],a[172:175],v[88:91]
ds_read_b64_tr_b16 v[38:39],v177 offset:24832
v_permlane16_swap_b32 v137,v139
v_mfma_f32_16x16x32_bf16 v[68:71],v[52:55],a[160:163],v[68:71]
buffer_load_dwordx4 v[180:183],v30,s[84:87],s93 offen
v_mfma_f32_16x16x32_bf16 v[76:79],v[52:55],a[164:167],v[76:79]
s_add_u32 s93,s93,s94
s_nop 1
v_mfma_f32_16x16x32_bf16 v[84:87],v[52:55],a[168:171],v[84:87]
v_permlane16_swap_b32 v140,v142
v_permlane16_swap_b32 v141,v143
v_mfma_f32_16x16x32_bf16 v[92:95],v[52:55],a[172:175],v[92:95]
s_waitcnt lgkmcnt(4)
v_mfma_f32_16x16x32_bf16 v[64:67],v[56:59],a[176:179],v[64:67]
ds_read_b64_tr_b16 v[40:41],v176 offset:26624
v_mfma_f32_16x16x32_bf16 v[72:75],v[56:59],a[180:183],v[72:75]
ds_read_b64_tr_b16 v[42:43],v176 offset:26880
v_mfma_f32_16x16x32_bf16 v[80:83],v[56:59],a[184:187],v[80:83]
ds_read_b64_tr_b16 v[44:45],v177 offset:26624
v_mfma_f32_16x16x32_bf16 v[88:91],v[56:59],a[188:191],v[88:91]
ds_read_b64_tr_b16 v[46:47],v177 offset:26880
v_mfma_f32_16x16x32_bf16 v[68:71],v[60:63],a[176:179],v[68:71]
buffer_load_dwordx4 v[184:187],v30,s[84:87],s93 offen
v_mfma_f32_16x16x32_bf16 v[76:79],v[60:63],a[180:183],v[76:79]
s_add_u32 s93,s93,s94
s_nop 0
v_mfma_f32_16x16x32_bf16 v[84:87],v[60:63],a[184:187],v[84:87]
v_mfma_f32_16x16x32_bf16 v[92:95],v[60:63],a[188:191],v[92:95]
s_waitcnt lgkmcnt(4)
s_nop 0
v_mfma_f32_16x16x32_bf16 v[64:67],v[32:35],a[192:195],v[64:67]
ds_read_b64_tr_b16 v[48:49],v176 offset:28672
v_mfma_f32_16x16x32_bf16 v[72:75],v[32:35],a[196:199],v[72:75]
ds_read_b64_tr_b16 v[50:51],v176 offset:28928
v_mfma_f32_16x16x32_bf16 v[80:83],v[32:35],a[200:203],v[80:83]
ds_read_b64_tr_b16 v[52:53],v177 offset:28672
v_mfma_f32_16x16x32_bf16 v[88:91],v[32:35],a[204:207],v[88:91]
ds_read_b64_tr_b16 v[54:55],v177 offset:28928
v_mfma_f32_16x16x32_bf16 v[68:71],v[36:39],a[192:195],v[68:71]
buffer_load_dwordx4 v[188:191],v30,s[84:87],s93 offen
v_mfma_f32_16x16x32_bf16 v[76:79],v[36:39],a[196:199],v[76:79]
v_mfma_f32_16x16x32_bf16 v[84:87],v[36:39],a[200:203],v[84:87]
v_mfma_f32_16x16x32_bf16 v[92:95],v[36:39],a[204:207],v[92:95]
s_waitcnt lgkmcnt(4)
s_nop 0
v_mfma_f32_16x16x32_bf16 v[64:67],v[40:43],a[208:211],v[64:67]
ds_read_b64_tr_b16 v[56:57],v176 offset:30720
s_add_u32 s40,s40,36864
v_mfma_f32_16x16x32_bf16 v[72:75],v[40:43],a[212:215],v[72:75]
ds_read_b64_tr_b16 v[58:59],v176 offset:30976
s_cmp_ge_u32 s40,147456
s_cselect_b32 s40,0,s40
v_mfma_f32_16x16x32_bf16 v[80:83],v[40:43],a[216:219],v[80:83]
ds_read_b64_tr_b16 v[60:61],v177 offset:30720
v_add_u32 v178,s40,v19
v_mfma_f32_16x16x32_bf16 v[88:91],v[40:43],a[220:223],v[88:91]
ds_read_b64_tr_b16 v[62:63],v177 offset:30976
v_xor_b32 v179,32,v178
v_mfma_f32_16x16x32_bf16 v[68:71],v[44:47],a[208:211],v[68:71]
buffer_store_dwordx4 v[128:131],v20,s[20:23],s43 offen sc1
v_mfma_f32_16x16x32_bf16 v[76:79],v[44:47],a[212:215],v[76:79]
s_nop 0
v_mfma_f32_16x16x32_bf16 v[84:87],v[44:47],a[216:219],v[84:87]
v_mfma_f32_16x16x32_bf16 v[92:95],v[44:47],a[220:223],v[92:95]
s_waitcnt lgkmcnt(4)
s_nop 0
v_mfma_f32_16x16x32_bf16 v[64:67],v[48:51],a[224:227],v[64:67]
ds_read_b64_tr_b16 v[32:33],v176 offset:32768
v_mfma_f32_16x16x32_bf16 v[72:75],v[48:51],a[228:231],v[72:75]
ds_read_b64_tr_b16 v[34:35],v176 offset:33024
v_mfma_f32_16x16x32_bf16 v[80:83],v[48:51],a[232:235],v[80:83]
ds_read_b64_tr_b16 v[36:37],v177 offset:32768
v_mfma_f32_16x16x32_bf16 v[88:91],v[48:51],a[236:239],v[88:91]
ds_read_b64_tr_b16 v[38:39],v177 offset:33024
v_mfma_f32_16x16x32_bf16 v[68:71],v[52:55],a[224:227],v[68:71]
buffer_store_dwordx4 v[132:135],v21,s[20:23],s43 offen sc1
v_mfma_f32_16x16x32_bf16 v[76:79],v[52:55],a[228:231],v[76:79]
v_mfma_f32_16x16x32_bf16 v[84:87],v[52:55],a[232:235],v[84:87]
v_mfma_f32_16x16x32_bf16 v[92:95],v[52:55],a[236:239],v[92:95]
s_waitcnt lgkmcnt(4)
s_nop 0
v_mfma_f32_16x16x32_bf16 v[64:67],v[56:59],a[240:243],v[64:67]
ds_read_b64_tr_b16 v[40:41],v176 offset:34816
v_mfma_f32_16x16x32_bf16 v[72:75],v[56:59],a[244:247],v[72:75]
ds_read_b64_tr_b16 v[42:43],v176 offset:35072
v_mfma_f32_16x16x32_bf16 v[80:83],v[56:59],a[248:251],v[80:83]
ds_read_b64_tr_b16 v[44:45],v177 offset:34816
v_mfma_f32_16x16x32_bf16 v[88:91],v[56:59],a[252:255],v[88:91]
ds_read_b64_tr_b16 v[46:47],v177 offset:35072
v_mfma_f32_16x16x32_bf16 v[68:71],v[60:63],a[240:243],v[68:71]
buffer_store_dwordx4 v[136:139],v22,s[20:23],s43 offen sc1
v_mfma_f32_16x16x32_bf16 v[76:79],v[60:63],a[244:247],v[76:79]
v_mfma_f32_16x16x32_bf16 v[84:87],v[60:63],a[248:251],v[84:87]
v_mfma_f32_16x16x32_bf16 v[92:95],v[60:63],a[252:255],v[92:95]
s_waitcnt lgkmcnt(4)
s_nop 0
v_mfma_f32_16x16x32_bf16 v[64:67],v[32:35],v[144:147],v[64:67]
s_waitcnt vmcnt(22)
s_barrier
ds_read_b64_tr_b16 v[48:49],v178 offset:0
v_mfma_f32_16x16x32_bf16 v[72:75],v[32:35],v[148:151],v[72:75]
ds_read_b64_tr_b16 v[50:51],v178 offset:256
v_mfma_f32_16x16x32_bf16 v[80:83],v[32:35],v[152:155],v[80:83]
ds_read_b64_tr_b16 v[52:53],v179 offset:0
v_mfma_f32_16x16x32_bf16 v[88:91],v[32:35],v[156:159],v[88:91]
ds_read_b64_tr_b16 v[54:55],v179 offset:256
v_mfma_f32_16x16x32_bf16 v[68:71],v[36:39],v[144:147],v[68:71]
buffer_store_dwordx4 v[140:143],v23,s[20:23],s43 offen sc1
v_mfma_f32_16x16x32_bf16 v[76:79],v[36:39],v[148:151],v[76:79]
v_mfma_f32_16x16x32_bf16 v[84:87],v[36:39],v[152:155],v[84:87]
v_mfma_f32_16x16x32_bf16 v[92:95],v[36:39],v[156:159],v[92:95]
s_waitcnt lgkmcnt(4)
s_nop 0
v_mfma_f32_16x16x32_bf16 v[64:67],v[40:43],v[160:163],v[64:67]
ds_read_b64_tr_b16 v[56:57],v178 offset:2048
v_mfma_f32_16x16x32_bf16 v[72:75],v[40:43],v[164:167],v[72:75]
ds_read_b64_tr_b16 v[58:59],v178 offset:2304
v_mfma_f32_16x16x32_bf16 v[80:83],v[40:43],v[168:171],v[80:83]
ds_read_b64_tr_b16 v[60:61],v179 offset:2048
v_mfma_f32_16x16x32_bf16 v[88:91],v[40:43],v[172:175],v[88:91]
ds_read_b64_tr_b16 v[62:63],v179 offset:2304
v_mfma_f32_16x16x32_bf16 v[68:71],v[44:47],v[160:163],v[68:71]
v_mfma_f32_16x16x32_bf16 v[76:79],v[44:47],v[164:167],v[76:79]
v_mfma_f32_16x16x32_bf16 v[84:87],v[44:47],v[168:171],v[84:87]
v_mfma_f32_16x16x32_bf16 v[92:95],v[44:47],v[172:175],v[92:95]
s_add_u32 s27,s27,1
s_cmp_lt_u32 s27,s28
s_cbranch_scc1 k1_T576_l1
s_waitcnt lgkmcnt(0)
s_nop 7
s_sub_u32 s37,s27,1
s_add_u32 s37,s37,s78
s_and_b32 s37,s37,s80
s_or_b32 s37,s37,s79
s_lshr_b32 s38,s37,2
s_mul_i32 s38,s38,s33
s_and_b32 s37,s37,3
s_mul_i32 s37,s37,s34
s_add_u32 s43,s37,s38
s_add_u32 s43,s43,s32
v_mul_f32 v64,s35,v64
v_mul_f32 v65,s35,v65
v_mul_f32 v66,s35,v66
v_mul_f32_e64 v67,s35,v67
v_cvt_pk_bf16_f32 v128,v64,v65
v_cvt_pk_bf16_f32 v129,v66,v67
v_mul_f32 v68,s35,v68
v_mul_f32 v69,s35,v69
v_mul_f32 v70,s35,v70
v_mul_f32 v71,s35,v71
v_cvt_pk_bf16_f32 v130,v68,v69
v_cvt_pk_bf16_f32 v131,v70,v71
v_mul_f32 v72,s35,v72
v_mul_f32 v73,s35,v73
v_mul_f32 v74,s35,v74
v_mul_f32 v75,s35,v75
v_cvt_pk_bf16_f32 v132,v72,v73
v_cvt_pk_bf16_f32 v133,v74,v75
v_mul_f32 v76,s35,v76
v_mul_f32 v77,s35,v77
v_mul_f32 v78,s35,v78
v_mul_f32 v79,s35,v79
v_cvt_pk_bf16_f32 v134,v76,v77
v_cvt_pk_bf16_f32 v135,v78,v79
v_permlane16_swap_b32 v128,v130
v_permlane16_swap_b32 v129,v131
v_mul_f32 v80,s35,v80
v_mul_f32 v81,s35,v81
v_mul_f32 v82,s35,v82
v_mul_f32 v83,s35,v83
v_cvt_pk_bf16_f32 v136,v80,v81
v_cvt_pk_bf16_f32 v137,v82,v83
v_mul_f32 v84,s35,v84
v_mul_f32 v85,s35,v85
v_mul_f32 v86,s35,v86
v_mul_f32 v87,s35,v87
v_cvt_pk_bf16_f32 v138,v84,v85
v_cvt_pk_bf16_f32 v139,v86,v87
v_permlane16_swap_b32 v132,v134
v_permlane16_swap_b32 v133,v135
v_mul_f32 v88,s35,v88
v_mul_f32 v89,s35,v89
v_mul_f32 v90,s35,v90
v_mul_f32 v91,s35,v91
v_cvt_pk_bf16_f32 v140,v88,v89
v_cvt_pk_bf16_f32 v141,v90,v91
v_mul_f32 v92,s35,v92
v_mul_f32 v93,s35,v93
v_mul_f32 v94,s35,v94
v_mul_f32 v95,s35,v95
v_cvt_pk_bf16_f32 v142,v92,v93
v_cvt_pk_bf16_f32 v143,v94,v95
v_permlane16_swap_b32 v136,v138
v_permlane16_swap_b32 v137,v139
s_nop 1
v_permlane16_swap_b32 v140,v142
v_permlane16_swap_b32 v141,v143
buffer_store_dwordx4 v[128:131],v20,s[20:23],s43 offen sc1
buffer_store_dwordx4 v[132:135],v21,s[20:23],s43 offen sc1
buffer_store_dwordx4 v[136:139],v22,s[20:23],s43 offen sc1
buffer_store_dwordx4 v[140:143],v23,s[20:23],s43 offen sc1
s_branch k1_end
k1_T576_t1:
s_waitcnt lgkmcnt(0)
s_nop 7
s_sub_u32 s37,s27,1
s_add_u32 s37,s37,s78
s_and_b32 s37,s37,s80
s_or_b32 s37,s37,s79
s_lshr_b32 s38,s37,2
s_mul_i32 s38,s38,s33
s_and_b32 s37,s37,3
s_mul_i32 s37,s37,s34
s_add_u32 s43,s37,s38
s_add_u32 s43,s43,s32
v_mul_f32 v96,s35,v96
v_mul_f32 v97,s35,v97
v_mul_f32 v98,s35,v98
v_mul_f32 v99,s35,v99
v_cvt_pk_bf16_f32 v128,v96,v97
v_cvt_pk_bf16_f32 v129,v98,v99
v_mul_f32 v100,s35,v100
v_mul_f32 v101,s35,v101
v_mul_f32 v102,s35,v102
v_mul_f32 v103,s35,v103
v_cvt_pk_bf16_f32 v130,v100,v101
v_cvt_pk_bf16_f32 v131,v102,v103
v_mul_f32 v104,s35,v104
v_mul_f32 v105,s35,v105
v_mul_f32 v106,s35,v106
v_mul_f32 v107,s35,v107
v_cvt_pk_bf16_f32 v132,v104,v105
v_cvt_pk_bf16_f32 v133,v106,v107
v_mul_f32 v108,s35,v108
v_mul_f32 v109,s35,v109
v_mul_f32 v110,s35,v110
v_mul_f32 v111,s35,v111
v_cvt_pk_bf16_f32 v134,v108,v109
v_cvt_pk_bf16_f32 v135,v110,v111
v_permlane16_swap_b32 v128,v130
v_permlane16_swap_b32 v129,v131
v_mul_f32 v112,s35,v112
v_mul_f32 v113,s35,v113
v_mul_f32 v114,s35,v114
v_mul_f32 v115,s35,v115
v_cvt_pk_bf16_f32 v136,v112,v113
v_cvt_pk_bf16_f32 v137,v114,v115
v_mul_f32 v116,s35,v116
v_mul_f32 v117,s35,v117
v_mul_f32 v118,s35,v118
v_mul_f32 v119,s35,v119
v_cvt_pk_bf16_f32 v138,v116,v117
v_cvt_pk_bf16_f32 v139,v118,v119
v_permlane16_swap_b32 v132,v134
v_permlane16_swap_b32 v133,v135
v_mul_f32 v120,s35,v120
v_mul_f32 v121,s35,v121
v_mul_f32 v122,s35,v122
v_mul_f32 v123,s35,v123
v_cvt_pk_bf16_f32 v140,v120,v121
v_cvt_pk_bf16_f32 v141,v122,v123
v_mul_f32 v124,s35,v124
v_mul_f32 v125,s35,v125
v_mul_f32 v126,s35,v126
v_mul_f32 v127,s35,v127
v_cvt_pk_bf16_f32 v142,v124,v125
v_cvt_pk_bf16_f32 v143,v126,v127
v_permlane16_swap_b32 v136,v138
v_permlane16_swap_b32 v137,v139
s_nop 1
v_permlane16_swap_b32 v140,v142
v_permlane16_swap_b32 v141,v143
buffer_store_dwordx4 v[128:131],v20,s[20:23],s43 offen sc1
buffer_store_dwordx4 v[132:135],v21,s[20:23],s43 offen sc1
buffer_store_dwordx4 v[136:139],v22,s[20:23],s43 offen sc1
buffer_store_dwordx4 v[140:143],v23,s[20:23],s43 offen sc1
s_branch k1_end
k1_typeA:
s_mov_b32 s45,9216
s_mul_i32 s46,s49,36864
s_mov_b32 s29,55296
s_mul_i32 s30,s24,497664
s_mul_i32 s41,s24,9216
v_mul_u32_u24 v16,3456,v7
v_add_u32 v16,v16,v6
v_lshrrev_b32 v8,3,v1
v_mul_u32_u24 v8,1152,v8
v_and_b32 v9,7,v1
v_lshrrev_b32 v2,4,v1
v_xor_b32 v9,v9,v2
v_lshl_add_u32 v24,v9,4,v8
v_xor_b32 v9,4,v9
v_lshl_add_u32 v25,v9,4,v8
s_sub_u32 s48,s26,26
s_mov_b32 s44,1990656
s_cmp_ge_u32 s48,4
s_cbranch_scc1 k1_typeAV
s_mul_i32 s27,s48,9
s_add_u32 s28,s27,9
s_mov_b32 s47,s27
s_mov_b32 s96,1051597459
s_lshl_b32 s32,s49,12
s_add_u32 s32,s32,96468992
s_add_u32 s43,s32,4096
v_and_b32 v2,15,v1
v_lshlrev_b32 v17,4,v2
v_lshlrev_b32 v2,3,v2
v_add_u32 v18,3072,v2
s_waitcnt lgkmcnt(0)
s_mov_b32 s12,s54
s_mov_b32 s13,s55
s_mov_b32 s14,1990656
s_mov_b32 s15,0x20000
s_mov_b32 s8,s52
s_mov_b32 s9,s53
s_mov_b32 s10,2359296
s_mov_b32 s11,0x20000
s_mov_b32 s16,s74
s_mov_b32 s17,s75
s_mov_b32 s18,268435456
s_mov_b32 s19,0x20000
s_mov_b32 s20,s74
s_mov_b32 s21,s75
s_mov_b32 s22,268435456
s_mov_b32 s23,0x20000
k1_S576:
s_mul_i32 s39,s24,16384
s_add_u32 s39,s39,73728
s_add_u32 s42,s47,s78
s_and_b32 s42,s42,s80
s_or_b32 s42,s42,s79
s_mul_i32 s42,s42,s31
s_add_u32 s42,s42,s30
s_cmp_lt_u32 s47,s28
s_cselect_b32 s14,s44,0
s_add_u32 s47,s47,1
s_add_u32 m0,s41,0
s_nop 0
buffer_load_dwordx4 v16,s[12:15],s42 offen lds
s_add_u32 m0,s41,1024
s_add_u32 s42,s42,s29
buffer_load_dwordx4 v16,s[12:15],s42 offen lds
s_add_u32 m0,s41,2048
s_add_u32 s42,s42,s29
buffer_load_dwordx4 v16,s[12:15],s42 offen lds
s_add_u32 m0,s41,3072
s_add_u32 s42,s42,s29
buffer_load_dwordx4 v16,s[12:15],s42 offen lds
s_add_u32 m0,s41,4096
s_add_u32 s42,s42,s29
buffer_load_dwordx4 v16,s[12:15],s42 offen lds
s_add_u32 m0,s41,5120
s_add_u32 s42,s42,s29
buffer_load_dwordx4 v16,s[12:15],s42 offen lds
s_add_u32 m0,s41,6144
s_add_u32 s42,s42,s29
buffer_load_dwordx4 v16,s[12:15],s42 offen lds
s_add_u32 m0,s41,7168
s_add_u32 s42,s42,s29
buffer_load_dwordx4 v16,s[12:15],s42 offen lds
s_add_u32 m0,s41,8192
s_add_u32 s42,s42,s29
buffer_load_dwordx4 v16,s[12:15],s42 offen lds
s_add_u32 s41,s41,36864
s_sub_u32 s36,s41,147456
s_cmp_ge_u32 s41,147456
s_cselect_b32 s41,s36,s41
s_lshr_b32 s37,s2,3
s_and_b32 s37,s37,7
s_lshl_b32 s37,s37,2
s_add_u32 s37,s37,s24
s_lshl_b32 s38,s25,5
s_add_u32 s37,s37,s38
s_mul_i32 s37,s37,9216
v_lshlrev_b32 v2,4,v1
buffer_load_dwordx4 v[180:183],v2,s[8:11],s37 offen offset:0
buffer_load_dwordx4 v[184:187],v2,s[8:11],s37 offen offset:1024
buffer_load_dwordx4 v[188:191],v2,s[8:11],s37 offen offset:2048
buffer_load_dwordx4 v[192:195],v2,s[8:11],s37 offen offset:3072
s_add_u32 s37,s37,4096
buffer_load_dwordx4 v[196:199],v2,s[8:11],s37 offen offset:0
buffer_load_dwordx4 v[200:203],v2,s[8:11],s37 offen offset:1024
buffer_load_dwordx4 v[204:207],v2,s[8:11],s37 offen offset:2048
buffer_load_dwordx4 v[208:211],v2,s[8:11],s37 offen offset:3072
s_add_u32 s37,s37,4096
buffer_load_dwordx4 v[212:215],v2,s[8:11],s37 offen offset:0
s_add_u32 s36,s46,0
s_add_u32 m0,s39,0
s_nop 0
buffer_load_dwordx4 v24,s[8:11],s36 offen lds
s_add_u32 m0,s39,1024
s_add_u32 s36,s36,s45
buffer_load_dwordx4 v25,s[8:11],s36 offen lds
s_add_u32 m0,s39,2048
s_add_u32 s36,s36,s45
buffer_load_dwordx4 v25,s[8:11],s36 offen lds
s_add_u32 m0,s39,3072
s_add_u32 s36,s36,s45
buffer_load_dwordx4 v24,s[8:11],s36 offen lds
s_add_u32 m0,s39,4096
s_add_u32 s36,s36,s45
buffer_load_dwordx4 v24,s[8:11],s36 offen lds
s_add_u32 m0,s39,5120
s_add_u32 s36,s36,s45
buffer_load_dwordx4 v25,s[8:11],s36 offen lds
s_add_u32 m0,s39,6144
s_add_u32 s36,s36,s45
buffer_load_dwordx4 v25,s[8:11],s36 offen lds
s_add_u32 m0,s39,7168
s_add_u32 s36,s36,s45
buffer_load_dwordx4 v24,s[8:11],s36 offen lds
s_add_u32 s36,s46,128
s_add_u32 m0,s39,8192
s_nop 0
buffer_load_dwordx4 v24,s[8:11],s36 offen lds
s_add_u32 m0,s39,9216
s_add_u32 s36,s36,s45
buffer_load_dwordx4 v25,s[8:11],s36 offen lds
s_add_u32 m0,s39,10240
s_add_u32 s36,s36,s45
buffer_load_dwordx4 v25,s[8:11],s36 offen lds
s_add_u32 m0,s39,11264
s_add_u32 s36,s36,s45
buffer_load_dwordx4 v24,s[8:11],s36 offen lds
s_add_u32 m0,s39,12288
s_add_u32 s36,s36,s45
buffer_load_dwordx4 v24,s[8:11],s36 offen lds
s_add_u32 m0,s39,13312
s_add_u32 s36,s36,s45
buffer_load_dwordx4 v25,s[8:11],s36 offen lds
s_add_u32 m0,s39,14336
s_add_u32 s36,s36,s45
buffer_load_dwordx4 v25,s[8:11],s36 offen lds
s_add_u32 m0,s39,15360
s_add_u32 s36,s36,s45
buffer_load_dwordx4 v24,s[8:11],s36 offen lds
v_add_u32 v26,s39,v26
v_xor_b32 v27,64,v26
s_lshr_b32 s81,s29,4
s_lshr_b32 s94,s29,2
s_lshr_b32 s51,s49,1
s_mul_i32 s51,s51,18
s_mul_i32 s51,s51,s81
s_mul_i32 s37,s27,s31
s_add_u32 s51,s51,s37
s_add_u32 s51,s51,s76
s_mov_b32 s84,s12
s_mov_b32 s85,s13
s_mov_b32 s86,s44
s_mov_b32 s87,0x20000
s_sub_u32 s82,s28,s27
s_mul_i32 s82,s82,s31
s_add_u32 s82,s82,-130
s_lshr_b32 s82,s82,8
s_min_u32 s82,s82,2
s_lshl_b32 s37,s78,6
s_lshl_b32 s92,s80,6
s_or_b32 s92,s92,63
s_add_u32 s83,s37,256
v_and_b32 v2,31,v1
v_lshlrev_b32 v2,4,v2
v_add_u32 v2,s37,v2
v_and_b32 v2,s92,v2
v_lshrrev_b32 v3,5,v1
v_mul_lo_u32 v3,v3,s81
v_add_u32 v31,v2,v3
v_and_b32 v2,15,v1
v_lshlrev_b32 v2,4,v2
v_lshrrev_b32 v3,4,v1
v_mul_lo_u32 v3,v3,s81
v_add_u32 v30,v2,v3
v_mov_b32_e64 v176,v19
v_xor_b32 v177,32,v19
s_mov_b32 s40,36864
v_add_u32 v178,s40,v19
v_xor_b32 v179,32,v178
s_lshl_b32 s37,s78,6
s_add_u32 s37,s37,0
s_and_b32 s37,s37,s92
s_add_u32 s93,s51,s37
buffer_load_dwordx4 v[180:183],v30,s[84:87],s93 offen
s_add_u32 s93,s93,s94
buffer_load_dwordx4 v[184:187],v30,s[84:87],s93 offen
s_add_u32 s93,s93,s94
buffer_load_dwordx4 v[188:191],v30,s[84:87],s93 offen
s_add_u32 s93,s93,s94
buffer_load_dwordx4 v[192:195],v30,s[84:87],s93 offen
s_add_u32 s93,s93,s94
buffer_load_dwordx4 v[196:199],v30,s[84:87],s93 offen
s_add_u32 s93,s93,s94
s_waitcnt vmcnt(13)
s_barrier
ds_read_b128 a[0:3],v26 offset:0
ds_read_b128 a[4:7],v27 offset:2048
ds_read_b128 a[8:11],v26 offset:4096
ds_read_b128 a[12:15],v27 offset:6144
ds_read_b128 a[16:19],v27 offset:0
ds_read_b128 a[20:23],v26 offset:2048
ds_read_b128 a[24:27],v27 offset:4096
ds_read_b128 a[28:31],v26 offset:6144
s_waitcnt lgkmcnt(6)
ds_read_b64_tr_b16 v[32:33],v176 offset:0
ds_read_b64_tr_b16 v[34:35],v176 offset:256
ds_read_b64_tr_b16 v[36:37],v177 offset:0
ds_read_b64_tr_b16 v[38:39],v177 offset:256
ds_read_b64_tr_b16 v[40:41],v176 offset:2048
ds_read_b64_tr_b16 v[42:43],v176 offset:2304
ds_read_b64_tr_b16 v[44:45],v177 offset:2048
ds_read_b64_tr_b16 v[46:47],v177 offset:2304
s_waitcnt lgkmcnt(8)
s_add_u32 s36,s46,256
s_add_u32 m0,s39,0
s_nop 0
buffer_load_dwordx4 v24,s[8:11],s36 offen lds
s_add_u32 m0,s39,1024
s_add_u32 s36,s36,s45
buffer_load_dwordx4 v25,s[8:11],s36 offen lds
s_add_u32 m0,s39,2048
s_add_u32 s36,s36,s45
buffer_load_dwordx4 v25,s[8:11],s36 offen lds
s_add_u32 m0,s39,3072
s_add_u32 s36,s36,s45
buffer_load_dwordx4 v24,s[8:11],s36 offen lds
s_add_u32 m0,s39,4096
s_add_u32 s36,s36,s45
buffer_load_dwordx4 v24,s[8:11],s36 offen lds
s_add_u32 m0,s39,5120
s_add_u32 s36,s36,s45
buffer_load_dwordx4 v25,s[8:11],s36 offen lds
s_add_u32 m0,s39,6144
s_add_u32 s36,s36,s45
buffer_load_dwordx4 v25,s[8:11],s36 offen lds
s_add_u32 m0,s39,7168
s_add_u32 s36,s36,s45
buffer_load_dwordx4 v24,s[8:11],s36 offen lds
s_waitcnt lgkmcnt(0)
v_mfma_f32_16x16x32_bf16 v[64:67],v[32:35],a[0:3],0
s_nop 0
v_mfma_f32_16x16x32_bf16 v[72:75],v[32:35],a[4:7],0
v_mfma_f32_16x16x32_bf16 v[80:83],v[32:35],a[8:11],0
v_mfma_f32_16x16x32_bf16 v[88:91],v[32:35],a[12:15],0
v_mfma_f32_16x16x32_bf16 v[68:71],v[36:39],a[0:3],0
v_mfma_f32_16x16x32_bf16 v[76:79],v[36:39],a[4:7],0
v_mfma_f32_16x16x32_bf16 v[84:87],v[36:39],a[8:11],0
v_mfma_f32_16x16x32_bf16 v[92:95],v[36:39],a[12:15],0
v_mfma_f32_16x16x32_bf16 v[64:67],v[40:43],a[16:19],v[64:67]
v_mfma_f32_16x16x32_bf16 v[72:75],v[40:43],a[20:23],v[72:75]
v_mfma_f32_16x16x32_bf16 v[80:83],v[40:43],a[24:27],v[80:83]
v_mfma_f32_16x16x32_bf16 v[88:91],v[40:43],a[28:31],v[88:91]
v_mfma_f32_16x16x32_bf16 v[68:71],v[44:47],a[16:19],v[68:71]
v_mfma_f32_16x16x32_bf16 v[76:79],v[44:47],a[20:23],v[76:79]
v_mfma_f32_16x16x32_bf16 v[84:87],v[44:47],a[24:27],v[84:87]
v_mfma_f32_16x16x32_bf16 v[92:95],v[44:47],a[28:31],v[92:95]
s_waitcnt vmcnt(13)
ds_read_b128 a[32:35],v26 offset:8192
ds_read_b128 a[36:39],v27 offset:10240
ds_read_b128 a[40:43],v26 offset:12288
ds_read_b128 a[44:47],v27 offset:14336
ds_read_b128 a[48:51],v27 offset:8192
ds_read_b128 a[52:55],v26 offset:10240
ds_read_b128 a[56:59],v27 offset:12288
ds_read_b128 a[60:63],v26 offset:14336
s_waitcnt lgkmcnt(6)
ds_read_b64_tr_b16 v[32:33],v176 offset:4096
ds_read_b64_tr_b16 v[34:35],v176 offset:4352
ds_read_b64_tr_b16 v[36:37],v177 offset:4096
ds_read_b64_tr_b16 v[38:39],v177 offset:4352
ds_read_b64_tr_b16 v[40:41],v176 offset:6144
ds_read_b64_tr_b16 v[42:43],v176 offset:6400
ds_read_b64_tr_b16 v[44:45],v177 offset:6144
ds_read_b64_tr_b16 v[46:47],v177 offset:6400
s_waitcnt lgkmcnt(8)
s_add_u32 s36,s46,384
s_add_u32 m0,s39,8192
s_nop 0
buffer_load_dwordx4 v24,s[8:11],s36 offen lds
s_add_u32 m0,s39,9216
s_add_u32 s36,s36,s45
buffer_load_dwordx4 v25,s[8:11],s36 offen lds
s_add_u32 m0,s39,10240
s_add_u32 s36,s36,s45
buffer_load_dwordx4 v25,s[8:11],s36 offen lds
s_add_u32 m0,s39,11264
s_add_u32 s36,s36,s45
buffer_load_dwordx4 v24,s[8:11],s36 offen lds
s_add_u32 m0,s39,12288
s_add_u32 s36,s36,s45
buffer_load_dwordx4 v24,s[8:11],s36 offen lds
s_add_u32 m0,s39,13312
s_add_u32 s36,s36,s45
buffer_load_dwordx4 v25,s[8:11],s36 offen lds
s_add_u32 m0,s39,14336
s_add_u32 s36,s36,s45
buffer_load_dwordx4 v25,s[8:11],s36 offen lds
s_add_u32 m0,s39,15360
s_add_u32 s36,s36,s45
buffer_load_dwordx4 v24,s[8:11],s36 offen lds
s_waitcnt lgkmcnt(0)
v_mfma_f32_16x16x32_bf16 v[64:67],v[32:35],a[32:35],v[64:67]
v_mfma_f32_16x16x32_bf16 v[72:75],v[32:35],a[36:39],v[72:75]
v_mfma_f32_16x16x32_bf16 v[80:83],v[32:35],a[40:43],v[80:83]
v_mfma_f32_16x16x32_bf16 v[88:91],v[32:35],a[44:47],v[88:91]
v_mfma_f32_16x16x32_bf16 v[68:71],v[36:39],a[32:35],v[68:71]
v_mfma_f32_16x16x32_bf16 v[76:79],v[36:39],a[36:39],v[76:79]
v_mfma_f32_16x16x32_bf16 v[84:87],v[36:39],a[40:43],v[84:87]
v_mfma_f32_16x16x32_bf16 v[92:95],v[36:39],a[44:47],v[92:95]
v_mfma_f32_16x16x32_bf16 v[64:67],v[40:43],a[48:51],v[64:67]
v_mfma_f32_16x16x32_bf16 v[72:75],v[40:43],a[52:55],v[72:75]
v_mfma_f32_16x16x32_bf16 v[80:83],v[40:43],a[56:59],v[80:83]
v_mfma_f32_16x16x32_bf16 v[88:91],v[40:43],a[60:63],v[88:91]
v_mfma_f32_16x16x32_bf16 v[68:71],v[44:47],a[48:51],v[68:71]
v_mfma_f32_16x16x32_bf16 v[76:79],v[44:47],a[52:55],v[76:79]
v_mfma_f32_16x16x32_bf16 v[84:87],v[44:47],a[56:59],v[84:87]
v_mfma_f32_16x16x32_bf16 v[92:95],v[44:47],a[60:63],v[92:95]
s_waitcnt vmcnt(8)
ds_read_b128 a[64:67],v26 offset:0
ds_read_b128 a[68:71],v27 offset:2048
ds_read_b128 a[72:75],v26 offset:4096
ds_read_b128 a[76:79],v27 offset:6144
ds_read_b128 a[80:83],v27 offset:0
ds_read_b128 a[84:87],v26 offset:2048
ds_read_b128 a[88:91],v27 offset:4096
ds_read_b128 a[92:95],v26 offset:6144
s_waitcnt lgkmcnt(6)
ds_read_b64_tr_b16 v[32:33],v176 offset:8192
ds_read_b64_tr_b16 v[34:35],v176 offset:8448
ds_read_b64_tr_b16 v[36:37],v177 offset:8192
ds_read_b64_tr_b16 v[38:39],v177 offset:8448
ds_read_b64_tr_b16 v[40:41],v176 offset:10240
ds_read_b64_tr_b16 v[42:43],v176 offset:10496
ds_read_b64_tr_b16 v[44:45],v177 offset:10240
ds_read_b64_tr_b16 v[46:47],v177 offset:10496
s_waitcnt lgkmcnt(8)
s_add_u32 s36,s46,512
s_add_u32 m0,s39,0
s_nop 0
buffer_load_dwordx4 v24,s[8:11],s36 offen lds
s_add_u32 m0,s39,1024
s_add_u32 s36,s36,s45
buffer_load_dwordx4 v25,s[8:11],s36 offen lds
s_add_u32 m0,s39,2048
s_add_u32 s36,s36,s45
buffer_load_dwordx4 v25,s[8:11],s36 offen lds
s_add_u32 m0,s39,3072
s_add_u32 s36,s36,s45
buffer_load_dwordx4 v24,s[8:11],s36 offen lds
s_add_u32 m0,s39,4096
s_add_u32 s36,s36,s45
buffer_load_dwordx4 v24,s[8:11],s36 offen lds
s_add_u32 m0,s39,5120
s_add_u32 s36,s36,s45
buffer_load_dwordx4 v25,s[8:11],s36 offen lds
s_add_u32 m0,s39,6144
s_add_u32 s36,s36,s45
buffer_load_dwordx4 v25,s[8:11],s36 offen lds
s_add_u32 m0,s39,7168
s_add_u32 s36,s36,s45
buffer_load_dwordx4 v24,s[8:11],s36 offen lds
s_waitcnt lgkmcnt(0)
v_mfma_f32_16x16x32_bf16 v[64:67],v[32:35],a[64:67],v[64:67]
s_nop 0
v_mfma_f32_16x16x32_bf16 v[72:75],v[32:35],a[68:71],v[72:75]
v_mfma_f32_16x16x32_bf16 v[80:83],v[32:35],a[72:75],v[80:83]
v_mfma_f32_16x16x32_bf16 v[88:91],v[32:35],a[76:79],v[88:91]
v_mfma_f32_16x16x32_bf16 v[68:71],v[36:39],a[64:67],v[68:71]
v_mfma_f32_16x16x32_bf16 v[76:79],v[36:39],a[68:71],v[76:79]
v_mfma_f32_16x16x32_bf16 v[84:87],v[36:39],a[72:75],v[84:87]
v_mfma_f32_16x16x32_bf16 v[92:95],v[36:39],a[76:79],v[92:95]
v_mfma_f32_16x16x32_bf16 v[64:67],v[40:43],a[80:83],v[64:67]
v_mfma_f32_16x16x32_bf16 v[72:75],v[40:43],a[84:87],v[72:75]
v_mfma_f32_16x16x32_bf16 v[80:83],v[40:43],a[88:91],v[80:83]
v_mfma_f32_16x16x32_bf16 v[88:91],v[40:43],a[92:95],v[88:91]
v_mfma_f32_16x16x32_bf16 v[68:71],v[44:47],a[80:83],v[68:71]
v_mfma_f32_16x16x32_bf16 v[76:79],v[44:47],a[84:87],v[76:79]
v_mfma_f32_16x16x32_bf16 v[84:87],v[44:47],a[88:91],v[84:87]
v_mfma_f32_16x16x32_bf16 v[92:95],v[44:47],a[92:95],v[92:95]
s_waitcnt vmcnt(8)
ds_read_b128 a[96:99],v26 offset:8192
ds_read_b128 a[100:103],v27 offset:10240
ds_read_b128 a[104:107],v26 offset:12288
ds_read_b128 a[108:111],v27 offset:14336
ds_read_b128 a[112:115],v27 offset:8192
ds_read_b128 a[116:119],v26 offset:10240
ds_read_b128 a[120:123],v27 offset:12288
ds_read_b128 a[124:127],v26 offset:14336
s_waitcnt lgkmcnt(6)
ds_read_b64_tr_b16 v[32:33],v176 offset:12288
ds_read_b64_tr_b16 v[34:35],v176 offset:12544
ds_read_b64_tr_b16 v[36:37],v177 offset:12288
ds_read_b64_tr_b16 v[38:39],v177 offset:12544
ds_read_b64_tr_b16 v[40:41],v176 offset:14336
ds_read_b64_tr_b16 v[42:43],v176 offset:14592
ds_read_b64_tr_b16 v[44:45],v177 offset:14336
ds_read_b64_tr_b16 v[46:47],v177 offset:14592
s_waitcnt lgkmcnt(8)
s_add_u32 s36,s46,640
s_add_u32 m0,s39,8192
s_nop 0
buffer_load_dwordx4 v24,s[8:11],s36 offen lds
s_add_u32 m0,s39,9216
s_add_u32 s36,s36,s45
buffer_load_dwordx4 v25,s[8:11],s36 offen lds
s_add_u32 m0,s39,10240
s_add_u32 s36,s36,s45
buffer_load_dwordx4 v25,s[8:11],s36 offen lds
s_add_u32 m0,s39,11264
s_add_u32 s36,s36,s45
buffer_load_dwordx4 v24,s[8:11],s36 offen lds
s_add_u32 m0,s39,12288
s_add_u32 s36,s36,s45
buffer_load_dwordx4 v24,s[8:11],s36 offen lds
s_add_u32 m0,s39,13312
s_add_u32 s36,s36,s45
buffer_load_dwordx4 v25,s[8:11],s36 offen lds
s_add_u32 m0,s39,14336
s_add_u32 s36,s36,s45
buffer_load_dwordx4 v25,s[8:11],s36 offen lds
s_add_u32 m0,s39,15360
s_add_u32 s36,s36,s45
buffer_load_dwordx4 v24,s[8:11],s36 offen lds
s_waitcnt lgkmcnt(0)
v_mfma_f32_16x16x32_bf16 v[64:67],v[32:35],a[96:99],v[64:67]
v_mfma_f32_16x16x32_bf16 v[72:75],v[32:35],a[100:103],v[72:75]
v_mfma_f32_16x16x32_bf16 v[80:83],v[32:35],a[104:107],v[80:83]
v_mfma_f32_16x16x32_bf16 v[88:91],v[32:35],a[108:111],v[88:91]
v_mfma_f32_16x16x32_bf16 v[68:71],v[36:39],a[96:99],v[68:71]
v_mfma_f32_16x16x32_bf16 v[76:79],v[36:39],a[100:103],v[76:79]
v_mfma_f32_16x16x32_bf16 v[84:87],v[36:39],a[104:107],v[84:87]
v_mfma_f32_16x16x32_bf16 v[92:95],v[36:39],a[108:111],v[92:95]
v_mfma_f32_16x16x32_bf16 v[64:67],v[40:43],a[112:115],v[64:67]
v_mfma_f32_16x16x32_bf16 v[72:75],v[40:43],a[116:119],v[72:75]
v_mfma_f32_16x16x32_bf16 v[80:83],v[40:43],a[120:123],v[80:83]
v_mfma_f32_16x16x32_bf16 v[88:91],v[40:43],a[124:127],v[88:91]
v_mfma_f32_16x16x32_bf16 v[68:71],v[44:47],a[112:115],v[68:71]
v_mfma_f32_16x16x32_bf16 v[76:79],v[44:47],a[116:119],v[76:79]
v_mfma_f32_16x16x32_bf16 v[84:87],v[44:47],a[120:123],v[84:87]
v_mfma_f32_16x16x32_bf16 v[92:95],v[44:47],a[124:127],v[92:95]
s_waitcnt vmcnt(8)
ds_read_b128 a[128:131],v26 offset:0
ds_read_b128 a[132:135],v27 offset:2048
ds_read_b128 a[136:139],v26 offset:4096
ds_read_b128 a[140:143],v27 offset:6144
ds_read_b128 a[144:147],v27 offset:0
ds_read_b128 a[148:151],v26 offset:2048
ds_read_b128 a[152:155],v27 offset:4096
ds_read_b128 a[156:159],v26 offset:6144
s_waitcnt lgkmcnt(6)
ds_read_b64_tr_b16 v[32:33],v176 offset:16384
ds_read_b64_tr_b16 v[34:35],v176 offset:16640
ds_read_b64_tr_b16 v[36:37],v177 offset:16384
ds_read_b64_tr_b16 v[38:39],v177 offset:16640
ds_read_b64_tr_b16 v[40:41],v176 offset:18432
ds_read_b64_tr_b16 v[42:43],v176 offset:18688
ds_read_b64_tr_b16 v[44:45],v177 offset:18432
ds_read_b64_tr_b16 v[46:47],v177 offset:18688
s_waitcnt lgkmcnt(8)
s_add_u32 s36,s46,768
s_add_u32 m0,s39,0
s_nop 0
buffer_load_dwordx4 v24,s[8:11],s36 offen lds
s_add_u32 m0,s39,1024
s_add_u32 s36,s36,s45
buffer_load_dwordx4 v25,s[8:11],s36 offen lds
s_add_u32 m0,s39,2048
s_add_u32 s36,s36,s45
buffer_load_dwordx4 v25,s[8:11],s36 offen lds
s_add_u32 m0,s39,3072
s_add_u32 s36,s36,s45
buffer_load_dwordx4 v24,s[8:11],s36 offen lds
s_add_u32 m0,s39,4096
s_add_u32 s36,s36,s45
buffer_load_dwordx4 v24,s[8:11],s36 offen lds
s_add_u32 m0,s39,5120
s_add_u32 s36,s36,s45
buffer_load_dwordx4 v25,s[8:11],s36 offen lds
s_add_u32 m0,s39,6144
s_add_u32 s36,s36,s45
buffer_load_dwordx4 v25,s[8:11],s36 offen lds
s_add_u32 m0,s39,7168
s_add_u32 s36,s36,s45
buffer_load_dwordx4 v24,s[8:11],s36 offen lds
s_waitcnt lgkmcnt(0)
v_mfma_f32_16x16x32_bf16 v[64:67],v[32:35],a[128:131],v[64:67]
s_nop 0
v_mfma_f32_16x16x32_bf16 v[72:75],v[32:35],a[132:135],v[72:75]
v_mfma_f32_16x16x32_bf16 v[80:83],v[32:35],a[136:139],v[80:83]
v_mfma_f32_16x16x32_bf16 v[88:91],v[32:35],a[140:143],v[88:91]
v_mfma_f32_16x16x32_bf16 v[68:71],v[36:39],a[128:131],v[68:71]
v_mfma_f32_16x16x32_bf16 v[76:79],v[36:39],a[132:135],v[76:79]
v_mfma_f32_16x16x32_bf16 v[84:87],v[36:39],a[136:139],v[84:87]
v_mfma_f32_16x16x32_bf16 v[92:95],v[36:39],a[140:143],v[92:95]
v_mfma_f32_16x16x32_bf16 v[64:67],v[40:43],a[144:147],v[64:67]
v_mfma_f32_16x16x32_bf16 v[72:75],v[40:43],a[148:151],v[72:75]
v_mfma_f32_16x16x32_bf16 v[80:83],v[40:43],a[152:155],v[80:83]
v_mfma_f32_16x16x32_bf16 v[88:91],v[40:43],a[156:159],v[88:91]
v_mfma_f32_16x16x32_bf16 v[68:71],v[44:47],a[144:147],v[68:71]
v_mfma_f32_16x16x32_bf16 v[76:79],v[44:47],a[148:151],v[76:79]
v_mfma_f32_16x16x32_bf16 v[84:87],v[44:47],a[152:155],v[84:87]
v_mfma_f32_16x16x32_bf16 v[92:95],v[44:47],a[156:159],v[92:95]
s_waitcnt vmcnt(8)
ds_read_b128 a[160:163],v26 offset:8192
ds_read_b128 a[164:167],v27 offset:10240
ds_read_b128 a[168:171],v26 offset:12288
ds_read_b128 a[172:175],v27 offset:14336
ds_read_b128 a[176:179],v27 offset:8192
ds_read_b128 a[180:183],v26 offset:10240
ds_read_b128 a[184:187],v27 offset:12288
ds_read_b128 a[188:191],v26 offset:14336
s_waitcnt lgkmcnt(6)
ds_read_b64_tr_b16 v[32:33],v176 offset:20480
ds_read_b64_tr_b16 v[34:35],v176 offset:20736
ds_read_b64_tr_b16 v[36:37],v177 offset:20480
ds_read_b64_tr_b16 v[38:39],v177 offset:20736
ds_read_b64_tr_b16 v[40:41],v176 offset:22528
ds_read_b64_tr_b16 v[42:43],v176 offset:22784
ds_read_b64_tr_b16 v[44:45],v177 offset:22528
ds_read_b64_tr_b16 v[46:47],v177 offset:22784
s_waitcnt lgkmcnt(8)
s_add_u32 s36,s46,896
s_add_u32 m0,s39,8192
s_nop 0
buffer_load_dwordx4 v24,s[8:11],s36 offen lds
s_add_u32 m0,s39,9216
s_add_u32 s36,s36,s45
buffer_load_dwordx4 v25,s[8:11],s36 offen lds
s_add_u32 m0,s39,10240
s_add_u32 s36,s36,s45
buffer_load_dwordx4 v25,s[8:11],s36 offen lds
s_add_u32 m0,s39,11264
s_add_u32 s36,s36,s45
buffer_load_dwordx4 v24,s[8:11],s36 offen lds
s_add_u32 m0,s39,12288
s_add_u32 s36,s36,s45
buffer_load_dwordx4 v24,s[8:11],s36 offen lds
s_add_u32 m0,s39,13312
s_add_u32 s36,s36,s45
buffer_load_dwordx4 v25,s[8:11],s36 offen lds
s_add_u32 m0,s39,14336
s_add_u32 s36,s36,s45
buffer_load_dwordx4 v25,s[8:11],s36 offen lds
s_add_u32 m0,s39,15360
s_add_u32 s36,s36,s45
buffer_load_dwordx4 v24,s[8:11],s36 offen lds
s_add_u32 s42,s47,s78
s_and_b32 s42,s42,s80
s_or_b32 s42,s42,s79
s_mul_i32 s42,s42,s31
s_add_u32 s42,s42,s30
s_cmp_lt_u32 s47,s28
s_cselect_b32 s14,s44,0
s_add_u32 s47,s47,1
s_add_u32 m0,s41,0
s_nop 0
buffer_load_dwordx4 v16,s[12:15],s42 offen lds
s_add_u32 m0,s41,1024
s_add_u32 s42,s42,s29
buffer_load_dwordx4 v16,s[12:15],s42 offen lds
s_add_u32 m0,s41,2048
s_add_u32 s42,s42,s29
buffer_load_dwordx4 v16,s[12:15],s42 offen lds
s_add_u32 m0,s41,3072
s_add_u32 s42,s42,s29
buffer_load_dwordx4 v16,s[12:15],s42 offen lds
s_add_u32 m0,s41,4096
s_add_u32 s42,s42,s29
buffer_load_dwordx4 v16,s[12:15],s42 offen lds
s_add_u32 m0,s41,5120
s_add_u32 s42,s42,s29
buffer_load_dwordx4 v16,s[12:15],s42 offen lds
s_add_u32 m0,s41,6144
s_add_u32 s42,s42,s29
buffer_load_dwordx4 v16,s[12:15],s42 offen lds
s_add_u32 m0,s41,7168
s_add_u32 s42,s42,s29
buffer_load_dwordx4 v16,s[12:15],s42 offen lds
s_add_u32 m0,s41,8192
s_add_u32 s42,s42,s29
buffer_load_dwordx4 v16,s[12:15],s42 offen lds
s_add_u32 s41,s41,36864
s_sub_u32 s36,s41,147456
s_cmp_ge_u32 s41,147456
s_cselect_b32 s41,s36,s41
s_waitcnt lgkmcnt(0)
v_mfma_f32_16x16x32_bf16 v[64:67],v[32:35],a[160:163],v[64:67]
s_nop 0
v_mfma_f32_16x16x32_bf16 v[72:75],v[32:35],a[164:167],v[72:75]
v_mfma_f32_16x16x32_bf16 v[80:83],v[32:35],a[168:171],v[80:83]
v_mfma_f32_16x16x32_bf16 v[88:91],v[32:35],a[172:175],v[88:91]
v_mfma_f32_16x16x32_bf16 v[68:71],v[36:39],a[160:163],v[68:71]
v_mfma_f32_16x16x32_bf16 v[76:79],v[36:39],a[164:167],v[76:79]
v_mfma_f32_16x16x32_bf16 v[84:87],v[36:39],a[168:171],v[84:87]
v_mfma_f32_16x16x32_bf16 v[92:95],v[36:39],a[172:175],v[92:95]
v_mfma_f32_16x16x32_bf16 v[64:67],v[40:43],a[176:179],v[64:67]
v_mfma_f32_16x16x32_bf16 v[72:75],v[40:43],a[180:183],v[72:75]
v_mfma_f32_16x16x32_bf16 v[80:83],v[40:43],a[184:187],v[80:83]
v_mfma_f32_16x16x32_bf16 v[88:91],v[40:43],a[188:191],v[88:91]
v_mfma_f32_16x16x32_bf16 v[68:71],v[44:47],a[176:179],v[68:71]
v_mfma_f32_16x16x32_bf16 v[76:79],v[44:47],a[180:183],v[76:79]
v_mfma_f32_16x16x32_bf16 v[84:87],v[44:47],a[184:187],v[84:87]
v_mfma_f32_16x16x32_bf16 v[92:95],v[44:47],a[188:191],v[92:95]
s_waitcnt vmcnt(17)
ds_read_b128 a[192:195],v26 offset:0
ds_read_b128 a[196:199],v27 offset:2048
ds_read_b128 a[200:203],v26 offset:4096
ds_read_b128 a[204:207],v27 offset:6144
ds_read_b128 a[208:211],v27 offset:0
ds_read_b128 a[212:215],v26 offset:2048
ds_read_b128 a[216:219],v27 offset:4096
ds_read_b128 a[220:223],v26 offset:6144
s_waitcnt lgkmcnt(6)
ds_read_b64_tr_b16 v[32:33],v176 offset:24576
ds_read_b64_tr_b16 v[34:35],v176 offset:24832
ds_read_b64_tr_b16 v[36:37],v177 offset:24576
ds_read_b64_tr_b16 v[38:39],v177 offset:24832
ds_read_b64_tr_b16 v[40:41],v176 offset:26624
ds_read_b64_tr_b16 v[42:43],v176 offset:26880
ds_read_b64_tr_b16 v[44:45],v177 offset:26624
ds_read_b64_tr_b16 v[46:47],v177 offset:26880
s_waitcnt lgkmcnt(8)
s_add_u32 s36,s46,1024
s_add_u32 m0,s39,0
s_nop 0
buffer_load_dwordx4 v24,s[8:11],s36 offen lds
s_add_u32 m0,s39,1024
s_add_u32 s36,s36,s45
buffer_load_dwordx4 v25,s[8:11],s36 offen lds
s_add_u32 m0,s39,2048
s_add_u32 s36,s36,s45
buffer_load_dwordx4 v25,s[8:11],s36 offen lds
s_add_u32 m0,s39,3072
s_add_u32 s36,s36,s45
buffer_load_dwordx4 v24,s[8:11],s36 offen lds
s_add_u32 m0,s39,4096
s_add_u32 s36,s36,s45
buffer_load_dwordx4 v24,s[8:11],s36 offen lds
s_add_u32 m0,s39,5120
s_add_u32 s36,s36,s45
buffer_load_dwordx4 v25,s[8:11],s36 offen lds
s_add_u32 m0,s39,6144
s_add_u32 s36,s36,s45
buffer_load_dwordx4 v25,s[8:11],s36 offen lds
s_add_u32 m0,s39,7168
s_add_u32 s36,s36,s45
buffer_load_dwordx4 v24,s[8:11],s36 offen lds
s_waitcnt lgkmcnt(0)
v_mfma_f32_16x16x32_bf16 v[64:67],v[32:35],a[192:195],v[64:67]
s_nop 0
v_mfma_f32_16x16x32_bf16 v[72:75],v[32:35],a[196:199],v[72:75]
v_mfma_f32_16x16x32_bf16 v[80:83],v[32:35],a[200:203],v[80:83]
v_mfma_f32_16x16x32_bf16 v[88:91],v[32:35],a[204:207],v[88:91]
v_mfma_f32_16x16x32_bf16 v[68:71],v[36:39],a[192:195],v[68:71]
v_mfma_f32_16x16x32_bf16 v[76:79],v[36:39],a[196:199],v[76:79]
v_mfma_f32_16x16x32_bf16 v[84:87],v[36:39],a[200:203],v[84:87]
v_mfma_f32_16x16x32_bf16 v[92:95],v[36:39],a[204:207],v[92:95]
v_mfma_f32_16x16x32_bf16 v[64:67],v[40:43],a[208:211],v[64:67]
v_mfma_f32_16x16x32_bf16 v[72:75],v[40:43],a[212:215],v[72:75]
v_mfma_f32_16x16x32_bf16 v[80:83],v[40:43],a[216:219],v[80:83]
v_mfma_f32_16x16x32_bf16 v[88:91],v[40:43],a[220:223],v[88:91]
v_mfma_f32_16x16x32_bf16 v[68:71],v[44:47],a[208:211],v[68:71]
v_mfma_f32_16x16x32_bf16 v[76:79],v[44:47],a[212:215],v[76:79]
v_mfma_f32_16x16x32_bf16 v[84:87],v[44:47],a[216:219],v[84:87]
v_mfma_f32_16x16x32_bf16 v[92:95],v[44:47],a[220:223],v[92:95]
s_waitcnt vmcnt(17)
ds_read_b128 a[224:227],v26 offset:8192
ds_read_b128 a[228:231],v27 offset:10240
ds_read_b128 a[232:235],v26 offset:12288
ds_read_b128 a[236:239],v27 offset:14336
ds_read_b128 a[240:243],v27 offset:8192
ds_read_b128 a[244:247],v26 offset:10240
ds_read_b128 a[248:251],v27 offset:12288
ds_read_b128 a[252:255],v26 offset:14336
s_waitcnt lgkmcnt(6)
ds_read_b64_tr_b16 v[32:33],v176 offset:28672
ds_read_b64_tr_b16 v[34:35],v176 offset:28928
ds_read_b64_tr_b16 v[36:37],v177 offset:28672
ds_read_b64_tr_b16 v[38:39],v177 offset:28928
ds_read_b64_tr_b16 v[40:41],v176 offset:30720
ds_read_b64_tr_b16 v[42:43],v176 offset:30976
ds_read_b64_tr_b16 v[44:45],v177 offset:30720
ds_read_b64_tr_b16 v[46:47],v177 offset:30976
s_waitcnt lgkmcnt(8)
s_waitcnt lgkmcnt(0)
v_mfma_f32_16x16x32_bf16 v[64:67],v[32:35],a[224:227],v[64:67]
v_mfma_f32_16x16x32_bf16 v[72:75],v[32:35],a[228:231],v[72:75]
v_mfma_f32_16x16x32_bf16 v[80:83],v[32:35],a[232:235],v[80:83]
v_mfma_f32_16x16x32_bf16 v[88:91],v[32:35],a[236:239],v[88:91]
v_mfma_f32_16x16x32_bf16 v[68:71],v[36:39],a[224:227],v[68:71]
v_mfma_f32_16x16x32_bf16 v[76:79],v[36:39],a[228:231],v[76:79]
v_mfma_f32_16x16x32_bf16 v[84:87],v[36:39],a[232:235],v[84:87]
v_mfma_f32_16x16x32_bf16 v[92:95],v[36:39],a[236:239],v[92:95]
v_mfma_f32_16x16x32_bf16 v[64:67],v[40:43],a[240:243],v[64:67]
v_mfma_f32_16x16x32_bf16 v[72:75],v[40:43],a[244:247],v[72:75]
v_mfma_f32_16x16x32_bf16 v[80:83],v[40:43],a[248:251],v[80:83]
v_mfma_f32_16x16x32_bf16 v[88:91],v[40:43],a[252:255],v[88:91]
v_mfma_f32_16x16x32_bf16 v[68:71],v[44:47],a[240:243],v[68:71]
v_mfma_f32_16x16x32_bf16 v[76:79],v[44:47],a[244:247],v[76:79]
v_mfma_f32_16x16x32_bf16 v[84:87],v[44:47],a[248:251],v[84:87]
v_mfma_f32_16x16x32_bf16 v[92:95],v[44:47],a[252:255],v[92:95]
s_waitcnt vmcnt(0)
ds_read_b128 v[144:147],v26 offset:0
ds_read_b128 v[148:151],v27 offset:2048
ds_read_b128 v[152:155],v26 offset:4096
ds_read_b128 v[156:159],v27 offset:6144
ds_read_b128 v[160:163],v27 offset:0
ds_read_b128 v[164:167],v26 offset:2048
ds_read_b128 v[168:171],v27 offset:4096
ds_read_b128 v[172:175],v26 offset:6144
s_waitcnt lgkmcnt(6)
ds_read_b64_tr_b16 v[32:33],v176 offset:32768
ds_read_b64_tr_b16 v[34:35],v176 offset:33024
ds_read_b64_tr_b16 v[36:37],v177 offset:32768
ds_read_b64_tr_b16 v[38:39],v177 offset:33024
ds_read_b64_tr_b16 v[40:41],v176 offset:34816
ds_read_b64_tr_b16 v[42:43],v176 offset:35072
ds_read_b64_tr_b16 v[44:45],v177 offset:34816
ds_read_b64_tr_b16 v[46:47],v177 offset:35072
s_waitcnt lgkmcnt(8)
s_waitcnt lgkmcnt(0)
v_mfma_f32_16x16x32_bf16 v[64:67],v[32:35],v[144:147],v[64:67]
v_mfma_f32_16x16x32_bf16 v[72:75],v[32:35],v[148:151],v[72:75]
v_mfma_f32_16x16x32_bf16 v[80:83],v[32:35],v[152:155],v[80:83]
v_mfma_f32_16x16x32_bf16 v[88:91],v[32:35],v[156:159],v[88:91]
v_mfma_f32_16x16x32_bf16 v[68:71],v[36:39],v[144:147],v[68:71]
v_mfma_f32_16x16x32_bf16 v[76:79],v[36:39],v[148:151],v[76:79]
v_mfma_f32_16x16x32_bf16 v[84:87],v[36:39],v[152:155],v[84:87]
v_mfma_f32_16x16x32_bf16 v[92:95],v[36:39],v[156:159],v[92:95]
v_mfma_f32_16x16x32_bf16 v[64:67],v[40:43],v[160:163],v[64:67]
v_mfma_f32_16x16x32_bf16 v[72:75],v[40:43],v[164:167],v[72:75]
v_mfma_f32_16x16x32_bf16 v[80:83],v[40:43],v[168:171],v[80:83]
v_mfma_f32_16x16x32_bf16 v[88:91],v[40:43],v[172:175],v[88:91]
v_mfma_f32_16x16x32_bf16 v[68:71],v[44:47],v[160:163],v[68:71]
v_mfma_f32_16x16x32_bf16 v[76:79],v[44:47],v[164:167],v[76:79]
v_mfma_f32_16x16x32_bf16 v[84:87],v[44:47],v[168:171],v[84:87]
v_mfma_f32_16x16x32_bf16 v[92:95],v[44:47],v[172:175],v[92:95]
s_barrier
ds_read_b64_tr_b16 v[48:49],v178 offset:0
ds_read_b64_tr_b16 v[50:51],v178 offset:256
ds_read_b64_tr_b16 v[52:53],v179 offset:0
ds_read_b64_tr_b16 v[54:55],v179 offset:256
ds_read_b64_tr_b16 v[56:57],v178 offset:2048
ds_read_b64_tr_b16 v[58:59],v178 offset:2304
ds_read_b64_tr_b16 v[60:61],v179 offset:2048
ds_read_b64_tr_b16 v[62:63],v179 offset:2304
s_add_u32 s42,s47,s78
s_and_b32 s42,s42,s80
s_or_b32 s42,s42,s79
s_mul_i32 s42,s42,s31
s_add_u32 s42,s42,s30
s_cmp_lt_u32 s47,s28
s_cselect_b32 s14,s44,0
s_add_u32 s47,s47,1
s_add_u32 m0,s41,0
s_nop 0
buffer_load_dwordx4 v16,s[12:15],s42 offen lds
s_add_u32 m0,s41,1024
s_add_u32 s42,s42,s29
buffer_load_dwordx4 v16,s[12:15],s42 offen lds
s_add_u32 m0,s41,2048
s_add_u32 s42,s42,s29
buffer_load_dwordx4 v16,s[12:15],s42 offen lds
s_add_u32 m0,s41,3072
s_add_u32 s42,s42,s29
buffer_load_dwordx4 v16,s[12:15],s42 offen lds
s_add_u32 m0,s41,4096
s_add_u32 s42,s42,s29
buffer_load_dwordx4 v16,s[12:15],s42 offen lds
s_add_u32 m0,s41,5120
s_add_u32 s42,s42,s29
buffer_load_dwordx4 v16,s[12:15],s42 offen lds
s_add_u32 m0,s41,6144
s_add_u32 s42,s42,s29
buffer_load_dwordx4 v16,s[12:15],s42 offen lds
s_add_u32 m0,s41,7168
s_add_u32 s42,s42,s29
buffer_load_dwordx4 v16,s[12:15],s42 offen lds
s_add_u32 m0,s41,8192
s_add_u32 s42,s42,s29
buffer_load_dwordx4 v16,s[12:15],s42 offen lds
s_add_u32 s41,s41,36864
s_sub_u32 s36,s41,147456
s_cmp_ge_u32 s41,147456
s_cselect_b32 s41,s36,s41
s_lshl_b32 s37,s78,6
s_add_u32 s37,s37,256
s_and_b32 s37,s37,s92
s_add_u32 s93,s51,s37
buffer_load_dwordx4 v[180:183],v30,s[84:87],s93 offen
s_add_u32 s93,s93,s94
buffer_load_dwordx4 v[184:187],v30,s[84:87],s93 offen
s_add_u32 s93,s93,s94
buffer_load_dwordx4 v[188:191],v30,s[84:87],s93 offen
s_add_u32 s93,s93,s94
buffer_load_dwordx4 v[192:195],v30,s[84:87],s93 offen
s_add_u32 s93,s93,s94
buffer_load_dwordx4 v[196:199],v30,s[84:87],s93 offen
s_add_u32 s93,s93,s94
s_mov_b32 s88,s12
s_mov_b32 s89,s13
s_mov_b32 s90,0
s_mov_b32 s91,0x20000
buffer_load_dword v204,v30,s[88:91],0 offen
buffer_load_dword v204,v30,s[88:91],0 offen
buffer_load_dword v204,v30,s[88:91],0 offen
buffer_load_dword v204,v30,s[88:91],0 offen
buffer_load_dword v204,v30,s[88:91],0 offen
buffer_load_dword v204,v30,s[88:91],0 offen
v_mov_b32 v6,128
v_mov_b32 v7,256
v_mov_b32 v9,0x40000
s_add_u32 s27,s27,1
k1_S576_l1:
s_waitcnt lgkmcnt(4)
v_mfma_f32_16x16x32_bf16 v[96:99],v[48:51],a[0:3],0
ds_read_b64_tr_b16 v[32:33],v178 offset:4096
s_add_u32 s42,s47,s78
s_and_b32 s42,s42,s80
v_mfma_f32_16x16x32_bf16 v[104:107],v[48:51],a[4:7],0
ds_read_b64_tr_b16 v[34:35],v178 offset:4352
s_or_b32 s42,s42,s79
s_mul_i32 s42,s42,s31
v_mfma_f32_16x16x32_bf16 v[112:115],v[48:51],a[8:11],0
ds_read_b64_tr_b16 v[36:37],v179 offset:4096
s_add_u32 s42,s42,s30
s_cmp_lt_u32 s47,s28
s_cselect_b32 s14,s44,0
v_mfma_f32_16x16x32_bf16 v[120:123],v[48:51],a[12:15],0
ds_read_b64_tr_b16 v[38:39],v179 offset:4352
s_add_u32 s47,s47,1
s_add_u32 m0,s41,0
v_mfma_f32_16x16x32_bf16 v[100:103],v[52:55],a[0:3],0
v_mfma_f32_16x16x32_bf16 v[108:111],v[52:55],a[4:7],0
v_mfma_f32_16x16x32_bf16 v[116:119],v[52:55],a[8:11],0
v_mfma_f32_16x16x32_bf16 v[124:127],v[52:55],a[12:15],0
s_waitcnt lgkmcnt(4)
s_nop 0
v_mfma_f32_16x16x32_bf16 v[96:99],v[56:59],a[16:19],v[96:99]
ds_read_b64_tr_b16 v[40:41],v178 offset:6144
s_sub_u32 s37,s27,1
s_cmp_lt_u32 s37,18
s_cselect_b32 s35,s96,1.0
v_mfma_f32_16x16x32_bf16 v[104:107],v[56:59],a[20:23],v[104:107]
ds_read_b64_tr_b16 v[42:43],v178 offset:6400
s_lshl_b32 s37,s37,3
v_lshrrev_b32 v2,4,v1
v_mfma_f32_16x16x32_bf16 v[112:115],v[56:59],a[24:27],v[112:115]
ds_read_b64_tr_b16 v[44:45],v179 offset:6144
v_add_u32 v2,s37,v2
v_mul_u32_u24 v3,7282,v2
v_mfma_f32_16x16x32_bf16 v[120:123],v[56:59],a[28:31],v[120:123]
ds_read_b64_tr_b16 v[46:47],v179 offset:6400
v_lshrrev_b32 v3,16,v3
v_mul_u32_u24 v4,9,v3
v_mfma_f32_16x16x32_bf16 v[100:103],v[60:63],a[16:19],v[100:103]
buffer_load_dwordx4 v16,s[12:15],s42 offen lds
v_mfma_f32_16x16x32_bf16 v[108:111],v[60:63],a[20:23],v[108:111]
s_add_u32 m0,s41,1024
s_add_u32 s42,s42,s29
v_sub_u32 v4,v2,v4
v_mfma_f32_16x16x32_bf16 v[116:119],v[60:63],a[24:27],v[116:119]
v_cmp_lt_u32 vcc,4,v4
v_lshlrev_b32 v3,19,v3
v_subrev_u32 v5,5,v4
v_mfma_f32_16x16x32_bf16 v[124:127],v[60:63],a[28:31],v[124:127]
v_cndmask_b32 v8,0,v9,vcc
v_cndmask_b32 v5,v4,v5,vcc
s_waitcnt lgkmcnt(4)
v_mfma_f32_16x16x32_bf16 v[96:99],v[32:35],a[32:35],v[96:99]
ds_read_b64_tr_b16 v[48:49],v178 offset:8192
v_cmp_eq_u32 vcc,4,v4
v_lshrrev_b32 v4,1,v5
v_mfma_f32_16x16x32_bf16 v[104:107],v[32:35],a[36:39],v[104:107]
ds_read_b64_tr_b16 v[50:51],v178 offset:8448
v_lshl_add_u32 v8,v4,9,v8
v_and_b32 v5,1,v5
v_mfma_f32_16x16x32_bf16 v[112:115],v[32:35],a[40:43],v[112:115]
ds_read_b64_tr_b16 v[52:53],v179 offset:8192
v_lshl_add_u32 v8,v5,3,v8
v_add_u32 v8,v17,v8
v_mfma_f32_16x16x32_bf16 v[120:123],v[32:35],a[44:47],v[120:123]
ds_read_b64_tr_b16 v[54:55],v179 offset:8448
v_cndmask_b32 v8,v8,v18,vcc
v_add_u32 v232,v3,v8
v_mfma_f32_16x16x32_bf16 v[100:103],v[36:39],a[32:35],v[100:103]
buffer_load_dwordx4 v16,s[12:15],s42 offen lds
v_mfma_f32_16x16x32_bf16 v[108:111],v[36:39],a[36:39],v[108:111]
s_add_u32 m0,s41,2048
s_add_u32 s42,s42,s29
v_cndmask_b32 v4,v7,v6,vcc
v_mfma_f32_16x16x32_bf16 v[116:119],v[36:39],a[40:43],v[116:119]
v_add_u32 v233,v232,v4
v_add_u32 v2,4,v2
v_mul_u32_u24 v3,7282,v2
v_mfma_f32_16x16x32_bf16 v[124:127],v[36:39],a[44:47],v[124:127]
v_lshrrev_b32 v3,16,v3
v_mul_u32_u24 v4,9,v3
s_waitcnt lgkmcnt(4)
v_mfma_f32_16x16x32_bf16 v[96:99],v[40:43],a[48:51],v[96:99]
ds_read_b64_tr_b16 v[56:57],v178 offset:10240
v_sub_u32 v4,v2,v4
v_cmp_lt_u32 vcc,4,v4
v_mfma_f32_16x16x32_bf16 v[104:107],v[40:43],a[52:55],v[104:107]
ds_read_b64_tr_b16 v[58:59],v178 offset:10496
v_lshlrev_b32 v3,19,v3
v_subrev_u32 v5,5,v4
v_mfma_f32_16x16x32_bf16 v[112:115],v[40:43],a[56:59],v[112:115]
ds_read_b64_tr_b16 v[60:61],v179 offset:10240
v_cndmask_b32 v8,0,v9,vcc
v_cndmask_b32 v5,v4,v5,vcc
v_mfma_f32_16x16x32_bf16 v[120:123],v[40:43],a[60:63],v[120:123]
ds_read_b64_tr_b16 v[62:63],v179 offset:10496
v_cmp_eq_u32 vcc,4,v4
v_lshrrev_b32 v4,1,v5
v_mfma_f32_16x16x32_bf16 v[100:103],v[44:47],a[48:51],v[100:103]
buffer_load_dwordx4 v16,s[12:15],s42 offen lds
v_mfma_f32_16x16x32_bf16 v[108:111],v[44:47],a[52:55],v[108:111]
s_add_u32 m0,s41,3072
s_add_u32 s42,s42,s29
v_lshl_add_u32 v8,v4,9,v8
v_mfma_f32_16x16x32_bf16 v[116:119],v[44:47],a[56:59],v[116:119]
v_and_b32 v5,1,v5
v_lshl_add_u32 v8,v5,3,v8
v_add_u32 v8,v17,v8
v_mfma_f32_16x16x32_bf16 v[124:127],v[44:47],a[60:63],v[124:127]
v_cndmask_b32 v8,v8,v18,vcc
v_add_u32_e64 v234,v3,v8
s_waitcnt lgkmcnt(4)
v_mfma_f32_16x16x32_bf16 v[96:99],v[48:51],a[64:67],v[96:99]
ds_read_b64_tr_b16 v[32:33],v178 offset:12288
v_cndmask_b32 v4,v7,v6,vcc
v_add_u32 v235,v234,v4
v_mfma_f32_16x16x32_bf16 v[104:107],v[48:51],a[68:71],v[104:107]
ds_read_b64_tr_b16 v[34:35],v178 offset:12544
v_mul_f32 v64,s35,v64
v_mul_f32 v65,s35,v65
v_mfma_f32_16x16x32_bf16 v[112:115],v[48:51],a[72:75],v[112:115]
ds_read_b64_tr_b16 v[36:37],v179 offset:12288
v_mul_f32 v66,s35,v66
v_mul_f32 v67,s35,v67
v_mfma_f32_16x16x32_bf16 v[120:123],v[48:51],a[76:79],v[120:123]
ds_read_b64_tr_b16 v[38:39],v179 offset:12544
v_mul_f32 v68,s35,v68
v_mul_f32 v69,s35,v69
v_mfma_f32_16x16x32_bf16 v[100:103],v[52:55],a[64:67],v[100:103]
buffer_load_dwordx4 v16,s[12:15],s42 offen lds
v_mfma_f32_16x16x32_bf16 v[108:111],v[52:55],a[68:71],v[108:111]
s_add_u32 m0,s41,4096
s_add_u32 s42,s42,s29
v_mul_f32 v70,s35,v70
v_mfma_f32_16x16x32_bf16 v[116:119],v[52:55],a[72:75],v[116:119]
v_mul_f32 v71,s35,v71
v_mul_f32 v72,s35,v72
v_mul_f32_e64 v73,s35,v73
v_mfma_f32_16x16x32_bf16 v[124:127],v[52:55],a[76:79],v[124:127]
v_mul_f32 v74,s35,v74
v_mul_f32_e64 v75,s35,v75
s_waitcnt lgkmcnt(4)
v_mfma_f32_16x16x32_bf16 v[96:99],v[56:59],a[80:83],v[96:99]
ds_read_b64_tr_b16 v[40:41],v178 offset:14336
v_mul_f32 v76,s35,v76
v_mul_f32 v77,s35,v77
v_mfma_f32_16x16x32_bf16 v[104:107],v[56:59],a[84:87],v[104:107]
ds_read_b64_tr_b16 v[42:43],v178 offset:14592
v_mul_f32 v78,s35,v78
v_mul_f32 v79,s35,v79
v_mfma_f32_16x16x32_bf16 v[112:115],v[56:59],a[88:91],v[112:115]
ds_read_b64_tr_b16 v[44:45],v179 offset:14336
v_mul_f32 v80,s35,v80
v_mul_f32 v81,s35,v81
v_mfma_f32_16x16x32_bf16 v[120:123],v[56:59],a[92:95],v[120:123]
ds_read_b64_tr_b16 v[46:47],v179 offset:14592
v_mul_f32 v82,s35,v82
v_mul_f32 v83,s35,v83
v_mfma_f32_16x16x32_bf16 v[100:103],v[60:63],a[80:83],v[100:103]
buffer_load_dwordx4 v16,s[12:15],s42 offen lds
v_mfma_f32_16x16x32_bf16 v[108:111],v[60:63],a[84:87],v[108:111]
s_add_u32 m0,s41,5120
s_add_u32 s42,s42,s29
v_mul_f32 v84,s35,v84
v_mfma_f32_16x16x32_bf16 v[116:119],v[60:63],a[88:91],v[116:119]
v_mul_f32 v85,s35,v85
v_mul_f32 v86,s35,v86
v_mul_f32_e64 v87,s35,v87
v_mfma_f32_16x16x32_bf16 v[124:127],v[60:63],a[92:95],v[124:127]
v_mul_f32 v88,s35,v88
v_mul_f32_e64 v89,s35,v89
s_waitcnt lgkmcnt(4)
v_mfma_f32_16x16x32_bf16 v[96:99],v[32:35],a[96:99],v[96:99]
ds_read_b64_tr_b16 v[48:49],v178 offset:16384
v_mul_f32 v90,s35,v90
v_mul_f32 v91,s35,v91
v_mfma_f32_16x16x32_bf16 v[104:107],v[32:35],a[100:103],v[104:107]
ds_read_b64_tr_b16 v[50:51],v178 offset:16640
v_mul_f32 v92,s35,v92
v_mul_f32 v93,s35,v93
v_mfma_f32_16x16x32_bf16 v[112:115],v[32:35],a[104:107],v[112:115]
ds_read_b64_tr_b16 v[52:53],v179 offset:16384
v_mul_f32 v94,s35,v94
v_mul_f32 v95,s35,v95
v_mfma_f32_16x16x32_bf16 v[120:123],v[32:35],a[108:111],v[120:123]
ds_read_b64_tr_b16 v[54:55],v179 offset:16640
v_cvt_pk_bf16_f32 v128,v64,v65
v_cvt_pk_bf16_f32 v129,v66,v67
v_mfma_f32_16x16x32_bf16 v[100:103],v[36:39],a[96:99],v[100:103]
buffer_load_dwordx4 v16,s[12:15],s42 offen lds
v_mfma_f32_16x16x32_bf16 v[108:111],v[36:39],a[100:103],v[108:111]
s_add_u32 m0,s41,6144
s_add_u32 s42,s42,s29
v_cvt_pk_bf16_f32 v130,v68,v69
v_mfma_f32_16x16x32_bf16 v[116:119],v[36:39],a[104:107],v[116:119]
v_cvt_pk_bf16_f32 v131,v70,v71
v_cvt_pk_bf16_f32 v132,v72,v73
v_cvt_pk_bf16_f32 v133,v74,v75
v_mfma_f32_16x16x32_bf16 v[124:127],v[36:39],a[108:111],v[124:127]
v_cvt_pk_bf16_f32 v134,v76,v77
v_cvt_pk_bf16_f32 v135,v78,v79
s_waitcnt lgkmcnt(4)
v_mfma_f32_16x16x32_bf16 v[96:99],v[40:43],a[112:115],v[96:99]
ds_read_b64_tr_b16 v[56:57],v178 offset:18432
v_cvt_pk_bf16_f32 v136,v80,v81
v_cvt_pk_bf16_f32 v137,v82,v83
v_mfma_f32_16x16x32_bf16 v[104:107],v[40:43],a[116:119],v[104:107]
ds_read_b64_tr_b16 v[58:59],v178 offset:18688
v_cvt_pk_bf16_f32 v138,v84,v85
v_cvt_pk_bf16_f32 v139,v86,v87
v_mfma_f32_16x16x32_bf16 v[112:115],v[40:43],a[120:123],v[112:115]
ds_read_b64_tr_b16 v[60:61],v179 offset:18432
v_cvt_pk_bf16_f32 v140,v88,v89
v_cvt_pk_bf16_f32 v141,v90,v91
v_mfma_f32_16x16x32_bf16 v[120:123],v[40:43],a[124:127],v[120:123]
ds_read_b64_tr_b16 v[62:63],v179 offset:18688
v_cvt_pk_bf16_f32 v142,v92,v93
v_cvt_pk_bf16_f32 v143,v94,v95
v_mfma_f32_16x16x32_bf16 v[100:103],v[44:47],a[112:115],v[100:103]
buffer_load_dwordx4 v16,s[12:15],s42 offen lds
v_mfma_f32_16x16x32_bf16 v[108:111],v[44:47],a[116:119],v[108:111]
s_add_u32 m0,s41,7168
s_add_u32 s42,s42,s29
v_mfma_f32_16x16x32_bf16 v[116:119],v[44:47],a[120:123],v[116:119]
s_nop 0
v_mfma_f32_16x16x32_bf16 v[124:127],v[44:47],a[124:127],v[124:127]
s_waitcnt lgkmcnt(4)
s_nop 0
v_mfma_f32_16x16x32_bf16 v[96:99],v[48:51],a[128:131],v[96:99]
ds_read_b64_tr_b16 v[32:33],v178 offset:20480
v_mfma_f32_16x16x32_bf16 v[104:107],v[48:51],a[132:135],v[104:107]
ds_read_b64_tr_b16 v[34:35],v178 offset:20736
v_mfma_f32_16x16x32_bf16 v[112:115],v[48:51],a[136:139],v[112:115]
ds_read_b64_tr_b16 v[36:37],v179 offset:20480
v_mfma_f32_16x16x32_bf16 v[120:123],v[48:51],a[140:143],v[120:123]
ds_read_b64_tr_b16 v[38:39],v179 offset:20736
v_mfma_f32_16x16x32_bf16 v[100:103],v[52:55],a[128:131],v[100:103]
buffer_load_dwordx4 v16,s[12:15],s42 offen lds
v_mfma_f32_16x16x32_bf16 v[108:111],v[52:55],a[132:135],v[108:111]
s_add_u32 m0,s41,8192
s_add_u32 s42,s42,s29
v_mfma_f32_16x16x32_bf16 v[116:119],v[52:55],a[136:139],v[116:119]
s_nop 0
v_mfma_f32_16x16x32_bf16 v[124:127],v[52:55],a[140:143],v[124:127]
s_waitcnt lgkmcnt(4)
s_nop 0
v_mfma_f32_16x16x32_bf16 v[96:99],v[56:59],a[144:147],v[96:99]
ds_read_b64_tr_b16 v[40:41],v178 offset:22528
v_mfma_f32_16x16x32_bf16 v[104:107],v[56:59],a[148:151],v[104:107]
ds_read_b64_tr_b16 v[42:43],v178 offset:22784
v_mfma_f32_16x16x32_bf16 v[112:115],v[56:59],a[152:155],v[112:115]
ds_read_b64_tr_b16 v[44:45],v179 offset:22528
v_mfma_f32_16x16x32_bf16 v[120:123],v[56:59],a[156:159],v[120:123]
ds_read_b64_tr_b16 v[46:47],v179 offset:22784
v_mfma_f32_16x16x32_bf16 v[100:103],v[60:63],a[144:147],v[100:103]
buffer_load_dwordx4 v16,s[12:15],s42 offen lds
v_mfma_f32_16x16x32_bf16 v[108:111],v[60:63],a[148:151],v[108:111]
s_add_u32 s41,s41,36864
s_sub_u32 s36,s41,147456
s_cmp_ge_u32 s41,147456
s_cselect_b32 s41,s36,s41
v_mfma_f32_16x16x32_bf16 v[116:119],v[60:63],a[152:155],v[116:119]
s_add_u32 s83,s83,256
s_and_b32 s83,s83,s92
s_sub_u32 s82,s82,1
v_mfma_f32_16x16x32_bf16 v[124:127],v[60:63],a[156:159],v[124:127]
s_cmp_ge_i32 s82,0
s_cselect_b32 s86,s44,0
s_waitcnt lgkmcnt(4)
v_mfma_f32_16x16x32_bf16 v[96:99],v[32:35],a[160:163],v[96:99]
ds_read_b64_tr_b16 v[48:49],v178 offset:24576
s_add_u32 s93,s51,s83
v_mfma_f32_16x16x32_bf16 v[104:107],v[32:35],a[164:167],v[104:107]
ds_read_b64_tr_b16 v[50:51],v178 offset:24832
s_nop 0
v_mfma_f32_16x16x32_bf16 v[112:115],v[32:35],a[168:171],v[112:115]
ds_read_b64_tr_b16 v[52:53],v179 offset:24576
v_mfma_f32_16x16x32_bf16 v[120:123],v[32:35],a[172:175],v[120:123]
ds_read_b64_tr_b16 v[54:55],v179 offset:24832
v_mfma_f32_16x16x32_bf16 v[100:103],v[36:39],a[160:163],v[100:103]
buffer_load_dwordx4 v[180:183],v30,s[84:87],s93 offen
v_mfma_f32_16x16x32_bf16 v[108:111],v[36:39],a[164:167],v[108:111]
s_add_u32 s93,s93,s94
s_nop 0
v_mfma_f32_16x16x32_bf16 v[116:119],v[36:39],a[168:171],v[116:119]
buffer_load_dwordx4 v[184:187],v30,s[84:87],s93 offen
v_mfma_f32_16x16x32_bf16 v[124:127],v[36:39],a[172:175],v[124:127]
s_add_u32 s93,s93,s94
s_waitcnt lgkmcnt(4)
v_mfma_f32_16x16x32_bf16 v[96:99],v[40:43],a[176:179],v[96:99]
ds_read_b64_tr_b16 v[56:57],v178 offset:26624
v_mfma_f32_16x16x32_bf16 v[104:107],v[40:43],a[180:183],v[104:107]
ds_read_b64_tr_b16 v[58:59],v178 offset:26880
v_mfma_f32_16x16x32_bf16 v[112:115],v[40:43],a[184:187],v[112:115]
ds_read_b64_tr_b16 v[60:61],v179 offset:26624
v_mfma_f32_16x16x32_bf16 v[120:123],v[40:43],a[188:191],v[120:123]
ds_read_b64_tr_b16 v[62:63],v179 offset:26880
v_mfma_f32_16x16x32_bf16 v[100:103],v[44:47],a[176:179],v[100:103]
buffer_load_dwordx4 v[188:191],v30,s[84:87],s93 offen
v_mfma_f32_16x16x32_bf16 v[108:111],v[44:47],a[180:183],v[108:111]
v_mfma_f32_16x16x32_bf16 v[116:119],v[44:47],a[184:187],v[116:119]
buffer_store_dwordx2 v[128:129],v232,s[20:23],s32 offen sc1
v_mfma_f32_16x16x32_bf16 v[124:127],v[44:47],a[188:191],v[124:127]
s_waitcnt lgkmcnt(4)
s_nop 0
v_mfma_f32_16x16x32_bf16 v[96:99],v[48:51],a[192:195],v[96:99]
ds_read_b64_tr_b16 v[32:33],v178 offset:28672
buffer_store_dwordx2 v[132:133],v233,s[20:23],s32 offen sc1
v_mfma_f32_16x16x32_bf16 v[104:107],v[48:51],a[196:199],v[104:107]
ds_read_b64_tr_b16 v[34:35],v178 offset:28928
v_mfma_f32_16x16x32_bf16 v[112:115],v[48:51],a[200:203],v[112:115]
ds_read_b64_tr_b16 v[36:37],v179 offset:28672
buffer_store_dwordx2 v[136:137],v232,s[20:23],s43 offen sc1
v_mfma_f32_16x16x32_bf16 v[120:123],v[48:51],a[204:207],v[120:123]
ds_read_b64_tr_b16 v[38:39],v179 offset:28928
v_mfma_f32_16x16x32_bf16 v[100:103],v[52:55],a[192:195],v[100:103]
buffer_store_dwordx2 v[140:141],v233,s[20:23],s43 offen sc1
v_mfma_f32_16x16x32_bf16 v[108:111],v[52:55],a[196:199],v[108:111]
v_mfma_f32_16x16x32_bf16 v[116:119],v[52:55],a[200:203],v[116:119]
buffer_store_dwordx2 v[130:131],v234,s[20:23],s32 offen sc1
v_mfma_f32_16x16x32_bf16 v[124:127],v[52:55],a[204:207],v[124:127]
s_waitcnt lgkmcnt(4)
s_nop 0
v_mfma_f32_16x16x32_bf16 v[96:99],v[56:59],a[208:211],v[96:99]
ds_read_b64_tr_b16 v[40:41],v178 offset:30720
buffer_store_dwordx2 v[134:135],v235,s[20:23],s32 offen sc1
v_mfma_f32_16x16x32_bf16 v[104:107],v[56:59],a[212:215],v[104:107]
ds_read_b64_tr_b16 v[42:43],v178 offset:30976
s_add_u32 s40,s40,36864
s_cmp_ge_u32 s40,147456
s_cselect_b32 s40,0,s40
v_mfma_f32_16x16x32_bf16 v[112:115],v[56:59],a[216:219],v[112:115]
ds_read_b64_tr_b16 v[44:45],v179 offset:30720
buffer_store_dwordx2 v[138:139],v234,s[20:23],s43 offen sc1
v_mfma_f32_16x16x32_bf16 v[120:123],v[56:59],a[220:223],v[120:123]
ds_read_b64_tr_b16 v[46:47],v179 offset:30976
v_add_u32_e64 v176,s40,v19
v_xor_b32 v177,32,v176
v_mfma_f32_16x16x32_bf16 v[100:103],v[60:63],a[208:211],v[100:103]
buffer_store_dwordx2 v[142:143],v235,s[20:23],s43 offen sc1
v_mfma_f32_16x16x32_bf16 v[108:111],v[60:63],a[212:215],v[108:111]
v_mfma_f32_16x16x32_bf16 v[116:119],v[60:63],a[216:219],v[116:119]
v_mfma_f32_16x16x32_bf16 v[124:127],v[60:63],a[220:223],v[124:127]
s_waitcnt lgkmcnt(4)
s_nop 0
v_mfma_f32_16x16x32_bf16 v[96:99],v[32:35],a[224:227],v[96:99]
ds_read_b64_tr_b16 v[48:49],v178 offset:32768
v_mfma_f32_16x16x32_bf16 v[104:107],v[32:35],a[228:231],v[104:107]
ds_read_b64_tr_b16 v[50:51],v178 offset:33024
v_mfma_f32_16x16x32_bf16 v[112:115],v[32:35],a[232:235],v[112:115]
ds_read_b64_tr_b16 v[52:53],v179 offset:32768
v_mfma_f32_16x16x32_bf16 v[120:123],v[32:35],a[236:239],v[120:123]
ds_read_b64_tr_b16 v[54:55],v179 offset:33024
v_mfma_f32_16x16x32_bf16 v[100:103],v[36:39],a[224:227],v[100:103]
v_mfma_f32_16x16x32_bf16 v[108:111],v[36:39],a[228:231],v[108:111]
v_mfma_f32_16x16x32_bf16 v[116:119],v[36:39],a[232:235],v[116:119]
v_mfma_f32_16x16x32_bf16 v[124:127],v[36:39],a[236:239],v[124:127]
s_waitcnt lgkmcnt(4)
s_nop 0
v_mfma_f32_16x16x32_bf16 v[96:99],v[40:43],a[240:243],v[96:99]
ds_read_b64_tr_b16 v[56:57],v178 offset:34816
v_mfma_f32_16x16x32_bf16 v[104:107],v[40:43],a[244:247],v[104:107]
ds_read_b64_tr_b16 v[58:59],v178 offset:35072
v_mfma_f32_16x16x32_bf16 v[112:115],v[40:43],a[248:251],v[112:115]
ds_read_b64_tr_b16 v[60:61],v179 offset:34816
v_mfma_f32_16x16x32_bf16 v[120:123],v[40:43],a[252:255],v[120:123]
ds_read_b64_tr_b16 v[62:63],v179 offset:35072
v_mfma_f32_16x16x32_bf16 v[100:103],v[44:47],a[240:243],v[100:103]
v_mfma_f32_16x16x32_bf16 v[108:111],v[44:47],a[244:247],v[108:111]
v_mfma_f32_16x16x32_bf16 v[116:119],v[44:47],a[248:251],v[116:119]
v_mfma_f32_16x16x32_bf16 v[124:127],v[44:47],a[252:255],v[124:127]
s_waitcnt lgkmcnt(4)
s_nop 0
v_mfma_f32_16x16x32_bf16 v[96:99],v[48:51],v[144:147],v[96:99]
s_waitcnt vmcnt(31)
s_barrier
ds_read_b64_tr_b16 v[32:33],v176 offset:0
v_mfma_f32_16x16x32_bf16 v[104:107],v[48:51],v[148:151],v[104:107]
ds_read_b64_tr_b16 v[34:35],v176 offset:256
v_mfma_f32_16x16x32_bf16 v[112:115],v[48:51],v[152:155],v[112:115]
ds_read_b64_tr_b16 v[36:37],v177 offset:0
v_mfma_f32_16x16x32_bf16 v[120:123],v[48:51],v[156:159],v[120:123]
ds_read_b64_tr_b16 v[38:39],v177 offset:256
v_mfma_f32_16x16x32_bf16 v[100:103],v[52:55],v[144:147],v[100:103]
v_mfma_f32_16x16x32_bf16 v[108:111],v[52:55],v[148:151],v[108:111]
v_mfma_f32_16x16x32_bf16 v[116:119],v[52:55],v[152:155],v[116:119]
v_mfma_f32_16x16x32_bf16 v[124:127],v[52:55],v[156:159],v[124:127]
s_waitcnt lgkmcnt(4)
s_nop 0
v_mfma_f32_16x16x32_bf16 v[96:99],v[56:59],v[160:163],v[96:99]
ds_read_b64_tr_b16 v[40:41],v176 offset:2048
v_mfma_f32_16x16x32_bf16 v[104:107],v[56:59],v[164:167],v[104:107]
ds_read_b64_tr_b16 v[42:43],v176 offset:2304
v_mfma_f32_16x16x32_bf16 v[112:115],v[56:59],v[168:171],v[112:115]
ds_read_b64_tr_b16 v[44:45],v177 offset:2048
v_mfma_f32_16x16x32_bf16 v[120:123],v[56:59],v[172:175],v[120:123]
ds_read_b64_tr_b16 v[46:47],v177 offset:2304
v_mfma_f32_16x16x32_bf16 v[100:103],v[60:63],v[160:163],v[100:103]
v_mfma_f32_16x16x32_bf16 v[108:111],v[60:63],v[164:167],v[108:111]
v_mfma_f32_16x16x32_bf16 v[116:119],v[60:63],v[168:171],v[116:119]
v_mfma_f32_16x16x32_bf16 v[124:127],v[60:63],v[172:175],v[124:127]
s_add_u32 s27,s27,1
s_cmp_ge_u32 s27,s28
s_cbranch_scc1 k1_S576_t1
s_waitcnt lgkmcnt(4)
v_mfma_f32_16x16x32_bf16 v[64:67],v[32:35],a[0:3],0
ds_read_b64_tr_b16 v[48:49],v176 offset:4096
s_add_u32 s42,s47,s78
s_and_b32 s42,s42,s80
v_mfma_f32_16x16x32_bf16 v[72:75],v[32:35],a[4:7],0
ds_read_b64_tr_b16 v[50:51],v176 offset:4352
s_or_b32 s42,s42,s79
s_mul_i32 s42,s42,s31
v_mfma_f32_16x16x32_bf16 v[80:83],v[32:35],a[8:11],0
ds_read_b64_tr_b16 v[52:53],v177 offset:4096
s_add_u32 s42,s42,s30
s_cmp_lt_u32 s47,s28
s_cselect_b32 s14,s44,0
v_mfma_f32_16x16x32_bf16 v[88:91],v[32:35],a[12:15],0
ds_read_b64_tr_b16 v[54:55],v177 offset:4352
s_add_u32 s47,s47,1
s_add_u32 m0,s41,0
v_mfma_f32_16x16x32_bf16 v[68:71],v[36:39],a[0:3],0
s_nop 0
v_mfma_f32_16x16x32_bf16 v[76:79],v[36:39],a[4:7],0
v_mfma_f32_16x16x32_bf16 v[84:87],v[36:39],a[8:11],0
v_mfma_f32_16x16x32_bf16 v[92:95],v[36:39],a[12:15],0
s_waitcnt lgkmcnt(4)
s_nop 0
v_mfma_f32_16x16x32_bf16 v[64:67],v[40:43],a[16:19],v[64:67]
ds_read_b64_tr_b16 v[56:57],v176 offset:6144
s_sub_u32 s37,s27,1
s_cmp_lt_u32 s37,18
s_cselect_b32 s35,s96,1.0
v_mfma_f32_16x16x32_bf16 v[72:75],v[40:43],a[20:23],v[72:75]
ds_read_b64_tr_b16 v[58:59],v176 offset:6400
s_lshl_b32 s37,s37,3
v_lshrrev_b32 v2,4,v1
v_mfma_f32_16x16x32_bf16 v[80:83],v[40:43],a[24:27],v[80:83]
ds_read_b64_tr_b16 v[60:61],v177 offset:6144
v_add_u32 v2,s37,v2
v_mul_u32_u24 v3,7282,v2
v_mfma_f32_16x16x32_bf16 v[88:91],v[40:43],a[28:31],v[88:91]
ds_read_b64_tr_b16 v[62:63],v177 offset:6400
v_lshrrev_b32 v3,16,v3
v_mul_u32_u24 v4,9,v3
v_mfma_f32_16x16x32_bf16 v[68:71],v[44:47],a[16:19],v[68:71]
buffer_load_dwordx4 v16,s[12:15],s42 offen lds
v_mfma_f32_16x16x32_bf16 v[76:79],v[44:47],a[20:23],v[76:79]
s_add_u32 m0,s41,1024
s_add_u32 s42,s42,s29
v_sub_u32 v4,v2,v4
v_mfma_f32_16x16x32_bf16 v[84:87],v[44:47],a[24:27],v[84:87]
v_cmp_lt_u32 vcc,4,v4
v_lshlrev_b32 v3,19,v3
v_subrev_u32 v5,5,v4
v_mfma_f32_16x16x32_bf16 v[92:95],v[44:47],a[28:31],v[92:95]
v_cndmask_b32 v8,0,v9,vcc
v_cndmask_b32 v5,v4,v5,vcc
s_waitcnt lgkmcnt(4)
v_mfma_f32_16x16x32_bf16 v[64:67],v[48:51],a[32:35],v[64:67]
ds_read_b64_tr_b16 v[32:33],v176 offset:8192
v_cmp_eq_u32 vcc,4,v4
v_lshrrev_b32 v4,1,v5
v_mfma_f32_16x16x32_bf16 v[72:75],v[48:51],a[36:39],v[72:75]
ds_read_b64_tr_b16 v[34:35],v176 offset:8448
v_lshl_add_u32 v8,v4,9,v8
v_and_b32 v5,1,v5
v_mfma_f32_16x16x32_bf16 v[80:83],v[48:51],a[40:43],v[80:83]
ds_read_b64_tr_b16 v[36:37],v177 offset:8192
v_lshl_add_u32 v8,v5,3,v8
v_add_u32 v8,v17,v8
v_mfma_f32_16x16x32_bf16 v[88:91],v[48:51],a[44:47],v[88:91]
ds_read_b64_tr_b16 v[38:39],v177 offset:8448
v_cndmask_b32 v8,v8,v18,vcc
v_add_u32 v232,v3,v8
v_mfma_f32_16x16x32_bf16 v[68:71],v[52:55],a[32:35],v[68:71]
buffer_load_dwordx4 v16,s[12:15],s42 offen lds
v_mfma_f32_16x16x32_bf16 v[76:79],v[52:55],a[36:39],v[76:79]
s_add_u32 m0,s41,2048
s_add_u32 s42,s42,s29
v_cndmask_b32 v4,v7,v6,vcc
v_mfma_f32_16x16x32_bf16 v[84:87],v[52:55],a[40:43],v[84:87]
v_add_u32 v233,v232,v4
v_add_u32 v2,4,v2
v_mul_u32_u24 v3,7282,v2
v_mfma_f32_16x16x32_bf16 v[92:95],v[52:55],a[44:47],v[92:95]
v_lshrrev_b32 v3,16,v3
v_mul_u32_u24 v4,9,v3
s_waitcnt lgkmcnt(4)
v_mfma_f32_16x16x32_bf16 v[64:67],v[56:59],a[48:51],v[64:67]
ds_read_b64_tr_b16 v[40:41],v176 offset:10240
v_sub_u32 v4,v2,v4
v_cmp_lt_u32 vcc,4,v4
v_mfma_f32_16x16x32_bf16 v[72:75],v[56:59],a[52:55],v[72:75]
ds_read_b64_tr_b16 v[42:43],v176 offset:10496
v_lshlrev_b32 v3,19,v3
v_subrev_u32 v5,5,v4
v_mfma_f32_16x16x32_bf16 v[80:83],v[56:59],a[56:59],v[80:83]
ds_read_b64_tr_b16 v[44:45],v177 offset:10240
v_cndmask_b32 v8,0,v9,vcc
v_cndmask_b32 v5,v4,v5,vcc
v_mfma_f32_16x16x32_bf16 v[88:91],v[56:59],a[60:63],v[88:91]
ds_read_b64_tr_b16 v[46:47],v177 offset:10496
v_cmp_eq_u32 vcc,4,v4
v_lshrrev_b32 v4,1,v5
v_mfma_f32_16x16x32_bf16 v[68:71],v[60:63],a[48:51],v[68:71]
buffer_load_dwordx4 v16,s[12:15],s42 offen lds
v_mfma_f32_16x16x32_bf16 v[76:79],v[60:63],a[52:55],v[76:79]
s_add_u32 m0,s41,3072
s_add_u32 s42,s42,s29
v_lshl_add_u32 v8,v4,9,v8
v_mfma_f32_16x16x32_bf16 v[84:87],v[60:63],a[56:59],v[84:87]
v_and_b32 v5,1,v5
v_lshl_add_u32 v8,v5,3,v8
v_add_u32 v8,v17,v8
v_mfma_f32_16x16x32_bf16 v[92:95],v[60:63],a[60:63],v[92:95]
v_cndmask_b32 v8,v8,v18,vcc
v_add_u32_e64 v234,v3,v8
s_waitcnt lgkmcnt(4)
v_mfma_f32_16x16x32_bf16 v[64:67],v[32:35],a[64:67],v[64:67]
ds_read_b64_tr_b16 v[48:49],v176 offset:12288
v_cndmask_b32 v4,v7,v6,vcc
v_add_u32 v235,v234,v4
v_mfma_f32_16x16x32_bf16 v[72:75],v[32:35],a[68:71],v[72:75]
ds_read_b64_tr_b16 v[50:51],v176 offset:12544
v_mul_f32 v96,s35,v96
v_mul_f32 v97,s35,v97
v_mfma_f32_16x16x32_bf16 v[80:83],v[32:35],a[72:75],v[80:83]
ds_read_b64_tr_b16 v[52:53],v177 offset:12288
v_mul_f32 v98,s35,v98
v_mul_f32 v99,s35,v99
v_mfma_f32_16x16x32_bf16 v[88:91],v[32:35],a[76:79],v[88:91]
ds_read_b64_tr_b16 v[54:55],v177 offset:12544
v_mul_f32 v100,s35,v100
v_mul_f32 v101,s35,v101
v_mfma_f32_16x16x32_bf16 v[68:71],v[36:39],a[64:67],v[68:71]
buffer_load_dwordx4 v16,s[12:15],s42 offen lds
v_mfma_f32_16x16x32_bf16 v[76:79],v[36:39],a[68:71],v[76:79]
s_add_u32 m0,s41,4096
s_add_u32 s42,s42,s29
v_mul_f32 v102,s35,v102
v_mfma_f32_16x16x32_bf16 v[84:87],v[36:39],a[72:75],v[84:87]
v_mul_f32 v103,s35,v103
v_mul_f32 v104,s35,v104
v_mul_f32_e64 v105,s35,v105
v_mfma_f32_16x16x32_bf16 v[92:95],v[36:39],a[76:79],v[92:95]
v_mul_f32 v106,s35,v106
v_mul_f32_e64 v107,s35,v107
s_waitcnt lgkmcnt(4)
v_mfma_f32_16x16x32_bf16 v[64:67],v[40:43],a[80:83],v[64:67]
ds_read_b64_tr_b16 v[56:57],v176 offset:14336
v_mul_f32 v108,s35,v108
v_mul_f32 v109,s35,v109
v_mfma_f32_16x16x32_bf16 v[72:75],v[40:43],a[84:87],v[72:75]
ds_read_b64_tr_b16 v[58:59],v176 offset:14592
v_mul_f32 v110,s35,v110
v_mul_f32 v111,s35,v111
v_mfma_f32_16x16x32_bf16 v[80:83],v[40:43],a[88:91],v[80:83]
ds_read_b64_tr_b16 v[60:61],v177 offset:14336
v_mul_f32 v112,s35,v112
v_mul_f32 v113,s35,v113
v_mfma_f32_16x16x32_bf16 v[88:91],v[40:43],a[92:95],v[88:91]
ds_read_b64_tr_b16 v[62:63],v177 offset:14592
v_mul_f32 v114,s35,v114
v_mul_f32 v115,s35,v115
v_mfma_f32_16x16x32_bf16 v[68:71],v[44:47],a[80:83],v[68:71]
buffer_load_dwordx4 v16,s[12:15],s42 offen lds
v_mfma_f32_16x16x32_bf16 v[76:79],v[44:47],a[84:87],v[76:79]
s_add_u32 m0,s41,5120
s_add_u32 s42,s42,s29
v_mul_f32 v116,s35,v116
v_mfma_f32_16x16x32_bf16 v[84:87],v[44:47],a[88:91],v[84:87]
v_mul_f32 v117,s35,v117
v_mul_f32 v118,s35,v118
v_mul_f32_e64 v119,s35,v119
v_mfma_f32_16x16x32_bf16 v[92:95],v[44:47],a[92:95],v[92:95]
v_mul_f32 v120,s35,v120
v_mul_f32_e64 v121,s35,v121
s_waitcnt lgkmcnt(4)
v_mfma_f32_16x16x32_bf16 v[64:67],v[48:51],a[96:99],v[64:67]
ds_read_b64_tr_b16 v[32:33],v176 offset:16384
v_mul_f32 v122,s35,v122
v_mul_f32 v123,s35,v123
v_mfma_f32_16x16x32_bf16 v[72:75],v[48:51],a[100:103],v[72:75]
ds_read_b64_tr_b16 v[34:35],v176 offset:16640
v_mul_f32 v124,s35,v124
v_mul_f32 v125,s35,v125
v_mfma_f32_16x16x32_bf16 v[80:83],v[48:51],a[104:107],v[80:83]
ds_read_b64_tr_b16 v[36:37],v177 offset:16384
v_mul_f32 v126,s35,v126
v_mul_f32 v127,s35,v127
v_mfma_f32_16x16x32_bf16 v[88:91],v[48:51],a[108:111],v[88:91]
ds_read_b64_tr_b16 v[38:39],v177 offset:16640
v_cvt_pk_bf16_f32 v128,v96,v97
v_cvt_pk_bf16_f32 v129,v98,v99
v_mfma_f32_16x16x32_bf16 v[68:71],v[52:55],a[96:99],v[68:71]
buffer_load_dwordx4 v16,s[12:15],s42 offen lds
v_mfma_f32_16x16x32_bf16 v[76:79],v[52:55],a[100:103],v[76:79]
s_add_u32 m0,s41,6144
s_add_u32 s42,s42,s29
v_cvt_pk_bf16_f32 v130,v100,v101
v_mfma_f32_16x16x32_bf16 v[84:87],v[52:55],a[104:107],v[84:87]
v_cvt_pk_bf16_f32 v131,v102,v103
v_cvt_pk_bf16_f32 v132,v104,v105
v_cvt_pk_bf16_f32 v133,v106,v107
v_mfma_f32_16x16x32_bf16 v[92:95],v[52:55],a[108:111],v[92:95]
v_cvt_pk_bf16_f32 v134,v108,v109
v_cvt_pk_bf16_f32 v135,v110,v111
s_waitcnt lgkmcnt(4)
v_mfma_f32_16x16x32_bf16 v[64:67],v[56:59],a[112:115],v[64:67]
ds_read_b64_tr_b16 v[40:41],v176 offset:18432
v_cvt_pk_bf16_f32 v136,v112,v113
v_cvt_pk_bf16_f32 v137,v114,v115
v_mfma_f32_16x16x32_bf16 v[72:75],v[56:59],a[116:119],v[72:75]
ds_read_b64_tr_b16 v[42:43],v176 offset:18688
v_cvt_pk_bf16_f32 v138,v116,v117
v_cvt_pk_bf16_f32 v139,v118,v119
v_mfma_f32_16x16x32_bf16 v[80:83],v[56:59],a[120:123],v[80:83]
ds_read_b64_tr_b16 v[44:45],v177 offset:18432
v_cvt_pk_bf16_f32 v140,v120,v121
v_cvt_pk_bf16_f32 v141,v122,v123
v_mfma_f32_16x16x32_bf16 v[88:91],v[56:59],a[124:127],v[88:91]
ds_read_b64_tr_b16 v[46:47],v177 offset:18688
v_cvt_pk_bf16_f32 v142,v124,v125
v_cvt_pk_bf16_f32 v143,v126,v127
v_mfma_f32_16x16x32_bf16 v[68:71],v[60:63],a[112:115],v[68:71]
buffer_load_dwordx4 v16,s[12:15],s42 offen lds
v_mfma_f32_16x16x32_bf16 v[76:79],v[60:63],a[116:119],v[76:79]
s_add_u32 m0,s41,7168
s_add_u32 s42,s42,s29
v_mfma_f32_16x16x32_bf16 v[84:87],v[60:63],a[120:123],v[84:87]
s_nop 0
v_mfma_f32_16x16x32_bf16 v[92:95],v[60:63],a[124:127],v[92:95]
s_waitcnt lgkmcnt(4)
s_nop 0
v_mfma_f32_16x16x32_bf16 v[64:67],v[32:35],a[128:131],v[64:67]
ds_read_b64_tr_b16 v[48:49],v176 offset:20480
v_mfma_f32_16x16x32_bf16 v[72:75],v[32:35],a[132:135],v[72:75]
ds_read_b64_tr_b16 v[50:51],v176 offset:20736
v_mfma_f32_16x16x32_bf16 v[80:83],v[32:35],a[136:139],v[80:83]
ds_read_b64_tr_b16 v[52:53],v177 offset:20480
v_mfma_f32_16x16x32_bf16 v[88:91],v[32:35],a[140:143],v[88:91]
ds_read_b64_tr_b16 v[54:55],v177 offset:20736
v_mfma_f32_16x16x32_bf16 v[68:71],v[36:39],a[128:131],v[68:71]
buffer_load_dwordx4 v16,s[12:15],s42 offen lds
v_mfma_f32_16x16x32_bf16 v[76:79],v[36:39],a[132:135],v[76:79]
s_add_u32 m0,s41,8192
s_add_u32 s42,s42,s29
v_mfma_f32_16x16x32_bf16 v[84:87],v[36:39],a[136:139],v[84:87]
s_nop 0
v_mfma_f32_16x16x32_bf16 v[92:95],v[36:39],a[140:143],v[92:95]
s_waitcnt lgkmcnt(4)
s_nop 0
v_mfma_f32_16x16x32_bf16 v[64:67],v[40:43],a[144:147],v[64:67]
ds_read_b64_tr_b16 v[56:57],v176 offset:22528
v_mfma_f32_16x16x32_bf16 v[72:75],v[40:43],a[148:151],v[72:75]
ds_read_b64_tr_b16 v[58:59],v176 offset:22784
v_mfma_f32_16x16x32_bf16 v[80:83],v[40:43],a[152:155],v[80:83]
ds_read_b64_tr_b16 v[60:61],v177 offset:22528
v_mfma_f32_16x16x32_bf16 v[88:91],v[40:43],a[156:159],v[88:91]
ds_read_b64_tr_b16 v[62:63],v177 offset:22784
v_mfma_f32_16x16x32_bf16 v[68:71],v[44:47],a[144:147],v[68:71]
buffer_load_dwordx4 v16,s[12:15],s42 offen lds
v_mfma_f32_16x16x32_bf16 v[76:79],v[44:47],a[148:151],v[76:79]
s_add_u32 s41,s41,36864
s_sub_u32 s36,s41,147456
s_cmp_ge_u32 s41,147456
s_cselect_b32 s41,s36,s41
v_mfma_f32_16x16x32_bf16 v[84:87],v[44:47],a[152:155],v[84:87]
s_add_u32 s93,s93,s81
v_mfma_f32_16x16x32_bf16 v[92:95],v[44:47],a[156:159],v[92:95]
s_waitcnt lgkmcnt(4)
s_nop 0
v_mfma_f32_16x16x32_bf16 v[64:67],v[48:51],a[160:163],v[64:67]
ds_read_b64_tr_b16 v[32:33],v176 offset:24576
v_mfma_f32_16x16x32_bf16 v[72:75],v[48:51],a[164:167],v[72:75]
ds_read_b64_tr_b16 v[34:35],v176 offset:24832
v_mfma_f32_16x16x32_bf16 v[80:83],v[48:51],a[168:171],v[80:83]
ds_read_b64_tr_b16 v[36:37],v177 offset:24576
v_mfma_f32_16x16x32_bf16 v[88:91],v[48:51],a[172:175],v[88:91]
ds_read_b64_tr_b16 v[38:39],v177 offset:24832
v_mfma_f32_16x16x32_bf16 v[68:71],v[52:55],a[160:163],v[68:71]
buffer_load_dwordx4 v[180:183],v30,s[84:87],s93 offen
v_mfma_f32_16x16x32_bf16 v[76:79],v[52:55],a[164:167],v[76:79]
s_add_u32 s93,s93,s94
s_nop 0
v_mfma_f32_16x16x32_bf16 v[84:87],v[52:55],a[168:171],v[84:87]
buffer_load_dwordx4 v[184:187],v30,s[84:87],s93 offen
v_mfma_f32_16x16x32_bf16 v[92:95],v[52:55],a[172:175],v[92:95]
s_add_u32 s93,s93,s94
s_waitcnt lgkmcnt(4)
v_mfma_f32_16x16x32_bf16 v[64:67],v[56:59],a[176:179],v[64:67]
ds_read_b64_tr_b16 v[40:41],v176 offset:26624
v_mfma_f32_16x16x32_bf16 v[72:75],v[56:59],a[180:183],v[72:75]
ds_read_b64_tr_b16 v[42:43],v176 offset:26880
v_mfma_f32_16x16x32_bf16 v[80:83],v[56:59],a[184:187],v[80:83]
ds_read_b64_tr_b16 v[44:45],v177 offset:26624
v_mfma_f32_16x16x32_bf16 v[88:91],v[56:59],a[188:191],v[88:91]
ds_read_b64_tr_b16 v[46:47],v177 offset:26880
v_mfma_f32_16x16x32_bf16 v[68:71],v[60:63],a[176:179],v[68:71]
buffer_load_dwordx4 v[188:191],v30,s[84:87],s93 offen
v_mfma_f32_16x16x32_bf16 v[76:79],v[60:63],a[180:183],v[76:79]
v_mfma_f32_16x16x32_bf16 v[84:87],v[60:63],a[184:187],v[84:87]
buffer_store_dwordx2 v[128:129],v232,s[20:23],s32 offen sc1
v_mfma_f32_16x16x32_bf16 v[92:95],v[60:63],a[188:191],v[92:95]
s_waitcnt lgkmcnt(4)
s_nop 0
v_mfma_f32_16x16x32_bf16 v[64:67],v[32:35],a[192:195],v[64:67]
ds_read_b64_tr_b16 v[48:49],v176 offset:28672
buffer_store_dwordx2 v[132:133],v233,s[20:23],s32 offen sc1
v_mfma_f32_16x16x32_bf16 v[72:75],v[32:35],a[196:199],v[72:75]
ds_read_b64_tr_b16 v[50:51],v176 offset:28928
v_mfma_f32_16x16x32_bf16 v[80:83],v[32:35],a[200:203],v[80:83]
ds_read_b64_tr_b16 v[52:53],v177 offset:28672
buffer_store_dwordx2 v[136:137],v232,s[20:23],s43 offen sc1
v_mfma_f32_16x16x32_bf16 v[88:91],v[32:35],a[204:207],v[88:91]
ds_read_b64_tr_b16 v[54:55],v177 offset:28928
v_mfma_f32_16x16x32_bf16 v[68:71],v[36:39],a[192:195],v[68:71]
buffer_store_dwordx2 v[140:141],v233,s[20:23],s43 offen sc1
v_mfma_f32_16x16x32_bf16 v[76:79],v[36:39],a[196:199],v[76:79]
v_mfma_f32_16x16x32_bf16 v[84:87],v[36:39],a[200:203],v[84:87]
buffer_store_dwordx2 v[130:131],v234,s[20:23],s32 offen sc1
v_mfma_f32_16x16x32_bf16 v[92:95],v[36:39],a[204:207],v[92:95]
s_waitcnt lgkmcnt(4)
s_nop 0
v_mfma_f32_16x16x32_bf16 v[64:67],v[40:43],a[208:211],v[64:67]
ds_read_b64_tr_b16 v[56:57],v176 offset:30720
buffer_store_dwordx2 v[134:135],v235,s[20:23],s32 offen sc1
v_mfma_f32_16x16x32_bf16 v[72:75],v[40:43],a[212:215],v[72:75]
ds_read_b64_tr_b16 v[58:59],v176 offset:30976
s_add_u32 s40,s40,36864
s_cmp_ge_u32 s40,147456
s_cselect_b32 s40,0,s40
v_mfma_f32_16x16x32_bf16 v[80:83],v[40:43],a[216:219],v[80:83]
ds_read_b64_tr_b16 v[60:61],v177 offset:30720
buffer_store_dwordx2 v[138:139],v234,s[20:23],s43 offen sc1
v_mfma_f32_16x16x32_bf16 v[88:91],v[40:43],a[220:223],v[88:91]
ds_read_b64_tr_b16 v[62:63],v177 offset:30976
v_add_u32_e64 v178,s40,v19
v_xor_b32 v179,32,v178
v_mfma_f32_16x16x32_bf16 v[68:71],v[44:47],a[208:211],v[68:71]
buffer_store_dwordx2 v[142:143],v235,s[20:23],s43 offen sc1
v_mfma_f32_16x16x32_bf16 v[76:79],v[44:47],a[212:215],v[76:79]
v_mfma_f32_16x16x32_bf16 v[84:87],v[44:47],a[216:219],v[84:87]
v_mfma_f32_16x16x32_bf16 v[92:95],v[44:47],a[220:223],v[92:95]
s_waitcnt lgkmcnt(4)
s_nop 0
v_mfma_f32_16x16x32_bf16 v[64:67],v[48:51],a[224:227],v[64:67]
ds_read_b64_tr_b16 v[32:33],v176 offset:32768
v_mfma_f32_16x16x32_bf16 v[72:75],v[48:51],a[228:231],v[72:75]
ds_read_b64_tr_b16 v[34:35],v176 offset:33024
v_mfma_f32_16x16x32_bf16 v[80:83],v[48:51],a[232:235],v[80:83]
ds_read_b64_tr_b16 v[36:37],v177 offset:32768
v_mfma_f32_16x16x32_bf16 v[88:91],v[48:51],a[236:239],v[88:91]
ds_read_b64_tr_b16 v[38:39],v177 offset:33024
v_mfma_f32_16x16x32_bf16 v[68:71],v[52:55],a[224:227],v[68:71]
v_mfma_f32_16x16x32_bf16 v[76:79],v[52:55],a[228:231],v[76:79]
v_mfma_f32_16x16x32_bf16 v[84:87],v[52:55],a[232:235],v[84:87]
v_mfma_f32_16x16x32_bf16 v[92:95],v[52:55],a[236:239],v[92:95]
s_waitcnt lgkmcnt(4)
s_nop 0
v_mfma_f32_16x16x32_bf16 v[64:67],v[56:59],a[240:243],v[64:67]
ds_read_b64_tr_b16 v[40:41],v176 offset:34816
v_mfma_f32_16x16x32_bf16 v[72:75],v[56:59],a[244:247],v[72:75]
ds_read_b64_tr_b16 v[42:43],v176 offset:35072
v_mfma_f32_16x16x32_bf16 v[80:83],v[56:59],a[248:251],v[80:83]
ds_read_b64_tr_b16 v[44:45],v177 offset:34816
v_mfma_f32_16x16x32_bf16 v[88:91],v[56:59],a[252:255],v[88:91]
ds_read_b64_tr_b16 v[46:47],v177 offset:35072
v_mfma_f32_16x16x32_bf16 v[68:71],v[60:63],a[240:243],v[68:71]
v_mfma_f32_16x16x32_bf16 v[76:79],v[60:63],a[244:247],v[76:79]
v_mfma_f32_16x16x32_bf16 v[84:87],v[60:63],a[248:251],v[84:87]
v_mfma_f32_16x16x32_bf16 v[92:95],v[60:63],a[252:255],v[92:95]
s_waitcnt lgkmcnt(4)
s_nop 0
v_mfma_f32_16x16x32_bf16 v[64:67],v[32:35],v[144:147],v[64:67]
s_waitcnt vmcnt(31)
s_barrier
ds_read_b64_tr_b16 v[48:49],v178 offset:0
v_mfma_f32_16x16x32_bf16 v[72:75],v[32:35],v[148:151],v[72:75]
ds_read_b64_tr_b16 v[50:51],v178 offset:256
v_mfma_f32_16x16x32_bf16 v[80:83],v[32:35],v[152:155],v[80:83]
ds_read_b64_tr_b16 v[52:53],v179 offset:0
v_mfma_f32_16x16x32_bf16 v[88:91],v[32:35],v[156:159],v[88:91]
ds_read_b64_tr_b16 v[54:55],v179 offset:256
v_mfma_f32_16x16x32_bf16 v[68:71],v[36:39],v[144:147],v[68:71]
v_mfma_f32_16x16x32_bf16 v[76:79],v[36:39],v[148:151],v[76:79]
v_mfma_f32_16x16x32_bf16 v[84:87],v[36:39],v[152:155],v[84:87]
v_mfma_f32_16x16x32_bf16 v[92:95],v[36:39],v[156:159],v[92:95]
s_waitcnt lgkmcnt(4)
s_nop 0
v_mfma_f32_16x16x32_bf16 v[64:67],v[40:43],v[160:163],v[64:67]
ds_read_b64_tr_b16 v[56:57],v178 offset:2048
v_mfma_f32_16x16x32_bf16 v[72:75],v[40:43],v[164:167],v[72:75]
ds_read_b64_tr_b16 v[58:59],v178 offset:2304
v_mfma_f32_16x16x32_bf16 v[80:83],v[40:43],v[168:171],v[80:83]
ds_read_b64_tr_b16 v[60:61],v179 offset:2048
v_mfma_f32_16x16x32_bf16 v[88:91],v[40:43],v[172:175],v[88:91]
ds_read_b64_tr_b16 v[62:63],v179 offset:2304
v_mfma_f32_16x16x32_bf16 v[68:71],v[44:47],v[160:163],v[68:71]
v_mfma_f32_16x16x32_bf16 v[76:79],v[44:47],v[164:167],v[76:79]
v_mfma_f32_16x16x32_bf16 v[84:87],v[44:47],v[168:171],v[84:87]
v_mfma_f32_16x16x32_bf16 v[92:95],v[44:47],v[172:175],v[92:95]
s_add_u32 s27,s27,1
s_cmp_lt_u32 s27,s28
s_cbranch_scc1 k1_S576_l1
s_waitcnt lgkmcnt(0)
s_nop 7
s_sub_u32 s37,s27,1
s_cmp_lt_u32 s37,18
s_cselect_b32 s35,s96,1.0
s_lshl_b32 s37,s37,3
v_lshrrev_b32 v2,4,v1
v_add_u32_e64 v2,s37,v2
v_mul_u32_u24 v3,7282,v2
v_lshrrev_b32 v3,16,v3
v_mul_u32_u24 v4,9,v3
v_sub_u32 v4,v2,v4
v_cmp_lt_u32 vcc,4,v4
v_lshlrev_b32 v3,19,v3
v_subrev_u32 v5,5,v4
v_cndmask_b32 v8,0,v9,vcc
v_cndmask_b32 v5,v4,v5,vcc
v_cmp_eq_u32 vcc,4,v4
v_lshrrev_b32 v4,1,v5
v_lshl_add_u32 v8,v4,9,v8
v_and_b32 v5,1,v5
v_lshl_add_u32 v8,v5,3,v8
v_add_u32 v8,v17,v8
v_cndmask_b32 v8,v8,v18,vcc
v_add_u32 v232,v3,v8
v_cndmask_b32 v4,v7,v6,vcc
v_add_u32 v233,v232,v4
v_add_u32_e64 v2,4,v2
v_mul_u32_u24 v3,7282,v2
v_lshrrev_b32 v3,16,v3
v_mul_u32_u24 v4,9,v3
v_sub_u32 v4,v2,v4
v_cmp_lt_u32 vcc,4,v4
v_lshlrev_b32 v3,19,v3
v_subrev_u32 v5,5,v4
v_cndmask_b32 v8,0,v9,vcc
v_cndmask_b32 v5,v4,v5,vcc
v_cmp_eq_u32 vcc,4,v4
v_lshrrev_b32 v4,1,v5
v_lshl_add_u32 v8,v4,9,v8
v_and_b32 v5,1,v5
v_lshl_add_u32 v8,v5,3,v8
v_add_u32 v8,v17,v8
v_cndmask_b32 v8,v8,v18,vcc
v_add_u32 v234,v3,v8
v_cndmask_b32 v4,v7,v6,vcc
v_add_u32 v235,v234,v4
v_mul_f32 v64,s35,v64
v_mul_f32 v65,s35,v65
v_mul_f32 v66,s35,v66
v_mul_f32 v67,s35,v67
v_mul_f32 v68,s35,v68
v_mul_f32 v69,s35,v69
v_mul_f32 v70,s35,v70
v_mul_f32 v71,s35,v71
v_mul_f32 v72,s35,v72
v_mul_f32 v73,s35,v73
v_mul_f32 v74,s35,v74
v_mul_f32 v75,s35,v75
v_mul_f32 v76,s35,v76
v_mul_f32 v77,s35,v77
v_mul_f32 v78,s35,v78
v_mul_f32 v79,s35,v79
v_mul_f32 v80,s35,v80
v_mul_f32 v81,s35,v81
v_mul_f32 v82,s35,v82
v_mul_f32 v83,s35,v83
v_mul_f32 v84,s35,v84
v_mul_f32 v85,s35,v85
v_mul_f32 v86,s35,v86
v_mul_f32 v87,s35,v87
v_mul_f32 v88,s35,v88
v_mul_f32 v89,s35,v89
v_mul_f32 v90,s35,v90
v_mul_f32 v91,s35,v91
v_mul_f32 v92,s35,v92
v_mul_f32 v93,s35,v93
v_mul_f32 v94,s35,v94
v_mul_f32 v95,s35,v95
v_cvt_pk_bf16_f32 v128,v64,v65
v_cvt_pk_bf16_f32 v129,v66,v67
v_cvt_pk_bf16_f32 v130,v68,v69
v_cvt_pk_bf16_f32 v131,v70,v71
v_cvt_pk_bf16_f32 v132,v72,v73
v_cvt_pk_bf16_f32 v133,v74,v75
v_cvt_pk_bf16_f32 v134,v76,v77
v_cvt_pk_bf16_f32 v135,v78,v79
v_cvt_pk_bf16_f32 v136,v80,v81
v_cvt_pk_bf16_f32 v137,v82,v83
v_cvt_pk_bf16_f32 v138,v84,v85
v_cvt_pk_bf16_f32 v139,v86,v87
v_cvt_pk_bf16_f32 v140,v88,v89
v_cvt_pk_bf16_f32 v141,v90,v91
v_cvt_pk_bf16_f32 v142,v92,v93
v_cvt_pk_bf16_f32 v143,v94,v95
buffer_store_dwordx2 v[128:129],v232,s[20:23],s32 offen sc1
buffer_store_dwordx2 v[132:133],v233,s[20:23],s32 offen sc1
buffer_store_dwordx2 v[136:137],v232,s[20:23],s43 offen sc1
buffer_store_dwordx2 v[140:141],v233,s[20:23],s43 offen sc1
buffer_store_dwordx2 v[130:131],v234,s[20:23],s32 offen sc1
buffer_store_dwordx2 v[134:135],v235,s[20:23],s32 offen sc1
buffer_store_dwordx2 v[138:139],v234,s[20:23],s43 offen sc1
buffer_store_dwordx2 v[142:143],v235,s[20:23],s43 offen sc1
s_branch k1_house
k1_S576_t1:
s_waitcnt lgkmcnt(0)
s_nop 7
s_sub_u32 s37,s27,1
s_cmp_lt_u32 s37,18
s_cselect_b32 s35,s96,1.0
s_lshl_b32 s37,s37,3
v_lshrrev_b32 v2,4,v1
v_add_u32_e64 v2,s37,v2
v_mul_u32_u24 v3,7282,v2
v_lshrrev_b32 v3,16,v3
v_mul_u32_u24 v4,9,v3
v_sub_u32 v4,v2,v4
v_cmp_lt_u32 vcc,4,v4
v_lshlrev_b32 v3,19,v3
v_subrev_u32 v5,5,v4
v_cndmask_b32 v8,0,v9,vcc
v_cndmask_b32 v5,v4,v5,vcc
v_cmp_eq_u32 vcc,4,v4
v_lshrrev_b32 v4,1,v5
v_lshl_add_u32 v8,v4,9,v8
v_and_b32 v5,1,v5
v_lshl_add_u32 v8,v5,3,v8
v_add_u32 v8,v17,v8
v_cndmask_b32 v8,v8,v18,vcc
v_add_u32 v232,v3,v8
v_cndmask_b32 v4,v7,v6,vcc
v_add_u32 v233,v232,v4
v_add_u32_e64 v2,4,v2
v_mul_u32_u24 v3,7282,v2
v_lshrrev_b32 v3,16,v3
v_mul_u32_u24 v4,9,v3
v_sub_u32 v4,v2,v4
v_cmp_lt_u32 vcc,4,v4
v_lshlrev_b32 v3,19,v3
v_subrev_u32 v5,5,v4
v_cndmask_b32 v8,0,v9,vcc
v_cndmask_b32 v5,v4,v5,vcc
v_cmp_eq_u32 vcc,4,v4
v_lshrrev_b32 v4,1,v5
v_lshl_add_u32 v8,v4,9,v8
v_and_b32 v5,1,v5
v_lshl_add_u32 v8,v5,3,v8
v_add_u32 v8,v17,v8
v_cndmask_b32 v8,v8,v18,vcc
v_add_u32 v234,v3,v8
v_cndmask_b32 v4,v7,v6,vcc
v_add_u32 v235,v234,v4
v_mul_f32 v96,s35,v96
v_mul_f32 v97,s35,v97
v_mul_f32 v98,s35,v98
v_mul_f32 v99,s35,v99
v_mul_f32 v100,s35,v100
v_mul_f32 v101,s35,v101
v_mul_f32 v102,s35,v102
v_mul_f32 v103,s35,v103
v_mul_f32 v104,s35,v104
v_mul_f32 v105,s35,v105
v_mul_f32 v106,s35,v106
v_mul_f32 v107,s35,v107
v_mul_f32 v108,s35,v108
v_mul_f32 v109,s35,v109
v_mul_f32 v110,s35,v110
v_mul_f32 v111,s35,v111
v_mul_f32 v112,s35,v112
v_mul_f32 v113,s35,v113
v_mul_f32 v114,s35,v114
v_mul_f32 v115,s35,v115
v_mul_f32 v116,s35,v116
v_mul_f32 v117,s35,v117
v_mul_f32 v118,s35,v118
v_mul_f32 v119,s35,v119
v_mul_f32 v120,s35,v120
v_mul_f32 v121,s35,v121
v_mul_f32 v122,s35,v122
v_mul_f32 v123,s35,v123
v_mul_f32 v124,s35,v124
v_mul_f32 v125,s35,v125
v_mul_f32 v126,s35,v126
v_mul_f32 v127,s35,v127
v_cvt_pk_bf16_f32 v128,v96,v97
v_cvt_pk_bf16_f32 v129,v98,v99
v_cvt_pk_bf16_f32 v130,v100,v101
v_cvt_pk_bf16_f32 v131,v102,v103
v_cvt_pk_bf16_f32 v132,v104,v105
v_cvt_pk_bf16_f32 v133,v106,v107
v_cvt_pk_bf16_f32 v134,v108,v109
v_cvt_pk_bf16_f32 v135,v110,v111
v_cvt_pk_bf16_f32 v136,v112,v113
v_cvt_pk_bf16_f32 v137,v114,v115
v_cvt_pk_bf16_f32 v138,v116,v117
v_cvt_pk_bf16_f32 v139,v118,v119
v_cvt_pk_bf16_f32 v140,v120,v121
v_cvt_pk_bf16_f32 v141,v122,v123
v_cvt_pk_bf16_f32 v142,v124,v125
v_cvt_pk_bf16_f32 v143,v126,v127
buffer_store_dwordx2 v[128:129],v232,s[20:23],s32 offen sc1
buffer_store_dwordx2 v[132:133],v233,s[20:23],s32 offen sc1
buffer_store_dwordx2 v[136:137],v232,s[20:23],s43 offen sc1
buffer_store_dwordx2 v[140:141],v233,s[20:23],s43 offen sc1
buffer_store_dwordx2 v[130:131],v234,s[20:23],s32 offen sc1
buffer_store_dwordx2 v[134:135],v235,s[20:23],s32 offen sc1
buffer_store_dwordx2 v[138:139],v234,s[20:23],s43 offen sc1
buffer_store_dwordx2 v[142:143],v235,s[20:23],s43 offen sc1
s_branch k1_house
k1_typeAV:
s_sub_u32 s36,s48,4
s_mul_i32 s27,s36,9
s_mov_b32 s47,s27
s_mov_b32 s76,2304
s_add_u32 s30,s30,2304
s_add_u32 s28,s27,9
s_lshl_b32 s32,s49,12
s_add_u32 s32,s32,104858624
v_and_b32 v2,15,v1
v_lshlrev_b32 v2,4,v2
v_bfe_u32 v3,v1,4,1
v_lshrrev_b32 v4,5,v1
v_lshlrev_b32 v3,9,v3
v_lshl_add_u32 v9,v4,10,v3
v_add_u32_e64 v20,v2,v9
v_add_u32 v21,256,v20
v_add_u32 v22,4096,v20
v_add_u32 v23,4096,v21
s_waitcnt lgkmcnt(0)
s_mov_b32 s12,s54
s_mov_b32 s13,s55
s_mov_b32 s14,1990656
s_mov_b32 s15,0x20000
s_mov_b32 s8,s52
s_mov_b32 s9,s53
s_mov_b32 s10,2359296
s_mov_b32 s11,0x20000
s_mov_b32 s16,s74
s_mov_b32 s17,s75
s_mov_b32 s18,268435456
s_mov_b32 s19,0x20000
s_mov_b32 s20,s74
s_mov_b32 s21,s75
s_mov_b32 s22,268435456
s_mov_b32 s23,0x20000
k1_N576:
s_mul_i32 s39,s24,16384
s_add_u32 s39,s39,73728
s_add_u32 s42,s47,s78
s_and_b32 s42,s42,s80
s_or_b32 s42,s42,s79
s_mul_i32 s42,s42,s31
s_add_u32 s42,s42,s30
s_cmp_lt_u32 s47,s28
s_cselect_b32 s14,s44,0
s_add_u32 s47,s47,1
s_add_u32 m0,s41,0
s_nop 0
buffer_load_dwordx4 v16,s[12:15],s42 offen lds
s_add_u32 m0,s41,1024
s_add_u32 s42,s42,s29
buffer_load_dwordx4 v16,s[12:15],s42 offen lds
s_add_u32 m0,s41,2048
s_add_u32 s42,s42,s29
buffer_load_dwordx4 v16,s[12:15],s42 offen lds
s_add_u32 m0,s41,3072
s_add_u32 s42,s42,s29
buffer_load_dwordx4 v16,s[12:15],s42 offen lds
s_add_u32 m0,s41,4096
s_add_u32 s42,s42,s29
buffer_load_dwordx4 v16,s[12:15],s42 offen lds
s_add_u32 m0,s41,5120
s_add_u32 s42,s42,s29
buffer_load_dwordx4 v16,s[12:15],s42 offen lds
s_add_u32 m0,s41,6144
s_add_u32 s42,s42,s29
buffer_load_dwordx4 v16,s[12:15],s42 offen lds
s_add_u32 m0,s41,7168
s_add_u32 s42,s42,s29
buffer_load_dwordx4 v16,s[12:15],s42 offen lds
s_add_u32 m0,s41,8192
s_add_u32 s42,s42,s29
buffer_load_dwordx4 v16,s[12:15],s42 offen lds
s_add_u32 s41,s41,36864
s_sub_u32 s36,s41,147456
s_cmp_ge_u32 s41,147456
s_cselect_b32 s41,s36,s41
s_lshr_b32 s37,s2,3
s_and_b32 s37,s37,7
s_lshl_b32 s37,s37,2
s_add_u32 s37,s37,s24
s_lshl_b32 s38,s25,5
s_add_u32 s37,s37,s38
s_mul_i32 s37,s37,9216
v_lshlrev_b32 v2,4,v1
buffer_load_dwordx4 v[180:183],v2,s[8:11],s37 offen offset:0
buffer_load_dwordx4 v[184:187],v2,s[8:11],s37 offen offset:1024
buffer_load_dwordx4 v[188:191],v2,s[8:11],s37 offen offset:2048
buffer_load_dwordx4 v[192:195],v2,s[8:11],s37 offen offset:3072
s_add_u32 s37,s37,4096
buffer_load_dwordx4 v[196:199],v2,s[8:11],s37 offen offset:0
buffer_load_dwordx4 v[200:203],v2,s[8:11],s37 offen offset:1024
buffer_load_dwordx4 v[204:207],v2,s[8:11],s37 offen offset:2048
buffer_load_dwordx4 v[208:211],v2,s[8:11],s37 offen offset:3072
s_add_u32 s37,s37,4096
buffer_load_dwordx4 v[212:215],v2,s[8:11],s37 offen offset:0
s_add_u32 s36,s46,0
s_add_u32 m0,s39,0
s_nop 0
buffer_load_dwordx4 v24,s[8:11],s36 offen lds
s_add_u32 m0,s39,1024
s_add_u32 s36,s36,s45
buffer_load_dwordx4 v25,s[8:11],s36 offen lds
s_add_u32 m0,s39,2048
s_add_u32 s36,s36,s45
buffer_load_dwordx4 v25,s[8:11],s36 offen lds
s_add_u32 m0,s39,3072
s_add_u32 s36,s36,s45
buffer_load_dwordx4 v24,s[8:11],s36 offen lds
s_add_u32 m0,s39,4096
s_add_u32 s36,s36,s45
buffer_load_dwordx4 v24,s[8:11],s36 offen lds
s_add_u32 m0,s39,5120
s_add_u32 s36,s36,s45
buffer_load_dwordx4 v25,s[8:11],s36 offen lds
s_add_u32 m0,s39,6144
s_add_u32 s36,s36,s45
buffer_load_dwordx4 v25,s[8:11],s36 offen lds
s_add_u32 m0,s39,7168
s_add_u32 s36,s36,s45
buffer_load_dwordx4 v24,s[8:11],s36 offen lds
s_add_u32 s36,s46,128
s_add_u32 m0,s39,8192
s_nop 0
buffer_load_dwordx4 v24,s[8:11],s36 offen lds
s_add_u32 m0,s39,9216
s_add_u32 s36,s36,s45
buffer_load_dwordx4 v25,s[8:11],s36 offen lds
s_add_u32 m0,s39,10240
s_add_u32 s36,s36,s45
buffer_load_dwordx4 v25,s[8:11],s36 offen lds
s_add_u32 m0,s39,11264
s_add_u32 s36,s36,s45
buffer_load_dwordx4 v24,s[8:11],s36 offen lds
s_add_u32 m0,s39,12288
s_add_u32 s36,s36,s45
buffer_load_dwordx4 v24,s[8:11],s36 offen lds
s_add_u32 m0,s39,13312
s_add_u32 s36,s36,s45
buffer_load_dwordx4 v25,s[8:11],s36 offen lds
s_add_u32 m0,s39,14336
s_add_u32 s36,s36,s45
buffer_load_dwordx4 v25,s[8:11],s36 offen lds
s_add_u32 m0,s39,15360
s_add_u32 s36,s36,s45
buffer_load_dwordx4 v24,s[8:11],s36 offen lds
v_bfe_u32 v2,v1,3,1
v_lshlrev_b32 v2,10,v2
v_add_u32 v26,v2,v26
v_add_u32 v26,s39,v26
v_xor_b32 v27,64,v26
s_lshr_b32 s81,s29,4
s_lshr_b32 s94,s29,2
s_lshr_b32 s51,s49,1
s_mul_i32 s51,s51,18
s_mul_i32 s51,s51,s81
s_mul_i32 s37,s27,s31
s_add_u32 s51,s51,s37
s_add_u32 s51,s51,s76
s_mov_b32 s84,s12
s_mov_b32 s85,s13
s_mov_b32 s86,s44
s_mov_b32 s87,0x20000
s_sub_u32 s82,s28,s27
s_mul_i32 s82,s82,s31
s_add_u32 s82,s82,-130
s_lshr_b32 s82,s82,8
s_min_u32 s82,s82,2
s_lshl_b32 s37,s78,6
s_lshl_b32 s92,s80,6
s_or_b32 s92,s92,63
s_add_u32 s83,s37,256
v_and_b32 v2,31,v1
v_lshlrev_b32 v2,4,v2
v_add_u32 v2,s37,v2
v_and_b32 v2,s92,v2
v_lshrrev_b32 v3,5,v1
v_mul_lo_u32 v3,v3,s81
v_add_u32 v31,v2,v3
v_and_b32 v2,15,v1
v_lshlrev_b32 v2,4,v2
v_lshrrev_b32 v3,4,v1
v_mul_lo_u32 v3,v3,s81
v_add_u32 v30,v2,v3
v_mov_b32_e64 v176,v19
v_xor_b32 v177,32,v19
s_mov_b32 s40,36864
v_add_u32 v178,s40,v19
v_xor_b32 v179,32,v178
s_lshl_b32 s37,s78,6
s_add_u32 s37,s37,0
s_and_b32 s37,s37,s92
s_add_u32 s93,s51,s37
buffer_load_dwordx4 v[180:183],v30,s[84:87],s93 offen
s_add_u32 s93,s93,s94
buffer_load_dwordx4 v[184:187],v30,s[84:87],s93 offen
s_add_u32 s93,s93,s94
buffer_load_dwordx4 v[188:191],v30,s[84:87],s93 offen
s_add_u32 s93,s93,s94
buffer_load_dwordx4 v[192:195],v30,s[84:87],s93 offen
s_add_u32 s93,s93,s94
buffer_load_dwordx4 v[196:199],v30,s[84:87],s93 offen
s_add_u32 s93,s93,s94
s_waitcnt vmcnt(13)
s_barrier
ds_read_b128 a[0:3],v26 offset:0
ds_read_b128 a[4:7],v27 offset:1024
ds_read_b128 a[8:11],v26 offset:4096
ds_read_b128 a[12:15],v27 offset:5120
ds_read_b128 a[16:19],v27 offset:0
ds_read_b128 a[20:23],v26 offset:1024
ds_read_b128 a[24:27],v27 offset:4096
ds_read_b128 a[28:31],v26 offset:5120
s_waitcnt lgkmcnt(6)
ds_read_b64_tr_b16 v[32:33],v176 offset:0
ds_read_b64_tr_b16 v[34:35],v176 offset:256
ds_read_b64_tr_b16 v[36:37],v177 offset:0
ds_read_b64_tr_b16 v[38:39],v177 offset:256
ds_read_b64_tr_b16 v[40:41],v176 offset:2048
ds_read_b64_tr_b16 v[42:43],v176 offset:2304
ds_read_b64_tr_b16 v[44:45],v177 offset:2048
ds_read_b64_tr_b16 v[46:47],v177 offset:2304
s_waitcnt lgkmcnt(8)
s_add_u32 s36,s46,256
s_add_u32 m0,s39,0
s_nop 0
buffer_load_dwordx4 v24,s[8:11],s36 offen lds
s_add_u32 m0,s39,1024
s_add_u32 s36,s36,s45
buffer_load_dwordx4 v25,s[8:11],s36 offen lds
s_add_u32 m0,s39,2048
s_add_u32 s36,s36,s45
buffer_load_dwordx4 v25,s[8:11],s36 offen lds
s_add_u32 m0,s39,3072
s_add_u32 s36,s36,s45
buffer_load_dwordx4 v24,s[8:11],s36 offen lds
s_add_u32 m0,s39,4096
s_add_u32 s36,s36,s45
buffer_load_dwordx4 v24,s[8:11],s36 offen lds
s_add_u32 m0,s39,5120
s_add_u32 s36,s36,s45
buffer_load_dwordx4 v25,s[8:11],s36 offen lds
s_add_u32 m0,s39,6144
s_add_u32 s36,s36,s45
buffer_load_dwordx4 v25,s[8:11],s36 offen lds
s_add_u32 m0,s39,7168
s_add_u32 s36,s36,s45
buffer_load_dwordx4 v24,s[8:11],s36 offen lds
s_waitcnt lgkmcnt(0)
v_mfma_f32_16x16x32_bf16 v[64:67],a[0:3],v[32:35],0
s_nop 0
v_mfma_f32_16x16x32_bf16 v[72:75],a[4:7],v[32:35],0
v_mfma_f32_16x16x32_bf16 v[80:83],a[8:11],v[32:35],0
v_mfma_f32_16x16x32_bf16 v[88:91],a[12:15],v[32:35],0
v_mfma_f32_16x16x32_bf16 v[68:71],a[0:3],v[36:39],0
v_mfma_f32_16x16x32_bf16 v[76:79],a[4:7],v[36:39],0
v_mfma_f32_16x16x32_bf16 v[84:87],a[8:11],v[36:39],0
v_mfma_f32_16x16x32_bf16 v[92:95],a[12:15],v[36:39],0
v_mfma_f32_16x16x32_bf16 v[64:67],a[16:19],v[40:43],v[64:67]
v_mfma_f32_16x16x32_bf16 v[72:75],a[20:23],v[40:43],v[72:75]
v_mfma_f32_16x16x32_bf16 v[80:83],a[24:27],v[40:43],v[80:83]
v_mfma_f32_16x16x32_bf16 v[88:91],a[28:31],v[40:43],v[88:91]
v_mfma_f32_16x16x32_bf16 v[68:71],a[16:19],v[44:47],v[68:71]
v_mfma_f32_16x16x32_bf16 v[76:79],a[20:23],v[44:47],v[76:79]
v_mfma_f32_16x16x32_bf16 v[84:87],a[24:27],v[44:47],v[84:87]
v_mfma_f32_16x16x32_bf16 v[92:95],a[28:31],v[44:47],v[92:95]
s_waitcnt vmcnt(13)
ds_read_b128 a[32:35],v26 offset:8192
ds_read_b128 a[36:39],v27 offset:9216
ds_read_b128 a[40:43],v26 offset:12288
ds_read_b128 a[44:47],v27 offset:13312
ds_read_b128 a[48:51],v27 offset:8192
ds_read_b128 a[52:55],v26 offset:9216
ds_read_b128 a[56:59],v27 offset:12288
ds_read_b128 a[60:63],v26 offset:13312
s_waitcnt lgkmcnt(6)
ds_read_b64_tr_b16 v[32:33],v176 offset:4096
ds_read_b64_tr_b16 v[34:35],v176 offset:4352
ds_read_b64_tr_b16 v[36:37],v177 offset:4096
ds_read_b64_tr_b16 v[38:39],v177 offset:4352
ds_read_b64_tr_b16 v[40:41],v176 offset:6144
ds_read_b64_tr_b16 v[42:43],v176 offset:6400
ds_read_b64_tr_b16 v[44:45],v177 offset:6144
ds_read_b64_tr_b16 v[46:47],v177 offset:6400
s_waitcnt lgkmcnt(8)
s_add_u32 s36,s46,384
s_add_u32 m0,s39,8192
s_nop 0
buffer_load_dwordx4 v24,s[8:11],s36 offen lds
s_add_u32 m0,s39,9216
s_add_u32 s36,s36,s45
buffer_load_dwordx4 v25,s[8:11],s36 offen lds
s_add_u32 m0,s39,10240
s_add_u32 s36,s36,s45
buffer_load_dwordx4 v25,s[8:11],s36 offen lds
s_add_u32 m0,s39,11264
s_add_u32 s36,s36,s45
buffer_load_dwordx4 v24,s[8:11],s36 offen lds
s_add_u32 m0,s39,12288
s_add_u32 s36,s36,s45
buffer_load_dwordx4 v24,s[8:11],s36 offen lds
s_add_u32 m0,s39,13312
s_add_u32 s36,s36,s45
buffer_load_dwordx4 v25,s[8:11],s36 offen lds
s_add_u32 m0,s39,14336
s_add_u32 s36,s36,s45
buffer_load_dwordx4 v25,s[8:11],s36 offen lds
s_add_u32 m0,s39,15360
s_add_u32 s36,s36,s45
buffer_load_dwordx4 v24,s[8:11],s36 offen lds
s_waitcnt lgkmcnt(0)
v_mfma_f32_16x16x32_bf16 v[64:67],a[32:35],v[32:35],v[64:67]
v_mfma_f32_16x16x32_bf16 v[72:75],a[36:39],v[32:35],v[72:75]
v_mfma_f32_16x16x32_bf16 v[80:83],a[40:43],v[32:35],v[80:83]
v_mfma_f32_16x16x32_bf16 v[88:91],a[44:47],v[32:35],v[88:91]
v_mfma_f32_16x16x32_bf16 v[68:71],a[32:35],v[36:39],v[68:71]
v_mfma_f32_16x16x32_bf16 v[76:79],a[36:39],v[36:39],v[76:79]
v_mfma_f32_16x16x32_bf16 v[84:87],a[40:43],v[36:39],v[84:87]
v_mfma_f32_16x16x32_bf16 v[92:95],a[44:47],v[36:39],v[92:95]
v_mfma_f32_16x16x32_bf16 v[64:67],a[48:51],v[40:43],v[64:67]
v_mfma_f32_16x16x32_bf16 v[72:75],a[52:55],v[40:43],v[72:75]
v_mfma_f32_16x16x32_bf16 v[80:83],a[56:59],v[40:43],v[80:83]
v_mfma_f32_16x16x32_bf16 v[88:91],a[60:63],v[40:43],v[88:91]
v_mfma_f32_16x16x32_bf16 v[68:71],a[48:51],v[44:47],v[68:71]
v_mfma_f32_16x16x32_bf16 v[76:79],a[52:55],v[44:47],v[76:79]
v_mfma_f32_16x16x32_bf16 v[84:87],a[56:59],v[44:47],v[84:87]
v_mfma_f32_16x16x32_bf16 v[92:95],a[60:63],v[44:47],v[92:95]
s_waitcnt vmcnt(8)
ds_read_b128 a[64:67],v26 offset:0
ds_read_b128 a[68:71],v27 offset:1024
ds_read_b128 a[72:75],v26 offset:4096
ds_read_b128 a[76:79],v27 offset:5120
ds_read_b128 a[80:83],v27 offset:0
ds_read_b128 a[84:87],v26 offset:1024
ds_read_b128 a[88:91],v27 offset:4096
ds_read_b128 a[92:95],v26 offset:5120
s_waitcnt lgkmcnt(6)
ds_read_b64_tr_b16 v[32:33],v176 offset:8192
ds_read_b64_tr_b16 v[34:35],v176 offset:8448
ds_read_b64_tr_b16 v[36:37],v177 offset:8192
ds_read_b64_tr_b16 v[38:39],v177 offset:8448
ds_read_b64_tr_b16 v[40:41],v176 offset:10240
ds_read_b64_tr_b16 v[42:43],v176 offset:10496
ds_read_b64_tr_b16 v[44:45],v177 offset:10240
ds_read_b64_tr_b16 v[46:47],v177 offset:10496
s_waitcnt lgkmcnt(8)
s_add_u32 s36,s46,512
s_add_u32 m0,s39,0
s_nop 0
buffer_load_dwordx4 v24,s[8:11],s36 offen lds
s_add_u32 m0,s39,1024
s_add_u32 s36,s36,s45
buffer_load_dwordx4 v25,s[8:11],s36 offen lds
s_add_u32 m0,s39,2048
s_add_u32 s36,s36,s45
buffer_load_dwordx4 v25,s[8:11],s36 offen lds
s_add_u32 m0,s39,3072
s_add_u32 s36,s36,s45
buffer_load_dwordx4 v24,s[8:11],s36 offen lds
s_add_u32 m0,s39,4096
s_add_u32 s36,s36,s45
buffer_load_dwordx4 v24,s[8:11],s36 offen lds
s_add_u32 m0,s39,5120
s_add_u32 s36,s36,s45
buffer_load_dwordx4 v25,s[8:11],s36 offen lds
s_add_u32 m0,s39,6144
s_add_u32 s36,s36,s45
buffer_load_dwordx4 v25,s[8:11],s36 offen lds
s_add_u32 m0,s39,7168
s_add_u32 s36,s36,s45
buffer_load_dwordx4 v24,s[8:11],s36 offen lds
s_waitcnt lgkmcnt(0)
v_mfma_f32_16x16x32_bf16 v[64:67],a[64:67],v[32:35],v[64:67]
s_nop 0
v_mfma_f32_16x16x32_bf16 v[72:75],a[68:71],v[32:35],v[72:75]
v_mfma_f32_16x16x32_bf16 v[80:83],a[72:75],v[32:35],v[80:83]
v_mfma_f32_16x16x32_bf16 v[88:91],a[76:79],v[32:35],v[88:91]
v_mfma_f32_16x16x32_bf16 v[68:71],a[64:67],v[36:39],v[68:71]
v_mfma_f32_16x16x32_bf16 v[76:79],a[68:71],v[36:39],v[76:79]
v_mfma_f32_16x16x32_bf16 v[84:87],a[72:75],v[36:39],v[84:87]
v_mfma_f32_16x16x32_bf16 v[92:95],a[76:79],v[36:39],v[92:95]
v_mfma_f32_16x16x32_bf16 v[64:67],a[80:83],v[40:43],v[64:67]
v_mfma_f32_16x16x32_bf16 v[72:75],a[84:87],v[40:43],v[72:75]
v_mfma_f32_16x16x32_bf16 v[80:83],a[88:91],v[40:43],v[80:83]
v_mfma_f32_16x16x32_bf16 v[88:91],a[92:95],v[40:43],v[88:91]
v_mfma_f32_16x16x32_bf16 v[68:71],a[80:83],v[44:47],v[68:71]
v_mfma_f32_16x16x32_bf16 v[76:79],a[84:87],v[44:47],v[76:79]
v_mfma_f32_16x16x32_bf16 v[84:87],a[88:91],v[44:47],v[84:87]
v_mfma_f32_16x16x32_bf16 v[92:95],a[92:95],v[44:47],v[92:95]
s_waitcnt vmcnt(8)
ds_read_b128 a[96:99],v26 offset:8192
ds_read_b128 a[100:103],v27 offset:9216
ds_read_b128 a[104:107],v26 offset:12288
ds_read_b128 a[108:111],v27 offset:13312
ds_read_b128 a[112:115],v27 offset:8192
ds_read_b128 a[116:119],v26 offset:9216
ds_read_b128 a[120:123],v27 offset:12288
ds_read_b128 a[124:127],v26 offset:13312
s_waitcnt lgkmcnt(6)
ds_read_b64_tr_b16 v[32:33],v176 offset:12288
ds_read_b64_tr_b16 v[34:35],v176 offset:12544
ds_read_b64_tr_b16 v[36:37],v177 offset:12288
ds_read_b64_tr_b16 v[38:39],v177 offset:12544
ds_read_b64_tr_b16 v[40:41],v176 offset:14336
ds_read_b64_tr_b16 v[42:43],v176 offset:14592
ds_read_b64_tr_b16 v[44:45],v177 offset:14336
ds_read_b64_tr_b16 v[46:47],v177 offset:14592
s_waitcnt lgkmcnt(8)
s_add_u32 s36,s46,640
s_add_u32 m0,s39,8192
s_nop 0
buffer_load_dwordx4 v24,s[8:11],s36 offen lds
s_add_u32 m0,s39,9216
s_add_u32 s36,s36,s45
buffer_load_dwordx4 v25,s[8:11],s36 offen lds
s_add_u32 m0,s39,10240
s_add_u32 s36,s36,s45
buffer_load_dwordx4 v25,s[8:11],s36 offen lds
s_add_u32 m0,s39,11264
s_add_u32 s36,s36,s45
buffer_load_dwordx4 v24,s[8:11],s36 offen lds
s_add_u32 m0,s39,12288
s_add_u32 s36,s36,s45
buffer_load_dwordx4 v24,s[8:11],s36 offen lds
s_add_u32 m0,s39,13312
s_add_u32 s36,s36,s45
buffer_load_dwordx4 v25,s[8:11],s36 offen lds
s_add_u32 m0,s39,14336
s_add_u32 s36,s36,s45
buffer_load_dwordx4 v25,s[8:11],s36 offen lds
s_add_u32 m0,s39,15360
s_add_u32 s36,s36,s45
buffer_load_dwordx4 v24,s[8:11],s36 offen lds
s_waitcnt lgkmcnt(0)
v_mfma_f32_16x16x32_bf16 v[64:67],a[96:99],v[32:35],v[64:67]
v_mfma_f32_16x16x32_bf16 v[72:75],a[100:103],v[32:35],v[72:75]
v_mfma_f32_16x16x32_bf16 v[80:83],a[104:107],v[32:35],v[80:83]
v_mfma_f32_16x16x32_bf16 v[88:91],a[108:111],v[32:35],v[88:91]
v_mfma_f32_16x16x32_bf16 v[68:71],a[96:99],v[36:39],v[68:71]
v_mfma_f32_16x16x32_bf16 v[76:79],a[100:103],v[36:39],v[76:79]
v_mfma_f32_16x16x32_bf16 v[84:87],a[104:107],v[36:39],v[84:87]
v_mfma_f32_16x16x32_bf16 v[92:95],a[108:111],v[36:39],v[92:95]
v_mfma_f32_16x16x32_bf16 v[64:67],a[112:115],v[40:43],v[64:67]
v_mfma_f32_16x16x32_bf16 v[72:75],a[116:119],v[40:43],v[72:75]
v_mfma_f32_16x16x32_bf16 v[80:83],a[120:123],v[40:43],v[80:83]
v_mfma_f32_16x16x32_bf16 v[88:91],a[124:127],v[40:43],v[88:91]
v_mfma_f32_16x16x32_bf16 v[68:71],a[112:115],v[44:47],v[68:71]
v_mfma_f32_16x16x32_bf16 v[76:79],a[116:119],v[44:47],v[76:79]
v_mfma_f32_16x16x32_bf16 v[84:87],a[120:123],v[44:47],v[84:87]
v_mfma_f32_16x16x32_bf16 v[92:95],a[124:127],v[44:47],v[92:95]
s_waitcnt vmcnt(8)
ds_read_b128 a[128:131],v26 offset:0
ds_read_b128 a[132:135],v27 offset:1024
ds_read_b128 a[136:139],v26 offset:4096
ds_read_b128 a[140:143],v27 offset:5120
ds_read_b128 a[144:147],v27 offset:0
ds_read_b128 a[148:151],v26 offset:1024
ds_read_b128 a[152:155],v27 offset:4096
ds_read_b128 a[156:159],v26 offset:5120
s_waitcnt lgkmcnt(6)
ds_read_b64_tr_b16 v[32:33],v176 offset:16384
ds_read_b64_tr_b16 v[34:35],v176 offset:16640
ds_read_b64_tr_b16 v[36:37],v177 offset:16384
ds_read_b64_tr_b16 v[38:39],v177 offset:16640
ds_read_b64_tr_b16 v[40:41],v176 offset:18432
ds_read_b64_tr_b16 v[42:43],v176 offset:18688
ds_read_b64_tr_b16 v[44:45],v177 offset:18432
ds_read_b64_tr_b16 v[46:47],v177 offset:18688
s_waitcnt lgkmcnt(8)
s_add_u32 s36,s46,768
s_add_u32 m0,s39,0
s_nop 0
buffer_load_dwordx4 v24,s[8:11],s36 offen lds
s_add_u32 m0,s39,1024
s_add_u32 s36,s36,s45
buffer_load_dwordx4 v25,s[8:11],s36 offen lds
s_add_u32 m0,s39,2048
s_add_u32 s36,s36,s45
buffer_load_dwordx4 v25,s[8:11],s36 offen lds
s_add_u32 m0,s39,3072
s_add_u32 s36,s36,s45
buffer_load_dwordx4 v24,s[8:11],s36 offen lds
s_add_u32 m0,s39,4096
s_add_u32 s36,s36,s45
buffer_load_dwordx4 v24,s[8:11],s36 offen lds
s_add_u32 m0,s39,5120
s_add_u32 s36,s36,s45
buffer_load_dwordx4 v25,s[8:11],s36 offen lds
s_add_u32 m0,s39,6144
s_add_u32 s36,s36,s45
buffer_load_dwordx4 v25,s[8:11],s36 offen lds
s_add_u32 m0,s39,7168
s_add_u32 s36,s36,s45
buffer_load_dwordx4 v24,s[8:11],s36 offen lds
s_waitcnt lgkmcnt(0)
v_mfma_f32_16x16x32_bf16 v[64:67],a[128:131],v[32:35],v[64:67]
s_nop 0
v_mfma_f32_16x16x32_bf16 v[72:75],a[132:135],v[32:35],v[72:75]
v_mfma_f32_16x16x32_bf16 v[80:83],a[136:139],v[32:35],v[80:83]
v_mfma_f32_16x16x32_bf16 v[88:91],a[140:143],v[32:35],v[88:91]
v_mfma_f32_16x16x32_bf16 v[68:71],a[128:131],v[36:39],v[68:71]
v_mfma_f32_16x16x32_bf16 v[76:79],a[132:135],v[36:39],v[76:79]
v_mfma_f32_16x16x32_bf16 v[84:87],a[136:139],v[36:39],v[84:87]
v_mfma_f32_16x16x32_bf16 v[92:95],a[140:143],v[36:39],v[92:95]
v_mfma_f32_16x16x32_bf16 v[64:67],a[144:147],v[40:43],v[64:67]
v_mfma_f32_16x16x32_bf16 v[72:75],a[148:151],v[40:43],v[72:75]
v_mfma_f32_16x16x32_bf16 v[80:83],a[152:155],v[40:43],v[80:83]
v_mfma_f32_16x16x32_bf16 v[88:91],a[156:159],v[40:43],v[88:91]
v_mfma_f32_16x16x32_bf16 v[68:71],a[144:147],v[44:47],v[68:71]
v_mfma_f32_16x16x32_bf16 v[76:79],a[148:151],v[44:47],v[76:79]
v_mfma_f32_16x16x32_bf16 v[84:87],a[152:155],v[44:47],v[84:87]
v_mfma_f32_16x16x32_bf16 v[92:95],a[156:159],v[44:47],v[92:95]
s_waitcnt vmcnt(8)
ds_read_b128 a[160:163],v26 offset:8192
ds_read_b128 a[164:167],v27 offset:9216
ds_read_b128 a[168:171],v26 offset:12288
ds_read_b128 a[172:175],v27 offset:13312
ds_read_b128 a[176:179],v27 offset:8192
ds_read_b128 a[180:183],v26 offset:9216
ds_read_b128 a[184:187],v27 offset:12288
ds_read_b128 a[188:191],v26 offset:13312
s_waitcnt lgkmcnt(6)
ds_read_b64_tr_b16 v[32:33],v176 offset:20480
ds_read_b64_tr_b16 v[34:35],v176 offset:20736
ds_read_b64_tr_b16 v[36:37],v177 offset:20480
ds_read_b64_tr_b16 v[38:39],v177 offset:20736
ds_read_b64_tr_b16 v[40:41],v176 offset:22528
ds_read_b64_tr_b16 v[42:43],v176 offset:22784
ds_read_b64_tr_b16 v[44:45],v177 offset:22528
ds_read_b64_tr_b16 v[46:47],v177 offset:22784
s_waitcnt lgkmcnt(8)
s_add_u32 s36,s46,896
s_add_u32 m0,s39,8192
s_nop 0
buffer_load_dwordx4 v24,s[8:11],s36 offen lds
s_add_u32 m0,s39,9216
s_add_u32 s36,s36,s45
buffer_load_dwordx4 v25,s[8:11],s36 offen lds
s_add_u32 m0,s39,10240
s_add_u32 s36,s36,s45
buffer_load_dwordx4 v25,s[8:11],s36 offen lds
s_add_u32 m0,s39,11264
s_add_u32 s36,s36,s45
buffer_load_dwordx4 v24,s[8:11],s36 offen lds
s_add_u32 m0,s39,12288
s_add_u32 s36,s36,s45
buffer_load_dwordx4 v24,s[8:11],s36 offen lds
s_add_u32 m0,s39,13312
s_add_u32 s36,s36,s45
buffer_load_dwordx4 v25,s[8:11],s36 offen lds
s_add_u32 m0,s39,14336
s_add_u32 s36,s36,s45
buffer_load_dwordx4 v25,s[8:11],s36 offen lds
s_add_u32 m0,s39,15360
s_add_u32 s36,s36,s45
buffer_load_dwordx4 v24,s[8:11],s36 offen lds
s_add_u32 s42,s47,s78
s_and_b32 s42,s42,s80
s_or_b32 s42,s42,s79
s_mul_i32 s42,s42,s31
s_add_u32 s42,s42,s30
s_cmp_lt_u32 s47,s28
s_cselect_b32 s14,s44,0
s_add_u32 s47,s47,1
s_add_u32 m0,s41,0
s_nop 0
buffer_load_dwordx4 v16,s[12:15],s42 offen lds
s_add_u32 m0,s41,1024
s_add_u32 s42,s42,s29
buffer_load_dwordx4 v16,s[12:15],s42 offen lds
s_add_u32 m0,s41,2048
s_add_u32 s42,s42,s29
buffer_load_dwordx4 v16,s[12:15],s42 offen lds
s_add_u32 m0,s41,3072
s_add_u32 s42,s42,s29
buffer_load_dwordx4 v16,s[12:15],s42 offen lds
s_add_u32 m0,s41,4096
s_add_u32 s42,s42,s29
buffer_load_dwordx4 v16,s[12:15],s42 offen lds
s_add_u32 m0,s41,5120
s_add_u32 s42,s42,s29
buffer_load_dwordx4 v16,s[12:15],s42 offen lds
s_add_u32 m0,s41,6144
s_add_u32 s42,s42,s29
buffer_load_dwordx4 v16,s[12:15],s42 offen lds
s_add_u32 m0,s41,7168
s_add_u32 s42,s42,s29
buffer_load_dwordx4 v16,s[12:15],s42 offen lds
s_add_u32 m0,s41,8192
s_add_u32 s42,s42,s29
buffer_load_dwordx4 v16,s[12:15],s42 offen lds
s_add_u32 s41,s41,36864
s_sub_u32 s36,s41,147456
s_cmp_ge_u32 s41,147456
s_cselect_b32 s41,s36,s41
s_waitcnt lgkmcnt(0)
v_mfma_f32_16x16x32_bf16 v[64:67],a[160:163],v[32:35],v[64:67]
s_nop 0
v_mfma_f32_16x16x32_bf16 v[72:75],a[164:167],v[32:35],v[72:75]
v_mfma_f32_16x16x32_bf16 v[80:83],a[168:171],v[32:35],v[80:83]
v_mfma_f32_16x16x32_bf16 v[88:91],a[172:175],v[32:35],v[88:91]
v_mfma_f32_16x16x32_bf16 v[68:71],a[160:163],v[36:39],v[68:71]
v_mfma_f32_16x16x32_bf16 v[76:79],a[164:167],v[36:39],v[76:79]
v_mfma_f32_16x16x32_bf16 v[84:87],a[168:171],v[36:39],v[84:87]
v_mfma_f32_16x16x32_bf16 v[92:95],a[172:175],v[36:39],v[92:95]
v_mfma_f32_16x16x32_bf16 v[64:67],a[176:179],v[40:43],v[64:67]
v_mfma_f32_16x16x32_bf16 v[72:75],a[180:183],v[40:43],v[72:75]
v_mfma_f32_16x16x32_bf16 v[80:83],a[184:187],v[40:43],v[80:83]
v_mfma_f32_16x16x32_bf16 v[88:91],a[188:191],v[40:43],v[88:91]
v_mfma_f32_16x16x32_bf16 v[68:71],a[176:179],v[44:47],v[68:71]
v_mfma_f32_16x16x32_bf16 v[76:79],a[180:183],v[44:47],v[76:79]
v_mfma_f32_16x16x32_bf16 v[84:87],a[184:187],v[44:47],v[84:87]
v_mfma_f32_16x16x32_bf16 v[92:95],a[188:191],v[44:47],v[92:95]
s_waitcnt vmcnt(17)
ds_read_b128 a[192:195],v26 offset:0
ds_read_b128 a[196:199],v27 offset:1024
ds_read_b128 a[200:203],v26 offset:4096
ds_read_b128 a[204:207],v27 offset:5120
ds_read_b128 a[208:211],v27 offset:0
ds_read_b128 a[212:215],v26 offset:1024
ds_read_b128 a[216:219],v27 offset:4096
ds_read_b128 a[220:223],v26 offset:5120
s_waitcnt lgkmcnt(6)
ds_read_b64_tr_b16 v[32:33],v176 offset:24576
ds_read_b64_tr_b16 v[34:35],v176 offset:24832
ds_read_b64_tr_b16 v[36:37],v177 offset:24576
ds_read_b64_tr_b16 v[38:39],v177 offset:24832
ds_read_b64_tr_b16 v[40:41],v176 offset:26624
ds_read_b64_tr_b16 v[42:43],v176 offset:26880
ds_read_b64_tr_b16 v[44:45],v177 offset:26624
ds_read_b64_tr_b16 v[46:47],v177 offset:26880
s_waitcnt lgkmcnt(8)
s_add_u32 s36,s46,1024
s_add_u32 m0,s39,0
s_nop 0
buffer_load_dwordx4 v24,s[8:11],s36 offen lds
s_add_u32 m0,s39,1024
s_add_u32 s36,s36,s45
buffer_load_dwordx4 v25,s[8:11],s36 offen lds
s_add_u32 m0,s39,2048
s_add_u32 s36,s36,s45
buffer_load_dwordx4 v25,s[8:11],s36 offen lds
s_add_u32 m0,s39,3072
s_add_u32 s36,s36,s45
buffer_load_dwordx4 v24,s[8:11],s36 offen lds
s_add_u32 m0,s39,4096
s_add_u32 s36,s36,s45
buffer_load_dwordx4 v24,s[8:11],s36 offen lds
s_add_u32 m0,s39,5120
s_add_u32 s36,s36,s45
buffer_load_dwordx4 v25,s[8:11],s36 offen lds
s_add_u32 m0,s39,6144
s_add_u32 s36,s36,s45
buffer_load_dwordx4 v25,s[8:11],s36 offen lds
s_add_u32 m0,s39,7168
s_add_u32 s36,s36,s45
buffer_load_dwordx4 v24,s[8:11],s36 offen lds
s_waitcnt lgkmcnt(0)
v_mfma_f32_16x16x32_bf16 v[64:67],a[192:195],v[32:35],v[64:67]
s_nop 0
v_mfma_f32_16x16x32_bf16 v[72:75],a[196:199],v[32:35],v[72:75]
v_mfma_f32_16x16x32_bf16 v[80:83],a[200:203],v[32:35],v[80:83]
v_mfma_f32_16x16x32_bf16 v[88:91],a[204:207],v[32:35],v[88:91]
v_mfma_f32_16x16x32_bf16 v[68:71],a[192:195],v[36:39],v[68:71]
v_mfma_f32_16x16x32_bf16 v[76:79],a[196:199],v[36:39],v[76:79]
v_mfma_f32_16x16x32_bf16 v[84:87],a[200:203],v[36:39],v[84:87]
v_mfma_f32_16x16x32_bf16 v[92:95],a[204:207],v[36:39],v[92:95]
v_mfma_f32_16x16x32_bf16 v[64:67],a[208:211],v[40:43],v[64:67]
v_mfma_f32_16x16x32_bf16 v[72:75],a[212:215],v[40:43],v[72:75]
v_mfma_f32_16x16x32_bf16 v[80:83],a[216:219],v[40:43],v[80:83]
v_mfma_f32_16x16x32_bf16 v[88:91],a[220:223],v[40:43],v[88:91]
v_mfma_f32_16x16x32_bf16 v[68:71],a[208:211],v[44:47],v[68:71]
v_mfma_f32_16x16x32_bf16 v[76:79],a[212:215],v[44:47],v[76:79]
v_mfma_f32_16x16x32_bf16 v[84:87],a[216:219],v[44:47],v[84:87]
v_mfma_f32_16x16x32_bf16 v[92:95],a[220:223],v[44:47],v[92:95]
s_waitcnt vmcnt(17)
ds_read_b128 a[224:227],v26 offset:8192
ds_read_b128 a[228:231],v27 offset:9216
ds_read_b128 a[232:235],v26 offset:12288
ds_read_b128 a[236:239],v27 offset:13312
ds_read_b128 a[240:243],v27 offset:8192
ds_read_b128 a[244:247],v26 offset:9216
ds_read_b128 a[248:251],v27 offset:12288
ds_read_b128 a[252:255],v26 offset:13312
s_waitcnt lgkmcnt(6)
ds_read_b64_tr_b16 v[32:33],v176 offset:28672
ds_read_b64_tr_b16 v[34:35],v176 offset:28928
ds_read_b64_tr_b16 v[36:37],v177 offset:28672
ds_read_b64_tr_b16 v[38:39],v177 offset:28928
ds_read_b64_tr_b16 v[40:41],v176 offset:30720
ds_read_b64_tr_b16 v[42:43],v176 offset:30976
ds_read_b64_tr_b16 v[44:45],v177 offset:30720
ds_read_b64_tr_b16 v[46:47],v177 offset:30976
s_waitcnt lgkmcnt(8)
s_waitcnt lgkmcnt(0)
v_mfma_f32_16x16x32_bf16 v[64:67],a[224:227],v[32:35],v[64:67]
v_mfma_f32_16x16x32_bf16 v[72:75],a[228:231],v[32:35],v[72:75]
v_mfma_f32_16x16x32_bf16 v[80:83],a[232:235],v[32:35],v[80:83]
v_mfma_f32_16x16x32_bf16 v[88:91],a[236:239],v[32:35],v[88:91]
v_mfma_f32_16x16x32_bf16 v[68:71],a[224:227],v[36:39],v[68:71]
v_mfma_f32_16x16x32_bf16 v[76:79],a[228:231],v[36:39],v[76:79]
v_mfma_f32_16x16x32_bf16 v[84:87],a[232:235],v[36:39],v[84:87]
v_mfma_f32_16x16x32_bf16 v[92:95],a[236:239],v[36:39],v[92:95]
v_mfma_f32_16x16x32_bf16 v[64:67],a[240:243],v[40:43],v[64:67]
v_mfma_f32_16x16x32_bf16 v[72:75],a[244:247],v[40:43],v[72:75]
v_mfma_f32_16x16x32_bf16 v[80:83],a[248:251],v[40:43],v[80:83]
v_mfma_f32_16x16x32_bf16 v[88:91],a[252:255],v[40:43],v[88:91]
v_mfma_f32_16x16x32_bf16 v[68:71],a[240:243],v[44:47],v[68:71]
v_mfma_f32_16x16x32_bf16 v[76:79],a[244:247],v[44:47],v[76:79]
v_mfma_f32_16x16x32_bf16 v[84:87],a[248:251],v[44:47],v[84:87]
v_mfma_f32_16x16x32_bf16 v[92:95],a[252:255],v[44:47],v[92:95]
s_waitcnt vmcnt(0)
ds_read_b128 v[144:147],v26 offset:0
ds_read_b128 v[148:151],v27 offset:1024
ds_read_b128 v[152:155],v26 offset:4096
ds_read_b128 v[156:159],v27 offset:5120
ds_read_b128 v[160:163],v27 offset:0
ds_read_b128 v[164:167],v26 offset:1024
ds_read_b128 v[168:171],v27 offset:4096
ds_read_b128 v[172:175],v26 offset:5120
s_waitcnt lgkmcnt(6)
ds_read_b64_tr_b16 v[32:33],v176 offset:32768
ds_read_b64_tr_b16 v[34:35],v176 offset:33024
ds_read_b64_tr_b16 v[36:37],v177 offset:32768
ds_read_b64_tr_b16 v[38:39],v177 offset:33024
ds_read_b64_tr_b16 v[40:41],v176 offset:34816
ds_read_b64_tr_b16 v[42:43],v176 offset:35072
ds_read_b64_tr_b16 v[44:45],v177 offset:34816
ds_read_b64_tr_b16 v[46:47],v177 offset:35072
s_waitcnt lgkmcnt(8)
s_waitcnt lgkmcnt(0)
v_mfma_f32_16x16x32_bf16 v[64:67],v[144:147],v[32:35],v[64:67]
v_mfma_f32_16x16x32_bf16 v[72:75],v[148:151],v[32:35],v[72:75]
v_mfma_f32_16x16x32_bf16 v[80:83],v[152:155],v[32:35],v[80:83]
v_mfma_f32_16x16x32_bf16 v[88:91],v[156:159],v[32:35],v[88:91]
v_mfma_f32_16x16x32_bf16 v[68:71],v[144:147],v[36:39],v[68:71]
v_mfma_f32_16x16x32_bf16 v[76:79],v[148:151],v[36:39],v[76:79]
v_mfma_f32_16x16x32_bf16 v[84:87],v[152:155],v[36:39],v[84:87]
v_mfma_f32_16x16x32_bf16 v[92:95],v[156:159],v[36:39],v[92:95]
v_mfma_f32_16x16x32_bf16 v[64:67],v[160:163],v[40:43],v[64:67]
v_mfma_f32_16x16x32_bf16 v[72:75],v[164:167],v[40:43],v[72:75]
v_mfma_f32_16x16x32_bf16 v[80:83],v[168:171],v[40:43],v[80:83]
v_mfma_f32_16x16x32_bf16 v[88:91],v[172:175],v[40:43],v[88:91]
v_mfma_f32_16x16x32_bf16 v[68:71],v[160:163],v[44:47],v[68:71]
v_mfma_f32_16x16x32_bf16 v[76:79],v[164:167],v[44:47],v[76:79]
v_mfma_f32_16x16x32_bf16 v[84:87],v[168:171],v[44:47],v[84:87]
v_mfma_f32_16x16x32_bf16 v[92:95],v[172:175],v[44:47],v[92:95]
s_barrier
ds_read_b64_tr_b16 v[48:49],v178 offset:0
ds_read_b64_tr_b16 v[50:51],v178 offset:256
ds_read_b64_tr_b16 v[52:53],v179 offset:0
ds_read_b64_tr_b16 v[54:55],v179 offset:256
ds_read_b64_tr_b16 v[56:57],v178 offset:2048
ds_read_b64_tr_b16 v[58:59],v178 offset:2304
ds_read_b64_tr_b16 v[60:61],v179 offset:2048
ds_read_b64_tr_b16 v[62:63],v179 offset:2304
s_add_u32 s42,s47,s78
s_and_b32 s42,s42,s80
s_or_b32 s42,s42,s79
s_mul_i32 s42,s42,s31
s_add_u32 s42,s42,s30
s_cmp_lt_u32 s47,s28
s_cselect_b32 s14,s44,0
s_add_u32 s47,s47,1
s_add_u32 m0,s41,0
s_nop 0
buffer_load_dwordx4 v16,s[12:15],s42 offen lds
s_add_u32 m0,s41,1024
s_add_u32 s42,s42,s29
buffer_load_dwordx4 v16,s[12:15],s42 offen lds
s_add_u32 m0,s41,2048
s_add_u32 s42,s42,s29
buffer_load_dwordx4 v16,s[12:15],s42 offen lds
s_add_u32 m0,s41,3072
s_add_u32 s42,s42,s29
buffer_load_dwordx4 v16,s[12:15],s42 offen lds
s_add_u32 m0,s41,4096
s_add_u32 s42,s42,s29
buffer_load_dwordx4 v16,s[12:15],s42 offen lds
s_add_u32 m0,s41,5120
s_add_u32 s42,s42,s29
buffer_load_dwordx4 v16,s[12:15],s42 offen lds
s_add_u32 m0,s41,6144
s_add_u32 s42,s42,s29
buffer_load_dwordx4 v16,s[12:15],s42 offen lds
s_add_u32 m0,s41,7168
s_add_u32 s42,s42,s29
buffer_load_dwordx4 v16,s[12:15],s42 offen lds
s_add_u32 m0,s41,8192
s_add_u32 s42,s42,s29
buffer_load_dwordx4 v16,s[12:15],s42 offen lds
s_add_u32 s41,s41,36864
s_sub_u32 s36,s41,147456
s_cmp_ge_u32 s41,147456
s_cselect_b32 s41,s36,s41
s_lshl_b32 s37,s78,6
s_add_u32 s37,s37,256
s_and_b32 s37,s37,s92
s_add_u32 s93,s51,s37
buffer_load_dwordx4 v[180:183],v30,s[84:87],s93 offen
s_add_u32 s93,s93,s94
buffer_load_dwordx4 v[184:187],v30,s[84:87],s93 offen
s_add_u32 s93,s93,s94
buffer_load_dwordx4 v[188:191],v30,s[84:87],s93 offen
s_add_u32 s93,s93,s94
buffer_load_dwordx4 v[192:195],v30,s[84:87],s93 offen
s_add_u32 s93,s93,s94
buffer_load_dwordx4 v[196:199],v30,s[84:87],s93 offen
s_add_u32 s93,s93,s94
s_mov_b32 s88,s12
s_mov_b32 s89,s13
s_mov_b32 s90,0
s_mov_b32 s91,0x20000
buffer_load_dword v204,v30,s[88:91],0 offen
buffer_load_dword v204,v30,s[88:91],0 offen
s_add_u32 s27,s27,1
k1_N576_l1:
s_waitcnt lgkmcnt(4)
v_mfma_f32_16x16x32_bf16 v[96:99],a[0:3],v[48:51],0
ds_read_b64_tr_b16 v[32:33],v178 offset:4096
s_add_u32 s42,s47,s78
v_mfma_f32_16x16x32_bf16 v[104:107],a[4:7],v[48:51],0
ds_read_b64_tr_b16 v[34:35],v178 offset:4352
s_and_b32 s42,s42,s80
v_mfma_f32_16x16x32_bf16 v[112:115],a[8:11],v[48:51],0
ds_read_b64_tr_b16 v[36:37],v179 offset:4096
s_or_b32 s42,s42,s79
v_mfma_f32_16x16x32_bf16 v[120:123],a[12:15],v[48:51],0
ds_read_b64_tr_b16 v[38:39],v179 offset:4352
s_mul_i32 s42,s42,s31
v_mfma_f32_16x16x32_bf16 v[100:103],a[0:3],v[52:55],0
s_add_u32 s42,s42,s30
s_cmp_lt_u32 s47,s28
s_cselect_b32 s14,s44,0
v_mfma_f32_16x16x32_bf16 v[108:111],a[4:7],v[52:55],0
s_add_u32 s47,s47,1
s_add_u32 m0,s41,0
v_mfma_f32_16x16x32_bf16 v[116:119],a[8:11],v[52:55],0
v_mfma_f32_16x16x32_bf16 v[124:127],a[12:15],v[52:55],0
s_waitcnt lgkmcnt(4)
s_nop 0
v_mfma_f32_16x16x32_bf16 v[96:99],a[16:19],v[56:59],v[96:99]
ds_read_b64_tr_b16 v[40:41],v178 offset:6144
s_sub_u32 s37,s27,1
v_mfma_f32_16x16x32_bf16 v[104:107],a[20:23],v[56:59],v[104:107]
ds_read_b64_tr_b16 v[42:43],v178 offset:6400
s_add_u32 s37,s37,s78
v_mfma_f32_16x16x32_bf16 v[112:115],a[24:27],v[56:59],v[112:115]
ds_read_b64_tr_b16 v[44:45],v179 offset:6144
s_and_b32 s37,s37,s80
v_mfma_f32_16x16x32_bf16 v[120:123],a[28:31],v[56:59],v[120:123]
ds_read_b64_tr_b16 v[46:47],v179 offset:6400
s_or_b32 s37,s37,s79
v_mfma_f32_16x16x32_bf16 v[100:103],a[16:19],v[60:63],v[100:103]
buffer_load_dwordx4 v16,s[12:15],s42 offen lds
v_mfma_f32_16x16x32_bf16 v[108:111],a[20:23],v[60:63],v[108:111]
s_add_u32 m0,s41,1024
s_add_u32 s42,s42,s29
v_mfma_f32_16x16x32_bf16 v[116:119],a[24:27],v[60:63],v[116:119]
s_mov_b32 s43,s32
s_lshl_b32 s37,s37,5
v_mfma_f32_16x16x32_bf16 v[124:127],a[28:31],v[60:63],v[124:127]
v_and_b32 v2,15,v1
s_waitcnt lgkmcnt(4)
v_mfma_f32_16x16x32_bf16 v[96:99],a[32:35],v[32:35],v[96:99]
ds_read_b64_tr_b16 v[48:49],v178 offset:8192
v_add_u32 v2,s37,v2
v_mfma_f32_16x16x32_bf16 v[104:107],a[36:39],v[32:35],v[104:107]
ds_read_b64_tr_b16 v[50:51],v178 offset:8448
v_mul_u32_u24 v3,3641,v2
v_mfma_f32_16x16x32_bf16 v[112:115],a[40:43],v[32:35],v[112:115]
ds_read_b64_tr_b16 v[52:53],v179 offset:8192
v_lshrrev_b32 v3,16,v3
v_mfma_f32_16x16x32_bf16 v[120:123],a[44:47],v[32:35],v[120:123]
ds_read_b64_tr_b16 v[54:55],v179 offset:8448
v_mul_u32_u24 v4,18,v3
v_mfma_f32_16x16x32_bf16 v[100:103],a[32:35],v[36:39],v[100:103]
buffer_load_dwordx4 v16,s[12:15],s42 offen lds
v_mfma_f32_16x16x32_bf16 v[108:111],a[36:39],v[36:39],v[108:111]
s_add_u32 m0,s41,2048
s_add_u32 s42,s42,s29
v_mfma_f32_16x16x32_bf16 v[116:119],a[40:43],v[36:39],v[116:119]
v_sub_u32 v4,v2,v4
v_lshlrev_b32 v3,18,v3
v_mfma_f32_16x16x32_bf16 v[124:127],a[44:47],v[36:39],v[124:127]
v_lshl_add_u32 v3,v4,4,v3
s_waitcnt lgkmcnt(4)
v_mfma_f32_16x16x32_bf16 v[96:99],a[48:51],v[40:43],v[96:99]
ds_read_b64_tr_b16 v[56:57],v178 offset:10240
v_add_u32_e64 v20,v3,v9
v_mfma_f32_16x16x32_bf16 v[104:107],a[52:55],v[40:43],v[104:107]
ds_read_b64_tr_b16 v[58:59],v178 offset:10496
v_add_u32 v22,4096,v20
v_mfma_f32_16x16x32_bf16 v[112:115],a[56:59],v[40:43],v[112:115]
ds_read_b64_tr_b16 v[60:61],v179 offset:10240
v_add_u32_e64 v2,16,v2
v_mfma_f32_16x16x32_bf16 v[120:123],a[60:63],v[40:43],v[120:123]
ds_read_b64_tr_b16 v[62:63],v179 offset:10496
v_mul_u32_u24 v3,3641,v2
v_mfma_f32_16x16x32_bf16 v[100:103],a[48:51],v[44:47],v[100:103]
buffer_load_dwordx4 v16,s[12:15],s42 offen lds
v_mfma_f32_16x16x32_bf16 v[108:111],a[52:55],v[44:47],v[108:111]
s_add_u32 m0,s41,3072
s_add_u32 s42,s42,s29
v_mfma_f32_16x16x32_bf16 v[116:119],a[56:59],v[44:47],v[116:119]
v_lshrrev_b32 v3,16,v3
v_mul_u32_u24 v4,18,v3
v_mfma_f32_16x16x32_bf16 v[124:127],a[60:63],v[44:47],v[124:127]
v_sub_u32 v4,v2,v4
s_waitcnt lgkmcnt(4)
v_mfma_f32_16x16x32_bf16 v[96:99],a[64:67],v[48:51],v[96:99]
ds_read_b64_tr_b16 v[32:33],v178 offset:12288
v_lshlrev_b32 v3,18,v3
v_mfma_f32_16x16x32_bf16 v[104:107],a[68:71],v[48:51],v[104:107]
ds_read_b64_tr_b16 v[34:35],v178 offset:12544
v_lshl_add_u32 v3,v4,4,v3
v_mfma_f32_16x16x32_bf16 v[112:115],a[72:75],v[48:51],v[112:115]
ds_read_b64_tr_b16 v[36:37],v179 offset:12288
v_add_u32_e64 v21,v3,v9
v_mfma_f32_16x16x32_bf16 v[120:123],a[76:79],v[48:51],v[120:123]
ds_read_b64_tr_b16 v[38:39],v179 offset:12544
v_add_u32 v23,4096,v21
v_mfma_f32_16x16x32_bf16 v[100:103],a[64:67],v[52:55],v[100:103]
buffer_load_dwordx4 v16,s[12:15],s42 offen lds
v_mfma_f32_16x16x32_bf16 v[108:111],a[68:71],v[52:55],v[108:111]
s_add_u32 m0,s41,4096
s_add_u32 s42,s42,s29
v_mfma_f32_16x16x32_bf16 v[116:119],a[72:75],v[52:55],v[116:119]
v_cvt_pk_bf16_f32 v128,v64,v65
v_cvt_pk_bf16_f32 v129,v66,v67
v_mfma_f32_16x16x32_bf16 v[124:127],a[76:79],v[52:55],v[124:127]
v_cvt_pk_bf16_f32 v130,v72,v73
s_waitcnt lgkmcnt(4)
v_mfma_f32_16x16x32_bf16 v[96:99],a[80:83],v[56:59],v[96:99]
ds_read_b64_tr_b16 v[40:41],v178 offset:14336
v_cvt_pk_bf16_f32 v131,v74,v75
v_mfma_f32_16x16x32_bf16 v[104:107],a[84:87],v[56:59],v[104:107]
ds_read_b64_tr_b16 v[42:43],v178 offset:14592
v_cvt_pk_bf16_f32 v132,v68,v69
v_mfma_f32_16x16x32_bf16 v[112:115],a[88:91],v[56:59],v[112:115]
ds_read_b64_tr_b16 v[44:45],v179 offset:14336
v_cvt_pk_bf16_f32 v133,v70,v71
v_mfma_f32_16x16x32_bf16 v[120:123],a[92:95],v[56:59],v[120:123]
ds_read_b64_tr_b16 v[46:47],v179 offset:14592
v_cvt_pk_bf16_f32 v134,v76,v77
v_mfma_f32_16x16x32_bf16 v[100:103],a[80:83],v[60:63],v[100:103]
buffer_load_dwordx4 v16,s[12:15],s42 offen lds
v_mfma_f32_16x16x32_bf16 v[108:111],a[84:87],v[60:63],v[108:111]
s_add_u32 m0,s41,5120
s_add_u32 s42,s42,s29
v_mfma_f32_16x16x32_bf16 v[116:119],a[88:91],v[60:63],v[116:119]
v_cvt_pk_bf16_f32 v135,v78,v79
v_cvt_pk_bf16_f32 v136,v80,v81
v_mfma_f32_16x16x32_bf16 v[124:127],a[92:95],v[60:63],v[124:127]
v_cvt_pk_bf16_f32 v137,v82,v83
s_waitcnt lgkmcnt(4)
v_mfma_f32_16x16x32_bf16 v[96:99],a[96:99],v[32:35],v[96:99]
ds_read_b64_tr_b16 v[48:49],v178 offset:16384
v_cvt_pk_bf16_f32 v138,v88,v89
v_mfma_f32_16x16x32_bf16 v[104:107],a[100:103],v[32:35],v[104:107]
ds_read_b64_tr_b16 v[50:51],v178 offset:16640
v_cvt_pk_bf16_f32 v139,v90,v91
v_mfma_f32_16x16x32_bf16 v[112:115],a[104:107],v[32:35],v[112:115]
ds_read_b64_tr_b16 v[52:53],v179 offset:16384
v_cvt_pk_bf16_f32 v140,v84,v85
v_mfma_f32_16x16x32_bf16 v[120:123],a[108:111],v[32:35],v[120:123]
ds_read_b64_tr_b16 v[54:55],v179 offset:16640
v_cvt_pk_bf16_f32 v141,v86,v87
v_mfma_f32_16x16x32_bf16 v[100:103],a[96:99],v[36:39],v[100:103]
buffer_load_dwordx4 v16,s[12:15],s42 offen lds
v_mfma_f32_16x16x32_bf16 v[108:111],a[100:103],v[36:39],v[108:111]
s_add_u32 m0,s41,6144
s_add_u32 s42,s42,s29
v_mfma_f32_16x16x32_bf16 v[116:119],a[104:107],v[36:39],v[116:119]
v_cvt_pk_bf16_f32 v142,v92,v93
v_cvt_pk_bf16_f32 v143,v94,v95
v_mfma_f32_16x16x32_bf16 v[124:127],a[108:111],v[36:39],v[124:127]
s_waitcnt lgkmcnt(4)
v_mfma_f32_16x16x32_bf16 v[96:99],a[112:115],v[40:43],v[96:99]
ds_read_b64_tr_b16 v[56:57],v178 offset:18432
v_mfma_f32_16x16x32_bf16 v[104:107],a[116:119],v[40:43],v[104:107]
ds_read_b64_tr_b16 v[58:59],v178 offset:18688
v_mfma_f32_16x16x32_bf16 v[112:115],a[120:123],v[40:43],v[112:115]
ds_read_b64_tr_b16 v[60:61],v179 offset:18432
v_mfma_f32_16x16x32_bf16 v[120:123],a[124:127],v[40:43],v[120:123]
ds_read_b64_tr_b16 v[62:63],v179 offset:18688
v_mfma_f32_16x16x32_bf16 v[100:103],a[112:115],v[44:47],v[100:103]
buffer_load_dwordx4 v16,s[12:15],s42 offen lds
v_mfma_f32_16x16x32_bf16 v[108:111],a[116:119],v[44:47],v[108:111]
s_add_u32 m0,s41,7168
s_add_u32 s42,s42,s29
v_mfma_f32_16x16x32_bf16 v[116:119],a[120:123],v[44:47],v[116:119]
s_nop 0
v_mfma_f32_16x16x32_bf16 v[124:127],a[124:127],v[44:47],v[124:127]
s_waitcnt lgkmcnt(4)
s_nop 0
v_mfma_f32_16x16x32_bf16 v[96:99],a[128:131],v[48:51],v[96:99]
ds_read_b64_tr_b16 v[32:33],v178 offset:20480
v_mfma_f32_16x16x32_bf16 v[104:107],a[132:135],v[48:51],v[104:107]
ds_read_b64_tr_b16 v[34:35],v178 offset:20736
v_mfma_f32_16x16x32_bf16 v[112:115],a[136:139],v[48:51],v[112:115]
ds_read_b64_tr_b16 v[36:37],v179 offset:20480
v_mfma_f32_16x16x32_bf16 v[120:123],a[140:143],v[48:51],v[120:123]
ds_read_b64_tr_b16 v[38:39],v179 offset:20736
v_mfma_f32_16x16x32_bf16 v[100:103],a[128:131],v[52:55],v[100:103]
buffer_load_dwordx4 v16,s[12:15],s42 offen lds
v_mfma_f32_16x16x32_bf16 v[108:111],a[132:135],v[52:55],v[108:111]
s_add_u32 m0,s41,8192
s_add_u32 s42,s42,s29
v_mfma_f32_16x16x32_bf16 v[116:119],a[136:139],v[52:55],v[116:119]
s_nop 0
v_mfma_f32_16x16x32_bf16 v[124:127],a[140:143],v[52:55],v[124:127]
s_waitcnt lgkmcnt(4)
s_nop 0
v_mfma_f32_16x16x32_bf16 v[96:99],a[144:147],v[56:59],v[96:99]
ds_read_b64_tr_b16 v[40:41],v178 offset:22528
v_mfma_f32_16x16x32_bf16 v[104:107],a[148:151],v[56:59],v[104:107]
ds_read_b64_tr_b16 v[42:43],v178 offset:22784
v_mfma_f32_16x16x32_bf16 v[112:115],a[152:155],v[56:59],v[112:115]
ds_read_b64_tr_b16 v[44:45],v179 offset:22528
v_mfma_f32_16x16x32_bf16 v[120:123],a[156:159],v[56:59],v[120:123]
ds_read_b64_tr_b16 v[46:47],v179 offset:22784
v_mfma_f32_16x16x32_bf16 v[100:103],a[144:147],v[60:63],v[100:103]
buffer_load_dwordx4 v16,s[12:15],s42 offen lds
v_mfma_f32_16x16x32_bf16 v[108:111],a[148:151],v[60:63],v[108:111]
s_add_u32 s41,s41,36864
s_sub_u32 s36,s41,147456
v_mfma_f32_16x16x32_bf16 v[116:119],a[152:155],v[60:63],v[116:119]
s_cmp_ge_u32 s41,147456
s_cselect_b32 s41,s36,s41
v_mfma_f32_16x16x32_bf16 v[124:127],a[156:159],v[60:63],v[124:127]
s_add_u32 s83,s83,256
s_waitcnt lgkmcnt(4)
v_mfma_f32_16x16x32_bf16 v[96:99],a[160:163],v[32:35],v[96:99]
ds_read_b64_tr_b16 v[48:49],v178 offset:24576
s_and_b32 s83,s83,s92
v_mfma_f32_16x16x32_bf16 v[104:107],a[164:167],v[32:35],v[104:107]
ds_read_b64_tr_b16 v[50:51],v178 offset:24832
s_sub_u32 s82,s82,1
v_mfma_f32_16x16x32_bf16 v[112:115],a[168:171],v[32:35],v[112:115]
ds_read_b64_tr_b16 v[52:53],v179 offset:24576
s_cmp_ge_i32 s82,0
s_cselect_b32 s86,s44,0
v_mfma_f32_16x16x32_bf16 v[120:123],a[172:175],v[32:35],v[120:123]
ds_read_b64_tr_b16 v[54:55],v179 offset:24832
s_add_u32 s93,s51,s83
v_mfma_f32_16x16x32_bf16 v[100:103],a[160:163],v[36:39],v[100:103]
buffer_load_dwordx4 v[180:183],v30,s[84:87],s93 offen
v_mfma_f32_16x16x32_bf16 v[108:111],a[164:167],v[36:39],v[108:111]
s_add_u32 s93,s93,s94
v_mfma_f32_16x16x32_bf16 v[116:119],a[168:171],v[36:39],v[116:119]
v_mfma_f32_16x16x32_bf16 v[124:127],a[172:175],v[36:39],v[124:127]
s_waitcnt lgkmcnt(4)
s_nop 0
v_mfma_f32_16x16x32_bf16 v[96:99],a[176:179],v[40:43],v[96:99]
ds_read_b64_tr_b16 v[56:57],v178 offset:26624
v_mfma_f32_16x16x32_bf16 v[104:107],a[180:183],v[40:43],v[104:107]
ds_read_b64_tr_b16 v[58:59],v178 offset:26880
v_mfma_f32_16x16x32_bf16 v[112:115],a[184:187],v[40:43],v[112:115]
ds_read_b64_tr_b16 v[60:61],v179 offset:26624
v_mfma_f32_16x16x32_bf16 v[120:123],a[188:191],v[40:43],v[120:123]
ds_read_b64_tr_b16 v[62:63],v179 offset:26880
v_mfma_f32_16x16x32_bf16 v[100:103],a[176:179],v[44:47],v[100:103]
buffer_load_dwordx4 v[184:187],v30,s[84:87],s93 offen
v_mfma_f32_16x16x32_bf16 v[108:111],a[180:183],v[44:47],v[108:111]
s_add_u32 s93,s93,s94
s_nop 0
v_mfma_f32_16x16x32_bf16 v[116:119],a[184:187],v[44:47],v[116:119]
v_mfma_f32_16x16x32_bf16 v[124:127],a[188:191],v[44:47],v[124:127]
s_waitcnt lgkmcnt(4)
s_nop 0
v_mfma_f32_16x16x32_bf16 v[96:99],a[192:195],v[48:51],v[96:99]
ds_read_b64_tr_b16 v[32:33],v178 offset:28672
v_mfma_f32_16x16x32_bf16 v[104:107],a[196:199],v[48:51],v[104:107]
ds_read_b64_tr_b16 v[34:35],v178 offset:28928
v_mfma_f32_16x16x32_bf16 v[112:115],a[200:203],v[48:51],v[112:115]
ds_read_b64_tr_b16 v[36:37],v179 offset:28672
v_mfma_f32_16x16x32_bf16 v[120:123],a[204:207],v[48:51],v[120:123]
ds_read_b64_tr_b16 v[38:39],v179 offset:28928
v_mfma_f32_16x16x32_bf16 v[100:103],a[192:195],v[52:55],v[100:103]
buffer_load_dwordx4 v[188:191],v30,s[84:87],s93 offen
v_mfma_f32_16x16x32_bf16 v[108:111],a[196:199],v[52:55],v[108:111]
v_mfma_f32_16x16x32_bf16 v[116:119],a[200:203],v[52:55],v[116:119]
v_mfma_f32_16x16x32_bf16 v[124:127],a[204:207],v[52:55],v[124:127]
s_waitcnt lgkmcnt(4)
s_nop 0
v_mfma_f32_16x16x32_bf16 v[96:99],a[208:211],v[56:59],v[96:99]
ds_read_b64_tr_b16 v[40:41],v178 offset:30720
s_add_u32 s40,s40,36864
v_mfma_f32_16x16x32_bf16 v[104:107],a[212:215],v[56:59],v[104:107]
ds_read_b64_tr_b16 v[42:43],v178 offset:30976
s_cmp_ge_u32 s40,147456
s_cselect_b32 s40,0,s40
v_mfma_f32_16x16x32_bf16 v[112:115],a[216:219],v[56:59],v[112:115]
ds_read_b64_tr_b16 v[44:45],v179 offset:30720
v_add_u32 v176,s40,v19
v_mfma_f32_16x16x32_bf16 v[120:123],a[220:223],v[56:59],v[120:123]
ds_read_b64_tr_b16 v[46:47],v179 offset:30976
v_xor_b32 v177,32,v176
v_mfma_f32_16x16x32_bf16 v[100:103],a[208:211],v[60:63],v[100:103]
buffer_store_dwordx4 v[128:131],v20,s[20:23],s43 offen sc1
v_mfma_f32_16x16x32_bf16 v[108:111],a[212:215],v[60:63],v[108:111]
s_nop 0
v_mfma_f32_16x16x32_bf16 v[116:119],a[216:219],v[60:63],v[116:119]
v_mfma_f32_16x16x32_bf16 v[124:127],a[220:223],v[60:63],v[124:127]
s_waitcnt lgkmcnt(4)
s_nop 0
v_mfma_f32_16x16x32_bf16 v[96:99],a[224:227],v[32:35],v[96:99]
ds_read_b64_tr_b16 v[48:49],v178 offset:32768
v_mfma_f32_16x16x32_bf16 v[104:107],a[228:231],v[32:35],v[104:107]
ds_read_b64_tr_b16 v[50:51],v178 offset:33024
v_mfma_f32_16x16x32_bf16 v[112:115],a[232:235],v[32:35],v[112:115]
ds_read_b64_tr_b16 v[52:53],v179 offset:32768
v_mfma_f32_16x16x32_bf16 v[120:123],a[236:239],v[32:35],v[120:123]
ds_read_b64_tr_b16 v[54:55],v179 offset:33024
v_mfma_f32_16x16x32_bf16 v[100:103],a[224:227],v[36:39],v[100:103]
buffer_store_dwordx4 v[132:135],v21,s[20:23],s43 offen sc1
v_mfma_f32_16x16x32_bf16 v[108:111],a[228:231],v[36:39],v[108:111]
v_mfma_f32_16x16x32_bf16 v[116:119],a[232:235],v[36:39],v[116:119]
v_mfma_f32_16x16x32_bf16 v[124:127],a[236:239],v[36:39],v[124:127]
s_waitcnt lgkmcnt(4)
s_nop 0
v_mfma_f32_16x16x32_bf16 v[96:99],a[240:243],v[40:43],v[96:99]
ds_read_b64_tr_b16 v[56:57],v178 offset:34816
v_mfma_f32_16x16x32_bf16 v[104:107],a[244:247],v[40:43],v[104:107]
ds_read_b64_tr_b16 v[58:59],v178 offset:35072
v_mfma_f32_16x16x32_bf16 v[112:115],a[248:251],v[40:43],v[112:115]
ds_read_b64_tr_b16 v[60:61],v179 offset:34816
v_mfma_f32_16x16x32_bf16 v[120:123],a[252:255],v[40:43],v[120:123]
ds_read_b64_tr_b16 v[62:63],v179 offset:35072
v_mfma_f32_16x16x32_bf16 v[100:103],a[240:243],v[44:47],v[100:103]
buffer_store_dwordx4 v[136:139],v22,s[20:23],s43 offen sc1
v_mfma_f32_16x16x32_bf16 v[108:111],a[244:247],v[44:47],v[108:111]
v_mfma_f32_16x16x32_bf16 v[116:119],a[248:251],v[44:47],v[116:119]
v_mfma_f32_16x16x32_bf16 v[124:127],a[252:255],v[44:47],v[124:127]
s_waitcnt lgkmcnt(4)
s_nop 0
v_mfma_f32_16x16x32_bf16 v[96:99],v[144:147],v[48:51],v[96:99]
s_waitcnt vmcnt(22)
s_barrier
ds_read_b64_tr_b16 v[32:33],v176 offset:0
v_mfma_f32_16x16x32_bf16 v[104:107],v[148:151],v[48:51],v[104:107]
ds_read_b64_tr_b16 v[34:35],v176 offset:256
v_mfma_f32_16x16x32_bf16 v[112:115],v[152:155],v[48:51],v[112:115]
ds_read_b64_tr_b16 v[36:37],v177 offset:0
v_mfma_f32_16x16x32_bf16 v[120:123],v[156:159],v[48:51],v[120:123]
ds_read_b64_tr_b16 v[38:39],v177 offset:256
v_mfma_f32_16x16x32_bf16 v[100:103],v[144:147],v[52:55],v[100:103]
buffer_store_dwordx4 v[140:143],v23,s[20:23],s43 offen sc1
v_mfma_f32_16x16x32_bf16 v[108:111],v[148:151],v[52:55],v[108:111]
v_mfma_f32_16x16x32_bf16 v[116:119],v[152:155],v[52:55],v[116:119]
v_mfma_f32_16x16x32_bf16 v[124:127],v[156:159],v[52:55],v[124:127]
s_waitcnt lgkmcnt(4)
s_nop 0
v_mfma_f32_16x16x32_bf16 v[96:99],v[160:163],v[56:59],v[96:99]
ds_read_b64_tr_b16 v[40:41],v176 offset:2048
v_mfma_f32_16x16x32_bf16 v[104:107],v[164:167],v[56:59],v[104:107]
ds_read_b64_tr_b16 v[42:43],v176 offset:2304
v_mfma_f32_16x16x32_bf16 v[112:115],v[168:171],v[56:59],v[112:115]
ds_read_b64_tr_b16 v[44:45],v177 offset:2048
v_mfma_f32_16x16x32_bf16 v[120:123],v[172:175],v[56:59],v[120:123]
ds_read_b64_tr_b16 v[46:47],v177 offset:2304
v_mfma_f32_16x16x32_bf16 v[100:103],v[160:163],v[60:63],v[100:103]
v_mfma_f32_16x16x32_bf16 v[108:111],v[164:167],v[60:63],v[108:111]
v_mfma_f32_16x16x32_bf16 v[116:119],v[168:171],v[60:63],v[116:119]
v_mfma_f32_16x16x32_bf16 v[124:127],v[172:175],v[60:63],v[124:127]
s_add_u32 s27,s27,1
s_cmp_ge_u32 s27,s28
s_cbranch_scc1 k1_N576_t1
s_waitcnt lgkmcnt(4)
v_mfma_f32_16x16x32_bf16 v[64:67],a[0:3],v[32:35],0
ds_read_b64_tr_b16 v[48:49],v176 offset:4096
s_add_u32 s42,s47,s78
v_mfma_f32_16x16x32_bf16 v[72:75],a[4:7],v[32:35],0
ds_read_b64_tr_b16 v[50:51],v176 offset:4352
s_and_b32 s42,s42,s80
v_mfma_f32_16x16x32_bf16 v[80:83],a[8:11],v[32:35],0
ds_read_b64_tr_b16 v[52:53],v177 offset:4096
s_or_b32 s42,s42,s79
v_mfma_f32_16x16x32_bf16 v[88:91],a[12:15],v[32:35],0
ds_read_b64_tr_b16 v[54:55],v177 offset:4352
s_mul_i32 s42,s42,s31
v_mfma_f32_16x16x32_bf16 v[68:71],a[0:3],v[36:39],0
s_add_u32 s42,s42,s30
s_cmp_lt_u32 s47,s28
s_cselect_b32 s14,s44,0
v_mfma_f32_16x16x32_bf16 v[76:79],a[4:7],v[36:39],0
s_add_u32 s47,s47,1
s_add_u32 m0,s41,0
v_mfma_f32_16x16x32_bf16 v[84:87],a[8:11],v[36:39],0
s_nop 0
v_mfma_f32_16x16x32_bf16 v[92:95],a[12:15],v[36:39],0
s_waitcnt lgkmcnt(4)
s_nop 0
v_mfma_f32_16x16x32_bf16 v[64:67],a[16:19],v[40:43],v[64:67]
ds_read_b64_tr_b16 v[56:57],v176 offset:6144
s_sub_u32 s37,s27,1
v_mfma_f32_16x16x32_bf16 v[72:75],a[20:23],v[40:43],v[72:75]
ds_read_b64_tr_b16 v[58:59],v176 offset:6400
s_add_u32 s37,s37,s78
v_mfma_f32_16x16x32_bf16 v[80:83],a[24:27],v[40:43],v[80:83]
ds_read_b64_tr_b16 v[60:61],v177 offset:6144
s_and_b32 s37,s37,s80
v_mfma_f32_16x16x32_bf16 v[88:91],a[28:31],v[40:43],v[88:91]
ds_read_b64_tr_b16 v[62:63],v177 offset:6400
s_or_b32 s37,s37,s79
v_mfma_f32_16x16x32_bf16 v[68:71],a[16:19],v[44:47],v[68:71]
buffer_load_dwordx4 v16,s[12:15],s42 offen lds
v_mfma_f32_16x16x32_bf16 v[76:79],a[20:23],v[44:47],v[76:79]
s_add_u32 m0,s41,1024
s_add_u32 s42,s42,s29
v_mfma_f32_16x16x32_bf16 v[84:87],a[24:27],v[44:47],v[84:87]
s_mov_b32 s43,s32
s_lshl_b32 s37,s37,5
v_mfma_f32_16x16x32_bf16 v[92:95],a[28:31],v[44:47],v[92:95]
v_and_b32 v2,15,v1
s_waitcnt lgkmcnt(4)
v_mfma_f32_16x16x32_bf16 v[64:67],a[32:35],v[48:51],v[64:67]
ds_read_b64_tr_b16 v[32:33],v176 offset:8192
v_add_u32 v2,s37,v2
v_mfma_f32_16x16x32_bf16 v[72:75],a[36:39],v[48:51],v[72:75]
ds_read_b64_tr_b16 v[34:35],v176 offset:8448
v_mul_u32_u24 v3,3641,v2
v_mfma_f32_16x16x32_bf16 v[80:83],a[40:43],v[48:51],v[80:83]
ds_read_b64_tr_b16 v[36:37],v177 offset:8192
v_lshrrev_b32 v3,16,v3
v_mfma_f32_16x16x32_bf16 v[88:91],a[44:47],v[48:51],v[88:91]
ds_read_b64_tr_b16 v[38:39],v177 offset:8448
v_mul_u32_u24 v4,18,v3
v_mfma_f32_16x16x32_bf16 v[68:71],a[32:35],v[52:55],v[68:71]
buffer_load_dwordx4 v16,s[12:15],s42 offen lds
v_mfma_f32_16x16x32_bf16 v[76:79],a[36:39],v[52:55],v[76:79]
s_add_u32 m0,s41,2048
s_add_u32 s42,s42,s29
v_mfma_f32_16x16x32_bf16 v[84:87],a[40:43],v[52:55],v[84:87]
v_sub_u32 v4,v2,v4
v_lshlrev_b32 v3,18,v3
v_mfma_f32_16x16x32_bf16 v[92:95],a[44:47],v[52:55],v[92:95]
v_lshl_add_u32 v3,v4,4,v3
s_waitcnt lgkmcnt(4)
v_mfma_f32_16x16x32_bf16 v[64:67],a[48:51],v[56:59],v[64:67]
ds_read_b64_tr_b16 v[40:41],v176 offset:10240
v_add_u32_e64 v20,v3,v9
v_mfma_f32_16x16x32_bf16 v[72:75],a[52:55],v[56:59],v[72:75]
ds_read_b64_tr_b16 v[42:43],v176 offset:10496
v_add_u32 v22,4096,v20
v_mfma_f32_16x16x32_bf16 v[80:83],a[56:59],v[56:59],v[80:83]
ds_read_b64_tr_b16 v[44:45],v177 offset:10240
v_add_u32_e64 v2,16,v2
v_mfma_f32_16x16x32_bf16 v[88:91],a[60:63],v[56:59],v[88:91]
ds_read_b64_tr_b16 v[46:47],v177 offset:10496
v_mul_u32_u24 v3,3641,v2
v_mfma_f32_16x16x32_bf16 v[68:71],a[48:51],v[60:63],v[68:71]
buffer_load_dwordx4 v16,s[12:15],s42 offen lds
v_mfma_f32_16x16x32_bf16 v[76:79],a[52:55],v[60:63],v[76:79]
s_add_u32 m0,s41,3072
s_add_u32 s42,s42,s29
v_mfma_f32_16x16x32_bf16 v[84:87],a[56:59],v[60:63],v[84:87]
v_lshrrev_b32 v3,16,v3
v_mul_u32_u24 v4,18,v3
v_mfma_f32_16x16x32_bf16 v[92:95],a[60:63],v[60:63],v[92:95]
v_sub_u32 v4,v2,v4
s_waitcnt lgkmcnt(4)
v_mfma_f32_16x16x32_bf16 v[64:67],a[64:67],v[32:35],v[64:67]
ds_read_b64_tr_b16 v[48:49],v176 offset:12288
v_lshlrev_b32 v3,18,v3
v_mfma_f32_16x16x32_bf16 v[72:75],a[68:71],v[32:35],v[72:75]
ds_read_b64_tr_b16 v[50:51],v176 offset:12544
v_lshl_add_u32 v3,v4,4,v3
v_mfma_f32_16x16x32_bf16 v[80:83],a[72:75],v[32:35],v[80:83]
ds_read_b64_tr_b16 v[52:53],v177 offset:12288
v_add_u32_e64 v21,v3,v9
v_mfma_f32_16x16x32_bf16 v[88:91],a[76:79],v[32:35],v[88:91]
ds_read_b64_tr_b16 v[54:55],v177 offset:12544
v_add_u32 v23,4096,v21
v_mfma_f32_16x16x32_bf16 v[68:71],a[64:67],v[36:39],v[68:71]
buffer_load_dwordx4 v16,s[12:15],s42 offen lds
v_mfma_f32_16x16x32_bf16 v[76:79],a[68:71],v[36:39],v[76:79]
s_add_u32 m0,s41,4096
s_add_u32 s42,s42,s29
v_mfma_f32_16x16x32_bf16 v[84:87],a[72:75],v[36:39],v[84:87]
v_cvt_pk_bf16_f32 v128,v96,v97
v_cvt_pk_bf16_f32 v129,v98,v99
v_mfma_f32_16x16x32_bf16 v[92:95],a[76:79],v[36:39],v[92:95]
v_cvt_pk_bf16_f32 v130,v104,v105
s_waitcnt lgkmcnt(4)
v_mfma_f32_16x16x32_bf16 v[64:67],a[80:83],v[40:43],v[64:67]
ds_read_b64_tr_b16 v[56:57],v176 offset:14336
v_cvt_pk_bf16_f32 v131,v106,v107
v_mfma_f32_16x16x32_bf16 v[72:75],a[84:87],v[40:43],v[72:75]
ds_read_b64_tr_b16 v[58:59],v176 offset:14592
v_cvt_pk_bf16_f32 v132,v100,v101
v_mfma_f32_16x16x32_bf16 v[80:83],a[88:91],v[40:43],v[80:83]
ds_read_b64_tr_b16 v[60:61],v177 offset:14336
v_cvt_pk_bf16_f32 v133,v102,v103
v_mfma_f32_16x16x32_bf16 v[88:91],a[92:95],v[40:43],v[88:91]
ds_read_b64_tr_b16 v[62:63],v177 offset:14592
v_cvt_pk_bf16_f32 v134,v108,v109
v_mfma_f32_16x16x32_bf16 v[68:71],a[80:83],v[44:47],v[68:71]
buffer_load_dwordx4 v16,s[12:15],s42 offen lds
v_mfma_f32_16x16x32_bf16 v[76:79],a[84:87],v[44:47],v[76:79]
s_add_u32 m0,s41,5120
s_add_u32 s42,s42,s29
v_mfma_f32_16x16x32_bf16 v[84:87],a[88:91],v[44:47],v[84:87]
v_cvt_pk_bf16_f32 v135,v110,v111
v_cvt_pk_bf16_f32 v136,v112,v113
v_mfma_f32_16x16x32_bf16 v[92:95],a[92:95],v[44:47],v[92:95]
v_cvt_pk_bf16_f32 v137,v114,v115
s_waitcnt lgkmcnt(4)
v_mfma_f32_16x16x32_bf16 v[64:67],a[96:99],v[48:51],v[64:67]
ds_read_b64_tr_b16 v[32:33],v176 offset:16384
v_cvt_pk_bf16_f32 v138,v120,v121
v_mfma_f32_16x16x32_bf16 v[72:75],a[100:103],v[48:51],v[72:75]
ds_read_b64_tr_b16 v[34:35],v176 offset:16640
v_cvt_pk_bf16_f32 v139,v122,v123
v_mfma_f32_16x16x32_bf16 v[80:83],a[104:107],v[48:51],v[80:83]
ds_read_b64_tr_b16 v[36:37],v177 offset:16384
v_cvt_pk_bf16_f32 v140,v116,v117
v_mfma_f32_16x16x32_bf16 v[88:91],a[108:111],v[48:51],v[88:91]
ds_read_b64_tr_b16 v[38:39],v177 offset:16640
v_cvt_pk_bf16_f32 v141,v118,v119
v_mfma_f32_16x16x32_bf16 v[68:71],a[96:99],v[52:55],v[68:71]
buffer_load_dwordx4 v16,s[12:15],s42 offen lds
v_mfma_f32_16x16x32_bf16 v[76:79],a[100:103],v[52:55],v[76:79]
s_add_u32 m0,s41,6144
s_add_u32 s42,s42,s29
v_mfma_f32_16x16x32_bf16 v[84:87],a[104:107],v[52:55],v[84:87]
v_cvt_pk_bf16_f32 v142,v124,v125
v_cvt_pk_bf16_f32 v143,v126,v127
v_mfma_f32_16x16x32_bf16 v[92:95],a[108:111],v[52:55],v[92:95]
s_waitcnt lgkmcnt(4)
v_mfma_f32_16x16x32_bf16 v[64:67],a[112:115],v[56:59],v[64:67]
ds_read_b64_tr_b16 v[40:41],v176 offset:18432
v_mfma_f32_16x16x32_bf16 v[72:75],a[116:119],v[56:59],v[72:75]
ds_read_b64_tr_b16 v[42:43],v176 offset:18688
v_mfma_f32_16x16x32_bf16 v[80:83],a[120:123],v[56:59],v[80:83]
ds_read_b64_tr_b16 v[44:45],v177 offset:18432
v_mfma_f32_16x16x32_bf16 v[88:91],a[124:127],v[56:59],v[88:91]
ds_read_b64_tr_b16 v[46:47],v177 offset:18688
v_mfma_f32_16x16x32_bf16 v[68:71],a[112:115],v[60:63],v[68:71]
buffer_load_dwordx4 v16,s[12:15],s42 offen lds
v_mfma_f32_16x16x32_bf16 v[76:79],a[116:119],v[60:63],v[76:79]
s_add_u32 m0,s41,7168
s_add_u32 s42,s42,s29
v_mfma_f32_16x16x32_bf16 v[84:87],a[120:123],v[60:63],v[84:87]
s_nop 0
v_mfma_f32_16x16x32_bf16 v[92:95],a[124:127],v[60:63],v[92:95]
s_waitcnt lgkmcnt(4)
s_nop 0
v_mfma_f32_16x16x32_bf16 v[64:67],a[128:131],v[32:35],v[64:67]
ds_read_b64_tr_b16 v[48:49],v176 offset:20480
v_mfma_f32_16x16x32_bf16 v[72:75],a[132:135],v[32:35],v[72:75]
ds_read_b64_tr_b16 v[50:51],v176 offset:20736
v_mfma_f32_16x16x32_bf16 v[80:83],a[136:139],v[32:35],v[80:83]
ds_read_b64_tr_b16 v[52:53],v177 offset:20480
v_mfma_f32_16x16x32_bf16 v[88:91],a[140:143],v[32:35],v[88:91]
ds_read_b64_tr_b16 v[54:55],v177 offset:20736
v_mfma_f32_16x16x32_bf16 v[68:71],a[128:131],v[36:39],v[68:71]
buffer_load_dwordx4 v16,s[12:15],s42 offen lds
v_mfma_f32_16x16x32_bf16 v[76:79],a[132:135],v[36:39],v[76:79]
s_add_u32 m0,s41,8192
s_add_u32 s42,s42,s29
v_mfma_f32_16x16x32_bf16 v[84:87],a[136:139],v[36:39],v[84:87]
s_nop 0
v_mfma_f32_16x16x32_bf16 v[92:95],a[140:143],v[36:39],v[92:95]
s_waitcnt lgkmcnt(4)
s_nop 0
v_mfma_f32_16x16x32_bf16 v[64:67],a[144:147],v[40:43],v[64:67]
ds_read_b64_tr_b16 v[56:57],v176 offset:22528
v_mfma_f32_16x16x32_bf16 v[72:75],a[148:151],v[40:43],v[72:75]
ds_read_b64_tr_b16 v[58:59],v176 offset:22784
v_mfma_f32_16x16x32_bf16 v[80:83],a[152:155],v[40:43],v[80:83]
ds_read_b64_tr_b16 v[60:61],v177 offset:22528
v_mfma_f32_16x16x32_bf16 v[88:91],a[156:159],v[40:43],v[88:91]
ds_read_b64_tr_b16 v[62:63],v177 offset:22784
v_mfma_f32_16x16x32_bf16 v[68:71],a[144:147],v[44:47],v[68:71]
buffer_load_dwordx4 v16,s[12:15],s42 offen lds
v_mfma_f32_16x16x32_bf16 v[76:79],a[148:151],v[44:47],v[76:79]
s_add_u32 s41,s41,36864
s_sub_u32 s36,s41,147456
v_mfma_f32_16x16x32_bf16 v[84:87],a[152:155],v[44:47],v[84:87]
s_cmp_ge_u32 s41,147456
s_cselect_b32 s41,s36,s41
v_mfma_f32_16x16x32_bf16 v[92:95],a[156:159],v[44:47],v[92:95]
s_add_u32 s93,s93,s81
s_waitcnt lgkmcnt(4)
v_mfma_f32_16x16x32_bf16 v[64:67],a[160:163],v[48:51],v[64:67]
ds_read_b64_tr_b16 v[32:33],v176 offset:24576
s_nop 0
v_mfma_f32_16x16x32_bf16 v[72:75],a[164:167],v[48:51],v[72:75]
ds_read_b64_tr_b16 v[34:35],v176 offset:24832
v_mfma_f32_16x16x32_bf16 v[80:83],a[168:171],v[48:51],v[80:83]
ds_read_b64_tr_b16 v[36:37],v177 offset:24576
v_mfma_f32_16x16x32_bf16 v[88:91],a[172:175],v[48:51],v[88:91]
ds_read_b64_tr_b16 v[38:39],v177 offset:24832
v_mfma_f32_16x16x32_bf16 v[68:71],a[160:163],v[52:55],v[68:71]
buffer_load_dwordx4 v[180:183],v30,s[84:87],s93 offen
v_mfma_f32_16x16x32_bf16 v[76:79],a[164:167],v[52:55],v[76:79]
s_add_u32 s93,s93,s94
s_nop 0
v_mfma_f32_16x16x32_bf16 v[84:87],a[168:171],v[52:55],v[84:87]
v_mfma_f32_16x16x32_bf16 v[92:95],a[172:175],v[52:55],v[92:95]
s_waitcnt lgkmcnt(4)
s_nop 0
v_mfma_f32_16x16x32_bf16 v[64:67],a[176:179],v[56:59],v[64:67]
ds_read_b64_tr_b16 v[40:41],v176 offset:26624
v_mfma_f32_16x16x32_bf16 v[72:75],a[180:183],v[56:59],v[72:75]
ds_read_b64_tr_b16 v[42:43],v176 offset:26880
v_mfma_f32_16x16x32_bf16 v[80:83],a[184:187],v[56:59],v[80:83]
ds_read_b64_tr_b16 v[44:45],v177 offset:26624
v_mfma_f32_16x16x32_bf16 v[88:91],a[188:191],v[56:59],v[88:91]
ds_read_b64_tr_b16 v[46:47],v177 offset:26880
v_mfma_f32_16x16x32_bf16 v[68:71],a[176:179],v[60:63],v[68:71]
buffer_load_dwordx4 v[184:187],v30,s[84:87],s93 offen
v_mfma_f32_16x16x32_bf16 v[76:79],a[180:183],v[60:63],v[76:79]
s_add_u32 s93,s93,s94
s_nop 0
v_mfma_f32_16x16x32_bf16 v[84:87],a[184:187],v[60:63],v[84:87]
v_mfma_f32_16x16x32_bf16 v[92:95],a[188:191],v[60:63],v[92:95]
s_waitcnt lgkmcnt(4)
s_nop 0
v_mfma_f32_16x16x32_bf16 v[64:67],a[192:195],v[32:35],v[64:67]
ds_read_b64_tr_b16 v[48:49],v176 offset:28672
v_mfma_f32_16x16x32_bf16 v[72:75],a[196:199],v[32:35],v[72:75]
ds_read_b64_tr_b16 v[50:51],v176 offset:28928
v_mfma_f32_16x16x32_bf16 v[80:83],a[200:203],v[32:35],v[80:83]
ds_read_b64_tr_b16 v[52:53],v177 offset:28672
v_mfma_f32_16x16x32_bf16 v[88:91],a[204:207],v[32:35],v[88:91]
ds_read_b64_tr_b16 v[54:55],v177 offset:28928
v_mfma_f32_16x16x32_bf16 v[68:71],a[192:195],v[36:39],v[68:71]
buffer_load_dwordx4 v[188:191],v30,s[84:87],s93 offen
v_mfma_f32_16x16x32_bf16 v[76:79],a[196:199],v[36:39],v[76:79]
v_mfma_f32_16x16x32_bf16 v[84:87],a[200:203],v[36:39],v[84:87]
v_mfma_f32_16x16x32_bf16 v[92:95],a[204:207],v[36:39],v[92:95]
s_waitcnt lgkmcnt(4)
s_nop 0
v_mfma_f32_16x16x32_bf16 v[64:67],a[208:211],v[40:43],v[64:67]
ds_read_b64_tr_b16 v[56:57],v176 offset:30720
s_add_u32 s40,s40,36864
v_mfma_f32_16x16x32_bf16 v[72:75],a[212:215],v[40:43],v[72:75]
ds_read_b64_tr_b16 v[58:59],v176 offset:30976
s_cmp_ge_u32 s40,147456
s_cselect_b32 s40,0,s40
v_mfma_f32_16x16x32_bf16 v[80:83],a[216:219],v[40:43],v[80:83]
ds_read_b64_tr_b16 v[60:61],v177 offset:30720
v_add_u32 v178,s40,v19
v_mfma_f32_16x16x32_bf16 v[88:91],a[220:223],v[40:43],v[88:91]
ds_read_b64_tr_b16 v[62:63],v177 offset:30976
v_xor_b32 v179,32,v178
v_mfma_f32_16x16x32_bf16 v[68:71],a[208:211],v[44:47],v[68:71]
buffer_store_dwordx4 v[128:131],v20,s[20:23],s43 offen sc1
v_mfma_f32_16x16x32_bf16 v[76:79],a[212:215],v[44:47],v[76:79]
s_nop 0
v_mfma_f32_16x16x32_bf16 v[84:87],a[216:219],v[44:47],v[84:87]
v_mfma_f32_16x16x32_bf16 v[92:95],a[220:223],v[44:47],v[92:95]
s_waitcnt lgkmcnt(4)
s_nop 0
v_mfma_f32_16x16x32_bf16 v[64:67],a[224:227],v[48:51],v[64:67]
ds_read_b64_tr_b16 v[32:33],v176 offset:32768
v_mfma_f32_16x16x32_bf16 v[72:75],a[228:231],v[48:51],v[72:75]
ds_read_b64_tr_b16 v[34:35],v176 offset:33024
v_mfma_f32_16x16x32_bf16 v[80:83],a[232:235],v[48:51],v[80:83]
ds_read_b64_tr_b16 v[36:37],v177 offset:32768
v_mfma_f32_16x16x32_bf16 v[88:91],a[236:239],v[48:51],v[88:91]
ds_read_b64_tr_b16 v[38:39],v177 offset:33024
v_mfma_f32_16x16x32_bf16 v[68:71],a[224:227],v[52:55],v[68:71]
buffer_store_dwordx4 v[132:135],v21,s[20:23],s43 offen sc1
v_mfma_f32_16x16x32_bf16 v[76:79],a[228:231],v[52:55],v[76:79]
v_mfma_f32_16x16x32_bf16 v[84:87],a[232:235],v[52:55],v[84:87]
v_mfma_f32_16x16x32_bf16 v[92:95],a[236:239],v[52:55],v[92:95]
s_waitcnt lgkmcnt(4)
s_nop 0
v_mfma_f32_16x16x32_bf16 v[64:67],a[240:243],v[56:59],v[64:67]
ds_read_b64_tr_b16 v[40:41],v176 offset:34816
v_mfma_f32_16x16x32_bf16 v[72:75],a[244:247],v[56:59],v[72:75]
ds_read_b64_tr_b16 v[42:43],v176 offset:35072
v_mfma_f32_16x16x32_bf16 v[80:83],a[248:251],v[56:59],v[80:83]
ds_read_b64_tr_b16 v[44:45],v177 offset:34816
v_mfma_f32_16x16x32_bf16 v[88:91],a[252:255],v[56:59],v[88:91]
ds_read_b64_tr_b16 v[46:47],v177 offset:35072
v_mfma_f32_16x16x32_bf16 v[68:71],a[240:243],v[60:63],v[68:71]
buffer_store_dwordx4 v[136:139],v22,s[20:23],s43 offen sc1
v_mfma_f32_16x16x32_bf16 v[76:79],a[244:247],v[60:63],v[76:79]
v_mfma_f32_16x16x32_bf16 v[84:87],a[248:251],v[60:63],v[84:87]
v_mfma_f32_16x16x32_bf16 v[92:95],a[252:255],v[60:63],v[92:95]
s_waitcnt lgkmcnt(4)
s_nop 0
v_mfma_f32_16x16x32_bf16 v[64:67],v[144:147],v[32:35],v[64:67]
s_waitcnt vmcnt(22)
s_barrier
ds_read_b64_tr_b16 v[48:49],v178 offset:0
v_mfma_f32_16x16x32_bf16 v[72:75],v[148:151],v[32:35],v[72:75]
ds_read_b64_tr_b16 v[50:51],v178 offset:256
v_mfma_f32_16x16x32_bf16 v[80:83],v[152:155],v[32:35],v[80:83]
ds_read_b64_tr_b16 v[52:53],v179 offset:0
v_mfma_f32_16x16x32_bf16 v[88:91],v[156:159],v[32:35],v[88:91]
ds_read_b64_tr_b16 v[54:55],v179 offset:256
v_mfma_f32_16x16x32_bf16 v[68:71],v[144:147],v[36:39],v[68:71]
buffer_store_dwordx4 v[140:143],v23,s[20:23],s43 offen sc1
v_mfma_f32_16x16x32_bf16 v[76:79],v[148:151],v[36:39],v[76:79]
v_mfma_f32_16x16x32_bf16 v[84:87],v[152:155],v[36:39],v[84:87]
v_mfma_f32_16x16x32_bf16 v[92:95],v[156:159],v[36:39],v[92:95]
s_waitcnt lgkmcnt(4)
s_nop 0
v_mfma_f32_16x16x32_bf16 v[64:67],v[160:163],v[40:43],v[64:67]
ds_read_b64_tr_b16 v[56:57],v178 offset:2048
v_mfma_f32_16x16x32_bf16 v[72:75],v[164:167],v[40:43],v[72:75]
ds_read_b64_tr_b16 v[58:59],v178 offset:2304
v_mfma_f32_16x16x32_bf16 v[80:83],v[168:171],v[40:43],v[80:83]
ds_read_b64_tr_b16 v[60:61],v179 offset:2048
v_mfma_f32_16x16x32_bf16 v[88:91],v[172:175],v[40:43],v[88:91]
ds_read_b64_tr_b16 v[62:63],v179 offset:2304
v_mfma_f32_16x16x32_bf16 v[68:71],v[160:163],v[44:47],v[68:71]
v_mfma_f32_16x16x32_bf16 v[76:79],v[164:167],v[44:47],v[76:79]
v_mfma_f32_16x16x32_bf16 v[84:87],v[168:171],v[44:47],v[84:87]
v_mfma_f32_16x16x32_bf16 v[92:95],v[172:175],v[44:47],v[92:95]
s_add_u32 s27,s27,1
s_cmp_lt_u32 s27,s28
s_cbranch_scc1 k1_N576_l1
s_waitcnt lgkmcnt(0)
s_nop 7
s_sub_u32 s37,s27,1
s_add_u32 s37,s37,s78
s_and_b32 s37,s37,s80
s_or_b32 s37,s37,s79
s_mov_b32 s43,s32
s_lshl_b32 s37,s37,5
v_and_b32 v2,15,v1
v_add_u32_e64 v2,s37,v2
v_mul_u32_u24 v3,3641,v2
v_lshrrev_b32 v3,16,v3
v_mul_u32_u24 v4,18,v3
v_sub_u32 v4,v2,v4
v_lshlrev_b32 v3,18,v3
v_lshl_add_u32 v3,v4,4,v3
v_add_u32_e64 v20,v3,v9
v_add_u32 v22,4096,v20
v_add_u32_e64 v2,16,v2
v_mul_u32_u24 v3,3641,v2
v_lshrrev_b32 v3,16,v3
v_mul_u32_u24 v4,18,v3
v_sub_u32 v4,v2,v4
v_lshlrev_b32 v3,18,v3
v_lshl_add_u32 v3,v4,4,v3
v_add_u32_e64 v21,v3,v9
v_add_u32 v23,4096,v21
v_cvt_pk_bf16_f32 v128,v64,v65
v_cvt_pk_bf16_f32 v129,v66,v67
v_cvt_pk_bf16_f32 v130,v72,v73
v_cvt_pk_bf16_f32 v131,v74,v75
v_cvt_pk_bf16_f32 v132,v68,v69
v_cvt_pk_bf16_f32 v133,v70,v71
v_cvt_pk_bf16_f32 v134,v76,v77
v_cvt_pk_bf16_f32 v135,v78,v79
v_cvt_pk_bf16_f32 v136,v80,v81
v_cvt_pk_bf16_f32 v137,v82,v83
v_cvt_pk_bf16_f32 v138,v88,v89
v_cvt_pk_bf16_f32 v139,v90,v91
v_cvt_pk_bf16_f32 v140,v84,v85
v_cvt_pk_bf16_f32 v141,v86,v87
v_cvt_pk_bf16_f32 v142,v92,v93
v_cvt_pk_bf16_f32 v143,v94,v95
buffer_store_dwordx4 v[128:131],v20,s[20:23],s43 offen sc1
buffer_store_dwordx4 v[132:135],v21,s[20:23],s43 offen sc1
buffer_store_dwordx4 v[136:139],v22,s[20:23],s43 offen sc1
buffer_store_dwordx4 v[140:143],v23,s[20:23],s43 offen sc1
s_branch k1_Aextra
k1_N576_t1:
s_waitcnt lgkmcnt(0)
s_nop 7
s_sub_u32 s37,s27,1
s_add_u32 s37,s37,s78
s_and_b32 s37,s37,s80
s_or_b32 s37,s37,s79
s_mov_b32 s43,s32
s_lshl_b32 s37,s37,5
v_and_b32 v2,15,v1
v_add_u32_e64 v2,s37,v2
v_mul_u32_u24 v3,3641,v2
v_lshrrev_b32 v3,16,v3
v_mul_u32_u24 v4,18,v3
v_sub_u32 v4,v2,v4
v_lshlrev_b32 v3,18,v3
v_lshl_add_u32 v3,v4,4,v3
v_add_u32_e64 v20,v3,v9
v_add_u32 v22,4096,v20
v_add_u32_e64 v2,16,v2
v_mul_u32_u24 v3,3641,v2
v_lshrrev_b32 v3,16,v3
v_mul_u32_u24 v4,18,v3
v_sub_u32 v4,v2,v4
v_lshlrev_b32 v3,18,v3
v_lshl_add_u32 v3,v4,4,v3
v_add_u32_e64 v21,v3,v9
v_add_u32 v23,4096,v21
v_cvt_pk_bf16_f32 v128,v96,v97
v_cvt_pk_bf16_f32 v129,v98,v99
v_cvt_pk_bf16_f32 v130,v104,v105
v_cvt_pk_bf16_f32 v131,v106,v107
v_cvt_pk_bf16_f32 v132,v100,v101
v_cvt_pk_bf16_f32 v133,v102,v103
v_cvt_pk_bf16_f32 v134,v108,v109
v_cvt_pk_bf16_f32 v135,v110,v111
v_cvt_pk_bf16_f32 v136,v112,v113
v_cvt_pk_bf16_f32 v137,v114,v115
v_cvt_pk_bf16_f32 v138,v120,v121
v_cvt_pk_bf16_f32 v139,v122,v123
v_cvt_pk_bf16_f32 v140,v116,v117
v_cvt_pk_bf16_f32 v141,v118,v119
v_cvt_pk_bf16_f32 v142,v124,v125
v_cvt_pk_bf16_f32 v143,v126,v127
buffer_store_dwordx4 v[128:131],v20,s[20:23],s43 offen sc1
buffer_store_dwordx4 v[132:135],v21,s[20:23],s43 offen sc1
buffer_store_dwordx4 v[136:139],v22,s[20:23],s43 offen sc1
buffer_store_dwordx4 v[140:143],v23,s[20:23],s43 offen sc1
s_branch k1_Aextra
k1_Aextra:
s_cmp_lg_u32 s48,4
s_cbranch_scc1 k1_house
v_lshrrev_b32 v2,4,v1
v_lshlrev_b32 v2,18,v2
v_bfe_u32 v3,v1,1,2
v_lshlrev_b32 v3,9,v3
v_add_u32_e64 v2,v2,v3
v_bfe_u32 v3,v1,3,1
v_lshlrev_b32 v3,12,v3
v_add_u32 v2,v2,v3
v_and_b32 v3,1,v1
v_lshlrev_b32 v3,6,v3
v_add_u32_e64 v2,v2,v3
v_add_u32 v2,288,v2
v_mov_b32 v4,0x3f803f80
v_mov_b32 v5,0x3f803f80
v_mov_b32 v6,0x3f803f80
v_mov_b32 v7,0x3f803f80
s_lshl_b32 s36,s49,12
s_add_u32 s36,s36,104858624
buffer_store_dwordx4 v[4:7],v2,s[16:19],s36 offen sc1
s_add_u32 s36,s36,1048576
buffer_store_dwordx4 v[4:7],v2,s[16:19],s36 offen sc1
s_add_u32 s36,s36,1048576
buffer_store_dwordx4 v[4:7],v2,s[16:19],s36 offen sc1
s_add_u32 s36,s36,1048576
buffer_store_dwordx4 v[4:7],v2,s[16:19],s36 offen sc1
s_add_u32 s36,s36,1048576
buffer_store_dwordx4 v[4:7],v2,s[16:19],s36 offen sc1
s_add_u32 s36,s36,1048576
buffer_store_dwordx4 v[4:7],v2,s[16:19],s36 offen sc1
s_add_u32 s36,s36,1048576
buffer_store_dwordx4 v[4:7],v2,s[16:19],s36 offen sc1
s_add_u32 s36,s36,1048576
buffer_store_dwordx4 v[4:7],v2,s[16:19],s36 offen sc1
s_add_u32 s36,s36,1048576
k1_house:
s_lshl_b32 s50,s48,3
s_add_u32 s50,s50,s25
s_lshl_b32 s50,s50,2
s_add_u32 s50,s50,s24
s_mul_i32 s38,s50,24576
v_lshlrev_b32 v2,4,v1
s_mov_b32 s36,6
s_mov_b32 s12,s68
s_mov_b32 s13,s69
s_mov_b32 s14,4718592
s_mov_b32 s15,0x20000
s_mov_b32 s8,s56
s_mov_b32 s9,s57
s_mov_b32 s10,663552
s_mov_b32 s11,0x20000
k1_h1:
buffer_load_dwordx4 v[180:183],v2,s[12:15],s38 offen offset:0
buffer_load_dwordx4 v[184:187],v2,s[12:15],s38 offen offset:1024
buffer_load_dwordx4 v[188:191],v2,s[12:15],s38 offen offset:2048
buffer_load_dwordx4 v[192:195],v2,s[12:15],s38 offen offset:3072
s_add_u32 s38,s38,4096
s_sub_u32 s36,s36,1
s_cmp_lg_u32 s36,0
s_cbranch_scc1 k1_h1
s_lshl_b32 s38,s50,12
buffer_load_dwordx4 v[180:183],v2,s[8:11],s38 offen offset:0
buffer_load_dwordx4 v[184:187],v2,s[8:11],s38 offen offset:1024
buffer_load_dwordx4 v[188:191],v2,s[8:11],s38 offen offset:2048
buffer_load_dwordx4 v[192:195],v2,s[8:11],s38 offen offset:3072
k1_end:
s_endpgm
.globl attn_kernel
.p2align 8
.type attn_kernel,@function
attn_kernel:
s_cmp_lt_u32 s2,256
s_cbranch_scc1 k2_go
s_endpgm
k2_go:
s_load_dwordx2 s[48:49],s[0:1],16
s_load_dwordx2 s[50:51],s[0:1],64
s_load_dwordx2 s[52:53],s[0:1],88
v_and_b32 v1,63,v0
v_lshrrev_b32 v12,6,v0
v_lshlrev_b32 v2,4,v1
s_and_b32 s24,s2,7
s_lshr_b32 s25,s2,3
v_readfirstlane_b32 s18,v12
s_lshr_b32 s17,s25,2
s_sub_u32 s17,7,s17
s_and_b32 s25,s25,3
s_lshl_b32 s16,s24,2
s_add_u32 s16,s16,s25
v_mov_b32 v6,0xff800000
s_mov_b32 s44,729808896
s_mov_b32 s45,1400897536
v_and_b32 v5,31,v1
v_lshlrev_b32 v7,3,v5
s_and_b32 s24,s16,1
s_xor_b32 s24,s24,1
s_mul_i32 s24,s24,262140
s_add_u32 s24,s24,4
v_add_u32_e64 v7,s24,v7
v_lshrrev_b32 v12,5,v1
v_lshlrev_b32 v12,2,v12
v_sub_u32 v5,v5,v12
v_and_b32 v12,31,v1
v_cmp_gt_u32 s[24:25],19,v12
v_cmp_eq_u32 s[26:27],22,v12
v_mov_b32 v248,0x80000000
s_or_b64 vcc,s[24:25],s[26:27]
v_cndmask_b32 v248,v248,v2,vcc
v_cmp_gt_i32 s[64:65],0,v5
v_cmp_gt_i32 s[66:67],1,v5
v_cmp_gt_i32 s[68:69],2,v5
v_cmp_gt_i32 s[70:71],3,v5
v_cmp_gt_i32 s[72:73],8,v5
v_cmp_gt_i32 s[74:75],9,v5
v_cmp_gt_i32 s[76:77],10,v5
v_cmp_gt_i32 s[78:79],11,v5
v_cmp_gt_i32 s[80:81],16,v5
v_cmp_gt_i32 s[82:83],17,v5
v_cmp_gt_i32 s[84:85],18,v5
v_cmp_gt_i32 s[86:87],19,v5
v_cmp_gt_i32 s[88:89],24,v5
v_cmp_gt_i32 s[90:91],25,v5
v_cmp_gt_i32 s[92:93],26,v5
v_cmp_gt_i32 s[94:95],27,v5
v_cmp_lt_u32 s[96:97],31,v1
s_getpc_b64 s[24:25]
attn_kernel_pc:
s_lshr_b32 s26,s2,3
s_lshl_b32 s26,s26,2
s_add_u32 s26,s26,s18
s_lshl_b32 s26,s26,10
v_add_u32 v12,s26,v2
v_min_u32 v12,oproj_kernel-attn_kernel_pc-16,v12
v_and_b32 v12,-4,v12
global_load_dwordx4 v[252:255],v12,s[24:25]
s_lshl_b32 s20,s17,2
s_lshl_b32 s61,s17,3
s_add_u32 s56,s61,7
s_add_u32 s61,s61,s18
s_sub_u32 s56,s56,s18
s_sub_u32 s21,s20,1
s_cmp_eq_u32 s18,0
s_cselect_b32 s21,s21,0x7fffffff
s_lshl_b32 s62,s16,20
s_add_u32 s62,s62,16777216
s_lshl_b32 s23,s18,13
s_add_u32 s22,s62,s23
s_sub_u32 s22,s22,28672
s_mov_b32 s19,0
s_mov_b32 s47,32768
s_lshl_b32 s4,s16,6
s_add_u32 s4,s4,s61
s_lshl_b32 s4,s4,13
s_add_u32 s4,s4,0
s_lshl_b32 s5,s16,6
s_add_u32 s5,s5,s56
s_lshl_b32 s5,s5,13
s_add_u32 s5,s5,0
s_lshl_b32 s36,s16,18
s_add_u32 s36,s36,104857600
s_lshl_b32 s24,s17,2
s_lshr_b32 s40,37966708,s24
s_and_b32 s40,s40,15
s_lshr_b32 s57,35721232,s24
s_and_b32 s57,s57,15
s_mov_b32 s25,1077819956
s_cmp_lt_u32 s17,4
s_cselect_b32 s25,706613248,s25
s_lshl_b32 s24,s17,3
s_lshr_b32 s37,s25,s24
s_and_b32 s37,s37,255
s_lshr_b32 s60,16,s57
s_lshr_b32 s24,s18,s57
s_lshl_b32 s25,s24,s57
s_sub_u32 s58,s18,s25
s_mul_i32 s24,s24,s40
s_add_u32 s37,s37,s24
s_mul_i32 s59,s58,s60
s_lshl_b32 s59,s59,14
s_add_u32 s59,s59,s36
s_lshl_b32 s39,s16,6
s_add_u32 s39,s39,s37
s_lshl_b32 s39,s39,12
s_add_u32 s39,s39,96468992
s_mov_b32 s41,s36
s_mov_b32 s46,3
s_waitcnt lgkmcnt(0)
s_mov_b32 s8,s52
s_mov_b32 s9,s53
s_mov_b32 s10,268435456
s_mov_b32 s11,0x20000
s_mov_b32 s12,s52
s_mov_b32 s13,s53
s_mov_b32 s14,268435456
s_mov_b32 s15,0x20000
s_sub_u32 s52,s8,262144
s_subb_u32 s53,s9,0
s_mov_b32 s54,268435456
s_mov_b32 s55,0x20000
s_cmp_lg_u32 s40,0
s_cbranch_scc1 a_go
s_mov_b32 s43,s23
s_add_u32 s23,s23,32768
s_add_u32 m0,s43,0
s_add_u32 s22,s22,28672
buffer_load_dwordx4 v2,s[12:15],s22 offen offset:0 lds
buffer_load_dwordx4 v2,s[12:15],s22 offen offset:1024 lds
buffer_load_dwordx4 v2,s[12:15],s22 offen offset:2048 lds
buffer_load_dwordx4 v2,s[12:15],s22 offen offset:3072 lds
s_add_u32 m0,s43,4096
s_add_u32 s22,s22,4096
buffer_load_dwordx4 v2,s[12:15],s22 offen offset:0 lds
buffer_load_dwordx4 v2,s[12:15],s22 offen offset:1024 lds
buffer_load_dwordx4 v2,s[12:15],s22 offen offset:2048 lds
buffer_load_dwordx4 v2,s[12:15],s22 offen offset:3072 lds
buffer_load_dwordx4 a[128:131],v2,s[8:11],s4 offen offset:0
buffer_load_dwordx4 a[132:135],v2,s[8:11],s4 offen offset:1024
buffer_load_dwordx4 a[136:139],v2,s[8:11],s4 offen offset:2048
buffer_load_dwordx4 a[140:143],v2,s[8:11],s4 offen offset:3072
s_add_u32 s4,s4,4096
buffer_load_dwordx4 a[144:147],v2,s[8:11],s4 offen offset:0
buffer_load_dwordx4 a[148:151],v2,s[8:11],s4 offen offset:1024
buffer_load_dwordx4 a[152:155],v2,s[8:11],s4 offen offset:2048
buffer_load_dwordx4 a[156:159],v2,s[8:11],s4 offen offset:3072
buffer_load_dwordx4 a[160:163],v2,s[8:11],s5 offen offset:0
buffer_load_dwordx4 a[164:167],v2,s[8:11],s5 offen offset:1024
buffer_load_dwordx4 a[168:171],v2,s[8:11],s5 offen offset:2048
buffer_load_dwordx4 a[172:175],v2,s[8:11],s5 offen offset:3072
s_add_u32 s5,s5,4096
buffer_load_dwordx4 a[176:179],v2,s[8:11],s5 offen offset:0
buffer_load_dwordx4 a[180:183],v2,s[8:11],s5 offen offset:1024
buffer_load_dwordx4 a[184:187],v2,s[8:11],s5 offen offset:2048
buffer_load_dwordx4 a[188:191],v2,s[8:11],s5 offen offset:3072
s_mov_b32 s43,s23
s_add_u32 s23,s23,32768
s_add_u32 m0,s43,0
s_add_u32 s22,s22,28672
buffer_load_dwordx4 v2,s[12:15],s22 offen offset:0 lds
buffer_load_dwordx4 v2,s[12:15],s22 offen offset:1024 lds
buffer_load_dwordx4 v2,s[12:15],s22 offen offset:2048 lds
buffer_load_dwordx4 v2,s[12:15],s22 offen offset:3072 lds
s_add_u32 m0,s43,4096
s_add_u32 s22,s22,4096
buffer_load_dwordx4 v2,s[12:15],s22 offen offset:0 lds
buffer_load_dwordx4 v2,s[12:15],s22 offen offset:1024 lds
buffer_load_dwordx4 v2,s[12:15],s22 offen offset:2048 lds
buffer_load_dwordx4 v2,s[12:15],s22 offen offset:3072 lds
s_lshl_b32 s24,s2,2
s_add_u32 s24,s24,s18
s_mul_i32 s24,s24,4608
s_add_u32 s24,s24,90177536
s_add_u32 s25,s24,3584
v_mov_b32 v244,-1
v_mov_b32 v245,-1
v_mov_b32 v246,-1
v_mov_b32_e64 v247,-1
buffer_store_dwordx4 v[244:247],v2,s[8:11],s24 offen offset:0
buffer_store_dwordx4 v[244:247],v2,s[8:11],s24 offen offset:1024
buffer_store_dwordx4 v[244:247],v2,s[8:11],s24 offen offset:2048
buffer_store_dwordx4 v[244:247],v2,s[8:11],s24 offen offset:3072
buffer_store_dwordx4 v[244:247],v2,s[8:11],s25 offen
s_waitcnt vmcnt(13)
s_branch k2_B3
a_go:
buffer_load_dwordx4 a[48:51],v2,s[8:11],s41 offen
buffer_load_dword a52,v7,s[52:55],s41 offen offset:3072
buffer_load_dwordx4 v[64:67],v2,s[8:11],s39 offen
buffer_load_dword v68,v7,s[52:55],s39 offen offset:3072
s_add_u32 s39,s39,4096
buffer_load_dwordx4 v[72:75],v2,s[8:11],s39 offen
buffer_load_dword v76,v7,s[52:55],s39 offen offset:3072
s_add_u32 s39,s39,4096
s_cmp_eq_u32 s40,2
s_cbranch_scc1 a_q
buffer_load_dwordx4 v[80:83],v2,s[8:11],s39 offen
buffer_load_dword v84,v7,s[52:55],s39 offen offset:3072
s_add_u32 s39,s39,4096
s_cmp_eq_u32 s40,3
s_cbranch_scc1 a_q
buffer_load_dwordx4 v[88:91],v2,s[8:11],s39 offen
buffer_load_dword v92,v7,s[52:55],s39 offen offset:3072
s_add_u32 s39,s39,4096
s_cmp_eq_u32 s40,4
s_cbranch_scc1 a_q
buffer_load_dwordx4 v[96:99],v2,s[8:11],s39 offen
buffer_load_dword v100,v7,s[52:55],s39 offen offset:3072
s_add_u32 s39,s39,4096
s_cmp_eq_u32 s40,5
s_cbranch_scc1 a_q
buffer_load_dwordx4 v[104:107],v2,s[8:11],s39 offen
buffer_load_dword v108,v7,s[52:55],s39 offen offset:3072
s_add_u32 s39,s39,4096
buffer_load_dwordx4 v[112:115],v2,s[8:11],s39 offen
buffer_load_dword v116,v7,s[52:55],s39 offen offset:3072
s_add_u32 s39,s39,4096
a_q:
s_mov_b32 s41,s59
buffer_load_dwordx4 a[0:3],v2,s[8:11],s41 offen
buffer_load_dword a4,v7,s[52:55],s41 offen offset:3072
buffer_load_dwordx4 a[8:11],v248,s[8:11],s41 offen offset:1024
buffer_load_dwordx4 a[12:15],v248,s[8:11],s41 offen offset:2048
s_add_u32 s41,s41,4096
buffer_load_dwordx4 a[16:19],v2,s[8:11],s41 offen
buffer_load_dword a20,v7,s[52:55],s41 offen offset:3072
buffer_load_dwordx4 a[24:27],v248,s[8:11],s41 offen offset:1024
buffer_load_dwordx4 a[28:31],v248,s[8:11],s41 offen offset:2048
s_add_u32 s41,s41,4096
buffer_load_dwordx4 a[32:35],v2,s[8:11],s41 offen
buffer_load_dword a36,v7,s[52:55],s41 offen offset:3072
buffer_load_dwordx4 a[40:43],v248,s[8:11],s41 offen offset:1024
buffer_load_dwordx4 a[44:47],v248,s[8:11],s41 offen offset:2048
s_add_u32 s41,s41,4096
s_mov_b32 s28,s48
s_mov_b32 s29,s49
s_mov_b32 s30,663552
s_mov_b32 s31,0x20000
s_mov_b32 s32,s50
s_mov_b32 s33,s51
s_mov_b32 s34,4718592
s_mov_b32 s35,0x20000
s_cmp_eq_u32 s17,0
s_cselect_b32 s46,0,s46
s_cmp_eq_u32 s17,2
s_cselect_b32 s46,1,s46
s_cmp_eq_u32 s17,4
s_cselect_b32 s46,2,s46
s_cmp_eq_u32 s46,3
s_cbranch_scc1 k2_nowo
s_lshl_b32 s24,s16,2
s_add_u32 s24,s24,s18
s_mul_i32 s42,s18,24576
s_add_u32 s42,s42,74752
v_lshrrev_b32 v20,2,v1
v_mul_u32_u24 v21,1152,v20
v_and_b32 v22,3,v1
v_lshlrev_b32 v22,4,v22
v_add_u32_e64 v240,v21,v22
s_mul_i32 s25,s24,36864
s_mul_i32 s26,s46,384
s_add_u32 s25,s25,s26
s_lshl_b32 s48,s24,11
s_mul_i32 s27,s46,1572864
s_add_u32 s48,s48,s27
s_add_u32 s48,s48,136314880
s_add_u32 m0,s42,0
s_nop 0
buffer_load_dwordx4 v240,s[32:35],s25 offen offset:0 lds
s_add_u32 m0,s42,960
s_nop 0
buffer_load_dwordx4 v240,s[32:35],s25 offen offset:64 lds
s_add_u32 m0,s42,1920
s_nop 0
buffer_load_dwordx4 v240,s[32:35],s25 offen offset:128 lds
s_add_u32 m0,s42,2880
s_nop 0
buffer_load_dwordx4 v240,s[32:35],s25 offen offset:192 lds
s_add_u32 m0,s42,3840
s_nop 0
buffer_load_dwordx4 v240,s[32:35],s25 offen offset:256 lds
s_add_u32 m0,s42,4800
s_nop 0
buffer_load_dwordx4 v240,s[32:35],s25 offen offset:320 lds
s_add_u32 m0,s42,6144
s_add_u32 s25,s25,18432
buffer_load_dwordx4 v240,s[32:35],s25 offen offset:0 lds
s_add_u32 m0,s42,7104
s_nop 0
buffer_load_dwordx4 v240,s[32:35],s25 offen offset:64 lds
s_add_u32 m0,s42,8064
s_nop 0
buffer_load_dwordx4 v240,s[32:35],s25 offen offset:128 lds
s_add_u32 m0,s42,9024
s_nop 0
buffer_load_dwordx4 v240,s[32:35],s25 offen offset:192 lds
s_add_u32 m0,s42,9984
s_nop 0
buffer_load_dwordx4 v240,s[32:35],s25 offen offset:256 lds
s_add_u32 m0,s42,10944
s_nop 0
buffer_load_dwordx4 v240,s[32:35],s25 offen offset:320 lds
v_bfe_u32 v23,v20,2,1
v_lshlrev_b32 v23,2,v23
v_lshrrev_b32 v24,3,v20
v_lshlrev_b32 v24,1,v24
v_add_u32_e64 v23,v23,v24
v_bfe_u32 v24,v20,1,1
v_add_u32 v23,v23,v24
v_mul_u32_u24 v23,18,v23
v_and_b32 v24,1,v20
v_add_u32 v23,v23,v24
v_add_u32_e64 v23,16,v23
v_mul_u32_u24 v23,1152,v23
v_add_u32_e64 v241,v23,v22
s_mul_i32 s27,s46,6
s_lshl_b32 s25,s18,1
s_add_u32 s25,s25,s27
s_mov_b32 s24,s16
s_mul_i32 s26,s16,20736
s_cmp_lg_u32 s18,3
s_cbranch_scc1 k2_wo1
s_and_b32 s24,s16,3
s_mul_i32 s26,s24,165888
s_add_u32 s24,s24,32
s_lshr_b32 s25,s16,2
s_min_u32 s25,s25,2
s_lshl_b32 s25,s25,1
s_add_u32 s25,s25,s27
v_mov_b32_e64 v240,v241
k2_wo1:
s_mul_i32 s49,s25,36864
s_lshl_b32 s24,s24,10
s_add_u32 s49,s49,s24
s_add_u32 s49,s49,88080384
s_lshl_b32 s25,s25,6
s_add_u32 s26,s26,s25
s_add_u32 m0,s42,12288
s_nop 0
buffer_load_dwordx4 v240,s[28:31],s26 offen offset:0 lds
s_add_u32 m0,s42,13248
s_nop 0
buffer_load_dwordx4 v240,s[28:31],s26 offen offset:64 lds
k2_nowo:
s_lshl_b32 s24,s2,2
s_add_u32 s24,s24,s18
s_mul_i32 s24,s24,4608
s_add_u32 s24,s24,90177536
s_add_u32 s25,s24,3584
v_mov_b32 v244,-1
v_mov_b32 v245,-1
v_mov_b32 v246,-1
v_mov_b32 v247,-1
buffer_store_dwordx4 v[244:247],v2,s[8:11],s24 offen offset:0
buffer_store_dwordx4 v[244:247],v2,s[8:11],s24 offen offset:1024
buffer_store_dwordx4 v[244:247],v2,s[8:11],s24 offen offset:2048
buffer_store_dwordx4 v[244:247],v2,s[8:11],s24 offen offset:3072
buffer_store_dwordx4 v[244:247],v2,s[8:11],s25 offen
v_mov_b32 v13,0x3f80
s_cmp_eq_u32 s40,3
s_cbranch_scc1 att3
s_cmp_eq_u32 s40,4
s_cbranch_scc1 att4
s_cmp_eq_u32 s40,5
s_cbranch_scc1 att5
s_cmp_eq_u32 s40,7
s_cbranch_scc1 att7
att2:
v_accvgpr_write_b32 a5,v13
v_accvgpr_write_b32 a6,0
v_accvgpr_write_b32 a7,0
v_accvgpr_write_b32 a21,v13
v_accvgpr_write_b32 a22,0
v_accvgpr_write_b32 a23,0
v_accvgpr_write_b32 a37,v13
v_accvgpr_write_b32 a38,0
v_accvgpr_write_b32 a39,0
v_accvgpr_write_b32 a53,v13
v_accvgpr_write_b32 a54,0
v_accvgpr_write_b32 a55,0
v_mov_b32 v69,0
v_mov_b32 v70,0
v_mov_b32 v71,0
v_mov_b32 v77,0
v_mov_b32 v78,0
v_mov_b32 v79,0
v_mov_b32 v48,0
v_mov_b32 v49,0
v_mov_b32 v50,0
v_mov_b32 v51,0
v_mov_b32 v52,0
v_mov_b32 v53,0
v_mov_b32 v54,0
v_mov_b32 v55,0
v_mov_b32 v56,0
v_mov_b32 v57,0
v_mov_b32 v58,0
v_mov_b32 v59,0
v_mov_b32 v60,0
v_mov_b32 v61,0
v_mov_b32 v62,0
v_mov_b32_e64 v63,0
s_nop 1
v_mfma_f32_32x32x16_bf16 v[120:135],v[48:51],v[48:51],0
v_mfma_f32_32x32x16_bf16 v[136:151],v[48:51],v[48:51],0
v_accvgpr_write_b32 a56,0
v_accvgpr_write_b32 a57,0
v_accvgpr_write_b32 a58,0
v_accvgpr_write_b32 a59,0
v_accvgpr_write_b32 a60,0
v_accvgpr_write_b32 a61,0
v_accvgpr_write_b32 a62,0
v_accvgpr_write_b32 a63,0
s_waitcnt vmcnt(17)
v_cndmask_b32 v68,v68,0,s[96:97]
v_cndmask_b32 v76,v76,0,s[96:97]
s_nop 0
v_mfma_f32_32x32x16_bf16 v[16:31],a[48:51],v[64:67],0
v_mfma_f32_32x32x16_bf16 v[16:31],a[52:55],v[68:71],v[16:31]
v_mfma_f32_32x32x16_bf16 v[32:47],a[48:51],v[72:75],0
v_mfma_f32_32x32x16_bf16 v[32:47],a[52:55],v[76:79],v[32:47]
s_nop 9
v_max_f32 v10,v16,v17
v_max3_f32 v10,v10,v18,v19
v_max3_f32 v10,v10,v20,v21
v_max3_f32 v10,v10,v22,v23
v_max3_f32 v10,v10,v24,v25
v_max3_f32 v10,v10,v26,v27
v_max3_f32 v10,v10,v28,v29
v_max3_f32 v10,v10,v30,v31
v_mov_b32 v12,v10
s_nop 1
v_permlane32_swap_b32 v10,v12
v_max_f32 v10,v10,v12
v_sub_f32_e64 v10,0,v10
v_cvt_pk_bf16_f32 v10,v10,0
v_cndmask_b32 v69,v10,0,s[96:97]
v_max_f32_e64 v10,v32,v33
v_max3_f32 v10,v10,v34,v35
v_max3_f32 v10,v10,v36,v37
v_max3_f32 v10,v10,v38,v39
v_max3_f32 v10,v10,v40,v41
v_max3_f32 v10,v10,v42,v43
v_max3_f32 v10,v10,v44,v45
v_max3_f32 v10,v10,v46,v47
v_mov_b32 v12,v10
s_nop 1
v_permlane32_swap_b32 v10,v12
v_max_f32 v10,v10,v12
v_sub_f32_e64 v10,0,v10
v_cvt_pk_bf16_f32 v10,v10,0
v_cndmask_b32 v77,v10,0,s[96:97]
s_mov_b32 s39,s60
s_waitcnt vmcnt(13)
v_mfma_f32_32x32x16_bf16 v[16:31],a[0:3],v[64:67],0
v_mfma_f32_32x32x16_bf16 v[16:31],a[4:7],v[68:71],v[16:31]
s_nop 9
s_sub_u32 s39,s39,1
att2_loop:
v_mfma_f32_32x32x16_bf16 v[32:47],a[0:3],v[72:75],0
buffer_load_dwordx4 a[48:51],v2,s[8:11],s41 offen
v_exp_f32 v16,v16
v_exp_f32 v17,v17
v_exp_f32 v18,v18
v_exp_f32 v19,v19
v_cvt_pk_bf16_f32 v48,v16,v17
v_cvt_pk_bf16_f32 v49,v18,v19
v_mfma_f32_32x32x16_bf16 v[32:47],a[4:7],v[76:79],v[32:47]
buffer_load_dword a52,v7,s[52:55],s41 offen offset:3072
v_exp_f32 v20,v20
v_exp_f32 v21,v21
v_exp_f32 v22,v22
v_exp_f32 v23,v23
v_cvt_pk_bf16_f32 v50,v20,v21
v_cvt_pk_bf16_f32 v51,v22,v23
v_mfma_f32_32x32x16_bf16 v[136:151],a[56:59],v[56:59],v[136:151]
v_exp_f32 v24,v24
v_exp_f32 v25,v25
v_exp_f32 v26,v26
v_exp_f32 v27,v27
v_cvt_pk_bf16_f32 v52,v24,v25
v_cvt_pk_bf16_f32 v53,v26,v27
v_mfma_f32_32x32x16_bf16 v[136:151],a[60:63],v[60:63],v[136:151]
buffer_load_dwordx4 a[56:59],v248,s[8:11],s41 offen offset:1024
v_exp_f32 v28,v28
v_exp_f32 v29,v29
v_exp_f32 v30,v30
v_exp_f32 v31,v31
v_cvt_pk_bf16_f32 v54,v28,v29
v_cvt_pk_bf16_f32 v55,v30,v31
s_waitcnt vmcnt(7)
v_mfma_f32_32x32x16_bf16 v[16:31],a[16:19],v[64:67],0
buffer_load_dwordx4 a[60:63],v248,s[8:11],s41 offen offset:2048
s_add_u32 s41,s41,4096
v_exp_f32 v32,v32
v_exp_f32 v33,v33
v_exp_f32 v34,v34
v_exp_f32_e64 v35,v35
v_cvt_pk_bf16_f32 v56,v32,v33
v_cvt_pk_bf16_f32 v57,v34,v35
v_mfma_f32_32x32x16_bf16 v[16:31],a[20:23],v[68:71],v[16:31]
v_exp_f32 v36,v36
v_exp_f32 v37,v37
v_exp_f32 v38,v38
v_exp_f32 v39,v39
v_cvt_pk_bf16_f32 v58,v36,v37
v_cvt_pk_bf16_f32 v59,v38,v39
v_mfma_f32_32x32x16_bf16 v[120:135],a[8:11],v[48:51],v[120:135]
v_exp_f32 v40,v40
v_exp_f32 v41,v41
v_exp_f32 v42,v42
v_exp_f32 v43,v43
v_cvt_pk_bf16_f32 v60,v40,v41
v_cvt_pk_bf16_f32 v61,v42,v43
v_mfma_f32_32x32x16_bf16 v[120:135],a[12:15],v[52:55],v[120:135]
v_exp_f32 v44,v44
v_exp_f32 v45,v45
v_exp_f32 v46,v46
v_exp_f32 v47,v47
v_cvt_pk_bf16_f32 v62,v44,v45
v_cvt_pk_bf16_f32 v63,v46,v47
v_mfma_f32_32x32x16_bf16 v[32:47],a[16:19],v[72:75],0
buffer_load_dwordx4 a[0:3],v2,s[8:11],s41 offen
v_exp_f32 v16,v16
v_exp_f32 v17,v17
v_exp_f32 v18,v18
v_exp_f32 v19,v19
v_cvt_pk_bf16_f32 v48,v16,v17
v_cvt_pk_bf16_f32 v49,v18,v19
v_mfma_f32_32x32x16_bf16 v[32:47],a[20:23],v[76:79],v[32:47]
buffer_load_dword a4,v7,s[52:55],s41 offen offset:3072
v_exp_f32 v20,v20
v_exp_f32 v21,v21
v_exp_f32 v22,v22
v_exp_f32 v23,v23
v_cvt_pk_bf16_f32 v50,v20,v21
v_cvt_pk_bf16_f32 v51,v22,v23
v_mfma_f32_32x32x16_bf16 v[136:151],a[8:11],v[56:59],v[136:151]
v_exp_f32 v24,v24
v_exp_f32 v25,v25
v_exp_f32 v26,v26
v_exp_f32 v27,v27
v_cvt_pk_bf16_f32 v52,v24,v25
v_cvt_pk_bf16_f32 v53,v26,v27
v_mfma_f32_32x32x16_bf16 v[136:151],a[12:15],v[60:63],v[136:151]
buffer_load_dwordx4 a[8:11],v248,s[8:11],s41 offen offset:1024
v_exp_f32 v28,v28
v_exp_f32 v29,v29
v_exp_f32 v30,v30
v_exp_f32 v31,v31
v_cvt_pk_bf16_f32 v54,v28,v29
v_cvt_pk_bf16_f32 v55,v30,v31
s_waitcnt vmcnt(7)
v_mfma_f32_32x32x16_bf16 v[16:31],a[32:35],v[64:67],0
buffer_load_dwordx4 a[12:15],v248,s[8:11],s41 offen offset:2048
s_add_u32 s41,s41,4096
v_exp_f32 v32,v32
v_exp_f32 v33,v33
v_exp_f32 v34,v34
v_exp_f32_e64 v35,v35
v_cvt_pk_bf16_f32 v56,v32,v33
v_cvt_pk_bf16_f32 v57,v34,v35
v_mfma_f32_32x32x16_bf16 v[16:31],a[36:39],v[68:71],v[16:31]
v_exp_f32 v36,v36
v_exp_f32 v37,v37
v_exp_f32 v38,v38
v_exp_f32 v39,v39
v_cvt_pk_bf16_f32 v58,v36,v37
v_cvt_pk_bf16_f32 v59,v38,v39
v_mfma_f32_32x32x16_bf16 v[120:135],a[24:27],v[48:51],v[120:135]
v_exp_f32 v40,v40
v_exp_f32 v41,v41
v_exp_f32 v42,v42
v_exp_f32 v43,v43
v_cvt_pk_bf16_f32 v60,v40,v41
v_cvt_pk_bf16_f32 v61,v42,v43
v_mfma_f32_32x32x16_bf16 v[120:135],a[28:31],v[52:55],v[120:135]
v_exp_f32 v44,v44
v_exp_f32 v45,v45
v_exp_f32 v46,v46
v_exp_f32 v47,v47
v_cvt_pk_bf16_f32 v62,v44,v45
v_cvt_pk_bf16_f32 v63,v46,v47
v_mfma_f32_32x32x16_bf16 v[32:47],a[32:35],v[72:75],0
buffer_load_dwordx4 a[16:19],v2,s[8:11],s41 offen
v_exp_f32 v16,v16
v_exp_f32 v17,v17
v_exp_f32 v18,v18
v_exp_f32 v19,v19
v_cvt_pk_bf16_f32 v48,v16,v17
v_cvt_pk_bf16_f32 v49,v18,v19
v_mfma_f32_32x32x16_bf16 v[32:47],a[36:39],v[76:79],v[32:47]
buffer_load_dword a20,v7,s[52:55],s41 offen offset:3072
v_exp_f32 v20,v20
v_exp_f32 v21,v21
v_exp_f32 v22,v22
v_exp_f32 v23,v23
v_cvt_pk_bf16_f32 v50,v20,v21
v_cvt_pk_bf16_f32 v51,v22,v23
v_mfma_f32_32x32x16_bf16 v[136:151],a[24:27],v[56:59],v[136:151]
v_exp_f32 v24,v24
v_exp_f32 v25,v25
v_exp_f32 v26,v26
v_exp_f32 v27,v27
v_cvt_pk_bf16_f32 v52,v24,v25
v_cvt_pk_bf16_f32 v53,v26,v27
v_mfma_f32_32x32x16_bf16 v[136:151],a[28:31],v[60:63],v[136:151]
buffer_load_dwordx4 a[24:27],v248,s[8:11],s41 offen offset:1024
v_exp_f32 v28,v28
v_exp_f32 v29,v29
v_exp_f32 v30,v30
v_exp_f32 v31,v31
v_cvt_pk_bf16_f32 v54,v28,v29
v_cvt_pk_bf16_f32 v55,v30,v31
s_waitcnt vmcnt(7)
v_mfma_f32_32x32x16_bf16 v[16:31],a[48:51],v[64:67],0
buffer_load_dwordx4 a[28:31],v248,s[8:11],s41 offen offset:2048
s_add_u32 s41,s41,4096
v_exp_f32 v32,v32
v_exp_f32 v33,v33
v_exp_f32 v34,v34
v_exp_f32_e64 v35,v35
v_cvt_pk_bf16_f32 v56,v32,v33
v_cvt_pk_bf16_f32 v57,v34,v35
v_mfma_f32_32x32x16_bf16 v[16:31],a[52:55],v[68:71],v[16:31]
v_exp_f32 v36,v36
v_exp_f32 v37,v37
v_exp_f32 v38,v38
v_exp_f32 v39,v39
v_cvt_pk_bf16_f32 v58,v36,v37
v_cvt_pk_bf16_f32 v59,v38,v39
v_mfma_f32_32x32x16_bf16 v[120:135],a[40:43],v[48:51],v[120:135]
v_exp_f32 v40,v40
v_exp_f32 v41,v41
v_exp_f32 v42,v42
v_exp_f32 v43,v43
v_cvt_pk_bf16_f32 v60,v40,v41
v_cvt_pk_bf16_f32 v61,v42,v43
v_mfma_f32_32x32x16_bf16 v[120:135],a[44:47],v[52:55],v[120:135]
v_exp_f32 v44,v44
v_exp_f32 v45,v45
v_exp_f32 v46,v46
v_exp_f32 v47,v47
v_cvt_pk_bf16_f32 v62,v44,v45
v_cvt_pk_bf16_f32 v63,v46,v47
v_mfma_f32_32x32x16_bf16 v[32:47],a[48:51],v[72:75],0
buffer_load_dwordx4 a[32:35],v2,s[8:11],s41 offen
v_exp_f32 v16,v16
v_exp_f32 v17,v17
v_exp_f32 v18,v18
v_exp_f32 v19,v19
v_cvt_pk_bf16_f32 v48,v16,v17
v_cvt_pk_bf16_f32 v49,v18,v19
v_mfma_f32_32x32x16_bf16 v[32:47],a[52:55],v[76:79],v[32:47]
buffer_load_dword a36,v7,s[52:55],s41 offen offset:3072
v_exp_f32 v20,v20
v_exp_f32 v21,v21
v_exp_f32 v22,v22
v_exp_f32 v23,v23
v_cvt_pk_bf16_f32 v50,v20,v21
v_cvt_pk_bf16_f32 v51,v22,v23
v_mfma_f32_32x32x16_bf16 v[136:151],a[40:43],v[56:59],v[136:151]
v_exp_f32 v24,v24
v_exp_f32 v25,v25
v_exp_f32 v26,v26
v_exp_f32 v27,v27
v_cvt_pk_bf16_f32 v52,v24,v25
v_cvt_pk_bf16_f32 v53,v26,v27
v_mfma_f32_32x32x16_bf16 v[136:151],a[44:47],v[60:63],v[136:151]
buffer_load_dwordx4 a[40:43],v248,s[8:11],s41 offen offset:1024
v_exp_f32 v28,v28
v_exp_f32 v29,v29
v_exp_f32 v30,v30
v_exp_f32 v31,v31
v_cvt_pk_bf16_f32 v54,v28,v29
v_cvt_pk_bf16_f32 v55,v30,v31
s_waitcnt vmcnt(7)
v_mfma_f32_32x32x16_bf16 v[16:31],a[0:3],v[64:67],0
buffer_load_dwordx4 a[44:47],v248,s[8:11],s41 offen offset:2048
s_add_u32 s41,s41,4096
v_exp_f32 v32,v32
v_exp_f32 v33,v33
v_exp_f32 v34,v34
v_exp_f32_e64 v35,v35
v_cvt_pk_bf16_f32 v56,v32,v33
v_cvt_pk_bf16_f32 v57,v34,v35
v_mfma_f32_32x32x16_bf16 v[16:31],a[4:7],v[68:71],v[16:31]
v_exp_f32 v36,v36
v_exp_f32 v37,v37
v_exp_f32 v38,v38
v_exp_f32 v39,v39
v_cvt_pk_bf16_f32 v58,v36,v37
v_cvt_pk_bf16_f32 v59,v38,v39
v_mfma_f32_32x32x16_bf16 v[120:135],a[56:59],v[48:51],v[120:135]
v_exp_f32 v40,v40
v_exp_f32 v41,v41
v_exp_f32 v42,v42
v_exp_f32 v43,v43
v_cvt_pk_bf16_f32 v60,v40,v41
v_cvt_pk_bf16_f32 v61,v42,v43
v_mfma_f32_32x32x16_bf16 v[120:135],a[60:63],v[52:55],v[120:135]
v_exp_f32 v44,v44
v_exp_f32 v45,v45
v_exp_f32 v46,v46
v_exp_f32 v47,v47
v_cvt_pk_bf16_f32 v62,v44,v45
v_cvt_pk_bf16_f32 v63,v46,v47
s_sub_u32 s39,s39,1
s_cmp_lg_u32 s39,0
s_cbranch_scc1 att2_loop
v_mfma_f32_32x32x16_bf16 v[32:47],a[0:3],v[72:75],0
buffer_load_dwordx4 a[48:51],v2,s[8:11],s41 offen
v_exp_f32 v16,v16
v_exp_f32 v17,v17
v_exp_f32 v18,v18
v_exp_f32_e64 v19,v19
v_cvt_pk_bf16_f32 v48,v16,v17
v_cvt_pk_bf16_f32 v49,v18,v19
v_mfma_f32_32x32x16_bf16 v[32:47],a[4:7],v[76:79],v[32:47]
buffer_load_dword a52,v7,s[52:55],s41 offen offset:3072
v_exp_f32 v20,v20
v_exp_f32 v21,v21
v_exp_f32 v22,v22
v_exp_f32 v23,v23
v_cvt_pk_bf16_f32 v50,v20,v21
v_cvt_pk_bf16_f32 v51,v22,v23
v_mfma_f32_32x32x16_bf16 v[136:151],a[56:59],v[56:59],v[136:151]
v_exp_f32 v24,v24
v_exp_f32 v25,v25
v_exp_f32 v26,v26
v_exp_f32 v27,v27
v_cvt_pk_bf16_f32 v52,v24,v25
v_cvt_pk_bf16_f32 v53,v26,v27
v_mfma_f32_32x32x16_bf16 v[136:151],a[60:63],v[60:63],v[136:151]
buffer_load_dwordx4 a[56:59],v248,s[8:11],s41 offen offset:1024
v_exp_f32 v28,v28
v_exp_f32 v29,v29
v_exp_f32 v30,v30
v_exp_f32 v31,v31
v_cvt_pk_bf16_f32 v54,v28,v29
v_cvt_pk_bf16_f32 v55,v30,v31
s_waitcnt vmcnt(7)
v_mfma_f32_32x32x16_bf16 v[16:31],a[16:19],v[64:67],0
buffer_load_dwordx4 a[60:63],v248,s[8:11],s41 offen offset:2048
s_add_u32 s41,s41,4096
v_exp_f32 v32,v32
v_exp_f32 v33,v33
v_exp_f32 v34,v34
v_exp_f32_e64 v35,v35
v_cvt_pk_bf16_f32 v56,v32,v33
v_cvt_pk_bf16_f32 v57,v34,v35
v_mfma_f32_32x32x16_bf16 v[16:31],a[20:23],v[68:71],v[16:31]
s_mov_b32 s43,s23
s_add_u32 s23,s23,32768
s_add_u32 m0,s43,0
s_add_u32 s22,s22,28672
buffer_load_dwordx4 v2,s[12:15],s22 offen offset:0 lds
v_exp_f32 v36,v36
v_exp_f32 v37,v37
v_exp_f32 v38,v38
v_exp_f32 v39,v39
v_cvt_pk_bf16_f32 v58,v36,v37
v_cvt_pk_bf16_f32 v59,v38,v39
v_mfma_f32_32x32x16_bf16 v[120:135],a[8:11],v[48:51],v[120:135]
buffer_load_dwordx4 v2,s[12:15],s22 offen offset:1024 lds
v_exp_f32 v40,v40
v_exp_f32 v41,v41
v_exp_f32 v42,v42
v_exp_f32 v43,v43
v_cvt_pk_bf16_f32 v60,v40,v41
v_cvt_pk_bf16_f32 v61,v42,v43
v_mfma_f32_32x32x16_bf16 v[120:135],a[12:15],v[52:55],v[120:135]
buffer_load_dwordx4 v2,s[12:15],s22 offen offset:2048 lds
v_exp_f32 v44,v44
v_exp_f32 v45,v45
v_exp_f32 v46,v46
v_exp_f32 v47,v47
v_cvt_pk_bf16_f32 v62,v44,v45
v_cvt_pk_bf16_f32 v63,v46,v47
v_mfma_f32_32x32x16_bf16 v[32:47],a[16:19],v[72:75],0
buffer_load_dwordx4 v2,s[12:15],s22 offen offset:3072 lds
v_exp_f32 v16,v16
v_exp_f32 v17,v17
v_exp_f32 v18,v18
v_exp_f32 v19,v19
v_cvt_pk_bf16_f32 v48,v16,v17
v_cvt_pk_bf16_f32 v49,v18,v19
v_mfma_f32_32x32x16_bf16 v[32:47],a[20:23],v[76:79],v[32:47]
s_add_u32 m0,s43,4096
s_add_u32 s22,s22,4096
buffer_load_dwordx4 v2,s[12:15],s22 offen offset:0 lds
v_exp_f32 v20,v20
v_exp_f32 v21,v21
v_exp_f32 v22,v22
v_exp_f32 v23,v23
v_cvt_pk_bf16_f32 v50,v20,v21
v_cvt_pk_bf16_f32 v51,v22,v23
v_mfma_f32_32x32x16_bf16 v[136:151],a[8:11],v[56:59],v[136:151]
buffer_load_dwordx4 v2,s[12:15],s22 offen offset:1024 lds
v_exp_f32 v24,v24
v_exp_f32 v25,v25
v_exp_f32 v26,v26
v_exp_f32 v27,v27
v_cvt_pk_bf16_f32 v52,v24,v25
v_cvt_pk_bf16_f32 v53,v26,v27
v_mfma_f32_32x32x16_bf16 v[136:151],a[12:15],v[60:63],v[136:151]
buffer_load_dwordx4 v2,s[12:15],s22 offen offset:2048 lds
v_exp_f32 v28,v28
v_exp_f32 v29,v29
v_exp_f32 v30,v30
v_exp_f32 v31,v31
v_cvt_pk_bf16_f32 v54,v28,v29
v_cvt_pk_bf16_f32 v55,v30,v31
s_waitcnt vmcnt(11)
v_mfma_f32_32x32x16_bf16 v[16:31],a[32:35],v[64:67],0
buffer_load_dwordx4 v2,s[12:15],s22 offen offset:3072 lds
v_exp_f32 v32,v32
v_exp_f32 v33,v33
v_exp_f32 v34,v34
v_exp_f32_e64 v35,v35
v_cvt_pk_bf16_f32 v56,v32,v33
v_cvt_pk_bf16_f32 v57,v34,v35
v_mfma_f32_32x32x16_bf16 v[16:31],a[36:39],v[68:71],v[16:31]
buffer_load_dwordx4 a[128:131],v2,s[8:11],s4 offen offset:0
v_exp_f32 v36,v36
v_exp_f32 v37,v37
v_exp_f32 v38,v38
v_exp_f32 v39,v39
v_cvt_pk_bf16_f32 v58,v36,v37
v_cvt_pk_bf16_f32 v59,v38,v39
v_mfma_f32_32x32x16_bf16 v[120:135],a[24:27],v[48:51],v[120:135]
buffer_load_dwordx4 a[132:135],v2,s[8:11],s4 offen offset:1024
v_exp_f32 v40,v40
v_exp_f32 v41,v41
v_exp_f32 v42,v42
v_exp_f32 v43,v43
v_cvt_pk_bf16_f32 v60,v40,v41
v_cvt_pk_bf16_f32 v61,v42,v43
v_mfma_f32_32x32x16_bf16 v[120:135],a[28:31],v[52:55],v[120:135]
buffer_load_dwordx4 a[136:139],v2,s[8:11],s4 offen offset:2048
v_exp_f32 v44,v44
v_exp_f32 v45,v45
v_exp_f32 v46,v46
v_exp_f32 v47,v47
v_cvt_pk_bf16_f32 v62,v44,v45
v_cvt_pk_bf16_f32 v63,v46,v47
v_mfma_f32_32x32x16_bf16 v[32:47],a[32:35],v[72:75],0
buffer_load_dwordx4 a[140:143],v2,s[8:11],s4 offen offset:3072
s_add_u32 s4,s4,4096
v_exp_f32 v16,v16
v_exp_f32 v17,v17
v_exp_f32 v18,v18
v_exp_f32 v19,v19
v_cvt_pk_bf16_f32 v48,v16,v17
v_cvt_pk_bf16_f32 v49,v18,v19
v_mfma_f32_32x32x16_bf16 v[32:47],a[36:39],v[76:79],v[32:47]
buffer_load_dwordx4 a[144:147],v2,s[8:11],s4 offen offset:0
v_exp_f32 v20,v20
v_exp_f32 v21,v21
v_exp_f32 v22,v22
v_exp_f32 v23,v23
v_cvt_pk_bf16_f32 v50,v20,v21
v_cvt_pk_bf16_f32 v51,v22,v23
v_mfma_f32_32x32x16_bf16 v[136:151],a[24:27],v[56:59],v[136:151]
buffer_load_dwordx4 a[148:151],v2,s[8:11],s4 offen offset:1024
v_exp_f32 v24,v24
v_exp_f32 v25,v25
v_exp_f32 v26,v26
v_exp_f32 v27,v27
v_cvt_pk_bf16_f32 v52,v24,v25
v_cvt_pk_bf16_f32 v53,v26,v27
v_mfma_f32_32x32x16_bf16 v[136:151],a[28:31],v[60:63],v[136:151]
buffer_load_dwordx4 a[152:155],v2,s[8:11],s4 offen offset:2048
v_exp_f32 v28,v28
v_exp_f32 v29,v29
v_exp_f32 v30,v30
v_exp_f32 v31,v31
v_cvt_pk_bf16_f32 v54,v28,v29
v_cvt_pk_bf16_f32 v55,v30,v31
s_waitcnt vmcnt(15)
v_mfma_f32_32x32x16_bf16 v[16:31],a[48:51],v[64:67],0
buffer_load_dwordx4 a[156:159],v2,s[8:11],s4 offen offset:3072
v_exp_f32 v32,v32
v_exp_f32 v33,v33
v_exp_f32 v34,v34
v_exp_f32_e64 v35,v35
v_cvt_pk_bf16_f32 v56,v32,v33
v_cvt_pk_bf16_f32 v57,v34,v35
v_mfma_f32_32x32x16_bf16 v[16:31],a[52:55],v[68:71],v[16:31]
buffer_load_dwordx4 a[160:163],v2,s[8:11],s5 offen offset:0
v_exp_f32 v36,v36
v_exp_f32 v37,v37
v_exp_f32 v38,v38
v_exp_f32 v39,v39
v_cvt_pk_bf16_f32 v58,v36,v37
v_cvt_pk_bf16_f32 v59,v38,v39
v_mfma_f32_32x32x16_bf16 v[120:135],a[40:43],v[48:51],v[120:135]
buffer_load_dwordx4 a[164:167],v2,s[8:11],s5 offen offset:1024
v_exp_f32 v40,v40
v_exp_f32 v41,v41
v_exp_f32 v42,v42
v_exp_f32 v43,v43
v_cvt_pk_bf16_f32 v60,v40,v41
v_cvt_pk_bf16_f32 v61,v42,v43
v_mfma_f32_32x32x16_bf16 v[120:135],a[44:47],v[52:55],v[120:135]
buffer_load_dwordx4 a[168:171],v2,s[8:11],s5 offen offset:2048
v_exp_f32 v44,v44
v_exp_f32 v45,v45
v_exp_f32 v46,v46
v_exp_f32 v47,v47
v_cvt_pk_bf16_f32 v62,v44,v45
v_cvt_pk_bf16_f32 v63,v46,v47
v_mfma_f32_32x32x16_bf16 v[32:47],a[48:51],v[72:75],0
buffer_load_dwordx4 a[172:175],v2,s[8:11],s5 offen offset:3072
s_add_u32 s5,s5,4096
v_exp_f32 v16,v16
v_exp_f32 v17,v17
v_exp_f32 v18,v18
v_exp_f32 v19,v19
v_cvt_pk_bf16_f32 v48,v16,v17
v_cvt_pk_bf16_f32 v49,v18,v19
v_mfma_f32_32x32x16_bf16 v[32:47],a[52:55],v[76:79],v[32:47]
buffer_load_dwordx4 a[176:179],v2,s[8:11],s5 offen offset:0
v_exp_f32 v20,v20
v_exp_f32 v21,v21
v_exp_f32 v22,v22
v_exp_f32 v23,v23
v_cvt_pk_bf16_f32 v50,v20,v21
v_cvt_pk_bf16_f32 v51,v22,v23
v_mfma_f32_32x32x16_bf16 v[136:151],a[40:43],v[56:59],v[136:151]
buffer_load_dwordx4 a[180:183],v2,s[8:11],s5 offen offset:1024
v_exp_f32 v24,v24
v_exp_f32 v25,v25
v_exp_f32 v26,v26
v_exp_f32 v27,v27
v_cvt_pk_bf16_f32 v52,v24,v25
v_cvt_pk_bf16_f32 v53,v26,v27
v_mfma_f32_32x32x16_bf16 v[136:151],a[44:47],v[60:63],v[136:151]
buffer_load_dwordx4 a[184:187],v2,s[8:11],s5 offen offset:2048
v_exp_f32 v28,v28
v_exp_f32 v29,v29
v_exp_f32 v30,v30
v_exp_f32 v31,v31
v_cvt_pk_bf16_f32 v54,v28,v29
v_cvt_pk_bf16_f32 v55,v30,v31
buffer_load_dwordx4 a[188:191],v2,s[8:11],s5 offen offset:3072
v_exp_f32 v32,v32
v_exp_f32 v33,v33
v_exp_f32 v34,v34
v_exp_f32 v35,v35
v_cvt_pk_bf16_f32 v56,v32,v33
v_cvt_pk_bf16_f32 v57,v34,v35
s_mov_b32 s43,s23
s_add_u32 s23,s23,32768
s_add_u32 m0,s43,0
s_add_u32 s22,s22,28672
buffer_load_dwordx4 v2,s[12:15],s22 offen offset:0 lds
v_exp_f32 v36,v36
v_exp_f32 v37,v37
v_exp_f32 v38,v38
v_exp_f32 v39,v39
v_cvt_pk_bf16_f32 v58,v36,v37
v_cvt_pk_bf16_f32 v59,v38,v39
v_mfma_f32_32x32x16_bf16 v[120:135],a[56:59],v[48:51],v[120:135]
buffer_load_dwordx4 v2,s[12:15],s22 offen offset:1024 lds
v_exp_f32 v40,v40
v_exp_f32 v41,v41
v_exp_f32 v42,v42
v_exp_f32 v43,v43
v_cvt_pk_bf16_f32 v60,v40,v41
v_cvt_pk_bf16_f32 v61,v42,v43
v_mfma_f32_32x32x16_bf16 v[120:135],a[60:63],v[52:55],v[120:135]
buffer_load_dwordx4 v2,s[12:15],s22 offen offset:2048 lds
v_exp_f32 v44,v44
v_exp_f32 v45,v45
v_exp_f32 v46,v46
v_exp_f32 v47,v47
v_cvt_pk_bf16_f32 v62,v44,v45
v_cvt_pk_bf16_f32 v63,v46,v47
buffer_load_dwordx4 v2,s[12:15],s22 offen offset:3072 lds
s_add_u32 m0,s43,4096
s_add_u32 s22,s22,4096
buffer_load_dwordx4 v2,s[12:15],s22 offen offset:0 lds
buffer_load_dwordx4 v2,s[12:15],s22 offen offset:1024 lds
buffer_load_dwordx4 v2,s[12:15],s22 offen offset:2048 lds
buffer_load_dwordx4 v2,s[12:15],s22 offen offset:3072 lds
s_nop 1
v_mfma_f32_32x32x16_bf16 v[136:151],a[56:59],v[56:59],v[136:151]
s_nop 0
v_mfma_f32_32x32x16_bf16 v[136:151],a[60:63],v[60:63],v[136:151]
s_mul_i32 s24,s37,36864
s_add_u32 s24,s24,79691776
s_lshl_b32 s25,s16,10
s_add_u32 s40,s25,s24
s_lshr_b32 s26,s16,3
s_lshl_b32 s26,s26,10
s_add_u32 s24,s24,s26
s_bfe_u32 s26,s16,0x10002
s_lshl_b32 s26,s26,9
s_add_u32 s24,s24,s26
s_and_b32 s26,s16,3
s_lshl_b32 s26,s26,2
s_add_u32 s24,s24,s26
s_add_u32 s38,s24,32768
v_mov_b32 v14,0x80000000
v_cndmask_b32 v14,v2,v14,s[96:97]
s_cmp_eq_u32 s57,0
s_cbranch_scc1 att2_fin
s_mul_i32 s24,s18,24576
s_add_u32 s24,s24,65536
v_add_u32_e64 v12,s24,v2
ds_write_b128 v12,v[120:123] offset:0
ds_write_b128 v12,v[124:127] offset:1024
ds_write_b128 v12,v[128:131] offset:2048
ds_write_b128 v12,v[136:139] offset:3072
ds_write_b128 v12,v[140:143] offset:4096
ds_write_b128 v12,v[144:147] offset:5120
s_waitcnt lgkmcnt(0)
s_barrier
s_xor_b32 s24,s18,1
s_mul_i32 s24,s24,24576
s_add_u32 s24,s24,65536
v_add_u32_e64 v60,s24,v2
s_xor_b32 s24,s18,2
s_mul_i32 s24,s24,24576
s_add_u32 s24,s24,65536
v_add_u32 v61,s24,v2
s_xor_b32 s24,s18,3
s_mul_i32 s24,s24,24576
s_add_u32 s24,s24,65536
v_add_u32_e64 v62,s24,v2
att2_fin:
s_nop 7
s_lshl_b32 s24,1,s57
s_sub_u32 s24,s24,1
s_and_b32 s24,s24,0
s_cmp_lg_u32 s24,s58
s_cbranch_scc1 att2_skip0
s_cmp_eq_u32 s57,0
s_cbranch_scc1 att2_c0
ds_read_b128 v[16:19],v60 offset:0
ds_read_b128 v[20:23],v60 offset:1024
ds_read_b128 v[24:27],v60 offset:2048
s_cmp_eq_u32 s57,1
s_cbranch_scc1 att2_d0
ds_read_b128 v[28:31],v61 offset:0
ds_read_b128 v[32:35],v61 offset:1024
ds_read_b128 v[36:39],v61 offset:2048
ds_read_b128 v[40:43],v62 offset:0
ds_read_b128 v[44:47],v62 offset:1024
ds_read_b128 v[48:51],v62 offset:2048
s_waitcnt lgkmcnt(0)
v_add_f32 v28,v28,v40
v_add_f32 v29,v29,v41
v_add_f32 v30,v30,v42
v_add_f32 v31,v31,v43
v_add_f32 v32,v32,v44
v_add_f32 v33,v33,v45
v_add_f32 v34,v34,v46
v_add_f32 v35,v35,v47
v_add_f32 v36,v36,v48
v_add_f32 v37,v37,v49
v_add_f32 v38,v38,v50
v_add_f32 v120,v120,v28
v_add_f32 v121,v121,v29
v_add_f32 v122,v122,v30
v_add_f32 v123,v123,v31
v_add_f32 v124,v124,v32
v_add_f32 v125,v125,v33
v_add_f32 v126,v126,v34
v_add_f32 v127,v127,v35
v_add_f32 v128,v128,v36
v_add_f32 v129,v129,v37
v_add_f32 v130,v130,v38
att2_d0:
s_waitcnt lgkmcnt(0)
v_add_f32 v120,v120,v16
v_add_f32 v121,v121,v17
v_add_f32 v122,v122,v18
v_add_f32 v123,v123,v19
v_add_f32 v124,v124,v20
v_add_f32 v125,v125,v21
v_add_f32 v126,v126,v22
v_add_f32 v127,v127,v23
v_add_f32 v128,v128,v24
v_add_f32 v129,v129,v25
v_add_f32 v130,v130,v26
att2_c0:
s_mov_b64 vcc,exec
v_cmp_le_f32 s[24:25],s44,v130
v_cmp_ge_f32 s[26:27],s45,v130
s_and_b64 vcc,vcc,s[24:25]
s_and_b64 vcc,vcc,s[26:27]
s_cmp_eq_u64 vcc,exec
s_cbranch_scc0 att2_fb0
att2_ok0:
v_rcp_f32 v130,v130
s_nop 0
v_mul_f32 v120,v130,v120
v_mul_f32 v121,v130,v121
v_mul_f32 v122,v130,v122
v_mul_f32 v123,v130,v123
v_mul_f32 v124,v130,v124
v_mul_f32 v125,v130,v125
v_mul_f32 v126,v130,v126
v_mul_f32 v127,v130,v127
v_mul_f32 v128,v130,v128
v_mul_f32 v129,v130,v129
v_cvt_pk_bf16_f32 v132,v120,v121
v_cvt_pk_bf16_f32 v133,v122,v123
v_cvt_pk_bf16_f32 v134,v124,v125
v_cvt_pk_bf16_f32 v135,v126,v127
v_cvt_pk_bf16_f32 v131,v128,v129
buffer_store_dwordx4 v[132:135],v2,s[8:11],s40 offen
buffer_store_dword v131,v14,s[8:11],s38 offen
att2_skip0:
s_add_u32 s40,s40,36864
s_add_u32 s38,s38,36864
s_lshl_b32 s24,1,s57
s_sub_u32 s24,s24,1
s_and_b32 s24,s24,1
s_cmp_lg_u32 s24,s58
s_cbranch_scc1 att2_skip1
s_cmp_eq_u32 s57,0
s_cbranch_scc1 att2_c1
ds_read_b128 v[16:19],v60 offset:3072
ds_read_b128 v[20:23],v60 offset:4096
ds_read_b128 v[24:27],v60 offset:5120
s_cmp_eq_u32 s57,1
s_cbranch_scc1 att2_d1
ds_read_b128 v[28:31],v61 offset:3072
ds_read_b128 v[32:35],v61 offset:4096
ds_read_b128 v[36:39],v61 offset:5120
ds_read_b128 v[40:43],v62 offset:3072
ds_read_b128 v[44:47],v62 offset:4096
ds_read_b128 v[48:51],v62 offset:5120
s_waitcnt lgkmcnt(0)
v_add_f32 v28,v28,v40
v_add_f32 v29,v29,v41
v_add_f32 v30,v30,v42
v_add_f32 v31,v31,v43
v_add_f32 v32,v32,v44
v_add_f32 v33,v33,v45
v_add_f32 v34,v34,v46
v_add_f32 v35,v35,v47
v_add_f32 v36,v36,v48
v_add_f32 v37,v37,v49
v_add_f32 v38,v38,v50
v_add_f32 v136,v136,v28
v_add_f32 v137,v137,v29
v_add_f32 v138,v138,v30
v_add_f32 v139,v139,v31
v_add_f32 v140,v140,v32
v_add_f32 v141,v141,v33
v_add_f32 v142,v142,v34
v_add_f32 v143,v143,v35
v_add_f32 v144,v144,v36
v_add_f32 v145,v145,v37
v_add_f32 v146,v146,v38
att2_d1:
s_waitcnt lgkmcnt(0)
v_add_f32 v136,v136,v16
v_add_f32 v137,v137,v17
v_add_f32 v138,v138,v18
v_add_f32 v139,v139,v19
v_add_f32 v140,v140,v20
v_add_f32 v141,v141,v21
v_add_f32 v142,v142,v22
v_add_f32 v143,v143,v23
v_add_f32 v144,v144,v24
v_add_f32 v145,v145,v25
v_add_f32_e64 v146,v146,v26
att2_c1:
s_mov_b64 vcc,exec
v_cmp_le_f32 s[24:25],s44,v146
v_cmp_ge_f32 s[26:27],s45,v146
s_and_b64 vcc,vcc,s[24:25]
s_and_b64 vcc,vcc,s[26:27]
s_cmp_eq_u64 vcc,exec
s_cbranch_scc0 att2_fb1
att2_ok1:
v_rcp_f32 v146,v146
s_nop 0
v_mul_f32 v136,v146,v136
v_mul_f32 v137,v146,v137
v_mul_f32 v138,v146,v138
v_mul_f32 v139,v146,v139
v_mul_f32 v140,v146,v140
v_mul_f32 v141,v146,v141
v_mul_f32 v142,v146,v142
v_mul_f32 v143,v146,v143
v_mul_f32 v144,v146,v144
v_mul_f32 v145,v146,v145
v_cvt_pk_bf16_f32 v148,v136,v137
v_cvt_pk_bf16_f32 v149,v138,v139
v_cvt_pk_bf16_f32 v150,v140,v141
v_cvt_pk_bf16_f32 v151,v142,v143
v_cvt_pk_bf16_f32 v147,v144,v145
buffer_store_dwordx4 v[148:151],v2,s[8:11],s40 offen
buffer_store_dword v147,v14,s[8:11],s38 offen
att2_skip1:
s_add_u32 s40,s40,36864
s_add_u32 s38,s38,36864
s_cmp_eq_u32 s57,0
s_cbranch_scc1 k2_B
s_barrier
s_branch k2_B
att3:
v_accvgpr_write_b32 a5,v13
v_accvgpr_write_b32 a6,0
v_accvgpr_write_b32 a7,0
v_accvgpr_write_b32 a21,v13
v_accvgpr_write_b32 a22,0
v_accvgpr_write_b32 a23,0
v_accvgpr_write_b32 a37,v13
v_accvgpr_write_b32 a38,0
v_accvgpr_write_b32 a39,0
v_accvgpr_write_b32 a53,v13
v_accvgpr_write_b32 a54,0
v_accvgpr_write_b32 a55,0
v_mov_b32 v69,0
v_mov_b32 v70,0
v_mov_b32 v71,0
v_mov_b32 v77,0
v_mov_b32 v78,0
v_mov_b32 v79,0
v_mov_b32 v85,0
v_mov_b32 v86,0
v_mov_b32 v87,0
v_mov_b32 v48,0
v_mov_b32 v49,0
v_mov_b32 v50,0
v_mov_b32 v51,0
v_mov_b32 v52,0
v_mov_b32 v53,0
v_mov_b32 v54,0
v_mov_b32 v55,0
v_mov_b32 v56,0
v_mov_b32 v57,0
v_mov_b32 v58,0
v_mov_b32 v59,0
v_mov_b32 v60,0
v_mov_b32 v61,0
v_mov_b32 v62,0
v_mov_b32 v63,0
s_nop 1
v_mfma_f32_32x32x16_bf16 v[120:135],v[48:51],v[48:51],0
v_mfma_f32_32x32x16_bf16 v[136:151],v[48:51],v[48:51],0
v_mfma_f32_32x32x16_bf16 v[152:167],v[48:51],v[48:51],0
v_accvgpr_write_b32 a56,0
v_accvgpr_write_b32 a57,0
v_accvgpr_write_b32 a58,0
v_accvgpr_write_b32 a59,0
v_accvgpr_write_b32 a60,0
v_accvgpr_write_b32 a61,0
v_accvgpr_write_b32 a62,0
v_accvgpr_write_b32 a63,0
s_waitcnt vmcnt(17)
v_cndmask_b32 v68,v68,0,s[96:97]
v_cndmask_b32 v76,v76,0,s[96:97]
v_cndmask_b32 v84,v84,0,s[96:97]
s_nop 0
v_mfma_f32_32x32x16_bf16 v[16:31],a[48:51],v[64:67],0
v_mfma_f32_32x32x16_bf16 v[16:31],a[52:55],v[68:71],v[16:31]
v_mfma_f32_32x32x16_bf16 v[32:47],a[48:51],v[72:75],0
v_mfma_f32_32x32x16_bf16 v[32:47],a[52:55],v[76:79],v[32:47]
s_nop 9
v_max_f32 v10,v16,v17
v_max3_f32 v10,v10,v18,v19
v_max3_f32 v10,v10,v20,v21
v_max3_f32 v10,v10,v22,v23
v_max3_f32 v10,v10,v24,v25
v_max3_f32 v10,v10,v26,v27
v_max3_f32 v10,v10,v28,v29
v_max3_f32 v10,v10,v30,v31
v_mov_b32 v12,v10
s_nop 1
v_permlane32_swap_b32 v10,v12
v_max_f32 v10,v10,v12
v_sub_f32_e64 v10,0,v10
v_cvt_pk_bf16_f32 v10,v10,0
v_cndmask_b32 v69,v10,0,s[96:97]
v_mfma_f32_32x32x16_bf16 v[16:31],a[48:51],v[80:83],0
v_mfma_f32_32x32x16_bf16 v[16:31],a[52:55],v[84:87],v[16:31]
v_max_f32_e64 v10,v32,v33
v_max3_f32 v10,v10,v34,v35
v_max3_f32 v10,v10,v36,v37
v_max3_f32 v10,v10,v38,v39
v_max3_f32 v10,v10,v40,v41
v_max3_f32 v10,v10,v42,v43
v_max3_f32 v10,v10,v44,v45
v_max3_f32 v10,v10,v46,v47
v_mov_b32 v12,v10
s_nop 1
v_permlane32_swap_b32 v10,v12
v_max_f32 v10,v10,v12
v_sub_f32_e64 v10,0,v10
v_cvt_pk_bf16_f32 v10,v10,0
v_cndmask_b32 v77,v10,0,s[96:97]
v_max_f32_e64 v10,v16,v17
v_max3_f32 v10,v10,v18,v19
v_max3_f32 v10,v10,v20,v21
v_max3_f32 v10,v10,v22,v23
v_max3_f32 v10,v10,v24,v25
v_max3_f32 v10,v10,v26,v27
v_max3_f32 v10,v10,v28,v29
v_max3_f32 v10,v10,v30,v31
v_mov_b32 v12,v10
s_nop 1
v_permlane32_swap_b32 v10,v12
v_max_f32 v10,v10,v12
v_sub_f32_e64 v10,0,v10
v_cvt_pk_bf16_f32 v10,v10,0
v_cndmask_b32 v85,v10,0,s[96:97]
s_mov_b32 s39,s60
s_waitcnt vmcnt(13)
v_mfma_f32_32x32x16_bf16 v[16:31],a[0:3],v[64:67],0
v_mfma_f32_32x32x16_bf16 v[16:31],a[4:7],v[68:71],v[16:31]
s_nop 9
s_sub_u32 s39,s39,1
att3_loop:
v_mfma_f32_32x32x16_bf16 v[32:47],a[0:3],v[72:75],0
buffer_load_dwordx4 a[48:51],v2,s[8:11],s41 offen
v_exp_f32 v16,v16
v_exp_f32 v17,v17
v_exp_f32 v18,v18
v_exp_f32 v19,v19
v_cvt_pk_bf16_f32 v48,v16,v17
v_cvt_pk_bf16_f32 v49,v18,v19
v_mfma_f32_32x32x16_bf16 v[32:47],a[4:7],v[76:79],v[32:47]
buffer_load_dword a52,v7,s[52:55],s41 offen offset:3072
v_exp_f32 v20,v20
v_exp_f32 v21,v21
v_exp_f32 v22,v22
v_exp_f32 v23,v23
v_cvt_pk_bf16_f32 v50,v20,v21
v_cvt_pk_bf16_f32 v51,v22,v23
v_mfma_f32_32x32x16_bf16 v[152:167],a[56:59],v[56:59],v[152:167]
v_exp_f32 v24,v24
v_exp_f32 v25,v25
v_exp_f32 v26,v26
v_exp_f32 v27,v27
v_cvt_pk_bf16_f32 v52,v24,v25
v_cvt_pk_bf16_f32 v53,v26,v27
v_mfma_f32_32x32x16_bf16 v[152:167],a[60:63],v[60:63],v[152:167]
buffer_load_dwordx4 a[56:59],v248,s[8:11],s41 offen offset:1024
v_exp_f32 v28,v28
v_exp_f32 v29,v29
v_exp_f32 v30,v30
v_exp_f32 v31,v31
v_cvt_pk_bf16_f32 v54,v28,v29
v_cvt_pk_bf16_f32 v55,v30,v31
v_mfma_f32_32x32x16_bf16 v[16:31],a[0:3],v[80:83],0
buffer_load_dwordx4 a[60:63],v248,s[8:11],s41 offen offset:2048
s_add_u32 s41,s41,4096
v_exp_f32 v32,v32
v_exp_f32 v33,v33
v_exp_f32 v34,v34
v_exp_f32 v35,v35
v_cvt_pk_bf16_f32 v56,v32,v33
v_cvt_pk_bf16_f32 v57,v34,v35
v_mfma_f32_32x32x16_bf16 v[16:31],a[4:7],v[84:87],v[16:31]
v_exp_f32 v36,v36
v_exp_f32 v37,v37
v_exp_f32 v38,v38
v_exp_f32 v39,v39
v_cvt_pk_bf16_f32 v58,v36,v37
v_cvt_pk_bf16_f32 v59,v38,v39
v_mfma_f32_32x32x16_bf16 v[120:135],a[8:11],v[48:51],v[120:135]
v_exp_f32 v40,v40
v_exp_f32 v41,v41
v_exp_f32 v42,v42
v_exp_f32 v43,v43
v_cvt_pk_bf16_f32 v60,v40,v41
v_cvt_pk_bf16_f32 v61,v42,v43
v_mfma_f32_32x32x16_bf16 v[120:135],a[12:15],v[52:55],v[120:135]
v_exp_f32 v44,v44
v_exp_f32 v45,v45
v_exp_f32 v46,v46
v_exp_f32 v47,v47
v_cvt_pk_bf16_f32 v62,v44,v45
v_cvt_pk_bf16_f32 v63,v46,v47
s_waitcnt vmcnt(8)
v_mfma_f32_32x32x16_bf16 v[32:47],a[16:19],v[64:67],0
v_exp_f32 v16,v16
v_exp_f32 v17,v17
v_exp_f32 v18,v18
v_exp_f32_e64 v19,v19
v_cvt_pk_bf16_f32 v48,v16,v17
v_cvt_pk_bf16_f32 v49,v18,v19
v_mfma_f32_32x32x16_bf16 v[32:47],a[20:23],v[68:71],v[32:47]
v_exp_f32 v20,v20
v_exp_f32 v21,v21
v_exp_f32 v22,v22
v_exp_f32 v23,v23
v_cvt_pk_bf16_f32 v50,v20,v21
v_cvt_pk_bf16_f32 v51,v22,v23
v_mfma_f32_32x32x16_bf16 v[136:151],a[8:11],v[56:59],v[136:151]
v_exp_f32 v24,v24
v_exp_f32 v25,v25
v_exp_f32 v26,v26
v_exp_f32 v27,v27
v_cvt_pk_bf16_f32 v52,v24,v25
v_cvt_pk_bf16_f32 v53,v26,v27
v_mfma_f32_32x32x16_bf16 v[136:151],a[12:15],v[60:63],v[136:151]
v_exp_f32 v28,v28
v_exp_f32 v29,v29
v_exp_f32 v30,v30
v_exp_f32 v31,v31
v_cvt_pk_bf16_f32 v54,v28,v29
v_cvt_pk_bf16_f32 v55,v30,v31
v_mfma_f32_32x32x16_bf16 v[16:31],a[16:19],v[72:75],0
buffer_load_dwordx4 a[0:3],v2,s[8:11],s41 offen
v_exp_f32 v32,v32
v_exp_f32 v33,v33
v_exp_f32 v34,v34
v_exp_f32 v35,v35
v_cvt_pk_bf16_f32 v56,v32,v33
v_cvt_pk_bf16_f32 v57,v34,v35
v_mfma_f32_32x32x16_bf16 v[16:31],a[20:23],v[76:79],v[16:31]
buffer_load_dword a4,v7,s[52:55],s41 offen offset:3072
v_exp_f32 v36,v36
v_exp_f32 v37,v37
v_exp_f32 v38,v38
v_exp_f32 v39,v39
v_cvt_pk_bf16_f32 v58,v36,v37
v_cvt_pk_bf16_f32 v59,v38,v39
v_mfma_f32_32x32x16_bf16 v[152:167],a[8:11],v[48:51],v[152:167]
v_exp_f32 v40,v40
v_exp_f32 v41,v41
v_exp_f32 v42,v42
v_exp_f32 v43,v43
v_cvt_pk_bf16_f32 v60,v40,v41
v_cvt_pk_bf16_f32 v61,v42,v43
v_mfma_f32_32x32x16_bf16 v[152:167],a[12:15],v[52:55],v[152:167]
buffer_load_dwordx4 a[8:11],v248,s[8:11],s41 offen offset:1024
v_exp_f32 v44,v44
v_exp_f32 v45,v45
v_exp_f32 v46,v46
v_exp_f32 v47,v47
v_cvt_pk_bf16_f32 v62,v44,v45
v_cvt_pk_bf16_f32 v63,v46,v47
v_mfma_f32_32x32x16_bf16 v[32:47],a[16:19],v[80:83],0
buffer_load_dwordx4 a[12:15],v248,s[8:11],s41 offen offset:2048
s_add_u32 s41,s41,4096
v_exp_f32 v16,v16
v_exp_f32 v17,v17
v_exp_f32 v18,v18
v_exp_f32 v19,v19
v_cvt_pk_bf16_f32 v48,v16,v17
v_cvt_pk_bf16_f32 v49,v18,v19
v_mfma_f32_32x32x16_bf16 v[32:47],a[20:23],v[84:87],v[32:47]
v_exp_f32 v20,v20
v_exp_f32 v21,v21
v_exp_f32 v22,v22
v_exp_f32 v23,v23
v_cvt_pk_bf16_f32 v50,v20,v21
v_cvt_pk_bf16_f32 v51,v22,v23
v_mfma_f32_32x32x16_bf16 v[120:135],a[24:27],v[56:59],v[120:135]
v_exp_f32 v24,v24
v_exp_f32 v25,v25
v_exp_f32 v26,v26
v_exp_f32 v27,v27
v_cvt_pk_bf16_f32 v52,v24,v25
v_cvt_pk_bf16_f32 v53,v26,v27
v_mfma_f32_32x32x16_bf16 v[120:135],a[28:31],v[60:63],v[120:135]
v_exp_f32 v28,v28
v_exp_f32 v29,v29
v_exp_f32 v30,v30
v_exp_f32 v31,v31
v_cvt_pk_bf16_f32 v54,v28,v29
v_cvt_pk_bf16_f32 v55,v30,v31
s_waitcnt vmcnt(8)
v_mfma_f32_32x32x16_bf16 v[16:31],a[32:35],v[64:67],0
v_exp_f32 v32,v32
v_exp_f32 v33,v33
v_exp_f32 v34,v34
v_exp_f32_e64 v35,v35
v_cvt_pk_bf16_f32 v56,v32,v33
v_cvt_pk_bf16_f32 v57,v34,v35
v_mfma_f32_32x32x16_bf16 v[16:31],a[36:39],v[68:71],v[16:31]
v_exp_f32 v36,v36
v_exp_f32 v37,v37
v_exp_f32 v38,v38
v_exp_f32 v39,v39
v_cvt_pk_bf16_f32 v58,v36,v37
v_cvt_pk_bf16_f32 v59,v38,v39
v_mfma_f32_32x32x16_bf16 v[136:151],a[24:27],v[48:51],v[136:151]
v_exp_f32 v40,v40
v_exp_f32 v41,v41
v_exp_f32 v42,v42
v_exp_f32 v43,v43
v_cvt_pk_bf16_f32 v60,v40,v41
v_cvt_pk_bf16_f32 v61,v42,v43
v_mfma_f32_32x32x16_bf16 v[136:151],a[28:31],v[52:55],v[136:151]
v_exp_f32 v44,v44
v_exp_f32 v45,v45
v_exp_f32 v46,v46
v_exp_f32 v47,v47
v_cvt_pk_bf16_f32 v62,v44,v45
v_cvt_pk_bf16_f32 v63,v46,v47
v_mfma_f32_32x32x16_bf16 v[32:47],a[32:35],v[72:75],0
buffer_load_dwordx4 a[16:19],v2,s[8:11],s41 offen
v_exp_f32 v16,v16
v_exp_f32 v17,v17
v_exp_f32 v18,v18
v_exp_f32 v19,v19
v_cvt_pk_bf16_f32 v48,v16,v17
v_cvt_pk_bf16_f32 v49,v18,v19
v_mfma_f32_32x32x16_bf16 v[32:47],a[36:39],v[76:79],v[32:47]
buffer_load_dword a20,v7,s[52:55],s41 offen offset:3072
v_exp_f32 v20,v20
v_exp_f32 v21,v21
v_exp_f32 v22,v22
v_exp_f32 v23,v23
v_cvt_pk_bf16_f32 v50,v20,v21
v_cvt_pk_bf16_f32 v51,v22,v23
v_mfma_f32_32x32x16_bf16 v[152:167],a[24:27],v[56:59],v[152:167]
v_exp_f32 v24,v24
v_exp_f32 v25,v25
v_exp_f32 v26,v26
v_exp_f32 v27,v27
v_cvt_pk_bf16_f32 v52,v24,v25
v_cvt_pk_bf16_f32 v53,v26,v27
v_mfma_f32_32x32x16_bf16 v[152:167],a[28:31],v[60:63],v[152:167]
buffer_load_dwordx4 a[24:27],v248,s[8:11],s41 offen offset:1024
v_exp_f32 v28,v28
v_exp_f32 v29,v29
v_exp_f32 v30,v30
v_exp_f32 v31,v31
v_cvt_pk_bf16_f32 v54,v28,v29
v_cvt_pk_bf16_f32 v55,v30,v31
v_mfma_f32_32x32x16_bf16 v[16:31],a[32:35],v[80:83],0
buffer_load_dwordx4 a[28:31],v248,s[8:11],s41 offen offset:2048
s_add_u32 s41,s41,4096
v_exp_f32 v32,v32
v_exp_f32 v33,v33
v_exp_f32 v34,v34
v_exp_f32 v35,v35
v_cvt_pk_bf16_f32 v56,v32,v33
v_cvt_pk_bf16_f32 v57,v34,v35
v_mfma_f32_32x32x16_bf16 v[16:31],a[36:39],v[84:87],v[16:31]
v_exp_f32 v36,v36
v_exp_f32 v37,v37
v_exp_f32 v38,v38
v_exp_f32 v39,v39
v_cvt_pk_bf16_f32 v58,v36,v37
v_cvt_pk_bf16_f32 v59,v38,v39
v_mfma_f32_32x32x16_bf16 v[120:135],a[40:43],v[48:51],v[120:135]
v_exp_f32 v40,v40
v_exp_f32 v41,v41
v_exp_f32 v42,v42
v_exp_f32 v43,v43
v_cvt_pk_bf16_f32 v60,v40,v41
v_cvt_pk_bf16_f32 v61,v42,v43
v_mfma_f32_32x32x16_bf16 v[120:135],a[44:47],v[52:55],v[120:135]
v_exp_f32 v44,v44
v_exp_f32 v45,v45
v_exp_f32 v46,v46
v_exp_f32 v47,v47
v_cvt_pk_bf16_f32 v62,v44,v45
v_cvt_pk_bf16_f32 v63,v46,v47
s_waitcnt vmcnt(8)
v_mfma_f32_32x32x16_bf16 v[32:47],a[48:51],v[64:67],0
v_exp_f32 v16,v16
v_exp_f32 v17,v17
v_exp_f32 v18,v18
v_exp_f32_e64 v19,v19
v_cvt_pk_bf16_f32 v48,v16,v17
v_cvt_pk_bf16_f32 v49,v18,v19
v_mfma_f32_32x32x16_bf16 v[32:47],a[52:55],v[68:71],v[32:47]
v_exp_f32 v20,v20
v_exp_f32 v21,v21
v_exp_f32 v22,v22
v_exp_f32 v23,v23
v_cvt_pk_bf16_f32 v50,v20,v21
v_cvt_pk_bf16_f32 v51,v22,v23
v_mfma_f32_32x32x16_bf16 v[136:151],a[40:43],v[56:59],v[136:151]
v_exp_f32 v24,v24
v_exp_f32 v25,v25
v_exp_f32 v26,v26
v_exp_f32 v27,v27
v_cvt_pk_bf16_f32 v52,v24,v25
v_cvt_pk_bf16_f32 v53,v26,v27
v_mfma_f32_32x32x16_bf16 v[136:151],a[44:47],v[60:63],v[136:151]
v_exp_f32 v28,v28
v_exp_f32 v29,v29
v_exp_f32 v30,v30
v_exp_f32 v31,v31
v_cvt_pk_bf16_f32 v54,v28,v29
v_cvt_pk_bf16_f32 v55,v30,v31
v_mfma_f32_32x32x16_bf16 v[16:31],a[48:51],v[72:75],0
buffer_load_dwordx4 a[32:35],v2,s[8:11],s41 offen
v_exp_f32 v32,v32
v_exp_f32 v33,v33
v_exp_f32 v34,v34
v_exp_f32 v35,v35
v_cvt_pk_bf16_f32 v56,v32,v33
v_cvt_pk_bf16_f32 v57,v34,v35
v_mfma_f32_32x32x16_bf16 v[16:31],a[52:55],v[76:79],v[16:31]
buffer_load_dword a36,v7,s[52:55],s41 offen offset:3072
v_exp_f32 v36,v36
v_exp_f32 v37,v37
v_exp_f32 v38,v38
v_exp_f32 v39,v39
v_cvt_pk_bf16_f32 v58,v36,v37
v_cvt_pk_bf16_f32 v59,v38,v39
v_mfma_f32_32x32x16_bf16 v[152:167],a[40:43],v[48:51],v[152:167]
v_exp_f32 v40,v40
v_exp_f32 v41,v41
v_exp_f32 v42,v42
v_exp_f32 v43,v43
v_cvt_pk_bf16_f32 v60,v40,v41
v_cvt_pk_bf16_f32 v61,v42,v43
v_mfma_f32_32x32x16_bf16 v[152:167],a[44:47],v[52:55],v[152:167]
buffer_load_dwordx4 a[40:43],v248,s[8:11],s41 offen offset:1024
v_exp_f32 v44,v44
v_exp_f32 v45,v45
v_exp_f32 v46,v46
v_exp_f32 v47,v47
v_cvt_pk_bf16_f32 v62,v44,v45
v_cvt_pk_bf16_f32 v63,v46,v47
v_mfma_f32_32x32x16_bf16 v[32:47],a[48:51],v[80:83],0
buffer_load_dwordx4 a[44:47],v248,s[8:11],s41 offen offset:2048
s_add_u32 s41,s41,4096
v_exp_f32 v16,v16
v_exp_f32 v17,v17
v_exp_f32 v18,v18
v_exp_f32 v19,v19
v_cvt_pk_bf16_f32 v48,v16,v17
v_cvt_pk_bf16_f32 v49,v18,v19
v_mfma_f32_32x32x16_bf16 v[32:47],a[52:55],v[84:87],v[32:47]
v_exp_f32 v20,v20
v_exp_f32 v21,v21
v_exp_f32 v22,v22
v_exp_f32 v23,v23
v_cvt_pk_bf16_f32 v50,v20,v21
v_cvt_pk_bf16_f32 v51,v22,v23
v_mfma_f32_32x32x16_bf16 v[120:135],a[56:59],v[56:59],v[120:135]
v_exp_f32 v24,v24
v_exp_f32 v25,v25
v_exp_f32 v26,v26
v_exp_f32 v27,v27
v_cvt_pk_bf16_f32 v52,v24,v25
v_cvt_pk_bf16_f32 v53,v26,v27
v_mfma_f32_32x32x16_bf16 v[120:135],a[60:63],v[60:63],v[120:135]
v_exp_f32 v28,v28
v_exp_f32 v29,v29
v_exp_f32 v30,v30
v_exp_f32 v31,v31
v_cvt_pk_bf16_f32 v54,v28,v29
v_cvt_pk_bf16_f32 v55,v30,v31
s_waitcnt vmcnt(8)
v_mfma_f32_32x32x16_bf16 v[16:31],a[0:3],v[64:67],0
v_exp_f32 v32,v32
v_exp_f32 v33,v33
v_exp_f32 v34,v34
v_exp_f32_e64 v35,v35
v_cvt_pk_bf16_f32 v56,v32,v33
v_cvt_pk_bf16_f32 v57,v34,v35
v_mfma_f32_32x32x16_bf16 v[16:31],a[4:7],v[68:71],v[16:31]
v_exp_f32 v36,v36
v_exp_f32 v37,v37
v_exp_f32 v38,v38
v_exp_f32 v39,v39
v_cvt_pk_bf16_f32 v58,v36,v37
v_cvt_pk_bf16_f32 v59,v38,v39
v_mfma_f32_32x32x16_bf16 v[136:151],a[56:59],v[48:51],v[136:151]
v_exp_f32 v40,v40
v_exp_f32 v41,v41
v_exp_f32 v42,v42
v_exp_f32 v43,v43
v_cvt_pk_bf16_f32 v60,v40,v41
v_cvt_pk_bf16_f32 v61,v42,v43
v_mfma_f32_32x32x16_bf16 v[136:151],a[60:63],v[52:55],v[136:151]
v_exp_f32 v44,v44
v_exp_f32 v45,v45
v_exp_f32 v46,v46
v_exp_f32 v47,v47
v_cvt_pk_bf16_f32 v62,v44,v45
v_cvt_pk_bf16_f32 v63,v46,v47
s_sub_u32 s39,s39,1
s_cmp_lg_u32 s39,0
s_cbranch_scc1 att3_loop
v_mfma_f32_32x32x16_bf16 v[32:47],a[0:3],v[72:75],0
buffer_load_dwordx4 a[48:51],v2,s[8:11],s41 offen
v_exp_f32 v16,v16
v_exp_f32 v17,v17
v_exp_f32 v18,v18
v_exp_f32_e64 v19,v19
v_cvt_pk_bf16_f32 v48,v16,v17
v_cvt_pk_bf16_f32 v49,v18,v19
v_mfma_f32_32x32x16_bf16 v[32:47],a[4:7],v[76:79],v[32:47]
buffer_load_dword a52,v7,s[52:55],s41 offen offset:3072
v_exp_f32 v20,v20
v_exp_f32 v21,v21
v_exp_f32 v22,v22
v_exp_f32 v23,v23
v_cvt_pk_bf16_f32 v50,v20,v21
v_cvt_pk_bf16_f32 v51,v22,v23
v_mfma_f32_32x32x16_bf16 v[152:167],a[56:59],v[56:59],v[152:167]
v_exp_f32 v24,v24
v_exp_f32 v25,v25
v_exp_f32 v26,v26
v_exp_f32 v27,v27
v_cvt_pk_bf16_f32 v52,v24,v25
v_cvt_pk_bf16_f32 v53,v26,v27
v_mfma_f32_32x32x16_bf16 v[152:167],a[60:63],v[60:63],v[152:167]
buffer_load_dwordx4 a[56:59],v248,s[8:11],s41 offen offset:1024
v_exp_f32 v28,v28
v_exp_f32 v29,v29
v_exp_f32 v30,v30
v_exp_f32 v31,v31
v_cvt_pk_bf16_f32 v54,v28,v29
v_cvt_pk_bf16_f32 v55,v30,v31
v_mfma_f32_32x32x16_bf16 v[16:31],a[0:3],v[80:83],0
buffer_load_dwordx4 a[60:63],v248,s[8:11],s41 offen offset:2048
s_add_u32 s41,s41,4096
v_exp_f32 v32,v32
v_exp_f32 v33,v33
v_exp_f32 v34,v34
v_exp_f32 v35,v35
v_cvt_pk_bf16_f32 v56,v32,v33
v_cvt_pk_bf16_f32 v57,v34,v35
v_mfma_f32_32x32x16_bf16 v[16:31],a[4:7],v[84:87],v[16:31]
s_mov_b32 s43,s23
s_add_u32 s23,s23,32768
s_add_u32 m0,s43,0
s_add_u32 s22,s22,28672
buffer_load_dwordx4 v2,s[12:15],s22 offen offset:0 lds
v_exp_f32 v36,v36
v_exp_f32 v37,v37
v_exp_f32 v38,v38
v_exp_f32 v39,v39
v_cvt_pk_bf16_f32 v58,v36,v37
v_cvt_pk_bf16_f32 v59,v38,v39
v_mfma_f32_32x32x16_bf16 v[120:135],a[8:11],v[48:51],v[120:135]
buffer_load_dwordx4 v2,s[12:15],s22 offen offset:1024 lds
v_exp_f32 v40,v40
v_exp_f32 v41,v41
v_exp_f32 v42,v42
v_exp_f32 v43,v43
v_cvt_pk_bf16_f32 v60,v40,v41
v_cvt_pk_bf16_f32 v61,v42,v43
v_mfma_f32_32x32x16_bf16 v[120:135],a[12:15],v[52:55],v[120:135]
buffer_load_dwordx4 v2,s[12:15],s22 offen offset:2048 lds
v_exp_f32 v44,v44
v_exp_f32 v45,v45
v_exp_f32 v46,v46
v_exp_f32 v47,v47
v_cvt_pk_bf16_f32 v62,v44,v45
v_cvt_pk_bf16_f32 v63,v46,v47
s_waitcnt vmcnt(11)
v_mfma_f32_32x32x16_bf16 v[32:47],a[16:19],v[64:67],0
buffer_load_dwordx4 v2,s[12:15],s22 offen offset:3072 lds
v_exp_f32 v16,v16
v_exp_f32 v17,v17
v_exp_f32 v18,v18
v_exp_f32_e64 v19,v19
v_cvt_pk_bf16_f32 v48,v16,v17
v_cvt_pk_bf16_f32 v49,v18,v19
v_mfma_f32_32x32x16_bf16 v[32:47],a[20:23],v[68:71],v[32:47]
s_add_u32 m0,s43,4096
s_add_u32 s22,s22,4096
buffer_load_dwordx4 v2,s[12:15],s22 offen offset:0 lds
v_exp_f32 v20,v20
v_exp_f32 v21,v21
v_exp_f32 v22,v22
v_exp_f32 v23,v23
v_cvt_pk_bf16_f32 v50,v20,v21
v_cvt_pk_bf16_f32 v51,v22,v23
v_mfma_f32_32x32x16_bf16 v[136:151],a[8:11],v[56:59],v[136:151]
buffer_load_dwordx4 v2,s[12:15],s22 offen offset:1024 lds
v_exp_f32 v24,v24
v_exp_f32 v25,v25
v_exp_f32 v26,v26
v_exp_f32 v27,v27
v_cvt_pk_bf16_f32 v52,v24,v25
v_cvt_pk_bf16_f32 v53,v26,v27
v_mfma_f32_32x32x16_bf16 v[136:151],a[12:15],v[60:63],v[136:151]
buffer_load_dwordx4 v2,s[12:15],s22 offen offset:2048 lds
v_exp_f32 v28,v28
v_exp_f32 v29,v29
v_exp_f32 v30,v30
v_exp_f32 v31,v31
v_cvt_pk_bf16_f32 v54,v28,v29
v_cvt_pk_bf16_f32 v55,v30,v31
v_mfma_f32_32x32x16_bf16 v[16:31],a[16:19],v[72:75],0
buffer_load_dwordx4 v2,s[12:15],s22 offen offset:3072 lds
v_exp_f32 v32,v32
v_exp_f32 v33,v33
v_exp_f32 v34,v34
v_exp_f32 v35,v35
v_cvt_pk_bf16_f32 v56,v32,v33
v_cvt_pk_bf16_f32 v57,v34,v35
v_mfma_f32_32x32x16_bf16 v[16:31],a[20:23],v[76:79],v[16:31]
buffer_load_dwordx4 a[128:131],v2,s[8:11],s4 offen offset:0
v_exp_f32 v36,v36
v_exp_f32 v37,v37
v_exp_f32 v38,v38
v_exp_f32 v39,v39
v_cvt_pk_bf16_f32 v58,v36,v37
v_cvt_pk_bf16_f32 v59,v38,v39
v_mfma_f32_32x32x16_bf16 v[152:167],a[8:11],v[48:51],v[152:167]
buffer_load_dwordx4 a[132:135],v2,s[8:11],s4 offen offset:1024
v_exp_f32 v40,v40
v_exp_f32 v41,v41
v_exp_f32 v42,v42
v_exp_f32 v43,v43
v_cvt_pk_bf16_f32 v60,v40,v41
v_cvt_pk_bf16_f32 v61,v42,v43
v_mfma_f32_32x32x16_bf16 v[152:167],a[12:15],v[52:55],v[152:167]
buffer_load_dwordx4 a[136:139],v2,s[8:11],s4 offen offset:2048
v_exp_f32 v44,v44
v_exp_f32 v45,v45
v_exp_f32 v46,v46
v_exp_f32 v47,v47
v_cvt_pk_bf16_f32 v62,v44,v45
v_cvt_pk_bf16_f32 v63,v46,v47
v_mfma_f32_32x32x16_bf16 v[32:47],a[16:19],v[80:83],0
buffer_load_dwordx4 a[140:143],v2,s[8:11],s4 offen offset:3072
s_add_u32 s4,s4,4096
v_exp_f32 v16,v16
v_exp_f32 v17,v17
v_exp_f32 v18,v18
v_exp_f32 v19,v19
v_cvt_pk_bf16_f32 v48,v16,v17
v_cvt_pk_bf16_f32 v49,v18,v19
v_mfma_f32_32x32x16_bf16 v[32:47],a[20:23],v[84:87],v[32:47]
buffer_load_dwordx4 a[144:147],v2,s[8:11],s4 offen offset:0
v_exp_f32 v20,v20
v_exp_f32 v21,v21
v_exp_f32 v22,v22
v_exp_f32 v23,v23
v_cvt_pk_bf16_f32 v50,v20,v21
v_cvt_pk_bf16_f32 v51,v22,v23
v_mfma_f32_32x32x16_bf16 v[120:135],a[24:27],v[56:59],v[120:135]
buffer_load_dwordx4 a[148:151],v2,s[8:11],s4 offen offset:1024
v_exp_f32 v24,v24
v_exp_f32 v25,v25
v_exp_f32 v26,v26
v_exp_f32 v27,v27
v_cvt_pk_bf16_f32 v52,v24,v25
v_cvt_pk_bf16_f32 v53,v26,v27
v_mfma_f32_32x32x16_bf16 v[120:135],a[28:31],v[60:63],v[120:135]
buffer_load_dwordx4 a[152:155],v2,s[8:11],s4 offen offset:2048
v_exp_f32 v28,v28
v_exp_f32 v29,v29
v_exp_f32 v30,v30
v_exp_f32 v31,v31
v_cvt_pk_bf16_f32 v54,v28,v29
v_cvt_pk_bf16_f32 v55,v30,v31
s_waitcnt vmcnt(19)
v_mfma_f32_32x32x16_bf16 v[16:31],a[32:35],v[64:67],0
buffer_load_dwordx4 a[156:159],v2,s[8:11],s4 offen offset:3072
v_exp_f32 v32,v32
v_exp_f32 v33,v33
v_exp_f32 v34,v34
v_exp_f32_e64 v35,v35
v_cvt_pk_bf16_f32 v56,v32,v33
v_cvt_pk_bf16_f32 v57,v34,v35
v_mfma_f32_32x32x16_bf16 v[16:31],a[36:39],v[68:71],v[16:31]
buffer_load_dwordx4 a[160:163],v2,s[8:11],s5 offen offset:0
v_exp_f32 v36,v36
v_exp_f32 v37,v37
v_exp_f32 v38,v38
v_exp_f32 v39,v39
v_cvt_pk_bf16_f32 v58,v36,v37
v_cvt_pk_bf16_f32 v59,v38,v39
v_mfma_f32_32x32x16_bf16 v[136:151],a[24:27],v[48:51],v[136:151]
buffer_load_dwordx4 a[164:167],v2,s[8:11],s5 offen offset:1024
v_exp_f32 v40,v40
v_exp_f32 v41,v41
v_exp_f32 v42,v42
v_exp_f32 v43,v43
v_cvt_pk_bf16_f32 v60,v40,v41
v_cvt_pk_bf16_f32 v61,v42,v43
v_mfma_f32_32x32x16_bf16 v[136:151],a[28:31],v[52:55],v[136:151]
buffer_load_dwordx4 a[168:171],v2,s[8:11],s5 offen offset:2048
v_exp_f32 v44,v44
v_exp_f32 v45,v45
v_exp_f32 v46,v46
v_exp_f32 v47,v47
v_cvt_pk_bf16_f32 v62,v44,v45
v_cvt_pk_bf16_f32 v63,v46,v47
v_mfma_f32_32x32x16_bf16 v[32:47],a[32:35],v[72:75],0
buffer_load_dwordx4 a[172:175],v2,s[8:11],s5 offen offset:3072
s_add_u32 s5,s5,4096
v_exp_f32 v16,v16
v_exp_f32 v17,v17
v_exp_f32 v18,v18
v_exp_f32 v19,v19
v_cvt_pk_bf16_f32 v48,v16,v17
v_cvt_pk_bf16_f32 v49,v18,v19
v_mfma_f32_32x32x16_bf16 v[32:47],a[36:39],v[76:79],v[32:47]
buffer_load_dwordx4 a[176:179],v2,s[8:11],s5 offen offset:0
v_exp_f32 v20,v20
v_exp_f32 v21,v21
v_exp_f32 v22,v22
v_exp_f32 v23,v23
v_cvt_pk_bf16_f32 v50,v20,v21
v_cvt_pk_bf16_f32 v51,v22,v23
v_mfma_f32_32x32x16_bf16 v[152:167],a[24:27],v[56:59],v[152:167]
buffer_load_dwordx4 a[180:183],v2,s[8:11],s5 offen offset:1024
v_exp_f32 v24,v24
v_exp_f32 v25,v25
v_exp_f32 v26,v26
v_exp_f32 v27,v27
v_cvt_pk_bf16_f32 v52,v24,v25
v_cvt_pk_bf16_f32 v53,v26,v27
v_mfma_f32_32x32x16_bf16 v[152:167],a[28:31],v[60:63],v[152:167]
buffer_load_dwordx4 a[184:187],v2,s[8:11],s5 offen offset:2048
v_exp_f32 v28,v28
v_exp_f32 v29,v29
v_exp_f32 v30,v30
v_exp_f32 v31,v31
v_cvt_pk_bf16_f32 v54,v28,v29
v_cvt_pk_bf16_f32 v55,v30,v31
v_mfma_f32_32x32x16_bf16 v[16:31],a[32:35],v[80:83],0
buffer_load_dwordx4 a[188:191],v2,s[8:11],s5 offen offset:3072
v_exp_f32 v32,v32
v_exp_f32 v33,v33
v_exp_f32 v34,v34
v_exp_f32 v35,v35
v_cvt_pk_bf16_f32 v56,v32,v33
v_cvt_pk_bf16_f32 v57,v34,v35
v_mfma_f32_32x32x16_bf16 v[16:31],a[36:39],v[84:87],v[16:31]
s_mov_b32 s43,s23
s_add_u32 s23,s23,32768
s_add_u32 m0,s43,0
s_add_u32 s22,s22,28672
buffer_load_dwordx4 v2,s[12:15],s22 offen offset:0 lds
v_exp_f32 v36,v36
v_exp_f32 v37,v37
v_exp_f32 v38,v38
v_exp_f32 v39,v39
v_cvt_pk_bf16_f32 v58,v36,v37
v_cvt_pk_bf16_f32 v59,v38,v39
v_mfma_f32_32x32x16_bf16 v[120:135],a[40:43],v[48:51],v[120:135]
buffer_load_dwordx4 v2,s[12:15],s22 offen offset:1024 lds
v_exp_f32 v40,v40
v_exp_f32 v41,v41
v_exp_f32 v42,v42
v_exp_f32 v43,v43
v_cvt_pk_bf16_f32 v60,v40,v41
v_cvt_pk_bf16_f32 v61,v42,v43
v_mfma_f32_32x32x16_bf16 v[120:135],a[44:47],v[52:55],v[120:135]
buffer_load_dwordx4 v2,s[12:15],s22 offen offset:2048 lds
v_exp_f32 v44,v44
v_exp_f32 v45,v45
v_exp_f32 v46,v46
v_exp_f32 v47,v47
v_cvt_pk_bf16_f32 v62,v44,v45
v_cvt_pk_bf16_f32 v63,v46,v47
s_waitcnt vmcnt(27)
v_mfma_f32_32x32x16_bf16 v[32:47],a[48:51],v[64:67],0
buffer_load_dwordx4 v2,s[12:15],s22 offen offset:3072 lds
v_exp_f32 v16,v16
v_exp_f32 v17,v17
v_exp_f32 v18,v18
v_exp_f32_e64 v19,v19
v_cvt_pk_bf16_f32 v48,v16,v17
v_cvt_pk_bf16_f32 v49,v18,v19
v_mfma_f32_32x32x16_bf16 v[32:47],a[52:55],v[68:71],v[32:47]
s_add_u32 m0,s43,4096
s_add_u32 s22,s22,4096
buffer_load_dwordx4 v2,s[12:15],s22 offen offset:0 lds
v_exp_f32 v20,v20
v_exp_f32 v21,v21
v_exp_f32 v22,v22
v_exp_f32 v23,v23
v_cvt_pk_bf16_f32 v50,v20,v21
v_cvt_pk_bf16_f32 v51,v22,v23
v_mfma_f32_32x32x16_bf16 v[136:151],a[40:43],v[56:59],v[136:151]
buffer_load_dwordx4 v2,s[12:15],s22 offen offset:1024 lds
v_exp_f32 v24,v24
v_exp_f32 v25,v25
v_exp_f32 v26,v26
v_exp_f32 v27,v27
v_cvt_pk_bf16_f32 v52,v24,v25
v_cvt_pk_bf16_f32 v53,v26,v27
v_mfma_f32_32x32x16_bf16 v[136:151],a[44:47],v[60:63],v[136:151]
buffer_load_dwordx4 v2,s[12:15],s22 offen offset:2048 lds
v_exp_f32 v28,v28
v_exp_f32 v29,v29
v_exp_f32 v30,v30
v_exp_f32 v31,v31
v_cvt_pk_bf16_f32 v54,v28,v29
v_cvt_pk_bf16_f32 v55,v30,v31
v_mfma_f32_32x32x16_bf16 v[16:31],a[48:51],v[72:75],0
buffer_load_dwordx4 v2,s[12:15],s22 offen offset:3072 lds
v_exp_f32 v32,v32
v_exp_f32 v33,v33
v_exp_f32 v34,v34
v_exp_f32 v35,v35
v_cvt_pk_bf16_f32 v56,v32,v33
v_cvt_pk_bf16_f32 v57,v34,v35
v_mfma_f32_32x32x16_bf16 v[16:31],a[52:55],v[76:79],v[16:31]
v_exp_f32 v36,v36
v_exp_f32 v37,v37
v_exp_f32 v38,v38
v_exp_f32 v39,v39
v_cvt_pk_bf16_f32 v58,v36,v37
v_cvt_pk_bf16_f32 v59,v38,v39
v_mfma_f32_32x32x16_bf16 v[152:167],a[40:43],v[48:51],v[152:167]
v_exp_f32 v40,v40
v_exp_f32 v41,v41
v_exp_f32 v42,v42
v_exp_f32 v43,v43
v_cvt_pk_bf16_f32 v60,v40,v41
v_cvt_pk_bf16_f32 v61,v42,v43
v_mfma_f32_32x32x16_bf16 v[152:167],a[44:47],v[52:55],v[152:167]
v_exp_f32 v44,v44
v_exp_f32 v45,v45
v_exp_f32 v46,v46
v_exp_f32 v47,v47
v_cvt_pk_bf16_f32 v62,v44,v45
v_cvt_pk_bf16_f32 v63,v46,v47
v_mfma_f32_32x32x16_bf16 v[32:47],a[48:51],v[80:83],0
v_exp_f32 v16,v16
v_exp_f32 v17,v17
v_exp_f32 v18,v18
v_exp_f32 v19,v19
v_cvt_pk_bf16_f32 v48,v16,v17
v_cvt_pk_bf16_f32 v49,v18,v19
v_mfma_f32_32x32x16_bf16 v[32:47],a[52:55],v[84:87],v[32:47]
v_exp_f32 v20,v20
v_exp_f32 v21,v21
v_exp_f32 v22,v22
v_exp_f32 v23,v23
v_cvt_pk_bf16_f32 v50,v20,v21
v_cvt_pk_bf16_f32 v51,v22,v23
v_mfma_f32_32x32x16_bf16 v[120:135],a[56:59],v[56:59],v[120:135]
v_exp_f32 v24,v24
v_exp_f32 v25,v25
v_exp_f32 v26,v26
v_exp_f32 v27,v27
v_cvt_pk_bf16_f32 v52,v24,v25
v_cvt_pk_bf16_f32 v53,v26,v27
v_mfma_f32_32x32x16_bf16 v[120:135],a[60:63],v[60:63],v[120:135]
v_exp_f32 v28,v28
v_exp_f32 v29,v29
v_exp_f32 v30,v30
v_exp_f32 v31,v31
v_cvt_pk_bf16_f32 v54,v28,v29
v_cvt_pk_bf16_f32 v55,v30,v31
v_exp_f32 v32,v32
v_exp_f32 v33,v33
v_exp_f32 v34,v34
v_exp_f32 v35,v35
v_cvt_pk_bf16_f32 v56,v32,v33
v_cvt_pk_bf16_f32 v57,v34,v35
v_exp_f32 v36,v36
v_exp_f32 v37,v37
v_exp_f32 v38,v38
v_exp_f32 v39,v39
v_cvt_pk_bf16_f32 v58,v36,v37
v_cvt_pk_bf16_f32 v59,v38,v39
v_mfma_f32_32x32x16_bf16 v[136:151],a[56:59],v[48:51],v[136:151]
v_exp_f32 v40,v40
v_exp_f32 v41,v41
v_exp_f32 v42,v42
v_exp_f32 v43,v43
v_cvt_pk_bf16_f32 v60,v40,v41
v_cvt_pk_bf16_f32 v61,v42,v43
v_mfma_f32_32x32x16_bf16 v[136:151],a[60:63],v[52:55],v[136:151]
v_exp_f32 v44,v44
v_exp_f32 v45,v45
v_exp_f32 v46,v46
v_exp_f32 v47,v47
v_cvt_pk_bf16_f32 v62,v44,v45
v_cvt_pk_bf16_f32 v63,v46,v47
s_nop 1
v_mfma_f32_32x32x16_bf16 v[152:167],a[56:59],v[56:59],v[152:167]
s_nop 0
v_mfma_f32_32x32x16_bf16 v[152:167],a[60:63],v[60:63],v[152:167]
s_mul_i32 s24,s37,36864
s_add_u32 s24,s24,79691776
s_lshl_b32 s25,s16,10
s_add_u32 s40,s25,s24
s_lshr_b32 s26,s16,3
s_lshl_b32 s26,s26,10
s_add_u32 s24,s24,s26
s_bfe_u32 s26,s16,0x10002
s_lshl_b32 s26,s26,9
s_add_u32 s24,s24,s26
s_and_b32 s26,s16,3
s_lshl_b32 s26,s26,2
s_add_u32 s24,s24,s26
s_add_u32 s38,s24,32768
v_mov_b32 v14,0x80000000
v_cndmask_b32 v14,v2,v14,s[96:97]
s_cmp_eq_u32 s57,0
s_cbranch_scc1 att3_fin
s_mul_i32 s24,s18,24576
s_add_u32 s24,s24,65536
v_add_u32_e64 v12,s24,v2
ds_write_b128 v12,v[120:123] offset:0
ds_write_b128 v12,v[124:127] offset:1024
ds_write_b128 v12,v[128:131] offset:2048
ds_write_b128 v12,v[136:139] offset:3072
ds_write_b128 v12,v[140:143] offset:4096
ds_write_b128 v12,v[144:147] offset:5120
ds_write_b128 v12,v[152:155] offset:6144
ds_write_b128 v12,v[156:159] offset:7168
ds_write_b128 v12,v[160:163] offset:8192
s_waitcnt lgkmcnt(0)
s_barrier
s_xor_b32 s24,s18,1
s_mul_i32 s24,s24,24576
s_add_u32 s24,s24,65536
v_add_u32_e64 v60,s24,v2
s_xor_b32 s24,s18,2
s_mul_i32 s24,s24,24576
s_add_u32 s24,s24,65536
v_add_u32 v61,s24,v2
s_xor_b32 s24,s18,3
s_mul_i32 s24,s24,24576
s_add_u32 s24,s24,65536
v_add_u32_e64 v62,s24,v2
att3_fin:
s_nop 7
s_lshl_b32 s24,1,s57
s_sub_u32 s24,s24,1
s_and_b32 s24,s24,0
s_cmp_lg_u32 s24,s58
s_cbranch_scc1 att3_skip0
s_cmp_eq_u32 s57,0
s_cbranch_scc1 att3_c0
ds_read_b128 v[16:19],v60 offset:0
ds_read_b128 v[20:23],v60 offset:1024
ds_read_b128 v[24:27],v60 offset:2048
s_waitcnt lgkmcnt(0)
v_add_f32 v120,v120,v16
v_add_f32 v121,v121,v17
v_add_f32 v122,v122,v18
v_add_f32 v123,v123,v19
v_add_f32 v124,v124,v20
v_add_f32 v125,v125,v21
v_add_f32 v126,v126,v22
v_add_f32 v127,v127,v23
v_add_f32 v128,v128,v24
v_add_f32 v129,v129,v25
v_add_f32_e64 v130,v130,v26
att3_c0:
s_mov_b64 vcc,exec
v_cmp_le_f32 s[24:25],s44,v130
v_cmp_ge_f32 s[26:27],s45,v130
s_and_b64 vcc,vcc,s[24:25]
s_and_b64 vcc,vcc,s[26:27]
s_cmp_eq_u64 vcc,exec
s_cbranch_scc0 att3_fb0
att3_ok0:
v_rcp_f32 v130,v130
s_nop 0
v_mul_f32 v120,v130,v120
v_mul_f32 v121,v130,v121
v_mul_f32 v122,v130,v122
v_mul_f32 v123,v130,v123
v_mul_f32 v124,v130,v124
v_mul_f32 v125,v130,v125
v_mul_f32 v126,v130,v126
v_mul_f32 v127,v130,v127
v_mul_f32 v128,v130,v128
v_mul_f32 v129,v130,v129
v_cvt_pk_bf16_f32 v132,v120,v121
v_cvt_pk_bf16_f32 v133,v122,v123
v_cvt_pk_bf16_f32 v134,v124,v125
v_cvt_pk_bf16_f32 v135,v126,v127
v_cvt_pk_bf16_f32 v131,v128,v129
buffer_store_dwordx4 v[132:135],v2,s[8:11],s40 offen
buffer_store_dword v131,v14,s[8:11],s38 offen
att3_skip0:
s_add_u32 s40,s40,36864
s_add_u32 s38,s38,36864
s_lshl_b32 s24,1,s57
s_sub_u32 s24,s24,1
s_and_b32 s24,s24,1
s_cmp_lg_u32 s24,s58
s_cbranch_scc1 att3_skip1
s_cmp_eq_u32 s57,0
s_cbranch_scc1 att3_c1
ds_read_b128 v[16:19],v60 offset:3072
ds_read_b128 v[20:23],v60 offset:4096
ds_read_b128 v[24:27],v60 offset:5120
s_waitcnt lgkmcnt(0)
v_add_f32 v136,v136,v16
v_add_f32 v137,v137,v17
v_add_f32 v138,v138,v18
v_add_f32 v139,v139,v19
v_add_f32 v140,v140,v20
v_add_f32 v141,v141,v21
v_add_f32 v142,v142,v22
v_add_f32 v143,v143,v23
v_add_f32 v144,v144,v24
v_add_f32 v145,v145,v25
v_add_f32 v146,v146,v26
att3_c1:
s_mov_b64 vcc,exec
v_cmp_le_f32 s[24:25],s44,v146
v_cmp_ge_f32 s[26:27],s45,v146
s_and_b64 vcc,vcc,s[24:25]
s_and_b64 vcc,vcc,s[26:27]
s_cmp_eq_u64 vcc,exec
s_cbranch_scc0 att3_fb1
att3_ok1:
v_rcp_f32 v146,v146
s_nop 0
v_mul_f32 v136,v146,v136
v_mul_f32 v137,v146,v137
v_mul_f32 v138,v146,v138
v_mul_f32 v139,v146,v139
v_mul_f32 v140,v146,v140
v_mul_f32 v141,v146,v141
v_mul_f32 v142,v146,v142
v_mul_f32 v143,v146,v143
v_mul_f32 v144,v146,v144
v_mul_f32 v145,v146,v145
v_cvt_pk_bf16_f32 v148,v136,v137
v_cvt_pk_bf16_f32 v149,v138,v139
v_cvt_pk_bf16_f32 v150,v140,v141
v_cvt_pk_bf16_f32 v151,v142,v143
v_cvt_pk_bf16_f32 v147,v144,v145
buffer_store_dwordx4 v[148:151],v2,s[8:11],s40 offen
buffer_store_dword v147,v14,s[8:11],s38 offen
att3_skip1:
s_add_u32 s40,s40,36864
s_add_u32 s38,s38,36864
s_lshl_b32 s24,1,s57
s_sub_u32 s24,s24,1
s_and_b32 s24,s24,2
s_cmp_lg_u32 s24,s58
s_cbranch_scc1 att3_skip2
s_cmp_eq_u32 s57,0
s_cbranch_scc1 att3_c2
ds_read_b128 v[16:19],v60 offset:6144
ds_read_b128 v[20:23],v60 offset:7168
ds_read_b128 v[24:27],v60 offset:8192
s_waitcnt lgkmcnt(0)
v_add_f32 v152,v152,v16
v_add_f32 v153,v153,v17
v_add_f32 v154,v154,v18
v_add_f32 v155,v155,v19
v_add_f32 v156,v156,v20
v_add_f32 v157,v157,v21
v_add_f32 v158,v158,v22
v_add_f32 v159,v159,v23
v_add_f32 v160,v160,v24
v_add_f32 v161,v161,v25
v_add_f32 v162,v162,v26
att3_c2:
s_mov_b64 vcc,exec
v_cmp_le_f32 s[24:25],s44,v162
v_cmp_ge_f32 s[26:27],s45,v162
s_and_b64 vcc,vcc,s[24:25]
s_and_b64 vcc,vcc,s[26:27]
s_cmp_eq_u64 vcc,exec
s_cbranch_scc0 att3_fb2
att3_ok2:
v_rcp_f32 v162,v162
s_nop 0
v_mul_f32 v152,v162,v152
v_mul_f32 v153,v162,v153
v_mul_f32 v154,v162,v154
v_mul_f32 v155,v162,v155
v_mul_f32 v156,v162,v156
v_mul_f32 v157,v162,v157
v_mul_f32 v158,v162,v158
v_mul_f32 v159,v162,v159
v_mul_f32 v160,v162,v160
v_mul_f32 v161,v162,v161
v_cvt_pk_bf16_f32 v164,v152,v153
v_cvt_pk_bf16_f32 v165,v154,v155
v_cvt_pk_bf16_f32 v166,v156,v157
v_cvt_pk_bf16_f32 v167,v158,v159
v_cvt_pk_bf16_f32 v163,v160,v161
buffer_store_dwordx4 v[164:167],v2,s[8:11],s40 offen
buffer_store_dword v163,v14,s[8:11],s38 offen
att3_skip2:
s_add_u32 s40,s40,36864
s_add_u32 s38,s38,36864
s_cmp_eq_u32 s57,0
s_cbranch_scc1 k2_B
s_barrier
s_branch k2_B
att4:
v_accvgpr_write_b32 a5,v13
v_accvgpr_write_b32 a6,0
v_accvgpr_write_b32 a7,0
v_accvgpr_write_b32 a21,v13
v_accvgpr_write_b32 a22,0
v_accvgpr_write_b32 a23,0
v_accvgpr_write_b32 a37,v13
v_accvgpr_write_b32 a38,0
v_accvgpr_write_b32 a39,0
v_accvgpr_write_b32 a53,v13
v_accvgpr_write_b32 a54,0
v_accvgpr_write_b32 a55,0
v_mov_b32 v69,0
v_mov_b32 v70,0
v_mov_b32 v71,0
v_mov_b32 v77,0
v_mov_b32 v78,0
v_mov_b32 v79,0
v_mov_b32 v85,0
v_mov_b32 v86,0
v_mov_b32 v87,0
v_mov_b32 v93,0
v_mov_b32 v94,0
v_mov_b32 v95,0
v_mov_b32 v48,0
v_mov_b32 v49,0
v_mov_b32 v50,0
v_mov_b32 v51,0
v_mov_b32 v52,0
v_mov_b32 v53,0
v_mov_b32 v54,0
v_mov_b32 v55,0
v_mov_b32 v56,0
v_mov_b32 v57,0
v_mov_b32 v58,0
v_mov_b32 v59,0
v_mov_b32 v60,0
v_mov_b32 v61,0
v_mov_b32 v62,0
v_mov_b32_e64 v63,0
s_nop 1
v_mfma_f32_32x32x16_bf16 v[120:135],v[48:51],v[48:51],0
v_mfma_f32_32x32x16_bf16 v[136:151],v[48:51],v[48:51],0
v_mfma_f32_32x32x16_bf16 v[152:167],v[48:51],v[48:51],0
v_mfma_f32_32x32x16_bf16 v[168:183],v[48:51],v[48:51],0
v_accvgpr_write_b32 a56,0
v_accvgpr_write_b32 a57,0
v_accvgpr_write_b32 a58,0
v_accvgpr_write_b32 a59,0
v_accvgpr_write_b32 a60,0
v_accvgpr_write_b32 a61,0
v_accvgpr_write_b32 a62,0
v_accvgpr_write_b32 a63,0
s_waitcnt vmcnt(17)
v_cndmask_b32 v68,v68,0,s[96:97]
v_cndmask_b32 v76,v76,0,s[96:97]
v_cndmask_b32 v84,v84,0,s[96:97]
v_cndmask_b32 v92,v92,0,s[96:97]
s_nop 0
v_mfma_f32_32x32x16_bf16 v[16:31],a[48:51],v[64:67],0
v_mfma_f32_32x32x16_bf16 v[16:31],a[52:55],v[68:71],v[16:31]
v_mfma_f32_32x32x16_bf16 v[32:47],a[48:51],v[72:75],0
v_mfma_f32_32x32x16_bf16 v[32:47],a[52:55],v[76:79],v[32:47]
s_nop 9
v_max_f32 v10,v16,v17
v_max3_f32 v10,v10,v18,v19
v_max3_f32 v10,v10,v20,v21
v_max3_f32 v10,v10,v22,v23
v_max3_f32 v10,v10,v24,v25
v_max3_f32 v10,v10,v26,v27
v_max3_f32 v10,v10,v28,v29
v_max3_f32 v10,v10,v30,v31
v_mov_b32 v12,v10
s_nop 1
v_permlane32_swap_b32 v10,v12
v_max_f32 v10,v10,v12
v_sub_f32_e64 v10,0,v10
v_cvt_pk_bf16_f32 v10,v10,0
v_cndmask_b32 v69,v10,0,s[96:97]
v_mfma_f32_32x32x16_bf16 v[16:31],a[48:51],v[80:83],0
v_mfma_f32_32x32x16_bf16 v[16:31],a[52:55],v[84:87],v[16:31]
v_max_f32_e64 v10,v32,v33
v_max3_f32 v10,v10,v34,v35
v_max3_f32 v10,v10,v36,v37
v_max3_f32 v10,v10,v38,v39
v_max3_f32 v10,v10,v40,v41
v_max3_f32 v10,v10,v42,v43
v_max3_f32 v10,v10,v44,v45
v_max3_f32 v10,v10,v46,v47
v_mov_b32 v12,v10
s_nop 1
v_permlane32_swap_b32 v10,v12
v_max_f32 v10,v10,v12
v_sub_f32_e64 v10,0,v10
v_cvt_pk_bf16_f32 v10,v10,0
v_cndmask_b32 v77,v10,0,s[96:97]
v_mfma_f32_32x32x16_bf16 v[32:47],a[48:51],v[88:91],0
v_mfma_f32_32x32x16_bf16 v[32:47],a[52:55],v[92:95],v[32:47]
v_max_f32_e64 v10,v16,v17
v_max3_f32 v10,v10,v18,v19
v_max3_f32 v10,v10,v20,v21
v_max3_f32 v10,v10,v22,v23
v_max3_f32 v10,v10,v24,v25
v_max3_f32 v10,v10,v26,v27
v_max3_f32 v10,v10,v28,v29
v_max3_f32 v10,v10,v30,v31
v_mov_b32 v12,v10
s_nop 1
v_permlane32_swap_b32 v10,v12
v_max_f32 v10,v10,v12
v_sub_f32_e64 v10,0,v10
v_cvt_pk_bf16_f32 v10,v10,0
v_cndmask_b32 v85,v10,0,s[96:97]
v_max_f32_e64 v10,v32,v33
v_max3_f32 v10,v10,v34,v35
v_max3_f32 v10,v10,v36,v37
v_max3_f32 v10,v10,v38,v39
v_max3_f32 v10,v10,v40,v41
v_max3_f32 v10,v10,v42,v43
v_max3_f32 v10,v10,v44,v45
v_max3_f32 v10,v10,v46,v47
v_mov_b32 v12,v10
s_nop 1
v_permlane32_swap_b32 v10,v12
v_max_f32 v10,v10,v12
v_sub_f32_e64 v10,0,v10
v_cvt_pk_bf16_f32 v10,v10,0
v_cndmask_b32 v93,v10,0,s[96:97]
s_mov_b32 s39,s60
s_waitcnt vmcnt(13)
v_mfma_f32_32x32x16_bf16 v[16:31],a[0:3],v[64:67],0
v_mfma_f32_32x32x16_bf16 v[16:31],a[4:7],v[68:71],v[16:31]
s_nop 9
s_sub_u32 s39,s39,1
att4_loop:
v_mfma_f32_32x32x16_bf16 v[32:47],a[0:3],v[72:75],0
buffer_load_dwordx4 a[48:51],v2,s[8:11],s41 offen
v_exp_f32 v16,v16
v_exp_f32 v17,v17
v_exp_f32 v18,v18
v_exp_f32 v19,v19
v_cvt_pk_bf16_f32 v48,v16,v17
v_cvt_pk_bf16_f32 v49,v18,v19
v_mfma_f32_32x32x16_bf16 v[32:47],a[4:7],v[76:79],v[32:47]
buffer_load_dword a52,v7,s[52:55],s41 offen offset:3072
v_exp_f32 v20,v20
v_exp_f32 v21,v21
v_exp_f32 v22,v22
v_exp_f32 v23,v23
v_cvt_pk_bf16_f32 v50,v20,v21
v_cvt_pk_bf16_f32 v51,v22,v23
v_mfma_f32_32x32x16_bf16 v[168:183],a[56:59],v[56:59],v[168:183]
v_exp_f32 v24,v24
v_exp_f32 v25,v25
v_exp_f32 v26,v26
v_exp_f32 v27,v27
v_cvt_pk_bf16_f32 v52,v24,v25
v_cvt_pk_bf16_f32 v53,v26,v27
v_mfma_f32_32x32x16_bf16 v[168:183],a[60:63],v[60:63],v[168:183]
buffer_load_dwordx4 a[56:59],v248,s[8:11],s41 offen offset:1024
v_exp_f32 v28,v28
v_exp_f32 v29,v29
v_exp_f32 v30,v30
v_exp_f32 v31,v31
v_cvt_pk_bf16_f32 v54,v28,v29
v_cvt_pk_bf16_f32 v55,v30,v31
v_mfma_f32_32x32x16_bf16 v[16:31],a[0:3],v[80:83],0
buffer_load_dwordx4 a[60:63],v248,s[8:11],s41 offen offset:2048
s_add_u32 s41,s41,4096
v_exp_f32 v32,v32
v_exp_f32 v33,v33
v_exp_f32 v34,v34
v_exp_f32 v35,v35
v_cvt_pk_bf16_f32 v56,v32,v33
v_cvt_pk_bf16_f32 v57,v34,v35
v_mfma_f32_32x32x16_bf16 v[16:31],a[4:7],v[84:87],v[16:31]
v_exp_f32 v36,v36
v_exp_f32 v37,v37
v_exp_f32 v38,v38
v_exp_f32 v39,v39
v_cvt_pk_bf16_f32 v58,v36,v37
v_cvt_pk_bf16_f32 v59,v38,v39
v_mfma_f32_32x32x16_bf16 v[120:135],a[8:11],v[48:51],v[120:135]
v_exp_f32 v40,v40
v_exp_f32 v41,v41
v_exp_f32 v42,v42
v_exp_f32 v43,v43
v_cvt_pk_bf16_f32 v60,v40,v41
v_cvt_pk_bf16_f32 v61,v42,v43
v_mfma_f32_32x32x16_bf16 v[120:135],a[12:15],v[52:55],v[120:135]
v_exp_f32 v44,v44
v_exp_f32 v45,v45
v_exp_f32 v46,v46
v_exp_f32 v47,v47
v_cvt_pk_bf16_f32 v62,v44,v45
v_cvt_pk_bf16_f32 v63,v46,v47
v_mfma_f32_32x32x16_bf16 v[32:47],a[0:3],v[88:91],0
v_exp_f32 v16,v16
v_exp_f32 v17,v17
v_exp_f32 v18,v18
v_exp_f32 v19,v19
v_cvt_pk_bf16_f32 v48,v16,v17
v_cvt_pk_bf16_f32 v49,v18,v19
v_mfma_f32_32x32x16_bf16 v[32:47],a[4:7],v[92:95],v[32:47]
v_exp_f32 v20,v20
v_exp_f32 v21,v21
v_exp_f32 v22,v22
v_exp_f32 v23,v23
v_cvt_pk_bf16_f32 v50,v20,v21
v_cvt_pk_bf16_f32 v51,v22,v23
v_mfma_f32_32x32x16_bf16 v[136:151],a[8:11],v[56:59],v[136:151]
v_exp_f32 v24,v24
v_exp_f32 v25,v25
v_exp_f32 v26,v26
v_exp_f32 v27,v27
v_cvt_pk_bf16_f32 v52,v24,v25
v_cvt_pk_bf16_f32 v53,v26,v27
v_mfma_f32_32x32x16_bf16 v[136:151],a[12:15],v[60:63],v[136:151]
v_exp_f32 v28,v28
v_exp_f32 v29,v29
v_exp_f32 v30,v30
v_exp_f32 v31,v31
v_cvt_pk_bf16_f32 v54,v28,v29
v_cvt_pk_bf16_f32 v55,v30,v31
s_waitcnt vmcnt(8)
v_mfma_f32_32x32x16_bf16 v[16:31],a[16:19],v[64:67],0
v_exp_f32 v32,v32
v_exp_f32 v33,v33
v_exp_f32 v34,v34
v_exp_f32_e64 v35,v35
v_cvt_pk_bf16_f32 v56,v32,v33
v_cvt_pk_bf16_f32 v57,v34,v35
v_mfma_f32_32x32x16_bf16 v[16:31],a[20:23],v[68:71],v[16:31]
v_exp_f32 v36,v36
v_exp_f32 v37,v37
v_exp_f32 v38,v38
v_exp_f32 v39,v39
v_cvt_pk_bf16_f32 v58,v36,v37
v_cvt_pk_bf16_f32 v59,v38,v39
v_mfma_f32_32x32x16_bf16 v[152:167],a[8:11],v[48:51],v[152:167]
v_exp_f32 v40,v40
v_exp_f32 v41,v41
v_exp_f32 v42,v42
v_exp_f32 v43,v43
v_cvt_pk_bf16_f32 v60,v40,v41
v_cvt_pk_bf16_f32 v61,v42,v43
v_mfma_f32_32x32x16_bf16 v[152:167],a[12:15],v[52:55],v[152:167]
v_exp_f32 v44,v44
v_exp_f32 v45,v45
v_exp_f32 v46,v46
v_exp_f32 v47,v47
v_cvt_pk_bf16_f32 v62,v44,v45
v_cvt_pk_bf16_f32 v63,v46,v47
v_mfma_f32_32x32x16_bf16 v[32:47],a[16:19],v[72:75],0
buffer_load_dwordx4 a[0:3],v2,s[8:11],s41 offen
v_exp_f32 v16,v16
v_exp_f32 v17,v17
v_exp_f32 v18,v18
v_exp_f32 v19,v19
v_cvt_pk_bf16_f32 v48,v16,v17
v_cvt_pk_bf16_f32 v49,v18,v19
v_mfma_f32_32x32x16_bf16 v[32:47],a[20:23],v[76:79],v[32:47]
buffer_load_dword a4,v7,s[52:55],s41 offen offset:3072
v_exp_f32 v20,v20
v_exp_f32 v21,v21
v_exp_f32 v22,v22
v_exp_f32 v23,v23
v_cvt_pk_bf16_f32 v50,v20,v21
v_cvt_pk_bf16_f32 v51,v22,v23
v_mfma_f32_32x32x16_bf16 v[168:183],a[8:11],v[56:59],v[168:183]
v_exp_f32 v24,v24
v_exp_f32 v25,v25
v_exp_f32 v26,v26
v_exp_f32 v27,v27
v_cvt_pk_bf16_f32 v52,v24,v25
v_cvt_pk_bf16_f32 v53,v26,v27
v_mfma_f32_32x32x16_bf16 v[168:183],a[12:15],v[60:63],v[168:183]
buffer_load_dwordx4 a[8:11],v248,s[8:11],s41 offen offset:1024
v_exp_f32 v28,v28
v_exp_f32 v29,v29
v_exp_f32 v30,v30
v_exp_f32 v31,v31
v_cvt_pk_bf16_f32 v54,v28,v29
v_cvt_pk_bf16_f32 v55,v30,v31
v_mfma_f32_32x32x16_bf16 v[16:31],a[16:19],v[80:83],0
buffer_load_dwordx4 a[12:15],v248,s[8:11],s41 offen offset:2048
s_add_u32 s41,s41,4096
v_exp_f32 v32,v32
v_exp_f32 v33,v33
v_exp_f32 v34,v34
v_exp_f32 v35,v35
v_cvt_pk_bf16_f32 v56,v32,v33
v_cvt_pk_bf16_f32 v57,v34,v35
v_mfma_f32_32x32x16_bf16 v[16:31],a[20:23],v[84:87],v[16:31]
v_exp_f32 v36,v36
v_exp_f32 v37,v37
v_exp_f32 v38,v38
v_exp_f32 v39,v39
v_cvt_pk_bf16_f32 v58,v36,v37
v_cvt_pk_bf16_f32 v59,v38,v39
v_mfma_f32_32x32x16_bf16 v[120:135],a[24:27],v[48:51],v[120:135]
v_exp_f32 v40,v40
v_exp_f32 v41,v41
v_exp_f32 v42,v42
v_exp_f32 v43,v43
v_cvt_pk_bf16_f32 v60,v40,v41
v_cvt_pk_bf16_f32 v61,v42,v43
v_mfma_f32_32x32x16_bf16 v[120:135],a[28:31],v[52:55],v[120:135]
v_exp_f32 v44,v44
v_exp_f32 v45,v45
v_exp_f32 v46,v46
v_exp_f32 v47,v47
v_cvt_pk_bf16_f32 v62,v44,v45
v_cvt_pk_bf16_f32 v63,v46,v47
v_mfma_f32_32x32x16_bf16 v[32:47],a[16:19],v[88:91],0
v_exp_f32 v16,v16
v_exp_f32 v17,v17
v_exp_f32 v18,v18
v_exp_f32 v19,v19
v_cvt_pk_bf16_f32 v48,v16,v17
v_cvt_pk_bf16_f32 v49,v18,v19
v_mfma_f32_32x32x16_bf16 v[32:47],a[20:23],v[92:95],v[32:47]
v_exp_f32 v20,v20
v_exp_f32 v21,v21
v_exp_f32 v22,v22
v_exp_f32 v23,v23
v_cvt_pk_bf16_f32 v50,v20,v21
v_cvt_pk_bf16_f32 v51,v22,v23
v_mfma_f32_32x32x16_bf16 v[136:151],a[24:27],v[56:59],v[136:151]
v_exp_f32 v24,v24
v_exp_f32 v25,v25
v_exp_f32 v26,v26
v_exp_f32 v27,v27
v_cvt_pk_bf16_f32 v52,v24,v25
v_cvt_pk_bf16_f32 v53,v26,v27
v_mfma_f32_32x32x16_bf16 v[136:151],a[28:31],v[60:63],v[136:151]
v_exp_f32 v28,v28
v_exp_f32 v29,v29
v_exp_f32 v30,v30
v_exp_f32 v31,v31
v_cvt_pk_bf16_f32 v54,v28,v29
v_cvt_pk_bf16_f32 v55,v30,v31
s_waitcnt vmcnt(8)
v_mfma_f32_32x32x16_bf16 v[16:31],a[32:35],v[64:67],0
v_exp_f32 v32,v32
v_exp_f32 v33,v33
v_exp_f32 v34,v34
v_exp_f32_e64 v35,v35
v_cvt_pk_bf16_f32 v56,v32,v33
v_cvt_pk_bf16_f32 v57,v34,v35
v_mfma_f32_32x32x16_bf16 v[16:31],a[36:39],v[68:71],v[16:31]
v_exp_f32 v36,v36
v_exp_f32 v37,v37
v_exp_f32 v38,v38
v_exp_f32 v39,v39
v_cvt_pk_bf16_f32 v58,v36,v37
v_cvt_pk_bf16_f32 v59,v38,v39
v_mfma_f32_32x32x16_bf16 v[152:167],a[24:27],v[48:51],v[152:167]
v_exp_f32 v40,v40
v_exp_f32 v41,v41
v_exp_f32 v42,v42
v_exp_f32 v43,v43
v_cvt_pk_bf16_f32 v60,v40,v41
v_cvt_pk_bf16_f32 v61,v42,v43
v_mfma_f32_32x32x16_bf16 v[152:167],a[28:31],v[52:55],v[152:167]
v_exp_f32 v44,v44
v_exp_f32 v45,v45
v_exp_f32 v46,v46
v_exp_f32 v47,v47
v_cvt_pk_bf16_f32 v62,v44,v45
v_cvt_pk_bf16_f32 v63,v46,v47
v_mfma_f32_32x32x16_bf16 v[32:47],a[32:35],v[72:75],0
buffer_load_dwordx4 a[16:19],v2,s[8:11],s41 offen
v_exp_f32 v16,v16
v_exp_f32 v17,v17
v_exp_f32 v18,v18
v_exp_f32 v19,v19
v_cvt_pk_bf16_f32 v48,v16,v17
v_cvt_pk_bf16_f32 v49,v18,v19
v_mfma_f32_32x32x16_bf16 v[32:47],a[36:39],v[76:79],v[32:47]
buffer_load_dword a20,v7,s[52:55],s41 offen offset:3072
v_exp_f32 v20,v20
v_exp_f32 v21,v21
v_exp_f32 v22,v22
v_exp_f32 v23,v23
v_cvt_pk_bf16_f32 v50,v20,v21
v_cvt_pk_bf16_f32 v51,v22,v23
v_mfma_f32_32x32x16_bf16 v[168:183],a[24:27],v[56:59],v[168:183]
v_exp_f32 v24,v24
v_exp_f32 v25,v25
v_exp_f32 v26,v26
v_exp_f32 v27,v27
v_cvt_pk_bf16_f32 v52,v24,v25
v_cvt_pk_bf16_f32 v53,v26,v27
v_mfma_f32_32x32x16_bf16 v[168:183],a[28:31],v[60:63],v[168:183]
buffer_load_dwordx4 a[24:27],v248,s[8:11],s41 offen offset:1024
v_exp_f32 v28,v28
v_exp_f32 v29,v29
v_exp_f32 v30,v30
v_exp_f32 v31,v31
v_cvt_pk_bf16_f32 v54,v28,v29
v_cvt_pk_bf16_f32 v55,v30,v31
v_mfma_f32_32x32x16_bf16 v[16:31],a[32:35],v[80:83],0
buffer_load_dwordx4 a[28:31],v248,s[8:11],s41 offen offset:2048
s_add_u32 s41,s41,4096
v_exp_f32 v32,v32
v_exp_f32 v33,v33
v_exp_f32 v34,v34
v_exp_f32 v35,v35
v_cvt_pk_bf16_f32 v56,v32,v33
v_cvt_pk_bf16_f32 v57,v34,v35
v_mfma_f32_32x32x16_bf16 v[16:31],a[36:39],v[84:87],v[16:31]
v_exp_f32 v36,v36
v_exp_f32 v37,v37
v_exp_f32 v38,v38
v_exp_f32 v39,v39
v_cvt_pk_bf16_f32 v58,v36,v37
v_cvt_pk_bf16_f32 v59,v38,v39
v_mfma_f32_32x32x16_bf16 v[120:135],a[40:43],v[48:51],v[120:135]
v_exp_f32 v40,v40
v_exp_f32 v41,v41
v_exp_f32 v42,v42
v_exp_f32 v43,v43
v_cvt_pk_bf16_f32 v60,v40,v41
v_cvt_pk_bf16_f32 v61,v42,v43
v_mfma_f32_32x32x16_bf16 v[120:135],a[44:47],v[52:55],v[120:135]
v_exp_f32 v44,v44
v_exp_f32 v45,v45
v_exp_f32 v46,v46
v_exp_f32 v47,v47
v_cvt_pk_bf16_f32 v62,v44,v45
v_cvt_pk_bf16_f32 v63,v46,v47
v_mfma_f32_32x32x16_bf16 v[32:47],a[32:35],v[88:91],0
v_exp_f32 v16,v16
v_exp_f32 v17,v17
v_exp_f32 v18,v18
v_exp_f32 v19,v19
v_cvt_pk_bf16_f32 v48,v16,v17
v_cvt_pk_bf16_f32 v49,v18,v19
v_mfma_f32_32x32x16_bf16 v[32:47],a[36:39],v[92:95],v[32:47]
v_exp_f32 v20,v20
v_exp_f32 v21,v21
v_exp_f32 v22,v22
v_exp_f32 v23,v23
v_cvt_pk_bf16_f32 v50,v20,v21
v_cvt_pk_bf16_f32 v51,v22,v23
v_mfma_f32_32x32x16_bf16 v[136:151],a[40:43],v[56:59],v[136:151]
v_exp_f32 v24,v24
v_exp_f32 v25,v25
v_exp_f32 v26,v26
v_exp_f32 v27,v27
v_cvt_pk_bf16_f32 v52,v24,v25
v_cvt_pk_bf16_f32 v53,v26,v27
v_mfma_f32_32x32x16_bf16 v[136:151],a[44:47],v[60:63],v[136:151]
v_exp_f32 v28,v28
v_exp_f32 v29,v29
v_exp_f32 v30,v30
v_exp_f32 v31,v31
v_cvt_pk_bf16_f32 v54,v28,v29
v_cvt_pk_bf16_f32 v55,v30,v31
s_waitcnt vmcnt(8)
v_mfma_f32_32x32x16_bf16 v[16:31],a[48:51],v[64:67],0
v_exp_f32 v32,v32
v_exp_f32 v33,v33
v_exp_f32 v34,v34
v_exp_f32_e64 v35,v35
v_cvt_pk_bf16_f32 v56,v32,v33
v_cvt_pk_bf16_f32 v57,v34,v35
v_mfma_f32_32x32x16_bf16 v[16:31],a[52:55],v[68:71],v[16:31]
v_exp_f32 v36,v36
v_exp_f32 v37,v37
v_exp_f32 v38,v38
v_exp_f32 v39,v39
v_cvt_pk_bf16_f32 v58,v36,v37
v_cvt_pk_bf16_f32 v59,v38,v39
v_mfma_f32_32x32x16_bf16 v[152:167],a[40:43],v[48:51],v[152:167]
v_exp_f32 v40,v40
v_exp_f32 v41,v41
v_exp_f32 v42,v42
v_exp_f32 v43,v43
v_cvt_pk_bf16_f32 v60,v40,v41
v_cvt_pk_bf16_f32 v61,v42,v43
v_mfma_f32_32x32x16_bf16 v[152:167],a[44:47],v[52:55],v[152:167]
v_exp_f32 v44,v44
v_exp_f32 v45,v45
v_exp_f32 v46,v46
v_exp_f32 v47,v47
v_cvt_pk_bf16_f32 v62,v44,v45
v_cvt_pk_bf16_f32 v63,v46,v47
v_mfma_f32_32x32x16_bf16 v[32:47],a[48:51],v[72:75],0
buffer_load_dwordx4 a[32:35],v2,s[8:11],s41 offen
v_exp_f32 v16,v16
v_exp_f32 v17,v17
v_exp_f32 v18,v18
v_exp_f32 v19,v19
v_cvt_pk_bf16_f32 v48,v16,v17
v_cvt_pk_bf16_f32 v49,v18,v19
v_mfma_f32_32x32x16_bf16 v[32:47],a[52:55],v[76:79],v[32:47]
buffer_load_dword a36,v7,s[52:55],s41 offen offset:3072
v_exp_f32 v20,v20
v_exp_f32 v21,v21
v_exp_f32 v22,v22
v_exp_f32 v23,v23
v_cvt_pk_bf16_f32 v50,v20,v21
v_cvt_pk_bf16_f32 v51,v22,v23
v_mfma_f32_32x32x16_bf16 v[168:183],a[40:43],v[56:59],v[168:183]
v_exp_f32 v24,v24
v_exp_f32 v25,v25
v_exp_f32 v26,v26
v_exp_f32 v27,v27
v_cvt_pk_bf16_f32 v52,v24,v25
v_cvt_pk_bf16_f32 v53,v26,v27
v_mfma_f32_32x32x16_bf16 v[168:183],a[44:47],v[60:63],v[168:183]
buffer_load_dwordx4 a[40:43],v248,s[8:11],s41 offen offset:1024
v_exp_f32 v28,v28
v_exp_f32 v29,v29
v_exp_f32 v30,v30
v_exp_f32 v31,v31
v_cvt_pk_bf16_f32 v54,v28,v29
v_cvt_pk_bf16_f32 v55,v30,v31
v_mfma_f32_32x32x16_bf16 v[16:31],a[48:51],v[80:83],0
buffer_load_dwordx4 a[44:47],v248,s[8:11],s41 offen offset:2048
s_add_u32 s41,s41,4096
v_exp_f32 v32,v32
v_exp_f32 v33,v33
v_exp_f32 v34,v34
v_exp_f32 v35,v35
v_cvt_pk_bf16_f32 v56,v32,v33
v_cvt_pk_bf16_f32 v57,v34,v35
v_mfma_f32_32x32x16_bf16 v[16:31],a[52:55],v[84:87],v[16:31]
v_exp_f32 v36,v36
v_exp_f32 v37,v37
v_exp_f32 v38,v38
v_exp_f32 v39,v39
v_cvt_pk_bf16_f32 v58,v36,v37
v_cvt_pk_bf16_f32 v59,v38,v39
v_mfma_f32_32x32x16_bf16 v[120:135],a[56:59],v[48:51],v[120:135]
v_exp_f32 v40,v40
v_exp_f32 v41,v41
v_exp_f32 v42,v42
v_exp_f32 v43,v43
v_cvt_pk_bf16_f32 v60,v40,v41
v_cvt_pk_bf16_f32 v61,v42,v43
v_mfma_f32_32x32x16_bf16 v[120:135],a[60:63],v[52:55],v[120:135]
v_exp_f32 v44,v44
v_exp_f32 v45,v45
v_exp_f32 v46,v46
v_exp_f32 v47,v47
v_cvt_pk_bf16_f32 v62,v44,v45
v_cvt_pk_bf16_f32 v63,v46,v47
v_mfma_f32_32x32x16_bf16 v[32:47],a[48:51],v[88:91],0
v_exp_f32 v16,v16
v_exp_f32 v17,v17
v_exp_f32 v18,v18
v_exp_f32 v19,v19
v_cvt_pk_bf16_f32 v48,v16,v17
v_cvt_pk_bf16_f32 v49,v18,v19
v_mfma_f32_32x32x16_bf16 v[32:47],a[52:55],v[92:95],v[32:47]
v_exp_f32 v20,v20
v_exp_f32 v21,v21
v_exp_f32 v22,v22
v_exp_f32 v23,v23
v_cvt_pk_bf16_f32 v50,v20,v21
v_cvt_pk_bf16_f32 v51,v22,v23
v_mfma_f32_32x32x16_bf16 v[136:151],a[56:59],v[56:59],v[136:151]
v_exp_f32 v24,v24
v_exp_f32 v25,v25
v_exp_f32 v26,v26
v_exp_f32 v27,v27
v_cvt_pk_bf16_f32 v52,v24,v25
v_cvt_pk_bf16_f32 v53,v26,v27
v_mfma_f32_32x32x16_bf16 v[136:151],a[60:63],v[60:63],v[136:151]
v_exp_f32 v28,v28
v_exp_f32 v29,v29
v_exp_f32 v30,v30
v_exp_f32 v31,v31
v_cvt_pk_bf16_f32 v54,v28,v29
v_cvt_pk_bf16_f32 v55,v30,v31
s_waitcnt vmcnt(8)
v_mfma_f32_32x32x16_bf16 v[16:31],a[0:3],v[64:67],0
v_exp_f32 v32,v32
v_exp_f32 v33,v33
v_exp_f32 v34,v34
v_exp_f32_e64 v35,v35
v_cvt_pk_bf16_f32 v56,v32,v33
v_cvt_pk_bf16_f32 v57,v34,v35
v_mfma_f32_32x32x16_bf16 v[16:31],a[4:7],v[68:71],v[16:31]
v_exp_f32 v36,v36
v_exp_f32 v37,v37
v_exp_f32 v38,v38
v_exp_f32 v39,v39
v_cvt_pk_bf16_f32 v58,v36,v37
v_cvt_pk_bf16_f32 v59,v38,v39
v_mfma_f32_32x32x16_bf16 v[152:167],a[56:59],v[48:51],v[152:167]
v_exp_f32 v40,v40
v_exp_f32 v41,v41
v_exp_f32 v42,v42
v_exp_f32 v43,v43
v_cvt_pk_bf16_f32 v60,v40,v41
v_cvt_pk_bf16_f32 v61,v42,v43
v_mfma_f32_32x32x16_bf16 v[152:167],a[60:63],v[52:55],v[152:167]
v_exp_f32 v44,v44
v_exp_f32 v45,v45
v_exp_f32 v46,v46
v_exp_f32 v47,v47
v_cvt_pk_bf16_f32 v62,v44,v45
v_cvt_pk_bf16_f32 v63,v46,v47
s_sub_u32 s39,s39,1
s_cmp_lg_u32 s39,0
s_cbranch_scc1 att4_loop
v_mfma_f32_32x32x16_bf16 v[32:47],a[0:3],v[72:75],0
buffer_load_dwordx4 a[48:51],v2,s[8:11],s41 offen
v_exp_f32 v16,v16
v_exp_f32 v17,v17
v_exp_f32 v18,v18
v_exp_f32_e64 v19,v19
v_cvt_pk_bf16_f32 v48,v16,v17
v_cvt_pk_bf16_f32 v49,v18,v19
v_mfma_f32_32x32x16_bf16 v[32:47],a[4:7],v[76:79],v[32:47]
buffer_load_dword a52,v7,s[52:55],s41 offen offset:3072
v_exp_f32 v20,v20
v_exp_f32 v21,v21
v_exp_f32 v22,v22
v_exp_f32 v23,v23
v_cvt_pk_bf16_f32 v50,v20,v21
v_cvt_pk_bf16_f32 v51,v22,v23
v_mfma_f32_32x32x16_bf16 v[168:183],a[56:59],v[56:59],v[168:183]
v_exp_f32 v24,v24
v_exp_f32 v25,v25
v_exp_f32 v26,v26
v_exp_f32 v27,v27
v_cvt_pk_bf16_f32 v52,v24,v25
v_cvt_pk_bf16_f32 v53,v26,v27
v_mfma_f32_32x32x16_bf16 v[168:183],a[60:63],v[60:63],v[168:183]
buffer_load_dwordx4 a[56:59],v248,s[8:11],s41 offen offset:1024
v_exp_f32 v28,v28
v_exp_f32 v29,v29
v_exp_f32 v30,v30
v_exp_f32 v31,v31
v_cvt_pk_bf16_f32 v54,v28,v29
v_cvt_pk_bf16_f32 v55,v30,v31
v_mfma_f32_32x32x16_bf16 v[16:31],a[0:3],v[80:83],0
buffer_load_dwordx4 a[60:63],v248,s[8:11],s41 offen offset:2048
s_add_u32 s41,s41,4096
v_exp_f32 v32,v32
v_exp_f32 v33,v33
v_exp_f32 v34,v34
v_exp_f32 v35,v35
v_cvt_pk_bf16_f32 v56,v32,v33
v_cvt_pk_bf16_f32 v57,v34,v35
v_mfma_f32_32x32x16_bf16 v[16:31],a[4:7],v[84:87],v[16:31]
s_mov_b32 s43,s23
s_add_u32 s23,s23,32768
s_add_u32 m0,s43,0
s_add_u32 s22,s22,28672
buffer_load_dwordx4 v2,s[12:15],s22 offen offset:0 lds
v_exp_f32 v36,v36
v_exp_f32 v37,v37
v_exp_f32 v38,v38
v_exp_f32 v39,v39
v_cvt_pk_bf16_f32 v58,v36,v37
v_cvt_pk_bf16_f32 v59,v38,v39
v_mfma_f32_32x32x16_bf16 v[120:135],a[8:11],v[48:51],v[120:135]
v_exp_f32 v40,v40
v_exp_f32 v41,v41
v_exp_f32 v42,v42
v_exp_f32 v43,v43
v_cvt_pk_bf16_f32 v60,v40,v41
v_cvt_pk_bf16_f32 v61,v42,v43
v_mfma_f32_32x32x16_bf16 v[120:135],a[12:15],v[52:55],v[120:135]
buffer_load_dwordx4 v2,s[12:15],s22 offen offset:1024 lds
v_exp_f32 v44,v44
v_exp_f32 v45,v45
v_exp_f32 v46,v46
v_exp_f32 v47,v47
v_cvt_pk_bf16_f32 v62,v44,v45
v_cvt_pk_bf16_f32 v63,v46,v47
v_mfma_f32_32x32x16_bf16 v[32:47],a[0:3],v[88:91],0
v_exp_f32 v16,v16
v_exp_f32 v17,v17
v_exp_f32 v18,v18
v_exp_f32 v19,v19
v_cvt_pk_bf16_f32 v48,v16,v17
v_cvt_pk_bf16_f32 v49,v18,v19
v_mfma_f32_32x32x16_bf16 v[32:47],a[4:7],v[92:95],v[32:47]
buffer_load_dwordx4 v2,s[12:15],s22 offen offset:2048 lds
v_exp_f32 v20,v20
v_exp_f32 v21,v21
v_exp_f32 v22,v22
v_exp_f32 v23,v23
v_cvt_pk_bf16_f32 v50,v20,v21
v_cvt_pk_bf16_f32 v51,v22,v23
v_mfma_f32_32x32x16_bf16 v[136:151],a[8:11],v[56:59],v[136:151]
v_exp_f32 v24,v24
v_exp_f32 v25,v25
v_exp_f32 v26,v26
v_exp_f32 v27,v27
v_cvt_pk_bf16_f32 v52,v24,v25
v_cvt_pk_bf16_f32 v53,v26,v27
v_mfma_f32_32x32x16_bf16 v[136:151],a[12:15],v[60:63],v[136:151]
buffer_load_dwordx4 v2,s[12:15],s22 offen offset:3072 lds
v_exp_f32 v28,v28
v_exp_f32 v29,v29
v_exp_f32 v30,v30
v_exp_f32 v31,v31
v_cvt_pk_bf16_f32 v54,v28,v29
v_cvt_pk_bf16_f32 v55,v30,v31
s_waitcnt vmcnt(12)
v_mfma_f32_32x32x16_bf16 v[16:31],a[16:19],v[64:67],0
v_exp_f32 v32,v32
v_exp_f32 v33,v33
v_exp_f32 v34,v34
v_exp_f32_e64 v35,v35
v_cvt_pk_bf16_f32 v56,v32,v33
v_cvt_pk_bf16_f32 v57,v34,v35
v_mfma_f32_32x32x16_bf16 v[16:31],a[20:23],v[68:71],v[16:31]
s_add_u32 m0,s43,4096
s_add_u32 s22,s22,4096
buffer_load_dwordx4 v2,s[12:15],s22 offen offset:0 lds
v_exp_f32 v36,v36
v_exp_f32 v37,v37
v_exp_f32 v38,v38
v_exp_f32 v39,v39
v_cvt_pk_bf16_f32 v58,v36,v37
v_cvt_pk_bf16_f32 v59,v38,v39
v_mfma_f32_32x32x16_bf16 v[152:167],a[8:11],v[48:51],v[152:167]
v_exp_f32 v40,v40
v_exp_f32 v41,v41
v_exp_f32 v42,v42
v_exp_f32 v43,v43
v_cvt_pk_bf16_f32 v60,v40,v41
v_cvt_pk_bf16_f32 v61,v42,v43
v_mfma_f32_32x32x16_bf16 v[152:167],a[12:15],v[52:55],v[152:167]
buffer_load_dwordx4 v2,s[12:15],s22 offen offset:1024 lds
v_exp_f32 v44,v44
v_exp_f32 v45,v45
v_exp_f32 v46,v46
v_exp_f32 v47,v47
v_cvt_pk_bf16_f32 v62,v44,v45
v_cvt_pk_bf16_f32 v63,v46,v47
v_mfma_f32_32x32x16_bf16 v[32:47],a[16:19],v[72:75],0
v_exp_f32 v16,v16
v_exp_f32 v17,v17
v_exp_f32 v18,v18
v_exp_f32 v19,v19
v_cvt_pk_bf16_f32 v48,v16,v17
v_cvt_pk_bf16_f32 v49,v18,v19
v_mfma_f32_32x32x16_bf16 v[32:47],a[20:23],v[76:79],v[32:47]
buffer_load_dwordx4 v2,s[12:15],s22 offen offset:2048 lds
v_exp_f32 v20,v20
v_exp_f32 v21,v21
v_exp_f32 v22,v22
v_exp_f32 v23,v23
v_cvt_pk_bf16_f32 v50,v20,v21
v_cvt_pk_bf16_f32 v51,v22,v23
v_mfma_f32_32x32x16_bf16 v[168:183],a[8:11],v[56:59],v[168:183]
v_exp_f32 v24,v24
v_exp_f32 v25,v25
v_exp_f32 v26,v26
v_exp_f32 v27,v27
v_cvt_pk_bf16_f32 v52,v24,v25
v_cvt_pk_bf16_f32 v53,v26,v27
v_mfma_f32_32x32x16_bf16 v[168:183],a[12:15],v[60:63],v[168:183]
buffer_load_dwordx4 v2,s[12:15],s22 offen offset:3072 lds
v_exp_f32 v28,v28
v_exp_f32 v29,v29
v_exp_f32 v30,v30
v_exp_f32 v31,v31
v_cvt_pk_bf16_f32 v54,v28,v29
v_cvt_pk_bf16_f32 v55,v30,v31
v_mfma_f32_32x32x16_bf16 v[16:31],a[16:19],v[80:83],0
v_exp_f32 v32,v32
v_exp_f32 v33,v33
v_exp_f32 v34,v34
v_exp_f32 v35,v35
v_cvt_pk_bf16_f32 v56,v32,v33
v_cvt_pk_bf16_f32 v57,v34,v35
v_mfma_f32_32x32x16_bf16 v[16:31],a[20:23],v[84:87],v[16:31]
buffer_load_dwordx4 a[128:131],v2,s[8:11],s4 offen offset:0
v_exp_f32 v36,v36
v_exp_f32 v37,v37
v_exp_f32 v38,v38
v_exp_f32 v39,v39
v_cvt_pk_bf16_f32 v58,v36,v37
v_cvt_pk_bf16_f32 v59,v38,v39
v_mfma_f32_32x32x16_bf16 v[120:135],a[24:27],v[48:51],v[120:135]
v_exp_f32 v40,v40
v_exp_f32 v41,v41
v_exp_f32 v42,v42
v_exp_f32 v43,v43
v_cvt_pk_bf16_f32 v60,v40,v41
v_cvt_pk_bf16_f32 v61,v42,v43
v_mfma_f32_32x32x16_bf16 v[120:135],a[28:31],v[52:55],v[120:135]
buffer_load_dwordx4 a[132:135],v2,s[8:11],s4 offen offset:1024
v_exp_f32 v44,v44
v_exp_f32 v45,v45
v_exp_f32 v46,v46
v_exp_f32 v47,v47
v_cvt_pk_bf16_f32 v62,v44,v45
v_cvt_pk_bf16_f32 v63,v46,v47
v_mfma_f32_32x32x16_bf16 v[32:47],a[16:19],v[88:91],0
v_exp_f32 v16,v16
v_exp_f32 v17,v17
v_exp_f32 v18,v18
v_exp_f32 v19,v19
v_cvt_pk_bf16_f32 v48,v16,v17
v_cvt_pk_bf16_f32 v49,v18,v19
v_mfma_f32_32x32x16_bf16 v[32:47],a[20:23],v[92:95],v[32:47]
buffer_load_dwordx4 a[136:139],v2,s[8:11],s4 offen offset:2048
v_exp_f32 v20,v20
v_exp_f32 v21,v21
v_exp_f32 v22,v22
v_exp_f32 v23,v23
v_cvt_pk_bf16_f32 v50,v20,v21
v_cvt_pk_bf16_f32 v51,v22,v23
v_mfma_f32_32x32x16_bf16 v[136:151],a[24:27],v[56:59],v[136:151]
v_exp_f32 v24,v24
v_exp_f32 v25,v25
v_exp_f32 v26,v26
v_exp_f32 v27,v27
v_cvt_pk_bf16_f32 v52,v24,v25
v_cvt_pk_bf16_f32 v53,v26,v27
v_mfma_f32_32x32x16_bf16 v[136:151],a[28:31],v[60:63],v[136:151]
buffer_load_dwordx4 a[140:143],v2,s[8:11],s4 offen offset:3072
s_add_u32 s4,s4,4096
v_exp_f32 v28,v28
v_exp_f32 v29,v29
v_exp_f32 v30,v30
v_exp_f32 v31,v31
v_cvt_pk_bf16_f32 v54,v28,v29
v_cvt_pk_bf16_f32 v55,v30,v31
s_waitcnt vmcnt(16)
v_mfma_f32_32x32x16_bf16 v[16:31],a[32:35],v[64:67],0
v_exp_f32 v32,v32
v_exp_f32 v33,v33
v_exp_f32 v34,v34
v_exp_f32_e64 v35,v35
v_cvt_pk_bf16_f32 v56,v32,v33
v_cvt_pk_bf16_f32 v57,v34,v35
v_mfma_f32_32x32x16_bf16 v[16:31],a[36:39],v[68:71],v[16:31]
buffer_load_dwordx4 a[144:147],v2,s[8:11],s4 offen offset:0
v_exp_f32 v36,v36
v_exp_f32 v37,v37
v_exp_f32 v38,v38
v_exp_f32 v39,v39
v_cvt_pk_bf16_f32 v58,v36,v37
v_cvt_pk_bf16_f32 v59,v38,v39
v_mfma_f32_32x32x16_bf16 v[152:167],a[24:27],v[48:51],v[152:167]
v_exp_f32 v40,v40
v_exp_f32 v41,v41
v_exp_f32 v42,v42
v_exp_f32 v43,v43
v_cvt_pk_bf16_f32 v60,v40,v41
v_cvt_pk_bf16_f32 v61,v42,v43
v_mfma_f32_32x32x16_bf16 v[152:167],a[28:31],v[52:55],v[152:167]
buffer_load_dwordx4 a[148:151],v2,s[8:11],s4 offen offset:1024
v_exp_f32 v44,v44
v_exp_f32 v45,v45
v_exp_f32 v46,v46
v_exp_f32 v47,v47
v_cvt_pk_bf16_f32 v62,v44,v45
v_cvt_pk_bf16_f32 v63,v46,v47
v_mfma_f32_32x32x16_bf16 v[32:47],a[32:35],v[72:75],0
v_exp_f32 v16,v16
v_exp_f32 v17,v17
v_exp_f32 v18,v18
v_exp_f32 v19,v19
v_cvt_pk_bf16_f32 v48,v16,v17
v_cvt_pk_bf16_f32 v49,v18,v19
v_mfma_f32_32x32x16_bf16 v[32:47],a[36:39],v[76:79],v[32:47]
buffer_load_dwordx4 a[152:155],v2,s[8:11],s4 offen offset:2048
v_exp_f32 v20,v20
v_exp_f32 v21,v21
v_exp_f32 v22,v22
v_exp_f32 v23,v23
v_cvt_pk_bf16_f32 v50,v20,v21
v_cvt_pk_bf16_f32 v51,v22,v23
v_mfma_f32_32x32x16_bf16 v[168:183],a[24:27],v[56:59],v[168:183]
v_exp_f32 v24,v24
v_exp_f32 v25,v25
v_exp_f32 v26,v26
v_exp_f32 v27,v27
v_cvt_pk_bf16_f32 v52,v24,v25
v_cvt_pk_bf16_f32 v53,v26,v27
v_mfma_f32_32x32x16_bf16 v[168:183],a[28:31],v[60:63],v[168:183]
buffer_load_dwordx4 a[156:159],v2,s[8:11],s4 offen offset:3072
v_exp_f32 v28,v28
v_exp_f32 v29,v29
v_exp_f32 v30,v30
v_exp_f32 v31,v31
v_cvt_pk_bf16_f32 v54,v28,v29
v_cvt_pk_bf16_f32 v55,v30,v31
v_mfma_f32_32x32x16_bf16 v[16:31],a[32:35],v[80:83],0
v_exp_f32 v32,v32
v_exp_f32 v33,v33
v_exp_f32 v34,v34
v_exp_f32 v35,v35
v_cvt_pk_bf16_f32 v56,v32,v33
v_cvt_pk_bf16_f32 v57,v34,v35
v_mfma_f32_32x32x16_bf16 v[16:31],a[36:39],v[84:87],v[16:31]
buffer_load_dwordx4 a[160:163],v2,s[8:11],s5 offen offset:0
v_exp_f32 v36,v36
v_exp_f32 v37,v37
v_exp_f32 v38,v38
v_exp_f32 v39,v39
v_cvt_pk_bf16_f32 v58,v36,v37
v_cvt_pk_bf16_f32 v59,v38,v39
v_mfma_f32_32x32x16_bf16 v[120:135],a[40:43],v[48:51],v[120:135]
v_exp_f32 v40,v40
v_exp_f32 v41,v41
v_exp_f32 v42,v42
v_exp_f32 v43,v43
v_cvt_pk_bf16_f32 v60,v40,v41
v_cvt_pk_bf16_f32 v61,v42,v43
v_mfma_f32_32x32x16_bf16 v[120:135],a[44:47],v[52:55],v[120:135]
buffer_load_dwordx4 a[164:167],v2,s[8:11],s5 offen offset:1024
v_exp_f32 v44,v44
v_exp_f32 v45,v45
v_exp_f32 v46,v46
v_exp_f32 v47,v47
v_cvt_pk_bf16_f32 v62,v44,v45
v_cvt_pk_bf16_f32 v63,v46,v47
v_mfma_f32_32x32x16_bf16 v[32:47],a[32:35],v[88:91],0
v_exp_f32 v16,v16
v_exp_f32 v17,v17
v_exp_f32 v18,v18
v_exp_f32 v19,v19
v_cvt_pk_bf16_f32 v48,v16,v17
v_cvt_pk_bf16_f32 v49,v18,v19
v_mfma_f32_32x32x16_bf16 v[32:47],a[36:39],v[92:95],v[32:47]
buffer_load_dwordx4 a[168:171],v2,s[8:11],s5 offen offset:2048
v_exp_f32 v20,v20
v_exp_f32 v21,v21
v_exp_f32 v22,v22
v_exp_f32 v23,v23
v_cvt_pk_bf16_f32 v50,v20,v21
v_cvt_pk_bf16_f32 v51,v22,v23
v_mfma_f32_32x32x16_bf16 v[136:151],a[40:43],v[56:59],v[136:151]
v_exp_f32 v24,v24
v_exp_f32 v25,v25
v_exp_f32 v26,v26
v_exp_f32 v27,v27
v_cvt_pk_bf16_f32 v52,v24,v25
v_cvt_pk_bf16_f32 v53,v26,v27
v_mfma_f32_32x32x16_bf16 v[136:151],a[44:47],v[60:63],v[136:151]
buffer_load_dwordx4 a[172:175],v2,s[8:11],s5 offen offset:3072
s_add_u32 s5,s5,4096
v_exp_f32 v28,v28
v_exp_f32 v29,v29
v_exp_f32 v30,v30
v_exp_f32 v31,v31
v_cvt_pk_bf16_f32 v54,v28,v29
v_cvt_pk_bf16_f32 v55,v30,v31
s_waitcnt vmcnt(20)
v_mfma_f32_32x32x16_bf16 v[16:31],a[48:51],v[64:67],0
v_exp_f32 v32,v32
v_exp_f32 v33,v33
v_exp_f32 v34,v34
v_exp_f32_e64 v35,v35
v_cvt_pk_bf16_f32 v56,v32,v33
v_cvt_pk_bf16_f32 v57,v34,v35
v_mfma_f32_32x32x16_bf16 v[16:31],a[52:55],v[68:71],v[16:31]
buffer_load_dwordx4 a[176:179],v2,s[8:11],s5 offen offset:0
v_exp_f32 v36,v36
v_exp_f32 v37,v37
v_exp_f32 v38,v38
v_exp_f32 v39,v39
v_cvt_pk_bf16_f32 v58,v36,v37
v_cvt_pk_bf16_f32 v59,v38,v39
v_mfma_f32_32x32x16_bf16 v[152:167],a[40:43],v[48:51],v[152:167]
v_exp_f32 v40,v40
v_exp_f32 v41,v41
v_exp_f32 v42,v42
v_exp_f32 v43,v43
v_cvt_pk_bf16_f32 v60,v40,v41
v_cvt_pk_bf16_f32 v61,v42,v43
v_mfma_f32_32x32x16_bf16 v[152:167],a[44:47],v[52:55],v[152:167]
buffer_load_dwordx4 a[180:183],v2,s[8:11],s5 offen offset:1024
v_exp_f32 v44,v44
v_exp_f32 v45,v45
v_exp_f32 v46,v46
v_exp_f32 v47,v47
v_cvt_pk_bf16_f32 v62,v44,v45
v_cvt_pk_bf16_f32 v63,v46,v47
v_mfma_f32_32x32x16_bf16 v[32:47],a[48:51],v[72:75],0
v_exp_f32 v16,v16
v_exp_f32 v17,v17
v_exp_f32 v18,v18
v_exp_f32 v19,v19
v_cvt_pk_bf16_f32 v48,v16,v17
v_cvt_pk_bf16_f32 v49,v18,v19
v_mfma_f32_32x32x16_bf16 v[32:47],a[52:55],v[76:79],v[32:47]
buffer_load_dwordx4 a[184:187],v2,s[8:11],s5 offen offset:2048
v_exp_f32 v20,v20
v_exp_f32 v21,v21
v_exp_f32 v22,v22
v_exp_f32 v23,v23
v_cvt_pk_bf16_f32 v50,v20,v21
v_cvt_pk_bf16_f32 v51,v22,v23
v_mfma_f32_32x32x16_bf16 v[168:183],a[40:43],v[56:59],v[168:183]
v_exp_f32 v24,v24
v_exp_f32 v25,v25
v_exp_f32 v26,v26
v_exp_f32 v27,v27
v_cvt_pk_bf16_f32 v52,v24,v25
v_cvt_pk_bf16_f32 v53,v26,v27
v_mfma_f32_32x32x16_bf16 v[168:183],a[44:47],v[60:63],v[168:183]
buffer_load_dwordx4 a[188:191],v2,s[8:11],s5 offen offset:3072
v_exp_f32 v28,v28
v_exp_f32 v29,v29
v_exp_f32 v30,v30
v_exp_f32 v31,v31
v_cvt_pk_bf16_f32 v54,v28,v29
v_cvt_pk_bf16_f32 v55,v30,v31
v_mfma_f32_32x32x16_bf16 v[16:31],a[48:51],v[80:83],0
v_exp_f32 v32,v32
v_exp_f32 v33,v33
v_exp_f32 v34,v34
v_exp_f32 v35,v35
v_cvt_pk_bf16_f32 v56,v32,v33
v_cvt_pk_bf16_f32 v57,v34,v35
v_mfma_f32_32x32x16_bf16 v[16:31],a[52:55],v[84:87],v[16:31]
s_mov_b32 s43,s23
s_add_u32 s23,s23,32768
s_add_u32 m0,s43,0
s_add_u32 s22,s22,28672
buffer_load_dwordx4 v2,s[12:15],s22 offen offset:0 lds
v_exp_f32 v36,v36
v_exp_f32 v37,v37
v_exp_f32 v38,v38
v_exp_f32 v39,v39
v_cvt_pk_bf16_f32 v58,v36,v37
v_cvt_pk_bf16_f32 v59,v38,v39
v_mfma_f32_32x32x16_bf16 v[120:135],a[56:59],v[48:51],v[120:135]
v_exp_f32 v40,v40
v_exp_f32 v41,v41
v_exp_f32 v42,v42
v_exp_f32 v43,v43
v_cvt_pk_bf16_f32 v60,v40,v41
v_cvt_pk_bf16_f32 v61,v42,v43
v_mfma_f32_32x32x16_bf16 v[120:135],a[60:63],v[52:55],v[120:135]
buffer_load_dwordx4 v2,s[12:15],s22 offen offset:1024 lds
v_exp_f32 v44,v44
v_exp_f32 v45,v45
v_exp_f32 v46,v46
v_exp_f32 v47,v47
v_cvt_pk_bf16_f32 v62,v44,v45
v_cvt_pk_bf16_f32 v63,v46,v47
v_mfma_f32_32x32x16_bf16 v[32:47],a[48:51],v[88:91],0
v_exp_f32 v16,v16
v_exp_f32 v17,v17
v_exp_f32 v18,v18
v_exp_f32 v19,v19
v_cvt_pk_bf16_f32 v48,v16,v17
v_cvt_pk_bf16_f32 v49,v18,v19
v_mfma_f32_32x32x16_bf16 v[32:47],a[52:55],v[92:95],v[32:47]
buffer_load_dwordx4 v2,s[12:15],s22 offen offset:2048 lds
v_exp_f32 v20,v20
v_exp_f32 v21,v21
v_exp_f32 v22,v22
v_exp_f32 v23,v23
v_cvt_pk_bf16_f32 v50,v20,v21
v_cvt_pk_bf16_f32 v51,v22,v23
v_mfma_f32_32x32x16_bf16 v[136:151],a[56:59],v[56:59],v[136:151]
v_exp_f32 v24,v24
v_exp_f32 v25,v25
v_exp_f32 v26,v26
v_exp_f32 v27,v27
v_cvt_pk_bf16_f32 v52,v24,v25
v_cvt_pk_bf16_f32 v53,v26,v27
v_mfma_f32_32x32x16_bf16 v[136:151],a[60:63],v[60:63],v[136:151]
buffer_load_dwordx4 v2,s[12:15],s22 offen offset:3072 lds
v_exp_f32 v28,v28
v_exp_f32 v29,v29
v_exp_f32 v30,v30
v_exp_f32 v31,v31
v_cvt_pk_bf16_f32 v54,v28,v29
v_cvt_pk_bf16_f32 v55,v30,v31
s_add_u32 m0,s43,4096
s_add_u32 s22,s22,4096
buffer_load_dwordx4 v2,s[12:15],s22 offen offset:0 lds
v_exp_f32 v32,v32
v_exp_f32 v33,v33
v_exp_f32 v34,v34
v_exp_f32 v35,v35
v_cvt_pk_bf16_f32 v56,v32,v33
v_cvt_pk_bf16_f32 v57,v34,v35
buffer_load_dwordx4 v2,s[12:15],s22 offen offset:1024 lds
v_exp_f32 v36,v36
v_exp_f32 v37,v37
v_exp_f32 v38,v38
v_exp_f32 v39,v39
v_cvt_pk_bf16_f32 v58,v36,v37
v_cvt_pk_bf16_f32 v59,v38,v39
v_mfma_f32_32x32x16_bf16 v[152:167],a[56:59],v[48:51],v[152:167]
buffer_load_dwordx4 v2,s[12:15],s22 offen offset:2048 lds
v_exp_f32 v40,v40
v_exp_f32 v41,v41
v_exp_f32 v42,v42
v_exp_f32 v43,v43
v_cvt_pk_bf16_f32 v60,v40,v41
v_cvt_pk_bf16_f32 v61,v42,v43
v_mfma_f32_32x32x16_bf16 v[152:167],a[60:63],v[52:55],v[152:167]
buffer_load_dwordx4 v2,s[12:15],s22 offen offset:3072 lds
v_exp_f32 v44,v44
v_exp_f32 v45,v45
v_exp_f32 v46,v46
v_exp_f32 v47,v47
v_cvt_pk_bf16_f32 v62,v44,v45
v_cvt_pk_bf16_f32 v63,v46,v47
s_nop 1
v_mfma_f32_32x32x16_bf16 v[168:183],a[56:59],v[56:59],v[168:183]
s_nop 0
v_mfma_f32_32x32x16_bf16 v[168:183],a[60:63],v[60:63],v[168:183]
s_mul_i32 s24,s37,36864
s_add_u32 s24,s24,79691776
s_lshl_b32 s25,s16,10
s_add_u32 s40,s25,s24
s_lshr_b32 s26,s16,3
s_lshl_b32 s26,s26,10
s_add_u32 s24,s24,s26
s_bfe_u32 s26,s16,0x10002
s_lshl_b32 s26,s26,9
s_add_u32 s24,s24,s26
s_and_b32 s26,s16,3
s_lshl_b32 s26,s26,2
s_add_u32 s24,s24,s26
s_add_u32 s38,s24,32768
v_mov_b32 v14,0x80000000
v_cndmask_b32 v14,v2,v14,s[96:97]
s_cmp_eq_u32 s57,0
s_cbranch_scc1 att4_fin
s_mul_i32 s24,s18,24576
s_add_u32 s24,s24,65536
v_add_u32_e64 v12,s24,v2
ds_write_b128 v12,v[120:123] offset:0
ds_write_b128 v12,v[124:127] offset:1024
ds_write_b128 v12,v[128:131] offset:2048
ds_write_b128 v12,v[136:139] offset:3072
ds_write_b128 v12,v[140:143] offset:4096
ds_write_b128 v12,v[144:147] offset:5120
ds_write_b128 v12,v[152:155] offset:6144
ds_write_b128 v12,v[156:159] offset:7168
ds_write_b128 v12,v[160:163] offset:8192
ds_write_b128 v12,v[168:171] offset:9216
ds_write_b128 v12,v[172:175] offset:10240
ds_write_b128 v12,v[176:179] offset:11264
s_waitcnt lgkmcnt(0)
s_barrier
s_xor_b32 s24,s18,1
s_mul_i32 s24,s24,24576
s_add_u32 s24,s24,65536
v_add_u32_e64 v60,s24,v2
s_xor_b32 s24,s18,2
s_mul_i32 s24,s24,24576
s_add_u32 s24,s24,65536
v_add_u32 v61,s24,v2
s_xor_b32 s24,s18,3
s_mul_i32 s24,s24,24576
s_add_u32 s24,s24,65536
v_add_u32_e64 v62,s24,v2
att4_fin:
s_nop 7
s_lshl_b32 s24,1,s57
s_sub_u32 s24,s24,1
s_and_b32 s24,s24,0
s_cmp_lg_u32 s24,s58
s_cbranch_scc1 att4_skip0
s_cmp_eq_u32 s57,0
s_cbranch_scc1 att4_c0
ds_read_b128 v[16:19],v60 offset:0
ds_read_b128 v[20:23],v60 offset:1024
ds_read_b128 v[24:27],v60 offset:2048
s_cmp_eq_u32 s57,1
s_cbranch_scc1 att4_d0
ds_read_b128 v[28:31],v61 offset:0
ds_read_b128 v[32:35],v61 offset:1024
ds_read_b128 v[36:39],v61 offset:2048
ds_read_b128 v[40:43],v62 offset:0
ds_read_b128 v[44:47],v62 offset:1024
ds_read_b128 v[48:51],v62 offset:2048
s_waitcnt lgkmcnt(0)
v_add_f32 v28,v28,v40
v_add_f32 v29,v29,v41
v_add_f32 v30,v30,v42
v_add_f32 v31,v31,v43
v_add_f32 v32,v32,v44
v_add_f32 v33,v33,v45
v_add_f32 v34,v34,v46
v_add_f32 v35,v35,v47
v_add_f32 v36,v36,v48
v_add_f32 v37,v37,v49
v_add_f32 v38,v38,v50
v_add_f32 v120,v120,v28
v_add_f32 v121,v121,v29
v_add_f32 v122,v122,v30
v_add_f32 v123,v123,v31
v_add_f32 v124,v124,v32
v_add_f32 v125,v125,v33
v_add_f32 v126,v126,v34
v_add_f32 v127,v127,v35
v_add_f32 v128,v128,v36
v_add_f32 v129,v129,v37
v_add_f32 v130,v130,v38
att4_d0:
s_waitcnt lgkmcnt(0)
v_add_f32 v120,v120,v16
v_add_f32 v121,v121,v17
v_add_f32 v122,v122,v18
v_add_f32 v123,v123,v19
v_add_f32 v124,v124,v20
v_add_f32 v125,v125,v21
v_add_f32 v126,v126,v22
v_add_f32 v127,v127,v23
v_add_f32 v128,v128,v24
v_add_f32 v129,v129,v25
v_add_f32 v130,v130,v26
att4_c0:
s_mov_b64 vcc,exec
v_cmp_le_f32 s[24:25],s44,v130
v_cmp_ge_f32 s[26:27],s45,v130
s_and_b64 vcc,vcc,s[24:25]
s_and_b64 vcc,vcc,s[26:27]
s_cmp_eq_u64 vcc,exec
s_cbranch_scc0 att4_fb0
att4_ok0:
v_rcp_f32 v130,v130
s_nop 0
v_mul_f32 v120,v130,v120
v_mul_f32 v121,v130,v121
v_mul_f32 v122,v130,v122
v_mul_f32 v123,v130,v123
v_mul_f32 v124,v130,v124
v_mul_f32 v125,v130,v125
v_mul_f32 v126,v130,v126
v_mul_f32 v127,v130,v127
v_mul_f32 v128,v130,v128
v_mul_f32 v129,v130,v129
v_cvt_pk_bf16_f32 v132,v120,v121
v_cvt_pk_bf16_f32 v133,v122,v123
v_cvt_pk_bf16_f32 v134,v124,v125
v_cvt_pk_bf16_f32 v135,v126,v127
v_cvt_pk_bf16_f32 v131,v128,v129
buffer_store_dwordx4 v[132:135],v2,s[8:11],s40 offen
buffer_store_dword v131,v14,s[8:11],s38 offen
att4_skip0:
s_add_u32 s40,s40,36864
s_add_u32 s38,s38,36864
s_lshl_b32 s24,1,s57
s_sub_u32 s24,s24,1
s_and_b32 s24,s24,1
s_cmp_lg_u32 s24,s58
s_cbranch_scc1 att4_skip1
s_cmp_eq_u32 s57,0
s_cbranch_scc1 att4_c1
ds_read_b128 v[16:19],v60 offset:3072
ds_read_b128 v[20:23],v60 offset:4096
ds_read_b128 v[24:27],v60 offset:5120
s_cmp_eq_u32 s57,1
s_cbranch_scc1 att4_d1
ds_read_b128 v[28:31],v61 offset:3072
ds_read_b128 v[32:35],v61 offset:4096
ds_read_b128 v[36:39],v61 offset:5120
ds_read_b128 v[40:43],v62 offset:3072
ds_read_b128 v[44:47],v62 offset:4096
ds_read_b128 v[48:51],v62 offset:5120
s_waitcnt lgkmcnt(0)
v_add_f32 v28,v28,v40
v_add_f32 v29,v29,v41
v_add_f32 v30,v30,v42
v_add_f32 v31,v31,v43
v_add_f32 v32,v32,v44
v_add_f32 v33,v33,v45
v_add_f32 v34,v34,v46
v_add_f32 v35,v35,v47
v_add_f32 v36,v36,v48
v_add_f32 v37,v37,v49
v_add_f32 v38,v38,v50
v_add_f32 v136,v136,v28
v_add_f32 v137,v137,v29
v_add_f32 v138,v138,v30
v_add_f32 v139,v139,v31
v_add_f32 v140,v140,v32
v_add_f32 v141,v141,v33
v_add_f32 v142,v142,v34
v_add_f32 v143,v143,v35
v_add_f32 v144,v144,v36
v_add_f32 v145,v145,v37
v_add_f32 v146,v146,v38
att4_d1:
s_waitcnt lgkmcnt(0)
v_add_f32 v136,v136,v16
v_add_f32 v137,v137,v17
v_add_f32 v138,v138,v18
v_add_f32 v139,v139,v19
v_add_f32 v140,v140,v20
v_add_f32 v141,v141,v21
v_add_f32 v142,v142,v22
v_add_f32 v143,v143,v23
v_add_f32 v144,v144,v24
v_add_f32 v145,v145,v25
v_add_f32_e64 v146,v146,v26
att4_c1:
s_mov_b64 vcc,exec
v_cmp_le_f32 s[24:25],s44,v146
v_cmp_ge_f32 s[26:27],s45,v146
s_and_b64 vcc,vcc,s[24:25]
s_and_b64 vcc,vcc,s[26:27]
s_cmp_eq_u64 vcc,exec
s_cbranch_scc0 att4_fb1
att4_ok1:
v_rcp_f32 v146,v146
s_nop 0
v_mul_f32 v136,v146,v136
v_mul_f32 v137,v146,v137
v_mul_f32 v138,v146,v138
v_mul_f32 v139,v146,v139
v_mul_f32 v140,v146,v140
v_mul_f32 v141,v146,v141
v_mul_f32 v142,v146,v142
v_mul_f32 v143,v146,v143
v_mul_f32 v144,v146,v144
v_mul_f32 v145,v146,v145
v_cvt_pk_bf16_f32 v148,v136,v137
v_cvt_pk_bf16_f32 v149,v138,v139
v_cvt_pk_bf16_f32 v150,v140,v141
v_cvt_pk_bf16_f32 v151,v142,v143
v_cvt_pk_bf16_f32 v147,v144,v145
buffer_store_dwordx4 v[148:151],v2,s[8:11],s40 offen
buffer_store_dword v147,v14,s[8:11],s38 offen
att4_skip1:
s_add_u32 s40,s40,36864
s_add_u32 s38,s38,36864
s_lshl_b32 s24,1,s57
s_sub_u32 s24,s24,1
s_and_b32 s24,s24,2
s_cmp_lg_u32 s24,s58
s_cbranch_scc1 att4_skip2
s_cmp_eq_u32 s57,0
s_cbranch_scc1 att4_c2
ds_read_b128 v[16:19],v60 offset:6144
ds_read_b128 v[20:23],v60 offset:7168
ds_read_b128 v[24:27],v60 offset:8192
s_cmp_eq_u32 s57,1
s_cbranch_scc1 att4_d2
ds_read_b128 v[28:31],v61 offset:6144
ds_read_b128 v[32:35],v61 offset:7168
ds_read_b128 v[36:39],v61 offset:8192
ds_read_b128 v[40:43],v62 offset:6144
ds_read_b128 v[44:47],v62 offset:7168
ds_read_b128 v[48:51],v62 offset:8192
s_waitcnt lgkmcnt(0)
v_add_f32 v28,v28,v40
v_add_f32 v29,v29,v41
v_add_f32 v30,v30,v42
v_add_f32 v31,v31,v43
v_add_f32 v32,v32,v44
v_add_f32 v33,v33,v45
v_add_f32 v34,v34,v46
v_add_f32 v35,v35,v47
v_add_f32 v36,v36,v48
v_add_f32 v37,v37,v49
v_add_f32 v38,v38,v50
v_add_f32 v152,v152,v28
v_add_f32 v153,v153,v29
v_add_f32 v154,v154,v30
v_add_f32 v155,v155,v31
v_add_f32 v156,v156,v32
v_add_f32 v157,v157,v33
v_add_f32 v158,v158,v34
v_add_f32 v159,v159,v35
v_add_f32 v160,v160,v36
v_add_f32 v161,v161,v37
v_add_f32 v162,v162,v38
att4_d2:
s_waitcnt lgkmcnt(0)
v_add_f32 v152,v152,v16
v_add_f32 v153,v153,v17
v_add_f32 v154,v154,v18
v_add_f32 v155,v155,v19
v_add_f32 v156,v156,v20
v_add_f32 v157,v157,v21
v_add_f32 v158,v158,v22
v_add_f32 v159,v159,v23
v_add_f32 v160,v160,v24
v_add_f32 v161,v161,v25
v_add_f32_e64 v162,v162,v26
att4_c2:
s_mov_b64 vcc,exec
v_cmp_le_f32 s[24:25],s44,v162
v_cmp_ge_f32 s[26:27],s45,v162
s_and_b64 vcc,vcc,s[24:25]
s_and_b64 vcc,vcc,s[26:27]
s_cmp_eq_u64 vcc,exec
s_cbranch_scc0 att4_fb2
att4_ok2:
v_rcp_f32 v162,v162
s_nop 0
v_mul_f32 v152,v162,v152
v_mul_f32 v153,v162,v153
v_mul_f32 v154,v162,v154
v_mul_f32 v155,v162,v155
v_mul_f32 v156,v162,v156
v_mul_f32 v157,v162,v157
v_mul_f32 v158,v162,v158
v_mul_f32 v159,v162,v159
v_mul_f32 v160,v162,v160
v_mul_f32 v161,v162,v161
v_cvt_pk_bf16_f32 v164,v152,v153
v_cvt_pk_bf16_f32 v165,v154,v155
v_cvt_pk_bf16_f32 v166,v156,v157
v_cvt_pk_bf16_f32 v167,v158,v159
v_cvt_pk_bf16_f32 v163,v160,v161
buffer_store_dwordx4 v[164:167],v2,s[8:11],s40 offen
buffer_store_dword v163,v14,s[8:11],s38 offen
att4_skip2:
s_add_u32 s40,s40,36864
s_add_u32 s38,s38,36864
s_lshl_b32 s24,1,s57
s_sub_u32 s24,s24,1
s_and_b32 s24,s24,3
s_cmp_lg_u32 s24,s58
s_cbranch_scc1 att4_skip3
s_cmp_eq_u32 s57,0
s_cbranch_scc1 att4_c3
ds_read_b128 v[16:19],v60 offset:9216
ds_read_b128 v[20:23],v60 offset:10240
ds_read_b128 v[24:27],v60 offset:11264
s_cmp_eq_u32 s57,1
s_cbranch_scc1 att4_d3
ds_read_b128 v[28:31],v61 offset:9216
ds_read_b128 v[32:35],v61 offset:10240
ds_read_b128 v[36:39],v61 offset:11264
ds_read_b128 v[40:43],v62 offset:9216
ds_read_b128 v[44:47],v62 offset:10240
ds_read_b128 v[48:51],v62 offset:11264
s_waitcnt lgkmcnt(0)
v_add_f32 v28,v28,v40
v_add_f32 v29,v29,v41
v_add_f32 v30,v30,v42
v_add_f32 v31,v31,v43
v_add_f32 v32,v32,v44
v_add_f32 v33,v33,v45
v_add_f32 v34,v34,v46
v_add_f32 v35,v35,v47
v_add_f32 v36,v36,v48
v_add_f32 v37,v37,v49
v_add_f32 v38,v38,v50
v_add_f32 v168,v168,v28
v_add_f32 v169,v169,v29
v_add_f32 v170,v170,v30
v_add_f32 v171,v171,v31
v_add_f32 v172,v172,v32
v_add_f32 v173,v173,v33
v_add_f32 v174,v174,v34
v_add_f32 v175,v175,v35
v_add_f32 v176,v176,v36
v_add_f32 v177,v177,v37
v_add_f32 v178,v178,v38
att4_d3:
s_waitcnt lgkmcnt(0)
v_add_f32 v168,v168,v16
v_add_f32 v169,v169,v17
v_add_f32 v170,v170,v18
v_add_f32 v171,v171,v19
v_add_f32 v172,v172,v20
v_add_f32 v173,v173,v21
v_add_f32 v174,v174,v22
v_add_f32 v175,v175,v23
v_add_f32 v176,v176,v24
v_add_f32 v177,v177,v25
v_add_f32_e64 v178,v178,v26
att4_c3:
s_mov_b64 vcc,exec
v_cmp_le_f32 s[24:25],s44,v178
v_cmp_ge_f32 s[26:27],s45,v178
s_and_b64 vcc,vcc,s[24:25]
s_and_b64 vcc,vcc,s[26:27]
s_cmp_eq_u64 vcc,exec
s_cbranch_scc0 att4_fb3
att4_ok3:
v_rcp_f32 v178,v178
s_nop 0
v_mul_f32 v168,v178,v168
v_mul_f32 v169,v178,v169
v_mul_f32 v170,v178,v170
v_mul_f32 v171,v178,v171
v_mul_f32 v172,v178,v172
v_mul_f32 v173,v178,v173
v_mul_f32 v174,v178,v174
v_mul_f32 v175,v178,v175
v_mul_f32 v176,v178,v176
v_mul_f32 v177,v178,v177
v_cvt_pk_bf16_f32 v180,v168,v169
v_cvt_pk_bf16_f32 v181,v170,v171
v_cvt_pk_bf16_f32 v182,v172,v173
v_cvt_pk_bf16_f32 v183,v174,v175
v_cvt_pk_bf16_f32 v179,v176,v177
buffer_store_dwordx4 v[180:183],v2,s[8:11],s40 offen
buffer_store_dword v179,v14,s[8:11],s38 offen
att4_skip3:
s_add_u32 s40,s40,36864
s_add_u32 s38,s38,36864
s_cmp_eq_u32 s57,0
s_cbranch_scc1 k2_B
s_barrier
s_branch k2_B
att5:
v_accvgpr_write_b32 a5,v13
v_accvgpr_write_b32 a6,0
v_accvgpr_write_b32 a7,0
v_accvgpr_write_b32 a21,v13
v_accvgpr_write_b32 a22,0
v_accvgpr_write_b32 a23,0
v_accvgpr_write_b32 a37,v13
v_accvgpr_write_b32 a38,0
v_accvgpr_write_b32 a39,0
v_accvgpr_write_b32 a53,v13
v_accvgpr_write_b32 a54,0
v_accvgpr_write_b32 a55,0
v_mov_b32 v69,0
v_mov_b32 v70,0
v_mov_b32 v71,0
v_mov_b32 v77,0
v_mov_b32 v78,0
v_mov_b32 v79,0
v_mov_b32 v85,0
v_mov_b32 v86,0
v_mov_b32 v87,0
v_mov_b32 v93,0
v_mov_b32 v94,0
v_mov_b32 v95,0
v_mov_b32 v101,0
v_mov_b32 v102,0
v_mov_b32 v103,0
v_mov_b32 v48,0
v_mov_b32 v49,0
v_mov_b32 v50,0
v_mov_b32 v51,0
v_mov_b32 v52,0
v_mov_b32 v53,0
v_mov_b32 v54,0
v_mov_b32 v55,0
v_mov_b32 v56,0
v_mov_b32 v57,0
v_mov_b32 v58,0
v_mov_b32 v59,0
v_mov_b32 v60,0
v_mov_b32 v61,0
v_mov_b32 v62,0
v_mov_b32 v63,0
s_nop 1
v_mfma_f32_32x32x16_bf16 v[120:135],v[48:51],v[48:51],0
v_mfma_f32_32x32x16_bf16 v[136:151],v[48:51],v[48:51],0
v_mfma_f32_32x32x16_bf16 v[152:167],v[48:51],v[48:51],0
v_mfma_f32_32x32x16_bf16 v[168:183],v[48:51],v[48:51],0
v_mfma_f32_32x32x16_bf16 v[184:199],v[48:51],v[48:51],0
v_accvgpr_write_b32 a56,0
v_accvgpr_write_b32 a57,0
v_accvgpr_write_b32 a58,0
v_accvgpr_write_b32 a59,0
v_accvgpr_write_b32 a60,0
v_accvgpr_write_b32 a61,0
v_accvgpr_write_b32 a62,0
v_accvgpr_write_b32 a63,0
s_waitcnt vmcnt(17)
v_cndmask_b32 v68,v68,0,s[96:97]
v_cndmask_b32 v76,v76,0,s[96:97]
v_cndmask_b32 v84,v84,0,s[96:97]
v_cndmask_b32 v92,v92,0,s[96:97]
v_cndmask_b32 v100,v100,0,s[96:97]
s_nop 0
v_mfma_f32_32x32x16_bf16 v[16:31],a[48:51],v[64:67],0
v_mfma_f32_32x32x16_bf16 v[16:31],a[52:55],v[68:71],v[16:31]
v_mfma_f32_32x32x16_bf16 v[32:47],a[48:51],v[72:75],0
v_mfma_f32_32x32x16_bf16 v[32:47],a[52:55],v[76:79],v[32:47]
s_nop 9
v_max_f32 v10,v16,v17
v_max3_f32 v10,v10,v18,v19
v_max3_f32 v10,v10,v20,v21
v_max3_f32 v10,v10,v22,v23
v_max3_f32 v10,v10,v24,v25
v_max3_f32 v10,v10,v26,v27
v_max3_f32 v10,v10,v28,v29
v_max3_f32 v10,v10,v30,v31
v_mov_b32 v12,v10
s_nop 1
v_permlane32_swap_b32 v10,v12
v_max_f32 v10,v10,v12
v_sub_f32_e64 v10,0,v10
v_cvt_pk_bf16_f32 v10,v10,0
v_cndmask_b32 v69,v10,0,s[96:97]
v_mfma_f32_32x32x16_bf16 v[16:31],a[48:51],v[80:83],0
v_mfma_f32_32x32x16_bf16 v[16:31],a[52:55],v[84:87],v[16:31]
v_max_f32_e64 v10,v32,v33
v_max3_f32 v10,v10,v34,v35
v_max3_f32 v10,v10,v36,v37
v_max3_f32 v10,v10,v38,v39
v_max3_f32 v10,v10,v40,v41
v_max3_f32 v10,v10,v42,v43
v_max3_f32 v10,v10,v44,v45
v_max3_f32 v10,v10,v46,v47
v_mov_b32 v12,v10
s_nop 1
v_permlane32_swap_b32 v10,v12
v_max_f32 v10,v10,v12
v_sub_f32_e64 v10,0,v10
v_cvt_pk_bf16_f32 v10,v10,0
v_cndmask_b32 v77,v10,0,s[96:97]
v_mfma_f32_32x32x16_bf16 v[32:47],a[48:51],v[88:91],0
v_mfma_f32_32x32x16_bf16 v[32:47],a[52:55],v[92:95],v[32:47]
v_max_f32_e64 v10,v16,v17
v_max3_f32 v10,v10,v18,v19
v_max3_f32 v10,v10,v20,v21
v_max3_f32 v10,v10,v22,v23
v_max3_f32 v10,v10,v24,v25
v_max3_f32 v10,v10,v26,v27
v_max3_f32 v10,v10,v28,v29
v_max3_f32 v10,v10,v30,v31
v_mov_b32 v12,v10
s_nop 1
v_permlane32_swap_b32 v10,v12
v_max_f32 v10,v10,v12
v_sub_f32_e64 v10,0,v10
v_cvt_pk_bf16_f32 v10,v10,0
v_cndmask_b32 v85,v10,0,s[96:97]
v_mfma_f32_32x32x16_bf16 v[16:31],a[48:51],v[96:99],0
v_mfma_f32_32x32x16_bf16 v[16:31],a[52:55],v[100:103],v[16:31]
v_max_f32_e64 v10,v32,v33
v_max3_f32 v10,v10,v34,v35
v_max3_f32 v10,v10,v36,v37
v_max3_f32 v10,v10,v38,v39
v_max3_f32 v10,v10,v40,v41
v_max3_f32 v10,v10,v42,v43
v_max3_f32 v10,v10,v44,v45
v_max3_f32 v10,v10,v46,v47
v_mov_b32 v12,v10
s_nop 1
v_permlane32_swap_b32 v10,v12
v_max_f32 v10,v10,v12
v_sub_f32_e64 v10,0,v10
v_cvt_pk_bf16_f32 v10,v10,0
v_cndmask_b32 v93,v10,0,s[96:97]
v_max_f32_e64 v10,v16,v17
v_max3_f32 v10,v10,v18,v19
v_max3_f32 v10,v10,v20,v21
v_max3_f32 v10,v10,v22,v23
v_max3_f32 v10,v10,v24,v25
v_max3_f32 v10,v10,v26,v27
v_max3_f32 v10,v10,v28,v29
v_max3_f32 v10,v10,v30,v31
v_mov_b32 v12,v10
s_nop 1
v_permlane32_swap_b32 v10,v12
v_max_f32 v10,v10,v12
v_sub_f32_e64 v10,0,v10
v_cvt_pk_bf16_f32 v10,v10,0
v_cndmask_b32 v101,v10,0,s[96:97]
s_mov_b32 s39,s60
s_waitcnt vmcnt(13)
v_mfma_f32_32x32x16_bf16 v[16:31],a[0:3],v[64:67],0
v_mfma_f32_32x32x16_bf16 v[16:31],a[4:7],v[68:71],v[16:31]
s_nop 9
s_sub_u32 s39,s39,1
att5_loop:
v_mfma_f32_32x32x16_bf16 v[32:47],a[0:3],v[72:75],0
buffer_load_dwordx4 a[48:51],v2,s[8:11],s41 offen
v_exp_f32 v16,v16
v_exp_f32 v17,v17
v_exp_f32 v18,v18
v_exp_f32 v19,v19
v_cvt_pk_bf16_f32 v48,v16,v17
v_cvt_pk_bf16_f32 v49,v18,v19
v_mfma_f32_32x32x16_bf16 v[32:47],a[4:7],v[76:79],v[32:47]
buffer_load_dword a52,v7,s[52:55],s41 offen offset:3072
v_exp_f32 v20,v20
v_exp_f32 v21,v21
v_exp_f32 v22,v22
v_exp_f32 v23,v23
v_cvt_pk_bf16_f32 v50,v20,v21
v_cvt_pk_bf16_f32 v51,v22,v23
v_mfma_f32_32x32x16_bf16 v[184:199],a[56:59],v[56:59],v[184:199]
v_exp_f32 v24,v24
v_exp_f32 v25,v25
v_exp_f32 v26,v26
v_exp_f32 v27,v27
v_cvt_pk_bf16_f32 v52,v24,v25
v_cvt_pk_bf16_f32 v53,v26,v27
v_mfma_f32_32x32x16_bf16 v[184:199],a[60:63],v[60:63],v[184:199]
buffer_load_dwordx4 a[56:59],v248,s[8:11],s41 offen offset:1024
v_exp_f32 v28,v28
v_exp_f32 v29,v29
v_exp_f32 v30,v30
v_exp_f32 v31,v31
v_cvt_pk_bf16_f32 v54,v28,v29
v_cvt_pk_bf16_f32 v55,v30,v31
v_mfma_f32_32x32x16_bf16 v[16:31],a[0:3],v[80:83],0
buffer_load_dwordx4 a[60:63],v248,s[8:11],s41 offen offset:2048
s_add_u32 s41,s41,4096
v_exp_f32 v32,v32
v_exp_f32 v33,v33
v_exp_f32 v34,v34
v_exp_f32 v35,v35
v_cvt_pk_bf16_f32 v56,v32,v33
v_cvt_pk_bf16_f32 v57,v34,v35
v_mfma_f32_32x32x16_bf16 v[16:31],a[4:7],v[84:87],v[16:31]
v_exp_f32 v36,v36
v_exp_f32 v37,v37
v_exp_f32 v38,v38
v_exp_f32 v39,v39
v_cvt_pk_bf16_f32 v58,v36,v37
v_cvt_pk_bf16_f32 v59,v38,v39
v_mfma_f32_32x32x16_bf16 v[120:135],a[8:11],v[48:51],v[120:135]
v_exp_f32 v40,v40
v_exp_f32 v41,v41
v_exp_f32 v42,v42
v_exp_f32 v43,v43
v_cvt_pk_bf16_f32 v60,v40,v41
v_cvt_pk_bf16_f32 v61,v42,v43
v_mfma_f32_32x32x16_bf16 v[120:135],a[12:15],v[52:55],v[120:135]
v_exp_f32 v44,v44
v_exp_f32 v45,v45
v_exp_f32 v46,v46
v_exp_f32 v47,v47
v_cvt_pk_bf16_f32 v62,v44,v45
v_cvt_pk_bf16_f32 v63,v46,v47
v_mfma_f32_32x32x16_bf16 v[32:47],a[0:3],v[88:91],0
v_exp_f32 v16,v16
v_exp_f32 v17,v17
v_exp_f32 v18,v18
v_exp_f32 v19,v19
v_cvt_pk_bf16_f32 v48,v16,v17
v_cvt_pk_bf16_f32 v49,v18,v19
v_mfma_f32_32x32x16_bf16 v[32:47],a[4:7],v[92:95],v[32:47]
v_exp_f32 v20,v20
v_exp_f32 v21,v21
v_exp_f32 v22,v22
v_exp_f32 v23,v23
v_cvt_pk_bf16_f32 v50,v20,v21
v_cvt_pk_bf16_f32 v51,v22,v23
v_mfma_f32_32x32x16_bf16 v[136:151],a[8:11],v[56:59],v[136:151]
v_exp_f32 v24,v24
v_exp_f32 v25,v25
v_exp_f32 v26,v26
v_exp_f32 v27,v27
v_cvt_pk_bf16_f32 v52,v24,v25
v_cvt_pk_bf16_f32 v53,v26,v27
v_mfma_f32_32x32x16_bf16 v[136:151],a[12:15],v[60:63],v[136:151]
v_exp_f32 v28,v28
v_exp_f32 v29,v29
v_exp_f32 v30,v30
v_exp_f32 v31,v31
v_cvt_pk_bf16_f32 v54,v28,v29
v_cvt_pk_bf16_f32 v55,v30,v31
v_mfma_f32_32x32x16_bf16 v[16:31],a[0:3],v[96:99],0
v_exp_f32 v32,v32
v_exp_f32 v33,v33
v_exp_f32 v34,v34
v_exp_f32 v35,v35
v_cvt_pk_bf16_f32 v56,v32,v33
v_cvt_pk_bf16_f32 v57,v34,v35
v_mfma_f32_32x32x16_bf16 v[16:31],a[4:7],v[100:103],v[16:31]
v_exp_f32 v36,v36
v_exp_f32 v37,v37
v_exp_f32 v38,v38
v_exp_f32 v39,v39
v_cvt_pk_bf16_f32 v58,v36,v37
v_cvt_pk_bf16_f32 v59,v38,v39
v_mfma_f32_32x32x16_bf16 v[152:167],a[8:11],v[48:51],v[152:167]
v_exp_f32 v40,v40
v_exp_f32 v41,v41
v_exp_f32 v42,v42
v_exp_f32 v43,v43
v_cvt_pk_bf16_f32 v60,v40,v41
v_cvt_pk_bf16_f32 v61,v42,v43
v_mfma_f32_32x32x16_bf16 v[152:167],a[12:15],v[52:55],v[152:167]
v_exp_f32 v44,v44
v_exp_f32 v45,v45
v_exp_f32 v46,v46
v_exp_f32 v47,v47
v_cvt_pk_bf16_f32 v62,v44,v45
v_cvt_pk_bf16_f32 v63,v46,v47
s_waitcnt vmcnt(8)
v_mfma_f32_32x32x16_bf16 v[32:47],a[16:19],v[64:67],0
v_exp_f32 v16,v16
v_exp_f32 v17,v17
v_exp_f32 v18,v18
v_exp_f32_e64 v19,v19
v_cvt_pk_bf16_f32 v48,v16,v17
v_cvt_pk_bf16_f32 v49,v18,v19
v_mfma_f32_32x32x16_bf16 v[32:47],a[20:23],v[68:71],v[32:47]
v_exp_f32 v20,v20
v_exp_f32 v21,v21
v_exp_f32 v22,v22
v_exp_f32 v23,v23
v_cvt_pk_bf16_f32 v50,v20,v21
v_cvt_pk_bf16_f32 v51,v22,v23
v_mfma_f32_32x32x16_bf16 v[168:183],a[8:11],v[56:59],v[168:183]
v_exp_f32 v24,v24
v_exp_f32 v25,v25
v_exp_f32 v26,v26
v_exp_f32 v27,v27
v_cvt_pk_bf16_f32 v52,v24,v25
v_cvt_pk_bf16_f32 v53,v26,v27
v_mfma_f32_32x32x16_bf16 v[168:183],a[12:15],v[60:63],v[168:183]
v_exp_f32 v28,v28
v_exp_f32 v29,v29
v_exp_f32 v30,v30
v_exp_f32 v31,v31
v_cvt_pk_bf16_f32 v54,v28,v29
v_cvt_pk_bf16_f32 v55,v30,v31
v_mfma_f32_32x32x16_bf16 v[16:31],a[16:19],v[72:75],0
buffer_load_dwordx4 a[0:3],v2,s[8:11],s41 offen
v_exp_f32 v32,v32
v_exp_f32 v33,v33
v_exp_f32 v34,v34
v_exp_f32 v35,v35
v_cvt_pk_bf16_f32 v56,v32,v33
v_cvt_pk_bf16_f32 v57,v34,v35
v_mfma_f32_32x32x16_bf16 v[16:31],a[20:23],v[76:79],v[16:31]
buffer_load_dword a4,v7,s[52:55],s41 offen offset:3072
v_exp_f32 v36,v36
v_exp_f32 v37,v37
v_exp_f32 v38,v38
v_exp_f32 v39,v39
v_cvt_pk_bf16_f32 v58,v36,v37
v_cvt_pk_bf16_f32 v59,v38,v39
v_mfma_f32_32x32x16_bf16 v[184:199],a[8:11],v[48:51],v[184:199]
v_exp_f32 v40,v40
v_exp_f32 v41,v41
v_exp_f32 v42,v42
v_exp_f32 v43,v43
v_cvt_pk_bf16_f32 v60,v40,v41
v_cvt_pk_bf16_f32 v61,v42,v43
v_mfma_f32_32x32x16_bf16 v[184:199],a[12:15],v[52:55],v[184:199]
buffer_load_dwordx4 a[8:11],v248,s[8:11],s41 offen offset:1024
v_exp_f32 v44,v44
v_exp_f32 v45,v45
v_exp_f32 v46,v46
v_exp_f32 v47,v47
v_cvt_pk_bf16_f32 v62,v44,v45
v_cvt_pk_bf16_f32 v63,v46,v47
v_mfma_f32_32x32x16_bf16 v[32:47],a[16:19],v[80:83],0
buffer_load_dwordx4 a[12:15],v248,s[8:11],s41 offen offset:2048
s_add_u32 s41,s41,4096
v_exp_f32 v16,v16
v_exp_f32 v17,v17
v_exp_f32 v18,v18
v_exp_f32 v19,v19
v_cvt_pk_bf16_f32 v48,v16,v17
v_cvt_pk_bf16_f32 v49,v18,v19
v_mfma_f32_32x32x16_bf16 v[32:47],a[20:23],v[84:87],v[32:47]
v_exp_f32 v20,v20
v_exp_f32 v21,v21
v_exp_f32 v22,v22
v_exp_f32 v23,v23
v_cvt_pk_bf16_f32 v50,v20,v21
v_cvt_pk_bf16_f32 v51,v22,v23
v_mfma_f32_32x32x16_bf16 v[120:135],a[24:27],v[56:59],v[120:135]
v_exp_f32 v24,v24
v_exp_f32 v25,v25
v_exp_f32 v26,v26
v_exp_f32 v27,v27
v_cvt_pk_bf16_f32 v52,v24,v25
v_cvt_pk_bf16_f32 v53,v26,v27
v_mfma_f32_32x32x16_bf16 v[120:135],a[28:31],v[60:63],v[120:135]
v_exp_f32 v28,v28
v_exp_f32 v29,v29
v_exp_f32 v30,v30
v_exp_f32 v31,v31
v_cvt_pk_bf16_f32 v54,v28,v29
v_cvt_pk_bf16_f32 v55,v30,v31
v_mfma_f32_32x32x16_bf16 v[16:31],a[16:19],v[88:91],0
v_exp_f32 v32,v32
v_exp_f32 v33,v33
v_exp_f32 v34,v34
v_exp_f32 v35,v35
v_cvt_pk_bf16_f32 v56,v32,v33
v_cvt_pk_bf16_f32 v57,v34,v35
v_mfma_f32_32x32x16_bf16 v[16:31],a[20:23],v[92:95],v[16:31]
v_exp_f32 v36,v36
v_exp_f32 v37,v37
v_exp_f32 v38,v38
v_exp_f32 v39,v39
v_cvt_pk_bf16_f32 v58,v36,v37
v_cvt_pk_bf16_f32 v59,v38,v39
v_mfma_f32_32x32x16_bf16 v[136:151],a[24:27],v[48:51],v[136:151]
v_exp_f32 v40,v40
v_exp_f32 v41,v41
v_exp_f32 v42,v42
v_exp_f32 v43,v43
v_cvt_pk_bf16_f32 v60,v40,v41
v_cvt_pk_bf16_f32 v61,v42,v43
v_mfma_f32_32x32x16_bf16 v[136:151],a[28:31],v[52:55],v[136:151]
v_exp_f32 v44,v44
v_exp_f32 v45,v45
v_exp_f32 v46,v46
v_exp_f32 v47,v47
v_cvt_pk_bf16_f32 v62,v44,v45
v_cvt_pk_bf16_f32 v63,v46,v47
v_mfma_f32_32x32x16_bf16 v[32:47],a[16:19],v[96:99],0
v_exp_f32 v16,v16
v_exp_f32 v17,v17
v_exp_f32 v18,v18
v_exp_f32 v19,v19
v_cvt_pk_bf16_f32 v48,v16,v17
v_cvt_pk_bf16_f32 v49,v18,v19
v_mfma_f32_32x32x16_bf16 v[32:47],a[20:23],v[100:103],v[32:47]
v_exp_f32 v20,v20
v_exp_f32 v21,v21
v_exp_f32 v22,v22
v_exp_f32 v23,v23
v_cvt_pk_bf16_f32 v50,v20,v21
v_cvt_pk_bf16_f32 v51,v22,v23
v_mfma_f32_32x32x16_bf16 v[152:167],a[24:27],v[56:59],v[152:167]
v_exp_f32 v24,v24
v_exp_f32 v25,v25
v_exp_f32 v26,v26
v_exp_f32 v27,v27
v_cvt_pk_bf16_f32 v52,v24,v25
v_cvt_pk_bf16_f32 v53,v26,v27
v_mfma_f32_32x32x16_bf16 v[152:167],a[28:31],v[60:63],v[152:167]
v_exp_f32 v28,v28
v_exp_f32 v29,v29
v_exp_f32 v30,v30
v_exp_f32 v31,v31
v_cvt_pk_bf16_f32 v54,v28,v29
v_cvt_pk_bf16_f32 v55,v30,v31
s_waitcnt vmcnt(8)
v_mfma_f32_32x32x16_bf16 v[16:31],a[32:35],v[64:67],0
v_exp_f32 v32,v32
v_exp_f32 v33,v33
v_exp_f32 v34,v34
v_exp_f32_e64 v35,v35
v_cvt_pk_bf16_f32 v56,v32,v33
v_cvt_pk_bf16_f32 v57,v34,v35
v_mfma_f32_32x32x16_bf16 v[16:31],a[36:39],v[68:71],v[16:31]
v_exp_f32 v36,v36
v_exp_f32 v37,v37
v_exp_f32 v38,v38
v_exp_f32 v39,v39
v_cvt_pk_bf16_f32 v58,v36,v37
v_cvt_pk_bf16_f32 v59,v38,v39
v_mfma_f32_32x32x16_bf16 v[168:183],a[24:27],v[48:51],v[168:183]
v_exp_f32 v40,v40
v_exp_f32 v41,v41
v_exp_f32 v42,v42
v_exp_f32 v43,v43
v_cvt_pk_bf16_f32 v60,v40,v41
v_cvt_pk_bf16_f32 v61,v42,v43
v_mfma_f32_32x32x16_bf16 v[168:183],a[28:31],v[52:55],v[168:183]
v_exp_f32 v44,v44
v_exp_f32 v45,v45
v_exp_f32 v46,v46
v_exp_f32 v47,v47
v_cvt_pk_bf16_f32 v62,v44,v45
v_cvt_pk_bf16_f32 v63,v46,v47
v_mfma_f32_32x32x16_bf16 v[32:47],a[32:35],v[72:75],0
buffer_load_dwordx4 a[16:19],v2,s[8:11],s41 offen
v_exp_f32 v16,v16
v_exp_f32 v17,v17
v_exp_f32 v18,v18
v_exp_f32 v19,v19
v_cvt_pk_bf16_f32 v48,v16,v17
v_cvt_pk_bf16_f32 v49,v18,v19
v_mfma_f32_32x32x16_bf16 v[32:47],a[36:39],v[76:79],v[32:47]
buffer_load_dword a20,v7,s[52:55],s41 offen offset:3072
v_exp_f32 v20,v20
v_exp_f32 v21,v21
v_exp_f32 v22,v22
v_exp_f32 v23,v23
v_cvt_pk_bf16_f32 v50,v20,v21
v_cvt_pk_bf16_f32 v51,v22,v23
v_mfma_f32_32x32x16_bf16 v[184:199],a[24:27],v[56:59],v[184:199]
v_exp_f32 v24,v24
v_exp_f32 v25,v25
v_exp_f32 v26,v26
v_exp_f32 v27,v27
v_cvt_pk_bf16_f32 v52,v24,v25
v_cvt_pk_bf16_f32 v53,v26,v27
v_mfma_f32_32x32x16_bf16 v[184:199],a[28:31],v[60:63],v[184:199]
buffer_load_dwordx4 a[24:27],v248,s[8:11],s41 offen offset:1024
v_exp_f32 v28,v28
v_exp_f32 v29,v29
v_exp_f32 v30,v30
v_exp_f32 v31,v31
v_cvt_pk_bf16_f32 v54,v28,v29
v_cvt_pk_bf16_f32 v55,v30,v31
v_mfma_f32_32x32x16_bf16 v[16:31],a[32:35],v[80:83],0
buffer_load_dwordx4 a[28:31],v248,s[8:11],s41 offen offset:2048
s_add_u32 s41,s41,4096
v_exp_f32 v32,v32
v_exp_f32 v33,v33
v_exp_f32 v34,v34
v_exp_f32 v35,v35
v_cvt_pk_bf16_f32 v56,v32,v33
v_cvt_pk_bf16_f32 v57,v34,v35
v_mfma_f32_32x32x16_bf16 v[16:31],a[36:39],v[84:87],v[16:31]
v_exp_f32 v36,v36
v_exp_f32 v37,v37
v_exp_f32 v38,v38
v_exp_f32 v39,v39
v_cvt_pk_bf16_f32 v58,v36,v37
v_cvt_pk_bf16_f32 v59,v38,v39
v_mfma_f32_32x32x16_bf16 v[120:135],a[40:43],v[48:51],v[120:135]
v_exp_f32 v40,v40
v_exp_f32 v41,v41
v_exp_f32 v42,v42
v_exp_f32 v43,v43
v_cvt_pk_bf16_f32 v60,v40,v41
v_cvt_pk_bf16_f32 v61,v42,v43
v_mfma_f32_32x32x16_bf16 v[120:135],a[44:47],v[52:55],v[120:135]
v_exp_f32 v44,v44
v_exp_f32 v45,v45
v_exp_f32 v46,v46
v_exp_f32 v47,v47
v_cvt_pk_bf16_f32 v62,v44,v45
v_cvt_pk_bf16_f32 v63,v46,v47
v_mfma_f32_32x32x16_bf16 v[32:47],a[32:35],v[88:91],0
v_exp_f32 v16,v16
v_exp_f32 v17,v17
v_exp_f32 v18,v18
v_exp_f32 v19,v19
v_cvt_pk_bf16_f32 v48,v16,v17
v_cvt_pk_bf16_f32 v49,v18,v19
v_mfma_f32_32x32x16_bf16 v[32:47],a[36:39],v[92:95],v[32:47]
v_exp_f32 v20,v20
v_exp_f32 v21,v21
v_exp_f32 v22,v22
v_exp_f32 v23,v23
v_cvt_pk_bf16_f32 v50,v20,v21
v_cvt_pk_bf16_f32 v51,v22,v23
v_mfma_f32_32x32x16_bf16 v[136:151],a[40:43],v[56:59],v[136:151]
v_exp_f32 v24,v24
v_exp_f32 v25,v25
v_exp_f32 v26,v26
v_exp_f32 v27,v27
v_cvt_pk_bf16_f32 v52,v24,v25
v_cvt_pk_bf16_f32 v53,v26,v27
v_mfma_f32_32x32x16_bf16 v[136:151],a[44:47],v[60:63],v[136:151]
v_exp_f32 v28,v28
v_exp_f32 v29,v29
v_exp_f32 v30,v30
v_exp_f32 v31,v31
v_cvt_pk_bf16_f32 v54,v28,v29
v_cvt_pk_bf16_f32 v55,v30,v31
v_mfma_f32_32x32x16_bf16 v[16:31],a[32:35],v[96:99],0
v_exp_f32 v32,v32
v_exp_f32 v33,v33
v_exp_f32 v34,v34
v_exp_f32 v35,v35
v_cvt_pk_bf16_f32 v56,v32,v33
v_cvt_pk_bf16_f32 v57,v34,v35
v_mfma_f32_32x32x16_bf16 v[16:31],a[36:39],v[100:103],v[16:31]
v_exp_f32 v36,v36
v_exp_f32 v37,v37
v_exp_f32 v38,v38
v_exp_f32 v39,v39
v_cvt_pk_bf16_f32 v58,v36,v37
v_cvt_pk_bf16_f32 v59,v38,v39
v_mfma_f32_32x32x16_bf16 v[152:167],a[40:43],v[48:51],v[152:167]
v_exp_f32 v40,v40
v_exp_f32 v41,v41
v_exp_f32 v42,v42
v_exp_f32 v43,v43
v_cvt_pk_bf16_f32 v60,v40,v41
v_cvt_pk_bf16_f32 v61,v42,v43
v_mfma_f32_32x32x16_bf16 v[152:167],a[44:47],v[52:55],v[152:167]
v_exp_f32 v44,v44
v_exp_f32 v45,v45
v_exp_f32 v46,v46
v_exp_f32 v47,v47
v_cvt_pk_bf16_f32 v62,v44,v45
v_cvt_pk_bf16_f32 v63,v46,v47
s_waitcnt vmcnt(8)
v_mfma_f32_32x32x16_bf16 v[32:47],a[48:51],v[64:67],0
v_exp_f32 v16,v16
v_exp_f32 v17,v17
v_exp_f32 v18,v18
v_exp_f32_e64 v19,v19
v_cvt_pk_bf16_f32 v48,v16,v17
v_cvt_pk_bf16_f32 v49,v18,v19
v_mfma_f32_32x32x16_bf16 v[32:47],a[52:55],v[68:71],v[32:47]
v_exp_f32 v20,v20
v_exp_f32 v21,v21
v_exp_f32 v22,v22
v_exp_f32 v23,v23
v_cvt_pk_bf16_f32 v50,v20,v21
v_cvt_pk_bf16_f32 v51,v22,v23
v_mfma_f32_32x32x16_bf16 v[168:183],a[40:43],v[56:59],v[168:183]
v_exp_f32 v24,v24
v_exp_f32 v25,v25
v_exp_f32 v26,v26
v_exp_f32 v27,v27
v_cvt_pk_bf16_f32 v52,v24,v25
v_cvt_pk_bf16_f32 v53,v26,v27
v_mfma_f32_32x32x16_bf16 v[168:183],a[44:47],v[60:63],v[168:183]
v_exp_f32 v28,v28
v_exp_f32 v29,v29
v_exp_f32 v30,v30
v_exp_f32 v31,v31
v_cvt_pk_bf16_f32 v54,v28,v29
v_cvt_pk_bf16_f32 v55,v30,v31
v_mfma_f32_32x32x16_bf16 v[16:31],a[48:51],v[72:75],0
buffer_load_dwordx4 a[32:35],v2,s[8:11],s41 offen
v_exp_f32 v32,v32
v_exp_f32 v33,v33
v_exp_f32 v34,v34
v_exp_f32 v35,v35
v_cvt_pk_bf16_f32 v56,v32,v33
v_cvt_pk_bf16_f32 v57,v34,v35
v_mfma_f32_32x32x16_bf16 v[16:31],a[52:55],v[76:79],v[16:31]
buffer_load_dword a36,v7,s[52:55],s41 offen offset:3072
v_exp_f32 v36,v36
v_exp_f32 v37,v37
v_exp_f32 v38,v38
v_exp_f32 v39,v39
v_cvt_pk_bf16_f32 v58,v36,v37
v_cvt_pk_bf16_f32 v59,v38,v39
v_mfma_f32_32x32x16_bf16 v[184:199],a[40:43],v[48:51],v[184:199]
v_exp_f32 v40,v40
v_exp_f32 v41,v41
v_exp_f32 v42,v42
v_exp_f32 v43,v43
v_cvt_pk_bf16_f32 v60,v40,v41
v_cvt_pk_bf16_f32 v61,v42,v43
v_mfma_f32_32x32x16_bf16 v[184:199],a[44:47],v[52:55],v[184:199]
buffer_load_dwordx4 a[40:43],v248,s[8:11],s41 offen offset:1024
v_exp_f32 v44,v44
v_exp_f32 v45,v45
v_exp_f32 v46,v46
v_exp_f32 v47,v47
v_cvt_pk_bf16_f32 v62,v44,v45
v_cvt_pk_bf16_f32 v63,v46,v47
v_mfma_f32_32x32x16_bf16 v[32:47],a[48:51],v[80:83],0
buffer_load_dwordx4 a[44:47],v248,s[8:11],s41 offen offset:2048
s_add_u32 s41,s41,4096
v_exp_f32 v16,v16
v_exp_f32 v17,v17
v_exp_f32 v18,v18
v_exp_f32 v19,v19
v_cvt_pk_bf16_f32 v48,v16,v17
v_cvt_pk_bf16_f32 v49,v18,v19
v_mfma_f32_32x32x16_bf16 v[32:47],a[52:55],v[84:87],v[32:47]
v_exp_f32 v20,v20
v_exp_f32 v21,v21
v_exp_f32 v22,v22
v_exp_f32 v23,v23
v_cvt_pk_bf16_f32 v50,v20,v21
v_cvt_pk_bf16_f32 v51,v22,v23
v_mfma_f32_32x32x16_bf16 v[120:135],a[56:59],v[56:59],v[120:135]
v_exp_f32 v24,v24
v_exp_f32 v25,v25
v_exp_f32 v26,v26
v_exp_f32 v27,v27
v_cvt_pk_bf16_f32 v52,v24,v25
v_cvt_pk_bf16_f32 v53,v26,v27
v_mfma_f32_32x32x16_bf16 v[120:135],a[60:63],v[60:63],v[120:135]
v_exp_f32 v28,v28
v_exp_f32 v29,v29
v_exp_f32 v30,v30
v_exp_f32 v31,v31
v_cvt_pk_bf16_f32 v54,v28,v29
v_cvt_pk_bf16_f32 v55,v30,v31
v_mfma_f32_32x32x16_bf16 v[16:31],a[48:51],v[88:91],0
v_exp_f32 v32,v32
v_exp_f32 v33,v33
v_exp_f32 v34,v34
v_exp_f32 v35,v35
v_cvt_pk_bf16_f32 v56,v32,v33
v_cvt_pk_bf16_f32 v57,v34,v35
v_mfma_f32_32x32x16_bf16 v[16:31],a[52:55],v[92:95],v[16:31]
v_exp_f32 v36,v36
v_exp_f32 v37,v37
v_exp_f32 v38,v38
v_exp_f32 v39,v39
v_cvt_pk_bf16_f32 v58,v36,v37
v_cvt_pk_bf16_f32 v59,v38,v39
v_mfma_f32_32x32x16_bf16 v[136:151],a[56:59],v[48:51],v[136:151]
v_exp_f32 v40,v40
v_exp_f32 v41,v41
v_exp_f32 v42,v42
v_exp_f32 v43,v43
v_cvt_pk_bf16_f32 v60,v40,v41
v_cvt_pk_bf16_f32 v61,v42,v43
v_mfma_f32_32x32x16_bf16 v[136:151],a[60:63],v[52:55],v[136:151]
v_exp_f32 v44,v44
v_exp_f32 v45,v45
v_exp_f32 v46,v46
v_exp_f32 v47,v47
v_cvt_pk_bf16_f32 v62,v44,v45
v_cvt_pk_bf16_f32 v63,v46,v47
v_mfma_f32_32x32x16_bf16 v[32:47],a[48:51],v[96:99],0
v_exp_f32 v16,v16
v_exp_f32 v17,v17
v_exp_f32 v18,v18
v_exp_f32 v19,v19
v_cvt_pk_bf16_f32 v48,v16,v17
v_cvt_pk_bf16_f32 v49,v18,v19
v_mfma_f32_32x32x16_bf16 v[32:47],a[52:55],v[100:103],v[32:47]
v_exp_f32 v20,v20
v_exp_f32 v21,v21
v_exp_f32 v22,v22
v_exp_f32 v23,v23
v_cvt_pk_bf16_f32 v50,v20,v21
v_cvt_pk_bf16_f32 v51,v22,v23
v_mfma_f32_32x32x16_bf16 v[152:167],a[56:59],v[56:59],v[152:167]
v_exp_f32 v24,v24
v_exp_f32 v25,v25
v_exp_f32 v26,v26
v_exp_f32 v27,v27
v_cvt_pk_bf16_f32 v52,v24,v25
v_cvt_pk_bf16_f32 v53,v26,v27
v_mfma_f32_32x32x16_bf16 v[152:167],a[60:63],v[60:63],v[152:167]
v_exp_f32 v28,v28
v_exp_f32 v29,v29
v_exp_f32 v30,v30
v_exp_f32 v31,v31
v_cvt_pk_bf16_f32 v54,v28,v29
v_cvt_pk_bf16_f32 v55,v30,v31
s_waitcnt vmcnt(8)
v_mfma_f32_32x32x16_bf16 v[16:31],a[0:3],v[64:67],0
v_exp_f32 v32,v32
v_exp_f32 v33,v33
v_exp_f32 v34,v34
v_exp_f32_e64 v35,v35
v_cvt_pk_bf16_f32 v56,v32,v33
v_cvt_pk_bf16_f32 v57,v34,v35
v_mfma_f32_32x32x16_bf16 v[16:31],a[4:7],v[68:71],v[16:31]
v_exp_f32 v36,v36
v_exp_f32 v37,v37
v_exp_f32 v38,v38
v_exp_f32 v39,v39
v_cvt_pk_bf16_f32 v58,v36,v37
v_cvt_pk_bf16_f32 v59,v38,v39
v_mfma_f32_32x32x16_bf16 v[168:183],a[56:59],v[48:51],v[168:183]
v_exp_f32 v40,v40
v_exp_f32 v41,v41
v_exp_f32 v42,v42
v_exp_f32 v43,v43
v_cvt_pk_bf16_f32 v60,v40,v41
v_cvt_pk_bf16_f32 v61,v42,v43
v_mfma_f32_32x32x16_bf16 v[168:183],a[60:63],v[52:55],v[168:183]
v_exp_f32 v44,v44
v_exp_f32 v45,v45
v_exp_f32 v46,v46
v_exp_f32 v47,v47
v_cvt_pk_bf16_f32 v62,v44,v45
v_cvt_pk_bf16_f32 v63,v46,v47
s_sub_u32 s39,s39,1
s_cmp_lg_u32 s39,0
s_cbranch_scc1 att5_loop
v_mfma_f32_32x32x16_bf16 v[32:47],a[0:3],v[72:75],0
buffer_load_dwordx4 a[48:51],v2,s[8:11],s41 offen
v_exp_f32 v16,v16
v_exp_f32 v17,v17
v_exp_f32 v18,v18
v_exp_f32_e64 v19,v19
v_cvt_pk_bf16_f32 v48,v16,v17
v_cvt_pk_bf16_f32 v49,v18,v19
v_mfma_f32_32x32x16_bf16 v[32:47],a[4:7],v[76:79],v[32:47]
buffer_load_dword a52,v7,s[52:55],s41 offen offset:3072
v_exp_f32 v20,v20
v_exp_f32 v21,v21
v_exp_f32 v22,v22
v_exp_f32 v23,v23
v_cvt_pk_bf16_f32 v50,v20,v21
v_cvt_pk_bf16_f32 v51,v22,v23
v_mfma_f32_32x32x16_bf16 v[184:199],a[56:59],v[56:59],v[184:199]
v_exp_f32 v24,v24
v_exp_f32 v25,v25
v_exp_f32 v26,v26
v_exp_f32 v27,v27
v_cvt_pk_bf16_f32 v52,v24,v25
v_cvt_pk_bf16_f32 v53,v26,v27
v_mfma_f32_32x32x16_bf16 v[184:199],a[60:63],v[60:63],v[184:199]
buffer_load_dwordx4 a[56:59],v248,s[8:11],s41 offen offset:1024
v_exp_f32 v28,v28
v_exp_f32 v29,v29
v_exp_f32 v30,v30
v_exp_f32 v31,v31
v_cvt_pk_bf16_f32 v54,v28,v29
v_cvt_pk_bf16_f32 v55,v30,v31
v_mfma_f32_32x32x16_bf16 v[16:31],a[0:3],v[80:83],0
buffer_load_dwordx4 a[60:63],v248,s[8:11],s41 offen offset:2048
s_add_u32 s41,s41,4096
v_exp_f32 v32,v32
v_exp_f32 v33,v33
v_exp_f32 v34,v34
v_exp_f32 v35,v35
v_cvt_pk_bf16_f32 v56,v32,v33
v_cvt_pk_bf16_f32 v57,v34,v35
v_mfma_f32_32x32x16_bf16 v[16:31],a[4:7],v[84:87],v[16:31]
s_mov_b32 s43,s23
s_add_u32 s23,s23,32768
s_add_u32 m0,s43,0
s_add_u32 s22,s22,28672
buffer_load_dwordx4 v2,s[12:15],s22 offen offset:0 lds
v_exp_f32 v36,v36
v_exp_f32 v37,v37
v_exp_f32 v38,v38
v_exp_f32 v39,v39
v_cvt_pk_bf16_f32 v58,v36,v37
v_cvt_pk_bf16_f32 v59,v38,v39
v_mfma_f32_32x32x16_bf16 v[120:135],a[8:11],v[48:51],v[120:135]
v_exp_f32 v40,v40
v_exp_f32 v41,v41
v_exp_f32 v42,v42
v_exp_f32 v43,v43
v_cvt_pk_bf16_f32 v60,v40,v41
v_cvt_pk_bf16_f32 v61,v42,v43
v_mfma_f32_32x32x16_bf16 v[120:135],a[12:15],v[52:55],v[120:135]
buffer_load_dwordx4 v2,s[12:15],s22 offen offset:1024 lds
v_exp_f32 v44,v44
v_exp_f32 v45,v45
v_exp_f32 v46,v46
v_exp_f32 v47,v47
v_cvt_pk_bf16_f32 v62,v44,v45
v_cvt_pk_bf16_f32 v63,v46,v47
v_mfma_f32_32x32x16_bf16 v[32:47],a[0:3],v[88:91],0
v_exp_f32 v16,v16
v_exp_f32 v17,v17
v_exp_f32 v18,v18
v_exp_f32 v19,v19
v_cvt_pk_bf16_f32 v48,v16,v17
v_cvt_pk_bf16_f32 v49,v18,v19
v_mfma_f32_32x32x16_bf16 v[32:47],a[4:7],v[92:95],v[32:47]
buffer_load_dwordx4 v2,s[12:15],s22 offen offset:2048 lds
v_exp_f32 v20,v20
v_exp_f32 v21,v21
v_exp_f32 v22,v22
v_exp_f32 v23,v23
v_cvt_pk_bf16_f32 v50,v20,v21
v_cvt_pk_bf16_f32 v51,v22,v23
v_mfma_f32_32x32x16_bf16 v[136:151],a[8:11],v[56:59],v[136:151]
v_exp_f32 v24,v24
v_exp_f32 v25,v25
v_exp_f32 v26,v26
v_exp_f32 v27,v27
v_cvt_pk_bf16_f32 v52,v24,v25
v_cvt_pk_bf16_f32 v53,v26,v27
v_mfma_f32_32x32x16_bf16 v[136:151],a[12:15],v[60:63],v[136:151]
buffer_load_dwordx4 v2,s[12:15],s22 offen offset:3072 lds
v_exp_f32 v28,v28
v_exp_f32 v29,v29
v_exp_f32 v30,v30
v_exp_f32 v31,v31
v_cvt_pk_bf16_f32 v54,v28,v29
v_cvt_pk_bf16_f32 v55,v30,v31
v_mfma_f32_32x32x16_bf16 v[16:31],a[0:3],v[96:99],0
v_exp_f32 v32,v32
v_exp_f32 v33,v33
v_exp_f32 v34,v34
v_exp_f32 v35,v35
v_cvt_pk_bf16_f32 v56,v32,v33
v_cvt_pk_bf16_f32 v57,v34,v35
v_mfma_f32_32x32x16_bf16 v[16:31],a[4:7],v[100:103],v[16:31]
s_add_u32 m0,s43,4096
s_add_u32 s22,s22,4096
buffer_load_dwordx4 v2,s[12:15],s22 offen offset:0 lds
v_exp_f32 v36,v36
v_exp_f32 v37,v37
v_exp_f32 v38,v38
v_exp_f32 v39,v39
v_cvt_pk_bf16_f32 v58,v36,v37
v_cvt_pk_bf16_f32 v59,v38,v39
v_mfma_f32_32x32x16_bf16 v[152:167],a[8:11],v[48:51],v[152:167]
v_exp_f32 v40,v40
v_exp_f32 v41,v41
v_exp_f32 v42,v42
v_exp_f32 v43,v43
v_cvt_pk_bf16_f32 v60,v40,v41
v_cvt_pk_bf16_f32 v61,v42,v43
v_mfma_f32_32x32x16_bf16 v[152:167],a[12:15],v[52:55],v[152:167]
buffer_load_dwordx4 v2,s[12:15],s22 offen offset:1024 lds
v_exp_f32 v44,v44
v_exp_f32 v45,v45
v_exp_f32 v46,v46
v_exp_f32 v47,v47
v_cvt_pk_bf16_f32 v62,v44,v45
v_cvt_pk_bf16_f32 v63,v46,v47
s_waitcnt vmcnt(14)
v_mfma_f32_32x32x16_bf16 v[32:47],a[16:19],v[64:67],0
v_exp_f32 v16,v16
v_exp_f32 v17,v17
v_exp_f32 v18,v18
v_exp_f32_e64 v19,v19
v_cvt_pk_bf16_f32 v48,v16,v17
v_cvt_pk_bf16_f32 v49,v18,v19
v_mfma_f32_32x32x16_bf16 v[32:47],a[20:23],v[68:71],v[32:47]
buffer_load_dwordx4 v2,s[12:15],s22 offen offset:2048 lds
v_exp_f32 v20,v20
v_exp_f32 v21,v21
v_exp_f32 v22,v22
v_exp_f32 v23,v23
v_cvt_pk_bf16_f32 v50,v20,v21
v_cvt_pk_bf16_f32 v51,v22,v23
v_mfma_f32_32x32x16_bf16 v[168:183],a[8:11],v[56:59],v[168:183]
v_exp_f32 v24,v24
v_exp_f32 v25,v25
v_exp_f32 v26,v26
v_exp_f32 v27,v27
v_cvt_pk_bf16_f32 v52,v24,v25
v_cvt_pk_bf16_f32 v53,v26,v27
v_mfma_f32_32x32x16_bf16 v[168:183],a[12:15],v[60:63],v[168:183]
buffer_load_dwordx4 v2,s[12:15],s22 offen offset:3072 lds
v_exp_f32 v28,v28
v_exp_f32 v29,v29
v_exp_f32 v30,v30
v_exp_f32 v31,v31
v_cvt_pk_bf16_f32 v54,v28,v29
v_cvt_pk_bf16_f32 v55,v30,v31
v_mfma_f32_32x32x16_bf16 v[16:31],a[16:19],v[72:75],0
v_exp_f32 v32,v32
v_exp_f32 v33,v33
v_exp_f32 v34,v34
v_exp_f32 v35,v35
v_cvt_pk_bf16_f32 v56,v32,v33
v_cvt_pk_bf16_f32 v57,v34,v35
v_mfma_f32_32x32x16_bf16 v[16:31],a[20:23],v[76:79],v[16:31]
buffer_load_dwordx4 a[128:131],v2,s[8:11],s4 offen offset:0
v_exp_f32 v36,v36
v_exp_f32 v37,v37
v_exp_f32 v38,v38
v_exp_f32 v39,v39
v_cvt_pk_bf16_f32 v58,v36,v37
v_cvt_pk_bf16_f32 v59,v38,v39
v_mfma_f32_32x32x16_bf16 v[184:199],a[8:11],v[48:51],v[184:199]
v_exp_f32 v40,v40
v_exp_f32 v41,v41
v_exp_f32 v42,v42
v_exp_f32 v43,v43
v_cvt_pk_bf16_f32 v60,v40,v41
v_cvt_pk_bf16_f32 v61,v42,v43
v_mfma_f32_32x32x16_bf16 v[184:199],a[12:15],v[52:55],v[184:199]
buffer_load_dwordx4 a[132:135],v2,s[8:11],s4 offen offset:1024
v_exp_f32 v44,v44
v_exp_f32 v45,v45
v_exp_f32 v46,v46
v_exp_f32 v47,v47
v_cvt_pk_bf16_f32 v62,v44,v45
v_cvt_pk_bf16_f32 v63,v46,v47
v_mfma_f32_32x32x16_bf16 v[32:47],a[16:19],v[80:83],0
v_exp_f32 v16,v16
v_exp_f32 v17,v17
v_exp_f32 v18,v18
v_exp_f32 v19,v19
v_cvt_pk_bf16_f32 v48,v16,v17
v_cvt_pk_bf16_f32 v49,v18,v19
v_mfma_f32_32x32x16_bf16 v[32:47],a[20:23],v[84:87],v[32:47]
buffer_load_dwordx4 a[136:139],v2,s[8:11],s4 offen offset:2048
v_exp_f32 v20,v20
v_exp_f32 v21,v21
v_exp_f32 v22,v22
v_exp_f32 v23,v23
v_cvt_pk_bf16_f32 v50,v20,v21
v_cvt_pk_bf16_f32 v51,v22,v23
v_mfma_f32_32x32x16_bf16 v[120:135],a[24:27],v[56:59],v[120:135]
v_exp_f32 v24,v24
v_exp_f32 v25,v25
v_exp_f32 v26,v26
v_exp_f32 v27,v27
v_cvt_pk_bf16_f32 v52,v24,v25
v_cvt_pk_bf16_f32 v53,v26,v27
v_mfma_f32_32x32x16_bf16 v[120:135],a[28:31],v[60:63],v[120:135]
buffer_load_dwordx4 a[140:143],v2,s[8:11],s4 offen offset:3072
s_add_u32 s4,s4,4096
v_exp_f32 v28,v28
v_exp_f32 v29,v29
v_exp_f32 v30,v30
v_exp_f32 v31,v31
v_cvt_pk_bf16_f32 v54,v28,v29
v_cvt_pk_bf16_f32 v55,v30,v31
v_mfma_f32_32x32x16_bf16 v[16:31],a[16:19],v[88:91],0
v_exp_f32 v32,v32
v_exp_f32 v33,v33
v_exp_f32 v34,v34
v_exp_f32 v35,v35
v_cvt_pk_bf16_f32 v56,v32,v33
v_cvt_pk_bf16_f32 v57,v34,v35
v_mfma_f32_32x32x16_bf16 v[16:31],a[20:23],v[92:95],v[16:31]
buffer_load_dwordx4 a[144:147],v2,s[8:11],s4 offen offset:0
v_exp_f32 v36,v36
v_exp_f32 v37,v37
v_exp_f32 v38,v38
v_exp_f32 v39,v39
v_cvt_pk_bf16_f32 v58,v36,v37
v_cvt_pk_bf16_f32 v59,v38,v39
v_mfma_f32_32x32x16_bf16 v[136:151],a[24:27],v[48:51],v[136:151]
v_exp_f32 v40,v40
v_exp_f32 v41,v41
v_exp_f32 v42,v42
v_exp_f32 v43,v43
v_cvt_pk_bf16_f32 v60,v40,v41
v_cvt_pk_bf16_f32 v61,v42,v43
v_mfma_f32_32x32x16_bf16 v[136:151],a[28:31],v[52:55],v[136:151]
buffer_load_dwordx4 a[148:151],v2,s[8:11],s4 offen offset:1024
v_exp_f32 v44,v44
v_exp_f32 v45,v45
v_exp_f32 v46,v46
v_exp_f32 v47,v47
v_cvt_pk_bf16_f32 v62,v44,v45
v_cvt_pk_bf16_f32 v63,v46,v47
v_mfma_f32_32x32x16_bf16 v[32:47],a[16:19],v[96:99],0
v_exp_f32 v16,v16
v_exp_f32 v17,v17
v_exp_f32 v18,v18
v_exp_f32 v19,v19
v_cvt_pk_bf16_f32 v48,v16,v17
v_cvt_pk_bf16_f32 v49,v18,v19
v_mfma_f32_32x32x16_bf16 v[32:47],a[20:23],v[100:103],v[32:47]
buffer_load_dwordx4 a[152:155],v2,s[8:11],s4 offen offset:2048
v_exp_f32 v20,v20
v_exp_f32 v21,v21
v_exp_f32 v22,v22
v_exp_f32 v23,v23
v_cvt_pk_bf16_f32 v50,v20,v21
v_cvt_pk_bf16_f32 v51,v22,v23
v_mfma_f32_32x32x16_bf16 v[152:167],a[24:27],v[56:59],v[152:167]
v_exp_f32 v24,v24
v_exp_f32 v25,v25
v_exp_f32 v26,v26
v_exp_f32 v27,v27
v_cvt_pk_bf16_f32 v52,v24,v25
v_cvt_pk_bf16_f32 v53,v26,v27
v_mfma_f32_32x32x16_bf16 v[152:167],a[28:31],v[60:63],v[152:167]
buffer_load_dwordx4 a[156:159],v2,s[8:11],s4 offen offset:3072
v_exp_f32 v28,v28
v_exp_f32 v29,v29
v_exp_f32 v30,v30
v_exp_f32 v31,v31
v_cvt_pk_bf16_f32 v54,v28,v29
v_cvt_pk_bf16_f32 v55,v30,v31
s_waitcnt vmcnt(20)
v_mfma_f32_32x32x16_bf16 v[16:31],a[32:35],v[64:67],0
v_exp_f32 v32,v32
v_exp_f32 v33,v33
v_exp_f32 v34,v34
v_exp_f32_e64 v35,v35
v_cvt_pk_bf16_f32 v56,v32,v33
v_cvt_pk_bf16_f32 v57,v34,v35
v_mfma_f32_32x32x16_bf16 v[16:31],a[36:39],v[68:71],v[16:31]
buffer_load_dwordx4 a[160:163],v2,s[8:11],s5 offen offset:0
v_exp_f32 v36,v36
v_exp_f32 v37,v37
v_exp_f32 v38,v38
v_exp_f32 v39,v39
v_cvt_pk_bf16_f32 v58,v36,v37
v_cvt_pk_bf16_f32 v59,v38,v39
v_mfma_f32_32x32x16_bf16 v[168:183],a[24:27],v[48:51],v[168:183]
v_exp_f32 v40,v40
v_exp_f32 v41,v41
v_exp_f32 v42,v42
v_exp_f32 v43,v43
v_cvt_pk_bf16_f32 v60,v40,v41
v_cvt_pk_bf16_f32 v61,v42,v43
v_mfma_f32_32x32x16_bf16 v[168:183],a[28:31],v[52:55],v[168:183]
buffer_load_dwordx4 a[164:167],v2,s[8:11],s5 offen offset:1024
v_exp_f32 v44,v44
v_exp_f32 v45,v45
v_exp_f32 v46,v46
v_exp_f32 v47,v47
v_cvt_pk_bf16_f32 v62,v44,v45
v_cvt_pk_bf16_f32 v63,v46,v47
v_mfma_f32_32x32x16_bf16 v[32:47],a[32:35],v[72:75],0
v_exp_f32 v16,v16
v_exp_f32 v17,v17
v_exp_f32 v18,v18
v_exp_f32 v19,v19
v_cvt_pk_bf16_f32 v48,v16,v17
v_cvt_pk_bf16_f32 v49,v18,v19
v_mfma_f32_32x32x16_bf16 v[32:47],a[36:39],v[76:79],v[32:47]
buffer_load_dwordx4 a[168:171],v2,s[8:11],s5 offen offset:2048
v_exp_f32 v20,v20
v_exp_f32 v21,v21
v_exp_f32 v22,v22
v_exp_f32 v23,v23
v_cvt_pk_bf16_f32 v50,v20,v21
v_cvt_pk_bf16_f32 v51,v22,v23
v_mfma_f32_32x32x16_bf16 v[184:199],a[24:27],v[56:59],v[184:199]
v_exp_f32 v24,v24
v_exp_f32 v25,v25
v_exp_f32 v26,v26
v_exp_f32 v27,v27
v_cvt_pk_bf16_f32 v52,v24,v25
v_cvt_pk_bf16_f32 v53,v26,v27
v_mfma_f32_32x32x16_bf16 v[184:199],a[28:31],v[60:63],v[184:199]
buffer_load_dwordx4 a[172:175],v2,s[8:11],s5 offen offset:3072
s_add_u32 s5,s5,4096
v_exp_f32 v28,v28
v_exp_f32 v29,v29
v_exp_f32 v30,v30
v_exp_f32 v31,v31
v_cvt_pk_bf16_f32 v54,v28,v29
v_cvt_pk_bf16_f32 v55,v30,v31
v_mfma_f32_32x32x16_bf16 v[16:31],a[32:35],v[80:83],0
v_exp_f32 v32,v32
v_exp_f32 v33,v33
v_exp_f32 v34,v34
v_exp_f32 v35,v35
v_cvt_pk_bf16_f32 v56,v32,v33
v_cvt_pk_bf16_f32 v57,v34,v35
v_mfma_f32_32x32x16_bf16 v[16:31],a[36:39],v[84:87],v[16:31]
buffer_load_dwordx4 a[176:179],v2,s[8:11],s5 offen offset:0
v_exp_f32 v36,v36
v_exp_f32 v37,v37
v_exp_f32 v38,v38
v_exp_f32 v39,v39
v_cvt_pk_bf16_f32 v58,v36,v37
v_cvt_pk_bf16_f32 v59,v38,v39
v_mfma_f32_32x32x16_bf16 v[120:135],a[40:43],v[48:51],v[120:135]
v_exp_f32 v40,v40
v_exp_f32 v41,v41
v_exp_f32 v42,v42
v_exp_f32 v43,v43
v_cvt_pk_bf16_f32 v60,v40,v41
v_cvt_pk_bf16_f32 v61,v42,v43
v_mfma_f32_32x32x16_bf16 v[120:135],a[44:47],v[52:55],v[120:135]
buffer_load_dwordx4 a[180:183],v2,s[8:11],s5 offen offset:1024
v_exp_f32 v44,v44
v_exp_f32 v45,v45
v_exp_f32 v46,v46
v_exp_f32 v47,v47
v_cvt_pk_bf16_f32 v62,v44,v45
v_cvt_pk_bf16_f32 v63,v46,v47
v_mfma_f32_32x32x16_bf16 v[32:47],a[32:35],v[88:91],0
v_exp_f32 v16,v16
v_exp_f32 v17,v17
v_exp_f32 v18,v18
v_exp_f32 v19,v19
v_cvt_pk_bf16_f32 v48,v16,v17
v_cvt_pk_bf16_f32 v49,v18,v19
v_mfma_f32_32x32x16_bf16 v[32:47],a[36:39],v[92:95],v[32:47]
buffer_load_dwordx4 a[184:187],v2,s[8:11],s5 offen offset:2048
v_exp_f32 v20,v20
v_exp_f32 v21,v21
v_exp_f32 v22,v22
v_exp_f32 v23,v23
v_cvt_pk_bf16_f32 v50,v20,v21
v_cvt_pk_bf16_f32 v51,v22,v23
v_mfma_f32_32x32x16_bf16 v[136:151],a[40:43],v[56:59],v[136:151]
v_exp_f32 v24,v24
v_exp_f32 v25,v25
v_exp_f32 v26,v26
v_exp_f32 v27,v27
v_cvt_pk_bf16_f32 v52,v24,v25
v_cvt_pk_bf16_f32 v53,v26,v27
v_mfma_f32_32x32x16_bf16 v[136:151],a[44:47],v[60:63],v[136:151]
buffer_load_dwordx4 a[188:191],v2,s[8:11],s5 offen offset:3072
v_exp_f32 v28,v28
v_exp_f32 v29,v29
v_exp_f32 v30,v30
v_exp_f32 v31,v31
v_cvt_pk_bf16_f32 v54,v28,v29
v_cvt_pk_bf16_f32 v55,v30,v31
v_mfma_f32_32x32x16_bf16 v[16:31],a[32:35],v[96:99],0
v_exp_f32 v32,v32
v_exp_f32 v33,v33
v_exp_f32 v34,v34
v_exp_f32 v35,v35
v_cvt_pk_bf16_f32 v56,v32,v33
v_cvt_pk_bf16_f32 v57,v34,v35
v_mfma_f32_32x32x16_bf16 v[16:31],a[36:39],v[100:103],v[16:31]
s_mov_b32 s43,s23
s_add_u32 s23,s23,32768
s_add_u32 m0,s43,0
s_add_u32 s22,s22,28672
buffer_load_dwordx4 v2,s[12:15],s22 offen offset:0 lds
v_exp_f32 v36,v36
v_exp_f32 v37,v37
v_exp_f32 v38,v38
v_exp_f32 v39,v39
v_cvt_pk_bf16_f32 v58,v36,v37
v_cvt_pk_bf16_f32 v59,v38,v39
v_mfma_f32_32x32x16_bf16 v[152:167],a[40:43],v[48:51],v[152:167]
v_exp_f32 v40,v40
v_exp_f32 v41,v41
v_exp_f32 v42,v42
v_exp_f32 v43,v43
v_cvt_pk_bf16_f32 v60,v40,v41
v_cvt_pk_bf16_f32 v61,v42,v43
v_mfma_f32_32x32x16_bf16 v[152:167],a[44:47],v[52:55],v[152:167]
buffer_load_dwordx4 v2,s[12:15],s22 offen offset:1024 lds
v_exp_f32 v44,v44
v_exp_f32 v45,v45
v_exp_f32 v46,v46
v_exp_f32 v47,v47
v_cvt_pk_bf16_f32 v62,v44,v45
v_cvt_pk_bf16_f32 v63,v46,v47
s_waitcnt vmcnt(26)
v_mfma_f32_32x32x16_bf16 v[32:47],a[48:51],v[64:67],0
v_exp_f32 v16,v16
v_exp_f32 v17,v17
v_exp_f32 v18,v18
v_exp_f32_e64 v19,v19
v_cvt_pk_bf16_f32 v48,v16,v17
v_cvt_pk_bf16_f32 v49,v18,v19
v_mfma_f32_32x32x16_bf16 v[32:47],a[52:55],v[68:71],v[32:47]
buffer_load_dwordx4 v2,s[12:15],s22 offen offset:2048 lds
v_exp_f32 v20,v20
v_exp_f32 v21,v21
v_exp_f32 v22,v22
v_exp_f32 v23,v23
v_cvt_pk_bf16_f32 v50,v20,v21
v_cvt_pk_bf16_f32 v51,v22,v23
v_mfma_f32_32x32x16_bf16 v[168:183],a[40:43],v[56:59],v[168:183]
v_exp_f32 v24,v24
v_exp_f32 v25,v25
v_exp_f32 v26,v26
v_exp_f32 v27,v27
v_cvt_pk_bf16_f32 v52,v24,v25
v_cvt_pk_bf16_f32 v53,v26,v27
v_mfma_f32_32x32x16_bf16 v[168:183],a[44:47],v[60:63],v[168:183]
buffer_load_dwordx4 v2,s[12:15],s22 offen offset:3072 lds
v_exp_f32 v28,v28
v_exp_f32 v29,v29
v_exp_f32 v30,v30
v_exp_f32 v31,v31
v_cvt_pk_bf16_f32 v54,v28,v29
v_cvt_pk_bf16_f32 v55,v30,v31
v_mfma_f32_32x32x16_bf16 v[16:31],a[48:51],v[72:75],0
v_exp_f32 v32,v32
v_exp_f32 v33,v33
v_exp_f32 v34,v34
v_exp_f32 v35,v35
v_cvt_pk_bf16_f32 v56,v32,v33
v_cvt_pk_bf16_f32 v57,v34,v35
v_mfma_f32_32x32x16_bf16 v[16:31],a[52:55],v[76:79],v[16:31]
s_add_u32 m0,s43,4096
s_add_u32 s22,s22,4096
buffer_load_dwordx4 v2,s[12:15],s22 offen offset:0 lds
v_exp_f32 v36,v36
v_exp_f32 v37,v37
v_exp_f32 v38,v38
v_exp_f32 v39,v39
v_cvt_pk_bf16_f32 v58,v36,v37
v_cvt_pk_bf16_f32 v59,v38,v39
v_mfma_f32_32x32x16_bf16 v[184:199],a[40:43],v[48:51],v[184:199]
v_exp_f32 v40,v40
v_exp_f32 v41,v41
v_exp_f32 v42,v42
v_exp_f32 v43,v43
v_cvt_pk_bf16_f32 v60,v40,v41
v_cvt_pk_bf16_f32 v61,v42,v43
v_mfma_f32_32x32x16_bf16 v[184:199],a[44:47],v[52:55],v[184:199]
buffer_load_dwordx4 v2,s[12:15],s22 offen offset:1024 lds
v_exp_f32 v44,v44
v_exp_f32 v45,v45
v_exp_f32 v46,v46
v_exp_f32 v47,v47
v_cvt_pk_bf16_f32 v62,v44,v45
v_cvt_pk_bf16_f32 v63,v46,v47
v_mfma_f32_32x32x16_bf16 v[32:47],a[48:51],v[80:83],0
v_exp_f32 v16,v16
v_exp_f32 v17,v17
v_exp_f32 v18,v18
v_exp_f32 v19,v19
v_cvt_pk_bf16_f32 v48,v16,v17
v_cvt_pk_bf16_f32 v49,v18,v19
v_mfma_f32_32x32x16_bf16 v[32:47],a[52:55],v[84:87],v[32:47]
buffer_load_dwordx4 v2,s[12:15],s22 offen offset:2048 lds
v_exp_f32 v20,v20
v_exp_f32 v21,v21
v_exp_f32 v22,v22
v_exp_f32 v23,v23
v_cvt_pk_bf16_f32 v50,v20,v21
v_cvt_pk_bf16_f32 v51,v22,v23
v_mfma_f32_32x32x16_bf16 v[120:135],a[56:59],v[56:59],v[120:135]
v_exp_f32 v24,v24
v_exp_f32 v25,v25
v_exp_f32 v26,v26
v_exp_f32 v27,v27
v_cvt_pk_bf16_f32 v52,v24,v25
v_cvt_pk_bf16_f32 v53,v26,v27
v_mfma_f32_32x32x16_bf16 v[120:135],a[60:63],v[60:63],v[120:135]
buffer_load_dwordx4 v2,s[12:15],s22 offen offset:3072 lds
v_exp_f32 v28,v28
v_exp_f32 v29,v29
v_exp_f32 v30,v30
v_exp_f32 v31,v31
v_cvt_pk_bf16_f32 v54,v28,v29
v_cvt_pk_bf16_f32 v55,v30,v31
v_mfma_f32_32x32x16_bf16 v[16:31],a[48:51],v[88:91],0
v_exp_f32 v32,v32
v_exp_f32 v33,v33
v_exp_f32 v34,v34
v_exp_f32 v35,v35
v_cvt_pk_bf16_f32 v56,v32,v33
v_cvt_pk_bf16_f32 v57,v34,v35
v_mfma_f32_32x32x16_bf16 v[16:31],a[52:55],v[92:95],v[16:31]
v_exp_f32 v36,v36
v_exp_f32 v37,v37
v_exp_f32 v38,v38
v_exp_f32 v39,v39
v_cvt_pk_bf16_f32 v58,v36,v37
v_cvt_pk_bf16_f32 v59,v38,v39
v_mfma_f32_32x32x16_bf16 v[136:151],a[56:59],v[48:51],v[136:151]
v_exp_f32 v40,v40
v_exp_f32 v41,v41
v_exp_f32 v42,v42
v_exp_f32 v43,v43
v_cvt_pk_bf16_f32 v60,v40,v41
v_cvt_pk_bf16_f32 v61,v42,v43
v_mfma_f32_32x32x16_bf16 v[136:151],a[60:63],v[52:55],v[136:151]
v_exp_f32 v44,v44
v_exp_f32 v45,v45
v_exp_f32 v46,v46
v_exp_f32 v47,v47
v_cvt_pk_bf16_f32 v62,v44,v45
v_cvt_pk_bf16_f32 v63,v46,v47
v_mfma_f32_32x32x16_bf16 v[32:47],a[48:51],v[96:99],0
v_exp_f32 v16,v16
v_exp_f32 v17,v17
v_exp_f32 v18,v18
v_exp_f32 v19,v19
v_cvt_pk_bf16_f32 v48,v16,v17
v_cvt_pk_bf16_f32 v49,v18,v19
v_mfma_f32_32x32x16_bf16 v[32:47],a[52:55],v[100:103],v[32:47]
v_exp_f32 v20,v20
v_exp_f32 v21,v21
v_exp_f32 v22,v22
v_exp_f32 v23,v23
v_cvt_pk_bf16_f32 v50,v20,v21
v_cvt_pk_bf16_f32 v51,v22,v23
v_mfma_f32_32x32x16_bf16 v[152:167],a[56:59],v[56:59],v[152:167]
v_exp_f32 v24,v24
v_exp_f32 v25,v25
v_exp_f32 v26,v26
v_exp_f32 v27,v27
v_cvt_pk_bf16_f32 v52,v24,v25
v_cvt_pk_bf16_f32 v53,v26,v27
v_mfma_f32_32x32x16_bf16 v[152:167],a[60:63],v[60:63],v[152:167]
v_exp_f32 v28,v28
v_exp_f32 v29,v29
v_exp_f32 v30,v30
v_exp_f32 v31,v31
v_cvt_pk_bf16_f32 v54,v28,v29
v_cvt_pk_bf16_f32 v55,v30,v31
v_exp_f32 v32,v32
v_exp_f32 v33,v33
v_exp_f32 v34,v34
v_exp_f32 v35,v35
v_cvt_pk_bf16_f32 v56,v32,v33
v_cvt_pk_bf16_f32 v57,v34,v35
v_exp_f32 v36,v36
v_exp_f32 v37,v37
v_exp_f32 v38,v38
v_exp_f32 v39,v39
v_cvt_pk_bf16_f32 v58,v36,v37
v_cvt_pk_bf16_f32 v59,v38,v39
v_mfma_f32_32x32x16_bf16 v[168:183],a[56:59],v[48:51],v[168:183]
v_exp_f32 v40,v40
v_exp_f32 v41,v41
v_exp_f32 v42,v42
v_exp_f32 v43,v43
v_cvt_pk_bf16_f32 v60,v40,v41
v_cvt_pk_bf16_f32 v61,v42,v43
v_mfma_f32_32x32x16_bf16 v[168:183],a[60:63],v[52:55],v[168:183]
v_exp_f32 v44,v44
v_exp_f32 v45,v45
v_exp_f32 v46,v46
v_exp_f32 v47,v47
v_cvt_pk_bf16_f32 v62,v44,v45
v_cvt_pk_bf16_f32 v63,v46,v47
s_nop 1
v_mfma_f32_32x32x16_bf16 v[184:199],a[56:59],v[56:59],v[184:199]
s_nop 0
v_mfma_f32_32x32x16_bf16 v[184:199],a[60:63],v[60:63],v[184:199]
s_mul_i32 s24,s37,36864
s_add_u32 s24,s24,79691776
s_lshl_b32 s25,s16,10
s_add_u32 s40,s25,s24
s_lshr_b32 s26,s16,3
s_lshl_b32 s26,s26,10
s_add_u32 s24,s24,s26
s_bfe_u32 s26,s16,0x10002
s_lshl_b32 s26,s26,9
s_add_u32 s24,s24,s26
s_and_b32 s26,s16,3
s_lshl_b32 s26,s26,2
s_add_u32 s24,s24,s26
s_add_u32 s38,s24,32768
v_mov_b32 v14,0x80000000
v_cndmask_b32 v14,v2,v14,s[96:97]
s_cmp_eq_u32 s57,0
s_cbranch_scc1 att5_fin
s_mul_i32 s24,s18,24576
s_add_u32 s24,s24,65536
v_add_u32_e64 v12,s24,v2
ds_write_b128 v12,v[120:123] offset:0
ds_write_b128 v12,v[124:127] offset:1024
ds_write_b128 v12,v[128:131] offset:2048
ds_write_b128 v12,v[136:139] offset:3072
ds_write_b128 v12,v[140:143] offset:4096
ds_write_b128 v12,v[144:147] offset:5120
ds_write_b128 v12,v[152:155] offset:6144
ds_write_b128 v12,v[156:159] offset:7168
ds_write_b128 v12,v[160:163] offset:8192
ds_write_b128 v12,v[168:171] offset:9216
ds_write_b128 v12,v[172:175] offset:10240
ds_write_b128 v12,v[176:179] offset:11264
ds_write_b128 v12,v[184:187] offset:12288
ds_write_b128 v12,v[188:191] offset:13312
ds_write_b128 v12,v[192:195] offset:14336
s_waitcnt lgkmcnt(0)
s_barrier
s_xor_b32 s24,s18,1
s_mul_i32 s24,s24,24576
s_add_u32 s24,s24,65536
v_add_u32_e64 v60,s24,v2
s_xor_b32 s24,s18,2
s_mul_i32 s24,s24,24576
s_add_u32 s24,s24,65536
v_add_u32 v61,s24,v2
s_xor_b32 s24,s18,3
s_mul_i32 s24,s24,24576
s_add_u32 s24,s24,65536
v_add_u32_e64 v62,s24,v2
att5_fin:
s_nop 7
s_lshl_b32 s24,1,s57
s_sub_u32 s24,s24,1
s_and_b32 s24,s24,0
s_cmp_lg_u32 s24,s58
s_cbranch_scc1 att5_skip0
s_cmp_eq_u32 s57,0
s_cbranch_scc1 att5_c0
ds_read_b128 v[16:19],v60 offset:0
ds_read_b128 v[20:23],v60 offset:1024
ds_read_b128 v[24:27],v60 offset:2048
s_waitcnt lgkmcnt(0)
v_add_f32 v120,v120,v16
v_add_f32 v121,v121,v17
v_add_f32 v122,v122,v18
v_add_f32 v123,v123,v19
v_add_f32 v124,v124,v20
v_add_f32 v125,v125,v21
v_add_f32 v126,v126,v22
v_add_f32 v127,v127,v23
v_add_f32 v128,v128,v24
v_add_f32 v129,v129,v25
v_add_f32_e64 v130,v130,v26
att5_c0:
s_mov_b64 vcc,exec
v_cmp_le_f32 s[24:25],s44,v130
v_cmp_ge_f32 s[26:27],s45,v130
s_and_b64 vcc,vcc,s[24:25]
s_and_b64 vcc,vcc,s[26:27]
s_cmp_eq_u64 vcc,exec
s_cbranch_scc0 att5_fb0
att5_ok0:
v_rcp_f32 v130,v130
s_nop 0
v_mul_f32 v120,v130,v120
v_mul_f32 v121,v130,v121
v_mul_f32 v122,v130,v122
v_mul_f32 v123,v130,v123
v_mul_f32 v124,v130,v124
v_mul_f32 v125,v130,v125
v_mul_f32 v126,v130,v126
v_mul_f32 v127,v130,v127
v_mul_f32 v128,v130,v128
v_mul_f32 v129,v130,v129
v_cvt_pk_bf16_f32 v132,v120,v121
v_cvt_pk_bf16_f32 v133,v122,v123
v_cvt_pk_bf16_f32 v134,v124,v125
v_cvt_pk_bf16_f32 v135,v126,v127
v_cvt_pk_bf16_f32 v131,v128,v129
buffer_store_dwordx4 v[132:135],v2,s[8:11],s40 offen
buffer_store_dword v131,v14,s[8:11],s38 offen
att5_skip0:
s_add_u32 s40,s40,36864
s_add_u32 s38,s38,36864
s_lshl_b32 s24,1,s57
s_sub_u32 s24,s24,1
s_and_b32 s24,s24,1
s_cmp_lg_u32 s24,s58
s_cbranch_scc1 att5_skip1
s_cmp_eq_u32 s57,0
s_cbranch_scc1 att5_c1
ds_read_b128 v[16:19],v60 offset:3072
ds_read_b128 v[20:23],v60 offset:4096
ds_read_b128 v[24:27],v60 offset:5120
s_waitcnt lgkmcnt(0)
v_add_f32 v136,v136,v16
v_add_f32 v137,v137,v17
v_add_f32 v138,v138,v18
v_add_f32 v139,v139,v19
v_add_f32 v140,v140,v20
v_add_f32 v141,v141,v21
v_add_f32 v142,v142,v22
v_add_f32 v143,v143,v23
v_add_f32 v144,v144,v24
v_add_f32 v145,v145,v25
v_add_f32 v146,v146,v26
att5_c1:
s_mov_b64 vcc,exec
v_cmp_le_f32 s[24:25],s44,v146
v_cmp_ge_f32 s[26:27],s45,v146
s_and_b64 vcc,vcc,s[24:25]
s_and_b64 vcc,vcc,s[26:27]
s_cmp_eq_u64 vcc,exec
s_cbranch_scc0 att5_fb1
att5_ok1:
v_rcp_f32 v146,v146
s_nop 0
v_mul_f32 v136,v146,v136
v_mul_f32 v137,v146,v137
v_mul_f32 v138,v146,v138
v_mul_f32 v139,v146,v139
v_mul_f32 v140,v146,v140
v_mul_f32 v141,v146,v141
v_mul_f32 v142,v146,v142
v_mul_f32 v143,v146,v143
v_mul_f32 v144,v146,v144
v_mul_f32 v145,v146,v145
v_cvt_pk_bf16_f32 v148,v136,v137
v_cvt_pk_bf16_f32 v149,v138,v139
v_cvt_pk_bf16_f32 v150,v140,v141
v_cvt_pk_bf16_f32 v151,v142,v143
v_cvt_pk_bf16_f32 v147,v144,v145
buffer_store_dwordx4 v[148:151],v2,s[8:11],s40 offen
buffer_store_dword v147,v14,s[8:11],s38 offen
att5_skip1:
s_add_u32 s40,s40,36864
s_add_u32 s38,s38,36864
s_lshl_b32 s24,1,s57
s_sub_u32 s24,s24,1
s_and_b32 s24,s24,2
s_cmp_lg_u32 s24,s58
s_cbranch_scc1 att5_skip2
s_cmp_eq_u32 s57,0
s_cbranch_scc1 att5_c2
ds_read_b128 v[16:19],v60 offset:6144
ds_read_b128 v[20:23],v60 offset:7168
ds_read_b128 v[24:27],v60 offset:8192
s_waitcnt lgkmcnt(0)
v_add_f32 v152,v152,v16
v_add_f32 v153,v153,v17
v_add_f32 v154,v154,v18
v_add_f32 v155,v155,v19
v_add_f32 v156,v156,v20
v_add_f32 v157,v157,v21
v_add_f32 v158,v158,v22
v_add_f32 v159,v159,v23
v_add_f32 v160,v160,v24
v_add_f32 v161,v161,v25
v_add_f32 v162,v162,v26
att5_c2:
s_mov_b64 vcc,exec
v_cmp_le_f32 s[24:25],s44,v162
v_cmp_ge_f32 s[26:27],s45,v162
s_and_b64 vcc,vcc,s[24:25]
s_and_b64 vcc,vcc,s[26:27]
s_cmp_eq_u64 vcc,exec
s_cbranch_scc0 att5_fb2
att5_ok2:
v_rcp_f32 v162,v162
s_nop 0
v_mul_f32 v152,v162,v152
v_mul_f32 v153,v162,v153
v_mul_f32 v154,v162,v154
v_mul_f32 v155,v162,v155
v_mul_f32 v156,v162,v156
v_mul_f32 v157,v162,v157
v_mul_f32 v158,v162,v158
v_mul_f32 v159,v162,v159
v_mul_f32 v160,v162,v160
v_mul_f32 v161,v162,v161
v_cvt_pk_bf16_f32 v164,v152,v153
v_cvt_pk_bf16_f32 v165,v154,v155
v_cvt_pk_bf16_f32 v166,v156,v157
v_cvt_pk_bf16_f32 v167,v158,v159
v_cvt_pk_bf16_f32 v163,v160,v161
buffer_store_dwordx4 v[164:167],v2,s[8:11],s40 offen
buffer_store_dword v163,v14,s[8:11],s38 offen
att5_skip2:
s_add_u32 s40,s40,36864
s_add_u32 s38,s38,36864
s_lshl_b32 s24,1,s57
s_sub_u32 s24,s24,1
s_and_b32 s24,s24,3
s_cmp_lg_u32 s24,s58
s_cbranch_scc1 att5_skip3
s_cmp_eq_u32 s57,0
s_cbranch_scc1 att5_c3
ds_read_b128 v[16:19],v60 offset:9216
ds_read_b128 v[20:23],v60 offset:10240
ds_read_b128 v[24:27],v60 offset:11264
s_waitcnt lgkmcnt(0)
v_add_f32 v168,v168,v16
v_add_f32 v169,v169,v17
v_add_f32 v170,v170,v18
v_add_f32 v171,v171,v19
v_add_f32 v172,v172,v20
v_add_f32 v173,v173,v21
v_add_f32 v174,v174,v22
v_add_f32 v175,v175,v23
v_add_f32 v176,v176,v24
v_add_f32 v177,v177,v25
v_add_f32 v178,v178,v26
att5_c3:
s_mov_b64 vcc,exec
v_cmp_le_f32 s[24:25],s44,v178
v_cmp_ge_f32 s[26:27],s45,v178
s_and_b64 vcc,vcc,s[24:25]
s_and_b64 vcc,vcc,s[26:27]
s_cmp_eq_u64 vcc,exec
s_cbranch_scc0 att5_fb3
att5_ok3:
v_rcp_f32 v178,v178
s_nop 0
v_mul_f32 v168,v178,v168
v_mul_f32 v169,v178,v169
v_mul_f32 v170,v178,v170
v_mul_f32 v171,v178,v171
v_mul_f32 v172,v178,v172
v_mul_f32 v173,v178,v173
v_mul_f32 v174,v178,v174
v_mul_f32 v175,v178,v175
v_mul_f32 v176,v178,v176
v_mul_f32 v177,v178,v177
v_cvt_pk_bf16_f32 v180,v168,v169
v_cvt_pk_bf16_f32 v181,v170,v171
v_cvt_pk_bf16_f32 v182,v172,v173
v_cvt_pk_bf16_f32 v183,v174,v175
v_cvt_pk_bf16_f32 v179,v176,v177
buffer_store_dwordx4 v[180:183],v2,s[8:11],s40 offen
buffer_store_dword v179,v14,s[8:11],s38 offen
att5_skip3:
s_add_u32 s40,s40,36864
s_add_u32 s38,s38,36864
s_lshl_b32 s24,1,s57
s_sub_u32 s24,s24,1
s_and_b32 s24,s24,4
s_cmp_lg_u32 s24,s58
s_cbranch_scc1 att5_skip4
s_cmp_eq_u32 s57,0
s_cbranch_scc1 att5_c4
ds_read_b128 v[16:19],v60 offset:12288
ds_read_b128 v[20:23],v60 offset:13312
ds_read_b128 v[24:27],v60 offset:14336
s_waitcnt lgkmcnt(0)
v_add_f32 v184,v184,v16
v_add_f32 v185,v185,v17
v_add_f32 v186,v186,v18
v_add_f32 v187,v187,v19
v_add_f32 v188,v188,v20
v_add_f32 v189,v189,v21
v_add_f32 v190,v190,v22
v_add_f32 v191,v191,v23
v_add_f32 v192,v192,v24
v_add_f32 v193,v193,v25
v_add_f32 v194,v194,v26
att5_c4:
s_mov_b64 vcc,exec
v_cmp_le_f32 s[24:25],s44,v194
v_cmp_ge_f32 s[26:27],s45,v194
s_and_b64 vcc,vcc,s[24:25]
s_and_b64 vcc,vcc,s[26:27]
s_cmp_eq_u64 vcc,exec
s_cbranch_scc0 att5_fb4
att5_ok4:
v_rcp_f32 v194,v194
s_nop 0
v_mul_f32 v184,v194,v184
v_mul_f32 v185,v194,v185
v_mul_f32 v186,v194,v186
v_mul_f32 v187,v194,v187
v_mul_f32 v188,v194,v188
v_mul_f32 v189,v194,v189
v_mul_f32 v190,v194,v190
v_mul_f32 v191,v194,v191
v_mul_f32 v192,v194,v192
v_mul_f32 v193,v194,v193
v_cvt_pk_bf16_f32 v196,v184,v185
v_cvt_pk_bf16_f32 v197,v186,v187
v_cvt_pk_bf16_f32 v198,v188,v189
v_cvt_pk_bf16_f32 v199,v190,v191
v_cvt_pk_bf16_f32 v195,v192,v193
buffer_store_dwordx4 v[196:199],v2,s[8:11],s40 offen
buffer_store_dword v195,v14,s[8:11],s38 offen
att5_skip4:
s_add_u32 s40,s40,36864
s_add_u32 s38,s38,36864
s_cmp_eq_u32 s57,0
s_cbranch_scc1 k2_B
s_barrier
s_branch k2_B
att7:
v_accvgpr_write_b32 a5,v13
v_accvgpr_write_b32 a6,0
v_accvgpr_write_b32 a7,0
v_accvgpr_write_b32 a21,v13
v_accvgpr_write_b32 a22,0
v_accvgpr_write_b32 a23,0
v_accvgpr_write_b32 a37,v13
v_accvgpr_write_b32 a38,0
v_accvgpr_write_b32 a39,0
v_accvgpr_write_b32 a53,v13
v_accvgpr_write_b32 a54,0
v_accvgpr_write_b32 a55,0
v_mov_b32 v69,0
v_mov_b32 v70,0
v_mov_b32 v71,0
v_mov_b32 v77,0
v_mov_b32 v78,0
v_mov_b32 v79,0
v_mov_b32 v85,0
v_mov_b32 v86,0
v_mov_b32 v87,0
v_mov_b32 v93,0
v_mov_b32 v94,0
v_mov_b32 v95,0
v_mov_b32 v101,0
v_mov_b32 v102,0
v_mov_b32 v103,0
v_mov_b32 v109,0
v_mov_b32 v110,0
v_mov_b32 v111,0
v_mov_b32 v117,0
v_mov_b32 v118,0
v_mov_b32 v119,0
v_mov_b32 v48,0
v_mov_b32 v49,0
v_mov_b32 v50,0
v_mov_b32 v51,0
v_mov_b32 v52,0
v_mov_b32 v53,0
v_mov_b32 v54,0
v_mov_b32 v55,0
v_mov_b32 v56,0
v_mov_b32 v57,0
v_mov_b32 v58,0
v_mov_b32 v59,0
v_mov_b32 v60,0
v_mov_b32 v61,0
v_mov_b32 v62,0
v_mov_b32 v63,0
s_nop 1
v_mfma_f32_32x32x16_bf16 v[120:135],v[48:51],v[48:51],0
v_mfma_f32_32x32x16_bf16 v[136:151],v[48:51],v[48:51],0
v_mfma_f32_32x32x16_bf16 v[152:167],v[48:51],v[48:51],0
v_mfma_f32_32x32x16_bf16 v[168:183],v[48:51],v[48:51],0
v_mfma_f32_32x32x16_bf16 v[184:199],v[48:51],v[48:51],0
v_mfma_f32_32x32x16_bf16 v[200:215],v[48:51],v[48:51],0
v_mfma_f32_32x32x16_bf16 v[216:231],v[48:51],v[48:51],0
v_accvgpr_write_b32 a56,0
v_accvgpr_write_b32 a57,0
v_accvgpr_write_b32 a58,0
v_accvgpr_write_b32 a59,0
v_accvgpr_write_b32 a60,0
v_accvgpr_write_b32 a61,0
v_accvgpr_write_b32 a62,0
v_accvgpr_write_b32 a63,0
s_waitcnt vmcnt(17)
v_cndmask_b32 v68,v68,0,s[96:97]
v_cndmask_b32 v76,v76,0,s[96:97]
v_cndmask_b32 v84,v84,0,s[96:97]
v_cndmask_b32 v92,v92,0,s[96:97]
v_cndmask_b32 v100,v100,0,s[96:97]
v_cndmask_b32 v108,v108,0,s[96:97]
v_cndmask_b32 v116,v116,0,s[96:97]
s_nop 0
v_mfma_f32_32x32x16_bf16 v[16:31],a[48:51],v[64:67],0
v_mfma_f32_32x32x16_bf16 v[16:31],a[52:55],v[68:71],v[16:31]
v_mfma_f32_32x32x16_bf16 v[32:47],a[48:51],v[72:75],0
v_mfma_f32_32x32x16_bf16 v[32:47],a[52:55],v[76:79],v[32:47]
s_nop 9
v_max_f32 v10,v16,v17
v_max3_f32 v10,v10,v18,v19
v_max3_f32 v10,v10,v20,v21
v_max3_f32 v10,v10,v22,v23
v_max3_f32 v10,v10,v24,v25
v_max3_f32 v10,v10,v26,v27
v_max3_f32 v10,v10,v28,v29
v_max3_f32 v10,v10,v30,v31
v_mov_b32 v12,v10
s_nop 1
v_permlane32_swap_b32 v10,v12
v_max_f32 v10,v10,v12
v_sub_f32_e64 v10,0,v10
v_cvt_pk_bf16_f32 v10,v10,0
v_cndmask_b32 v69,v10,0,s[96:97]
v_mfma_f32_32x32x16_bf16 v[16:31],a[48:51],v[80:83],0
v_mfma_f32_32x32x16_bf16 v[16:31],a[52:55],v[84:87],v[16:31]
v_max_f32_e64 v10,v32,v33
v_max3_f32 v10,v10,v34,v35
v_max3_f32 v10,v10,v36,v37
v_max3_f32 v10,v10,v38,v39
v_max3_f32 v10,v10,v40,v41
v_max3_f32 v10,v10,v42,v43
v_max3_f32 v10,v10,v44,v45
v_max3_f32 v10,v10,v46,v47
v_mov_b32 v12,v10
s_nop 1
v_permlane32_swap_b32 v10,v12
v_max_f32 v10,v10,v12
v_sub_f32_e64 v10,0,v10
v_cvt_pk_bf16_f32 v10,v10,0
v_cndmask_b32 v77,v10,0,s[96:97]
v_mfma_f32_32x32x16_bf16 v[32:47],a[48:51],v[88:91],0
v_mfma_f32_32x32x16_bf16 v[32:47],a[52:55],v[92:95],v[32:47]
v_max_f32_e64 v10,v16,v17
v_max3_f32 v10,v10,v18,v19
v_max3_f32 v10,v10,v20,v21
v_max3_f32 v10,v10,v22,v23
v_max3_f32 v10,v10,v24,v25
v_max3_f32 v10,v10,v26,v27
v_max3_f32 v10,v10,v28,v29
v_max3_f32 v10,v10,v30,v31
v_mov_b32 v12,v10
s_nop 1
v_permlane32_swap_b32 v10,v12
v_max_f32 v10,v10,v12
v_sub_f32_e64 v10,0,v10
v_cvt_pk_bf16_f32 v10,v10,0
v_cndmask_b32 v85,v10,0,s[96:97]
v_mfma_f32_32x32x16_bf16 v[16:31],a[48:51],v[96:99],0
v_mfma_f32_32x32x16_bf16 v[16:31],a[52:55],v[100:103],v[16:31]
v_max_f32_e64 v10,v32,v33
v_max3_f32 v10,v10,v34,v35
v_max3_f32 v10,v10,v36,v37
v_max3_f32 v10,v10,v38,v39
v_max3_f32 v10,v10,v40,v41
v_max3_f32 v10,v10,v42,v43
v_max3_f32 v10,v10,v44,v45
v_max3_f32 v10,v10,v46,v47
v_mov_b32 v12,v10
s_nop 1
v_permlane32_swap_b32 v10,v12
v_max_f32 v10,v10,v12
v_sub_f32_e64 v10,0,v10
v_cvt_pk_bf16_f32 v10,v10,0
v_cndmask_b32 v93,v10,0,s[96:97]
v_mfma_f32_32x32x16_bf16 v[32:47],a[48:51],v[104:107],0
v_mfma_f32_32x32x16_bf16 v[32:47],a[52:55],v[108:111],v[32:47]
v_max_f32_e64 v10,v16,v17
v_max3_f32 v10,v10,v18,v19
v_max3_f32 v10,v10,v20,v21
v_max3_f32 v10,v10,v22,v23
v_max3_f32 v10,v10,v24,v25
v_max3_f32 v10,v10,v26,v27
v_max3_f32 v10,v10,v28,v29
v_max3_f32 v10,v10,v30,v31
v_mov_b32 v12,v10
s_nop 1
v_permlane32_swap_b32 v10,v12
v_max_f32 v10,v10,v12
v_sub_f32_e64 v10,0,v10
v_cvt_pk_bf16_f32 v10,v10,0
v_cndmask_b32 v101,v10,0,s[96:97]
v_mfma_f32_32x32x16_bf16 v[16:31],a[48:51],v[112:115],0
v_mfma_f32_32x32x16_bf16 v[16:31],a[52:55],v[116:119],v[16:31]
v_max_f32_e64 v10,v32,v33
v_max3_f32 v10,v10,v34,v35
v_max3_f32 v10,v10,v36,v37
v_max3_f32 v10,v10,v38,v39
v_max3_f32 v10,v10,v40,v41
v_max3_f32 v10,v10,v42,v43
v_max3_f32 v10,v10,v44,v45
v_max3_f32 v10,v10,v46,v47
v_mov_b32 v12,v10
s_nop 1
v_permlane32_swap_b32 v10,v12
v_max_f32 v10,v10,v12
v_sub_f32_e64 v10,0,v10
v_cvt_pk_bf16_f32 v10,v10,0
v_cndmask_b32 v109,v10,0,s[96:97]
v_max_f32_e64 v10,v16,v17
v_max3_f32 v10,v10,v18,v19
v_max3_f32 v10,v10,v20,v21
v_max3_f32 v10,v10,v22,v23
v_max3_f32 v10,v10,v24,v25
v_max3_f32 v10,v10,v26,v27
v_max3_f32 v10,v10,v28,v29
v_max3_f32 v10,v10,v30,v31
v_mov_b32 v12,v10
s_nop 1
v_permlane32_swap_b32 v10,v12
v_max_f32 v10,v10,v12
v_sub_f32_e64 v10,0,v10
v_cvt_pk_bf16_f32 v10,v10,0
v_cndmask_b32 v117,v10,0,s[96:97]
s_mov_b32 s39,s60
s_waitcnt vmcnt(13)
v_mfma_f32_32x32x16_bf16 v[16:31],a[0:3],v[64:67],0
v_mfma_f32_32x32x16_bf16 v[16:31],a[4:7],v[68:71],v[16:31]
s_nop 9
s_sub_u32 s39,s39,1
att7_loop:
v_mfma_f32_32x32x16_bf16 v[32:47],a[0:3],v[72:75],0
buffer_load_dwordx4 a[48:51],v2,s[8:11],s41 offen
v_exp_f32 v16,v16
v_exp_f32 v17,v17
v_exp_f32 v18,v18
v_exp_f32 v19,v19
v_cvt_pk_bf16_f32 v48,v16,v17
v_cvt_pk_bf16_f32 v49,v18,v19
v_mfma_f32_32x32x16_bf16 v[32:47],a[4:7],v[76:79],v[32:47]
buffer_load_dword a52,v7,s[52:55],s41 offen offset:3072
v_exp_f32 v20,v20
v_exp_f32 v21,v21
v_exp_f32 v22,v22
v_exp_f32 v23,v23
v_cvt_pk_bf16_f32 v50,v20,v21
v_cvt_pk_bf16_f32 v51,v22,v23
v_mfma_f32_32x32x16_bf16 v[216:231],a[56:59],v[56:59],v[216:231]
v_exp_f32 v24,v24
v_exp_f32 v25,v25
v_exp_f32 v26,v26
v_exp_f32 v27,v27
v_cvt_pk_bf16_f32 v52,v24,v25
v_cvt_pk_bf16_f32 v53,v26,v27
v_mfma_f32_32x32x16_bf16 v[216:231],a[60:63],v[60:63],v[216:231]
buffer_load_dwordx4 a[56:59],v248,s[8:11],s41 offen offset:1024
v_exp_f32 v28,v28
v_exp_f32 v29,v29
v_exp_f32 v30,v30
v_exp_f32 v31,v31
v_cvt_pk_bf16_f32 v54,v28,v29
v_cvt_pk_bf16_f32 v55,v30,v31
v_mfma_f32_32x32x16_bf16 v[16:31],a[0:3],v[80:83],0
buffer_load_dwordx4 a[60:63],v248,s[8:11],s41 offen offset:2048
s_add_u32 s41,s41,4096
v_exp_f32 v32,v32
v_exp_f32 v33,v33
v_exp_f32 v34,v34
v_exp_f32 v35,v35
v_cvt_pk_bf16_f32 v56,v32,v33
v_cvt_pk_bf16_f32 v57,v34,v35
v_mfma_f32_32x32x16_bf16 v[16:31],a[4:7],v[84:87],v[16:31]
v_exp_f32 v36,v36
v_exp_f32 v37,v37
v_exp_f32 v38,v38
v_exp_f32 v39,v39
v_cvt_pk_bf16_f32 v58,v36,v37
v_cvt_pk_bf16_f32 v59,v38,v39
v_mfma_f32_32x32x16_bf16 v[120:135],a[8:11],v[48:51],v[120:135]
v_exp_f32 v40,v40
v_exp_f32 v41,v41
v_exp_f32 v42,v42
v_exp_f32 v43,v43
v_cvt_pk_bf16_f32 v60,v40,v41
v_cvt_pk_bf16_f32 v61,v42,v43
v_mfma_f32_32x32x16_bf16 v[120:135],a[12:15],v[52:55],v[120:135]
v_exp_f32 v44,v44
v_exp_f32 v45,v45
v_exp_f32 v46,v46
v_exp_f32 v47,v47
v_cvt_pk_bf16_f32 v62,v44,v45
v_cvt_pk_bf16_f32 v63,v46,v47
v_mfma_f32_32x32x16_bf16 v[32:47],a[0:3],v[88:91],0
v_exp_f32 v16,v16
v_exp_f32 v17,v17
v_exp_f32 v18,v18
v_exp_f32 v19,v19
v_cvt_pk_bf16_f32 v48,v16,v17
v_cvt_pk_bf16_f32 v49,v18,v19
v_mfma_f32_32x32x16_bf16 v[32:47],a[4:7],v[92:95],v[32:47]
v_exp_f32 v20,v20
v_exp_f32 v21,v21
v_exp_f32 v22,v22
v_exp_f32 v23,v23
v_cvt_pk_bf16_f32 v50,v20,v21
v_cvt_pk_bf16_f32 v51,v22,v23
v_mfma_f32_32x32x16_bf16 v[136:151],a[8:11],v[56:59],v[136:151]
v_exp_f32 v24,v24
v_exp_f32 v25,v25
v_exp_f32 v26,v26
v_exp_f32 v27,v27
v_cvt_pk_bf16_f32 v52,v24,v25
v_cvt_pk_bf16_f32 v53,v26,v27
v_mfma_f32_32x32x16_bf16 v[136:151],a[12:15],v[60:63],v[136:151]
v_exp_f32 v28,v28
v_exp_f32 v29,v29
v_exp_f32 v30,v30
v_exp_f32 v31,v31
v_cvt_pk_bf16_f32 v54,v28,v29
v_cvt_pk_bf16_f32 v55,v30,v31
v_mfma_f32_32x32x16_bf16 v[16:31],a[0:3],v[96:99],0
v_exp_f32 v32,v32
v_exp_f32 v33,v33
v_exp_f32 v34,v34
v_exp_f32 v35,v35
v_cvt_pk_bf16_f32 v56,v32,v33
v_cvt_pk_bf16_f32 v57,v34,v35
v_mfma_f32_32x32x16_bf16 v[16:31],a[4:7],v[100:103],v[16:31]
v_exp_f32 v36,v36
v_exp_f32 v37,v37
v_exp_f32 v38,v38
v_exp_f32 v39,v39
v_cvt_pk_bf16_f32 v58,v36,v37
v_cvt_pk_bf16_f32 v59,v38,v39
v_mfma_f32_32x32x16_bf16 v[152:167],a[8:11],v[48:51],v[152:167]
v_exp_f32 v40,v40
v_exp_f32 v41,v41
v_exp_f32 v42,v42
v_exp_f32 v43,v43
v_cvt_pk_bf16_f32 v60,v40,v41
v_cvt_pk_bf16_f32 v61,v42,v43
v_mfma_f32_32x32x16_bf16 v[152:167],a[12:15],v[52:55],v[152:167]
v_exp_f32 v44,v44
v_exp_f32 v45,v45
v_exp_f32 v46,v46
v_exp_f32 v47,v47
v_cvt_pk_bf16_f32 v62,v44,v45
v_cvt_pk_bf16_f32 v63,v46,v47
v_mfma_f32_32x32x16_bf16 v[32:47],a[0:3],v[104:107],0
v_exp_f32 v16,v16
v_exp_f32 v17,v17
v_exp_f32 v18,v18
v_exp_f32 v19,v19
v_cvt_pk_bf16_f32 v48,v16,v17
v_cvt_pk_bf16_f32 v49,v18,v19
v_mfma_f32_32x32x16_bf16 v[32:47],a[4:7],v[108:111],v[32:47]
v_exp_f32 v20,v20
v_exp_f32 v21,v21
v_exp_f32 v22,v22
v_exp_f32 v23,v23
v_cvt_pk_bf16_f32 v50,v20,v21
v_cvt_pk_bf16_f32 v51,v22,v23
v_mfma_f32_32x32x16_bf16 v[168:183],a[8:11],v[56:59],v[168:183]
v_exp_f32 v24,v24
v_exp_f32 v25,v25
v_exp_f32 v26,v26
v_exp_f32 v27,v27
v_cvt_pk_bf16_f32 v52,v24,v25
v_cvt_pk_bf16_f32 v53,v26,v27
v_mfma_f32_32x32x16_bf16 v[168:183],a[12:15],v[60:63],v[168:183]
v_exp_f32 v28,v28
v_exp_f32 v29,v29
v_exp_f32 v30,v30
v_exp_f32 v31,v31
v_cvt_pk_bf16_f32 v54,v28,v29
v_cvt_pk_bf16_f32 v55,v30,v31
v_mfma_f32_32x32x16_bf16 v[16:31],a[0:3],v[112:115],0
v_exp_f32 v32,v32
v_exp_f32 v33,v33
v_exp_f32 v34,v34
v_exp_f32 v35,v35
v_cvt_pk_bf16_f32 v56,v32,v33
v_cvt_pk_bf16_f32 v57,v34,v35
v_mfma_f32_32x32x16_bf16 v[16:31],a[4:7],v[116:119],v[16:31]
v_exp_f32 v36,v36
v_exp_f32 v37,v37
v_exp_f32 v38,v38
v_exp_f32 v39,v39
v_cvt_pk_bf16_f32 v58,v36,v37
v_cvt_pk_bf16_f32 v59,v38,v39
v_mfma_f32_32x32x16_bf16 v[184:199],a[8:11],v[48:51],v[184:199]
v_exp_f32 v40,v40
v_exp_f32 v41,v41
v_exp_f32 v42,v42
v_exp_f32 v43,v43
v_cvt_pk_bf16_f32 v60,v40,v41
v_cvt_pk_bf16_f32 v61,v42,v43
v_mfma_f32_32x32x16_bf16 v[184:199],a[12:15],v[52:55],v[184:199]
v_exp_f32 v44,v44
v_exp_f32 v45,v45
v_exp_f32 v46,v46
v_exp_f32 v47,v47
v_cvt_pk_bf16_f32 v62,v44,v45
v_cvt_pk_bf16_f32 v63,v46,v47
s_waitcnt vmcnt(8)
v_mfma_f32_32x32x16_bf16 v[32:47],a[16:19],v[64:67],0
v_exp_f32 v16,v16
v_exp_f32 v17,v17
v_exp_f32 v18,v18
v_exp_f32_e64 v19,v19
v_cvt_pk_bf16_f32 v48,v16,v17
v_cvt_pk_bf16_f32 v49,v18,v19
v_mfma_f32_32x32x16_bf16 v[32:47],a[20:23],v[68:71],v[32:47]
v_exp_f32 v20,v20
v_exp_f32 v21,v21
v_exp_f32 v22,v22
v_exp_f32 v23,v23
v_cvt_pk_bf16_f32 v50,v20,v21
v_cvt_pk_bf16_f32 v51,v22,v23
v_mfma_f32_32x32x16_bf16 v[200:215],a[8:11],v[56:59],v[200:215]
v_exp_f32 v24,v24
v_exp_f32 v25,v25
v_exp_f32 v26,v26
v_exp_f32 v27,v27
v_cvt_pk_bf16_f32 v52,v24,v25
v_cvt_pk_bf16_f32 v53,v26,v27
v_mfma_f32_32x32x16_bf16 v[200:215],a[12:15],v[60:63],v[200:215]
v_exp_f32 v28,v28
v_exp_f32 v29,v29
v_exp_f32 v30,v30
v_exp_f32 v31,v31
v_cvt_pk_bf16_f32 v54,v28,v29
v_cvt_pk_bf16_f32 v55,v30,v31
v_mfma_f32_32x32x16_bf16 v[16:31],a[16:19],v[72:75],0
buffer_load_dwordx4 a[0:3],v2,s[8:11],s41 offen
v_exp_f32 v32,v32
v_exp_f32 v33,v33
v_exp_f32 v34,v34
v_exp_f32 v35,v35
v_cvt_pk_bf16_f32 v56,v32,v33
v_cvt_pk_bf16_f32 v57,v34,v35
v_mfma_f32_32x32x16_bf16 v[16:31],a[20:23],v[76:79],v[16:31]
buffer_load_dword a4,v7,s[52:55],s41 offen offset:3072
v_exp_f32 v36,v36
v_exp_f32 v37,v37
v_exp_f32 v38,v38
v_exp_f32 v39,v39
v_cvt_pk_bf16_f32 v58,v36,v37
v_cvt_pk_bf16_f32 v59,v38,v39
v_mfma_f32_32x32x16_bf16 v[216:231],a[8:11],v[48:51],v[216:231]
v_exp_f32 v40,v40
v_exp_f32 v41,v41
v_exp_f32 v42,v42
v_exp_f32 v43,v43
v_cvt_pk_bf16_f32 v60,v40,v41
v_cvt_pk_bf16_f32 v61,v42,v43
v_mfma_f32_32x32x16_bf16 v[216:231],a[12:15],v[52:55],v[216:231]
buffer_load_dwordx4 a[8:11],v248,s[8:11],s41 offen offset:1024
v_exp_f32 v44,v44
v_exp_f32 v45,v45
v_exp_f32 v46,v46
v_exp_f32 v47,v47
v_cvt_pk_bf16_f32 v62,v44,v45
v_cvt_pk_bf16_f32 v63,v46,v47
v_mfma_f32_32x32x16_bf16 v[32:47],a[16:19],v[80:83],0
buffer_load_dwordx4 a[12:15],v248,s[8:11],s41 offen offset:2048
s_add_u32 s41,s41,4096
v_exp_f32 v16,v16
v_exp_f32 v17,v17
v_exp_f32 v18,v18
v_exp_f32 v19,v19
v_cvt_pk_bf16_f32 v48,v16,v17
v_cvt_pk_bf16_f32 v49,v18,v19
v_mfma_f32_32x32x16_bf16 v[32:47],a[20:23],v[84:87],v[32:47]
v_exp_f32 v20,v20
v_exp_f32 v21,v21
v_exp_f32 v22,v22
v_exp_f32 v23,v23
v_cvt_pk_bf16_f32 v50,v20,v21
v_cvt_pk_bf16_f32 v51,v22,v23
v_mfma_f32_32x32x16_bf16 v[120:135],a[24:27],v[56:59],v[120:135]
v_exp_f32 v24,v24
v_exp_f32 v25,v25
v_exp_f32 v26,v26
v_exp_f32 v27,v27
v_cvt_pk_bf16_f32 v52,v24,v25
v_cvt_pk_bf16_f32 v53,v26,v27
v_mfma_f32_32x32x16_bf16 v[120:135],a[28:31],v[60:63],v[120:135]
v_exp_f32 v28,v28
v_exp_f32 v29,v29
v_exp_f32 v30,v30
v_exp_f32 v31,v31
v_cvt_pk_bf16_f32 v54,v28,v29
v_cvt_pk_bf16_f32 v55,v30,v31
v_mfma_f32_32x32x16_bf16 v[16:31],a[16:19],v[88:91],0
v_exp_f32 v32,v32
v_exp_f32 v33,v33
v_exp_f32 v34,v34
v_exp_f32 v35,v35
v_cvt_pk_bf16_f32 v56,v32,v33
v_cvt_pk_bf16_f32 v57,v34,v35
v_mfma_f32_32x32x16_bf16 v[16:31],a[20:23],v[92:95],v[16:31]
v_exp_f32 v36,v36
v_exp_f32 v37,v37
v_exp_f32 v38,v38
v_exp_f32 v39,v39
v_cvt_pk_bf16_f32 v58,v36,v37
v_cvt_pk_bf16_f32 v59,v38,v39
v_mfma_f32_32x32x16_bf16 v[136:151],a[24:27],v[48:51],v[136:151]
v_exp_f32 v40,v40
v_exp_f32 v41,v41
v_exp_f32 v42,v42
v_exp_f32 v43,v43
v_cvt_pk_bf16_f32 v60,v40,v41
v_cvt_pk_bf16_f32 v61,v42,v43
v_mfma_f32_32x32x16_bf16 v[136:151],a[28:31],v[52:55],v[136:151]
v_exp_f32 v44,v44
v_exp_f32 v45,v45
v_exp_f32 v46,v46
v_exp_f32 v47,v47
v_cvt_pk_bf16_f32 v62,v44,v45
v_cvt_pk_bf16_f32 v63,v46,v47
v_mfma_f32_32x32x16_bf16 v[32:47],a[16:19],v[96:99],0
v_exp_f32 v16,v16
v_exp_f32 v17,v17
v_exp_f32 v18,v18
v_exp_f32 v19,v19
v_cvt_pk_bf16_f32 v48,v16,v17
v_cvt_pk_bf16_f32 v49,v18,v19
v_mfma_f32_32x32x16_bf16 v[32:47],a[20:23],v[100:103],v[32:47]
v_exp_f32 v20,v20
v_exp_f32 v21,v21
v_exp_f32 v22,v22
v_exp_f32 v23,v23
v_cvt_pk_bf16_f32 v50,v20,v21
v_cvt_pk_bf16_f32 v51,v22,v23
v_mfma_f32_32x32x16_bf16 v[152:167],a[24:27],v[56:59],v[152:167]
v_exp_f32 v24,v24
v_exp_f32 v25,v25
v_exp_f32 v26,v26
v_exp_f32 v27,v27
v_cvt_pk_bf16_f32 v52,v24,v25
v_cvt_pk_bf16_f32 v53,v26,v27
v_mfma_f32_32x32x16_bf16 v[152:167],a[28:31],v[60:63],v[152:167]
v_exp_f32 v28,v28
v_exp_f32 v29,v29
v_exp_f32 v30,v30
v_exp_f32 v31,v31
v_cvt_pk_bf16_f32 v54,v28,v29
v_cvt_pk_bf16_f32 v55,v30,v31
v_mfma_f32_32x32x16_bf16 v[16:31],a[16:19],v[104:107],0
v_exp_f32 v32,v32
v_exp_f32 v33,v33
v_exp_f32 v34,v34
v_exp_f32 v35,v35
v_cvt_pk_bf16_f32 v56,v32,v33
v_cvt_pk_bf16_f32 v57,v34,v35
v_mfma_f32_32x32x16_bf16 v[16:31],a[20:23],v[108:111],v[16:31]
v_exp_f32 v36,v36
v_exp_f32 v37,v37
v_exp_f32 v38,v38
v_exp_f32 v39,v39
v_cvt_pk_bf16_f32 v58,v36,v37
v_cvt_pk_bf16_f32 v59,v38,v39
v_mfma_f32_32x32x16_bf16 v[168:183],a[24:27],v[48:51],v[168:183]
v_exp_f32 v40,v40
v_exp_f32 v41,v41
v_exp_f32 v42,v42
v_exp_f32 v43,v43
v_cvt_pk_bf16_f32 v60,v40,v41
v_cvt_pk_bf16_f32 v61,v42,v43
v_mfma_f32_32x32x16_bf16 v[168:183],a[28:31],v[52:55],v[168:183]
v_exp_f32 v44,v44
v_exp_f32 v45,v45
v_exp_f32 v46,v46
v_exp_f32 v47,v47
v_cvt_pk_bf16_f32 v62,v44,v45
v_cvt_pk_bf16_f32 v63,v46,v47
v_mfma_f32_32x32x16_bf16 v[32:47],a[16:19],v[112:115],0
v_exp_f32 v16,v16
v_exp_f32 v17,v17
v_exp_f32 v18,v18
v_exp_f32 v19,v19
v_cvt_pk_bf16_f32 v48,v16,v17
v_cvt_pk_bf16_f32 v49,v18,v19
v_mfma_f32_32x32x16_bf16 v[32:47],a[20:23],v[116:119],v[32:47]
v_exp_f32 v20,v20
v_exp_f32 v21,v21
v_exp_f32 v22,v22
v_exp_f32 v23,v23
v_cvt_pk_bf16_f32 v50,v20,v21
v_cvt_pk_bf16_f32 v51,v22,v23
v_mfma_f32_32x32x16_bf16 v[184:199],a[24:27],v[56:59],v[184:199]
v_exp_f32 v24,v24
v_exp_f32 v25,v25
v_exp_f32 v26,v26
v_exp_f32 v27,v27
v_cvt_pk_bf16_f32 v52,v24,v25
v_cvt_pk_bf16_f32 v53,v26,v27
v_mfma_f32_32x32x16_bf16 v[184:199],a[28:31],v[60:63],v[184:199]
v_exp_f32 v28,v28
v_exp_f32 v29,v29
v_exp_f32 v30,v30
v_exp_f32 v31,v31
v_cvt_pk_bf16_f32 v54,v28,v29
v_cvt_pk_bf16_f32 v55,v30,v31
s_waitcnt vmcnt(8)
v_mfma_f32_32x32x16_bf16 v[16:31],a[32:35],v[64:67],0
v_exp_f32 v32,v32
v_exp_f32 v33,v33
v_exp_f32 v34,v34
v_exp_f32_e64 v35,v35
v_cvt_pk_bf16_f32 v56,v32,v33
v_cvt_pk_bf16_f32 v57,v34,v35
v_mfma_f32_32x32x16_bf16 v[16:31],a[36:39],v[68:71],v[16:31]
v_exp_f32 v36,v36
v_exp_f32 v37,v37
v_exp_f32 v38,v38
v_exp_f32 v39,v39
v_cvt_pk_bf16_f32 v58,v36,v37
v_cvt_pk_bf16_f32 v59,v38,v39
v_mfma_f32_32x32x16_bf16 v[200:215],a[24:27],v[48:51],v[200:215]
v_exp_f32 v40,v40
v_exp_f32 v41,v41
v_exp_f32 v42,v42
v_exp_f32 v43,v43
v_cvt_pk_bf16_f32 v60,v40,v41
v_cvt_pk_bf16_f32 v61,v42,v43
v_mfma_f32_32x32x16_bf16 v[200:215],a[28:31],v[52:55],v[200:215]
v_exp_f32 v44,v44
v_exp_f32 v45,v45
v_exp_f32 v46,v46
v_exp_f32 v47,v47
v_cvt_pk_bf16_f32 v62,v44,v45
v_cvt_pk_bf16_f32 v63,v46,v47
v_mfma_f32_32x32x16_bf16 v[32:47],a[32:35],v[72:75],0
buffer_load_dwordx4 a[16:19],v2,s[8:11],s41 offen
v_exp_f32 v16,v16
v_exp_f32 v17,v17
v_exp_f32 v18,v18
v_exp_f32 v19,v19
v_cvt_pk_bf16_f32 v48,v16,v17
v_cvt_pk_bf16_f32 v49,v18,v19
v_mfma_f32_32x32x16_bf16 v[32:47],a[36:39],v[76:79],v[32:47]
buffer_load_dword a20,v7,s[52:55],s41 offen offset:3072
v_exp_f32 v20,v20
v_exp_f32 v21,v21
v_exp_f32 v22,v22
v_exp_f32 v23,v23
v_cvt_pk_bf16_f32 v50,v20,v21
v_cvt_pk_bf16_f32 v51,v22,v23
v_mfma_f32_32x32x16_bf16 v[216:231],a[24:27],v[56:59],v[216:231]
v_exp_f32 v24,v24
v_exp_f32 v25,v25
v_exp_f32 v26,v26
v_exp_f32 v27,v27
v_cvt_pk_bf16_f32 v52,v24,v25
v_cvt_pk_bf16_f32 v53,v26,v27
v_mfma_f32_32x32x16_bf16 v[216:231],a[28:31],v[60:63],v[216:231]
buffer_load_dwordx4 a[24:27],v248,s[8:11],s41 offen offset:1024
v_exp_f32 v28,v28
v_exp_f32 v29,v29
v_exp_f32 v30,v30
v_exp_f32 v31,v31
v_cvt_pk_bf16_f32 v54,v28,v29
v_cvt_pk_bf16_f32 v55,v30,v31
v_mfma_f32_32x32x16_bf16 v[16:31],a[32:35],v[80:83],0
buffer_load_dwordx4 a[28:31],v248,s[8:11],s41 offen offset:2048
s_add_u32 s41,s41,4096
v_exp_f32 v32,v32
v_exp_f32 v33,v33
v_exp_f32 v34,v34
v_exp_f32 v35,v35
v_cvt_pk_bf16_f32 v56,v32,v33
v_cvt_pk_bf16_f32 v57,v34,v35
v_mfma_f32_32x32x16_bf16 v[16:31],a[36:39],v[84:87],v[16:31]
v_exp_f32 v36,v36
v_exp_f32 v37,v37
v_exp_f32 v38,v38
v_exp_f32 v39,v39
v_cvt_pk_bf16_f32 v58,v36,v37
v_cvt_pk_bf16_f32 v59,v38,v39
v_mfma_f32_32x32x16_bf16 v[120:135],a[40:43],v[48:51],v[120:135]
v_exp_f32 v40,v40
v_exp_f32 v41,v41
v_exp_f32 v42,v42
v_exp_f32 v43,v43
v_cvt_pk_bf16_f32 v60,v40,v41
v_cvt_pk_bf16_f32 v61,v42,v43
v_mfma_f32_32x32x16_bf16 v[120:135],a[44:47],v[52:55],v[120:135]
v_exp_f32 v44,v44
v_exp_f32 v45,v45
v_exp_f32 v46,v46
v_exp_f32 v47,v47
v_cvt_pk_bf16_f32 v62,v44,v45
v_cvt_pk_bf16_f32 v63,v46,v47
v_mfma_f32_32x32x16_bf16 v[32:47],a[32:35],v[88:91],0
v_exp_f32 v16,v16
v_exp_f32 v17,v17
v_exp_f32 v18,v18
v_exp_f32 v19,v19
v_cvt_pk_bf16_f32 v48,v16,v17
v_cvt_pk_bf16_f32 v49,v18,v19
v_mfma_f32_32x32x16_bf16 v[32:47],a[36:39],v[92:95],v[32:47]
v_exp_f32 v20,v20
v_exp_f32 v21,v21
v_exp_f32 v22,v22
v_exp_f32 v23,v23
v_cvt_pk_bf16_f32 v50,v20,v21
v_cvt_pk_bf16_f32 v51,v22,v23
v_mfma_f32_32x32x16_bf16 v[136:151],a[40:43],v[56:59],v[136:151]
v_exp_f32 v24,v24
v_exp_f32 v25,v25
v_exp_f32 v26,v26
v_exp_f32 v27,v27
v_cvt_pk_bf16_f32 v52,v24,v25
v_cvt_pk_bf16_f32 v53,v26,v27
v_mfma_f32_32x32x16_bf16 v[136:151],a[44:47],v[60:63],v[136:151]
v_exp_f32 v28,v28
v_exp_f32 v29,v29
v_exp_f32 v30,v30
v_exp_f32 v31,v31
v_cvt_pk_bf16_f32 v54,v28,v29
v_cvt_pk_bf16_f32 v55,v30,v31
v_mfma_f32_32x32x16_bf16 v[16:31],a[32:35],v[96:99],0
v_exp_f32 v32,v32
v_exp_f32 v33,v33
v_exp_f32 v34,v34
v_exp_f32 v35,v35
v_cvt_pk_bf16_f32 v56,v32,v33
v_cvt_pk_bf16_f32 v57,v34,v35
v_mfma_f32_32x32x16_bf16 v[16:31],a[36:39],v[100:103],v[16:31]
v_exp_f32 v36,v36
v_exp_f32 v37,v37
v_exp_f32 v38,v38
v_exp_f32 v39,v39
v_cvt_pk_bf16_f32 v58,v36,v37
v_cvt_pk_bf16_f32 v59,v38,v39
v_mfma_f32_32x32x16_bf16 v[152:167],a[40:43],v[48:51],v[152:167]
v_exp_f32 v40,v40
v_exp_f32 v41,v41
v_exp_f32 v42,v42
v_exp_f32 v43,v43
v_cvt_pk_bf16_f32 v60,v40,v41
v_cvt_pk_bf16_f32 v61,v42,v43
v_mfma_f32_32x32x16_bf16 v[152:167],a[44:47],v[52:55],v[152:167]
v_exp_f32 v44,v44
v_exp_f32 v45,v45
v_exp_f32 v46,v46
v_exp_f32 v47,v47
v_cvt_pk_bf16_f32 v62,v44,v45
v_cvt_pk_bf16_f32 v63,v46,v47
v_mfma_f32_32x32x16_bf16 v[32:47],a[32:35],v[104:107],0
v_exp_f32 v16,v16
v_exp_f32 v17,v17
v_exp_f32 v18,v18
v_exp_f32 v19,v19
v_cvt_pk_bf16_f32 v48,v16,v17
v_cvt_pk_bf16_f32 v49,v18,v19
v_mfma_f32_32x32x16_bf16 v[32:47],a[36:39],v[108:111],v[32:47]
v_exp_f32 v20,v20
v_exp_f32 v21,v21
v_exp_f32 v22,v22
v_exp_f32 v23,v23
v_cvt_pk_bf16_f32 v50,v20,v21
v_cvt_pk_bf16_f32 v51,v22,v23
v_mfma_f32_32x32x16_bf16 v[168:183],a[40:43],v[56:59],v[168:183]
v_exp_f32 v24,v24
v_exp_f32 v25,v25
v_exp_f32 v26,v26
v_exp_f32 v27,v27
v_cvt_pk_bf16_f32 v52,v24,v25
v_cvt_pk_bf16_f32 v53,v26,v27
v_mfma_f32_32x32x16_bf16 v[168:183],a[44:47],v[60:63],v[168:183]
v_exp_f32 v28,v28
v_exp_f32 v29,v29
v_exp_f32 v30,v30
v_exp_f32 v31,v31
v_cvt_pk_bf16_f32 v54,v28,v29
v_cvt_pk_bf16_f32 v55,v30,v31
v_mfma_f32_32x32x16_bf16 v[16:31],a[32:35],v[112:115],0
v_exp_f32 v32,v32
v_exp_f32 v33,v33
v_exp_f32 v34,v34
v_exp_f32 v35,v35
v_cvt_pk_bf16_f32 v56,v32,v33
v_cvt_pk_bf16_f32 v57,v34,v35
v_mfma_f32_32x32x16_bf16 v[16:31],a[36:39],v[116:119],v[16:31]
v_exp_f32 v36,v36
v_exp_f32 v37,v37
v_exp_f32 v38,v38
v_exp_f32 v39,v39
v_cvt_pk_bf16_f32 v58,v36,v37
v_cvt_pk_bf16_f32 v59,v38,v39
v_mfma_f32_32x32x16_bf16 v[184:199],a[40:43],v[48:51],v[184:199]
v_exp_f32 v40,v40
v_exp_f32 v41,v41
v_exp_f32 v42,v42
v_exp_f32 v43,v43
v_cvt_pk_bf16_f32 v60,v40,v41
v_cvt_pk_bf16_f32 v61,v42,v43
v_mfma_f32_32x32x16_bf16 v[184:199],a[44:47],v[52:55],v[184:199]
v_exp_f32 v44,v44
v_exp_f32 v45,v45
v_exp_f32 v46,v46
v_exp_f32 v47,v47
v_cvt_pk_bf16_f32 v62,v44,v45
v_cvt_pk_bf16_f32 v63,v46,v47
s_waitcnt vmcnt(8)
v_mfma_f32_32x32x16_bf16 v[32:47],a[48:51],v[64:67],0
v_exp_f32 v16,v16
v_exp_f32 v17,v17
v_exp_f32 v18,v18
v_exp_f32_e64 v19,v19
v_cvt_pk_bf16_f32 v48,v16,v17
v_cvt_pk_bf16_f32 v49,v18,v19
v_mfma_f32_32x32x16_bf16 v[32:47],a[52:55],v[68:71],v[32:47]
v_exp_f32 v20,v20
v_exp_f32 v21,v21
v_exp_f32 v22,v22
v_exp_f32 v23,v23
v_cvt_pk_bf16_f32 v50,v20,v21
v_cvt_pk_bf16_f32 v51,v22,v23
v_mfma_f32_32x32x16_bf16 v[200:215],a[40:43],v[56:59],v[200:215]
v_exp_f32 v24,v24
v_exp_f32 v25,v25
v_exp_f32 v26,v26
v_exp_f32 v27,v27
v_cvt_pk_bf16_f32 v52,v24,v25
v_cvt_pk_bf16_f32 v53,v26,v27
v_mfma_f32_32x32x16_bf16 v[200:215],a[44:47],v[60:63],v[200:215]
v_exp_f32 v28,v28
v_exp_f32 v29,v29
v_exp_f32 v30,v30
v_exp_f32 v31,v31
v_cvt_pk_bf16_f32 v54,v28,v29
v_cvt_pk_bf16_f32 v55,v30,v31
v_mfma_f32_32x32x16_bf16 v[16:31],a[48:51],v[72:75],0
buffer_load_dwordx4 a[32:35],v2,s[8:11],s41 offen
v_exp_f32 v32,v32
v_exp_f32 v33,v33
v_exp_f32 v34,v34
v_exp_f32 v35,v35
v_cvt_pk_bf16_f32 v56,v32,v33
v_cvt_pk_bf16_f32 v57,v34,v35
v_mfma_f32_32x32x16_bf16 v[16:31],a[52:55],v[76:79],v[16:31]
buffer_load_dword a36,v7,s[52:55],s41 offen offset:3072
v_exp_f32 v36,v36
v_exp_f32 v37,v37
v_exp_f32 v38,v38
v_exp_f32 v39,v39
v_cvt_pk_bf16_f32 v58,v36,v37
v_cvt_pk_bf16_f32 v59,v38,v39
v_mfma_f32_32x32x16_bf16 v[216:231],a[40:43],v[48:51],v[216:231]
v_exp_f32 v40,v40
v_exp_f32 v41,v41
v_exp_f32 v42,v42
v_exp_f32 v43,v43
v_cvt_pk_bf16_f32 v60,v40,v41
v_cvt_pk_bf16_f32 v61,v42,v43
v_mfma_f32_32x32x16_bf16 v[216:231],a[44:47],v[52:55],v[216:231]
buffer_load_dwordx4 a[40:43],v248,s[8:11],s41 offen offset:1024
v_exp_f32 v44,v44
v_exp_f32 v45,v45
v_exp_f32 v46,v46
v_exp_f32 v47,v47
v_cvt_pk_bf16_f32 v62,v44,v45
v_cvt_pk_bf16_f32 v63,v46,v47
v_mfma_f32_32x32x16_bf16 v[32:47],a[48:51],v[80:83],0
buffer_load_dwordx4 a[44:47],v248,s[8:11],s41 offen offset:2048
s_add_u32 s41,s41,4096
v_exp_f32 v16,v16
v_exp_f32 v17,v17
v_exp_f32 v18,v18
v_exp_f32 v19,v19
v_cvt_pk_bf16_f32 v48,v16,v17
v_cvt_pk_bf16_f32 v49,v18,v19
v_mfma_f32_32x32x16_bf16 v[32:47],a[52:55],v[84:87],v[32:47]
v_exp_f32 v20,v20
v_exp_f32 v21,v21
v_exp_f32 v22,v22
v_exp_f32 v23,v23
v_cvt_pk_bf16_f32 v50,v20,v21
v_cvt_pk_bf16_f32 v51,v22,v23
v_mfma_f32_32x32x16_bf16 v[120:135],a[56:59],v[56:59],v[120:135]
v_exp_f32 v24,v24
v_exp_f32 v25,v25
v_exp_f32 v26,v26
v_exp_f32 v27,v27
v_cvt_pk_bf16_f32 v52,v24,v25
v_cvt_pk_bf16_f32 v53,v26,v27
v_mfma_f32_32x32x16_bf16 v[120:135],a[60:63],v[60:63],v[120:135]
v_exp_f32 v28,v28
v_exp_f32 v29,v29
v_exp_f32 v30,v30
v_exp_f32 v31,v31
v_cvt_pk_bf16_f32 v54,v28,v29
v_cvt_pk_bf16_f32 v55,v30,v31
v_mfma_f32_32x32x16_bf16 v[16:31],a[48:51],v[88:91],0
v_exp_f32 v32,v32
v_exp_f32 v33,v33
v_exp_f32 v34,v34
v_exp_f32 v35,v35
v_cvt_pk_bf16_f32 v56,v32,v33
v_cvt_pk_bf16_f32 v57,v34,v35
v_mfma_f32_32x32x16_bf16 v[16:31],a[52:55],v[92:95],v[16:31]
v_exp_f32 v36,v36
v_exp_f32 v37,v37
v_exp_f32 v38,v38
v_exp_f32 v39,v39
v_cvt_pk_bf16_f32 v58,v36,v37
v_cvt_pk_bf16_f32 v59,v38,v39
v_mfma_f32_32x32x16_bf16 v[136:151],a[56:59],v[48:51],v[136:151]
v_exp_f32 v40,v40
v_exp_f32 v41,v41
v_exp_f32 v42,v42
v_exp_f32 v43,v43
v_cvt_pk_bf16_f32 v60,v40,v41
v_cvt_pk_bf16_f32 v61,v42,v43
v_mfma_f32_32x32x16_bf16 v[136:151],a[60:63],v[52:55],v[136:151]
v_exp_f32 v44,v44
v_exp_f32 v45,v45
v_exp_f32 v46,v46
v_exp_f32 v47,v47
v_cvt_pk_bf16_f32 v62,v44,v45
v_cvt_pk_bf16_f32 v63,v46,v47
v_mfma_f32_32x32x16_bf16 v[32:47],a[48:51],v[96:99],0
v_exp_f32 v16,v16
v_exp_f32 v17,v17
v_exp_f32 v18,v18
v_exp_f32 v19,v19
v_cvt_pk_bf16_f32 v48,v16,v17
v_cvt_pk_bf16_f32 v49,v18,v19
v_mfma_f32_32x32x16_bf16 v[32:47],a[52:55],v[100:103],v[32:47]
v_exp_f32 v20,v20
v_exp_f32 v21,v21
v_exp_f32 v22,v22
v_exp_f32 v23,v23
v_cvt_pk_bf16_f32 v50,v20,v21
v_cvt_pk_bf16_f32 v51,v22,v23
v_mfma_f32_32x32x16_bf16 v[152:167],a[56:59],v[56:59],v[152:167]
v_exp_f32 v24,v24
v_exp_f32 v25,v25
v_exp_f32 v26,v26
v_exp_f32 v27,v27
v_cvt_pk_bf16_f32 v52,v24,v25
v_cvt_pk_bf16_f32 v53,v26,v27
v_mfma_f32_32x32x16_bf16 v[152:167],a[60:63],v[60:63],v[152:167]
v_exp_f32 v28,v28
v_exp_f32 v29,v29
v_exp_f32 v30,v30
v_exp_f32 v31,v31
v_cvt_pk_bf16_f32 v54,v28,v29
v_cvt_pk_bf16_f32 v55,v30,v31
v_mfma_f32_32x32x16_bf16 v[16:31],a[48:51],v[104:107],0
v_exp_f32 v32,v32
v_exp_f32 v33,v33
v_exp_f32 v34,v34
v_exp_f32 v35,v35
v_cvt_pk_bf16_f32 v56,v32,v33
v_cvt_pk_bf16_f32 v57,v34,v35
v_mfma_f32_32x32x16_bf16 v[16:31],a[52:55],v[108:111],v[16:31]
v_exp_f32 v36,v36
v_exp_f32 v37,v37
v_exp_f32 v38,v38
v_exp_f32 v39,v39
v_cvt_pk_bf16_f32 v58,v36,v37
v_cvt_pk_bf16_f32 v59,v38,v39
v_mfma_f32_32x32x16_bf16 v[168:183],a[56:59],v[48:51],v[168:183]
v_exp_f32 v40,v40
v_exp_f32 v41,v41
v_exp_f32 v42,v42
v_exp_f32 v43,v43
v_cvt_pk_bf16_f32 v60,v40,v41
v_cvt_pk_bf16_f32 v61,v42,v43
v_mfma_f32_32x32x16_bf16 v[168:183],a[60:63],v[52:55],v[168:183]
v_exp_f32 v44,v44
v_exp_f32 v45,v45
v_exp_f32 v46,v46
v_exp_f32 v47,v47
v_cvt_pk_bf16_f32 v62,v44,v45
v_cvt_pk_bf16_f32 v63,v46,v47
v_mfma_f32_32x32x16_bf16 v[32:47],a[48:51],v[112:115],0
v_exp_f32 v16,v16
v_exp_f32 v17,v17
v_exp_f32 v18,v18
v_exp_f32 v19,v19
v_cvt_pk_bf16_f32 v48,v16,v17
v_cvt_pk_bf16_f32 v49,v18,v19
v_mfma_f32_32x32x16_bf16 v[32:47],a[52:55],v[116:119],v[32:47]
v_exp_f32 v20,v20
v_exp_f32 v21,v21
v_exp_f32 v22,v22
v_exp_f32 v23,v23
v_cvt_pk_bf16_f32 v50,v20,v21
v_cvt_pk_bf16_f32 v51,v22,v23
v_mfma_f32_32x32x16_bf16 v[184:199],a[56:59],v[56:59],v[184:199]
v_exp_f32 v24,v24
v_exp_f32 v25,v25
v_exp_f32 v26,v26
v_exp_f32 v27,v27
v_cvt_pk_bf16_f32 v52,v24,v25
v_cvt_pk_bf16_f32 v53,v26,v27
v_mfma_f32_32x32x16_bf16 v[184:199],a[60:63],v[60:63],v[184:199]
v_exp_f32 v28,v28
v_exp_f32 v29,v29
v_exp_f32 v30,v30
v_exp_f32 v31,v31
v_cvt_pk_bf16_f32 v54,v28,v29
v_cvt_pk_bf16_f32 v55,v30,v31
s_waitcnt vmcnt(8)
v_mfma_f32_32x32x16_bf16 v[16:31],a[0:3],v[64:67],0
v_exp_f32 v32,v32
v_exp_f32 v33,v33
v_exp_f32 v34,v34
v_exp_f32_e64 v35,v35
v_cvt_pk_bf16_f32 v56,v32,v33
v_cvt_pk_bf16_f32 v57,v34,v35
v_mfma_f32_32x32x16_bf16 v[16:31],a[4:7],v[68:71],v[16:31]
v_exp_f32 v36,v36
v_exp_f32 v37,v37
v_exp_f32 v38,v38
v_exp_f32 v39,v39
v_cvt_pk_bf16_f32 v58,v36,v37
v_cvt_pk_bf16_f32 v59,v38,v39
v_mfma_f32_32x32x16_bf16 v[200:215],a[56:59],v[48:51],v[200:215]
v_exp_f32 v40,v40
v_exp_f32 v41,v41
v_exp_f32 v42,v42
v_exp_f32 v43,v43
v_cvt_pk_bf16_f32 v60,v40,v41
v_cvt_pk_bf16_f32 v61,v42,v43
v_mfma_f32_32x32x16_bf16 v[200:215],a[60:63],v[52:55],v[200:215]
v_exp_f32 v44,v44
v_exp_f32 v45,v45
v_exp_f32 v46,v46
v_exp_f32 v47,v47
v_cvt_pk_bf16_f32 v62,v44,v45
v_cvt_pk_bf16_f32 v63,v46,v47
s_sub_u32 s39,s39,1
s_cmp_lg_u32 s39,0
s_cbranch_scc1 att7_loop
v_mfma_f32_32x32x16_bf16 v[32:47],a[0:3],v[72:75],0
buffer_load_dwordx4 a[48:51],v2,s[8:11],s41 offen
v_exp_f32 v16,v16
v_exp_f32 v17,v17
v_exp_f32 v18,v18
v_exp_f32_e64 v19,v19
v_cvt_pk_bf16_f32 v48,v16,v17
v_cvt_pk_bf16_f32 v49,v18,v19
v_mfma_f32_32x32x16_bf16 v[32:47],a[4:7],v[76:79],v[32:47]
buffer_load_dword a52,v7,s[52:55],s41 offen offset:3072
v_exp_f32 v20,v20
v_exp_f32 v21,v21
v_exp_f32 v22,v22
v_exp_f32 v23,v23
v_cvt_pk_bf16_f32 v50,v20,v21
v_cvt_pk_bf16_f32 v51,v22,v23
v_mfma_f32_32x32x16_bf16 v[216:231],a[56:59],v[56:59],v[216:231]
v_exp_f32 v24,v24
v_exp_f32 v25,v25
v_exp_f32 v26,v26
v_exp_f32 v27,v27
v_cvt_pk_bf16_f32 v52,v24,v25
v_cvt_pk_bf16_f32 v53,v26,v27
v_mfma_f32_32x32x16_bf16 v[216:231],a[60:63],v[60:63],v[216:231]
buffer_load_dwordx4 a[56:59],v248,s[8:11],s41 offen offset:1024
v_exp_f32 v28,v28
v_exp_f32 v29,v29
v_exp_f32 v30,v30
v_exp_f32 v31,v31
v_cvt_pk_bf16_f32 v54,v28,v29
v_cvt_pk_bf16_f32 v55,v30,v31
v_mfma_f32_32x32x16_bf16 v[16:31],a[0:3],v[80:83],0
buffer_load_dwordx4 a[60:63],v248,s[8:11],s41 offen offset:2048
s_add_u32 s41,s41,4096
v_exp_f32 v32,v32
v_exp_f32 v33,v33
v_exp_f32 v34,v34
v_exp_f32 v35,v35
v_cvt_pk_bf16_f32 v56,v32,v33
v_cvt_pk_bf16_f32 v57,v34,v35
v_mfma_f32_32x32x16_bf16 v[16:31],a[4:7],v[84:87],v[16:31]
s_mov_b32 s43,s23
s_add_u32 s23,s23,32768
s_add_u32 m0,s43,0
s_add_u32 s22,s22,28672
buffer_load_dwordx4 v2,s[12:15],s22 offen offset:0 lds
v_exp_f32 v36,v36
v_exp_f32 v37,v37
v_exp_f32 v38,v38
v_exp_f32 v39,v39
v_cvt_pk_bf16_f32 v58,v36,v37
v_cvt_pk_bf16_f32 v59,v38,v39
v_mfma_f32_32x32x16_bf16 v[120:135],a[8:11],v[48:51],v[120:135]
v_exp_f32 v40,v40
v_exp_f32 v41,v41
v_exp_f32 v42,v42
v_exp_f32 v43,v43
v_cvt_pk_bf16_f32 v60,v40,v41
v_cvt_pk_bf16_f32 v61,v42,v43
v_mfma_f32_32x32x16_bf16 v[120:135],a[12:15],v[52:55],v[120:135]
v_exp_f32 v44,v44
v_exp_f32 v45,v45
v_exp_f32 v46,v46
v_exp_f32 v47,v47
v_cvt_pk_bf16_f32 v62,v44,v45
v_cvt_pk_bf16_f32 v63,v46,v47
v_mfma_f32_32x32x16_bf16 v[32:47],a[0:3],v[88:91],0
buffer_load_dwordx4 v2,s[12:15],s22 offen offset:1024 lds
v_exp_f32 v16,v16
v_exp_f32 v17,v17
v_exp_f32 v18,v18
v_exp_f32 v19,v19
v_cvt_pk_bf16_f32 v48,v16,v17
v_cvt_pk_bf16_f32 v49,v18,v19
v_mfma_f32_32x32x16_bf16 v[32:47],a[4:7],v[92:95],v[32:47]
v_exp_f32 v20,v20
v_exp_f32 v21,v21
v_exp_f32 v22,v22
v_exp_f32 v23,v23
v_cvt_pk_bf16_f32 v50,v20,v21
v_cvt_pk_bf16_f32 v51,v22,v23
v_mfma_f32_32x32x16_bf16 v[136:151],a[8:11],v[56:59],v[136:151]
v_exp_f32 v24,v24
v_exp_f32 v25,v25
v_exp_f32 v26,v26
v_exp_f32 v27,v27
v_cvt_pk_bf16_f32 v52,v24,v25
v_cvt_pk_bf16_f32 v53,v26,v27
v_mfma_f32_32x32x16_bf16 v[136:151],a[12:15],v[60:63],v[136:151]
buffer_load_dwordx4 v2,s[12:15],s22 offen offset:2048 lds
v_exp_f32 v28,v28
v_exp_f32 v29,v29
v_exp_f32 v30,v30
v_exp_f32 v31,v31
v_cvt_pk_bf16_f32 v54,v28,v29
v_cvt_pk_bf16_f32 v55,v30,v31
v_mfma_f32_32x32x16_bf16 v[16:31],a[0:3],v[96:99],0
v_exp_f32 v32,v32
v_exp_f32 v33,v33
v_exp_f32 v34,v34
v_exp_f32 v35,v35
v_cvt_pk_bf16_f32 v56,v32,v33
v_cvt_pk_bf16_f32 v57,v34,v35
v_mfma_f32_32x32x16_bf16 v[16:31],a[4:7],v[100:103],v[16:31]
v_exp_f32 v36,v36
v_exp_f32 v37,v37
v_exp_f32 v38,v38
v_exp_f32 v39,v39
v_cvt_pk_bf16_f32 v58,v36,v37
v_cvt_pk_bf16_f32 v59,v38,v39
v_mfma_f32_32x32x16_bf16 v[152:167],a[8:11],v[48:51],v[152:167]
buffer_load_dwordx4 v2,s[12:15],s22 offen offset:3072 lds
v_exp_f32 v40,v40
v_exp_f32 v41,v41
v_exp_f32 v42,v42
v_exp_f32 v43,v43
v_cvt_pk_bf16_f32 v60,v40,v41
v_cvt_pk_bf16_f32 v61,v42,v43
v_mfma_f32_32x32x16_bf16 v[152:167],a[12:15],v[52:55],v[152:167]
v_exp_f32 v44,v44
v_exp_f32 v45,v45
v_exp_f32 v46,v46
v_exp_f32 v47,v47
v_cvt_pk_bf16_f32 v62,v44,v45
v_cvt_pk_bf16_f32 v63,v46,v47
v_mfma_f32_32x32x16_bf16 v[32:47],a[0:3],v[104:107],0
v_exp_f32 v16,v16
v_exp_f32 v17,v17
v_exp_f32 v18,v18
v_exp_f32 v19,v19
v_cvt_pk_bf16_f32 v48,v16,v17
v_cvt_pk_bf16_f32 v49,v18,v19
v_mfma_f32_32x32x16_bf16 v[32:47],a[4:7],v[108:111],v[32:47]
s_add_u32 m0,s43,4096
s_add_u32 s22,s22,4096
buffer_load_dwordx4 v2,s[12:15],s22 offen offset:0 lds
v_exp_f32 v20,v20
v_exp_f32 v21,v21
v_exp_f32 v22,v22
v_exp_f32 v23,v23
v_cvt_pk_bf16_f32 v50,v20,v21
v_cvt_pk_bf16_f32 v51,v22,v23
v_mfma_f32_32x32x16_bf16 v[168:183],a[8:11],v[56:59],v[168:183]
v_exp_f32 v24,v24
v_exp_f32 v25,v25
v_exp_f32 v26,v26
v_exp_f32 v27,v27
v_cvt_pk_bf16_f32 v52,v24,v25
v_cvt_pk_bf16_f32 v53,v26,v27
v_mfma_f32_32x32x16_bf16 v[168:183],a[12:15],v[60:63],v[168:183]
v_exp_f32 v28,v28
v_exp_f32 v29,v29
v_exp_f32 v30,v30
v_exp_f32 v31,v31
v_cvt_pk_bf16_f32 v54,v28,v29
v_cvt_pk_bf16_f32 v55,v30,v31
v_mfma_f32_32x32x16_bf16 v[16:31],a[0:3],v[112:115],0
buffer_load_dwordx4 v2,s[12:15],s22 offen offset:1024 lds
v_exp_f32 v32,v32
v_exp_f32 v33,v33
v_exp_f32 v34,v34
v_exp_f32 v35,v35
v_cvt_pk_bf16_f32 v56,v32,v33
v_cvt_pk_bf16_f32 v57,v34,v35
v_mfma_f32_32x32x16_bf16 v[16:31],a[4:7],v[116:119],v[16:31]
v_exp_f32 v36,v36
v_exp_f32 v37,v37
v_exp_f32 v38,v38
v_exp_f32 v39,v39
v_cvt_pk_bf16_f32 v58,v36,v37
v_cvt_pk_bf16_f32 v59,v38,v39
v_mfma_f32_32x32x16_bf16 v[184:199],a[8:11],v[48:51],v[184:199]
v_exp_f32 v40,v40
v_exp_f32 v41,v41
v_exp_f32 v42,v42
v_exp_f32 v43,v43
v_cvt_pk_bf16_f32 v60,v40,v41
v_cvt_pk_bf16_f32 v61,v42,v43
v_mfma_f32_32x32x16_bf16 v[184:199],a[12:15],v[52:55],v[184:199]
buffer_load_dwordx4 v2,s[12:15],s22 offen offset:2048 lds
v_exp_f32 v44,v44
v_exp_f32 v45,v45
v_exp_f32 v46,v46
v_exp_f32 v47,v47
v_cvt_pk_bf16_f32 v62,v44,v45
v_cvt_pk_bf16_f32 v63,v46,v47
s_waitcnt vmcnt(15)
v_mfma_f32_32x32x16_bf16 v[32:47],a[16:19],v[64:67],0
v_exp_f32 v16,v16
v_exp_f32 v17,v17
v_exp_f32 v18,v18
v_exp_f32_e64 v19,v19
v_cvt_pk_bf16_f32 v48,v16,v17
v_cvt_pk_bf16_f32 v49,v18,v19
v_mfma_f32_32x32x16_bf16 v[32:47],a[20:23],v[68:71],v[32:47]
v_exp_f32 v20,v20
v_exp_f32 v21,v21
v_exp_f32 v22,v22
v_exp_f32 v23,v23
v_cvt_pk_bf16_f32 v50,v20,v21
v_cvt_pk_bf16_f32 v51,v22,v23
v_mfma_f32_32x32x16_bf16 v[200:215],a[8:11],v[56:59],v[200:215]
buffer_load_dwordx4 v2,s[12:15],s22 offen offset:3072 lds
v_exp_f32 v24,v24
v_exp_f32 v25,v25
v_exp_f32 v26,v26
v_exp_f32 v27,v27
v_cvt_pk_bf16_f32 v52,v24,v25
v_cvt_pk_bf16_f32 v53,v26,v27
v_mfma_f32_32x32x16_bf16 v[200:215],a[12:15],v[60:63],v[200:215]
v_exp_f32 v28,v28
v_exp_f32 v29,v29
v_exp_f32 v30,v30
v_exp_f32 v31,v31
v_cvt_pk_bf16_f32 v54,v28,v29
v_cvt_pk_bf16_f32 v55,v30,v31
v_mfma_f32_32x32x16_bf16 v[16:31],a[16:19],v[72:75],0
v_exp_f32 v32,v32
v_exp_f32 v33,v33
v_exp_f32 v34,v34
v_exp_f32 v35,v35
v_cvt_pk_bf16_f32 v56,v32,v33
v_cvt_pk_bf16_f32 v57,v34,v35
v_mfma_f32_32x32x16_bf16 v[16:31],a[20:23],v[76:79],v[16:31]
buffer_load_dwordx4 a[128:131],v2,s[8:11],s4 offen offset:0
v_exp_f32 v36,v36
v_exp_f32 v37,v37
v_exp_f32 v38,v38
v_exp_f32 v39,v39
v_cvt_pk_bf16_f32 v58,v36,v37
v_cvt_pk_bf16_f32 v59,v38,v39
v_mfma_f32_32x32x16_bf16 v[216:231],a[8:11],v[48:51],v[216:231]
v_exp_f32 v40,v40
v_exp_f32 v41,v41
v_exp_f32 v42,v42
v_exp_f32 v43,v43
v_cvt_pk_bf16_f32 v60,v40,v41
v_cvt_pk_bf16_f32 v61,v42,v43
v_mfma_f32_32x32x16_bf16 v[216:231],a[12:15],v[52:55],v[216:231]
v_exp_f32 v44,v44
v_exp_f32 v45,v45
v_exp_f32 v46,v46
v_exp_f32 v47,v47
v_cvt_pk_bf16_f32 v62,v44,v45
v_cvt_pk_bf16_f32 v63,v46,v47
v_mfma_f32_32x32x16_bf16 v[32:47],a[16:19],v[80:83],0
buffer_load_dwordx4 a[132:135],v2,s[8:11],s4 offen offset:1024
v_exp_f32 v16,v16
v_exp_f32 v17,v17
v_exp_f32 v18,v18
v_exp_f32 v19,v19
v_cvt_pk_bf16_f32 v48,v16,v17
v_cvt_pk_bf16_f32 v49,v18,v19
v_mfma_f32_32x32x16_bf16 v[32:47],a[20:23],v[84:87],v[32:47]
v_exp_f32 v20,v20
v_exp_f32 v21,v21
v_exp_f32 v22,v22
v_exp_f32 v23,v23
v_cvt_pk_bf16_f32 v50,v20,v21
v_cvt_pk_bf16_f32 v51,v22,v23
v_mfma_f32_32x32x16_bf16 v[120:135],a[24:27],v[56:59],v[120:135]
v_exp_f32 v24,v24
v_exp_f32 v25,v25
v_exp_f32 v26,v26
v_exp_f32 v27,v27
v_cvt_pk_bf16_f32 v52,v24,v25
v_cvt_pk_bf16_f32 v53,v26,v27
v_mfma_f32_32x32x16_bf16 v[120:135],a[28:31],v[60:63],v[120:135]
buffer_load_dwordx4 a[136:139],v2,s[8:11],s4 offen offset:2048
v_exp_f32 v28,v28
v_exp_f32 v29,v29
v_exp_f32 v30,v30
v_exp_f32 v31,v31
v_cvt_pk_bf16_f32 v54,v28,v29
v_cvt_pk_bf16_f32 v55,v30,v31
v_mfma_f32_32x32x16_bf16 v[16:31],a[16:19],v[88:91],0
v_exp_f32 v32,v32
v_exp_f32 v33,v33
v_exp_f32 v34,v34
v_exp_f32 v35,v35
v_cvt_pk_bf16_f32 v56,v32,v33
v_cvt_pk_bf16_f32 v57,v34,v35
v_mfma_f32_32x32x16_bf16 v[16:31],a[20:23],v[92:95],v[16:31]
v_exp_f32 v36,v36
v_exp_f32 v37,v37
v_exp_f32 v38,v38
v_exp_f32 v39,v39
v_cvt_pk_bf16_f32 v58,v36,v37
v_cvt_pk_bf16_f32 v59,v38,v39
v_mfma_f32_32x32x16_bf16 v[136:151],a[24:27],v[48:51],v[136:151]
buffer_load_dwordx4 a[140:143],v2,s[8:11],s4 offen offset:3072
s_add_u32 s4,s4,4096
v_exp_f32 v40,v40
v_exp_f32 v41,v41
v_exp_f32 v42,v42
v_exp_f32 v43,v43
v_cvt_pk_bf16_f32 v60,v40,v41
v_cvt_pk_bf16_f32 v61,v42,v43
v_mfma_f32_32x32x16_bf16 v[136:151],a[28:31],v[52:55],v[136:151]
v_exp_f32 v44,v44
v_exp_f32 v45,v45
v_exp_f32 v46,v46
v_exp_f32 v47,v47
v_cvt_pk_bf16_f32 v62,v44,v45
v_cvt_pk_bf16_f32 v63,v46,v47
v_mfma_f32_32x32x16_bf16 v[32:47],a[16:19],v[96:99],0
v_exp_f32 v16,v16
v_exp_f32 v17,v17
v_exp_f32 v18,v18
v_exp_f32 v19,v19
v_cvt_pk_bf16_f32 v48,v16,v17
v_cvt_pk_bf16_f32 v49,v18,v19
v_mfma_f32_32x32x16_bf16 v[32:47],a[20:23],v[100:103],v[32:47]
buffer_load_dwordx4 a[144:147],v2,s[8:11],s4 offen offset:0
v_exp_f32 v20,v20
v_exp_f32 v21,v21
v_exp_f32 v22,v22
v_exp_f32 v23,v23
v_cvt_pk_bf16_f32 v50,v20,v21
v_cvt_pk_bf16_f32 v51,v22,v23
v_mfma_f32_32x32x16_bf16 v[152:167],a[24:27],v[56:59],v[152:167]
v_exp_f32 v24,v24
v_exp_f32 v25,v25
v_exp_f32 v26,v26
v_exp_f32 v27,v27
v_cvt_pk_bf16_f32 v52,v24,v25
v_cvt_pk_bf16_f32 v53,v26,v27
v_mfma_f32_32x32x16_bf16 v[152:167],a[28:31],v[60:63],v[152:167]
v_exp_f32 v28,v28
v_exp_f32 v29,v29
v_exp_f32 v30,v30
v_exp_f32 v31,v31
v_cvt_pk_bf16_f32 v54,v28,v29
v_cvt_pk_bf16_f32 v55,v30,v31
v_mfma_f32_32x32x16_bf16 v[16:31],a[16:19],v[104:107],0
buffer_load_dwordx4 a[148:151],v2,s[8:11],s4 offen offset:1024
v_exp_f32 v32,v32
v_exp_f32 v33,v33
v_exp_f32 v34,v34
v_exp_f32 v35,v35
v_cvt_pk_bf16_f32 v56,v32,v33
v_cvt_pk_bf16_f32 v57,v34,v35
v_mfma_f32_32x32x16_bf16 v[16:31],a[20:23],v[108:111],v[16:31]
v_exp_f32 v36,v36
v_exp_f32 v37,v37
v_exp_f32 v38,v38
v_exp_f32 v39,v39
v_cvt_pk_bf16_f32 v58,v36,v37
v_cvt_pk_bf16_f32 v59,v38,v39
v_mfma_f32_32x32x16_bf16 v[168:183],a[24:27],v[48:51],v[168:183]
v_exp_f32 v40,v40
v_exp_f32 v41,v41
v_exp_f32 v42,v42
v_exp_f32 v43,v43
v_cvt_pk_bf16_f32 v60,v40,v41
v_cvt_pk_bf16_f32 v61,v42,v43
v_mfma_f32_32x32x16_bf16 v[168:183],a[28:31],v[52:55],v[168:183]
buffer_load_dwordx4 a[152:155],v2,s[8:11],s4 offen offset:2048
v_exp_f32 v44,v44
v_exp_f32 v45,v45
v_exp_f32 v46,v46
v_exp_f32 v47,v47
v_cvt_pk_bf16_f32 v62,v44,v45
v_cvt_pk_bf16_f32 v63,v46,v47
v_mfma_f32_32x32x16_bf16 v[32:47],a[16:19],v[112:115],0
v_exp_f32 v16,v16
v_exp_f32 v17,v17
v_exp_f32 v18,v18
v_exp_f32 v19,v19
v_cvt_pk_bf16_f32 v48,v16,v17
v_cvt_pk_bf16_f32 v49,v18,v19
v_mfma_f32_32x32x16_bf16 v[32:47],a[20:23],v[116:119],v[32:47]
v_exp_f32 v20,v20
v_exp_f32 v21,v21
v_exp_f32 v22,v22
v_exp_f32 v23,v23
v_cvt_pk_bf16_f32 v50,v20,v21
v_cvt_pk_bf16_f32 v51,v22,v23
v_mfma_f32_32x32x16_bf16 v[184:199],a[24:27],v[56:59],v[184:199]
buffer_load_dwordx4 a[156:159],v2,s[8:11],s4 offen offset:3072
v_exp_f32 v24,v24
v_exp_f32 v25,v25
v_exp_f32 v26,v26
v_exp_f32 v27,v27
v_cvt_pk_bf16_f32 v52,v24,v25
v_cvt_pk_bf16_f32 v53,v26,v27
v_mfma_f32_32x32x16_bf16 v[184:199],a[28:31],v[60:63],v[184:199]
v_exp_f32 v28,v28
v_exp_f32 v29,v29
v_exp_f32 v30,v30
v_exp_f32 v31,v31
v_cvt_pk_bf16_f32 v54,v28,v29
v_cvt_pk_bf16_f32 v55,v30,v31
s_waitcnt vmcnt(20)
v_mfma_f32_32x32x16_bf16 v[16:31],a[32:35],v[64:67],0
v_exp_f32 v32,v32
v_exp_f32 v33,v33
v_exp_f32 v34,v34
v_exp_f32_e64 v35,v35
v_cvt_pk_bf16_f32 v56,v32,v33
v_cvt_pk_bf16_f32 v57,v34,v35
v_mfma_f32_32x32x16_bf16 v[16:31],a[36:39],v[68:71],v[16:31]
buffer_load_dwordx4 a[160:163],v2,s[8:11],s5 offen offset:0
v_exp_f32 v36,v36
v_exp_f32 v37,v37
v_exp_f32 v38,v38
v_exp_f32 v39,v39
v_cvt_pk_bf16_f32 v58,v36,v37
v_cvt_pk_bf16_f32 v59,v38,v39
v_mfma_f32_32x32x16_bf16 v[200:215],a[24:27],v[48:51],v[200:215]
v_exp_f32 v40,v40
v_exp_f32 v41,v41
v_exp_f32 v42,v42
v_exp_f32 v43,v43
v_cvt_pk_bf16_f32 v60,v40,v41
v_cvt_pk_bf16_f32 v61,v42,v43
v_mfma_f32_32x32x16_bf16 v[200:215],a[28:31],v[52:55],v[200:215]
v_exp_f32 v44,v44
v_exp_f32 v45,v45
v_exp_f32 v46,v46
v_exp_f32 v47,v47
v_cvt_pk_bf16_f32 v62,v44,v45
v_cvt_pk_bf16_f32 v63,v46,v47
v_mfma_f32_32x32x16_bf16 v[32:47],a[32:35],v[72:75],0
buffer_load_dwordx4 a[164:167],v2,s[8:11],s5 offen offset:1024
v_exp_f32 v16,v16
v_exp_f32 v17,v17
v_exp_f32 v18,v18
v_exp_f32 v19,v19
v_cvt_pk_bf16_f32 v48,v16,v17
v_cvt_pk_bf16_f32 v49,v18,v19
v_mfma_f32_32x32x16_bf16 v[32:47],a[36:39],v[76:79],v[32:47]
v_exp_f32 v20,v20
v_exp_f32 v21,v21
v_exp_f32 v22,v22
v_exp_f32 v23,v23
v_cvt_pk_bf16_f32 v50,v20,v21
v_cvt_pk_bf16_f32 v51,v22,v23
v_mfma_f32_32x32x16_bf16 v[216:231],a[24:27],v[56:59],v[216:231]
v_exp_f32 v24,v24
v_exp_f32 v25,v25
v_exp_f32 v26,v26
v_exp_f32 v27,v27
v_cvt_pk_bf16_f32 v52,v24,v25
v_cvt_pk_bf16_f32 v53,v26,v27
v_mfma_f32_32x32x16_bf16 v[216:231],a[28:31],v[60:63],v[216:231]
buffer_load_dwordx4 a[168:171],v2,s[8:11],s5 offen offset:2048
v_exp_f32 v28,v28
v_exp_f32 v29,v29
v_exp_f32 v30,v30
v_exp_f32 v31,v31
v_cvt_pk_bf16_f32 v54,v28,v29
v_cvt_pk_bf16_f32 v55,v30,v31
v_mfma_f32_32x32x16_bf16 v[16:31],a[32:35],v[80:83],0
v_exp_f32 v32,v32
v_exp_f32 v33,v33
v_exp_f32 v34,v34
v_exp_f32 v35,v35
v_cvt_pk_bf16_f32 v56,v32,v33
v_cvt_pk_bf16_f32 v57,v34,v35
v_mfma_f32_32x32x16_bf16 v[16:31],a[36:39],v[84:87],v[16:31]
v_exp_f32 v36,v36
v_exp_f32 v37,v37
v_exp_f32 v38,v38
v_exp_f32 v39,v39
v_cvt_pk_bf16_f32 v58,v36,v37
v_cvt_pk_bf16_f32 v59,v38,v39
v_mfma_f32_32x32x16_bf16 v[120:135],a[40:43],v[48:51],v[120:135]
buffer_load_dwordx4 a[172:175],v2,s[8:11],s5 offen offset:3072
s_add_u32 s5,s5,4096
v_exp_f32 v40,v40
v_exp_f32 v41,v41
v_exp_f32 v42,v42
v_exp_f32 v43,v43
v_cvt_pk_bf16_f32 v60,v40,v41
v_cvt_pk_bf16_f32 v61,v42,v43
v_mfma_f32_32x32x16_bf16 v[120:135],a[44:47],v[52:55],v[120:135]
v_exp_f32 v44,v44
v_exp_f32 v45,v45
v_exp_f32 v46,v46
v_exp_f32 v47,v47
v_cvt_pk_bf16_f32 v62,v44,v45
v_cvt_pk_bf16_f32 v63,v46,v47
v_mfma_f32_32x32x16_bf16 v[32:47],a[32:35],v[88:91],0
v_exp_f32 v16,v16
v_exp_f32 v17,v17
v_exp_f32 v18,v18
v_exp_f32 v19,v19
v_cvt_pk_bf16_f32 v48,v16,v17
v_cvt_pk_bf16_f32 v49,v18,v19
v_mfma_f32_32x32x16_bf16 v[32:47],a[36:39],v[92:95],v[32:47]
buffer_load_dwordx4 a[176:179],v2,s[8:11],s5 offen offset:0
v_exp_f32 v20,v20
v_exp_f32 v21,v21
v_exp_f32 v22,v22
v_exp_f32 v23,v23
v_cvt_pk_bf16_f32 v50,v20,v21
v_cvt_pk_bf16_f32 v51,v22,v23
v_mfma_f32_32x32x16_bf16 v[136:151],a[40:43],v[56:59],v[136:151]
v_exp_f32 v24,v24
v_exp_f32 v25,v25
v_exp_f32 v26,v26
v_exp_f32 v27,v27
v_cvt_pk_bf16_f32 v52,v24,v25
v_cvt_pk_bf16_f32 v53,v26,v27
v_mfma_f32_32x32x16_bf16 v[136:151],a[44:47],v[60:63],v[136:151]
v_exp_f32 v28,v28
v_exp_f32 v29,v29
v_exp_f32 v30,v30
v_exp_f32 v31,v31
v_cvt_pk_bf16_f32 v54,v28,v29
v_cvt_pk_bf16_f32 v55,v30,v31
v_mfma_f32_32x32x16_bf16 v[16:31],a[32:35],v[96:99],0
buffer_load_dwordx4 a[180:183],v2,s[8:11],s5 offen offset:1024
v_exp_f32 v32,v32
v_exp_f32 v33,v33
v_exp_f32 v34,v34
v_exp_f32 v35,v35
v_cvt_pk_bf16_f32 v56,v32,v33
v_cvt_pk_bf16_f32 v57,v34,v35
v_mfma_f32_32x32x16_bf16 v[16:31],a[36:39],v[100:103],v[16:31]
v_exp_f32 v36,v36
v_exp_f32 v37,v37
v_exp_f32 v38,v38
v_exp_f32 v39,v39
v_cvt_pk_bf16_f32 v58,v36,v37
v_cvt_pk_bf16_f32 v59,v38,v39
v_mfma_f32_32x32x16_bf16 v[152:167],a[40:43],v[48:51],v[152:167]
v_exp_f32 v40,v40
v_exp_f32 v41,v41
v_exp_f32 v42,v42
v_exp_f32 v43,v43
v_cvt_pk_bf16_f32 v60,v40,v41
v_cvt_pk_bf16_f32 v61,v42,v43
v_mfma_f32_32x32x16_bf16 v[152:167],a[44:47],v[52:55],v[152:167]
buffer_load_dwordx4 a[184:187],v2,s[8:11],s5 offen offset:2048
v_exp_f32 v44,v44
v_exp_f32 v45,v45
v_exp_f32 v46,v46
v_exp_f32 v47,v47
v_cvt_pk_bf16_f32 v62,v44,v45
v_cvt_pk_bf16_f32 v63,v46,v47
v_mfma_f32_32x32x16_bf16 v[32:47],a[32:35],v[104:107],0
v_exp_f32 v16,v16
v_exp_f32 v17,v17
v_exp_f32 v18,v18
v_exp_f32 v19,v19
v_cvt_pk_bf16_f32 v48,v16,v17
v_cvt_pk_bf16_f32 v49,v18,v19
v_mfma_f32_32x32x16_bf16 v[32:47],a[36:39],v[108:111],v[32:47]
v_exp_f32 v20,v20
v_exp_f32 v21,v21
v_exp_f32 v22,v22
v_exp_f32 v23,v23
v_cvt_pk_bf16_f32 v50,v20,v21
v_cvt_pk_bf16_f32 v51,v22,v23
v_mfma_f32_32x32x16_bf16 v[168:183],a[40:43],v[56:59],v[168:183]
buffer_load_dwordx4 a[188:191],v2,s[8:11],s5 offen offset:3072
v_exp_f32 v24,v24
v_exp_f32 v25,v25
v_exp_f32 v26,v26
v_exp_f32 v27,v27
v_cvt_pk_bf16_f32 v52,v24,v25
v_cvt_pk_bf16_f32 v53,v26,v27
v_mfma_f32_32x32x16_bf16 v[168:183],a[44:47],v[60:63],v[168:183]
v_exp_f32 v28,v28
v_exp_f32 v29,v29
v_exp_f32 v30,v30
v_exp_f32 v31,v31
v_cvt_pk_bf16_f32 v54,v28,v29
v_cvt_pk_bf16_f32 v55,v30,v31
v_mfma_f32_32x32x16_bf16 v[16:31],a[32:35],v[112:115],0
v_exp_f32 v32,v32
v_exp_f32 v33,v33
v_exp_f32 v34,v34
v_exp_f32 v35,v35
v_cvt_pk_bf16_f32 v56,v32,v33
v_cvt_pk_bf16_f32 v57,v34,v35
v_mfma_f32_32x32x16_bf16 v[16:31],a[36:39],v[116:119],v[16:31]
s_mov_b32 s43,s23
s_add_u32 s23,s23,32768
s_add_u32 m0,s43,0
s_add_u32 s22,s22,28672
buffer_load_dwordx4 v2,s[12:15],s22 offen offset:0 lds
v_exp_f32 v36,v36
v_exp_f32 v37,v37
v_exp_f32 v38,v38
v_exp_f32 v39,v39
v_cvt_pk_bf16_f32 v58,v36,v37
v_cvt_pk_bf16_f32 v59,v38,v39
v_mfma_f32_32x32x16_bf16 v[184:199],a[40:43],v[48:51],v[184:199]
v_exp_f32 v40,v40
v_exp_f32 v41,v41
v_exp_f32 v42,v42
v_exp_f32 v43,v43
v_cvt_pk_bf16_f32 v60,v40,v41
v_cvt_pk_bf16_f32 v61,v42,v43
v_mfma_f32_32x32x16_bf16 v[184:199],a[44:47],v[52:55],v[184:199]
v_exp_f32 v44,v44
v_exp_f32 v45,v45
v_exp_f32 v46,v46
v_exp_f32 v47,v47
v_cvt_pk_bf16_f32 v62,v44,v45
v_cvt_pk_bf16_f32 v63,v46,v47
s_waitcnt vmcnt(25)
v_mfma_f32_32x32x16_bf16 v[32:47],a[48:51],v[64:67],0
buffer_load_dwordx4 v2,s[12:15],s22 offen offset:1024 lds
v_exp_f32 v16,v16
v_exp_f32 v17,v17
v_exp_f32 v18,v18
v_exp_f32_e64 v19,v19
v_cvt_pk_bf16_f32 v48,v16,v17
v_cvt_pk_bf16_f32 v49,v18,v19
v_mfma_f32_32x32x16_bf16 v[32:47],a[52:55],v[68:71],v[32:47]
v_exp_f32 v20,v20
v_exp_f32 v21,v21
v_exp_f32 v22,v22
v_exp_f32 v23,v23
v_cvt_pk_bf16_f32 v50,v20,v21
v_cvt_pk_bf16_f32 v51,v22,v23
v_mfma_f32_32x32x16_bf16 v[200:215],a[40:43],v[56:59],v[200:215]
v_exp_f32 v24,v24
v_exp_f32 v25,v25
v_exp_f32 v26,v26
v_exp_f32 v27,v27
v_cvt_pk_bf16_f32 v52,v24,v25
v_cvt_pk_bf16_f32 v53,v26,v27
v_mfma_f32_32x32x16_bf16 v[200:215],a[44:47],v[60:63],v[200:215]
buffer_load_dwordx4 v2,s[12:15],s22 offen offset:2048 lds
v_exp_f32 v28,v28
v_exp_f32 v29,v29
v_exp_f32 v30,v30
v_exp_f32 v31,v31
v_cvt_pk_bf16_f32 v54,v28,v29
v_cvt_pk_bf16_f32 v55,v30,v31
v_mfma_f32_32x32x16_bf16 v[16:31],a[48:51],v[72:75],0
v_exp_f32 v32,v32
v_exp_f32 v33,v33
v_exp_f32 v34,v34
v_exp_f32 v35,v35
v_cvt_pk_bf16_f32 v56,v32,v33
v_cvt_pk_bf16_f32 v57,v34,v35
v_mfma_f32_32x32x16_bf16 v[16:31],a[52:55],v[76:79],v[16:31]
v_exp_f32 v36,v36
v_exp_f32 v37,v37
v_exp_f32 v38,v38
v_exp_f32 v39,v39
v_cvt_pk_bf16_f32 v58,v36,v37
v_cvt_pk_bf16_f32 v59,v38,v39
v_mfma_f32_32x32x16_bf16 v[216:231],a[40:43],v[48:51],v[216:231]
buffer_load_dwordx4 v2,s[12:15],s22 offen offset:3072 lds
v_exp_f32 v40,v40
v_exp_f32 v41,v41
v_exp_f32 v42,v42
v_exp_f32 v43,v43
v_cvt_pk_bf16_f32 v60,v40,v41
v_cvt_pk_bf16_f32 v61,v42,v43
v_mfma_f32_32x32x16_bf16 v[216:231],a[44:47],v[52:55],v[216:231]
v_exp_f32 v44,v44
v_exp_f32 v45,v45
v_exp_f32 v46,v46
v_exp_f32 v47,v47
v_cvt_pk_bf16_f32 v62,v44,v45
v_cvt_pk_bf16_f32 v63,v46,v47
v_mfma_f32_32x32x16_bf16 v[32:47],a[48:51],v[80:83],0
v_exp_f32 v16,v16
v_exp_f32 v17,v17
v_exp_f32 v18,v18
v_exp_f32 v19,v19
v_cvt_pk_bf16_f32 v48,v16,v17
v_cvt_pk_bf16_f32 v49,v18,v19
v_mfma_f32_32x32x16_bf16 v[32:47],a[52:55],v[84:87],v[32:47]
s_add_u32 m0,s43,4096
s_add_u32 s22,s22,4096
buffer_load_dwordx4 v2,s[12:15],s22 offen offset:0 lds
v_exp_f32 v20,v20
v_exp_f32 v21,v21
v_exp_f32 v22,v22
v_exp_f32 v23,v23
v_cvt_pk_bf16_f32 v50,v20,v21
v_cvt_pk_bf16_f32 v51,v22,v23
v_mfma_f32_32x32x16_bf16 v[120:135],a[56:59],v[56:59],v[120:135]
v_exp_f32 v24,v24
v_exp_f32 v25,v25
v_exp_f32 v26,v26
v_exp_f32 v27,v27
v_cvt_pk_bf16_f32 v52,v24,v25
v_cvt_pk_bf16_f32 v53,v26,v27
v_mfma_f32_32x32x16_bf16 v[120:135],a[60:63],v[60:63],v[120:135]
v_exp_f32 v28,v28
v_exp_f32 v29,v29
v_exp_f32 v30,v30
v_exp_f32 v31,v31
v_cvt_pk_bf16_f32 v54,v28,v29
v_cvt_pk_bf16_f32 v55,v30,v31
v_mfma_f32_32x32x16_bf16 v[16:31],a[48:51],v[88:91],0
buffer_load_dwordx4 v2,s[12:15],s22 offen offset:1024 lds
v_exp_f32 v32,v32
v_exp_f32 v33,v33
v_exp_f32 v34,v34
v_exp_f32 v35,v35
v_cvt_pk_bf16_f32 v56,v32,v33
v_cvt_pk_bf16_f32 v57,v34,v35
v_mfma_f32_32x32x16_bf16 v[16:31],a[52:55],v[92:95],v[16:31]
v_exp_f32 v36,v36
v_exp_f32 v37,v37
v_exp_f32 v38,v38
v_exp_f32 v39,v39
v_cvt_pk_bf16_f32 v58,v36,v37
v_cvt_pk_bf16_f32 v59,v38,v39
v_mfma_f32_32x32x16_bf16 v[136:151],a[56:59],v[48:51],v[136:151]
v_exp_f32 v40,v40
v_exp_f32 v41,v41
v_exp_f32 v42,v42
v_exp_f32 v43,v43
v_cvt_pk_bf16_f32 v60,v40,v41
v_cvt_pk_bf16_f32 v61,v42,v43
v_mfma_f32_32x32x16_bf16 v[136:151],a[60:63],v[52:55],v[136:151]
buffer_load_dwordx4 v2,s[12:15],s22 offen offset:2048 lds
v_exp_f32 v44,v44
v_exp_f32 v45,v45
v_exp_f32 v46,v46
v_exp_f32 v47,v47
v_cvt_pk_bf16_f32 v62,v44,v45
v_cvt_pk_bf16_f32 v63,v46,v47
v_mfma_f32_32x32x16_bf16 v[32:47],a[48:51],v[96:99],0
v_exp_f32 v16,v16
v_exp_f32 v17,v17
v_exp_f32 v18,v18
v_exp_f32 v19,v19
v_cvt_pk_bf16_f32 v48,v16,v17
v_cvt_pk_bf16_f32 v49,v18,v19
v_mfma_f32_32x32x16_bf16 v[32:47],a[52:55],v[100:103],v[32:47]
v_exp_f32 v20,v20
v_exp_f32 v21,v21
v_exp_f32 v22,v22
v_exp_f32 v23,v23
v_cvt_pk_bf16_f32 v50,v20,v21
v_cvt_pk_bf16_f32 v51,v22,v23
v_mfma_f32_32x32x16_bf16 v[152:167],a[56:59],v[56:59],v[152:167]
buffer_load_dwordx4 v2,s[12:15],s22 offen offset:3072 lds
v_exp_f32 v24,v24
v_exp_f32 v25,v25
v_exp_f32 v26,v26
v_exp_f32 v27,v27
v_cvt_pk_bf16_f32 v52,v24,v25
v_cvt_pk_bf16_f32 v53,v26,v27
v_mfma_f32_32x32x16_bf16 v[152:167],a[60:63],v[60:63],v[152:167]
v_exp_f32 v28,v28
v_exp_f32 v29,v29
v_exp_f32 v30,v30
v_exp_f32 v31,v31
v_cvt_pk_bf16_f32 v54,v28,v29
v_cvt_pk_bf16_f32 v55,v30,v31
v_mfma_f32_32x32x16_bf16 v[16:31],a[48:51],v[104:107],0
v_exp_f32 v32,v32
v_exp_f32 v33,v33
v_exp_f32 v34,v34
v_exp_f32 v35,v35
v_cvt_pk_bf16_f32 v56,v32,v33
v_cvt_pk_bf16_f32 v57,v34,v35
v_mfma_f32_32x32x16_bf16 v[16:31],a[52:55],v[108:111],v[16:31]
v_exp_f32 v36,v36
v_exp_f32 v37,v37
v_exp_f32 v38,v38
v_exp_f32 v39,v39
v_cvt_pk_bf16_f32 v58,v36,v37
v_cvt_pk_bf16_f32 v59,v38,v39
v_mfma_f32_32x32x16_bf16 v[168:183],a[56:59],v[48:51],v[168:183]
v_exp_f32 v40,v40
v_exp_f32 v41,v41
v_exp_f32 v42,v42
v_exp_f32 v43,v43
v_cvt_pk_bf16_f32 v60,v40,v41
v_cvt_pk_bf16_f32 v61,v42,v43
v_mfma_f32_32x32x16_bf16 v[168:183],a[60:63],v[52:55],v[168:183]
v_exp_f32 v44,v44
v_exp_f32 v45,v45
v_exp_f32 v46,v46
v_exp_f32 v47,v47
v_cvt_pk_bf16_f32 v62,v44,v45
v_cvt_pk_bf16_f32 v63,v46,v47
v_mfma_f32_32x32x16_bf16 v[32:47],a[48:51],v[112:115],0
v_exp_f32 v16,v16
v_exp_f32 v17,v17
v_exp_f32 v18,v18
v_exp_f32 v19,v19
v_cvt_pk_bf16_f32 v48,v16,v17
v_cvt_pk_bf16_f32 v49,v18,v19
v_mfma_f32_32x32x16_bf16 v[32:47],a[52:55],v[116:119],v[32:47]
v_exp_f32 v20,v20
v_exp_f32 v21,v21
v_exp_f32 v22,v22
v_exp_f32 v23,v23
v_cvt_pk_bf16_f32 v50,v20,v21
v_cvt_pk_bf16_f32 v51,v22,v23
v_mfma_f32_32x32x16_bf16 v[184:199],a[56:59],v[56:59],v[184:199]
v_exp_f32 v24,v24
v_exp_f32 v25,v25
v_exp_f32 v26,v26
v_exp_f32 v27,v27
v_cvt_pk_bf16_f32 v52,v24,v25
v_cvt_pk_bf16_f32 v53,v26,v27
v_mfma_f32_32x32x16_bf16 v[184:199],a[60:63],v[60:63],v[184:199]
v_exp_f32 v28,v28
v_exp_f32 v29,v29
v_exp_f32 v30,v30
v_exp_f32 v31,v31
v_cvt_pk_bf16_f32 v54,v28,v29
v_cvt_pk_bf16_f32 v55,v30,v31
v_exp_f32 v32,v32
v_exp_f32 v33,v33
v_exp_f32 v34,v34
v_exp_f32 v35,v35
v_cvt_pk_bf16_f32 v56,v32,v33
v_cvt_pk_bf16_f32 v57,v34,v35
v_exp_f32 v36,v36
v_exp_f32 v37,v37
v_exp_f32 v38,v38
v_exp_f32 v39,v39
v_cvt_pk_bf16_f32 v58,v36,v37
v_cvt_pk_bf16_f32 v59,v38,v39
v_mfma_f32_32x32x16_bf16 v[200:215],a[56:59],v[48:51],v[200:215]
v_exp_f32 v40,v40
v_exp_f32 v41,v41
v_exp_f32 v42,v42
v_exp_f32 v43,v43
v_cvt_pk_bf16_f32 v60,v40,v41
v_cvt_pk_bf16_f32 v61,v42,v43
v_mfma_f32_32x32x16_bf16 v[200:215],a[60:63],v[52:55],v[200:215]
v_exp_f32 v44,v44
v_exp_f32 v45,v45
v_exp_f32 v46,v46
v_exp_f32 v47,v47
v_cvt_pk_bf16_f32 v62,v44,v45
v_cvt_pk_bf16_f32 v63,v46,v47
s_nop 1
v_mfma_f32_32x32x16_bf16 v[216:231],a[56:59],v[56:59],v[216:231]
s_nop 0
v_mfma_f32_32x32x16_bf16 v[216:231],a[60:63],v[60:63],v[216:231]
s_mul_i32 s24,s37,36864
s_add_u32 s24,s24,79691776
s_lshl_b32 s25,s16,10
s_add_u32 s40,s25,s24
s_lshr_b32 s26,s16,3
s_lshl_b32 s26,s26,10
s_add_u32 s24,s24,s26
s_bfe_u32 s26,s16,0x10002
s_lshl_b32 s26,s26,9
s_add_u32 s24,s24,s26
s_and_b32 s26,s16,3
s_lshl_b32 s26,s26,2
s_add_u32 s24,s24,s26
s_add_u32 s38,s24,32768
v_mov_b32 v14,0x80000000
v_cndmask_b32 v14,v2,v14,s[96:97]
s_cmp_eq_u32 s57,0
s_cbranch_scc1 att7_fin
s_mul_i32 s24,s18,24576
s_add_u32 s24,s24,65536
v_add_u32_e64 v12,s24,v2
ds_write_b128 v12,v[120:123] offset:0
ds_write_b128 v12,v[124:127] offset:1024
ds_write_b128 v12,v[128:131] offset:2048
ds_write_b128 v12,v[136:139] offset:3072
ds_write_b128 v12,v[140:143] offset:4096
ds_write_b128 v12,v[144:147] offset:5120
ds_write_b128 v12,v[152:155] offset:6144
ds_write_b128 v12,v[156:159] offset:7168
ds_write_b128 v12,v[160:163] offset:8192
ds_write_b128 v12,v[168:171] offset:9216
ds_write_b128 v12,v[172:175] offset:10240
ds_write_b128 v12,v[176:179] offset:11264
ds_write_b128 v12,v[184:187] offset:12288
ds_write_b128 v12,v[188:191] offset:13312
ds_write_b128 v12,v[192:195] offset:14336
ds_write_b128 v12,v[200:203] offset:15360
ds_write_b128 v12,v[204:207] offset:16384
ds_write_b128 v12,v[208:211] offset:17408
ds_write_b128 v12,v[216:219] offset:18432
ds_write_b128 v12,v[220:223] offset:19456
ds_write_b128 v12,v[224:227] offset:20480
s_waitcnt lgkmcnt(0)
s_barrier
s_xor_b32 s24,s18,1
s_mul_i32 s24,s24,24576
s_add_u32 s24,s24,65536
v_add_u32_e64 v60,s24,v2
s_xor_b32 s24,s18,2
s_mul_i32 s24,s24,24576
s_add_u32 s24,s24,65536
v_add_u32 v61,s24,v2
s_xor_b32 s24,s18,3
s_mul_i32 s24,s24,24576
s_add_u32 s24,s24,65536
v_add_u32_e64 v62,s24,v2
att7_fin:
s_nop 7
s_lshl_b32 s24,1,s57
s_sub_u32 s24,s24,1
s_and_b32 s24,s24,0
s_cmp_lg_u32 s24,s58
s_cbranch_scc1 att7_skip0
s_cmp_eq_u32 s57,0
s_cbranch_scc1 att7_c0
ds_read_b128 v[16:19],v60 offset:0
ds_read_b128 v[20:23],v60 offset:1024
ds_read_b128 v[24:27],v60 offset:2048
s_waitcnt lgkmcnt(0)
v_add_f32 v120,v120,v16
v_add_f32 v121,v121,v17
v_add_f32 v122,v122,v18
v_add_f32 v123,v123,v19
v_add_f32 v124,v124,v20
v_add_f32 v125,v125,v21
v_add_f32 v126,v126,v22
v_add_f32 v127,v127,v23
v_add_f32 v128,v128,v24
v_add_f32 v129,v129,v25
v_add_f32_e64 v130,v130,v26
att7_c0:
s_mov_b64 vcc,exec
v_cmp_le_f32 s[24:25],s44,v130
v_cmp_ge_f32 s[26:27],s45,v130
s_and_b64 vcc,vcc,s[24:25]
s_and_b64 vcc,vcc,s[26:27]
s_cmp_eq_u64 vcc,exec
s_cbranch_scc0 att7_fb0
att7_ok0:
v_rcp_f32 v130,v130
s_nop 0
v_mul_f32 v120,v130,v120
v_mul_f32 v121,v130,v121
v_mul_f32 v122,v130,v122
v_mul_f32 v123,v130,v123
v_mul_f32 v124,v130,v124
v_mul_f32 v125,v130,v125
v_mul_f32 v126,v130,v126
v_mul_f32 v127,v130,v127
v_mul_f32 v128,v130,v128
v_mul_f32 v129,v130,v129
v_cvt_pk_bf16_f32 v132,v120,v121
v_cvt_pk_bf16_f32 v133,v122,v123
v_cvt_pk_bf16_f32 v134,v124,v125
v_cvt_pk_bf16_f32 v135,v126,v127
v_cvt_pk_bf16_f32 v131,v128,v129
buffer_store_dwordx4 v[132:135],v2,s[8:11],s40 offen
buffer_store_dword v131,v14,s[8:11],s38 offen
att7_skip0:
s_add_u32 s40,s40,36864
s_add_u32 s38,s38,36864
s_lshl_b32 s24,1,s57
s_sub_u32 s24,s24,1
s_and_b32 s24,s24,1
s_cmp_lg_u32 s24,s58
s_cbranch_scc1 att7_skip1
s_cmp_eq_u32 s57,0
s_cbranch_scc1 att7_c1
ds_read_b128 v[16:19],v60 offset:3072
ds_read_b128 v[20:23],v60 offset:4096
ds_read_b128 v[24:27],v60 offset:5120
s_waitcnt lgkmcnt(0)
v_add_f32 v136,v136,v16
v_add_f32 v137,v137,v17
v_add_f32 v138,v138,v18
v_add_f32 v139,v139,v19
v_add_f32 v140,v140,v20
v_add_f32 v141,v141,v21
v_add_f32 v142,v142,v22
v_add_f32 v143,v143,v23
v_add_f32 v144,v144,v24
v_add_f32 v145,v145,v25
v_add_f32 v146,v146,v26
att7_c1:
s_mov_b64 vcc,exec
v_cmp_le_f32 s[24:25],s44,v146
v_cmp_ge_f32 s[26:27],s45,v146
s_and_b64 vcc,vcc,s[24:25]
s_and_b64 vcc,vcc,s[26:27]
s_cmp_eq_u64 vcc,exec
s_cbranch_scc0 att7_fb1
att7_ok1:
v_rcp_f32 v146,v146
s_nop 0
v_mul_f32 v136,v146,v136
v_mul_f32 v137,v146,v137
v_mul_f32 v138,v146,v138
v_mul_f32 v139,v146,v139
v_mul_f32 v140,v146,v140
v_mul_f32 v141,v146,v141
v_mul_f32 v142,v146,v142
v_mul_f32 v143,v146,v143
v_mul_f32 v144,v146,v144
v_mul_f32 v145,v146,v145
v_cvt_pk_bf16_f32 v148,v136,v137
v_cvt_pk_bf16_f32 v149,v138,v139
v_cvt_pk_bf16_f32 v150,v140,v141
v_cvt_pk_bf16_f32 v151,v142,v143
v_cvt_pk_bf16_f32 v147,v144,v145
buffer_store_dwordx4 v[148:151],v2,s[8:11],s40 offen
buffer_store_dword v147,v14,s[8:11],s38 offen
att7_skip1:
s_add_u32 s40,s40,36864
s_add_u32 s38,s38,36864
s_lshl_b32 s24,1,s57
s_sub_u32 s24,s24,1
s_and_b32 s24,s24,2
s_cmp_lg_u32 s24,s58
s_cbranch_scc1 att7_skip2
s_cmp_eq_u32 s57,0
s_cbranch_scc1 att7_c2
ds_read_b128 v[16:19],v60 offset:6144
ds_read_b128 v[20:23],v60 offset:7168
ds_read_b128 v[24:27],v60 offset:8192
s_waitcnt lgkmcnt(0)
v_add_f32 v152,v152,v16
v_add_f32 v153,v153,v17
v_add_f32 v154,v154,v18
v_add_f32 v155,v155,v19
v_add_f32 v156,v156,v20
v_add_f32 v157,v157,v21
v_add_f32 v158,v158,v22
v_add_f32 v159,v159,v23
v_add_f32 v160,v160,v24
v_add_f32 v161,v161,v25
v_add_f32 v162,v162,v26
att7_c2:
s_mov_b64 vcc,exec
v_cmp_le_f32 s[24:25],s44,v162
v_cmp_ge_f32 s[26:27],s45,v162
s_and_b64 vcc,vcc,s[24:25]
s_and_b64 vcc,vcc,s[26:27]
s_cmp_eq_u64 vcc,exec
s_cbranch_scc0 att7_fb2
att7_ok2:
v_rcp_f32 v162,v162
s_nop 0
v_mul_f32 v152,v162,v152
v_mul_f32 v153,v162,v153
v_mul_f32 v154,v162,v154
v_mul_f32 v155,v162,v155
v_mul_f32 v156,v162,v156
v_mul_f32 v157,v162,v157
v_mul_f32 v158,v162,v158
v_mul_f32 v159,v162,v159
v_mul_f32 v160,v162,v160
v_mul_f32 v161,v162,v161
v_cvt_pk_bf16_f32 v164,v152,v153
v_cvt_pk_bf16_f32 v165,v154,v155
v_cvt_pk_bf16_f32 v166,v156,v157
v_cvt_pk_bf16_f32 v167,v158,v159
v_cvt_pk_bf16_f32 v163,v160,v161
buffer_store_dwordx4 v[164:167],v2,s[8:11],s40 offen
buffer_store_dword v163,v14,s[8:11],s38 offen
att7_skip2:
s_add_u32 s40,s40,36864
s_add_u32 s38,s38,36864
s_lshl_b32 s24,1,s57
s_sub_u32 s24,s24,1
s_and_b32 s24,s24,3
s_cmp_lg_u32 s24,s58
s_cbranch_scc1 att7_skip3
s_cmp_eq_u32 s57,0
s_cbranch_scc1 att7_c3
ds_read_b128 v[16:19],v60 offset:9216
ds_read_b128 v[20:23],v60 offset:10240
ds_read_b128 v[24:27],v60 offset:11264
s_waitcnt lgkmcnt(0)
v_add_f32 v168,v168,v16
v_add_f32 v169,v169,v17
v_add_f32 v170,v170,v18
v_add_f32 v171,v171,v19
v_add_f32 v172,v172,v20
v_add_f32 v173,v173,v21
v_add_f32 v174,v174,v22
v_add_f32 v175,v175,v23
v_add_f32 v176,v176,v24
v_add_f32 v177,v177,v25
v_add_f32 v178,v178,v26
att7_c3:
s_mov_b64 vcc,exec
v_cmp_le_f32 s[24:25],s44,v178
v_cmp_ge_f32 s[26:27],s45,v178
s_and_b64 vcc,vcc,s[24:25]
s_and_b64 vcc,vcc,s[26:27]
s_cmp_eq_u64 vcc,exec
s_cbranch_scc0 att7_fb3
att7_ok3:
v_rcp_f32 v178,v178
s_nop 0
v_mul_f32 v168,v178,v168
v_mul_f32 v169,v178,v169
v_mul_f32 v170,v178,v170
v_mul_f32 v171,v178,v171
v_mul_f32 v172,v178,v172
v_mul_f32 v173,v178,v173
v_mul_f32 v174,v178,v174
v_mul_f32 v175,v178,v175
v_mul_f32 v176,v178,v176
v_mul_f32 v177,v178,v177
v_cvt_pk_bf16_f32 v180,v168,v169
v_cvt_pk_bf16_f32 v181,v170,v171
v_cvt_pk_bf16_f32 v182,v172,v173
v_cvt_pk_bf16_f32 v183,v174,v175
v_cvt_pk_bf16_f32 v179,v176,v177
buffer_store_dwordx4 v[180:183],v2,s[8:11],s40 offen
buffer_store_dword v179,v14,s[8:11],s38 offen
att7_skip3:
s_add_u32 s40,s40,36864
s_add_u32 s38,s38,36864
s_lshl_b32 s24,1,s57
s_sub_u32 s24,s24,1
s_and_b32 s24,s24,4
s_cmp_lg_u32 s24,s58
s_cbranch_scc1 att7_skip4
s_cmp_eq_u32 s57,0
s_cbranch_scc1 att7_c4
ds_read_b128 v[16:19],v60 offset:12288
ds_read_b128 v[20:23],v60 offset:13312
ds_read_b128 v[24:27],v60 offset:14336
s_waitcnt lgkmcnt(0)
v_add_f32 v184,v184,v16
v_add_f32 v185,v185,v17
v_add_f32 v186,v186,v18
v_add_f32 v187,v187,v19
v_add_f32 v188,v188,v20
v_add_f32 v189,v189,v21
v_add_f32 v190,v190,v22
v_add_f32 v191,v191,v23
v_add_f32 v192,v192,v24
v_add_f32 v193,v193,v25
v_add_f32 v194,v194,v26
att7_c4:
s_mov_b64 vcc,exec
v_cmp_le_f32 s[24:25],s44,v194
v_cmp_ge_f32 s[26:27],s45,v194
s_and_b64 vcc,vcc,s[24:25]
s_and_b64 vcc,vcc,s[26:27]
s_cmp_eq_u64 vcc,exec
s_cbranch_scc0 att7_fb4
att7_ok4:
v_rcp_f32 v194,v194
s_nop 0
v_mul_f32 v184,v194,v184
v_mul_f32 v185,v194,v185
v_mul_f32 v186,v194,v186
v_mul_f32 v187,v194,v187
v_mul_f32 v188,v194,v188
v_mul_f32 v189,v194,v189
v_mul_f32 v190,v194,v190
v_mul_f32 v191,v194,v191
v_mul_f32 v192,v194,v192
v_mul_f32 v193,v194,v193
v_cvt_pk_bf16_f32 v196,v184,v185
v_cvt_pk_bf16_f32 v197,v186,v187
v_cvt_pk_bf16_f32 v198,v188,v189
v_cvt_pk_bf16_f32 v199,v190,v191
v_cvt_pk_bf16_f32 v195,v192,v193
buffer_store_dwordx4 v[196:199],v2,s[8:11],s40 offen
buffer_store_dword v195,v14,s[8:11],s38 offen
att7_skip4:
s_add_u32 s40,s40,36864
s_add_u32 s38,s38,36864
s_lshl_b32 s24,1,s57
s_sub_u32 s24,s24,1
s_and_b32 s24,s24,5
s_cmp_lg_u32 s24,s58
s_cbranch_scc1 att7_skip5
s_cmp_eq_u32 s57,0
s_cbranch_scc1 att7_c5
ds_read_b128 v[16:19],v60 offset:15360
ds_read_b128 v[20:23],v60 offset:16384
ds_read_b128 v[24:27],v60 offset:17408
s_waitcnt lgkmcnt(0)
v_add_f32 v200,v200,v16
v_add_f32 v201,v201,v17
v_add_f32 v202,v202,v18
v_add_f32 v203,v203,v19
v_add_f32 v204,v204,v20
v_add_f32 v205,v205,v21
v_add_f32 v206,v206,v22
v_add_f32 v207,v207,v23
v_add_f32 v208,v208,v24
v_add_f32 v209,v209,v25
v_add_f32 v210,v210,v26
att7_c5:
s_mov_b64 vcc,exec
v_cmp_le_f32 s[24:25],s44,v210
v_cmp_ge_f32 s[26:27],s45,v210
s_and_b64 vcc,vcc,s[24:25]
s_and_b64 vcc,vcc,s[26:27]
s_cmp_eq_u64 vcc,exec
s_cbranch_scc0 att7_fb5
att7_ok5:
v_rcp_f32 v210,v210
s_nop 0
v_mul_f32 v200,v210,v200
v_mul_f32 v201,v210,v201
v_mul_f32 v202,v210,v202
v_mul_f32 v203,v210,v203
v_mul_f32 v204,v210,v204
v_mul_f32 v205,v210,v205
v_mul_f32 v206,v210,v206
v_mul_f32 v207,v210,v207
v_mul_f32 v208,v210,v208
v_mul_f32 v209,v210,v209
v_cvt_pk_bf16_f32 v212,v200,v201
v_cvt_pk_bf16_f32 v213,v202,v203
v_cvt_pk_bf16_f32 v214,v204,v205
v_cvt_pk_bf16_f32 v215,v206,v207
v_cvt_pk_bf16_f32 v211,v208,v209
buffer_store_dwordx4 v[212:215],v2,s[8:11],s40 offen
buffer_store_dword v211,v14,s[8:11],s38 offen
att7_skip5:
s_add_u32 s40,s40,36864
s_add_u32 s38,s38,36864
s_lshl_b32 s24,1,s57
s_sub_u32 s24,s24,1
s_and_b32 s24,s24,6
s_cmp_lg_u32 s24,s58
s_cbranch_scc1 att7_skip6
s_cmp_eq_u32 s57,0
s_cbranch_scc1 att7_c6
ds_read_b128 v[16:19],v60 offset:18432
ds_read_b128 v[20:23],v60 offset:19456
ds_read_b128 v[24:27],v60 offset:20480
s_waitcnt lgkmcnt(0)
v_add_f32 v216,v216,v16
v_add_f32 v217,v217,v17
v_add_f32 v218,v218,v18
v_add_f32 v219,v219,v19
v_add_f32 v220,v220,v20
v_add_f32 v221,v221,v21
v_add_f32 v222,v222,v22
v_add_f32 v223,v223,v23
v_add_f32 v224,v224,v24
v_add_f32 v225,v225,v25
v_add_f32 v226,v226,v26
att7_c6:
s_mov_b64 vcc,exec
v_cmp_le_f32 s[24:25],s44,v226
v_cmp_ge_f32 s[26:27],s45,v226
s_and_b64 vcc,vcc,s[24:25]
s_and_b64 vcc,vcc,s[26:27]
s_cmp_eq_u64 vcc,exec
s_cbranch_scc0 att7_fb6
att7_ok6:
v_rcp_f32 v226,v226
s_nop 0
v_mul_f32 v216,v226,v216
v_mul_f32 v217,v226,v217
v_mul_f32 v218,v226,v218
v_mul_f32 v219,v226,v219
v_mul_f32 v220,v226,v220
v_mul_f32 v221,v226,v221
v_mul_f32 v222,v226,v222
v_mul_f32 v223,v226,v223
v_mul_f32 v224,v226,v224
v_mul_f32 v225,v226,v225
v_cvt_pk_bf16_f32 v228,v216,v217
v_cvt_pk_bf16_f32 v229,v218,v219
v_cvt_pk_bf16_f32 v230,v220,v221
v_cvt_pk_bf16_f32 v231,v222,v223
v_cvt_pk_bf16_f32 v227,v224,v225
buffer_store_dwordx4 v[228:231],v2,s[8:11],s40 offen
buffer_store_dword v227,v14,s[8:11],s38 offen
att7_skip6:
s_add_u32 s40,s40,36864
s_add_u32 s38,s38,36864
s_cmp_eq_u32 s57,0
s_cbranch_scc1 k2_B
s_barrier
s_branch k2_B
k2_B:
s_cmp_eq_u32 s46,3
s_cbranch_scc1 k2_B2
v_lshrrev_b32 v20,5,v1
v_lshlrev_b32 v18,8,v20
v_bfe_u32 v21,v1,2,2
v_lshlrev_b32 v21,6,v21
v_add_u32 v18,v18,v21
v_bfe_u32 v21,v1,4,1
v_lshlrev_b32 v21,5,v21
v_add_u32 v18,v18,v21
v_and_b32 v21,3,v1
v_lshlrev_b32 v21,3,v21
v_add_u32 v18,v18,v21
v_add_u32 v18,s42,v18
ds_read_b64_tr_b16 v[32:33],v18 offset:0
ds_read_b64_tr_b16 v[34:35],v18 offset:512
ds_read_b64_tr_b16 v[36:37],v18 offset:1024
ds_read_b64_tr_b16 v[38:39],v18 offset:1536
ds_read_b64_tr_b16 v[40:41],v18 offset:2048
ds_read_b64_tr_b16 v[42:43],v18 offset:2560
ds_read_b64_tr_b16 v[44:45],v18 offset:3072
ds_read_b64_tr_b16 v[46:47],v18 offset:3584
s_waitcnt lgkmcnt(4)
ds_read_b64_tr_b16 v[48:49],v18 offset:4096
ds_read_b64_tr_b16 v[50:51],v18 offset:4608
ds_read_b64_tr_b16 v[52:53],v18 offset:5120
ds_read_b64_tr_b16 v[54:55],v18 offset:5632
ds_read_b64_tr_b16 v[56:57],v18 offset:6144
ds_read_b64_tr_b16 v[58:59],v18 offset:6656
ds_read_b64_tr_b16 v[60:61],v18 offset:7168
ds_read_b64_tr_b16 v[62:63],v18 offset:7680
s_waitcnt lgkmcnt(4)
ds_read_b64_tr_b16 v[64:65],v18 offset:8192
ds_read_b64_tr_b16 v[66:67],v18 offset:8704
ds_read_b64_tr_b16 v[68:69],v18 offset:9216
ds_read_b64_tr_b16 v[70:71],v18 offset:9728
ds_read_b64_tr_b16 v[72:73],v18 offset:10240
ds_read_b64_tr_b16 v[74:75],v18 offset:10752
ds_read_b64_tr_b16 v[76:77],v18 offset:11264
ds_read_b64_tr_b16 v[78:79],v18 offset:11776
s_waitcnt lgkmcnt(4)
ds_read_b64_tr_b16 v[80:81],v18 offset:12288
ds_read_b64_tr_b16 v[82:83],v18 offset:12800
ds_read_b64_tr_b16 v[84:85],v18 offset:13312
ds_read_b64_tr_b16 v[86:87],v18 offset:13824
s_waitcnt vmcnt(0) lgkmcnt(0)
buffer_store_dwordx4 v[32:35],v2,s[8:11],s48 offen offset:0 sc1
buffer_store_dwordx4 v[56:59],v2,s[8:11],s48 offen offset:1024 sc1
s_add_u32 s48,s48,262144
buffer_store_dwordx4 v[36:39],v2,s[8:11],s48 offen offset:0 sc1
buffer_store_dwordx4 v[60:63],v2,s[8:11],s48 offen offset:1024 sc1
s_add_u32 s48,s48,262144
buffer_store_dwordx4 v[40:43],v2,s[8:11],s48 offen offset:0 sc1
buffer_store_dwordx4 v[64:67],v2,s[8:11],s48 offen offset:1024 sc1
s_add_u32 s48,s48,262144
buffer_store_dwordx4 v[44:47],v2,s[8:11],s48 offen offset:0 sc1
buffer_store_dwordx4 v[68:71],v2,s[8:11],s48 offen offset:1024 sc1
s_add_u32 s48,s48,262144
buffer_store_dwordx4 v[48:51],v2,s[8:11],s48 offen offset:0 sc1
buffer_store_dwordx4 v[72:75],v2,s[8:11],s48 offen offset:1024 sc1
s_add_u32 s48,s48,262144
buffer_store_dwordx4 v[52:55],v2,s[8:11],s48 offen offset:0 sc1
buffer_store_dwordx4 v[76:79],v2,s[8:11],s48 offen offset:1024 sc1
s_add_u32 s48,s48,262144
buffer_store_dwordx4 v[80:83],v2,s[8:11],s49 offen sc1
s_add_u32 s49,s49,36864
buffer_store_dwordx4 v[84:87],v2,s[8:11],s49 offen sc1
s_add_u32 s49,s49,36864
s_branch k2_B3
k2_B2:
s_waitcnt vmcnt(0)
k2_B3:
v_mov_b32 v3,v2
v_mov_b32 v4,v2
v_mov_b32 v8,0
v_mov_b32 v9,0
s_barrier
v_mov_b32 v144,0
v_mov_b32 v145,0
v_mov_b32 v146,0
v_mov_b32_e64 v147,0
ds_read_b128 a[192:195],v3 offset:0
ds_read_b128 a[196:199],v3 offset:1024
ds_read_b128 a[200:203],v3 offset:2048
ds_read_b128 a[204:207],v3 offset:3072
ds_read_b128 a[208:211],v3 offset:4096
ds_read_b128 a[212:215],v3 offset:5120
ds_read_b128 a[216:219],v3 offset:6144
ds_read_b128 a[220:223],v3 offset:7168
s_waitcnt lgkmcnt(0)
v_mfma_f32_32x32x16_bf16 v[48:63],a[192:195],a[128:131],0
s_mov_b32 s43,s23
s_add_u32 s23,s23,32768
s_add_u32 m0,s43,0
s_add_u32 s22,s22,28672
buffer_load_dwordx4 v2,s[12:15],s22 offen offset:0 lds
v_mfma_f32_32x32x16_bf16 v[64:79],a[192:195],a[160:163],0
buffer_load_dwordx4 v2,s[12:15],s22 offen offset:1024 lds
s_nop 0
v_mfma_f32_32x32x16_bf16 v[48:63],a[196:199],a[132:135],v[48:63]
buffer_load_dwordx4 v2,s[12:15],s22 offen offset:2048 lds
v_mfma_f32_32x32x16_bf16 v[64:79],a[196:199],a[164:167],v[64:79]
buffer_load_dwordx4 v2,s[12:15],s22 offen offset:3072 lds
v_mfma_f32_32x32x16_bf16 v[48:63],a[200:203],a[136:139],v[48:63]
s_add_u32 m0,s43,4096
s_add_u32 s22,s22,4096
buffer_load_dwordx4 v2,s[12:15],s22 offen offset:0 lds
v_mfma_f32_32x32x16_bf16 v[64:79],a[200:203],a[168:171],v[64:79]
buffer_load_dwordx4 v2,s[12:15],s22 offen offset:1024 lds
v_mfma_f32_32x32x16_bf16 v[48:63],a[204:207],a[140:143],v[48:63]
buffer_load_dwordx4 v2,s[12:15],s22 offen offset:2048 lds
v_mfma_f32_32x32x16_bf16 v[64:79],a[204:207],a[172:175],v[64:79]
buffer_load_dwordx4 v2,s[12:15],s22 offen offset:3072 lds
v_mfma_f32_32x32x16_bf16 v[48:63],a[208:211],a[144:147],v[48:63]
s_mov_b32 s43,s23
s_add_u32 s23,s23,32768
s_add_u32 m0,s43,0
s_add_u32 s22,s22,28672
buffer_load_dwordx4 v2,s[12:15],s22 offen offset:0 lds
v_mfma_f32_32x32x16_bf16 v[64:79],a[208:211],a[176:179],v[64:79]
buffer_load_dwordx4 v2,s[12:15],s22 offen offset:1024 lds
v_mfma_f32_32x32x16_bf16 v[48:63],a[212:215],a[148:151],v[48:63]
buffer_load_dwordx4 v2,s[12:15],s22 offen offset:2048 lds
v_mfma_f32_32x32x16_bf16 v[64:79],a[212:215],a[180:183],v[64:79]
buffer_load_dwordx4 v2,s[12:15],s22 offen offset:3072 lds
v_mfma_f32_32x32x16_bf16 v[48:63],a[216:219],a[152:155],v[48:63]
s_add_u32 m0,s43,4096
s_add_u32 s22,s22,4096
buffer_load_dwordx4 v2,s[12:15],s22 offen offset:0 lds
v_mfma_f32_32x32x16_bf16 v[64:79],a[216:219],a[184:187],v[64:79]
buffer_load_dwordx4 v2,s[12:15],s22 offen offset:1024 lds
v_mfma_f32_32x32x16_bf16 v[48:63],a[220:223],a[156:159],v[48:63]
buffer_load_dwordx4 v2,s[12:15],s22 offen offset:2048 lds
v_mfma_f32_32x32x16_bf16 v[64:79],a[220:223],a[188:191],v[64:79]
buffer_load_dwordx4 v2,s[12:15],s22 offen offset:3072 lds
ds_read_b128 a[192:195],v3 offset:16384
ds_read_b128 a[196:199],v3 offset:17408
ds_read_b128 a[200:203],v3 offset:18432
ds_read_b128 a[204:207],v3 offset:19456
ds_read_b128 a[208:211],v3 offset:20480
ds_read_b128 a[212:215],v3 offset:21504
ds_read_b128 a[216:219],v3 offset:22528
ds_read_b128 a[220:223],v3 offset:23552
v_add_u32 v3,32768,v3
s_nop 1
v_mfma_f32_32x32x16_bf16 v[208:223],v[144:147],v[144:147],0
v_max_f32 v10,v48,v49
v_max3_f32 v10,v10,v50,v51
v_max3_f32 v10,v10,v52,v53
v_max3_f32 v10,v10,v54,v55
v_max3_f32 v10,v10,v56,v57
v_max3_f32 v10,v10,v58,v59
v_max3_f32 v10,v10,v60,v61
v_max3_f32 v10,v10,v62,v63
v_mov_b32 v12,v10
s_nop 1
v_permlane32_swap_b32 v10,v12
v_max_f32 v10,v10,v12
v_mfma_f32_32x32x16_bf16 v[192:207],v[144:147],v[144:147],0
v_max_f32_e64 v11,v64,v65
v_max3_f32 v11,v11,v66,v67
v_max3_f32 v11,v11,v68,v69
v_max3_f32 v11,v11,v70,v71
v_max3_f32 v11,v11,v72,v73
v_max3_f32 v11,v11,v74,v75
v_max3_f32 v11,v11,v76,v77
v_max3_f32 v11,v11,v78,v79
v_mov_b32 v12,v11
s_nop 1
v_permlane32_swap_b32 v11,v12
v_max_f32 v11,v11,v12
v_mfma_f32_32x32x16_bf16 v[176:191],v[144:147],v[144:147],0
v_sub_f32 v16,0,v10
v_sub_f32 v17,0,v10
v_sub_f32 v18,0,v10
v_sub_f32 v19,0,v10
v_sub_f32 v20,0,v10
v_sub_f32 v21,0,v10
v_sub_f32 v22,0,v10
v_sub_f32 v23,0,v10
v_mfma_f32_32x32x16_bf16 v[160:175],v[144:147],v[144:147],0
v_sub_f32 v24,0,v10
v_sub_f32 v25,0,v10
v_sub_f32 v26,0,v10
v_sub_f32 v27,0,v10
v_sub_f32 v28,0,v10
v_sub_f32 v29,0,v10
v_sub_f32 v30,0,v10
v_sub_f32 v31,0,v10
v_mfma_f32_32x32x16_bf16 a[48:63],v[144:147],v[144:147],0
v_sub_f32 v32,0,v11
v_sub_f32 v33,0,v11
v_sub_f32 v34,0,v11
v_sub_f32 v35,0,v11
v_sub_f32 v36,0,v11
v_sub_f32 v37,0,v11
v_sub_f32 v38,0,v11
v_sub_f32 v39,0,v11
v_mfma_f32_32x32x16_bf16 a[32:47],v[144:147],v[144:147],0
v_sub_f32 v40,0,v11
v_sub_f32 v41,0,v11
v_sub_f32 v42,0,v11
v_sub_f32 v43,0,v11
v_sub_f32 v44,0,v11
v_sub_f32 v45,0,v11
v_sub_f32 v46,0,v11
v_sub_f32 v47,0,v11
s_cmp_eq_u32 s61,0
s_cbranch_scc1 b_m0
b_m0r:
v_mfma_f32_32x32x16_bf16 a[16:31],v[144:147],v[144:147],0
v_add_f32 v48,v16,v48
v_add_f32 v49,v17,v49
v_add_f32 v50,v18,v50
v_add_f32 v51,v19,v51
v_add_f32 v52,v20,v52
v_add_f32 v53,v21,v53
v_add_f32 v54,v22,v54
v_add_f32 v55,v23,v55
v_add_f32 v56,v24,v56
v_add_f32 v57,v25,v57
v_add_f32 v58,v26,v58
v_add_f32 v59,v27,v59
v_add_f32 v60,v28,v60
v_add_f32 v61,v29,v61
v_add_f32 v62,v30,v62
v_add_f32 v63,v31,v63
v_mfma_f32_32x32x16_bf16 a[0:15],v[144:147],v[144:147],0
v_add_f32 v64,v32,v64
v_add_f32 v65,v33,v65
v_add_f32 v66,v34,v66
v_add_f32 v67,v35,v67
v_add_f32 v68,v36,v68
v_add_f32 v69,v37,v69
v_add_f32 v70,v38,v70
v_add_f32 v71,v39,v71
v_add_f32 v72,v40,v72
v_add_f32 v73,v41,v73
v_add_f32 v74,v42,v74
v_add_f32 v75,v43,v75
v_add_f32 v76,v44,v76
v_add_f32 v77,v45,v77
v_add_f32 v78,v46,v78
v_add_f32 v79,v47,v79
v_exp_f32 v48,v48
v_exp_f32 v49,v49
v_add_f32 v8,v48,v8
v_exp_f32 v50,v50
v_add_f32 v8,v49,v8
v_exp_f32 v51,v51
v_add_f32_e64 v8,v50,v8
v_cvt_pk_bf16_f32 v112,v48,v49
v_exp_f32 v52,v52
v_add_f32 v8,v51,v8
v_exp_f32 v53,v53
v_add_f32 v8,v52,v8
v_cvt_pk_bf16_f32 v113,v50,v51
v_exp_f32 v54,v54
v_add_f32 v8,v53,v8
v_exp_f32 v55,v55
v_add_f32 v8,v54,v8
v_cvt_pk_bf16_f32 v114,v52,v53
v_exp_f32 v64,v64
v_add_f32 v8,v55,v8
v_exp_f32 v65,v65
v_add_f32 v9,v64,v9
v_cvt_pk_bf16_f32 v115,v54,v55
v_exp_f32 v66,v66
v_add_f32 v9,v65,v9
v_exp_f32 v67,v67
v_add_f32 v9,v66,v9
v_cvt_pk_bf16_f32 v120,v64,v65
v_exp_f32 v68,v68
s_waitcnt lgkmcnt(0)
s_cmp_eq_u32 s20,0
s_cbranch_scc1 b_tails
b_loop:
v_mfma_f32_32x32x16_bf16 v[80:95],a[192:195],a[128:131],v[16:31]
ds_read_b128 a[224:227],v4 offset:8192
v_add_f32 v9,v67,v9
v_exp_f32 v69,v69
v_mfma_f32_32x32x16_bf16 v[96:111],a[192:195],a[160:163],v[32:47]
ds_read_b128 a[232:235],v4 offset:10240
v_add_f32_e64 v9,v68,v9
v_cvt_pk_bf16_f32 v121,v66,v67
v_exp_f32_e64 v70,v70
v_mfma_f32_32x32x16_bf16 v[80:95],a[196:199],a[132:135],v[80:95]
ds_read_b128 a[240:243],v4 offset:12288
v_add_f32 v9,v69,v9
v_exp_f32 v71,v71
v_mfma_f32_32x32x16_bf16 v[96:111],a[196:199],a[164:167],v[96:111]
v_add_f32_e64 v9,v70,v9
v_cvt_pk_bf16_f32 v122,v68,v69
v_exp_f32 v56,v56
v_add_f32 v9,v71,v9
v_mfma_f32_32x32x16_bf16 v[80:95],a[200:203],a[136:139],v[80:95]
ds_read_b128 a[248:251],v4 offset:14336
v_exp_f32 v57,v57
v_add_f32 v8,v56,v8
v_mfma_f32_32x32x16_bf16 v[96:111],a[200:203],a[168:171],v[96:111]
v_cvt_pk_bf16_f32 v123,v70,v71
v_exp_f32 v58,v58
v_add_f32 v8,v57,v8
v_mfma_f32_32x32x16_bf16 v[80:95],a[204:207],a[140:143],v[80:95]
ds_read_b128 a[228:231],v4 offset:9216
v_exp_f32 v59,v59
v_add_f32 v8,v58,v8
v_cvt_pk_bf16_f32 v116,v56,v57
v_mfma_f32_32x32x16_bf16 v[96:111],a[204:207],a[172:175],v[96:111]
v_exp_f32 v60,v60
v_add_f32 v8,v59,v8
v_exp_f32_e64 v61,v61
v_mfma_f32_32x32x16_bf16 v[80:95],a[208:211],a[144:147],v[80:95]
ds_read_b128 a[236:239],v4 offset:11264
v_add_f32_e64 v8,v60,v8
v_cvt_pk_bf16_f32 v117,v58,v59
v_exp_f32_e64 v62,v62
v_mfma_f32_32x32x16_bf16 v[96:111],a[208:211],a[176:179],v[96:111]
v_add_f32 v8,v61,v8
v_exp_f32 v63,v63
v_add_f32_e64 v8,v62,v8
v_mfma_f32_32x32x16_bf16 v[80:95],a[212:215],a[148:151],v[80:95]
ds_read_b128 a[244:247],v4 offset:13312
v_cvt_pk_bf16_f32 v118,v60,v61
v_exp_f32_e64 v72,v72
v_mfma_f32_32x32x16_bf16 v[96:111],a[212:215],a[180:183],v[96:111]
ds_read_b128 a[252:255],v4 offset:15360
v_add_f32 v8,v63,v8
v_exp_f32 v73,v73
v_add_f32_e64 v9,v72,v9
v_mfma_f32_32x32x16_bf16 v[80:95],a[216:219],a[152:155],v[80:95]
v_cvt_pk_bf16_f32 v119,v62,v63
v_exp_f32 v74,v74
v_add_f32 v9,v73,v9
v_mfma_f32_32x32x16_bf16 v[96:111],a[216:219],a[184:187],v[96:111]
v_exp_f32 v75,v75
v_add_f32 v9,v74,v9
v_cvt_pk_bf16_f32 v124,v72,v73
v_mfma_f32_32x32x16_bf16 v[80:95],a[220:223],a[156:159],v[80:95]
v_exp_f32 v76,v76
v_add_f32 v9,v75,v9
v_exp_f32_e64 v77,v77
v_mfma_f32_32x32x16_bf16 v[96:111],a[220:223],a[188:191],v[96:111]
v_add_f32_e64 v9,v76,v9
v_cvt_pk_bf16_f32 v125,v74,v75
v_exp_f32 v78,v78
s_waitcnt lgkmcnt(0)
v_mfma_f32_32x32x16_bf16 a[0:15],a[224:227],v[112:115],a[0:15]
s_waitcnt vmcnt(16)
s_barrier
ds_read_b128 a[192:195],v3 offset:0
v_mfma_f32_32x32x16_bf16 v[160:175],a[224:227],v[120:123],v[160:175]
ds_read_b128 a[196:199],v3 offset:1024
v_add_f32 v9,v77,v9
v_exp_f32 v79,v79
v_mfma_f32_32x32x16_bf16 a[16:31],a[232:235],v[112:115],a[16:31]
ds_read_b128 a[200:203],v3 offset:2048
v_add_f32_e64 v9,v78,v9
v_cvt_pk_bf16_f32 v126,v76,v77
v_add_f32_e64 v9,v79,v9
v_cvt_pk_bf16_f32 v127,v78,v79
v_mfma_f32_32x32x16_bf16 v[176:191],a[232:235],v[120:123],v[176:191]
v_exp_f32 v80,v80
v_exp_f32_e64 v81,v81
s_mov_b32 m0,s23
s_add_u32 s22,s22,28672
v_mfma_f32_32x32x16_bf16 a[32:47],a[240:243],v[112:115],a[32:47]
ds_read_b128 a[204:207],v3 offset:3072
v_add_f32 v8,v80,v8
v_exp_f32 v82,v82
v_mfma_f32_32x32x16_bf16 v[192:207],a[240:243],v[120:123],v[192:207]
buffer_load_dwordx4 v2,s[12:15],s22 offen offset:0 lds
v_add_f32_e64 v8,v81,v8
v_mfma_f32_32x32x16_bf16 a[48:63],a[248:251],v[112:115],a[48:63]
ds_read_b128 a[208:211],v3 offset:4096
v_exp_f32 v83,v83
v_add_f32 v8,v82,v8
v_cvt_pk_bf16_f32 v128,v80,v81
v_mfma_f32_32x32x16_bf16 v[208:223],a[248:251],v[120:123],v[208:223]
v_exp_f32 v84,v84
v_add_f32 v8,v83,v8
v_exp_f32 v85,v85
v_add_f32 v8,v84,v8
v_mfma_f32_32x32x16_bf16 a[0:15],a[228:231],v[116:119],a[0:15]
ds_read_b128 a[212:215],v3 offset:5120
v_cvt_pk_bf16_f32 v129,v82,v83
v_exp_f32 v86,v86
v_add_f32 v8,v85,v8
v_mfma_f32_32x32x16_bf16 v[160:175],a[228:231],v[124:127],v[160:175]
buffer_load_dwordx4 v2,s[12:15],s22 offen offset:1024 lds
v_exp_f32_e64 v87,v87
v_mfma_f32_32x32x16_bf16 a[16:31],a[236:239],v[116:119],a[16:31]
ds_read_b128 a[216:219],v3 offset:6144
v_add_f32_e64 v8,v86,v8
v_cvt_pk_bf16_f32 v130,v84,v85
v_exp_f32_e64 v96,v96
v_mfma_f32_32x32x16_bf16 v[176:191],a[236:239],v[124:127],v[176:191]
ds_read_b128 a[220:223],v3 offset:7168
v_add_f32 v8,v87,v8
v_exp_f32 v97,v97
v_mfma_f32_32x32x16_bf16 a[32:47],a[244:247],v[116:119],a[32:47]
v_add_f32_e64 v9,v96,v9
v_cvt_pk_bf16_f32 v131,v86,v87
v_exp_f32 v98,v98
v_add_f32 v9,v97,v9
v_mfma_f32_32x32x16_bf16 v[192:207],a[244:247],v[124:127],v[192:207]
buffer_load_dwordx4 v2,s[12:15],s22 offen offset:2048 lds
v_exp_f32_e64 v99,v99
v_mfma_f32_32x32x16_bf16 a[48:63],a[252:255],v[116:119],a[48:63]
v_add_f32_e64 v9,v98,v9
v_cvt_pk_bf16_f32 v136,v96,v97
v_exp_f32 v100,v100
v_add_f32 v9,v99,v9
v_mfma_f32_32x32x16_bf16 v[208:223],a[252:255],v[124:127],v[208:223]
v_exp_f32 v101,v101
s_cmp_eq_u32 s19,s21
s_cbranch_scc1 b_m1
b_m1r:
s_waitcnt lgkmcnt(0)
v_mfma_f32_32x32x16_bf16 v[48:63],a[192:195],a[128:131],v[16:31]
ds_read_b128 a[224:227],v4 offset:24576
v_add_f32_e64 v9,v100,v9
v_cvt_pk_bf16_f32 v137,v98,v99
v_exp_f32_e64 v102,v102
v_mfma_f32_32x32x16_bf16 v[64:79],a[192:195],a[160:163],v[32:47]
ds_read_b128 a[232:235],v4 offset:26624
v_add_f32 v9,v101,v9
v_exp_f32 v103,v103
v_add_f32_e64 v9,v102,v9
v_mfma_f32_32x32x16_bf16 v[48:63],a[196:199],a[132:135],v[48:63]
ds_read_b128 a[240:243],v4 offset:28672
v_cvt_pk_bf16_f32 v138,v100,v101
v_exp_f32 v88,v88
v_add_f32 v9,v103,v9
v_mfma_f32_32x32x16_bf16 v[64:79],a[196:199],a[164:167],v[64:79]
buffer_load_dwordx4 v2,s[12:15],s22 offen offset:3072 lds
v_exp_f32_e64 v89,v89
v_mfma_f32_32x32x16_bf16 v[48:63],a[200:203],a[136:139],v[48:63]
ds_read_b128 a[248:251],v4 offset:30720
v_add_f32_e64 v8,v88,v8
v_cvt_pk_bf16_f32 v139,v102,v103
v_exp_f32_e64 v90,v90
v_mfma_f32_32x32x16_bf16 v[64:79],a[200:203],a[168:171],v[64:79]
v_add_f32 v8,v89,v8
v_exp_f32 v91,v91
s_add_u32 m0,s23,4096
s_add_u32 s22,s22,4096
v_mfma_f32_32x32x16_bf16 v[48:63],a[204:207],a[140:143],v[48:63]
ds_read_b128 a[228:231],v4 offset:25600
v_add_f32_e64 v8,v90,v8
v_cvt_pk_bf16_f32 v132,v88,v89
v_exp_f32_e64 v92,v92
v_mfma_f32_32x32x16_bf16 v[64:79],a[204:207],a[172:175],v[64:79]
buffer_load_dwordx4 v2,s[12:15],s22 offen offset:0 lds
v_add_f32_e64 v8,v91,v8
v_mfma_f32_32x32x16_bf16 v[48:63],a[208:211],a[144:147],v[48:63]
ds_read_b128 a[236:239],v4 offset:27648
v_exp_f32 v93,v93
v_add_f32 v8,v92,v8
v_cvt_pk_bf16_f32 v133,v90,v91
v_mfma_f32_32x32x16_bf16 v[64:79],a[208:211],a[176:179],v[64:79]
v_exp_f32 v94,v94
v_add_f32 v8,v93,v8
s_add_u32 s23,s23,32768
s_cmp_ge_u32 s23,163840
v_mfma_f32_32x32x16_bf16 v[48:63],a[212:215],a[148:151],v[48:63]
ds_read_b128 a[244:247],v4 offset:29696
v_exp_f32 v95,v95
v_add_f32 v8,v94,v8
v_cvt_pk_bf16_f32 v134,v92,v93
v_mfma_f32_32x32x16_bf16 v[64:79],a[212:215],a[180:183],v[64:79]
ds_read_b128 a[252:255],v4 offset:31744
v_exp_f32 v104,v104
v_add_f32 v8,v95,v8
s_cselect_b32 s24,163840,0
s_sub_u32 s23,s23,s24
v_mfma_f32_32x32x16_bf16 v[48:63],a[216:219],a[152:155],v[48:63]
v_exp_f32 v105,v105
v_add_f32_e64 v9,v104,v9
v_cvt_pk_bf16_f32 v135,v94,v95
v_exp_f32_e64 v106,v106
v_mfma_f32_32x32x16_bf16 v[64:79],a[216:219],a[184:187],v[64:79]
buffer_load_dwordx4 v2,s[12:15],s22 offen offset:1024 lds
v_add_f32_e64 v9,v105,v9
v_mfma_f32_32x32x16_bf16 v[48:63],a[220:223],a[156:159],v[48:63]
v_exp_f32 v107,v107
v_add_f32 v9,v106,v9
v_cvt_pk_bf16_f32 v140,v104,v105
v_mov_b32_e64 v4,v3
v_mfma_f32_32x32x16_bf16 v[64:79],a[220:223],a[188:191],v[64:79]
v_exp_f32 v108,v108
v_add_f32_e64 v9,v107,v9
s_waitcnt lgkmcnt(0)
v_mfma_f32_32x32x16_bf16 a[0:15],a[224:227],v[128:131],a[0:15]
ds_read_b128 a[192:195],v3 offset:16384
v_exp_f32 v109,v109
v_add_f32 v9,v108,v9
v_cvt_pk_bf16_f32 v141,v106,v107
v_mfma_f32_32x32x16_bf16 v[160:175],a[224:227],v[136:139],v[160:175]
ds_read_b128 a[196:199],v3 offset:17408
v_exp_f32 v110,v110
v_add_f32 v9,v109,v9
v_exp_f32_e64 v111,v111
v_mfma_f32_32x32x16_bf16 a[16:31],a[232:235],v[128:131],a[16:31]
ds_read_b128 a[200:203],v3 offset:18432
v_add_f32_e64 v9,v110,v9
v_cvt_pk_bf16_f32 v142,v108,v109
v_add_f32_e64 v9,v111,v9
v_cvt_pk_bf16_f32 v143,v110,v111
v_mfma_f32_32x32x16_bf16 v[176:191],a[232:235],v[136:139],v[176:191]
buffer_load_dwordx4 v2,s[12:15],s22 offen offset:2048 lds
v_exp_f32_e64 v48,v48
v_mfma_f32_32x32x16_bf16 a[32:47],a[240:243],v[128:131],a[32:47]
ds_read_b128 a[204:207],v3 offset:19456
v_exp_f32 v49,v49
v_add_f32 v8,v48,v8
v_mfma_f32_32x32x16_bf16 v[192:207],a[240:243],v[136:139],v[192:207]
v_exp_f32 v50,v50
v_add_f32 v8,v49,v8
s_add_u32 s47,s47,32768
s_cmp_ge_u32 s47,163840
v_mfma_f32_32x32x16_bf16 a[48:63],a[248:251],v[128:131],a[48:63]
ds_read_b128 a[208:211],v3 offset:20480
v_exp_f32 v51,v51
v_add_f32 v8,v50,v8
v_cvt_pk_bf16_f32 v112,v48,v49
v_mfma_f32_32x32x16_bf16 v[208:223],a[248:251],v[136:139],v[208:223]
v_exp_f32 v52,v52
v_add_f32_e64 v8,v51,v8
s_cselect_b32 s47,0,s47
v_mfma_f32_32x32x16_bf16 a[0:15],a[228:231],v[132:135],a[0:15]
ds_read_b128 a[212:215],v3 offset:21504
v_exp_f32 v53,v53
v_add_f32 v8,v52,v8
v_cvt_pk_bf16_f32 v113,v50,v51
v_mfma_f32_32x32x16_bf16 v[160:175],a[228:231],v[140:143],v[160:175]
buffer_load_dwordx4 v2,s[12:15],s22 offen offset:3072 lds
v_exp_f32_e64 v54,v54
v_mfma_f32_32x32x16_bf16 a[16:31],a[236:239],v[132:135],a[16:31]
ds_read_b128 a[216:219],v3 offset:22528
v_add_f32 v8,v53,v8
v_exp_f32 v55,v55
v_mfma_f32_32x32x16_bf16 v[176:191],a[236:239],v[140:143],v[176:191]
ds_read_b128 a[220:223],v3 offset:23552
v_add_f32_e64 v8,v54,v8
v_cvt_pk_bf16_f32 v114,v52,v53
v_exp_f32_e64 v64,v64
v_mfma_f32_32x32x16_bf16 a[32:47],a[244:247],v[132:135],a[32:47]
v_add_f32 v8,v55,v8
v_exp_f32 v65,v65
v_add_u32_e64 v3,s47,v2
v_mfma_f32_32x32x16_bf16 v[192:207],a[244:247],v[140:143],v[192:207]
v_add_f32_e64 v9,v64,v9
v_cvt_pk_bf16_f32 v115,v54,v55
v_exp_f32 v66,v66
s_add_u32 s19,s19,1
v_mfma_f32_32x32x16_bf16 a[48:63],a[252:255],v[132:135],a[48:63]
v_add_f32 v9,v65,v9
v_exp_f32 v67,v67
v_add_f32_e64 v9,v66,v9
v_mfma_f32_32x32x16_bf16 v[208:223],a[252:255],v[140:143],v[208:223]
v_cvt_pk_bf16_f32 v120,v64,v65
v_exp_f32 v68,v68
s_waitcnt lgkmcnt(0)
s_cmp_lt_u32 s19,s20
s_cbranch_scc1 b_loop
b_tails:
s_cmp_eq_u32 s18,1
s_cbranch_scc1 b_tail1
s_cmp_eq_u32 s18,2
s_cbranch_scc1 b_tail2
s_cmp_eq_u32 s18,3
s_cbranch_scc1 b_tail3
b_tail0:
s_add_u32 s50,s47,32768
s_cmp_ge_u32 s50,163840
s_cselect_b32 s50,0,s50
s_add_u32 s51,s50,32768
s_cmp_ge_u32 s51,163840
s_cselect_b32 s51,0,s51
s_waitcnt lgkmcnt(0)
v_mfma_f32_32x32x16_bf16 v[96:111],a[192:195],a[160:163],v[32:47]
ds_read_b128 a[224:227],v4 offset:8192
ds_read_b128 a[232:235],v4 offset:10240
v_add_f32 v9,v67,v9
v_exp_f32_e64 v69,v69
v_mfma_f32_32x32x16_bf16 v[96:111],a[196:199],a[164:167],v[96:111]
ds_read_b128 a[240:243],v4 offset:12288
ds_read_b128 a[248:251],v4 offset:14336
v_add_f32_e64 v9,v68,v9
v_cvt_pk_bf16_f32 v121,v66,v67
v_mfma_f32_32x32x16_bf16 v[96:111],a[200:203],a[168:171],v[96:111]
ds_read_b128 a[228:231],v4 offset:9216
ds_read_b128 a[236:239],v4 offset:11264
v_exp_f32 v70,v70
v_add_f32 v9,v69,v9
v_mfma_f32_32x32x16_bf16 v[96:111],a[204:207],a[172:175],v[96:111]
ds_read_b128 a[244:247],v4 offset:13312
ds_read_b128 a[252:255],v4 offset:15360
v_exp_f32 v71,v71
v_add_f32 v9,v70,v9
v_mfma_f32_32x32x16_bf16 v[96:111],a[208:211],a[176:179],v[96:111]
v_cvt_pk_bf16_f32 v122,v68,v69
v_exp_f32 v56,v56
v_add_f32 v9,v71,v9
v_exp_f32_e64 v57,v57
v_mfma_f32_32x32x16_bf16 v[96:111],a[212:215],a[180:183],v[96:111]
v_add_f32_e64 v8,v56,v8
v_cvt_pk_bf16_f32 v123,v70,v71
v_exp_f32 v58,v58
v_add_f32 v8,v57,v8
v_mfma_f32_32x32x16_bf16 v[96:111],a[216:219],a[184:187],v[96:111]
v_exp_f32 v59,v59
v_add_f32 v8,v58,v8
v_cvt_pk_bf16_f32 v116,v56,v57
v_exp_f32_e64 v60,v60
v_mfma_f32_32x32x16_bf16 v[96:111],a[220:223],a[188:191],v[96:111]
v_add_f32 v8,v59,v8
v_exp_f32 v61,v61
v_add_f32_e64 v8,v60,v8
v_cvt_pk_bf16_f32 v117,v58,v59
s_waitcnt lgkmcnt(0)
v_mfma_f32_32x32x16_bf16 a[0:15],a[224:227],v[112:115],a[0:15]
s_waitcnt vmcnt(0)
s_barrier
ds_read_b128 a[192:195],v3 offset:0
v_mfma_f32_32x32x16_bf16 v[160:175],a[224:227],v[120:123],v[160:175]
ds_read_b128 a[196:199],v3 offset:1024
v_exp_f32 v62,v62
v_add_f32 v8,v61,v8
v_exp_f32 v63,v63
v_mfma_f32_32x32x16_bf16 a[16:31],a[232:235],v[112:115],a[16:31]
ds_read_b128 a[200:203],v3 offset:2048
v_add_f32_e64 v8,v62,v8
v_cvt_pk_bf16_f32 v118,v60,v61
v_exp_f32 v72,v72
v_add_f32 v8,v63,v8
v_mfma_f32_32x32x16_bf16 v[176:191],a[232:235],v[120:123],v[176:191]
v_exp_f32 v73,v73
v_add_f32 v9,v72,v9
v_cvt_pk_bf16_f32 v119,v62,v63
v_exp_f32_e64 v74,v74
v_mfma_f32_32x32x16_bf16 a[32:47],a[240:243],v[112:115],a[32:47]
ds_read_b128 a[204:207],v3 offset:3072
v_add_f32 v9,v73,v9
v_exp_f32 v75,v75
v_add_f32_e64 v9,v74,v9
v_cvt_pk_bf16_f32 v124,v72,v73
v_mfma_f32_32x32x16_bf16 v[192:207],a[240:243],v[120:123],v[192:207]
v_exp_f32 v76,v76
v_add_f32 v9,v75,v9
v_exp_f32 v77,v77
v_add_f32 v9,v76,v9
v_mfma_f32_32x32x16_bf16 a[48:63],a[248:251],v[112:115],a[48:63]
ds_read_b128 a[208:211],v3 offset:4096
v_cvt_pk_bf16_f32 v125,v74,v75
v_exp_f32 v78,v78
v_add_f32 v9,v77,v9
v_mfma_f32_32x32x16_bf16 v[208:223],a[248:251],v[120:123],v[208:223]
v_exp_f32 v79,v79
v_add_f32 v9,v78,v9
v_cvt_pk_bf16_f32 v126,v76,v77
v_add_f32_e64 v9,v79,v9
v_cvt_pk_bf16_f32 v127,v78,v79
v_mfma_f32_32x32x16_bf16 a[0:15],a[228:231],v[116:119],a[0:15]
ds_read_b128 a[212:215],v3 offset:5120
v_exp_f32 v96,v96
v_exp_f32 v97,v97
v_add_f32_e64 v9,v96,v9
v_mfma_f32_32x32x16_bf16 v[160:175],a[228:231],v[124:127],v[160:175]
v_exp_f32 v98,v98
v_add_f32 v9,v97,v9
v_exp_f32 v99,v99
v_add_f32 v9,v98,v9
v_mfma_f32_32x32x16_bf16 a[16:31],a[236:239],v[116:119],a[16:31]
ds_read_b128 a[216:219],v3 offset:6144
v_cvt_pk_bf16_f32 v136,v96,v97
v_exp_f32 v100,v100
v_add_f32 v9,v99,v9
v_mfma_f32_32x32x16_bf16 v[176:191],a[236:239],v[124:127],v[176:191]
ds_read_b128 a[220:223],v3 offset:7168
v_exp_f32 v101,v101
v_add_f32 v9,v100,v9
v_cvt_pk_bf16_f32 v137,v98,v99
v_mfma_f32_32x32x16_bf16 a[32:47],a[244:247],v[116:119],a[32:47]
v_exp_f32 v102,v102
v_add_f32 v9,v101,v9
v_exp_f32 v103,v103
v_add_f32 v9,v102,v9
v_mfma_f32_32x32x16_bf16 v[192:207],a[244:247],v[124:127],v[192:207]
v_cvt_pk_bf16_f32 v138,v100,v101
v_exp_f32 v104,v104
v_add_f32 v9,v103,v9
v_exp_f32_e64 v105,v105
v_mfma_f32_32x32x16_bf16 a[48:63],a[252:255],v[116:119],a[48:63]
v_add_f32_e64 v9,v104,v9
v_cvt_pk_bf16_f32 v139,v102,v103
v_exp_f32 v106,v106
v_add_f32 v9,v105,v9
v_mfma_f32_32x32x16_bf16 v[208:223],a[252:255],v[124:127],v[208:223]
v_exp_f32 v107,v107
v_add_f32 v9,v106,v9
v_cvt_pk_bf16_f32 v140,v104,v105
s_waitcnt lgkmcnt(0)
s_nop 0
v_mfma_f32_32x32x16_bf16 v[64:79],a[192:195],a[160:163],v[32:47]
ds_read_b128 a[224:227],v4 offset:24576
ds_read_b128 a[232:235],v4 offset:26624
v_exp_f32 v108,v108
v_add_f32 v9,v107,v9
v_mfma_f32_32x32x16_bf16 v[64:79],a[196:199],a[164:167],v[64:79]
ds_read_b128 a[240:243],v4 offset:28672
ds_read_b128 a[248:251],v4 offset:30720
v_exp_f32 v109,v109
v_add_f32 v9,v108,v9
v_mfma_f32_32x32x16_bf16 v[64:79],a[200:203],a[168:171],v[64:79]
ds_read_b128 a[228:231],v4 offset:25600
ds_read_b128 a[236:239],v4 offset:27648
v_cvt_pk_bf16_f32 v141,v106,v107
v_exp_f32_e64 v110,v110
v_mfma_f32_32x32x16_bf16 v[64:79],a[204:207],a[172:175],v[64:79]
ds_read_b128 a[244:247],v4 offset:29696
ds_read_b128 a[252:255],v4 offset:31744
v_add_f32 v9,v109,v9
v_exp_f32 v111,v111
v_mfma_f32_32x32x16_bf16 v[64:79],a[208:211],a[176:179],v[64:79]
v_add_f32_e64 v9,v110,v9
v_cvt_pk_bf16_f32 v142,v108,v109
v_add_f32_e64 v9,v111,v9
v_cvt_pk_bf16_f32 v143,v110,v111
v_mfma_f32_32x32x16_bf16 v[64:79],a[212:215],a[180:183],v[64:79]
v_mfma_f32_32x32x16_bf16 v[64:79],a[216:219],a[184:187],v[64:79]
v_mfma_f32_32x32x16_bf16 v[64:79],a[220:223],a[188:191],v[64:79]
s_waitcnt lgkmcnt(0)
s_nop 0
v_mfma_f32_32x32x16_bf16 v[160:175],a[224:227],v[136:139],v[160:175]
ds_read_b128 a[192:195],v3 offset:16384
ds_read_b128 a[196:199],v3 offset:17408
v_mfma_f32_32x32x16_bf16 v[176:191],a[232:235],v[136:139],v[176:191]
ds_read_b128 a[200:203],v3 offset:18432
ds_read_b128 a[204:207],v3 offset:19456
v_mfma_f32_32x32x16_bf16 v[192:207],a[240:243],v[136:139],v[192:207]
ds_read_b128 a[208:211],v3 offset:20480
ds_read_b128 a[212:215],v3 offset:21504
v_mfma_f32_32x32x16_bf16 v[208:223],a[248:251],v[136:139],v[208:223]
ds_read_b128 a[216:219],v3 offset:22528
ds_read_b128 a[220:223],v3 offset:23552
v_exp_f32_e64 v64,v64
v_mfma_f32_32x32x16_bf16 v[160:175],a[228:231],v[140:143],v[160:175]
v_exp_f32 v65,v65
v_add_f32 v9,v64,v9
v_exp_f32 v66,v66
v_add_f32 v9,v65,v9
v_mfma_f32_32x32x16_bf16 v[176:191],a[236:239],v[140:143],v[176:191]
v_exp_f32 v67,v67
v_add_f32 v9,v66,v9
v_cvt_pk_bf16_f32 v120,v64,v65
v_exp_f32_e64 v68,v68
v_mfma_f32_32x32x16_bf16 v[192:207],a[244:247],v[140:143],v[192:207]
v_add_f32 v9,v67,v9
v_exp_f32 v69,v69
v_add_f32_e64 v9,v68,v9
v_cvt_pk_bf16_f32 v121,v66,v67
v_mfma_f32_32x32x16_bf16 v[208:223],a[252:255],v[140:143],v[208:223]
v_exp_f32 v70,v70
v_add_f32 v9,v69,v9
v_exp_f32 v71,v71
v_mov_b32 v4,v3
s_nop 0
s_waitcnt lgkmcnt(0)
v_mfma_f32_32x32x16_bf16 v[96:111],a[192:195],a[160:163],v[32:47]
ds_read_b128 a[224:227],v4 offset:8192
ds_read_b128 a[232:235],v4 offset:10240
v_add_f32_e64 v9,v70,v9
v_cvt_pk_bf16_f32 v122,v68,v69
v_mfma_f32_32x32x16_bf16 v[96:111],a[196:199],a[164:167],v[96:111]
ds_read_b128 a[240:243],v4 offset:12288
ds_read_b128 a[248:251],v4 offset:14336
v_exp_f32 v72,v72
v_add_f32 v9,v71,v9
v_mfma_f32_32x32x16_bf16 v[96:111],a[200:203],a[168:171],v[96:111]
ds_read_b128 a[228:231],v4 offset:9216
ds_read_b128 a[236:239],v4 offset:11264
v_exp_f32 v73,v73
v_add_f32 v9,v72,v9
v_mfma_f32_32x32x16_bf16 v[96:111],a[204:207],a[172:175],v[96:111]
ds_read_b128 a[244:247],v4 offset:13312
ds_read_b128 a[252:255],v4 offset:15360
v_cvt_pk_bf16_f32 v123,v70,v71
v_exp_f32_e64 v74,v74
v_mfma_f32_32x32x16_bf16 v[96:111],a[208:211],a[176:179],v[96:111]
v_add_f32 v9,v73,v9
v_exp_f32 v75,v75
v_add_f32_e64 v9,v74,v9
v_cvt_pk_bf16_f32 v124,v72,v73
v_mfma_f32_32x32x16_bf16 v[96:111],a[212:215],a[180:183],v[96:111]
v_exp_f32 v76,v76
v_add_f32 v9,v75,v9
v_exp_f32 v77,v77
v_add_f32 v9,v76,v9
v_mfma_f32_32x32x16_bf16 v[96:111],a[216:219],a[184:187],v[96:111]
v_cvt_pk_bf16_f32 v125,v74,v75
v_exp_f32 v78,v78
v_add_f32 v9,v77,v9
v_exp_f32_e64 v79,v79
v_mfma_f32_32x32x16_bf16 v[96:111],a[220:223],a[188:191],v[96:111]
v_add_f32_e64 v9,v78,v9
v_cvt_pk_bf16_f32 v126,v76,v77
v_add_f32_e64 v9,v79,v9
v_cvt_pk_bf16_f32 v127,v78,v79
v_add_u32_e64 v3,s50,v2
s_nop 0
s_waitcnt lgkmcnt(0)
v_mfma_f32_32x32x16_bf16 v[160:175],a[224:227],v[120:123],v[160:175]
ds_read_b128 a[192:195],v3 offset:0
ds_read_b128 a[196:199],v3 offset:1024
v_mfma_f32_32x32x16_bf16 v[176:191],a[232:235],v[120:123],v[176:191]
ds_read_b128 a[200:203],v3 offset:2048
ds_read_b128 a[204:207],v3 offset:3072
v_mfma_f32_32x32x16_bf16 v[192:207],a[240:243],v[120:123],v[192:207]
ds_read_b128 a[208:211],v3 offset:4096
ds_read_b128 a[212:215],v3 offset:5120
v_mfma_f32_32x32x16_bf16 v[208:223],a[248:251],v[120:123],v[208:223]
ds_read_b128 a[216:219],v3 offset:6144
ds_read_b128 a[220:223],v3 offset:7168
v_exp_f32_e64 v96,v96
v_mfma_f32_32x32x16_bf16 v[160:175],a[228:231],v[124:127],v[160:175]
v_exp_f32 v97,v97
v_add_f32 v9,v96,v9
v_exp_f32 v98,v98
v_add_f32 v9,v97,v9
v_mfma_f32_32x32x16_bf16 v[176:191],a[236:239],v[124:127],v[176:191]
v_exp_f32 v99,v99
v_add_f32 v9,v98,v9
v_cvt_pk_bf16_f32 v136,v96,v97
v_exp_f32_e64 v100,v100
v_mfma_f32_32x32x16_bf16 v[192:207],a[244:247],v[124:127],v[192:207]
v_add_f32 v9,v99,v9
v_exp_f32 v101,v101
v_add_f32_e64 v9,v100,v9
v_cvt_pk_bf16_f32 v137,v98,v99
v_mfma_f32_32x32x16_bf16 v[208:223],a[252:255],v[124:127],v[208:223]
v_exp_f32 v102,v102
v_add_f32 v9,v101,v9
v_exp_f32 v103,v103
s_waitcnt lgkmcnt(0)
v_mfma_f32_32x32x16_bf16 v[64:79],a[192:195],a[160:163],v[32:47]
ds_read_b128 a[224:227],v4 offset:24576
ds_read_b128 a[232:235],v4 offset:26624
v_add_f32_e64 v9,v102,v9
v_cvt_pk_bf16_f32 v138,v100,v101
v_mfma_f32_32x32x16_bf16 v[64:79],a[196:199],a[164:167],v[64:79]
ds_read_b128 a[240:243],v4 offset:28672
ds_read_b128 a[248:251],v4 offset:30720
v_exp_f32 v104,v104
v_add_f32 v9,v103,v9
v_mfma_f32_32x32x16_bf16 v[64:79],a[200:203],a[168:171],v[64:79]
ds_read_b128 a[228:231],v4 offset:25600
ds_read_b128 a[236:239],v4 offset:27648
v_exp_f32 v105,v105
v_add_f32 v9,v104,v9
v_mfma_f32_32x32x16_bf16 v[64:79],a[204:207],a[172:175],v[64:79]
ds_read_b128 a[244:247],v4 offset:29696
ds_read_b128 a[252:255],v4 offset:31744
v_cvt_pk_bf16_f32 v139,v102,v103
v_exp_f32_e64 v106,v106
v_mfma_f32_32x32x16_bf16 v[64:79],a[208:211],a[176:179],v[64:79]
v_add_f32 v9,v105,v9
v_exp_f32 v107,v107
v_add_f32_e64 v9,v106,v9
v_cvt_pk_bf16_f32 v140,v104,v105
v_mfma_f32_32x32x16_bf16 v[64:79],a[212:215],a[180:183],v[64:79]
v_exp_f32 v108,v108
v_add_f32 v9,v107,v9
v_exp_f32 v109,v109
v_add_f32 v9,v108,v9
v_mfma_f32_32x32x16_bf16 v[64:79],a[216:219],a[184:187],v[64:79]
v_cvt_pk_bf16_f32 v141,v106,v107
v_exp_f32 v110,v110
v_add_f32 v9,v109,v9
v_exp_f32_e64 v111,v111
v_mfma_f32_32x32x16_bf16 v[64:79],a[220:223],a[188:191],v[64:79]
v_add_f32_e64 v9,v110,v9
v_cvt_pk_bf16_f32 v142,v108,v109
v_add_f32_e64 v9,v111,v9
v_cvt_pk_bf16_f32 v143,v110,v111
s_waitcnt lgkmcnt(0)
s_nop 0
v_mfma_f32_32x32x16_bf16 v[160:175],a[224:227],v[136:139],v[160:175]
ds_read_b128 a[192:195],v3 offset:16384
ds_read_b128 a[196:199],v3 offset:17408
v_mfma_f32_32x32x16_bf16 v[176:191],a[232:235],v[136:139],v[176:191]
ds_read_b128 a[200:203],v3 offset:18432
ds_read_b128 a[204:207],v3 offset:19456
v_mfma_f32_32x32x16_bf16 v[192:207],a[240:243],v[136:139],v[192:207]
ds_read_b128 a[208:211],v3 offset:20480
ds_read_b128 a[212:215],v3 offset:21504
v_mfma_f32_32x32x16_bf16 v[208:223],a[248:251],v[136:139],v[208:223]
ds_read_b128 a[216:219],v3 offset:22528
ds_read_b128 a[220:223],v3 offset:23552
v_exp_f32_e64 v64,v64
v_mfma_f32_32x32x16_bf16 v[160:175],a[228:231],v[140:143],v[160:175]
v_exp_f32 v65,v65
v_add_f32 v9,v64,v9
v_exp_f32 v66,v66
v_add_f32 v9,v65,v9
v_mfma_f32_32x32x16_bf16 v[176:191],a[236:239],v[140:143],v[176:191]
v_exp_f32 v67,v67
v_add_f32 v9,v66,v9
v_cvt_pk_bf16_f32 v120,v64,v65
v_exp_f32_e64 v68,v68
v_mfma_f32_32x32x16_bf16 v[192:207],a[244:247],v[140:143],v[192:207]
v_add_f32 v9,v67,v9
v_exp_f32 v69,v69
v_add_f32_e64 v9,v68,v9
v_cvt_pk_bf16_f32 v121,v66,v67
v_mfma_f32_32x32x16_bf16 v[208:223],a[252:255],v[140:143],v[208:223]
v_exp_f32 v70,v70
v_add_f32 v9,v69,v9
v_exp_f32 v71,v71
v_mov_b32 v4,v3
s_nop 0
s_waitcnt lgkmcnt(0)
v_mfma_f32_32x32x16_bf16 v[96:111],a[192:195],a[160:163],v[32:47]
ds_read_b128 a[224:227],v4 offset:8192
ds_read_b128 a[232:235],v4 offset:10240
v_add_f32_e64 v9,v70,v9
v_cvt_pk_bf16_f32 v122,v68,v69
v_mfma_f32_32x32x16_bf16 v[96:111],a[196:199],a[164:167],v[96:111]
ds_read_b128 a[240:243],v4 offset:12288
ds_read_b128 a[248:251],v4 offset:14336
v_exp_f32 v72,v72
v_add_f32 v9,v71,v9
v_mfma_f32_32x32x16_bf16 v[96:111],a[200:203],a[168:171],v[96:111]
ds_read_b128 a[228:231],v4 offset:9216
ds_read_b128 a[236:239],v4 offset:11264
v_exp_f32 v73,v73
v_add_f32 v9,v72,v9
v_mfma_f32_32x32x16_bf16 v[96:111],a[204:207],a[172:175],v[96:111]
ds_read_b128 a[244:247],v4 offset:13312
ds_read_b128 a[252:255],v4 offset:15360
v_cvt_pk_bf16_f32 v123,v70,v71
v_exp_f32_e64 v74,v74
v_mfma_f32_32x32x16_bf16 v[96:111],a[208:211],a[176:179],v[96:111]
v_add_f32 v9,v73,v9
v_exp_f32 v75,v75
v_add_f32_e64 v9,v74,v9
v_cvt_pk_bf16_f32 v124,v72,v73
v_mfma_f32_32x32x16_bf16 v[96:111],a[212:215],a[180:183],v[96:111]
v_exp_f32 v76,v76
v_add_f32 v9,v75,v9
v_exp_f32 v77,v77
v_add_f32 v9,v76,v9
v_mfma_f32_32x32x16_bf16 v[96:111],a[216:219],a[184:187],v[96:111]
v_cvt_pk_bf16_f32 v125,v74,v75
v_exp_f32 v78,v78
v_add_f32 v9,v77,v9
v_exp_f32_e64 v79,v79
v_mfma_f32_32x32x16_bf16 v[96:111],a[220:223],a[188:191],v[96:111]
v_add_f32_e64 v9,v78,v9
v_cvt_pk_bf16_f32 v126,v76,v77
v_add_f32_e64 v9,v79,v9
v_cvt_pk_bf16_f32 v127,v78,v79
v_add_u32_e64 v3,s51,v2
s_nop 0
s_waitcnt lgkmcnt(0)
v_mfma_f32_32x32x16_bf16 v[160:175],a[224:227],v[120:123],v[160:175]
ds_read_b128 a[192:195],v3 offset:0
ds_read_b128 a[196:199],v3 offset:1024
v_mfma_f32_32x32x16_bf16 v[176:191],a[232:235],v[120:123],v[176:191]
ds_read_b128 a[200:203],v3 offset:2048
ds_read_b128 a[204:207],v3 offset:3072
v_mfma_f32_32x32x16_bf16 v[192:207],a[240:243],v[120:123],v[192:207]
ds_read_b128 a[208:211],v3 offset:4096
ds_read_b128 a[212:215],v3 offset:5120
v_mfma_f32_32x32x16_bf16 v[208:223],a[248:251],v[120:123],v[208:223]
ds_read_b128 a[216:219],v3 offset:6144
ds_read_b128 a[220:223],v3 offset:7168
v_exp_f32_e64 v96,v96
v_mfma_f32_32x32x16_bf16 v[160:175],a[228:231],v[124:127],v[160:175]
v_exp_f32 v97,v97
v_add_f32 v9,v96,v9
v_exp_f32 v98,v98
v_add_f32 v9,v97,v9
v_mfma_f32_32x32x16_bf16 v[176:191],a[236:239],v[124:127],v[176:191]
v_exp_f32 v99,v99
v_add_f32 v9,v98,v9
v_cvt_pk_bf16_f32 v136,v96,v97
v_exp_f32_e64 v100,v100
v_mfma_f32_32x32x16_bf16 v[192:207],a[244:247],v[124:127],v[192:207]
v_add_f32 v9,v99,v9
v_exp_f32 v101,v101
v_add_f32_e64 v9,v100,v9
v_cvt_pk_bf16_f32 v137,v98,v99
v_mfma_f32_32x32x16_bf16 v[208:223],a[252:255],v[124:127],v[208:223]
v_exp_f32 v102,v102
v_add_f32 v9,v101,v9
v_exp_f32 v103,v103
s_waitcnt lgkmcnt(0)
v_mfma_f32_32x32x16_bf16 v[64:79],a[192:195],a[160:163],v[32:47]
ds_read_b128 a[224:227],v4 offset:24576
ds_read_b128 a[232:235],v4 offset:26624
v_add_f32_e64 v9,v102,v9
v_cvt_pk_bf16_f32 v138,v100,v101
v_mfma_f32_32x32x16_bf16 v[64:79],a[196:199],a[164:167],v[64:79]
ds_read_b128 a[240:243],v4 offset:28672
ds_read_b128 a[248:251],v4 offset:30720
v_exp_f32 v104,v104
v_add_f32 v9,v103,v9
v_mfma_f32_32x32x16_bf16 v[64:79],a[200:203],a[168:171],v[64:79]
ds_read_b128 a[228:231],v4 offset:25600
ds_read_b128 a[236:239],v4 offset:27648
v_exp_f32 v105,v105
v_add_f32 v9,v104,v9
v_mfma_f32_32x32x16_bf16 v[64:79],a[204:207],a[172:175],v[64:79]
ds_read_b128 a[244:247],v4 offset:29696
ds_read_b128 a[252:255],v4 offset:31744
v_cvt_pk_bf16_f32 v139,v102,v103
v_exp_f32_e64 v106,v106
v_mfma_f32_32x32x16_bf16 v[64:79],a[208:211],a[176:179],v[64:79]
v_add_f32 v9,v105,v9
v_exp_f32 v107,v107
v_add_f32_e64 v9,v106,v9
v_cvt_pk_bf16_f32 v140,v104,v105
v_mfma_f32_32x32x16_bf16 v[64:79],a[212:215],a[180:183],v[64:79]
v_exp_f32 v108,v108
v_add_f32 v9,v107,v9
v_exp_f32 v109,v109
v_add_f32 v9,v108,v9
v_mfma_f32_32x32x16_bf16 v[64:79],a[216:219],a[184:187],v[64:79]
v_cvt_pk_bf16_f32 v141,v106,v107
v_exp_f32 v110,v110
v_add_f32 v9,v109,v9
v_exp_f32_e64 v111,v111
v_mfma_f32_32x32x16_bf16 v[64:79],a[220:223],a[188:191],v[64:79]
v_add_f32_e64 v9,v110,v9
v_cvt_pk_bf16_f32 v142,v108,v109
v_add_f32_e64 v9,v111,v9
v_cvt_pk_bf16_f32 v143,v110,v111
s_waitcnt lgkmcnt(0)
s_nop 0
v_mfma_f32_32x32x16_bf16 v[160:175],a[224:227],v[136:139],v[160:175]
ds_read_b128 a[192:195],v3 offset:16384
ds_read_b128 a[196:199],v3 offset:17408
v_mfma_f32_32x32x16_bf16 v[176:191],a[232:235],v[136:139],v[176:191]
ds_read_b128 a[200:203],v3 offset:18432
ds_read_b128 a[204:207],v3 offset:19456
v_mfma_f32_32x32x16_bf16 v[192:207],a[240:243],v[136:139],v[192:207]
ds_read_b128 a[208:211],v3 offset:20480
ds_read_b128 a[212:215],v3 offset:21504
v_mfma_f32_32x32x16_bf16 v[208:223],a[248:251],v[136:139],v[208:223]
ds_read_b128 a[216:219],v3 offset:22528
ds_read_b128 a[220:223],v3 offset:23552
v_exp_f32_e64 v64,v64
v_mfma_f32_32x32x16_bf16 v[160:175],a[228:231],v[140:143],v[160:175]
v_exp_f32 v65,v65
v_add_f32 v9,v64,v9
v_exp_f32 v66,v66
v_add_f32 v9,v65,v9
v_mfma_f32_32x32x16_bf16 v[176:191],a[236:239],v[140:143],v[176:191]
v_exp_f32 v67,v67
v_add_f32 v9,v66,v9
v_cvt_pk_bf16_f32 v120,v64,v65
v_exp_f32_e64 v68,v68
v_mfma_f32_32x32x16_bf16 v[192:207],a[244:247],v[140:143],v[192:207]
v_add_f32 v9,v67,v9
v_exp_f32 v69,v69
v_add_f32_e64 v9,v68,v9
v_cvt_pk_bf16_f32 v121,v66,v67
v_mfma_f32_32x32x16_bf16 v[208:223],a[252:255],v[140:143],v[208:223]
v_exp_f32 v70,v70
v_add_f32 v9,v69,v9
v_exp_f32_e64 v71,v71
v_cndmask_b32 v32,v32,v6,s[64:65]
v_cndmask_b32 v33,v33,v6,s[66:67]
v_cndmask_b32 v34,v34,v6,s[68:69]
v_cndmask_b32 v35,v35,v6,s[70:71]
v_cndmask_b32 v36,v36,v6,s[72:73]
v_cndmask_b32 v37,v37,v6,s[74:75]
v_cndmask_b32 v38,v38,v6,s[76:77]
v_cndmask_b32 v39,v39,v6,s[78:79]
v_cndmask_b32 v40,v40,v6,s[80:81]
v_cndmask_b32 v41,v41,v6,s[82:83]
v_cndmask_b32 v42,v42,v6,s[84:85]
v_cndmask_b32 v43,v43,v6,s[86:87]
v_cndmask_b32 v44,v44,v6,s[88:89]
v_cndmask_b32 v45,v45,v6,s[90:91]
v_cndmask_b32 v46,v46,v6,s[92:93]
v_cndmask_b32 v47,v47,v6,s[94:95]
v_mov_b32_e64 v4,v3
s_nop 0
s_waitcnt lgkmcnt(0)
v_mfma_f32_32x32x16_bf16 v[96:111],a[192:195],a[160:163],v[32:47]
ds_read_b128 a[224:227],v4 offset:8192
ds_read_b128 a[232:235],v4 offset:10240
v_add_f32_e64 v9,v70,v9
v_cvt_pk_bf16_f32 v122,v68,v69
v_mfma_f32_32x32x16_bf16 v[96:111],a[196:199],a[164:167],v[96:111]
ds_read_b128 a[240:243],v4 offset:12288
ds_read_b128 a[248:251],v4 offset:14336
v_exp_f32 v72,v72
v_add_f32 v9,v71,v9
v_mfma_f32_32x32x16_bf16 v[96:111],a[200:203],a[168:171],v[96:111]
ds_read_b128 a[228:231],v4 offset:9216
ds_read_b128 a[236:239],v4 offset:11264
v_exp_f32 v73,v73
v_add_f32 v9,v72,v9
v_mfma_f32_32x32x16_bf16 v[96:111],a[204:207],a[172:175],v[96:111]
ds_read_b128 a[244:247],v4 offset:13312
ds_read_b128 a[252:255],v4 offset:15360
v_cvt_pk_bf16_f32 v123,v70,v71
v_exp_f32_e64 v74,v74
v_mfma_f32_32x32x16_bf16 v[96:111],a[208:211],a[176:179],v[96:111]
v_add_f32 v9,v73,v9
v_exp_f32 v75,v75
v_add_f32_e64 v9,v74,v9
v_cvt_pk_bf16_f32 v124,v72,v73
v_mfma_f32_32x32x16_bf16 v[96:111],a[212:215],a[180:183],v[96:111]
v_exp_f32 v76,v76
v_add_f32 v9,v75,v9
v_exp_f32 v77,v77
v_add_f32 v9,v76,v9
v_mfma_f32_32x32x16_bf16 v[96:111],a[216:219],a[184:187],v[96:111]
v_cvt_pk_bf16_f32 v125,v74,v75
v_exp_f32 v78,v78
v_add_f32 v9,v77,v9
v_exp_f32_e64 v79,v79
v_mfma_f32_32x32x16_bf16 v[96:111],a[220:223],a[188:191],v[96:111]
v_add_f32_e64 v9,v78,v9
v_cvt_pk_bf16_f32 v126,v76,v77
v_add_f32_e64 v9,v79,v9
v_cvt_pk_bf16_f32 v127,v78,v79
s_waitcnt lgkmcnt(0)
s_nop 0
v_mfma_f32_32x32x16_bf16 v[160:175],a[224:227],v[120:123],v[160:175]
ds_read_b128 a[192:195],v4 offset:24576
ds_read_b128 a[200:203],v4 offset:26624
v_mfma_f32_32x32x16_bf16 v[176:191],a[232:235],v[120:123],v[176:191]
ds_read_b128 a[208:211],v4 offset:28672
ds_read_b128 a[216:219],v4 offset:30720
v_mfma_f32_32x32x16_bf16 v[192:207],a[240:243],v[120:123],v[192:207]
ds_read_b128 a[196:199],v4 offset:25600
ds_read_b128 a[204:207],v4 offset:27648
v_mfma_f32_32x32x16_bf16 v[208:223],a[248:251],v[120:123],v[208:223]
ds_read_b128 a[212:215],v4 offset:29696
ds_read_b128 a[220:223],v4 offset:31744
v_exp_f32_e64 v96,v96
v_mfma_f32_32x32x16_bf16 v[160:175],a[228:231],v[124:127],v[160:175]
v_exp_f32 v97,v97
v_add_f32 v9,v96,v9
v_exp_f32 v98,v98
v_add_f32 v9,v97,v9
v_mfma_f32_32x32x16_bf16 v[176:191],a[236:239],v[124:127],v[176:191]
v_exp_f32 v99,v99
v_add_f32 v9,v98,v9
v_cvt_pk_bf16_f32 v136,v96,v97
v_exp_f32_e64 v100,v100
v_mfma_f32_32x32x16_bf16 v[192:207],a[244:247],v[124:127],v[192:207]
v_add_f32 v9,v99,v9
v_exp_f32 v101,v101
v_add_f32_e64 v9,v100,v9
v_cvt_pk_bf16_f32 v137,v98,v99
v_mfma_f32_32x32x16_bf16 v[208:223],a[252:255],v[124:127],v[208:223]
v_exp_f32 v102,v102
v_add_f32 v9,v101,v9
v_exp_f32 v103,v103
s_waitcnt lgkmcnt(0)
v_add_f32_e64 v9,v102,v9
v_cvt_pk_bf16_f32 v138,v100,v101
v_exp_f32 v104,v104
v_add_f32 v9,v103,v9
v_exp_f32 v105,v105
v_add_f32 v9,v104,v9
v_cvt_pk_bf16_f32 v139,v102,v103
s_nop 1
v_mfma_f32_32x32x16_bf16 v[160:175],a[192:195],v[136:139],v[160:175]
v_exp_f32 v106,v106
v_add_f32 v9,v105,v9
v_exp_f32 v107,v107
v_add_f32_e64 v9,v106,v9
v_mfma_f32_32x32x16_bf16 v[176:191],a[200:203],v[136:139],v[176:191]
v_cvt_pk_bf16_f32 v140,v104,v105
v_exp_f32 v108,v108
v_add_f32 v9,v107,v9
v_exp_f32_e64 v109,v109
v_mfma_f32_32x32x16_bf16 v[192:207],a[208:211],v[136:139],v[192:207]
v_add_f32_e64 v9,v108,v9
v_cvt_pk_bf16_f32 v141,v106,v107
v_exp_f32 v110,v110
v_add_f32 v9,v109,v9
v_mfma_f32_32x32x16_bf16 v[208:223],a[216:219],v[136:139],v[208:223]
v_exp_f32 v111,v111
v_add_f32 v9,v110,v9
v_cvt_pk_bf16_f32 v142,v108,v109
v_add_f32_e64 v9,v111,v9
v_cvt_pk_bf16_f32 v143,v110,v111
s_nop 1
v_mfma_f32_32x32x16_bf16 v[160:175],a[196:199],v[140:143],v[160:175]
s_nop 0
v_mfma_f32_32x32x16_bf16 v[176:191],a[204:207],v[140:143],v[176:191]
v_mfma_f32_32x32x16_bf16 v[192:207],a[212:215],v[140:143],v[192:207]
v_mfma_f32_32x32x16_bf16 v[208:223],a[220:223],v[140:143],v[208:223]
s_branch b_done
s_nop 0
b_tail1:
s_add_u32 s50,s47,32768
s_cmp_ge_u32 s50,163840
s_cselect_b32 s50,0,s50
s_add_u32 s51,s50,32768
s_cmp_ge_u32 s51,163840
s_cselect_b32 s51,0,s51
v_cndmask_b32 v16,v16,v6,s[64:65]
v_cndmask_b32 v17,v17,v6,s[66:67]
v_cndmask_b32 v18,v18,v6,s[68:69]
v_cndmask_b32 v19,v19,v6,s[70:71]
v_cndmask_b32 v20,v20,v6,s[72:73]
v_cndmask_b32 v21,v21,v6,s[74:75]
v_cndmask_b32 v22,v22,v6,s[76:77]
v_cndmask_b32 v23,v23,v6,s[78:79]
v_cndmask_b32 v24,v24,v6,s[80:81]
v_cndmask_b32 v25,v25,v6,s[82:83]
v_cndmask_b32 v26,v26,v6,s[84:85]
v_cndmask_b32 v27,v27,v6,s[86:87]
v_cndmask_b32 v28,v28,v6,s[88:89]
v_cndmask_b32 v29,v29,v6,s[90:91]
v_cndmask_b32 v30,v30,v6,s[92:93]
v_cndmask_b32 v31,v31,v6,s[94:95]
s_nop 0
s_waitcnt lgkmcnt(0)
v_mfma_f32_32x32x16_bf16 v[80:95],a[192:195],a[128:131],v[16:31]
ds_read_b128 a[224:227],v4 offset:8192
v_add_f32 v9,v67,v9
v_exp_f32 v69,v69
v_add_f32_e64 v9,v68,v9
v_cvt_pk_bf16_f32 v121,v66,v67
v_mfma_f32_32x32x16_bf16 v[96:111],a[192:195],a[160:163],v[32:47]
ds_read_b128 a[232:235],v4 offset:10240
v_exp_f32 v70,v70
v_add_f32 v9,v69,v9
v_exp_f32_e64 v71,v71
v_mfma_f32_32x32x16_bf16 v[80:95],a[196:199],a[132:135],v[80:95]
ds_read_b128 a[240:243],v4 offset:12288
v_add_f32_e64 v9,v70,v9
v_cvt_pk_bf16_f32 v122,v68,v69
v_exp_f32 v56,v56
v_add_f32 v9,v71,v9
v_mfma_f32_32x32x16_bf16 v[96:111],a[196:199],a[164:167],v[96:111]
v_exp_f32 v57,v57
v_add_f32 v8,v56,v8
v_cvt_pk_bf16_f32 v123,v70,v71
v_exp_f32_e64 v58,v58
v_mfma_f32_32x32x16_bf16 v[80:95],a[200:203],a[136:139],v[80:95]
ds_read_b128 a[248:251],v4 offset:14336
v_add_f32 v8,v57,v8
v_exp_f32 v59,v59
v_add_f32_e64 v8,v58,v8
v_cvt_pk_bf16_f32 v116,v56,v57
v_mfma_f32_32x32x16_bf16 v[96:111],a[200:203],a[168:171],v[96:111]
v_exp_f32 v60,v60
v_add_f32 v8,v59,v8
v_exp_f32 v61,v61
v_add_f32 v8,v60,v8
v_mfma_f32_32x32x16_bf16 v[80:95],a[204:207],a[140:143],v[80:95]
ds_read_b128 a[228:231],v4 offset:9216
v_cvt_pk_bf16_f32 v117,v58,v59
v_exp_f32 v62,v62
v_add_f32 v8,v61,v8
v_mfma_f32_32x32x16_bf16 v[96:111],a[204:207],a[172:175],v[96:111]
v_exp_f32 v63,v63
v_add_f32 v8,v62,v8
v_cvt_pk_bf16_f32 v118,v60,v61
v_exp_f32_e64 v72,v72
v_mfma_f32_32x32x16_bf16 v[80:95],a[208:211],a[144:147],v[80:95]
ds_read_b128 a[236:239],v4 offset:11264
v_add_f32 v8,v63,v8
v_exp_f32 v73,v73
v_add_f32_e64 v9,v72,v9
v_cvt_pk_bf16_f32 v119,v62,v63
v_mfma_f32_32x32x16_bf16 v[96:111],a[208:211],a[176:179],v[96:111]
v_exp_f32 v74,v74
v_add_f32 v9,v73,v9
v_exp_f32 v75,v75
v_add_f32 v9,v74,v9
v_mfma_f32_32x32x16_bf16 v[80:95],a[212:215],a[148:151],v[80:95]
ds_read_b128 a[244:247],v4 offset:13312
v_cvt_pk_bf16_f32 v124,v72,v73
v_exp_f32 v76,v76
v_add_f32 v9,v75,v9
v_mfma_f32_32x32x16_bf16 v[96:111],a[212:215],a[180:183],v[96:111]
ds_read_b128 a[252:255],v4 offset:15360
v_exp_f32 v77,v77
v_add_f32 v9,v76,v9
v_cvt_pk_bf16_f32 v125,v74,v75
v_mfma_f32_32x32x16_bf16 v[80:95],a[216:219],a[152:155],v[80:95]
v_exp_f32 v78,v78
v_add_f32 v9,v77,v9
v_exp_f32 v79,v79
v_add_f32 v9,v78,v9
v_mfma_f32_32x32x16_bf16 v[96:111],a[216:219],a[184:187],v[96:111]
v_cvt_pk_bf16_f32 v126,v76,v77
v_add_f32_e64 v9,v79,v9
v_cvt_pk_bf16_f32 v127,v78,v79
v_mfma_f32_32x32x16_bf16 v[80:95],a[220:223],a[156:159],v[80:95]
v_mfma_f32_32x32x16_bf16 v[96:111],a[220:223],a[188:191],v[96:111]
s_waitcnt lgkmcnt(0)
s_nop 0
v_mfma_f32_32x32x16_bf16 a[0:15],a[224:227],v[112:115],a[0:15]
s_waitcnt vmcnt(0)
s_barrier
ds_read_b128 a[192:195],v3 offset:0
v_mfma_f32_32x32x16_bf16 v[160:175],a[224:227],v[120:123],v[160:175]
ds_read_b128 a[196:199],v3 offset:1024
v_mfma_f32_32x32x16_bf16 a[16:31],a[232:235],v[112:115],a[16:31]
ds_read_b128 a[200:203],v3 offset:2048
v_mfma_f32_32x32x16_bf16 v[176:191],a[232:235],v[120:123],v[176:191]
s_nop 0
v_exp_f32 v80,v80
v_exp_f32 v81,v81
v_add_f32 v8,v80,v8
v_mfma_f32_32x32x16_bf16 a[32:47],a[240:243],v[112:115],a[32:47]
ds_read_b128 a[204:207],v3 offset:3072
v_exp_f32 v82,v82
v_add_f32 v8,v81,v8
v_exp_f32_e64 v83,v83
v_mfma_f32_32x32x16_bf16 v[192:207],a[240:243],v[120:123],v[192:207]
v_add_f32_e64 v8,v82,v8
v_cvt_pk_bf16_f32 v128,v80,v81
v_exp_f32 v84,v84
v_add_f32 v8,v83,v8
v_mfma_f32_32x32x16_bf16 a[48:63],a[248:251],v[112:115],a[48:63]
ds_read_b128 a[208:211],v3 offset:4096
v_exp_f32 v85,v85
v_add_f32 v8,v84,v8
v_cvt_pk_bf16_f32 v129,v82,v83
v_mfma_f32_32x32x16_bf16 v[208:223],a[248:251],v[120:123],v[208:223]
v_exp_f32 v86,v86
v_add_f32 v8,v85,v8
v_exp_f32 v87,v87
v_add_f32 v8,v86,v8
v_mfma_f32_32x32x16_bf16 a[0:15],a[228:231],v[116:119],a[0:15]
ds_read_b128 a[212:215],v3 offset:5120
v_cvt_pk_bf16_f32 v130,v84,v85
v_exp_f32 v96,v96
v_add_f32 v8,v87,v8
v_mfma_f32_32x32x16_bf16 v[160:175],a[228:231],v[124:127],v[160:175]
v_exp_f32 v97,v97
v_add_f32 v9,v96,v9
v_cvt_pk_bf16_f32 v131,v86,v87
v_exp_f32_e64 v98,v98
v_mfma_f32_32x32x16_bf16 a[16:31],a[236:239],v[116:119],a[16:31]
ds_read_b128 a[216:219],v3 offset:6144
v_add_f32 v9,v97,v9
v_exp_f32 v99,v99
v_add_f32_e64 v9,v98,v9
v_cvt_pk_bf16_f32 v136,v96,v97
v_mfma_f32_32x32x16_bf16 v[176:191],a[236:239],v[124:127],v[176:191]
ds_read_b128 a[220:223],v3 offset:7168
v_exp_f32 v100,v100
v_add_f32 v9,v99,v9
v_exp_f32_e64 v101,v101
v_mfma_f32_32x32x16_bf16 a[32:47],a[244:247],v[116:119],a[32:47]
v_add_f32_e64 v9,v100,v9
v_cvt_pk_bf16_f32 v137,v98,v99
v_exp_f32 v102,v102
v_add_f32 v9,v101,v9
v_mfma_f32_32x32x16_bf16 v[192:207],a[244:247],v[124:127],v[192:207]
v_exp_f32 v103,v103
v_add_f32 v9,v102,v9
v_cvt_pk_bf16_f32 v138,v100,v101
v_exp_f32_e64 v88,v88
v_mfma_f32_32x32x16_bf16 a[48:63],a[252:255],v[116:119],a[48:63]
v_add_f32 v9,v103,v9
v_exp_f32 v89,v89
v_add_f32_e64 v8,v88,v8
v_cvt_pk_bf16_f32 v139,v102,v103
v_mfma_f32_32x32x16_bf16 v[208:223],a[252:255],v[124:127],v[208:223]
v_exp_f32 v90,v90
v_add_f32 v8,v89,v8
v_exp_f32 v91,v91
s_waitcnt lgkmcnt(0)
v_mfma_f32_32x32x16_bf16 v[64:79],a[192:195],a[160:163],v[32:47]
ds_read_b128 a[224:227],v4 offset:24576
ds_read_b128 a[232:235],v4 offset:26624
v_add_f32_e64 v8,v90,v8
v_cvt_pk_bf16_f32 v132,v88,v89
v_mfma_f32_32x32x16_bf16 v[64:79],a[196:199],a[164:167],v[64:79]
ds_read_b128 a[240:243],v4 offset:28672
ds_read_b128 a[248:251],v4 offset:30720
v_exp_f32 v92,v92
v_add_f32 v8,v91,v8
v_mfma_f32_32x32x16_bf16 v[64:79],a[200:203],a[168:171],v[64:79]
ds_read_b128 a[228:231],v4 offset:25600
ds_read_b128 a[236:239],v4 offset:27648
v_exp_f32 v93,v93
v_add_f32 v8,v92,v8
v_mfma_f32_32x32x16_bf16 v[64:79],a[204:207],a[172:175],v[64:79]
ds_read_b128 a[244:247],v4 offset:29696
ds_read_b128 a[252:255],v4 offset:31744
v_cvt_pk_bf16_f32 v133,v90,v91
v_exp_f32_e64 v94,v94
v_mfma_f32_32x32x16_bf16 v[64:79],a[208:211],a[176:179],v[64:79]
v_add_f32 v8,v93,v8
v_exp_f32 v95,v95
v_add_f32_e64 v8,v94,v8
v_cvt_pk_bf16_f32 v134,v92,v93
v_mfma_f32_32x32x16_bf16 v[64:79],a[212:215],a[180:183],v[64:79]
v_exp_f32 v104,v104
v_add_f32 v8,v95,v8
v_exp_f32 v105,v105
v_add_f32 v9,v104,v9
v_mfma_f32_32x32x16_bf16 v[64:79],a[216:219],a[184:187],v[64:79]
v_cvt_pk_bf16_f32 v135,v94,v95
v_exp_f32 v106,v106
v_add_f32 v9,v105,v9
v_exp_f32_e64 v107,v107
v_mfma_f32_32x32x16_bf16 v[64:79],a[220:223],a[188:191],v[64:79]
v_add_f32_e64 v9,v106,v9
v_cvt_pk_bf16_f32 v140,v104,v105
v_exp_f32 v108,v108
v_add_f32_e64 v9,v107,v9
s_waitcnt lgkmcnt(0)
v_mfma_f32_32x32x16_bf16 a[0:15],a[224:227],v[128:131],a[0:15]
ds_read_b128 a[192:195],v3 offset:16384
v_exp_f32 v109,v109
v_add_f32 v9,v108,v9
v_cvt_pk_bf16_f32 v141,v106,v107
v_mfma_f32_32x32x16_bf16 v[160:175],a[224:227],v[136:139],v[160:175]
ds_read_b128 a[196:199],v3 offset:17408
v_exp_f32 v110,v110
v_add_f32 v9,v109,v9
v_exp_f32_e64 v111,v111
v_mfma_f32_32x32x16_bf16 a[16:31],a[232:235],v[128:131],a[16:31]
ds_read_b128 a[200:203],v3 offset:18432
v_add_f32_e64 v9,v110,v9
v_cvt_pk_bf16_f32 v142,v108,v109
v_add_f32_e64 v9,v111,v9
v_cvt_pk_bf16_f32 v143,v110,v111
v_mfma_f32_32x32x16_bf16 v[176:191],a[232:235],v[136:139],v[176:191]
v_exp_f32 v64,v64
v_exp_f32 v65,v65
v_add_f32_e64 v9,v64,v9
v_mfma_f32_32x32x16_bf16 a[32:47],a[240:243],v[128:131],a[32:47]
ds_read_b128 a[204:207],v3 offset:19456
v_exp_f32 v66,v66
v_add_f32 v9,v65,v9
v_exp_f32_e64 v67,v67
v_mfma_f32_32x32x16_bf16 v[192:207],a[240:243],v[136:139],v[192:207]
v_add_f32_e64 v9,v66,v9
v_cvt_pk_bf16_f32 v120,v64,v65
v_exp_f32 v68,v68
v_add_f32 v9,v67,v9
v_mfma_f32_32x32x16_bf16 a[48:63],a[248:251],v[128:131],a[48:63]
ds_read_b128 a[208:211],v3 offset:20480
v_exp_f32 v69,v69
v_add_f32 v9,v68,v9
v_cvt_pk_bf16_f32 v121,v66,v67
v_mfma_f32_32x32x16_bf16 v[208:223],a[248:251],v[136:139],v[208:223]
v_exp_f32 v70,v70
v_add_f32 v9,v69,v9
v_exp_f32 v71,v71
v_add_f32 v9,v70,v9
v_mfma_f32_32x32x16_bf16 a[0:15],a[228:231],v[132:135],a[0:15]
ds_read_b128 a[212:215],v3 offset:21504
v_cvt_pk_bf16_f32 v122,v68,v69
v_exp_f32 v72,v72
v_add_f32 v9,v71,v9
v_mfma_f32_32x32x16_bf16 v[160:175],a[228:231],v[140:143],v[160:175]
v_exp_f32 v73,v73
v_add_f32 v9,v72,v9
v_cvt_pk_bf16_f32 v123,v70,v71
v_exp_f32_e64 v74,v74
v_mfma_f32_32x32x16_bf16 a[16:31],a[236:239],v[132:135],a[16:31]
ds_read_b128 a[216:219],v3 offset:22528
v_add_f32 v9,v73,v9
v_exp_f32 v75,v75
v_add_f32_e64 v9,v74,v9
v_cvt_pk_bf16_f32 v124,v72,v73
v_mfma_f32_32x32x16_bf16 v[176:191],a[236:239],v[140:143],v[176:191]
ds_read_b128 a[220:223],v3 offset:23552
v_exp_f32 v76,v76
v_add_f32 v9,v75,v9
v_exp_f32_e64 v77,v77
v_mfma_f32_32x32x16_bf16 a[32:47],a[244:247],v[132:135],a[32:47]
v_add_f32_e64 v9,v76,v9
v_cvt_pk_bf16_f32 v125,v74,v75
v_exp_f32 v78,v78
v_add_f32 v9,v77,v9
v_mfma_f32_32x32x16_bf16 v[192:207],a[244:247],v[140:143],v[192:207]
v_exp_f32 v79,v79
v_add_f32 v9,v78,v9
v_cvt_pk_bf16_f32 v126,v76,v77
v_add_f32_e64 v9,v79,v9
v_cvt_pk_bf16_f32 v127,v78,v79
v_mfma_f32_32x32x16_bf16 a[48:63],a[252:255],v[132:135],a[48:63]
v_mfma_f32_32x32x16_bf16 v[208:223],a[252:255],v[140:143],v[208:223]
v_mov_b32_e64 v4,v3
s_nop 0
s_waitcnt lgkmcnt(0)
v_mfma_f32_32x32x16_bf16 v[96:111],a[192:195],a[160:163],v[32:47]
ds_read_b128 a[224:227],v4 offset:8192
ds_read_b128 a[232:235],v4 offset:10240
v_mfma_f32_32x32x16_bf16 v[96:111],a[196:199],a[164:167],v[96:111]
ds_read_b128 a[240:243],v4 offset:12288
ds_read_b128 a[248:251],v4 offset:14336
v_mfma_f32_32x32x16_bf16 v[96:111],a[200:203],a[168:171],v[96:111]
ds_read_b128 a[228:231],v4 offset:9216
ds_read_b128 a[236:239],v4 offset:11264
v_mfma_f32_32x32x16_bf16 v[96:111],a[204:207],a[172:175],v[96:111]
ds_read_b128 a[244:247],v4 offset:13312
ds_read_b128 a[252:255],v4 offset:15360
v_mfma_f32_32x32x16_bf16 v[96:111],a[208:211],a[176:179],v[96:111]
v_mfma_f32_32x32x16_bf16 v[96:111],a[212:215],a[180:183],v[96:111]
v_mfma_f32_32x32x16_bf16 v[96:111],a[216:219],a[184:187],v[96:111]
v_mfma_f32_32x32x16_bf16 v[96:111],a[220:223],a[188:191],v[96:111]
v_add_u32_e64 v3,s50,v2
s_nop 0
s_waitcnt lgkmcnt(0)
v_mfma_f32_32x32x16_bf16 v[160:175],a[224:227],v[120:123],v[160:175]
ds_read_b128 a[192:195],v3 offset:0
ds_read_b128 a[196:199],v3 offset:1024
v_mfma_f32_32x32x16_bf16 v[176:191],a[232:235],v[120:123],v[176:191]
ds_read_b128 a[200:203],v3 offset:2048
ds_read_b128 a[204:207],v3 offset:3072
v_mfma_f32_32x32x16_bf16 v[192:207],a[240:243],v[120:123],v[192:207]
ds_read_b128 a[208:211],v3 offset:4096
ds_read_b128 a[212:215],v3 offset:5120
v_mfma_f32_32x32x16_bf16 v[208:223],a[248:251],v[120:123],v[208:223]
ds_read_b128 a[216:219],v3 offset:6144
ds_read_b128 a[220:223],v3 offset:7168
v_exp_f32_e64 v96,v96
v_mfma_f32_32x32x16_bf16 v[160:175],a[228:231],v[124:127],v[160:175]
v_exp_f32 v97,v97
v_add_f32 v9,v96,v9
v_exp_f32 v98,v98
v_add_f32 v9,v97,v9
v_mfma_f32_32x32x16_bf16 v[176:191],a[236:239],v[124:127],v[176:191]
v_exp_f32 v99,v99
v_add_f32 v9,v98,v9
v_cvt_pk_bf16_f32 v136,v96,v97
v_exp_f32_e64 v100,v100
v_mfma_f32_32x32x16_bf16 v[192:207],a[244:247],v[124:127],v[192:207]
v_add_f32 v9,v99,v9
v_exp_f32 v101,v101
v_add_f32_e64 v9,v100,v9
v_cvt_pk_bf16_f32 v137,v98,v99
v_mfma_f32_32x32x16_bf16 v[208:223],a[252:255],v[124:127],v[208:223]
v_exp_f32 v102,v102
v_add_f32 v9,v101,v9
v_exp_f32 v103,v103
s_waitcnt lgkmcnt(0)
v_mfma_f32_32x32x16_bf16 v[64:79],a[192:195],a[160:163],v[32:47]
ds_read_b128 a[224:227],v4 offset:24576
ds_read_b128 a[232:235],v4 offset:26624
v_add_f32_e64 v9,v102,v9
v_cvt_pk_bf16_f32 v138,v100,v101
v_mfma_f32_32x32x16_bf16 v[64:79],a[196:199],a[164:167],v[64:79]
ds_read_b128 a[240:243],v4 offset:28672
ds_read_b128 a[248:251],v4 offset:30720
v_exp_f32 v104,v104
v_add_f32 v9,v103,v9
v_mfma_f32_32x32x16_bf16 v[64:79],a[200:203],a[168:171],v[64:79]
ds_read_b128 a[228:231],v4 offset:25600
ds_read_b128 a[236:239],v4 offset:27648
v_exp_f32 v105,v105
v_add_f32 v9,v104,v9
v_mfma_f32_32x32x16_bf16 v[64:79],a[204:207],a[172:175],v[64:79]
ds_read_b128 a[244:247],v4 offset:29696
ds_read_b128 a[252:255],v4 offset:31744
v_cvt_pk_bf16_f32 v139,v102,v103
v_exp_f32_e64 v106,v106
v_mfma_f32_32x32x16_bf16 v[64:79],a[208:211],a[176:179],v[64:79]
v_add_f32 v9,v105,v9
v_exp_f32 v107,v107
v_add_f32_e64 v9,v106,v9
v_cvt_pk_bf16_f32 v140,v104,v105
v_mfma_f32_32x32x16_bf16 v[64:79],a[212:215],a[180:183],v[64:79]
v_exp_f32 v108,v108
v_add_f32 v9,v107,v9
v_exp_f32 v109,v109
v_add_f32 v9,v108,v9
v_mfma_f32_32x32x16_bf16 v[64:79],a[216:219],a[184:187],v[64:79]
v_cvt_pk_bf16_f32 v141,v106,v107
v_exp_f32 v110,v110
v_add_f32 v9,v109,v9
v_exp_f32_e64 v111,v111
v_mfma_f32_32x32x16_bf16 v[64:79],a[220:223],a[188:191],v[64:79]
v_add_f32_e64 v9,v110,v9
v_cvt_pk_bf16_f32 v142,v108,v109
v_add_f32_e64 v9,v111,v9
v_cvt_pk_bf16_f32 v143,v110,v111
s_waitcnt lgkmcnt(0)
s_nop 0
v_mfma_f32_32x32x16_bf16 v[160:175],a[224:227],v[136:139],v[160:175]
ds_read_b128 a[192:195],v3 offset:16384
ds_read_b128 a[196:199],v3 offset:17408
v_mfma_f32_32x32x16_bf16 v[176:191],a[232:235],v[136:139],v[176:191]
ds_read_b128 a[200:203],v3 offset:18432
ds_read_b128 a[204:207],v3 offset:19456
v_mfma_f32_32x32x16_bf16 v[192:207],a[240:243],v[136:139],v[192:207]
ds_read_b128 a[208:211],v3 offset:20480
ds_read_b128 a[212:215],v3 offset:21504
v_mfma_f32_32x32x16_bf16 v[208:223],a[248:251],v[136:139],v[208:223]
ds_read_b128 a[216:219],v3 offset:22528
ds_read_b128 a[220:223],v3 offset:23552
v_exp_f32_e64 v64,v64
v_mfma_f32_32x32x16_bf16 v[160:175],a[228:231],v[140:143],v[160:175]
v_exp_f32 v65,v65
v_add_f32 v9,v64,v9
v_exp_f32 v66,v66
v_add_f32 v9,v65,v9
v_mfma_f32_32x32x16_bf16 v[176:191],a[236:239],v[140:143],v[176:191]
v_exp_f32 v67,v67
v_add_f32 v9,v66,v9
v_cvt_pk_bf16_f32 v120,v64,v65
v_exp_f32_e64 v68,v68
v_mfma_f32_32x32x16_bf16 v[192:207],a[244:247],v[140:143],v[192:207]
v_add_f32 v9,v67,v9
v_exp_f32 v69,v69
v_add_f32_e64 v9,v68,v9
v_cvt_pk_bf16_f32 v121,v66,v67
v_mfma_f32_32x32x16_bf16 v[208:223],a[252:255],v[140:143],v[208:223]
v_exp_f32 v70,v70
v_add_f32 v9,v69,v9
v_exp_f32 v71,v71
v_mov_b32 v4,v3
s_nop 0
s_waitcnt lgkmcnt(0)
v_mfma_f32_32x32x16_bf16 v[96:111],a[192:195],a[160:163],v[32:47]
ds_read_b128 a[224:227],v4 offset:8192
ds_read_b128 a[232:235],v4 offset:10240
v_add_f32_e64 v9,v70,v9
v_cvt_pk_bf16_f32 v122,v68,v69
v_mfma_f32_32x32x16_bf16 v[96:111],a[196:199],a[164:167],v[96:111]
ds_read_b128 a[240:243],v4 offset:12288
ds_read_b128 a[248:251],v4 offset:14336
v_exp_f32 v72,v72
v_add_f32 v9,v71,v9
v_mfma_f32_32x32x16_bf16 v[96:111],a[200:203],a[168:171],v[96:111]
ds_read_b128 a[228:231],v4 offset:9216
ds_read_b128 a[236:239],v4 offset:11264
v_exp_f32 v73,v73
v_add_f32 v9,v72,v9
v_mfma_f32_32x32x16_bf16 v[96:111],a[204:207],a[172:175],v[96:111]
ds_read_b128 a[244:247],v4 offset:13312
ds_read_b128 a[252:255],v4 offset:15360
v_cvt_pk_bf16_f32 v123,v70,v71
v_exp_f32_e64 v74,v74
v_mfma_f32_32x32x16_bf16 v[96:111],a[208:211],a[176:179],v[96:111]
v_add_f32 v9,v73,v9
v_exp_f32 v75,v75
v_add_f32_e64 v9,v74,v9
v_cvt_pk_bf16_f32 v124,v72,v73
v_mfma_f32_32x32x16_bf16 v[96:111],a[212:215],a[180:183],v[96:111]
v_exp_f32 v76,v76
v_add_f32 v9,v75,v9
v_exp_f32 v77,v77
v_add_f32 v9,v76,v9
v_mfma_f32_32x32x16_bf16 v[96:111],a[216:219],a[184:187],v[96:111]
v_cvt_pk_bf16_f32 v125,v74,v75
v_exp_f32 v78,v78
v_add_f32 v9,v77,v9
v_exp_f32_e64 v79,v79
v_mfma_f32_32x32x16_bf16 v[96:111],a[220:223],a[188:191],v[96:111]
v_add_f32_e64 v9,v78,v9
v_cvt_pk_bf16_f32 v126,v76,v77
v_add_f32_e64 v9,v79,v9
v_cvt_pk_bf16_f32 v127,v78,v79
v_add_u32_e64 v3,s51,v2
s_nop 0
s_waitcnt lgkmcnt(0)
v_mfma_f32_32x32x16_bf16 v[160:175],a[224:227],v[120:123],v[160:175]
ds_read_b128 a[192:195],v3 offset:0
ds_read_b128 a[196:199],v3 offset:1024
v_mfma_f32_32x32x16_bf16 v[176:191],a[232:235],v[120:123],v[176:191]
ds_read_b128 a[200:203],v3 offset:2048
ds_read_b128 a[204:207],v3 offset:3072
v_mfma_f32_32x32x16_bf16 v[192:207],a[240:243],v[120:123],v[192:207]
ds_read_b128 a[208:211],v3 offset:4096
ds_read_b128 a[212:215],v3 offset:5120
v_mfma_f32_32x32x16_bf16 v[208:223],a[248:251],v[120:123],v[208:223]
ds_read_b128 a[216:219],v3 offset:6144
ds_read_b128 a[220:223],v3 offset:7168
v_exp_f32_e64 v96,v96
v_mfma_f32_32x32x16_bf16 v[160:175],a[228:231],v[124:127],v[160:175]
v_exp_f32 v97,v97
v_add_f32 v9,v96,v9
v_exp_f32 v98,v98
v_add_f32 v9,v97,v9
v_mfma_f32_32x32x16_bf16 v[176:191],a[236:239],v[124:127],v[176:191]
v_exp_f32 v99,v99
v_add_f32 v9,v98,v9
v_cvt_pk_bf16_f32 v136,v96,v97
v_exp_f32_e64 v100,v100
v_mfma_f32_32x32x16_bf16 v[192:207],a[244:247],v[124:127],v[192:207]
v_add_f32 v9,v99,v9
v_exp_f32 v101,v101
v_add_f32_e64 v9,v100,v9
v_cvt_pk_bf16_f32 v137,v98,v99
v_mfma_f32_32x32x16_bf16 v[208:223],a[252:255],v[124:127],v[208:223]
v_exp_f32 v102,v102
v_add_f32 v9,v101,v9
v_exp_f32_e64 v103,v103
v_cndmask_b32 v32,v32,v6,s[64:65]
v_cndmask_b32 v33,v33,v6,s[66:67]
v_cndmask_b32 v34,v34,v6,s[68:69]
v_cndmask_b32 v35,v35,v6,s[70:71]
v_cndmask_b32 v36,v36,v6,s[72:73]
v_cndmask_b32 v37,v37,v6,s[74:75]
v_cndmask_b32 v38,v38,v6,s[76:77]
v_cndmask_b32 v39,v39,v6,s[78:79]
v_cndmask_b32 v40,v40,v6,s[80:81]
v_cndmask_b32 v41,v41,v6,s[82:83]
v_cndmask_b32 v42,v42,v6,s[84:85]
v_cndmask_b32 v43,v43,v6,s[86:87]
v_cndmask_b32 v44,v44,v6,s[88:89]
v_cndmask_b32 v45,v45,v6,s[90:91]
v_cndmask_b32 v46,v46,v6,s[92:93]
v_cndmask_b32 v47,v47,v6,s[94:95]
s_nop 0
s_waitcnt lgkmcnt(0)
v_mfma_f32_32x32x16_bf16 v[64:79],a[192:195],a[160:163],v[32:47]
ds_read_b128 a[224:227],v4 offset:24576
ds_read_b128 a[232:235],v4 offset:26624
v_add_f32_e64 v9,v102,v9
v_cvt_pk_bf16_f32 v138,v100,v101
v_mfma_f32_32x32x16_bf16 v[64:79],a[196:199],a[164:167],v[64:79]
ds_read_b128 a[240:243],v4 offset:28672
ds_read_b128 a[248:251],v4 offset:30720
v_exp_f32 v104,v104
v_add_f32 v9,v103,v9
v_mfma_f32_32x32x16_bf16 v[64:79],a[200:203],a[168:171],v[64:79]
ds_read_b128 a[228:231],v4 offset:25600
ds_read_b128 a[236:239],v4 offset:27648
v_exp_f32 v105,v105
v_add_f32 v9,v104,v9
v_mfma_f32_32x32x16_bf16 v[64:79],a[204:207],a[172:175],v[64:79]
ds_read_b128 a[244:247],v4 offset:29696
ds_read_b128 a[252:255],v4 offset:31744
v_cvt_pk_bf16_f32 v139,v102,v103
v_exp_f32_e64 v106,v106
v_mfma_f32_32x32x16_bf16 v[64:79],a[208:211],a[176:179],v[64:79]
v_add_f32 v9,v105,v9
v_exp_f32 v107,v107
v_add_f32_e64 v9,v106,v9
v_cvt_pk_bf16_f32 v140,v104,v105
v_mfma_f32_32x32x16_bf16 v[64:79],a[212:215],a[180:183],v[64:79]
v_exp_f32 v108,v108
v_add_f32 v9,v107,v9
v_exp_f32 v109,v109
v_add_f32 v9,v108,v9
v_mfma_f32_32x32x16_bf16 v[64:79],a[216:219],a[184:187],v[64:79]
v_cvt_pk_bf16_f32 v141,v106,v107
v_exp_f32 v110,v110
v_add_f32 v9,v109,v9
v_exp_f32_e64 v111,v111
v_mfma_f32_32x32x16_bf16 v[64:79],a[220:223],a[188:191],v[64:79]
v_add_f32_e64 v9,v110,v9
v_cvt_pk_bf16_f32 v142,v108,v109
v_add_f32_e64 v9,v111,v9
v_cvt_pk_bf16_f32 v143,v110,v111
v_mov_b32_e64 v4,v3
s_nop 0
s_waitcnt lgkmcnt(0)
v_mfma_f32_32x32x16_bf16 v[160:175],a[224:227],v[136:139],v[160:175]
ds_read_b128 a[192:195],v4 offset:8192
ds_read_b128 a[200:203],v4 offset:10240
v_mfma_f32_32x32x16_bf16 v[176:191],a[232:235],v[136:139],v[176:191]
ds_read_b128 a[208:211],v4 offset:12288
ds_read_b128 a[216:219],v4 offset:14336
v_mfma_f32_32x32x16_bf16 v[192:207],a[240:243],v[136:139],v[192:207]
ds_read_b128 a[196:199],v4 offset:9216
ds_read_b128 a[204:207],v4 offset:11264
v_mfma_f32_32x32x16_bf16 v[208:223],a[248:251],v[136:139],v[208:223]
ds_read_b128 a[212:215],v4 offset:13312
ds_read_b128 a[220:223],v4 offset:15360
v_exp_f32_e64 v64,v64
v_mfma_f32_32x32x16_bf16 v[160:175],a[228:231],v[140:143],v[160:175]
v_exp_f32 v65,v65
v_add_f32 v9,v64,v9
v_exp_f32 v66,v66
v_add_f32 v9,v65,v9
v_mfma_f32_32x32x16_bf16 v[176:191],a[236:239],v[140:143],v[176:191]
v_exp_f32 v67,v67
v_add_f32 v9,v66,v9
v_cvt_pk_bf16_f32 v120,v64,v65
v_exp_f32_e64 v68,v68
v_mfma_f32_32x32x16_bf16 v[192:207],a[244:247],v[140:143],v[192:207]
v_add_f32 v9,v67,v9
v_exp_f32 v69,v69
v_add_f32_e64 v9,v68,v9
v_cvt_pk_bf16_f32 v121,v66,v67
v_mfma_f32_32x32x16_bf16 v[208:223],a[252:255],v[140:143],v[208:223]
v_exp_f32 v70,v70
v_add_f32 v9,v69,v9
v_exp_f32 v71,v71
s_waitcnt lgkmcnt(0)
v_add_f32_e64 v9,v70,v9
v_cvt_pk_bf16_f32 v122,v68,v69
v_exp_f32 v72,v72
v_add_f32 v9,v71,v9
v_exp_f32 v73,v73
v_add_f32 v9,v72,v9
v_cvt_pk_bf16_f32 v123,v70,v71
s_nop 1
v_mfma_f32_32x32x16_bf16 v[160:175],a[192:195],v[120:123],v[160:175]
v_exp_f32 v74,v74
v_add_f32 v9,v73,v9
v_exp_f32 v75,v75
v_add_f32_e64 v9,v74,v9
v_mfma_f32_32x32x16_bf16 v[176:191],a[200:203],v[120:123],v[176:191]
v_cvt_pk_bf16_f32 v124,v72,v73
v_exp_f32 v76,v76
v_add_f32 v9,v75,v9
v_exp_f32_e64 v77,v77
v_mfma_f32_32x32x16_bf16 v[192:207],a[208:211],v[120:123],v[192:207]
v_add_f32_e64 v9,v76,v9
v_cvt_pk_bf16_f32 v125,v74,v75
v_exp_f32 v78,v78
v_add_f32 v9,v77,v9
v_mfma_f32_32x32x16_bf16 v[208:223],a[216:219],v[120:123],v[208:223]
v_exp_f32 v79,v79
v_add_f32 v9,v78,v9
v_cvt_pk_bf16_f32 v126,v76,v77
v_add_f32_e64 v9,v79,v9
v_cvt_pk_bf16_f32 v127,v78,v79
s_nop 1
v_mfma_f32_32x32x16_bf16 v[160:175],a[196:199],v[124:127],v[160:175]
s_nop 0
v_mfma_f32_32x32x16_bf16 v[176:191],a[204:207],v[124:127],v[176:191]
v_mfma_f32_32x32x16_bf16 v[192:207],a[212:215],v[124:127],v[192:207]
v_mfma_f32_32x32x16_bf16 v[208:223],a[220:223],v[124:127],v[208:223]
s_branch b_done
s_nop 0
b_tail2:
s_add_u32 s50,s47,32768
s_cmp_ge_u32 s50,163840
s_cselect_b32 s50,0,s50
s_add_u32 s51,s50,32768
s_cmp_ge_u32 s51,163840
s_cselect_b32 s51,0,s51
s_waitcnt lgkmcnt(0)
v_mfma_f32_32x32x16_bf16 v[80:95],a[192:195],a[128:131],v[16:31]
ds_read_b128 a[224:227],v4 offset:8192
v_add_f32 v9,v67,v9
v_exp_f32 v69,v69
v_add_f32 v9,v68,v9
v_cvt_pk_bf16_f32 v121,v66,v67
v_mfma_f32_32x32x16_bf16 v[96:111],a[192:195],a[160:163],v[32:47]
ds_read_b128 a[232:235],v4 offset:10240
v_exp_f32 v70,v70
v_add_f32 v9,v69,v9
v_exp_f32_e64 v71,v71
v_mfma_f32_32x32x16_bf16 v[80:95],a[196:199],a[132:135],v[80:95]
ds_read_b128 a[240:243],v4 offset:12288
v_add_f32_e64 v9,v70,v9
v_cvt_pk_bf16_f32 v122,v68,v69
v_exp_f32 v56,v56
v_add_f32 v9,v71,v9
v_mfma_f32_32x32x16_bf16 v[96:111],a[196:199],a[164:167],v[96:111]
v_exp_f32 v57,v57
v_add_f32 v8,v56,v8
v_cvt_pk_bf16_f32 v123,v70,v71
v_exp_f32_e64 v58,v58
v_mfma_f32_32x32x16_bf16 v[80:95],a[200:203],a[136:139],v[80:95]
ds_read_b128 a[248:251],v4 offset:14336
v_add_f32 v8,v57,v8
v_exp_f32 v59,v59
v_add_f32_e64 v8,v58,v8
v_cvt_pk_bf16_f32 v116,v56,v57
v_mfma_f32_32x32x16_bf16 v[96:111],a[200:203],a[168:171],v[96:111]
v_exp_f32 v60,v60
v_add_f32 v8,v59,v8
v_exp_f32 v61,v61
v_add_f32 v8,v60,v8
v_mfma_f32_32x32x16_bf16 v[80:95],a[204:207],a[140:143],v[80:95]
ds_read_b128 a[228:231],v4 offset:9216
v_cvt_pk_bf16_f32 v117,v58,v59
v_exp_f32 v62,v62
v_add_f32 v8,v61,v8
v_mfma_f32_32x32x16_bf16 v[96:111],a[204:207],a[172:175],v[96:111]
v_exp_f32 v63,v63
v_add_f32 v8,v62,v8
v_cvt_pk_bf16_f32 v118,v60,v61
v_exp_f32_e64 v72,v72
v_mfma_f32_32x32x16_bf16 v[80:95],a[208:211],a[144:147],v[80:95]
ds_read_b128 a[236:239],v4 offset:11264
v_add_f32 v8,v63,v8
v_exp_f32 v73,v73
v_add_f32_e64 v9,v72,v9
v_cvt_pk_bf16_f32 v119,v62,v63
v_mfma_f32_32x32x16_bf16 v[96:111],a[208:211],a[176:179],v[96:111]
v_exp_f32 v74,v74
v_add_f32 v9,v73,v9
v_exp_f32 v75,v75
v_add_f32 v9,v74,v9
v_mfma_f32_32x32x16_bf16 v[80:95],a[212:215],a[148:151],v[80:95]
ds_read_b128 a[244:247],v4 offset:13312
v_cvt_pk_bf16_f32 v124,v72,v73
v_exp_f32 v76,v76
v_add_f32 v9,v75,v9
v_mfma_f32_32x32x16_bf16 v[96:111],a[212:215],a[180:183],v[96:111]
ds_read_b128 a[252:255],v4 offset:15360
v_exp_f32 v77,v77
v_add_f32 v9,v76,v9
v_cvt_pk_bf16_f32 v125,v74,v75
v_mfma_f32_32x32x16_bf16 v[80:95],a[216:219],a[152:155],v[80:95]
v_exp_f32 v78,v78
v_add_f32 v9,v77,v9
v_exp_f32 v79,v79
v_add_f32 v9,v78,v9
v_mfma_f32_32x32x16_bf16 v[96:111],a[216:219],a[184:187],v[96:111]
v_cvt_pk_bf16_f32 v126,v76,v77
v_add_f32_e64 v9,v79,v9
v_cvt_pk_bf16_f32 v127,v78,v79
v_mfma_f32_32x32x16_bf16 v[80:95],a[220:223],a[156:159],v[80:95]
v_mfma_f32_32x32x16_bf16 v[96:111],a[220:223],a[188:191],v[96:111]
s_waitcnt lgkmcnt(0)
s_nop 0
v_mfma_f32_32x32x16_bf16 a[0:15],a[224:227],v[112:115],a[0:15]
s_waitcnt vmcnt(0)
s_barrier
ds_read_b128 a[192:195],v3 offset:0
v_mfma_f32_32x32x16_bf16 v[160:175],a[224:227],v[120:123],v[160:175]
ds_read_b128 a[196:199],v3 offset:1024
v_mfma_f32_32x32x16_bf16 a[16:31],a[232:235],v[112:115],a[16:31]
ds_read_b128 a[200:203],v3 offset:2048
v_mfma_f32_32x32x16_bf16 v[176:191],a[232:235],v[120:123],v[176:191]
s_nop 0
v_exp_f32 v80,v80
v_exp_f32 v81,v81
v_add_f32 v8,v80,v8
v_mfma_f32_32x32x16_bf16 a[32:47],a[240:243],v[112:115],a[32:47]
ds_read_b128 a[204:207],v3 offset:3072
v_exp_f32 v82,v82
v_add_f32 v8,v81,v8
v_exp_f32_e64 v83,v83
v_mfma_f32_32x32x16_bf16 v[192:207],a[240:243],v[120:123],v[192:207]
v_add_f32_e64 v8,v82,v8
v_cvt_pk_bf16_f32 v128,v80,v81
v_exp_f32 v84,v84
v_add_f32 v8,v83,v8
v_mfma_f32_32x32x16_bf16 a[48:63],a[248:251],v[112:115],a[48:63]
ds_read_b128 a[208:211],v3 offset:4096
v_exp_f32 v85,v85
v_add_f32 v8,v84,v8
v_cvt_pk_bf16_f32 v129,v82,v83
v_mfma_f32_32x32x16_bf16 v[208:223],a[248:251],v[120:123],v[208:223]
v_exp_f32 v86,v86
v_add_f32 v8,v85,v8
v_exp_f32 v87,v87
v_add_f32 v8,v86,v8
v_mfma_f32_32x32x16_bf16 a[0:15],a[228:231],v[116:119],a[0:15]
ds_read_b128 a[212:215],v3 offset:5120
v_cvt_pk_bf16_f32 v130,v84,v85
v_exp_f32 v96,v96
v_add_f32 v8,v87,v8
v_mfma_f32_32x32x16_bf16 v[160:175],a[228:231],v[124:127],v[160:175]
v_exp_f32 v97,v97
v_add_f32 v9,v96,v9
v_cvt_pk_bf16_f32 v131,v86,v87
v_exp_f32_e64 v98,v98
v_mfma_f32_32x32x16_bf16 a[16:31],a[236:239],v[116:119],a[16:31]
ds_read_b128 a[216:219],v3 offset:6144
v_add_f32 v9,v97,v9
v_exp_f32 v99,v99
v_add_f32_e64 v9,v98,v9
v_cvt_pk_bf16_f32 v136,v96,v97
v_mfma_f32_32x32x16_bf16 v[176:191],a[236:239],v[124:127],v[176:191]
ds_read_b128 a[220:223],v3 offset:7168
v_exp_f32 v100,v100
v_add_f32 v9,v99,v9
v_exp_f32_e64 v101,v101
v_mfma_f32_32x32x16_bf16 a[32:47],a[244:247],v[116:119],a[32:47]
v_add_f32_e64 v9,v100,v9
v_cvt_pk_bf16_f32 v137,v98,v99
v_exp_f32 v102,v102
v_add_f32 v9,v101,v9
v_mfma_f32_32x32x16_bf16 v[192:207],a[244:247],v[124:127],v[192:207]
v_exp_f32 v103,v103
v_add_f32 v9,v102,v9
v_cvt_pk_bf16_f32 v138,v100,v101
v_exp_f32_e64 v88,v88
v_mfma_f32_32x32x16_bf16 a[48:63],a[252:255],v[116:119],a[48:63]
v_add_f32 v9,v103,v9
v_exp_f32 v89,v89
v_add_f32_e64 v8,v88,v8
v_cvt_pk_bf16_f32 v139,v102,v103
v_mfma_f32_32x32x16_bf16 v[208:223],a[252:255],v[124:127],v[208:223]
v_exp_f32 v90,v90
v_add_f32 v8,v89,v8
v_exp_f32_e64 v91,v91
v_cndmask_b32 v16,v16,v6,s[64:65]
v_cndmask_b32 v17,v17,v6,s[66:67]
v_cndmask_b32 v18,v18,v6,s[68:69]
v_cndmask_b32 v19,v19,v6,s[70:71]
v_cndmask_b32 v20,v20,v6,s[72:73]
v_cndmask_b32 v21,v21,v6,s[74:75]
v_cndmask_b32 v22,v22,v6,s[76:77]
v_cndmask_b32 v23,v23,v6,s[78:79]
v_cndmask_b32 v24,v24,v6,s[80:81]
v_cndmask_b32 v25,v25,v6,s[82:83]
v_cndmask_b32 v26,v26,v6,s[84:85]
v_cndmask_b32 v27,v27,v6,s[86:87]
v_cndmask_b32 v28,v28,v6,s[88:89]
v_cndmask_b32 v29,v29,v6,s[90:91]
v_cndmask_b32 v30,v30,v6,s[92:93]
v_cndmask_b32 v31,v31,v6,s[94:95]
s_nop 0
s_waitcnt lgkmcnt(0)
v_mfma_f32_32x32x16_bf16 v[48:63],a[192:195],a[128:131],v[16:31]
ds_read_b128 a[224:227],v4 offset:24576
v_add_f32_e64 v8,v90,v8
v_cvt_pk_bf16_f32 v132,v88,v89
v_exp_f32 v92,v92
v_add_f32 v8,v91,v8
v_mfma_f32_32x32x16_bf16 v[64:79],a[192:195],a[160:163],v[32:47]
ds_read_b128 a[232:235],v4 offset:26624
v_exp_f32 v93,v93
v_add_f32 v8,v92,v8
v_cvt_pk_bf16_f32 v133,v90,v91
v_mfma_f32_32x32x16_bf16 v[48:63],a[196:199],a[132:135],v[48:63]
ds_read_b128 a[240:243],v4 offset:28672
v_exp_f32 v94,v94
v_add_f32 v8,v93,v8
v_exp_f32_e64 v95,v95
v_mfma_f32_32x32x16_bf16 v[64:79],a[196:199],a[164:167],v[64:79]
v_add_f32_e64 v8,v94,v8
v_cvt_pk_bf16_f32 v134,v92,v93
v_exp_f32 v104,v104
v_add_f32 v8,v95,v8
v_mfma_f32_32x32x16_bf16 v[48:63],a[200:203],a[136:139],v[48:63]
ds_read_b128 a[248:251],v4 offset:30720
v_exp_f32 v105,v105
v_add_f32 v9,v104,v9
v_cvt_pk_bf16_f32 v135,v94,v95
v_mfma_f32_32x32x16_bf16 v[64:79],a[200:203],a[168:171],v[64:79]
v_exp_f32 v106,v106
v_add_f32 v9,v105,v9
v_exp_f32 v107,v107
v_add_f32 v9,v106,v9
v_mfma_f32_32x32x16_bf16 v[48:63],a[204:207],a[140:143],v[48:63]
ds_read_b128 a[228:231],v4 offset:25600
v_cvt_pk_bf16_f32 v140,v104,v105
v_exp_f32 v108,v108
v_add_f32 v9,v107,v9
v_mfma_f32_32x32x16_bf16 v[64:79],a[204:207],a[172:175],v[64:79]
v_exp_f32 v109,v109
v_add_f32 v9,v108,v9
v_cvt_pk_bf16_f32 v141,v106,v107
v_exp_f32_e64 v110,v110
v_mfma_f32_32x32x16_bf16 v[48:63],a[208:211],a[144:147],v[48:63]
ds_read_b128 a[236:239],v4 offset:27648
v_add_f32 v9,v109,v9
v_exp_f32 v111,v111
v_add_f32_e64 v9,v110,v9
v_cvt_pk_bf16_f32 v142,v108,v109
v_mfma_f32_32x32x16_bf16 v[64:79],a[208:211],a[176:179],v[64:79]
v_add_f32_e64 v9,v111,v9
v_cvt_pk_bf16_f32 v143,v110,v111
v_mfma_f32_32x32x16_bf16 v[48:63],a[212:215],a[148:151],v[48:63]
ds_read_b128 a[244:247],v4 offset:29696
v_mfma_f32_32x32x16_bf16 v[64:79],a[212:215],a[180:183],v[64:79]
ds_read_b128 a[252:255],v4 offset:31744
v_mfma_f32_32x32x16_bf16 v[48:63],a[216:219],a[152:155],v[48:63]
v_mfma_f32_32x32x16_bf16 v[64:79],a[216:219],a[184:187],v[64:79]
v_mfma_f32_32x32x16_bf16 v[48:63],a[220:223],a[156:159],v[48:63]
v_mfma_f32_32x32x16_bf16 v[64:79],a[220:223],a[188:191],v[64:79]
s_waitcnt lgkmcnt(0)
s_nop 0
v_mfma_f32_32x32x16_bf16 a[0:15],a[224:227],v[128:131],a[0:15]
ds_read_b128 a[192:195],v3 offset:16384
v_mfma_f32_32x32x16_bf16 v[160:175],a[224:227],v[136:139],v[160:175]
ds_read_b128 a[196:199],v3 offset:17408
v_mfma_f32_32x32x16_bf16 a[16:31],a[232:235],v[128:131],a[16:31]
ds_read_b128 a[200:203],v3 offset:18432
v_mfma_f32_32x32x16_bf16 v[176:191],a[232:235],v[136:139],v[176:191]
s_nop 2
v_exp_f32 v48,v48
v_exp_f32 v49,v49
v_add_f32 v8,v48,v8
v_mfma_f32_32x32x16_bf16 a[32:47],a[240:243],v[128:131],a[32:47]
ds_read_b128 a[204:207],v3 offset:19456
v_exp_f32 v50,v50
v_add_f32 v8,v49,v8
v_exp_f32_e64 v51,v51
v_mfma_f32_32x32x16_bf16 v[192:207],a[240:243],v[136:139],v[192:207]
v_add_f32_e64 v8,v50,v8
v_cvt_pk_bf16_f32 v112,v48,v49
v_exp_f32 v52,v52
v_add_f32 v8,v51,v8
v_mfma_f32_32x32x16_bf16 a[48:63],a[248:251],v[128:131],a[48:63]
ds_read_b128 a[208:211],v3 offset:20480
v_exp_f32 v53,v53
v_add_f32 v8,v52,v8
v_cvt_pk_bf16_f32 v113,v50,v51
v_mfma_f32_32x32x16_bf16 v[208:223],a[248:251],v[136:139],v[208:223]
v_exp_f32 v54,v54
v_add_f32 v8,v53,v8
v_exp_f32 v55,v55
v_add_f32 v8,v54,v8
v_mfma_f32_32x32x16_bf16 a[0:15],a[228:231],v[132:135],a[0:15]
ds_read_b128 a[212:215],v3 offset:21504
v_cvt_pk_bf16_f32 v114,v52,v53
v_exp_f32 v64,v64
v_add_f32 v8,v55,v8
v_mfma_f32_32x32x16_bf16 v[160:175],a[228:231],v[140:143],v[160:175]
v_exp_f32 v65,v65
v_add_f32 v9,v64,v9
v_cvt_pk_bf16_f32 v115,v54,v55
v_exp_f32_e64 v66,v66
v_mfma_f32_32x32x16_bf16 a[16:31],a[236:239],v[132:135],a[16:31]
ds_read_b128 a[216:219],v3 offset:22528
v_add_f32 v9,v65,v9
v_exp_f32 v67,v67
v_add_f32_e64 v9,v66,v9
v_cvt_pk_bf16_f32 v120,v64,v65
v_mfma_f32_32x32x16_bf16 v[176:191],a[236:239],v[140:143],v[176:191]
ds_read_b128 a[220:223],v3 offset:23552
v_exp_f32 v68,v68
v_add_f32 v9,v67,v9
v_exp_f32_e64 v69,v69
v_mfma_f32_32x32x16_bf16 a[32:47],a[244:247],v[132:135],a[32:47]
v_add_f32_e64 v9,v68,v9
v_cvt_pk_bf16_f32 v121,v66,v67
v_exp_f32 v70,v70
v_add_f32 v9,v69,v9
v_mfma_f32_32x32x16_bf16 v[192:207],a[244:247],v[140:143],v[192:207]
v_exp_f32 v71,v71
v_add_f32 v9,v70,v9
v_cvt_pk_bf16_f32 v122,v68,v69
v_exp_f32_e64 v56,v56
v_mfma_f32_32x32x16_bf16 a[48:63],a[252:255],v[132:135],a[48:63]
v_add_f32 v9,v71,v9
v_exp_f32 v57,v57
v_add_f32_e64 v8,v56,v8
v_cvt_pk_bf16_f32 v123,v70,v71
v_mfma_f32_32x32x16_bf16 v[208:223],a[252:255],v[140:143],v[208:223]
v_exp_f32 v58,v58
v_add_f32 v8,v57,v8
v_exp_f32 v59,v59
v_mov_b32 v4,v3
s_nop 0
s_waitcnt lgkmcnt(0)
v_mfma_f32_32x32x16_bf16 v[96:111],a[192:195],a[160:163],v[32:47]
ds_read_b128 a[224:227],v4 offset:8192
ds_read_b128 a[232:235],v4 offset:10240
v_add_f32_e64 v8,v58,v8
v_cvt_pk_bf16_f32 v116,v56,v57
v_mfma_f32_32x32x16_bf16 v[96:111],a[196:199],a[164:167],v[96:111]
ds_read_b128 a[240:243],v4 offset:12288
ds_read_b128 a[248:251],v4 offset:14336
v_exp_f32 v60,v60
v_add_f32 v8,v59,v8
v_mfma_f32_32x32x16_bf16 v[96:111],a[200:203],a[168:171],v[96:111]
ds_read_b128 a[228:231],v4 offset:9216
ds_read_b128 a[236:239],v4 offset:11264
v_exp_f32 v61,v61
v_add_f32 v8,v60,v8
v_mfma_f32_32x32x16_bf16 v[96:111],a[204:207],a[172:175],v[96:111]
ds_read_b128 a[244:247],v4 offset:13312
ds_read_b128 a[252:255],v4 offset:15360
v_cvt_pk_bf16_f32 v117,v58,v59
v_exp_f32_e64 v62,v62
v_mfma_f32_32x32x16_bf16 v[96:111],a[208:211],a[176:179],v[96:111]
v_add_f32 v8,v61,v8
v_exp_f32 v63,v63
v_add_f32_e64 v8,v62,v8
v_cvt_pk_bf16_f32 v118,v60,v61
v_mfma_f32_32x32x16_bf16 v[96:111],a[212:215],a[180:183],v[96:111]
v_exp_f32 v72,v72
v_add_f32 v8,v63,v8
v_exp_f32 v73,v73
v_add_f32 v9,v72,v9
v_mfma_f32_32x32x16_bf16 v[96:111],a[216:219],a[184:187],v[96:111]
v_cvt_pk_bf16_f32 v119,v62,v63
v_exp_f32 v74,v74
v_add_f32 v9,v73,v9
v_exp_f32_e64 v75,v75
v_mfma_f32_32x32x16_bf16 v[96:111],a[220:223],a[188:191],v[96:111]
v_add_f32_e64 v9,v74,v9
v_cvt_pk_bf16_f32 v124,v72,v73
v_exp_f32 v76,v76
v_add_f32 v9,v75,v9
v_add_u32_e64 v3,s50,v2
s_nop 0
s_waitcnt lgkmcnt(0)
v_mfma_f32_32x32x16_bf16 a[0:15],a[224:227],v[112:115],a[0:15]
ds_read_b128 a[192:195],v3 offset:0
v_exp_f32 v77,v77
v_add_f32 v9,v76,v9
v_cvt_pk_bf16_f32 v125,v74,v75
v_mfma_f32_32x32x16_bf16 v[160:175],a[224:227],v[120:123],v[160:175]
ds_read_b128 a[196:199],v3 offset:1024
v_exp_f32 v78,v78
v_add_f32 v9,v77,v9
v_exp_f32_e64 v79,v79
v_mfma_f32_32x32x16_bf16 a[16:31],a[232:235],v[112:115],a[16:31]
ds_read_b128 a[200:203],v3 offset:2048
v_add_f32_e64 v9,v78,v9
v_cvt_pk_bf16_f32 v126,v76,v77
v_add_f32_e64 v9,v79,v9
v_cvt_pk_bf16_f32 v127,v78,v79
v_mfma_f32_32x32x16_bf16 v[176:191],a[232:235],v[120:123],v[176:191]
v_exp_f32 v96,v96
v_exp_f32 v97,v97
v_add_f32_e64 v9,v96,v9
v_mfma_f32_32x32x16_bf16 a[32:47],a[240:243],v[112:115],a[32:47]
ds_read_b128 a[204:207],v3 offset:3072
v_exp_f32 v98,v98
v_add_f32 v9,v97,v9
v_exp_f32_e64 v99,v99
v_mfma_f32_32x32x16_bf16 v[192:207],a[240:243],v[120:123],v[192:207]
v_add_f32_e64 v9,v98,v9
v_cvt_pk_bf16_f32 v136,v96,v97
v_exp_f32 v100,v100
v_add_f32 v9,v99,v9
v_mfma_f32_32x32x16_bf16 a[48:63],a[248:251],v[112:115],a[48:63]
ds_read_b128 a[208:211],v3 offset:4096
v_exp_f32 v101,v101
v_add_f32 v9,v100,v9
v_cvt_pk_bf16_f32 v137,v98,v99
v_mfma_f32_32x32x16_bf16 v[208:223],a[248:251],v[120:123],v[208:223]
v_exp_f32 v102,v102
v_add_f32 v9,v101,v9
v_exp_f32 v103,v103
v_add_f32 v9,v102,v9
v_mfma_f32_32x32x16_bf16 a[0:15],a[228:231],v[116:119],a[0:15]
ds_read_b128 a[212:215],v3 offset:5120
v_cvt_pk_bf16_f32 v138,v100,v101
v_exp_f32 v104,v104
v_add_f32 v9,v103,v9
v_mfma_f32_32x32x16_bf16 v[160:175],a[228:231],v[124:127],v[160:175]
v_exp_f32 v105,v105
v_add_f32 v9,v104,v9
v_cvt_pk_bf16_f32 v139,v102,v103
v_exp_f32_e64 v106,v106
v_mfma_f32_32x32x16_bf16 a[16:31],a[236:239],v[116:119],a[16:31]
ds_read_b128 a[216:219],v3 offset:6144
v_add_f32 v9,v105,v9
v_exp_f32 v107,v107
v_add_f32_e64 v9,v106,v9
v_cvt_pk_bf16_f32 v140,v104,v105
v_mfma_f32_32x32x16_bf16 v[176:191],a[236:239],v[124:127],v[176:191]
ds_read_b128 a[220:223],v3 offset:7168
v_exp_f32 v108,v108
v_add_f32 v9,v107,v9
v_exp_f32_e64 v109,v109
v_mfma_f32_32x32x16_bf16 a[32:47],a[244:247],v[116:119],a[32:47]
v_add_f32_e64 v9,v108,v9
v_cvt_pk_bf16_f32 v141,v106,v107
v_exp_f32 v110,v110
v_add_f32 v9,v109,v9
v_mfma_f32_32x32x16_bf16 v[192:207],a[244:247],v[124:127],v[192:207]
v_exp_f32 v111,v111
v_add_f32 v9,v110,v9
v_cvt_pk_bf16_f32 v142,v108,v109
v_add_f32_e64 v9,v111,v9
v_cvt_pk_bf16_f32 v143,v110,v111
v_mfma_f32_32x32x16_bf16 a[48:63],a[252:255],v[116:119],a[48:63]
v_mfma_f32_32x32x16_bf16 v[208:223],a[252:255],v[124:127],v[208:223]
s_waitcnt lgkmcnt(0)
s_nop 0
v_mfma_f32_32x32x16_bf16 v[64:79],a[192:195],a[160:163],v[32:47]
ds_read_b128 a[224:227],v4 offset:24576
ds_read_b128 a[232:235],v4 offset:26624
v_mfma_f32_32x32x16_bf16 v[64:79],a[196:199],a[164:167],v[64:79]
ds_read_b128 a[240:243],v4 offset:28672
ds_read_b128 a[248:251],v4 offset:30720
v_mfma_f32_32x32x16_bf16 v[64:79],a[200:203],a[168:171],v[64:79]
ds_read_b128 a[228:231],v4 offset:25600
ds_read_b128 a[236:239],v4 offset:27648
v_mfma_f32_32x32x16_bf16 v[64:79],a[204:207],a[172:175],v[64:79]
ds_read_b128 a[244:247],v4 offset:29696
ds_read_b128 a[252:255],v4 offset:31744
v_mfma_f32_32x32x16_bf16 v[64:79],a[208:211],a[176:179],v[64:79]
v_mfma_f32_32x32x16_bf16 v[64:79],a[212:215],a[180:183],v[64:79]
v_mfma_f32_32x32x16_bf16 v[64:79],a[216:219],a[184:187],v[64:79]
v_mfma_f32_32x32x16_bf16 v[64:79],a[220:223],a[188:191],v[64:79]
s_waitcnt lgkmcnt(0)
s_nop 0
v_mfma_f32_32x32x16_bf16 v[160:175],a[224:227],v[136:139],v[160:175]
ds_read_b128 a[192:195],v3 offset:16384
ds_read_b128 a[196:199],v3 offset:17408
v_mfma_f32_32x32x16_bf16 v[176:191],a[232:235],v[136:139],v[176:191]
ds_read_b128 a[200:203],v3 offset:18432
ds_read_b128 a[204:207],v3 offset:19456
v_mfma_f32_32x32x16_bf16 v[192:207],a[240:243],v[136:139],v[192:207]
ds_read_b128 a[208:211],v3 offset:20480
ds_read_b128 a[212:215],v3 offset:21504
v_mfma_f32_32x32x16_bf16 v[208:223],a[248:251],v[136:139],v[208:223]
ds_read_b128 a[216:219],v3 offset:22528
ds_read_b128 a[220:223],v3 offset:23552
v_exp_f32_e64 v64,v64
v_mfma_f32_32x32x16_bf16 v[160:175],a[228:231],v[140:143],v[160:175]
v_exp_f32 v65,v65
v_add_f32 v9,v64,v9
v_exp_f32 v66,v66
v_add_f32 v9,v65,v9
v_mfma_f32_32x32x16_bf16 v[176:191],a[236:239],v[140:143],v[176:191]
v_exp_f32 v67,v67
v_add_f32 v9,v66,v9
v_cvt_pk_bf16_f32 v120,v64,v65
v_exp_f32_e64 v68,v68
v_mfma_f32_32x32x16_bf16 v[192:207],a[244:247],v[140:143],v[192:207]
v_add_f32 v9,v67,v9
v_exp_f32 v69,v69
v_add_f32_e64 v9,v68,v9
v_cvt_pk_bf16_f32 v121,v66,v67
v_mfma_f32_32x32x16_bf16 v[208:223],a[252:255],v[140:143],v[208:223]
v_exp_f32 v70,v70
v_add_f32 v9,v69,v9
v_exp_f32_e64 v71,v71
v_cndmask_b32 v32,v32,v6,s[64:65]
v_cndmask_b32 v33,v33,v6,s[66:67]
v_cndmask_b32 v34,v34,v6,s[68:69]
v_cndmask_b32 v35,v35,v6,s[70:71]
v_cndmask_b32 v36,v36,v6,s[72:73]
v_cndmask_b32 v37,v37,v6,s[74:75]
v_cndmask_b32 v38,v38,v6,s[76:77]
v_cndmask_b32 v39,v39,v6,s[78:79]
v_cndmask_b32 v40,v40,v6,s[80:81]
v_cndmask_b32 v41,v41,v6,s[82:83]
v_cndmask_b32 v42,v42,v6,s[84:85]
v_cndmask_b32 v43,v43,v6,s[86:87]
v_cndmask_b32 v44,v44,v6,s[88:89]
v_cndmask_b32 v45,v45,v6,s[90:91]
v_cndmask_b32 v46,v46,v6,s[92:93]
v_cndmask_b32 v47,v47,v6,s[94:95]
v_mov_b32_e64 v4,v3
s_nop 0
s_waitcnt lgkmcnt(0)
v_mfma_f32_32x32x16_bf16 v[96:111],a[192:195],a[160:163],v[32:47]
ds_read_b128 a[224:227],v4 offset:8192
ds_read_b128 a[232:235],v4 offset:10240
v_add_f32_e64 v9,v70,v9
v_cvt_pk_bf16_f32 v122,v68,v69
v_mfma_f32_32x32x16_bf16 v[96:111],a[196:199],a[164:167],v[96:111]
ds_read_b128 a[240:243],v4 offset:12288
ds_read_b128 a[248:251],v4 offset:14336
v_exp_f32 v72,v72
v_add_f32 v9,v71,v9
v_mfma_f32_32x32x16_bf16 v[96:111],a[200:203],a[168:171],v[96:111]
ds_read_b128 a[228:231],v4 offset:9216
ds_read_b128 a[236:239],v4 offset:11264
v_exp_f32 v73,v73
v_add_f32 v9,v72,v9
v_mfma_f32_32x32x16_bf16 v[96:111],a[204:207],a[172:175],v[96:111]
ds_read_b128 a[244:247],v4 offset:13312
ds_read_b128 a[252:255],v4 offset:15360
v_cvt_pk_bf16_f32 v123,v70,v71
v_exp_f32_e64 v74,v74
v_mfma_f32_32x32x16_bf16 v[96:111],a[208:211],a[176:179],v[96:111]
v_add_f32 v9,v73,v9
v_exp_f32 v75,v75
v_add_f32_e64 v9,v74,v9
v_cvt_pk_bf16_f32 v124,v72,v73
v_mfma_f32_32x32x16_bf16 v[96:111],a[212:215],a[180:183],v[96:111]
v_exp_f32 v76,v76
v_add_f32 v9,v75,v9
v_exp_f32 v77,v77
v_add_f32 v9,v76,v9
v_mfma_f32_32x32x16_bf16 v[96:111],a[216:219],a[184:187],v[96:111]
v_cvt_pk_bf16_f32 v125,v74,v75
v_exp_f32 v78,v78
v_add_f32 v9,v77,v9
v_exp_f32_e64 v79,v79
v_mfma_f32_32x32x16_bf16 v[96:111],a[220:223],a[188:191],v[96:111]
v_add_f32_e64 v9,v78,v9
v_cvt_pk_bf16_f32 v126,v76,v77
v_add_f32_e64 v9,v79,v9
v_cvt_pk_bf16_f32 v127,v78,v79
s_waitcnt lgkmcnt(0)
s_nop 0
v_mfma_f32_32x32x16_bf16 v[160:175],a[224:227],v[120:123],v[160:175]
ds_read_b128 a[192:195],v4 offset:24576
ds_read_b128 a[200:203],v4 offset:26624
v_mfma_f32_32x32x16_bf16 v[176:191],a[232:235],v[120:123],v[176:191]
ds_read_b128 a[208:211],v4 offset:28672
ds_read_b128 a[216:219],v4 offset:30720
v_mfma_f32_32x32x16_bf16 v[192:207],a[240:243],v[120:123],v[192:207]
ds_read_b128 a[196:199],v4 offset:25600
ds_read_b128 a[204:207],v4 offset:27648
v_mfma_f32_32x32x16_bf16 v[208:223],a[248:251],v[120:123],v[208:223]
ds_read_b128 a[212:215],v4 offset:29696
ds_read_b128 a[220:223],v4 offset:31744
v_exp_f32_e64 v96,v96
v_mfma_f32_32x32x16_bf16 v[160:175],a[228:231],v[124:127],v[160:175]
v_exp_f32 v97,v97
v_add_f32 v9,v96,v9
v_exp_f32 v98,v98
v_add_f32 v9,v97,v9
v_mfma_f32_32x32x16_bf16 v[176:191],a[236:239],v[124:127],v[176:191]
v_exp_f32 v99,v99
v_add_f32 v9,v98,v9
v_cvt_pk_bf16_f32 v136,v96,v97
v_exp_f32_e64 v100,v100
v_mfma_f32_32x32x16_bf16 v[192:207],a[244:247],v[124:127],v[192:207]
v_add_f32 v9,v99,v9
v_exp_f32 v101,v101
v_add_f32_e64 v9,v100,v9
v_cvt_pk_bf16_f32 v137,v98,v99
v_mfma_f32_32x32x16_bf16 v[208:223],a[252:255],v[124:127],v[208:223]
v_exp_f32 v102,v102
v_add_f32 v9,v101,v9
v_exp_f32 v103,v103
s_waitcnt lgkmcnt(0)
v_add_f32_e64 v9,v102,v9
v_cvt_pk_bf16_f32 v138,v100,v101
v_exp_f32 v104,v104
v_add_f32 v9,v103,v9
v_exp_f32 v105,v105
v_add_f32 v9,v104,v9
v_cvt_pk_bf16_f32 v139,v102,v103
s_nop 1
v_mfma_f32_32x32x16_bf16 v[160:175],a[192:195],v[136:139],v[160:175]
v_exp_f32 v106,v106
v_add_f32 v9,v105,v9
v_exp_f32 v107,v107
v_add_f32_e64 v9,v106,v9
v_mfma_f32_32x32x16_bf16 v[176:191],a[200:203],v[136:139],v[176:191]
v_cvt_pk_bf16_f32 v140,v104,v105
v_exp_f32 v108,v108
v_add_f32 v9,v107,v9
v_exp_f32_e64 v109,v109
v_mfma_f32_32x32x16_bf16 v[192:207],a[208:211],v[136:139],v[192:207]
v_add_f32_e64 v9,v108,v9
v_cvt_pk_bf16_f32 v141,v106,v107
v_exp_f32 v110,v110
v_add_f32 v9,v109,v9
v_mfma_f32_32x32x16_bf16 v[208:223],a[216:219],v[136:139],v[208:223]
v_exp_f32 v111,v111
v_add_f32 v9,v110,v9
v_cvt_pk_bf16_f32 v142,v108,v109
v_add_f32_e64 v9,v111,v9
v_cvt_pk_bf16_f32 v143,v110,v111
s_nop 1
v_mfma_f32_32x32x16_bf16 v[160:175],a[196:199],v[140:143],v[160:175]
s_nop 0
v_mfma_f32_32x32x16_bf16 v[176:191],a[204:207],v[140:143],v[176:191]
v_mfma_f32_32x32x16_bf16 v[192:207],a[212:215],v[140:143],v[192:207]
v_mfma_f32_32x32x16_bf16 v[208:223],a[220:223],v[140:143],v[208:223]
s_branch b_done
s_nop 0
b_tail3:
s_add_u32 s50,s47,32768
s_cmp_ge_u32 s50,163840
s_cselect_b32 s50,0,s50
s_add_u32 s51,s50,32768
s_cmp_ge_u32 s51,163840
s_cselect_b32 s51,0,s51
s_waitcnt lgkmcnt(0)
v_mfma_f32_32x32x16_bf16 v[80:95],a[192:195],a[128:131],v[16:31]
ds_read_b128 a[224:227],v4 offset:8192
v_add_f32 v9,v67,v9
v_exp_f32 v69,v69
v_add_f32 v9,v68,v9
v_cvt_pk_bf16_f32 v121,v66,v67
v_mfma_f32_32x32x16_bf16 v[96:111],a[192:195],a[160:163],v[32:47]
ds_read_b128 a[232:235],v4 offset:10240
v_exp_f32 v70,v70
v_add_f32 v9,v69,v9
v_exp_f32_e64 v71,v71
v_mfma_f32_32x32x16_bf16 v[80:95],a[196:199],a[132:135],v[80:95]
ds_read_b128 a[240:243],v4 offset:12288
v_add_f32_e64 v9,v70,v9
v_cvt_pk_bf16_f32 v122,v68,v69
v_exp_f32 v56,v56
v_add_f32 v9,v71,v9
v_mfma_f32_32x32x16_bf16 v[96:111],a[196:199],a[164:167],v[96:111]
v_exp_f32 v57,v57
v_add_f32 v8,v56,v8
v_cvt_pk_bf16_f32 v123,v70,v71
v_exp_f32_e64 v58,v58
v_mfma_f32_32x32x16_bf16 v[80:95],a[200:203],a[136:139],v[80:95]
ds_read_b128 a[248:251],v4 offset:14336
v_add_f32 v8,v57,v8
v_exp_f32 v59,v59
v_add_f32_e64 v8,v58,v8
v_cvt_pk_bf16_f32 v116,v56,v57
v_mfma_f32_32x32x16_bf16 v[96:111],a[200:203],a[168:171],v[96:111]
v_exp_f32 v60,v60
v_add_f32 v8,v59,v8
v_exp_f32 v61,v61
v_add_f32 v8,v60,v8
v_mfma_f32_32x32x16_bf16 v[80:95],a[204:207],a[140:143],v[80:95]
ds_read_b128 a[228:231],v4 offset:9216
v_cvt_pk_bf16_f32 v117,v58,v59
v_exp_f32 v62,v62
v_add_f32 v8,v61,v8
v_mfma_f32_32x32x16_bf16 v[96:111],a[204:207],a[172:175],v[96:111]
v_exp_f32 v63,v63
v_add_f32 v8,v62,v8
v_cvt_pk_bf16_f32 v118,v60,v61
v_exp_f32_e64 v72,v72
v_mfma_f32_32x32x16_bf16 v[80:95],a[208:211],a[144:147],v[80:95]
ds_read_b128 a[236:239],v4 offset:11264
v_add_f32 v8,v63,v8
v_exp_f32 v73,v73
v_add_f32_e64 v9,v72,v9
v_cvt_pk_bf16_f32 v119,v62,v63
v_mfma_f32_32x32x16_bf16 v[96:111],a[208:211],a[176:179],v[96:111]
v_exp_f32 v74,v74
v_add_f32 v9,v73,v9
v_exp_f32 v75,v75
v_add_f32 v9,v74,v9
v_mfma_f32_32x32x16_bf16 v[80:95],a[212:215],a[148:151],v[80:95]
ds_read_b128 a[244:247],v4 offset:13312
v_cvt_pk_bf16_f32 v124,v72,v73
v_exp_f32 v76,v76
v_add_f32 v9,v75,v9
v_mfma_f32_32x32x16_bf16 v[96:111],a[212:215],a[180:183],v[96:111]
ds_read_b128 a[252:255],v4 offset:15360
v_exp_f32 v77,v77
v_add_f32 v9,v76,v9
v_cvt_pk_bf16_f32 v125,v74,v75
v_mfma_f32_32x32x16_bf16 v[80:95],a[216:219],a[152:155],v[80:95]
v_exp_f32 v78,v78
v_add_f32 v9,v77,v9
v_exp_f32 v79,v79
v_add_f32 v9,v78,v9
v_mfma_f32_32x32x16_bf16 v[96:111],a[216:219],a[184:187],v[96:111]
v_cvt_pk_bf16_f32 v126,v76,v77
v_add_f32_e64 v9,v79,v9
v_cvt_pk_bf16_f32 v127,v78,v79
v_mfma_f32_32x32x16_bf16 v[80:95],a[220:223],a[156:159],v[80:95]
v_mfma_f32_32x32x16_bf16 v[96:111],a[220:223],a[188:191],v[96:111]
s_waitcnt lgkmcnt(0)
s_nop 0
v_mfma_f32_32x32x16_bf16 a[0:15],a[224:227],v[112:115],a[0:15]
s_waitcnt vmcnt(0)
s_barrier
ds_read_b128 a[192:195],v3 offset:0
v_mfma_f32_32x32x16_bf16 v[160:175],a[224:227],v[120:123],v[160:175]
ds_read_b128 a[196:199],v3 offset:1024
v_mfma_f32_32x32x16_bf16 a[16:31],a[232:235],v[112:115],a[16:31]
ds_read_b128 a[200:203],v3 offset:2048
v_mfma_f32_32x32x16_bf16 v[176:191],a[232:235],v[120:123],v[176:191]
s_nop 0
v_exp_f32 v80,v80
v_exp_f32 v81,v81
v_add_f32 v8,v80,v8
v_mfma_f32_32x32x16_bf16 a[32:47],a[240:243],v[112:115],a[32:47]
ds_read_b128 a[204:207],v3 offset:3072
v_exp_f32 v82,v82
v_add_f32 v8,v81,v8
v_exp_f32_e64 v83,v83
v_mfma_f32_32x32x16_bf16 v[192:207],a[240:243],v[120:123],v[192:207]
v_add_f32_e64 v8,v82,v8
v_cvt_pk_bf16_f32 v128,v80,v81
v_exp_f32 v84,v84
v_add_f32 v8,v83,v8
v_mfma_f32_32x32x16_bf16 a[48:63],a[248:251],v[112:115],a[48:63]
ds_read_b128 a[208:211],v3 offset:4096
v_exp_f32 v85,v85
v_add_f32 v8,v84,v8
v_cvt_pk_bf16_f32 v129,v82,v83
v_mfma_f32_32x32x16_bf16 v[208:223],a[248:251],v[120:123],v[208:223]
v_exp_f32 v86,v86
v_add_f32 v8,v85,v8
v_exp_f32 v87,v87
v_add_f32 v8,v86,v8
v_mfma_f32_32x32x16_bf16 a[0:15],a[228:231],v[116:119],a[0:15]
ds_read_b128 a[212:215],v3 offset:5120
v_cvt_pk_bf16_f32 v130,v84,v85
v_exp_f32 v96,v96
v_add_f32 v8,v87,v8
v_mfma_f32_32x32x16_bf16 v[160:175],a[228:231],v[124:127],v[160:175]
v_exp_f32 v97,v97
v_add_f32 v9,v96,v9
v_cvt_pk_bf16_f32 v131,v86,v87
v_exp_f32_e64 v98,v98
v_mfma_f32_32x32x16_bf16 a[16:31],a[236:239],v[116:119],a[16:31]
ds_read_b128 a[216:219],v3 offset:6144
v_add_f32 v9,v97,v9
v_exp_f32 v99,v99
v_add_f32_e64 v9,v98,v9
v_cvt_pk_bf16_f32 v136,v96,v97
v_mfma_f32_32x32x16_bf16 v[176:191],a[236:239],v[124:127],v[176:191]
ds_read_b128 a[220:223],v3 offset:7168
v_exp_f32 v100,v100
v_add_f32 v9,v99,v9
v_exp_f32_e64 v101,v101
v_mfma_f32_32x32x16_bf16 a[32:47],a[244:247],v[116:119],a[32:47]
v_add_f32_e64 v9,v100,v9
v_cvt_pk_bf16_f32 v137,v98,v99
v_exp_f32 v102,v102
v_add_f32 v9,v101,v9
v_mfma_f32_32x32x16_bf16 v[192:207],a[244:247],v[124:127],v[192:207]
v_exp_f32 v103,v103
v_add_f32 v9,v102,v9
v_cvt_pk_bf16_f32 v138,v100,v101
v_exp_f32_e64 v88,v88
v_mfma_f32_32x32x16_bf16 a[48:63],a[252:255],v[116:119],a[48:63]
v_add_f32 v9,v103,v9
v_exp_f32 v89,v89
v_add_f32_e64 v8,v88,v8
v_cvt_pk_bf16_f32 v139,v102,v103
v_mfma_f32_32x32x16_bf16 v[208:223],a[252:255],v[124:127],v[208:223]
v_exp_f32 v90,v90
v_add_f32 v8,v89,v8
v_exp_f32 v91,v91
s_waitcnt lgkmcnt(0)
v_mfma_f32_32x32x16_bf16 v[48:63],a[192:195],a[128:131],v[16:31]
ds_read_b128 a[224:227],v4 offset:24576
v_add_f32_e64 v8,v90,v8
v_cvt_pk_bf16_f32 v132,v88,v89
v_exp_f32 v92,v92
v_add_f32 v8,v91,v8
v_mfma_f32_32x32x16_bf16 v[64:79],a[192:195],a[160:163],v[32:47]
ds_read_b128 a[232:235],v4 offset:26624
v_exp_f32 v93,v93
v_add_f32 v8,v92,v8
v_cvt_pk_bf16_f32 v133,v90,v91
v_mfma_f32_32x32x16_bf16 v[48:63],a[196:199],a[132:135],v[48:63]
ds_read_b128 a[240:243],v4 offset:28672
v_exp_f32 v94,v94
v_add_f32 v8,v93,v8
v_exp_f32_e64 v95,v95
v_mfma_f32_32x32x16_bf16 v[64:79],a[196:199],a[164:167],v[64:79]
v_add_f32_e64 v8,v94,v8
v_cvt_pk_bf16_f32 v134,v92,v93
v_exp_f32 v104,v104
v_add_f32 v8,v95,v8
v_mfma_f32_32x32x16_bf16 v[48:63],a[200:203],a[136:139],v[48:63]
ds_read_b128 a[248:251],v4 offset:30720
v_exp_f32 v105,v105
v_add_f32 v9,v104,v9
v_cvt_pk_bf16_f32 v135,v94,v95
v_mfma_f32_32x32x16_bf16 v[64:79],a[200:203],a[168:171],v[64:79]
v_exp_f32 v106,v106
v_add_f32 v9,v105,v9
v_exp_f32 v107,v107
v_add_f32 v9,v106,v9
v_mfma_f32_32x32x16_bf16 v[48:63],a[204:207],a[140:143],v[48:63]
ds_read_b128 a[228:231],v4 offset:25600
v_cvt_pk_bf16_f32 v140,v104,v105
v_exp_f32 v108,v108
v_add_f32 v9,v107,v9
v_mfma_f32_32x32x16_bf16 v[64:79],a[204:207],a[172:175],v[64:79]
v_exp_f32 v109,v109
v_add_f32 v9,v108,v9
v_cvt_pk_bf16_f32 v141,v106,v107
v_exp_f32_e64 v110,v110
v_mfma_f32_32x32x16_bf16 v[48:63],a[208:211],a[144:147],v[48:63]
ds_read_b128 a[236:239],v4 offset:27648
v_add_f32 v9,v109,v9
v_exp_f32 v111,v111
v_add_f32_e64 v9,v110,v9
v_cvt_pk_bf16_f32 v142,v108,v109
v_mfma_f32_32x32x16_bf16 v[64:79],a[208:211],a[176:179],v[64:79]
v_add_f32_e64 v9,v111,v9
v_cvt_pk_bf16_f32 v143,v110,v111
v_mfma_f32_32x32x16_bf16 v[48:63],a[212:215],a[148:151],v[48:63]
ds_read_b128 a[244:247],v4 offset:29696
v_mfma_f32_32x32x16_bf16 v[64:79],a[212:215],a[180:183],v[64:79]
ds_read_b128 a[252:255],v4 offset:31744
v_mfma_f32_32x32x16_bf16 v[48:63],a[216:219],a[152:155],v[48:63]
v_mfma_f32_32x32x16_bf16 v[64:79],a[216:219],a[184:187],v[64:79]
v_mfma_f32_32x32x16_bf16 v[48:63],a[220:223],a[156:159],v[48:63]
v_mfma_f32_32x32x16_bf16 v[64:79],a[220:223],a[188:191],v[64:79]
s_waitcnt lgkmcnt(0)
s_nop 0
v_mfma_f32_32x32x16_bf16 a[0:15],a[224:227],v[128:131],a[0:15]
ds_read_b128 a[192:195],v3 offset:16384
v_mfma_f32_32x32x16_bf16 v[160:175],a[224:227],v[136:139],v[160:175]
ds_read_b128 a[196:199],v3 offset:17408
v_mfma_f32_32x32x16_bf16 a[16:31],a[232:235],v[128:131],a[16:31]
ds_read_b128 a[200:203],v3 offset:18432
v_mfma_f32_32x32x16_bf16 v[176:191],a[232:235],v[136:139],v[176:191]
s_nop 2
v_exp_f32 v48,v48
v_exp_f32 v49,v49
v_add_f32 v8,v48,v8
v_mfma_f32_32x32x16_bf16 a[32:47],a[240:243],v[128:131],a[32:47]
ds_read_b128 a[204:207],v3 offset:19456
v_exp_f32 v50,v50
v_add_f32 v8,v49,v8
v_exp_f32_e64 v51,v51
v_mfma_f32_32x32x16_bf16 v[192:207],a[240:243],v[136:139],v[192:207]
v_add_f32_e64 v8,v50,v8
v_cvt_pk_bf16_f32 v112,v48,v49
v_exp_f32 v52,v52
v_add_f32 v8,v51,v8
v_mfma_f32_32x32x16_bf16 a[48:63],a[248:251],v[128:131],a[48:63]
ds_read_b128 a[208:211],v3 offset:20480
v_exp_f32 v53,v53
v_add_f32 v8,v52,v8
v_cvt_pk_bf16_f32 v113,v50,v51
v_mfma_f32_32x32x16_bf16 v[208:223],a[248:251],v[136:139],v[208:223]
v_exp_f32 v54,v54
v_add_f32 v8,v53,v8
v_exp_f32 v55,v55
v_add_f32 v8,v54,v8
v_mfma_f32_32x32x16_bf16 a[0:15],a[228:231],v[132:135],a[0:15]
ds_read_b128 a[212:215],v3 offset:21504
v_cvt_pk_bf16_f32 v114,v52,v53
v_exp_f32 v64,v64
v_add_f32 v8,v55,v8
v_mfma_f32_32x32x16_bf16 v[160:175],a[228:231],v[140:143],v[160:175]
v_exp_f32 v65,v65
v_add_f32 v9,v64,v9
v_cvt_pk_bf16_f32 v115,v54,v55
v_exp_f32_e64 v66,v66
v_mfma_f32_32x32x16_bf16 a[16:31],a[236:239],v[132:135],a[16:31]
ds_read_b128 a[216:219],v3 offset:22528
v_add_f32 v9,v65,v9
v_exp_f32 v67,v67
v_add_f32_e64 v9,v66,v9
v_cvt_pk_bf16_f32 v120,v64,v65
v_mfma_f32_32x32x16_bf16 v[176:191],a[236:239],v[140:143],v[176:191]
ds_read_b128 a[220:223],v3 offset:23552
v_exp_f32 v68,v68
v_add_f32 v9,v67,v9
v_exp_f32_e64 v69,v69
v_mfma_f32_32x32x16_bf16 a[32:47],a[244:247],v[132:135],a[32:47]
v_add_f32_e64 v9,v68,v9
v_cvt_pk_bf16_f32 v121,v66,v67
v_exp_f32 v70,v70
v_add_f32 v9,v69,v9
v_mfma_f32_32x32x16_bf16 v[192:207],a[244:247],v[140:143],v[192:207]
v_exp_f32 v71,v71
v_add_f32 v9,v70,v9
v_cvt_pk_bf16_f32 v122,v68,v69
v_exp_f32_e64 v56,v56
v_mfma_f32_32x32x16_bf16 a[48:63],a[252:255],v[132:135],a[48:63]
v_add_f32 v9,v71,v9
v_exp_f32 v57,v57
v_add_f32_e64 v8,v56,v8
v_cvt_pk_bf16_f32 v123,v70,v71
v_mfma_f32_32x32x16_bf16 v[208:223],a[252:255],v[140:143],v[208:223]
v_exp_f32 v58,v58
v_add_f32 v8,v57,v8
v_exp_f32_e64 v59,v59
v_cndmask_b32 v16,v16,v6,s[64:65]
v_cndmask_b32 v17,v17,v6,s[66:67]
v_cndmask_b32 v18,v18,v6,s[68:69]
v_cndmask_b32 v19,v19,v6,s[70:71]
v_cndmask_b32 v20,v20,v6,s[72:73]
v_cndmask_b32 v21,v21,v6,s[74:75]
v_cndmask_b32 v22,v22,v6,s[76:77]
v_cndmask_b32 v23,v23,v6,s[78:79]
v_cndmask_b32 v24,v24,v6,s[80:81]
v_cndmask_b32 v25,v25,v6,s[82:83]
v_cndmask_b32 v26,v26,v6,s[84:85]
v_cndmask_b32 v27,v27,v6,s[86:87]
v_cndmask_b32 v28,v28,v6,s[88:89]
v_cndmask_b32 v29,v29,v6,s[90:91]
v_cndmask_b32 v30,v30,v6,s[92:93]
v_cndmask_b32 v31,v31,v6,s[94:95]
v_mov_b32_e64 v4,v3
s_nop 0
s_waitcnt lgkmcnt(0)
v_mfma_f32_32x32x16_bf16 v[80:95],a[192:195],a[128:131],v[16:31]
ds_read_b128 a[224:227],v4 offset:8192
v_add_f32_e64 v8,v58,v8
v_cvt_pk_bf16_f32 v116,v56,v57
v_exp_f32 v60,v60
v_add_f32 v8,v59,v8
v_mfma_f32_32x32x16_bf16 v[96:111],a[192:195],a[160:163],v[32:47]
ds_read_b128 a[232:235],v4 offset:10240
v_exp_f32 v61,v61
v_add_f32 v8,v60,v8
v_cvt_pk_bf16_f32 v117,v58,v59
v_mfma_f32_32x32x16_bf16 v[80:95],a[196:199],a[132:135],v[80:95]
ds_read_b128 a[240:243],v4 offset:12288
v_exp_f32 v62,v62
v_add_f32 v8,v61,v8
v_exp_f32_e64 v63,v63
v_mfma_f32_32x32x16_bf16 v[96:111],a[196:199],a[164:167],v[96:111]
v_add_f32_e64 v8,v62,v8
v_cvt_pk_bf16_f32 v118,v60,v61
v_exp_f32 v72,v72
v_add_f32 v8,v63,v8
v_mfma_f32_32x32x16_bf16 v[80:95],a[200:203],a[136:139],v[80:95]
ds_read_b128 a[248:251],v4 offset:14336
v_exp_f32 v73,v73
v_add_f32 v9,v72,v9
v_cvt_pk_bf16_f32 v119,v62,v63
v_mfma_f32_32x32x16_bf16 v[96:111],a[200:203],a[168:171],v[96:111]
v_exp_f32 v74,v74
v_add_f32 v9,v73,v9
v_exp_f32 v75,v75
v_add_f32 v9,v74,v9
v_mfma_f32_32x32x16_bf16 v[80:95],a[204:207],a[140:143],v[80:95]
ds_read_b128 a[228:231],v4 offset:9216
v_cvt_pk_bf16_f32 v124,v72,v73
v_exp_f32 v76,v76
v_add_f32 v9,v75,v9
v_mfma_f32_32x32x16_bf16 v[96:111],a[204:207],a[172:175],v[96:111]
v_exp_f32 v77,v77
v_add_f32 v9,v76,v9
v_cvt_pk_bf16_f32 v125,v74,v75
v_exp_f32_e64 v78,v78
v_mfma_f32_32x32x16_bf16 v[80:95],a[208:211],a[144:147],v[80:95]
ds_read_b128 a[236:239],v4 offset:11264
v_add_f32 v9,v77,v9
v_exp_f32 v79,v79
v_add_f32_e64 v9,v78,v9
v_cvt_pk_bf16_f32 v126,v76,v77
v_mfma_f32_32x32x16_bf16 v[96:111],a[208:211],a[176:179],v[96:111]
v_add_f32_e64 v9,v79,v9
v_cvt_pk_bf16_f32 v127,v78,v79
v_mfma_f32_32x32x16_bf16 v[80:95],a[212:215],a[148:151],v[80:95]
ds_read_b128 a[244:247],v4 offset:13312
v_mfma_f32_32x32x16_bf16 v[96:111],a[212:215],a[180:183],v[96:111]
ds_read_b128 a[252:255],v4 offset:15360
v_mfma_f32_32x32x16_bf16 v[80:95],a[216:219],a[152:155],v[80:95]
v_mfma_f32_32x32x16_bf16 v[96:111],a[216:219],a[184:187],v[96:111]
v_mfma_f32_32x32x16_bf16 v[80:95],a[220:223],a[156:159],v[80:95]
v_mfma_f32_32x32x16_bf16 v[96:111],a[220:223],a[188:191],v[96:111]
v_add_u32_e64 v3,s50,v2
s_nop 0
s_waitcnt lgkmcnt(0)
v_mfma_f32_32x32x16_bf16 a[0:15],a[224:227],v[112:115],a[0:15]
ds_read_b128 a[192:195],v3 offset:0
v_mfma_f32_32x32x16_bf16 v[160:175],a[224:227],v[120:123],v[160:175]
ds_read_b128 a[196:199],v3 offset:1024
v_mfma_f32_32x32x16_bf16 a[16:31],a[232:235],v[112:115],a[16:31]
ds_read_b128 a[200:203],v3 offset:2048
v_mfma_f32_32x32x16_bf16 v[176:191],a[232:235],v[120:123],v[176:191]
s_nop 0
v_exp_f32 v80,v80
v_exp_f32 v81,v81
v_add_f32 v8,v80,v8
v_mfma_f32_32x32x16_bf16 a[32:47],a[240:243],v[112:115],a[32:47]
ds_read_b128 a[204:207],v3 offset:3072
v_exp_f32 v82,v82
v_add_f32 v8,v81,v8
v_exp_f32_e64 v83,v83
v_mfma_f32_32x32x16_bf16 v[192:207],a[240:243],v[120:123],v[192:207]
v_add_f32_e64 v8,v82,v8
v_cvt_pk_bf16_f32 v128,v80,v81
v_exp_f32 v84,v84
v_add_f32 v8,v83,v8
v_mfma_f32_32x32x16_bf16 a[48:63],a[248:251],v[112:115],a[48:63]
ds_read_b128 a[208:211],v3 offset:4096
v_exp_f32 v85,v85
v_add_f32 v8,v84,v8
v_cvt_pk_bf16_f32 v129,v82,v83
v_mfma_f32_32x32x16_bf16 v[208:223],a[248:251],v[120:123],v[208:223]
v_exp_f32 v86,v86
v_add_f32 v8,v85,v8
v_exp_f32 v87,v87
v_add_f32 v8,v86,v8
v_mfma_f32_32x32x16_bf16 a[0:15],a[228:231],v[116:119],a[0:15]
ds_read_b128 a[212:215],v3 offset:5120
v_cvt_pk_bf16_f32 v130,v84,v85
v_exp_f32 v96,v96
v_add_f32 v8,v87,v8
v_mfma_f32_32x32x16_bf16 v[160:175],a[228:231],v[124:127],v[160:175]
v_exp_f32 v97,v97
v_add_f32 v9,v96,v9
v_cvt_pk_bf16_f32 v131,v86,v87
v_exp_f32_e64 v98,v98
v_mfma_f32_32x32x16_bf16 a[16:31],a[236:239],v[116:119],a[16:31]
ds_read_b128 a[216:219],v3 offset:6144
v_add_f32 v9,v97,v9
v_exp_f32 v99,v99
v_add_f32_e64 v9,v98,v9
v_cvt_pk_bf16_f32 v136,v96,v97
v_mfma_f32_32x32x16_bf16 v[176:191],a[236:239],v[124:127],v[176:191]
ds_read_b128 a[220:223],v3 offset:7168
v_exp_f32 v100,v100
v_add_f32 v9,v99,v9
v_exp_f32_e64 v101,v101
v_mfma_f32_32x32x16_bf16 a[32:47],a[244:247],v[116:119],a[32:47]
v_add_f32_e64 v9,v100,v9
v_cvt_pk_bf16_f32 v137,v98,v99
v_exp_f32 v102,v102
v_add_f32 v9,v101,v9
v_mfma_f32_32x32x16_bf16 v[192:207],a[244:247],v[124:127],v[192:207]
v_exp_f32 v103,v103
v_add_f32 v9,v102,v9
v_cvt_pk_bf16_f32 v138,v100,v101
v_exp_f32_e64 v88,v88
v_mfma_f32_32x32x16_bf16 a[48:63],a[252:255],v[116:119],a[48:63]
v_add_f32 v9,v103,v9
v_exp_f32 v89,v89
v_add_f32_e64 v8,v88,v8
v_cvt_pk_bf16_f32 v139,v102,v103
v_mfma_f32_32x32x16_bf16 v[208:223],a[252:255],v[124:127],v[208:223]
v_exp_f32 v90,v90
v_add_f32 v8,v89,v8
v_exp_f32_e64 v91,v91
v_cndmask_b32 v32,v32,v6,s[64:65]
v_cndmask_b32 v33,v33,v6,s[66:67]
v_cndmask_b32 v34,v34,v6,s[68:69]
v_cndmask_b32 v35,v35,v6,s[70:71]
v_cndmask_b32 v36,v36,v6,s[72:73]
v_cndmask_b32 v37,v37,v6,s[74:75]
v_cndmask_b32 v38,v38,v6,s[76:77]
v_cndmask_b32 v39,v39,v6,s[78:79]
v_cndmask_b32 v40,v40,v6,s[80:81]
v_cndmask_b32 v41,v41,v6,s[82:83]
v_cndmask_b32 v42,v42,v6,s[84:85]
v_cndmask_b32 v43,v43,v6,s[86:87]
v_cndmask_b32 v44,v44,v6,s[88:89]
v_cndmask_b32 v45,v45,v6,s[90:91]
v_cndmask_b32 v46,v46,v6,s[92:93]
v_cndmask_b32 v47,v47,v6,s[94:95]
s_nop 0
s_waitcnt lgkmcnt(0)
v_mfma_f32_32x32x16_bf16 v[64:79],a[192:195],a[160:163],v[32:47]
ds_read_b128 a[224:227],v4 offset:24576
ds_read_b128 a[232:235],v4 offset:26624
v_add_f32_e64 v8,v90,v8
v_cvt_pk_bf16_f32 v132,v88,v89
v_mfma_f32_32x32x16_bf16 v[64:79],a[196:199],a[164:167],v[64:79]
ds_read_b128 a[240:243],v4 offset:28672
ds_read_b128 a[248:251],v4 offset:30720
v_exp_f32 v92,v92
v_add_f32 v8,v91,v8
v_mfma_f32_32x32x16_bf16 v[64:79],a[200:203],a[168:171],v[64:79]
ds_read_b128 a[228:231],v4 offset:25600
ds_read_b128 a[236:239],v4 offset:27648
v_exp_f32 v93,v93
v_add_f32 v8,v92,v8
v_mfma_f32_32x32x16_bf16 v[64:79],a[204:207],a[172:175],v[64:79]
ds_read_b128 a[244:247],v4 offset:29696
ds_read_b128 a[252:255],v4 offset:31744
v_cvt_pk_bf16_f32 v133,v90,v91
v_exp_f32_e64 v94,v94
v_mfma_f32_32x32x16_bf16 v[64:79],a[208:211],a[176:179],v[64:79]
v_add_f32 v8,v93,v8
v_exp_f32 v95,v95
v_add_f32_e64 v8,v94,v8
v_cvt_pk_bf16_f32 v134,v92,v93
v_mfma_f32_32x32x16_bf16 v[64:79],a[212:215],a[180:183],v[64:79]
v_exp_f32 v104,v104
v_add_f32 v8,v95,v8
v_exp_f32 v105,v105
v_add_f32 v9,v104,v9
v_mfma_f32_32x32x16_bf16 v[64:79],a[216:219],a[184:187],v[64:79]
v_cvt_pk_bf16_f32 v135,v94,v95
v_exp_f32 v106,v106
v_add_f32 v9,v105,v9
v_exp_f32_e64 v107,v107
v_mfma_f32_32x32x16_bf16 v[64:79],a[220:223],a[188:191],v[64:79]
v_add_f32_e64 v9,v106,v9
v_cvt_pk_bf16_f32 v140,v104,v105
v_exp_f32 v108,v108
v_add_f32 v9,v107,v9
v_mov_b32_e64 v4,v3
s_nop 0
s_waitcnt lgkmcnt(0)
v_mfma_f32_32x32x16_bf16 a[0:15],a[224:227],v[128:131],a[0:15]
ds_read_b128 a[192:195],v4 offset:8192
v_exp_f32 v109,v109
v_add_f32 v9,v108,v9
v_cvt_pk_bf16_f32 v141,v106,v107
v_mfma_f32_32x32x16_bf16 v[160:175],a[224:227],v[136:139],v[160:175]
ds_read_b128 a[200:203],v4 offset:10240
v_exp_f32 v110,v110
v_add_f32 v9,v109,v9
v_exp_f32_e64 v111,v111
v_mfma_f32_32x32x16_bf16 a[16:31],a[232:235],v[128:131],a[16:31]
ds_read_b128 a[208:211],v4 offset:12288
v_add_f32_e64 v9,v110,v9
v_cvt_pk_bf16_f32 v142,v108,v109
v_add_f32_e64 v9,v111,v9
v_cvt_pk_bf16_f32 v143,v110,v111
v_mfma_f32_32x32x16_bf16 v[176:191],a[232:235],v[136:139],v[176:191]
v_exp_f32 v64,v64
v_exp_f32 v65,v65
v_add_f32_e64 v9,v64,v9
v_mfma_f32_32x32x16_bf16 a[32:47],a[240:243],v[128:131],a[32:47]
ds_read_b128 a[216:219],v4 offset:14336
v_exp_f32 v66,v66
v_add_f32 v9,v65,v9
v_exp_f32_e64 v67,v67
v_mfma_f32_32x32x16_bf16 v[192:207],a[240:243],v[136:139],v[192:207]
v_add_f32_e64 v9,v66,v9
v_cvt_pk_bf16_f32 v120,v64,v65
v_exp_f32 v68,v68
v_add_f32 v9,v67,v9
v_mfma_f32_32x32x16_bf16 a[48:63],a[248:251],v[128:131],a[48:63]
ds_read_b128 a[196:199],v4 offset:9216
v_exp_f32 v69,v69
v_add_f32 v9,v68,v9
v_cvt_pk_bf16_f32 v121,v66,v67
v_mfma_f32_32x32x16_bf16 v[208:223],a[248:251],v[136:139],v[208:223]
v_exp_f32 v70,v70
v_add_f32 v9,v69,v9
v_exp_f32 v71,v71
v_add_f32 v9,v70,v9
v_mfma_f32_32x32x16_bf16 a[0:15],a[228:231],v[132:135],a[0:15]
ds_read_b128 a[204:207],v4 offset:11264
v_cvt_pk_bf16_f32 v122,v68,v69
v_exp_f32 v72,v72
v_add_f32 v9,v71,v9
v_mfma_f32_32x32x16_bf16 v[160:175],a[228:231],v[140:143],v[160:175]
v_exp_f32 v73,v73
v_add_f32 v9,v72,v9
v_cvt_pk_bf16_f32 v123,v70,v71
v_exp_f32_e64 v74,v74
v_mfma_f32_32x32x16_bf16 a[16:31],a[236:239],v[132:135],a[16:31]
ds_read_b128 a[212:215],v4 offset:13312
v_add_f32 v9,v73,v9
v_exp_f32 v75,v75
v_add_f32_e64 v9,v74,v9
v_cvt_pk_bf16_f32 v124,v72,v73
v_mfma_f32_32x32x16_bf16 v[176:191],a[236:239],v[140:143],v[176:191]
ds_read_b128 a[220:223],v4 offset:15360
v_exp_f32 v76,v76
v_add_f32 v9,v75,v9
v_exp_f32_e64 v77,v77
v_mfma_f32_32x32x16_bf16 a[32:47],a[244:247],v[132:135],a[32:47]
v_add_f32_e64 v9,v76,v9
v_cvt_pk_bf16_f32 v125,v74,v75
v_exp_f32 v78,v78
v_add_f32 v9,v77,v9
v_mfma_f32_32x32x16_bf16 v[192:207],a[244:247],v[140:143],v[192:207]
v_exp_f32 v79,v79
v_add_f32 v9,v78,v9
v_cvt_pk_bf16_f32 v126,v76,v77
v_add_f32_e64 v9,v79,v9
v_cvt_pk_bf16_f32 v127,v78,v79
v_mfma_f32_32x32x16_bf16 a[48:63],a[252:255],v[132:135],a[48:63]
v_mfma_f32_32x32x16_bf16 v[208:223],a[252:255],v[140:143],v[208:223]
s_waitcnt lgkmcnt(0)
s_nop 0
v_mfma_f32_32x32x16_bf16 v[160:175],a[192:195],v[120:123],v[160:175]
v_mfma_f32_32x32x16_bf16 v[176:191],a[200:203],v[120:123],v[176:191]
v_mfma_f32_32x32x16_bf16 v[192:207],a[208:211],v[120:123],v[192:207]
v_mfma_f32_32x32x16_bf16 v[208:223],a[216:219],v[120:123],v[208:223]
v_mfma_f32_32x32x16_bf16 v[160:175],a[196:199],v[124:127],v[160:175]
v_mfma_f32_32x32x16_bf16 v[176:191],a[204:207],v[124:127],v[176:191]
v_mfma_f32_32x32x16_bf16 v[192:207],a[212:215],v[124:127],v[192:207]
v_mfma_f32_32x32x16_bf16 v[208:223],a[220:223],v[124:127],v[208:223]
s_branch b_done
b_done:
v_mov_b32 v12,v8
s_nop 1
v_permlane32_swap_b32 v8,v12
v_add_f32 v8,v8,v12
v_mov_b32 v12,v9
s_nop 1
v_permlane32_swap_b32 v9,v12
v_add_f32 v9,v9,v12
s_mov_b64 vcc,exec
v_cmp_le_f32 s[24:25],s44,v8
v_cmp_ge_f32 s[26:27],s45,v8
s_and_b64 vcc,vcc,s[24:25]
s_and_b64 vcc,vcc,s[26:27]
v_cmp_le_f32 s[24:25],s44,v9
v_cmp_ge_f32 s[26:27],s45,v9
s_and_b64 vcc,vcc,s[24:25]
s_and_b64 vcc,vcc,s[26:27]
s_cmp_eq_u64 vcc,exec
s_cbranch_scc0 b_fb
b_ok:
v_rcp_f32 v10,v8
v_rcp_f32_e64 v8,v9
s_lshl_b32 s25,s16,13
s_add_u32 s25,s25,115343360
s_nop 7
s_mul_i32 s24,s61,262144
s_add_u32 s24,s24,s25
v_accvgpr_read_b32 v48,a0
v_accvgpr_read_b32 v49,a1
v_accvgpr_read_b32 v50,a2
v_accvgpr_read_b32 v51,a3
v_accvgpr_read_b32 v52,a4
v_accvgpr_read_b32 v53,a5
v_accvgpr_read_b32 v54,a6
v_accvgpr_read_b32 v55,a7
v_accvgpr_read_b32 v56,a8
v_accvgpr_read_b32 v57,a9
v_accvgpr_read_b32 v58,a10
v_accvgpr_read_b32 v59,a11
v_accvgpr_read_b32 v60,a12
v_accvgpr_read_b32 v61,a13
v_accvgpr_read_b32 v62,a14
v_accvgpr_read_b32 v63,a15
v_pk_mul_f32 v[48:49],v[48:49],v[10:11] op_sel_hi:[1,0]
v_pk_mul_f32 v[50:51],v[50:51],v[10:11] op_sel_hi:[1,0]
v_pk_mul_f32 v[52:53],v[52:53],v[10:11] op_sel_hi:[1,0]
v_pk_mul_f32 v[54:55],v[54:55],v[10:11] op_sel_hi:[1,0]
v_pk_mul_f32 v[56:57],v[56:57],v[10:11] op_sel_hi:[1,0]
v_pk_mul_f32 v[58:59],v[58:59],v[10:11] op_sel_hi:[1,0]
v_pk_mul_f32 v[60:61],v[60:61],v[10:11] op_sel_hi:[1,0]
v_pk_mul_f32 v[62:63],v[62:63],v[10:11] op_sel_hi:[1,0]
v_cvt_pk_bf16_f32 v112,v48,v49
v_cvt_pk_bf16_f32 v113,v50,v51
v_cvt_pk_bf16_f32 v114,v52,v53
v_cvt_pk_bf16_f32 v115,v54,v55
v_cvt_pk_bf16_f32 v116,v56,v57
v_cvt_pk_bf16_f32 v117,v58,v59
v_cvt_pk_bf16_f32 v118,v60,v61
v_cvt_pk_bf16_f32 v119,v62,v63
buffer_store_dwordx4 v[112:115],v2,s[8:11],s24 offen offset:0 sc1
buffer_store_dwordx4 v[116:119],v2,s[8:11],s24 offen offset:1024 sc1
v_accvgpr_read_b32 v64,a16
v_accvgpr_read_b32 v65,a17
v_accvgpr_read_b32 v66,a18
v_accvgpr_read_b32 v67,a19
v_accvgpr_read_b32 v68,a20
v_accvgpr_read_b32 v69,a21
v_accvgpr_read_b32 v70,a22
v_accvgpr_read_b32 v71,a23
v_accvgpr_read_b32 v72,a24
v_accvgpr_read_b32 v73,a25
v_accvgpr_read_b32 v74,a26
v_accvgpr_read_b32 v75,a27
v_accvgpr_read_b32 v76,a28
v_accvgpr_read_b32 v77,a29
v_accvgpr_read_b32 v78,a30
v_accvgpr_read_b32 v79,a31
v_pk_mul_f32 v[64:65],v[64:65],v[10:11] op_sel_hi:[1,0]
v_pk_mul_f32 v[66:67],v[66:67],v[10:11] op_sel_hi:[1,0]
v_pk_mul_f32 v[68:69],v[68:69],v[10:11] op_sel_hi:[1,0]
v_pk_mul_f32 v[70:71],v[70:71],v[10:11] op_sel_hi:[1,0]
v_pk_mul_f32 v[72:73],v[72:73],v[10:11] op_sel_hi:[1,0]
v_pk_mul_f32 v[74:75],v[74:75],v[10:11] op_sel_hi:[1,0]
v_pk_mul_f32 v[76:77],v[76:77],v[10:11] op_sel_hi:[1,0]
v_pk_mul_f32 v[78:79],v[78:79],v[10:11] op_sel_hi:[1,0]
v_cvt_pk_bf16_f32 v120,v64,v65
v_cvt_pk_bf16_f32 v121,v66,v67
v_cvt_pk_bf16_f32 v122,v68,v69
v_cvt_pk_bf16_f32 v123,v70,v71
v_cvt_pk_bf16_f32 v124,v72,v73
v_cvt_pk_bf16_f32 v125,v74,v75
v_cvt_pk_bf16_f32 v126,v76,v77
v_cvt_pk_bf16_f32 v127,v78,v79
buffer_store_dwordx4 v[120:123],v2,s[8:11],s24 offen offset:2048 sc1
buffer_store_dwordx4 v[124:127],v2,s[8:11],s24 offen offset:3072 sc1
s_add_u32 s24,s24,4096
v_accvgpr_read_b32 v80,a32
v_accvgpr_read_b32 v81,a33
v_accvgpr_read_b32 v82,a34
v_accvgpr_read_b32 v83,a35
v_accvgpr_read_b32 v84,a36
v_accvgpr_read_b32 v85,a37
v_accvgpr_read_b32 v86,a38
v_accvgpr_read_b32 v87,a39
v_accvgpr_read_b32 v88,a40
v_accvgpr_read_b32 v89,a41
v_accvgpr_read_b32 v90,a42
v_accvgpr_read_b32 v91,a43
v_accvgpr_read_b32 v92,a44
v_accvgpr_read_b32 v93,a45
v_accvgpr_read_b32 v94,a46
v_accvgpr_read_b32 v95,a47
v_pk_mul_f32 v[80:81],v[80:81],v[10:11] op_sel_hi:[1,0]
v_pk_mul_f32 v[82:83],v[82:83],v[10:11] op_sel_hi:[1,0]
v_pk_mul_f32 v[84:85],v[84:85],v[10:11] op_sel_hi:[1,0]
v_pk_mul_f32 v[86:87],v[86:87],v[10:11] op_sel_hi:[1,0]
v_pk_mul_f32 v[88:89],v[88:89],v[10:11] op_sel_hi:[1,0]
v_pk_mul_f32 v[90:91],v[90:91],v[10:11] op_sel_hi:[1,0]
v_pk_mul_f32 v[92:93],v[92:93],v[10:11] op_sel_hi:[1,0]
v_pk_mul_f32 v[94:95],v[94:95],v[10:11] op_sel_hi:[1,0]
v_cvt_pk_bf16_f32 v128,v80,v81
v_cvt_pk_bf16_f32 v129,v82,v83
v_cvt_pk_bf16_f32 v130,v84,v85
v_cvt_pk_bf16_f32 v131,v86,v87
v_cvt_pk_bf16_f32 v132,v88,v89
v_cvt_pk_bf16_f32 v133,v90,v91
v_cvt_pk_bf16_f32 v134,v92,v93
v_cvt_pk_bf16_f32 v135,v94,v95
buffer_store_dwordx4 v[128:131],v2,s[8:11],s24 offen offset:0 sc1
buffer_store_dwordx4 v[132:135],v2,s[8:11],s24 offen offset:1024 sc1
v_accvgpr_read_b32 v96,a48
v_accvgpr_read_b32 v97,a49
v_accvgpr_read_b32 v98,a50
v_accvgpr_read_b32 v99,a51
v_accvgpr_read_b32 v100,a52
v_accvgpr_read_b32 v101,a53
v_accvgpr_read_b32 v102,a54
v_accvgpr_read_b32 v103,a55
v_accvgpr_read_b32 v104,a56
v_accvgpr_read_b32 v105,a57
v_accvgpr_read_b32 v106,a58
v_accvgpr_read_b32 v107,a59
v_accvgpr_read_b32 v108,a60
v_accvgpr_read_b32 v109,a61
v_accvgpr_read_b32 v110,a62
v_accvgpr_read_b32 v111,a63
v_pk_mul_f32 v[96:97],v[96:97],v[10:11] op_sel_hi:[1,0]
v_pk_mul_f32 v[98:99],v[98:99],v[10:11] op_sel_hi:[1,0]
v_pk_mul_f32 v[100:101],v[100:101],v[10:11] op_sel_hi:[1,0]
v_pk_mul_f32 v[102:103],v[102:103],v[10:11] op_sel_hi:[1,0]
v_pk_mul_f32 v[104:105],v[104:105],v[10:11] op_sel_hi:[1,0]
v_pk_mul_f32 v[106:107],v[106:107],v[10:11] op_sel_hi:[1,0]
v_pk_mul_f32 v[108:109],v[108:109],v[10:11] op_sel_hi:[1,0]
v_pk_mul_f32 v[110:111],v[110:111],v[10:11] op_sel_hi:[1,0]
v_cvt_pk_bf16_f32 v136,v96,v97
v_cvt_pk_bf16_f32 v137,v98,v99
v_cvt_pk_bf16_f32 v138,v100,v101
v_cvt_pk_bf16_f32 v139,v102,v103
v_cvt_pk_bf16_f32 v140,v104,v105
v_cvt_pk_bf16_f32 v141,v106,v107
v_cvt_pk_bf16_f32 v142,v108,v109
v_cvt_pk_bf16_f32 v143,v110,v111
buffer_store_dwordx4 v[136:139],v2,s[8:11],s24 offen offset:2048 sc1
buffer_store_dwordx4 v[140:143],v2,s[8:11],s24 offen offset:3072 sc1
s_mul_i32 s24,s56,262144
s_add_u32 s24,s24,s25
v_pk_mul_f32 v[160:161],v[160:161],v[8:9] op_sel_hi:[1,0]
v_pk_mul_f32 v[162:163],v[162:163],v[8:9] op_sel_hi:[1,0]
v_pk_mul_f32 v[164:165],v[164:165],v[8:9] op_sel_hi:[1,0]
v_pk_mul_f32 v[166:167],v[166:167],v[8:9] op_sel_hi:[1,0]
v_pk_mul_f32 v[168:169],v[168:169],v[8:9] op_sel_hi:[1,0]
v_pk_mul_f32 v[170:171],v[170:171],v[8:9] op_sel_hi:[1,0]
v_pk_mul_f32 v[172:173],v[172:173],v[8:9] op_sel_hi:[1,0]
v_pk_mul_f32 v[174:175],v[174:175],v[8:9] op_sel_hi:[1,0]
v_cvt_pk_bf16_f32 v112,v160,v161
v_cvt_pk_bf16_f32 v113,v162,v163
v_cvt_pk_bf16_f32 v114,v164,v165
v_cvt_pk_bf16_f32 v115,v166,v167
v_cvt_pk_bf16_f32 v116,v168,v169
v_cvt_pk_bf16_f32 v117,v170,v171
v_cvt_pk_bf16_f32 v118,v172,v173
v_cvt_pk_bf16_f32 v119,v174,v175
buffer_store_dwordx4 v[112:115],v2,s[8:11],s24 offen offset:0 sc1
buffer_store_dwordx4 v[116:119],v2,s[8:11],s24 offen offset:1024 sc1
v_pk_mul_f32 v[176:177],v[176:177],v[8:9] op_sel_hi:[1,0]
v_pk_mul_f32 v[178:179],v[178:179],v[8:9] op_sel_hi:[1,0]
v_pk_mul_f32 v[180:181],v[180:181],v[8:9] op_sel_hi:[1,0]
v_pk_mul_f32 v[182:183],v[182:183],v[8:9] op_sel_hi:[1,0]
v_pk_mul_f32 v[184:185],v[184:185],v[8:9] op_sel_hi:[1,0]
v_pk_mul_f32 v[186:187],v[186:187],v[8:9] op_sel_hi:[1,0]
v_pk_mul_f32 v[188:189],v[188:189],v[8:9] op_sel_hi:[1,0]
v_pk_mul_f32 v[190:191],v[190:191],v[8:9] op_sel_hi:[1,0]
v_cvt_pk_bf16_f32 v120,v176,v177
v_cvt_pk_bf16_f32 v121,v178,v179
v_cvt_pk_bf16_f32 v122,v180,v181
v_cvt_pk_bf16_f32 v123,v182,v183
v_cvt_pk_bf16_f32 v124,v184,v185
v_cvt_pk_bf16_f32 v125,v186,v187
v_cvt_pk_bf16_f32 v126,v188,v189
v_cvt_pk_bf16_f32 v127,v190,v191
buffer_store_dwordx4 v[120:123],v2,s[8:11],s24 offen offset:2048 sc1
buffer_store_dwordx4 v[124:127],v2,s[8:11],s24 offen offset:3072 sc1
s_add_u32 s24,s24,4096
v_pk_mul_f32 v[192:193],v[192:193],v[8:9] op_sel_hi:[1,0]
v_pk_mul_f32 v[194:195],v[194:195],v[8:9] op_sel_hi:[1,0]
v_pk_mul_f32 v[196:197],v[196:197],v[8:9] op_sel_hi:[1,0]
v_pk_mul_f32 v[198:199],v[198:199],v[8:9] op_sel_hi:[1,0]
v_pk_mul_f32 v[200:201],v[200:201],v[8:9] op_sel_hi:[1,0]
v_pk_mul_f32 v[202:203],v[202:203],v[8:9] op_sel_hi:[1,0]
v_pk_mul_f32 v[204:205],v[204:205],v[8:9] op_sel_hi:[1,0]
v_pk_mul_f32 v[206:207],v[206:207],v[8:9] op_sel_hi:[1,0]
v_cvt_pk_bf16_f32 v128,v192,v193
v_cvt_pk_bf16_f32 v129,v194,v195
v_cvt_pk_bf16_f32 v130,v196,v197
v_cvt_pk_bf16_f32 v131,v198,v199
v_cvt_pk_bf16_f32 v132,v200,v201
v_cvt_pk_bf16_f32 v133,v202,v203
v_cvt_pk_bf16_f32 v134,v204,v205
v_cvt_pk_bf16_f32 v135,v206,v207
buffer_store_dwordx4 v[128:131],v2,s[8:11],s24 offen offset:0 sc1
buffer_store_dwordx4 v[132:135],v2,s[8:11],s24 offen offset:1024 sc1
v_pk_mul_f32 v[208:209],v[208:209],v[8:9] op_sel_hi:[1,0]
v_pk_mul_f32 v[210:211],v[210:211],v[8:9] op_sel_hi:[1,0]
v_pk_mul_f32 v[212:213],v[212:213],v[8:9] op_sel_hi:[1,0]
v_pk_mul_f32 v[214:215],v[214:215],v[8:9] op_sel_hi:[1,0]
v_pk_mul_f32 v[216:217],v[216:217],v[8:9] op_sel_hi:[1,0]
v_pk_mul_f32 v[218:219],v[218:219],v[8:9] op_sel_hi:[1,0]
v_pk_mul_f32 v[220:221],v[220:221],v[8:9] op_sel_hi:[1,0]
v_pk_mul_f32 v[222:223],v[222:223],v[8:9] op_sel_hi:[1,0]
v_cvt_pk_bf16_f32 v136,v208,v209
v_cvt_pk_bf16_f32 v137,v210,v211
v_cvt_pk_bf16_f32 v138,v212,v213
v_cvt_pk_bf16_f32 v139,v214,v215
v_cvt_pk_bf16_f32 v140,v216,v217
v_cvt_pk_bf16_f32 v141,v218,v219
v_cvt_pk_bf16_f32 v142,v220,v221
v_cvt_pk_bf16_f32 v143,v222,v223
buffer_store_dwordx4 v[136:139],v2,s[8:11],s24 offen offset:2048 sc1
buffer_store_dwordx4 v[140:143],v2,s[8:11],s24 offen offset:3072 sc1
s_endpgm
k2_cold:
att2_fb0:
s_waitcnt vmcnt(0)
v_mov_b32 v69,0
v_mov_b32_e64 v8,v6
s_mov_b32 s41,s36
s_mov_b32 s39,64
att2_f1_0:
buffer_load_dwordx4 a[0:3],v2,s[8:11],s41 offen
buffer_load_dword a4,v7,s[52:55],s41 offen offset:3072
buffer_load_dwordx4 a[8:11],v248,s[8:11],s41 offen offset:1024
buffer_load_dwordx4 a[12:15],v248,s[8:11],s41 offen offset:2048
s_add_u32 s41,s41,4096
s_waitcnt vmcnt(0)
v_mfma_f32_32x32x16_bf16 v[16:31],a[0:3],v[64:67],0
s_nop 0
v_mfma_f32_32x32x16_bf16 v[16:31],a[4:7],v[68:71],v[16:31]
s_nop 11
v_max3_f32 v8,v8,v16,v17
v_max3_f32 v8,v8,v18,v19
v_max3_f32 v8,v8,v20,v21
v_max3_f32 v8,v8,v22,v23
v_max3_f32 v8,v8,v24,v25
v_max3_f32 v8,v8,v26,v27
v_max3_f32 v8,v8,v28,v29
v_max3_f32 v8,v8,v30,v31
s_sub_u32 s39,s39,1
s_cmp_lg_u32 s39,0
s_cbranch_scc1 att2_f1_0
v_mov_b32 v12,v8
s_nop 1
v_permlane32_swap_b32 v8,v12
v_max_f32 v8,v8,v12
v_sub_f32_e64 v10,0,v8
v_cvt_pk_bf16_f32 v10,v10,0
v_cndmask_b32 v69,v10,0,s[96:97]
v_mov_b32 v120,0
v_mov_b32 v121,0
v_mov_b32 v122,0
v_mov_b32 v123,0
v_mov_b32 v124,0
v_mov_b32 v125,0
v_mov_b32 v126,0
v_mov_b32 v127,0
v_mov_b32 v128,0
v_mov_b32 v129,0
v_mov_b32 v130,0
v_mov_b32 v131,0
v_mov_b32 v132,0
v_mov_b32 v133,0
v_mov_b32 v134,0
v_mov_b32 v135,0
s_mov_b32 s41,s36
s_mov_b32 s39,64
att2_f2_0:
buffer_load_dwordx4 a[0:3],v2,s[8:11],s41 offen
buffer_load_dword a4,v7,s[52:55],s41 offen offset:3072
buffer_load_dwordx4 a[8:11],v248,s[8:11],s41 offen offset:1024
buffer_load_dwordx4 a[12:15],v248,s[8:11],s41 offen offset:2048
s_add_u32 s41,s41,4096
s_waitcnt vmcnt(0)
v_mfma_f32_32x32x16_bf16 v[16:31],a[0:3],v[64:67],0
s_nop 0
v_mfma_f32_32x32x16_bf16 v[16:31],a[4:7],v[68:71],v[16:31]
s_nop 11
v_exp_f32 v16,v16
v_exp_f32 v17,v17
v_exp_f32 v18,v18
v_exp_f32_e64 v19,v19
v_cvt_pk_bf16_f32 v48,v16,v17
v_cvt_pk_bf16_f32 v49,v18,v19
v_exp_f32 v20,v20
v_exp_f32 v21,v21
v_exp_f32 v22,v22
v_exp_f32 v23,v23
v_cvt_pk_bf16_f32 v50,v20,v21
v_cvt_pk_bf16_f32 v51,v22,v23
v_exp_f32 v24,v24
v_exp_f32 v25,v25
v_exp_f32 v26,v26
v_exp_f32 v27,v27
v_cvt_pk_bf16_f32 v52,v24,v25
v_cvt_pk_bf16_f32 v53,v26,v27
v_exp_f32 v28,v28
v_exp_f32 v29,v29
v_exp_f32 v30,v30
v_exp_f32 v31,v31
v_cvt_pk_bf16_f32 v54,v28,v29
v_cvt_pk_bf16_f32 v55,v30,v31
s_nop 1
v_mfma_f32_32x32x16_bf16 v[120:135],a[8:11],v[48:51],v[120:135]
s_nop 0
v_mfma_f32_32x32x16_bf16 v[120:135],a[12:15],v[52:55],v[120:135]
s_sub_u32 s39,s39,1
s_cmp_lg_u32 s39,0
s_cbranch_scc1 att2_f2_0
s_nop 11
s_branch att2_ok0
att2_fb1:
s_waitcnt vmcnt(0)
v_mov_b32 v77,0
v_mov_b32 v8,v6
s_mov_b32 s41,s36
s_mov_b32 s39,64
att2_f1_1:
buffer_load_dwordx4 a[0:3],v2,s[8:11],s41 offen
buffer_load_dword a4,v7,s[52:55],s41 offen offset:3072
buffer_load_dwordx4 a[8:11],v248,s[8:11],s41 offen offset:1024
buffer_load_dwordx4 a[12:15],v248,s[8:11],s41 offen offset:2048
s_add_u32 s41,s41,4096
s_waitcnt vmcnt(0)
v_mfma_f32_32x32x16_bf16 v[16:31],a[0:3],v[72:75],0
s_nop 0
v_mfma_f32_32x32x16_bf16 v[16:31],a[4:7],v[76:79],v[16:31]
s_nop 11
v_max3_f32 v8,v8,v16,v17
v_max3_f32 v8,v8,v18,v19
v_max3_f32 v8,v8,v20,v21
v_max3_f32 v8,v8,v22,v23
v_max3_f32 v8,v8,v24,v25
v_max3_f32 v8,v8,v26,v27
v_max3_f32 v8,v8,v28,v29
v_max3_f32 v8,v8,v30,v31
s_sub_u32 s39,s39,1
s_cmp_lg_u32 s39,0
s_cbranch_scc1 att2_f1_1
v_mov_b32 v12,v8
s_nop 1
v_permlane32_swap_b32 v8,v12
v_max_f32 v8,v8,v12
v_sub_f32_e64 v10,0,v8
v_cvt_pk_bf16_f32 v10,v10,0
v_cndmask_b32 v77,v10,0,s[96:97]
v_mov_b32 v136,0
v_mov_b32 v137,0
v_mov_b32 v138,0
v_mov_b32 v139,0
v_mov_b32 v140,0
v_mov_b32 v141,0
v_mov_b32 v142,0
v_mov_b32 v143,0
v_mov_b32 v144,0
v_mov_b32 v145,0
v_mov_b32 v146,0
v_mov_b32 v147,0
v_mov_b32 v148,0
v_mov_b32 v149,0
v_mov_b32 v150,0
v_mov_b32 v151,0
s_mov_b32 s41,s36
s_mov_b32 s39,64
att2_f2_1:
buffer_load_dwordx4 a[0:3],v2,s[8:11],s41 offen
buffer_load_dword a4,v7,s[52:55],s41 offen offset:3072
buffer_load_dwordx4 a[8:11],v248,s[8:11],s41 offen offset:1024
buffer_load_dwordx4 a[12:15],v248,s[8:11],s41 offen offset:2048
s_add_u32 s41,s41,4096
s_waitcnt vmcnt(0)
v_mfma_f32_32x32x16_bf16 v[16:31],a[0:3],v[72:75],0
s_nop 0
v_mfma_f32_32x32x16_bf16 v[16:31],a[4:7],v[76:79],v[16:31]
s_nop 11
v_exp_f32 v16,v16
v_exp_f32 v17,v17
v_exp_f32 v18,v18
v_exp_f32_e64 v19,v19
v_cvt_pk_bf16_f32 v48,v16,v17
v_cvt_pk_bf16_f32 v49,v18,v19
v_exp_f32 v20,v20
v_exp_f32 v21,v21
v_exp_f32 v22,v22
v_exp_f32 v23,v23
v_cvt_pk_bf16_f32 v50,v20,v21
v_cvt_pk_bf16_f32 v51,v22,v23
v_exp_f32 v24,v24
v_exp_f32 v25,v25
v_exp_f32 v26,v26
v_exp_f32 v27,v27
v_cvt_pk_bf16_f32 v52,v24,v25
v_cvt_pk_bf16_f32 v53,v26,v27
v_exp_f32 v28,v28
v_exp_f32 v29,v29
v_exp_f32 v30,v30
v_exp_f32 v31,v31
v_cvt_pk_bf16_f32 v54,v28,v29
v_cvt_pk_bf16_f32 v55,v30,v31
s_nop 1
v_mfma_f32_32x32x16_bf16 v[136:151],a[8:11],v[48:51],v[136:151]
s_nop 0
v_mfma_f32_32x32x16_bf16 v[136:151],a[12:15],v[52:55],v[136:151]
s_sub_u32 s39,s39,1
s_cmp_lg_u32 s39,0
s_cbranch_scc1 att2_f2_1
s_nop 11
s_branch att2_ok1
att3_fb0:
s_waitcnt vmcnt(0)
v_mov_b32 v69,0
v_mov_b32 v8,v6
s_mov_b32 s41,s36
s_mov_b32 s39,64
att3_f1_0:
buffer_load_dwordx4 a[0:3],v2,s[8:11],s41 offen
buffer_load_dword a4,v7,s[52:55],s41 offen offset:3072
buffer_load_dwordx4 a[8:11],v248,s[8:11],s41 offen offset:1024
buffer_load_dwordx4 a[12:15],v248,s[8:11],s41 offen offset:2048
s_add_u32 s41,s41,4096
s_waitcnt vmcnt(0)
v_mfma_f32_32x32x16_bf16 v[16:31],a[0:3],v[64:67],0
s_nop 0
v_mfma_f32_32x32x16_bf16 v[16:31],a[4:7],v[68:71],v[16:31]
s_nop 11
v_max3_f32 v8,v8,v16,v17
v_max3_f32 v8,v8,v18,v19
v_max3_f32 v8,v8,v20,v21
v_max3_f32 v8,v8,v22,v23
v_max3_f32 v8,v8,v24,v25
v_max3_f32 v8,v8,v26,v27
v_max3_f32 v8,v8,v28,v29
v_max3_f32 v8,v8,v30,v31
s_sub_u32 s39,s39,1
s_cmp_lg_u32 s39,0
s_cbranch_scc1 att3_f1_0
v_mov_b32 v12,v8
s_nop 1
v_permlane32_swap_b32 v8,v12
v_max_f32 v8,v8,v12
v_sub_f32_e64 v10,0,v8
v_cvt_pk_bf16_f32 v10,v10,0
v_cndmask_b32 v69,v10,0,s[96:97]
v_mov_b32 v120,0
v_mov_b32 v121,0
v_mov_b32 v122,0
v_mov_b32 v123,0
v_mov_b32 v124,0
v_mov_b32 v125,0
v_mov_b32 v126,0
v_mov_b32 v127,0
v_mov_b32 v128,0
v_mov_b32 v129,0
v_mov_b32 v130,0
v_mov_b32 v131,0
v_mov_b32 v132,0
v_mov_b32 v133,0
v_mov_b32 v134,0
v_mov_b32 v135,0
s_mov_b32 s41,s36
s_mov_b32 s39,64
att3_f2_0:
buffer_load_dwordx4 a[0:3],v2,s[8:11],s41 offen
buffer_load_dword a4,v7,s[52:55],s41 offen offset:3072
buffer_load_dwordx4 a[8:11],v248,s[8:11],s41 offen offset:1024
buffer_load_dwordx4 a[12:15],v248,s[8:11],s41 offen offset:2048
s_add_u32 s41,s41,4096
s_waitcnt vmcnt(0)
v_mfma_f32_32x32x16_bf16 v[16:31],a[0:3],v[64:67],0
s_nop 0
v_mfma_f32_32x32x16_bf16 v[16:31],a[4:7],v[68:71],v[16:31]
s_nop 11
v_exp_f32 v16,v16
v_exp_f32 v17,v17
v_exp_f32 v18,v18
v_exp_f32_e64 v19,v19
v_cvt_pk_bf16_f32 v48,v16,v17
v_cvt_pk_bf16_f32 v49,v18,v19
v_exp_f32 v20,v20
v_exp_f32 v21,v21
v_exp_f32 v22,v22
v_exp_f32 v23,v23
v_cvt_pk_bf16_f32 v50,v20,v21
v_cvt_pk_bf16_f32 v51,v22,v23
v_exp_f32 v24,v24
v_exp_f32 v25,v25
v_exp_f32 v26,v26
v_exp_f32 v27,v27
v_cvt_pk_bf16_f32 v52,v24,v25
v_cvt_pk_bf16_f32 v53,v26,v27
v_exp_f32 v28,v28
v_exp_f32 v29,v29
v_exp_f32 v30,v30
v_exp_f32 v31,v31
v_cvt_pk_bf16_f32 v54,v28,v29
v_cvt_pk_bf16_f32 v55,v30,v31
s_nop 1
v_mfma_f32_32x32x16_bf16 v[120:135],a[8:11],v[48:51],v[120:135]
s_nop 0
v_mfma_f32_32x32x16_bf16 v[120:135],a[12:15],v[52:55],v[120:135]
s_sub_u32 s39,s39,1
s_cmp_lg_u32 s39,0
s_cbranch_scc1 att3_f2_0
s_nop 11
s_branch att3_ok0
att3_fb1:
s_waitcnt vmcnt(0)
v_mov_b32 v77,0
v_mov_b32 v8,v6
s_mov_b32 s41,s36
s_mov_b32 s39,64
att3_f1_1:
buffer_load_dwordx4 a[0:3],v2,s[8:11],s41 offen
buffer_load_dword a4,v7,s[52:55],s41 offen offset:3072
buffer_load_dwordx4 a[8:11],v248,s[8:11],s41 offen offset:1024
buffer_load_dwordx4 a[12:15],v248,s[8:11],s41 offen offset:2048
s_add_u32 s41,s41,4096
s_waitcnt vmcnt(0)
v_mfma_f32_32x32x16_bf16 v[16:31],a[0:3],v[72:75],0
s_nop 0
v_mfma_f32_32x32x16_bf16 v[16:31],a[4:7],v[76:79],v[16:31]
s_nop 11
v_max3_f32 v8,v8,v16,v17
v_max3_f32 v8,v8,v18,v19
v_max3_f32 v8,v8,v20,v21
v_max3_f32 v8,v8,v22,v23
v_max3_f32 v8,v8,v24,v25
v_max3_f32 v8,v8,v26,v27
v_max3_f32 v8,v8,v28,v29
v_max3_f32 v8,v8,v30,v31
s_sub_u32 s39,s39,1
s_cmp_lg_u32 s39,0
s_cbranch_scc1 att3_f1_1
v_mov_b32 v12,v8
s_nop 1
v_permlane32_swap_b32 v8,v12
v_max_f32 v8,v8,v12
v_sub_f32_e64 v10,0,v8
v_cvt_pk_bf16_f32 v10,v10,0
v_cndmask_b32 v77,v10,0,s[96:97]
v_mov_b32 v136,0
v_mov_b32 v137,0
v_mov_b32 v138,0
v_mov_b32 v139,0
v_mov_b32 v140,0
v_mov_b32 v141,0
v_mov_b32 v142,0
v_mov_b32 v143,0
v_mov_b32 v144,0
v_mov_b32 v145,0
v_mov_b32 v146,0
v_mov_b32 v147,0
v_mov_b32 v148,0
v_mov_b32 v149,0
v_mov_b32 v150,0
v_mov_b32 v151,0
s_mov_b32 s41,s36
s_mov_b32 s39,64
att3_f2_1:
buffer_load_dwordx4 a[0:3],v2,s[8:11],s41 offen
buffer_load_dword a4,v7,s[52:55],s41 offen offset:3072
buffer_load_dwordx4 a[8:11],v248,s[8:11],s41 offen offset:1024
buffer_load_dwordx4 a[12:15],v248,s[8:11],s41 offen offset:2048
s_add_u32 s41,s41,4096
s_waitcnt vmcnt(0)
v_mfma_f32_32x32x16_bf16 v[16:31],a[0:3],v[72:75],0
s_nop 0
v_mfma_f32_32x32x16_bf16 v[16:31],a[4:7],v[76:79],v[16:31]
s_nop 11
v_exp_f32 v16,v16
v_exp_f32 v17,v17
v_exp_f32 v18,v18
v_exp_f32_e64 v19,v19
v_cvt_pk_bf16_f32 v48,v16,v17
v_cvt_pk_bf16_f32 v49,v18,v19
v_exp_f32 v20,v20
v_exp_f32 v21,v21
v_exp_f32 v22,v22
v_exp_f32 v23,v23
v_cvt_pk_bf16_f32 v50,v20,v21
v_cvt_pk_bf16_f32 v51,v22,v23
v_exp_f32 v24,v24
v_exp_f32 v25,v25
v_exp_f32 v26,v26
v_exp_f32 v27,v27
v_cvt_pk_bf16_f32 v52,v24,v25
v_cvt_pk_bf16_f32 v53,v26,v27
v_exp_f32 v28,v28
v_exp_f32 v29,v29
v_exp_f32 v30,v30
v_exp_f32 v31,v31
v_cvt_pk_bf16_f32 v54,v28,v29
v_cvt_pk_bf16_f32 v55,v30,v31
s_nop 1
v_mfma_f32_32x32x16_bf16 v[136:151],a[8:11],v[48:51],v[136:151]
s_nop 0
v_mfma_f32_32x32x16_bf16 v[136:151],a[12:15],v[52:55],v[136:151]
s_sub_u32 s39,s39,1
s_cmp_lg_u32 s39,0
s_cbranch_scc1 att3_f2_1
s_nop 11
s_branch att3_ok1
att3_fb2:
s_waitcnt vmcnt(0)
v_mov_b32 v85,0
v_mov_b32 v8,v6
s_mov_b32 s41,s36
s_mov_b32 s39,64
att3_f1_2:
buffer_load_dwordx4 a[0:3],v2,s[8:11],s41 offen
buffer_load_dword a4,v7,s[52:55],s41 offen offset:3072
buffer_load_dwordx4 a[8:11],v248,s[8:11],s41 offen offset:1024
buffer_load_dwordx4 a[12:15],v248,s[8:11],s41 offen offset:2048
s_add_u32 s41,s41,4096
s_waitcnt vmcnt(0)
v_mfma_f32_32x32x16_bf16 v[16:31],a[0:3],v[80:83],0
s_nop 0
v_mfma_f32_32x32x16_bf16 v[16:31],a[4:7],v[84:87],v[16:31]
s_nop 11
v_max3_f32 v8,v8,v16,v17
v_max3_f32 v8,v8,v18,v19
v_max3_f32 v8,v8,v20,v21
v_max3_f32 v8,v8,v22,v23
v_max3_f32 v8,v8,v24,v25
v_max3_f32 v8,v8,v26,v27
v_max3_f32 v8,v8,v28,v29
v_max3_f32 v8,v8,v30,v31
s_sub_u32 s39,s39,1
s_cmp_lg_u32 s39,0
s_cbranch_scc1 att3_f1_2
v_mov_b32 v12,v8
s_nop 1
v_permlane32_swap_b32 v8,v12
v_max_f32 v8,v8,v12
v_sub_f32_e64 v10,0,v8
v_cvt_pk_bf16_f32 v10,v10,0
v_cndmask_b32 v85,v10,0,s[96:97]
v_mov_b32 v152,0
v_mov_b32 v153,0
v_mov_b32 v154,0
v_mov_b32 v155,0
v_mov_b32 v156,0
v_mov_b32 v157,0
v_mov_b32 v158,0
v_mov_b32 v159,0
v_mov_b32 v160,0
v_mov_b32 v161,0
v_mov_b32 v162,0
v_mov_b32 v163,0
v_mov_b32 v164,0
v_mov_b32 v165,0
v_mov_b32 v166,0
v_mov_b32 v167,0
s_mov_b32 s41,s36
s_mov_b32 s39,64
att3_f2_2:
buffer_load_dwordx4 a[0:3],v2,s[8:11],s41 offen
buffer_load_dword a4,v7,s[52:55],s41 offen offset:3072
buffer_load_dwordx4 a[8:11],v248,s[8:11],s41 offen offset:1024
buffer_load_dwordx4 a[12:15],v248,s[8:11],s41 offen offset:2048
s_add_u32 s41,s41,4096
s_waitcnt vmcnt(0)
v_mfma_f32_32x32x16_bf16 v[16:31],a[0:3],v[80:83],0
s_nop 0
v_mfma_f32_32x32x16_bf16 v[16:31],a[4:7],v[84:87],v[16:31]
s_nop 11
v_exp_f32 v16,v16
v_exp_f32 v17,v17
v_exp_f32 v18,v18
v_exp_f32_e64 v19,v19
v_cvt_pk_bf16_f32 v48,v16,v17
v_cvt_pk_bf16_f32 v49,v18,v19
v_exp_f32 v20,v20
v_exp_f32 v21,v21
v_exp_f32 v22,v22
v_exp_f32 v23,v23
v_cvt_pk_bf16_f32 v50,v20,v21
v_cvt_pk_bf16_f32 v51,v22,v23
v_exp_f32 v24,v24
v_exp_f32 v25,v25
v_exp_f32 v26,v26
v_exp_f32 v27,v27
v_cvt_pk_bf16_f32 v52,v24,v25
v_cvt_pk_bf16_f32 v53,v26,v27
v_exp_f32 v28,v28
v_exp_f32 v29,v29
v_exp_f32 v30,v30
v_exp_f32 v31,v31
v_cvt_pk_bf16_f32 v54,v28,v29
v_cvt_pk_bf16_f32 v55,v30,v31
s_nop 1
v_mfma_f32_32x32x16_bf16 v[152:167],a[8:11],v[48:51],v[152:167]
s_nop 0
v_mfma_f32_32x32x16_bf16 v[152:167],a[12:15],v[52:55],v[152:167]
s_sub_u32 s39,s39,1
s_cmp_lg_u32 s39,0
s_cbranch_scc1 att3_f2_2
s_nop 11
s_branch att3_ok2
att4_fb0:
s_waitcnt vmcnt(0)
v_mov_b32 v69,0
v_mov_b32 v8,v6
s_mov_b32 s41,s36
s_mov_b32 s39,64
att4_f1_0:
buffer_load_dwordx4 a[0:3],v2,s[8:11],s41 offen
buffer_load_dword a4,v7,s[52:55],s41 offen offset:3072
buffer_load_dwordx4 a[8:11],v248,s[8:11],s41 offen offset:1024
buffer_load_dwordx4 a[12:15],v248,s[8:11],s41 offen offset:2048
s_add_u32 s41,s41,4096
s_waitcnt vmcnt(0)
v_mfma_f32_32x32x16_bf16 v[16:31],a[0:3],v[64:67],0
s_nop 0
v_mfma_f32_32x32x16_bf16 v[16:31],a[4:7],v[68:71],v[16:31]
s_nop 11
v_max3_f32 v8,v8,v16,v17
v_max3_f32 v8,v8,v18,v19
v_max3_f32 v8,v8,v20,v21
v_max3_f32 v8,v8,v22,v23
v_max3_f32 v8,v8,v24,v25
v_max3_f32 v8,v8,v26,v27
v_max3_f32 v8,v8,v28,v29
v_max3_f32 v8,v8,v30,v31
s_sub_u32 s39,s39,1
s_cmp_lg_u32 s39,0
s_cbranch_scc1 att4_f1_0
v_mov_b32 v12,v8
s_nop 1
v_permlane32_swap_b32 v8,v12
v_max_f32 v8,v8,v12
v_sub_f32_e64 v10,0,v8
v_cvt_pk_bf16_f32 v10,v10,0
v_cndmask_b32 v69,v10,0,s[96:97]
v_mov_b32 v120,0
v_mov_b32 v121,0
v_mov_b32 v122,0
v_mov_b32 v123,0
v_mov_b32 v124,0
v_mov_b32 v125,0
v_mov_b32 v126,0
v_mov_b32 v127,0
v_mov_b32 v128,0
v_mov_b32 v129,0
v_mov_b32 v130,0
v_mov_b32 v131,0
v_mov_b32 v132,0
v_mov_b32 v133,0
v_mov_b32 v134,0
v_mov_b32 v135,0
s_mov_b32 s41,s36
s_mov_b32 s39,64
att4_f2_0:
buffer_load_dwordx4 a[0:3],v2,s[8:11],s41 offen
buffer_load_dword a4,v7,s[52:55],s41 offen offset:3072
buffer_load_dwordx4 a[8:11],v248,s[8:11],s41 offen offset:1024
buffer_load_dwordx4 a[12:15],v248,s[8:11],s41 offen offset:2048
s_add_u32 s41,s41,4096
s_waitcnt vmcnt(0)
v_mfma_f32_32x32x16_bf16 v[16:31],a[0:3],v[64:67],0
s_nop 0
v_mfma_f32_32x32x16_bf16 v[16:31],a[4:7],v[68:71],v[16:31]
s_nop 11
v_exp_f32 v16,v16
v_exp_f32 v17,v17
v_exp_f32 v18,v18
v_exp_f32_e64 v19,v19
v_cvt_pk_bf16_f32 v48,v16,v17
v_cvt_pk_bf16_f32 v49,v18,v19
v_exp_f32 v20,v20
v_exp_f32 v21,v21
v_exp_f32 v22,v22
v_exp_f32 v23,v23
v_cvt_pk_bf16_f32 v50,v20,v21
v_cvt_pk_bf16_f32 v51,v22,v23
v_exp_f32 v24,v24
v_exp_f32 v25,v25
v_exp_f32 v26,v26
v_exp_f32 v27,v27
v_cvt_pk_bf16_f32 v52,v24,v25
v_cvt_pk_bf16_f32 v53,v26,v27
v_exp_f32 v28,v28
v_exp_f32 v29,v29
v_exp_f32 v30,v30
v_exp_f32 v31,v31
v_cvt_pk_bf16_f32 v54,v28,v29
v_cvt_pk_bf16_f32 v55,v30,v31
s_nop 1
v_mfma_f32_32x32x16_bf16 v[120:135],a[8:11],v[48:51],v[120:135]
s_nop 0
v_mfma_f32_32x32x16_bf16 v[120:135],a[12:15],v[52:55],v[120:135]
s_sub_u32 s39,s39,1
s_cmp_lg_u32 s39,0
s_cbranch_scc1 att4_f2_0
s_nop 11
s_branch att4_ok0
att4_fb1:
s_waitcnt vmcnt(0)
v_mov_b32 v77,0
v_mov_b32 v8,v6
s_mov_b32 s41,s36
s_mov_b32 s39,64
att4_f1_1:
buffer_load_dwordx4 a[0:3],v2,s[8:11],s41 offen
buffer_load_dword a4,v7,s[52:55],s41 offen offset:3072
buffer_load_dwordx4 a[8:11],v248,s[8:11],s41 offen offset:1024
buffer_load_dwordx4 a[12:15],v248,s[8:11],s41 offen offset:2048
s_add_u32 s41,s41,4096
s_waitcnt vmcnt(0)
v_mfma_f32_32x32x16_bf16 v[16:31],a[0:3],v[72:75],0
s_nop 0
v_mfma_f32_32x32x16_bf16 v[16:31],a[4:7],v[76:79],v[16:31]
s_nop 11
v_max3_f32 v8,v8,v16,v17
v_max3_f32 v8,v8,v18,v19
v_max3_f32 v8,v8,v20,v21
v_max3_f32 v8,v8,v22,v23
v_max3_f32 v8,v8,v24,v25
v_max3_f32 v8,v8,v26,v27
v_max3_f32 v8,v8,v28,v29
v_max3_f32 v8,v8,v30,v31
s_sub_u32 s39,s39,1
s_cmp_lg_u32 s39,0
s_cbranch_scc1 att4_f1_1
v_mov_b32 v12,v8
s_nop 1
v_permlane32_swap_b32 v8,v12
v_max_f32 v8,v8,v12
v_sub_f32_e64 v10,0,v8
v_cvt_pk_bf16_f32 v10,v10,0
v_cndmask_b32 v77,v10,0,s[96:97]
v_mov_b32 v136,0
v_mov_b32 v137,0
v_mov_b32 v138,0
v_mov_b32 v139,0
v_mov_b32 v140,0
v_mov_b32 v141,0
v_mov_b32 v142,0
v_mov_b32 v143,0
v_mov_b32 v144,0
v_mov_b32 v145,0
v_mov_b32 v146,0
v_mov_b32 v147,0
v_mov_b32 v148,0
v_mov_b32 v149,0
v_mov_b32 v150,0
v_mov_b32 v151,0
s_mov_b32 s41,s36
s_mov_b32 s39,64
att4_f2_1:
buffer_load_dwordx4 a[0:3],v2,s[8:11],s41 offen
buffer_load_dword a4,v7,s[52:55],s41 offen offset:3072
buffer_load_dwordx4 a[8:11],v248,s[8:11],s41 offen offset:1024
buffer_load_dwordx4 a[12:15],v248,s[8:11],s41 offen offset:2048
s_add_u32 s41,s41,4096
s_waitcnt vmcnt(0)
v_mfma_f32_32x32x16_bf16 v[16:31],a[0:3],v[72:75],0
s_nop 0
v_mfma_f32_32x32x16_bf16 v[16:31],a[4:7],v[76:79],v[16:31]
s_nop 11
v_exp_f32 v16,v16
v_exp_f32 v17,v17
v_exp_f32 v18,v18
v_exp_f32_e64 v19,v19
v_cvt_pk_bf16_f32 v48,v16,v17
v_cvt_pk_bf16_f32 v49,v18,v19
v_exp_f32 v20,v20
v_exp_f32 v21,v21
v_exp_f32 v22,v22
v_exp_f32 v23,v23
v_cvt_pk_bf16_f32 v50,v20,v21
v_cvt_pk_bf16_f32 v51,v22,v23
v_exp_f32 v24,v24
v_exp_f32 v25,v25
v_exp_f32 v26,v26
v_exp_f32 v27,v27
v_cvt_pk_bf16_f32 v52,v24,v25
v_cvt_pk_bf16_f32 v53,v26,v27
v_exp_f32 v28,v28
v_exp_f32 v29,v29
v_exp_f32 v30,v30
v_exp_f32 v31,v31
v_cvt_pk_bf16_f32 v54,v28,v29
v_cvt_pk_bf16_f32 v55,v30,v31
s_nop 1
v_mfma_f32_32x32x16_bf16 v[136:151],a[8:11],v[48:51],v[136:151]
s_nop 0
v_mfma_f32_32x32x16_bf16 v[136:151],a[12:15],v[52:55],v[136:151]
s_sub_u32 s39,s39,1
s_cmp_lg_u32 s39,0
s_cbranch_scc1 att4_f2_1
s_nop 11
s_branch att4_ok1
att4_fb2:
s_waitcnt vmcnt(0)
v_mov_b32 v85,0
v_mov_b32 v8,v6
s_mov_b32 s41,s36
s_mov_b32 s39,64
att4_f1_2:
buffer_load_dwordx4 a[0:3],v2,s[8:11],s41 offen
buffer_load_dword a4,v7,s[52:55],s41 offen offset:3072
buffer_load_dwordx4 a[8:11],v248,s[8:11],s41 offen offset:1024
buffer_load_dwordx4 a[12:15],v248,s[8:11],s41 offen offset:2048
s_add_u32 s41,s41,4096
s_waitcnt vmcnt(0)
v_mfma_f32_32x32x16_bf16 v[16:31],a[0:3],v[80:83],0
s_nop 0
v_mfma_f32_32x32x16_bf16 v[16:31],a[4:7],v[84:87],v[16:31]
s_nop 11
v_max3_f32 v8,v8,v16,v17
v_max3_f32 v8,v8,v18,v19
v_max3_f32 v8,v8,v20,v21
v_max3_f32 v8,v8,v22,v23
v_max3_f32 v8,v8,v24,v25
v_max3_f32 v8,v8,v26,v27
v_max3_f32 v8,v8,v28,v29
v_max3_f32 v8,v8,v30,v31
s_sub_u32 s39,s39,1
s_cmp_lg_u32 s39,0
s_cbranch_scc1 att4_f1_2
v_mov_b32 v12,v8
s_nop 1
v_permlane32_swap_b32 v8,v12
v_max_f32 v8,v8,v12
v_sub_f32_e64 v10,0,v8
v_cvt_pk_bf16_f32 v10,v10,0
v_cndmask_b32 v85,v10,0,s[96:97]
v_mov_b32 v152,0
v_mov_b32 v153,0
v_mov_b32 v154,0
v_mov_b32 v155,0
v_mov_b32 v156,0
v_mov_b32 v157,0
v_mov_b32 v158,0
v_mov_b32 v159,0
v_mov_b32 v160,0
v_mov_b32 v161,0
v_mov_b32 v162,0
v_mov_b32 v163,0
v_mov_b32 v164,0
v_mov_b32 v165,0
v_mov_b32 v166,0
v_mov_b32 v167,0
s_mov_b32 s41,s36
s_mov_b32 s39,64
att4_f2_2:
buffer_load_dwordx4 a[0:3],v2,s[8:11],s41 offen
buffer_load_dword a4,v7,s[52:55],s41 offen offset:3072
buffer_load_dwordx4 a[8:11],v248,s[8:11],s41 offen offset:1024
buffer_load_dwordx4 a[12:15],v248,s[8:11],s41 offen offset:2048
s_add_u32 s41,s41,4096
s_waitcnt vmcnt(0)
v_mfma_f32_32x32x16_bf16 v[16:31],a[0:3],v[80:83],0
s_nop 0
v_mfma_f32_32x32x16_bf16 v[16:31],a[4:7],v[84:87],v[16:31]
s_nop 11
v_exp_f32 v16,v16
v_exp_f32 v17,v17
v_exp_f32 v18,v18
v_exp_f32_e64 v19,v19
v_cvt_pk_bf16_f32 v48,v16,v17
v_cvt_pk_bf16_f32 v49,v18,v19
v_exp_f32 v20,v20
v_exp_f32 v21,v21
v_exp_f32 v22,v22
v_exp_f32 v23,v23
v_cvt_pk_bf16_f32 v50,v20,v21
v_cvt_pk_bf16_f32 v51,v22,v23
v_exp_f32 v24,v24
v_exp_f32 v25,v25
v_exp_f32 v26,v26
v_exp_f32 v27,v27
v_cvt_pk_bf16_f32 v52,v24,v25
v_cvt_pk_bf16_f32 v53,v26,v27
v_exp_f32 v28,v28
v_exp_f32 v29,v29
v_exp_f32 v30,v30
v_exp_f32 v31,v31
v_cvt_pk_bf16_f32 v54,v28,v29
v_cvt_pk_bf16_f32 v55,v30,v31
s_nop 1
v_mfma_f32_32x32x16_bf16 v[152:167],a[8:11],v[48:51],v[152:167]
s_nop 0
v_mfma_f32_32x32x16_bf16 v[152:167],a[12:15],v[52:55],v[152:167]
s_sub_u32 s39,s39,1
s_cmp_lg_u32 s39,0
s_cbranch_scc1 att4_f2_2
s_nop 11
s_branch att4_ok2
att4_fb3:
s_waitcnt vmcnt(0)
v_mov_b32 v93,0
v_mov_b32 v8,v6
s_mov_b32 s41,s36
s_mov_b32 s39,64
att4_f1_3:
buffer_load_dwordx4 a[0:3],v2,s[8:11],s41 offen
buffer_load_dword a4,v7,s[52:55],s41 offen offset:3072
buffer_load_dwordx4 a[8:11],v248,s[8:11],s41 offen offset:1024
buffer_load_dwordx4 a[12:15],v248,s[8:11],s41 offen offset:2048
s_add_u32 s41,s41,4096
s_waitcnt vmcnt(0)
v_mfma_f32_32x32x16_bf16 v[16:31],a[0:3],v[88:91],0
s_nop 0
v_mfma_f32_32x32x16_bf16 v[16:31],a[4:7],v[92:95],v[16:31]
s_nop 11
v_max3_f32 v8,v8,v16,v17
v_max3_f32 v8,v8,v18,v19
v_max3_f32 v8,v8,v20,v21
v_max3_f32 v8,v8,v22,v23
v_max3_f32 v8,v8,v24,v25
v_max3_f32 v8,v8,v26,v27
v_max3_f32 v8,v8,v28,v29
v_max3_f32 v8,v8,v30,v31
s_sub_u32 s39,s39,1
s_cmp_lg_u32 s39,0
s_cbranch_scc1 att4_f1_3
v_mov_b32 v12,v8
s_nop 1
v_permlane32_swap_b32 v8,v12
v_max_f32 v8,v8,v12
v_sub_f32_e64 v10,0,v8
v_cvt_pk_bf16_f32 v10,v10,0
v_cndmask_b32 v93,v10,0,s[96:97]
v_mov_b32 v168,0
v_mov_b32 v169,0
v_mov_b32 v170,0
v_mov_b32 v171,0
v_mov_b32 v172,0
v_mov_b32 v173,0
v_mov_b32 v174,0
v_mov_b32 v175,0
v_mov_b32 v176,0
v_mov_b32 v177,0
v_mov_b32 v178,0
v_mov_b32 v179,0
v_mov_b32 v180,0
v_mov_b32 v181,0
v_mov_b32 v182,0
v_mov_b32 v183,0
s_mov_b32 s41,s36
s_mov_b32 s39,64
att4_f2_3:
buffer_load_dwordx4 a[0:3],v2,s[8:11],s41 offen
buffer_load_dword a4,v7,s[52:55],s41 offen offset:3072
buffer_load_dwordx4 a[8:11],v248,s[8:11],s41 offen offset:1024
buffer_load_dwordx4 a[12:15],v248,s[8:11],s41 offen offset:2048
s_add_u32 s41,s41,4096
s_waitcnt vmcnt(0)
v_mfma_f32_32x32x16_bf16 v[16:31],a[0:3],v[88:91],0
s_nop 0
v_mfma_f32_32x32x16_bf16 v[16:31],a[4:7],v[92:95],v[16:31]
s_nop 11
v_exp_f32 v16,v16
v_exp_f32 v17,v17
v_exp_f32 v18,v18
v_exp_f32_e64 v19,v19
v_cvt_pk_bf16_f32 v48,v16,v17
v_cvt_pk_bf16_f32 v49,v18,v19
v_exp_f32 v20,v20
v_exp_f32 v21,v21
v_exp_f32 v22,v22
v_exp_f32 v23,v23
v_cvt_pk_bf16_f32 v50,v20,v21
v_cvt_pk_bf16_f32 v51,v22,v23
v_exp_f32 v24,v24
v_exp_f32 v25,v25
v_exp_f32 v26,v26
v_exp_f32 v27,v27
v_cvt_pk_bf16_f32 v52,v24,v25
v_cvt_pk_bf16_f32 v53,v26,v27
v_exp_f32 v28,v28
v_exp_f32 v29,v29
v_exp_f32 v30,v30
v_exp_f32 v31,v31
v_cvt_pk_bf16_f32 v54,v28,v29
v_cvt_pk_bf16_f32 v55,v30,v31
s_nop 1
v_mfma_f32_32x32x16_bf16 v[168:183],a[8:11],v[48:51],v[168:183]
s_nop 0
v_mfma_f32_32x32x16_bf16 v[168:183],a[12:15],v[52:55],v[168:183]
s_sub_u32 s39,s39,1
s_cmp_lg_u32 s39,0
s_cbranch_scc1 att4_f2_3
s_nop 11
s_branch att4_ok3
att5_fb0:
s_waitcnt vmcnt(0)
v_mov_b32 v69,0
v_mov_b32 v8,v6
s_mov_b32 s41,s36
s_mov_b32 s39,64
att5_f1_0:
buffer_load_dwordx4 a[0:3],v2,s[8:11],s41 offen
buffer_load_dword a4,v7,s[52:55],s41 offen offset:3072
buffer_load_dwordx4 a[8:11],v248,s[8:11],s41 offen offset:1024
buffer_load_dwordx4 a[12:15],v248,s[8:11],s41 offen offset:2048
s_add_u32 s41,s41,4096
s_waitcnt vmcnt(0)
v_mfma_f32_32x32x16_bf16 v[16:31],a[0:3],v[64:67],0
s_nop 0
v_mfma_f32_32x32x16_bf16 v[16:31],a[4:7],v[68:71],v[16:31]
s_nop 11
v_max3_f32 v8,v8,v16,v17
v_max3_f32 v8,v8,v18,v19
v_max3_f32 v8,v8,v20,v21
v_max3_f32 v8,v8,v22,v23
v_max3_f32 v8,v8,v24,v25
v_max3_f32 v8,v8,v26,v27
v_max3_f32 v8,v8,v28,v29
v_max3_f32 v8,v8,v30,v31
s_sub_u32 s39,s39,1
s_cmp_lg_u32 s39,0
s_cbranch_scc1 att5_f1_0
v_mov_b32 v12,v8
s_nop 1
v_permlane32_swap_b32 v8,v12
v_max_f32 v8,v8,v12
v_sub_f32_e64 v10,0,v8
v_cvt_pk_bf16_f32 v10,v10,0
v_cndmask_b32 v69,v10,0,s[96:97]
v_mov_b32 v120,0
v_mov_b32 v121,0
v_mov_b32 v122,0
v_mov_b32 v123,0
v_mov_b32 v124,0
v_mov_b32 v125,0
v_mov_b32 v126,0
v_mov_b32 v127,0
v_mov_b32 v128,0
v_mov_b32 v129,0
v_mov_b32 v130,0
v_mov_b32 v131,0
v_mov_b32 v132,0
v_mov_b32 v133,0
v_mov_b32 v134,0
v_mov_b32 v135,0
s_mov_b32 s41,s36
s_mov_b32 s39,64
att5_f2_0:
buffer_load_dwordx4 a[0:3],v2,s[8:11],s41 offen
buffer_load_dword a4,v7,s[52:55],s41 offen offset:3072
buffer_load_dwordx4 a[8:11],v248,s[8:11],s41 offen offset:1024
buffer_load_dwordx4 a[12:15],v248,s[8:11],s41 offen offset:2048
s_add_u32 s41,s41,4096
s_waitcnt vmcnt(0)
v_mfma_f32_32x32x16_bf16 v[16:31],a[0:3],v[64:67],0
s_nop 0
v_mfma_f32_32x32x16_bf16 v[16:31],a[4:7],v[68:71],v[16:31]
s_nop 11
v_exp_f32 v16,v16
v_exp_f32 v17,v17
v_exp_f32 v18,v18
v_exp_f32_e64 v19,v19
v_cvt_pk_bf16_f32 v48,v16,v17
v_cvt_pk_bf16_f32 v49,v18,v19
v_exp_f32 v20,v20
v_exp_f32 v21,v21
v_exp_f32 v22,v22
v_exp_f32 v23,v23
v_cvt_pk_bf16_f32 v50,v20,v21
v_cvt_pk_bf16_f32 v51,v22,v23
v_exp_f32 v24,v24
v_exp_f32 v25,v25
v_exp_f32 v26,v26
v_exp_f32 v27,v27
v_cvt_pk_bf16_f32 v52,v24,v25
v_cvt_pk_bf16_f32 v53,v26,v27
v_exp_f32 v28,v28
v_exp_f32 v29,v29
v_exp_f32 v30,v30
v_exp_f32 v31,v31
v_cvt_pk_bf16_f32 v54,v28,v29
v_cvt_pk_bf16_f32 v55,v30,v31
s_nop 1
v_mfma_f32_32x32x16_bf16 v[120:135],a[8:11],v[48:51],v[120:135]
s_nop 0
v_mfma_f32_32x32x16_bf16 v[120:135],a[12:15],v[52:55],v[120:135]
s_sub_u32 s39,s39,1
s_cmp_lg_u32 s39,0
s_cbranch_scc1 att5_f2_0
s_nop 11
s_branch att5_ok0
att5_fb1:
s_waitcnt vmcnt(0)
v_mov_b32 v77,0
v_mov_b32 v8,v6
s_mov_b32 s41,s36
s_mov_b32 s39,64
att5_f1_1:
buffer_load_dwordx4 a[0:3],v2,s[8:11],s41 offen
buffer_load_dword a4,v7,s[52:55],s41 offen offset:3072
buffer_load_dwordx4 a[8:11],v248,s[8:11],s41 offen offset:1024
buffer_load_dwordx4 a[12:15],v248,s[8:11],s41 offen offset:2048
s_add_u32 s41,s41,4096
s_waitcnt vmcnt(0)
v_mfma_f32_32x32x16_bf16 v[16:31],a[0:3],v[72:75],0
s_nop 0
v_mfma_f32_32x32x16_bf16 v[16:31],a[4:7],v[76:79],v[16:31]
s_nop 11
v_max3_f32 v8,v8,v16,v17
v_max3_f32 v8,v8,v18,v19
v_max3_f32 v8,v8,v20,v21
v_max3_f32 v8,v8,v22,v23
v_max3_f32 v8,v8,v24,v25
v_max3_f32 v8,v8,v26,v27
v_max3_f32 v8,v8,v28,v29
v_max3_f32 v8,v8,v30,v31
s_sub_u32 s39,s39,1
s_cmp_lg_u32 s39,0
s_cbranch_scc1 att5_f1_1
v_mov_b32 v12,v8
s_nop 1
v_permlane32_swap_b32 v8,v12
v_max_f32 v8,v8,v12
v_sub_f32_e64 v10,0,v8
v_cvt_pk_bf16_f32 v10,v10,0
v_cndmask_b32 v77,v10,0,s[96:97]
v_mov_b32 v136,0
v_mov_b32 v137,0
v_mov_b32 v138,0
v_mov_b32 v139,0
v_mov_b32 v140,0
v_mov_b32 v141,0
v_mov_b32 v142,0
v_mov_b32 v143,0
v_mov_b32 v144,0
v_mov_b32 v145,0
v_mov_b32 v146,0
v_mov_b32 v147,0
v_mov_b32 v148,0
v_mov_b32 v149,0
v_mov_b32 v150,0
v_mov_b32 v151,0
s_mov_b32 s41,s36
s_mov_b32 s39,64
att5_f2_1:
buffer_load_dwordx4 a[0:3],v2,s[8:11],s41 offen
buffer_load_dword a4,v7,s[52:55],s41 offen offset:3072
buffer_load_dwordx4 a[8:11],v248,s[8:11],s41 offen offset:1024
buffer_load_dwordx4 a[12:15],v248,s[8:11],s41 offen offset:2048
s_add_u32 s41,s41,4096
s_waitcnt vmcnt(0)
v_mfma_f32_32x32x16_bf16 v[16:31],a[0:3],v[72:75],0
s_nop 0
v_mfma_f32_32x32x16_bf16 v[16:31],a[4:7],v[76:79],v[16:31]
s_nop 11
v_exp_f32 v16,v16
v_exp_f32 v17,v17
v_exp_f32 v18,v18
v_exp_f32_e64 v19,v19
v_cvt_pk_bf16_f32 v48,v16,v17
v_cvt_pk_bf16_f32 v49,v18,v19
v_exp_f32 v20,v20
v_exp_f32 v21,v21
v_exp_f32 v22,v22
v_exp_f32 v23,v23
v_cvt_pk_bf16_f32 v50,v20,v21
v_cvt_pk_bf16_f32 v51,v22,v23
v_exp_f32 v24,v24
v_exp_f32 v25,v25
v_exp_f32 v26,v26
v_exp_f32 v27,v27
v_cvt_pk_bf16_f32 v52,v24,v25
v_cvt_pk_bf16_f32 v53,v26,v27
v_exp_f32 v28,v28
v_exp_f32 v29,v29
v_exp_f32 v30,v30
v_exp_f32 v31,v31
v_cvt_pk_bf16_f32 v54,v28,v29
v_cvt_pk_bf16_f32 v55,v30,v31
s_nop 1
v_mfma_f32_32x32x16_bf16 v[136:151],a[8:11],v[48:51],v[136:151]
s_nop 0
v_mfma_f32_32x32x16_bf16 v[136:151],a[12:15],v[52:55],v[136:151]
s_sub_u32 s39,s39,1
s_cmp_lg_u32 s39,0
s_cbranch_scc1 att5_f2_1
s_nop 11
s_branch att5_ok1
att5_fb2:
s_waitcnt vmcnt(0)
v_mov_b32 v85,0
v_mov_b32 v8,v6
s_mov_b32 s41,s36
s_mov_b32 s39,64
att5_f1_2:
buffer_load_dwordx4 a[0:3],v2,s[8:11],s41 offen
buffer_load_dword a4,v7,s[52:55],s41 offen offset:3072
buffer_load_dwordx4 a[8:11],v248,s[8:11],s41 offen offset:1024
buffer_load_dwordx4 a[12:15],v248,s[8:11],s41 offen offset:2048
s_add_u32 s41,s41,4096
s_waitcnt vmcnt(0)
v_mfma_f32_32x32x16_bf16 v[16:31],a[0:3],v[80:83],0
s_nop 0
v_mfma_f32_32x32x16_bf16 v[16:31],a[4:7],v[84:87],v[16:31]
s_nop 11
v_max3_f32 v8,v8,v16,v17
v_max3_f32 v8,v8,v18,v19
v_max3_f32 v8,v8,v20,v21
v_max3_f32 v8,v8,v22,v23
v_max3_f32 v8,v8,v24,v25
v_max3_f32 v8,v8,v26,v27
v_max3_f32 v8,v8,v28,v29
v_max3_f32 v8,v8,v30,v31
s_sub_u32 s39,s39,1
s_cmp_lg_u32 s39,0
s_cbranch_scc1 att5_f1_2
v_mov_b32 v12,v8
s_nop 1
v_permlane32_swap_b32 v8,v12
v_max_f32 v8,v8,v12
v_sub_f32_e64 v10,0,v8
v_cvt_pk_bf16_f32 v10,v10,0
v_cndmask_b32 v85,v10,0,s[96:97]
v_mov_b32 v152,0
v_mov_b32 v153,0
v_mov_b32 v154,0
v_mov_b32 v155,0
v_mov_b32 v156,0
v_mov_b32 v157,0
v_mov_b32 v158,0
v_mov_b32 v159,0
v_mov_b32 v160,0
v_mov_b32 v161,0
v_mov_b32 v162,0
v_mov_b32 v163,0
v_mov_b32 v164,0
v_mov_b32 v165,0
v_mov_b32 v166,0
v_mov_b32 v167,0
s_mov_b32 s41,s36
s_mov_b32 s39,64
att5_f2_2:
buffer_load_dwordx4 a[0:3],v2,s[8:11],s41 offen
buffer_load_dword a4,v7,s[52:55],s41 offen offset:3072
buffer_load_dwordx4 a[8:11],v248,s[8:11],s41 offen offset:1024
buffer_load_dwordx4 a[12:15],v248,s[8:11],s41 offen offset:2048
s_add_u32 s41,s41,4096
s_waitcnt vmcnt(0)
v_mfma_f32_32x32x16_bf16 v[16:31],a[0:3],v[80:83],0
s_nop 0
v_mfma_f32_32x32x16_bf16 v[16:31],a[4:7],v[84:87],v[16:31]
s_nop 11
v_exp_f32 v16,v16
v_exp_f32 v17,v17
v_exp_f32 v18,v18
v_exp_f32_e64 v19,v19
v_cvt_pk_bf16_f32 v48,v16,v17
v_cvt_pk_bf16_f32 v49,v18,v19
v_exp_f32 v20,v20
v_exp_f32 v21,v21
v_exp_f32 v22,v22
v_exp_f32 v23,v23
v_cvt_pk_bf16_f32 v50,v20,v21
v_cvt_pk_bf16_f32 v51,v22,v23
v_exp_f32 v24,v24
v_exp_f32 v25,v25
v_exp_f32 v26,v26
v_exp_f32 v27,v27
v_cvt_pk_bf16_f32 v52,v24,v25
v_cvt_pk_bf16_f32 v53,v26,v27
v_exp_f32 v28,v28
v_exp_f32 v29,v29
v_exp_f32 v30,v30
v_exp_f32 v31,v31
v_cvt_pk_bf16_f32 v54,v28,v29
v_cvt_pk_bf16_f32 v55,v30,v31
s_nop 1
v_mfma_f32_32x32x16_bf16 v[152:167],a[8:11],v[48:51],v[152:167]
s_nop 0
v_mfma_f32_32x32x16_bf16 v[152:167],a[12:15],v[52:55],v[152:167]
s_sub_u32 s39,s39,1
s_cmp_lg_u32 s39,0
s_cbranch_scc1 att5_f2_2
s_nop 11
s_branch att5_ok2
att5_fb3:
s_waitcnt vmcnt(0)
v_mov_b32 v93,0
v_mov_b32 v8,v6
s_mov_b32 s41,s36
s_mov_b32 s39,64
att5_f1_3:
buffer_load_dwordx4 a[0:3],v2,s[8:11],s41 offen
buffer_load_dword a4,v7,s[52:55],s41 offen offset:3072
buffer_load_dwordx4 a[8:11],v248,s[8:11],s41 offen offset:1024
buffer_load_dwordx4 a[12:15],v248,s[8:11],s41 offen offset:2048
s_add_u32 s41,s41,4096
s_waitcnt vmcnt(0)
v_mfma_f32_32x32x16_bf16 v[16:31],a[0:3],v[88:91],0
s_nop 0
v_mfma_f32_32x32x16_bf16 v[16:31],a[4:7],v[92:95],v[16:31]
s_nop 11
v_max3_f32 v8,v8,v16,v17
v_max3_f32 v8,v8,v18,v19
v_max3_f32 v8,v8,v20,v21
v_max3_f32 v8,v8,v22,v23
v_max3_f32 v8,v8,v24,v25
v_max3_f32 v8,v8,v26,v27
v_max3_f32 v8,v8,v28,v29
v_max3_f32 v8,v8,v30,v31
s_sub_u32 s39,s39,1
s_cmp_lg_u32 s39,0
s_cbranch_scc1 att5_f1_3
v_mov_b32 v12,v8
s_nop 1
v_permlane32_swap_b32 v8,v12
v_max_f32 v8,v8,v12
v_sub_f32_e64 v10,0,v8
v_cvt_pk_bf16_f32 v10,v10,0
v_cndmask_b32 v93,v10,0,s[96:97]
v_mov_b32 v168,0
v_mov_b32 v169,0
v_mov_b32 v170,0
v_mov_b32 v171,0
v_mov_b32 v172,0
v_mov_b32 v173,0
v_mov_b32 v174,0
v_mov_b32 v175,0
v_mov_b32 v176,0
v_mov_b32 v177,0
v_mov_b32 v178,0
v_mov_b32 v179,0
v_mov_b32 v180,0
v_mov_b32 v181,0
v_mov_b32 v182,0
v_mov_b32 v183,0
s_mov_b32 s41,s36
s_mov_b32 s39,64
att5_f2_3:
buffer_load_dwordx4 a[0:3],v2,s[8:11],s41 offen
buffer_load_dword a4,v7,s[52:55],s41 offen offset:3072
buffer_load_dwordx4 a[8:11],v248,s[8:11],s41 offen offset:1024
buffer_load_dwordx4 a[12:15],v248,s[8:11],s41 offen offset:2048
s_add_u32 s41,s41,4096
s_waitcnt vmcnt(0)
v_mfma_f32_32x32x16_bf16 v[16:31],a[0:3],v[88:91],0
s_nop 0
v_mfma_f32_32x32x16_bf16 v[16:31],a[4:7],v[92:95],v[16:31]
s_nop 11
v_exp_f32 v16,v16
v_exp_f32 v17,v17
v_exp_f32 v18,v18
v_exp_f32_e64 v19,v19
v_cvt_pk_bf16_f32 v48,v16,v17
v_cvt_pk_bf16_f32 v49,v18,v19
v_exp_f32 v20,v20
v_exp_f32 v21,v21
v_exp_f32 v22,v22
v_exp_f32 v23,v23
v_cvt_pk_bf16_f32 v50,v20,v21
v_cvt_pk_bf16_f32 v51,v22,v23
v_exp_f32 v24,v24
v_exp_f32 v25,v25
v_exp_f32 v26,v26
v_exp_f32 v27,v27
v_cvt_pk_bf16_f32 v52,v24,v25
v_cvt_pk_bf16_f32 v53,v26,v27
v_exp_f32 v28,v28
v_exp_f32 v29,v29
v_exp_f32 v30,v30
v_exp_f32 v31,v31
v_cvt_pk_bf16_f32 v54,v28,v29
v_cvt_pk_bf16_f32 v55,v30,v31
s_nop 1
v_mfma_f32_32x32x16_bf16 v[168:183],a[8:11],v[48:51],v[168:183]
s_nop 0
v_mfma_f32_32x32x16_bf16 v[168:183],a[12:15],v[52:55],v[168:183]
s_sub_u32 s39,s39,1
s_cmp_lg_u32 s39,0
s_cbranch_scc1 att5_f2_3
s_nop 11
s_branch att5_ok3
att5_fb4:
s_waitcnt vmcnt(0)
v_mov_b32 v101,0
v_mov_b32 v8,v6
s_mov_b32 s41,s36
s_mov_b32 s39,64
att5_f1_4:
buffer_load_dwordx4 a[0:3],v2,s[8:11],s41 offen
buffer_load_dword a4,v7,s[52:55],s41 offen offset:3072
buffer_load_dwordx4 a[8:11],v248,s[8:11],s41 offen offset:1024
buffer_load_dwordx4 a[12:15],v248,s[8:11],s41 offen offset:2048
s_add_u32 s41,s41,4096
s_waitcnt vmcnt(0)
v_mfma_f32_32x32x16_bf16 v[16:31],a[0:3],v[96:99],0
s_nop 0
v_mfma_f32_32x32x16_bf16 v[16:31],a[4:7],v[100:103],v[16:31]
s_nop 11
v_max3_f32 v8,v8,v16,v17
v_max3_f32 v8,v8,v18,v19
v_max3_f32 v8,v8,v20,v21
v_max3_f32 v8,v8,v22,v23
v_max3_f32 v8,v8,v24,v25
v_max3_f32 v8,v8,v26,v27
v_max3_f32 v8,v8,v28,v29
v_max3_f32 v8,v8,v30,v31
s_sub_u32 s39,s39,1
s_cmp_lg_u32 s39,0
s_cbranch_scc1 att5_f1_4
v_mov_b32 v12,v8
s_nop 1
v_permlane32_swap_b32 v8,v12
v_max_f32 v8,v8,v12
v_sub_f32_e64 v10,0,v8
v_cvt_pk_bf16_f32 v10,v10,0
v_cndmask_b32 v101,v10,0,s[96:97]
v_mov_b32 v184,0
v_mov_b32 v185,0
v_mov_b32 v186,0
v_mov_b32 v187,0
v_mov_b32 v188,0
v_mov_b32 v189,0
v_mov_b32 v190,0
v_mov_b32 v191,0
v_mov_b32 v192,0
v_mov_b32 v193,0
v_mov_b32 v194,0
v_mov_b32 v195,0
v_mov_b32 v196,0
v_mov_b32 v197,0
v_mov_b32 v198,0
v_mov_b32 v199,0
s_mov_b32 s41,s36
s_mov_b32 s39,64
att5_f2_4:
buffer_load_dwordx4 a[0:3],v2,s[8:11],s41 offen
buffer_load_dword a4,v7,s[52:55],s41 offen offset:3072
buffer_load_dwordx4 a[8:11],v248,s[8:11],s41 offen offset:1024
buffer_load_dwordx4 a[12:15],v248,s[8:11],s41 offen offset:2048
s_add_u32 s41,s41,4096
s_waitcnt vmcnt(0)
v_mfma_f32_32x32x16_bf16 v[16:31],a[0:3],v[96:99],0
s_nop 0
v_mfma_f32_32x32x16_bf16 v[16:31],a[4:7],v[100:103],v[16:31]
s_nop 11
v_exp_f32 v16,v16
v_exp_f32 v17,v17
v_exp_f32 v18,v18
v_exp_f32_e64 v19,v19
v_cvt_pk_bf16_f32 v48,v16,v17
v_cvt_pk_bf16_f32 v49,v18,v19
v_exp_f32 v20,v20
v_exp_f32 v21,v21
v_exp_f32 v22,v22
v_exp_f32 v23,v23
v_cvt_pk_bf16_f32 v50,v20,v21
v_cvt_pk_bf16_f32 v51,v22,v23
v_exp_f32 v24,v24
v_exp_f32 v25,v25
v_exp_f32 v26,v26
v_exp_f32 v27,v27
v_cvt_pk_bf16_f32 v52,v24,v25
v_cvt_pk_bf16_f32 v53,v26,v27
v_exp_f32 v28,v28
v_exp_f32 v29,v29
v_exp_f32 v30,v30
v_exp_f32 v31,v31
v_cvt_pk_bf16_f32 v54,v28,v29
v_cvt_pk_bf16_f32 v55,v30,v31
s_nop 1
v_mfma_f32_32x32x16_bf16 v[184:199],a[8:11],v[48:51],v[184:199]
s_nop 0
v_mfma_f32_32x32x16_bf16 v[184:199],a[12:15],v[52:55],v[184:199]
s_sub_u32 s39,s39,1
s_cmp_lg_u32 s39,0
s_cbranch_scc1 att5_f2_4
s_nop 11
s_branch att5_ok4
att7_fb0:
s_waitcnt vmcnt(0)
v_mov_b32 v69,0
v_mov_b32 v8,v6
s_mov_b32 s41,s36
s_mov_b32 s39,64
att7_f1_0:
buffer_load_dwordx4 a[0:3],v2,s[8:11],s41 offen
buffer_load_dword a4,v7,s[52:55],s41 offen offset:3072
buffer_load_dwordx4 a[8:11],v248,s[8:11],s41 offen offset:1024
buffer_load_dwordx4 a[12:15],v248,s[8:11],s41 offen offset:2048
s_add_u32 s41,s41,4096
s_waitcnt vmcnt(0)
v_mfma_f32_32x32x16_bf16 v[16:31],a[0:3],v[64:67],0
s_nop 0
v_mfma_f32_32x32x16_bf16 v[16:31],a[4:7],v[68:71],v[16:31]
s_nop 11
v_max3_f32 v8,v8,v16,v17
v_max3_f32 v8,v8,v18,v19
v_max3_f32 v8,v8,v20,v21
v_max3_f32 v8,v8,v22,v23
v_max3_f32 v8,v8,v24,v25
v_max3_f32 v8,v8,v26,v27
v_max3_f32 v8,v8,v28,v29
v_max3_f32 v8,v8,v30,v31
s_sub_u32 s39,s39,1
s_cmp_lg_u32 s39,0
s_cbranch_scc1 att7_f1_0
v_mov_b32 v12,v8
s_nop 1
v_permlane32_swap_b32 v8,v12
v_max_f32 v8,v8,v12
v_sub_f32_e64 v10,0,v8
v_cvt_pk_bf16_f32 v10,v10,0
v_cndmask_b32 v69,v10,0,s[96:97]
v_mov_b32 v120,0
v_mov_b32 v121,0
v_mov_b32 v122,0
v_mov_b32 v123,0
v_mov_b32 v124,0
v_mov_b32 v125,0
v_mov_b32 v126,0
v_mov_b32 v127,0
v_mov_b32 v128,0
v_mov_b32 v129,0
v_mov_b32 v130,0
v_mov_b32 v131,0
v_mov_b32 v132,0
v_mov_b32 v133,0
v_mov_b32 v134,0
v_mov_b32 v135,0
s_mov_b32 s41,s36
s_mov_b32 s39,64
att7_f2_0:
buffer_load_dwordx4 a[0:3],v2,s[8:11],s41 offen
buffer_load_dword a4,v7,s[52:55],s41 offen offset:3072
buffer_load_dwordx4 a[8:11],v248,s[8:11],s41 offen offset:1024
buffer_load_dwordx4 a[12:15],v248,s[8:11],s41 offen offset:2048
s_add_u32 s41,s41,4096
s_waitcnt vmcnt(0)
v_mfma_f32_32x32x16_bf16 v[16:31],a[0:3],v[64:67],0
s_nop 0
v_mfma_f32_32x32x16_bf16 v[16:31],a[4:7],v[68:71],v[16:31]
s_nop 11
v_exp_f32 v16,v16
v_exp_f32 v17,v17
v_exp_f32 v18,v18
v_exp_f32_e64 v19,v19
v_cvt_pk_bf16_f32 v48,v16,v17
v_cvt_pk_bf16_f32 v49,v18,v19
v_exp_f32 v20,v20
v_exp_f32 v21,v21
v_exp_f32 v22,v22
v_exp_f32 v23,v23
v_cvt_pk_bf16_f32 v50,v20,v21
v_cvt_pk_bf16_f32 v51,v22,v23
v_exp_f32 v24,v24
v_exp_f32 v25,v25
v_exp_f32 v26,v26
v_exp_f32 v27,v27
v_cvt_pk_bf16_f32 v52,v24,v25
v_cvt_pk_bf16_f32 v53,v26,v27
v_exp_f32 v28,v28
v_exp_f32 v29,v29
v_exp_f32 v30,v30
v_exp_f32 v31,v31
v_cvt_pk_bf16_f32 v54,v28,v29
v_cvt_pk_bf16_f32 v55,v30,v31
s_nop 1
v_mfma_f32_32x32x16_bf16 v[120:135],a[8:11],v[48:51],v[120:135]
s_nop 0
v_mfma_f32_32x32x16_bf16 v[120:135],a[12:15],v[52:55],v[120:135]
s_sub_u32 s39,s39,1
s_cmp_lg_u32 s39,0
s_cbranch_scc1 att7_f2_0
s_nop 11
s_branch att7_ok0
att7_fb1:
s_waitcnt vmcnt(0)
v_mov_b32 v77,0
v_mov_b32 v8,v6
s_mov_b32 s41,s36
s_mov_b32 s39,64
att7_f1_1:
buffer_load_dwordx4 a[0:3],v2,s[8:11],s41 offen
buffer_load_dword a4,v7,s[52:55],s41 offen offset:3072
buffer_load_dwordx4 a[8:11],v248,s[8:11],s41 offen offset:1024
buffer_load_dwordx4 a[12:15],v248,s[8:11],s41 offen offset:2048
s_add_u32 s41,s41,4096
s_waitcnt vmcnt(0)
v_mfma_f32_32x32x16_bf16 v[16:31],a[0:3],v[72:75],0
s_nop 0
v_mfma_f32_32x32x16_bf16 v[16:31],a[4:7],v[76:79],v[16:31]
s_nop 11
v_max3_f32 v8,v8,v16,v17
v_max3_f32 v8,v8,v18,v19
v_max3_f32 v8,v8,v20,v21
v_max3_f32 v8,v8,v22,v23
v_max3_f32 v8,v8,v24,v25
v_max3_f32 v8,v8,v26,v27
v_max3_f32 v8,v8,v28,v29
v_max3_f32 v8,v8,v30,v31
s_sub_u32 s39,s39,1
s_cmp_lg_u32 s39,0
s_cbranch_scc1 att7_f1_1
v_mov_b32 v12,v8
s_nop 1
v_permlane32_swap_b32 v8,v12
v_max_f32 v8,v8,v12
v_sub_f32_e64 v10,0,v8
v_cvt_pk_bf16_f32 v10,v10,0
v_cndmask_b32 v77,v10,0,s[96:97]
v_mov_b32 v136,0
v_mov_b32 v137,0
v_mov_b32 v138,0
v_mov_b32 v139,0
v_mov_b32 v140,0
v_mov_b32 v141,0
v_mov_b32 v142,0
v_mov_b32 v143,0
v_mov_b32 v144,0
v_mov_b32 v145,0
v_mov_b32 v146,0
v_mov_b32 v147,0
v_mov_b32 v148,0
v_mov_b32 v149,0
v_mov_b32 v150,0
v_mov_b32 v151,0
s_mov_b32 s41,s36
s_mov_b32 s39,64
att7_f2_1:
buffer_load_dwordx4 a[0:3],v2,s[8:11],s41 offen
buffer_load_dword a4,v7,s[52:55],s41 offen offset:3072
buffer_load_dwordx4 a[8:11],v248,s[8:11],s41 offen offset:1024
buffer_load_dwordx4 a[12:15],v248,s[8:11],s41 offen offset:2048
s_add_u32 s41,s41,4096
s_waitcnt vmcnt(0)
v_mfma_f32_32x32x16_bf16 v[16:31],a[0:3],v[72:75],0
s_nop 0
v_mfma_f32_32x32x16_bf16 v[16:31],a[4:7],v[76:79],v[16:31]
s_nop 11
v_exp_f32 v16,v16
v_exp_f32 v17,v17
v_exp_f32 v18,v18
v_exp_f32_e64 v19,v19
v_cvt_pk_bf16_f32 v48,v16,v17
v_cvt_pk_bf16_f32 v49,v18,v19
v_exp_f32 v20,v20
v_exp_f32 v21,v21
v_exp_f32 v22,v22
v_exp_f32 v23,v23
v_cvt_pk_bf16_f32 v50,v20,v21
v_cvt_pk_bf16_f32 v51,v22,v23
v_exp_f32 v24,v24
v_exp_f32 v25,v25
v_exp_f32 v26,v26
v_exp_f32 v27,v27
v_cvt_pk_bf16_f32 v52,v24,v25
v_cvt_pk_bf16_f32 v53,v26,v27
v_exp_f32 v28,v28
v_exp_f32 v29,v29
v_exp_f32 v30,v30
v_exp_f32 v31,v31
v_cvt_pk_bf16_f32 v54,v28,v29
v_cvt_pk_bf16_f32 v55,v30,v31
s_nop 1
v_mfma_f32_32x32x16_bf16 v[136:151],a[8:11],v[48:51],v[136:151]
s_nop 0
v_mfma_f32_32x32x16_bf16 v[136:151],a[12:15],v[52:55],v[136:151]
s_sub_u32 s39,s39,1
s_cmp_lg_u32 s39,0
s_cbranch_scc1 att7_f2_1
s_nop 11
s_branch att7_ok1
att7_fb2:
s_waitcnt vmcnt(0)
v_mov_b32 v85,0
v_mov_b32 v8,v6
s_mov_b32 s41,s36
s_mov_b32 s39,64
att7_f1_2:
buffer_load_dwordx4 a[0:3],v2,s[8:11],s41 offen
buffer_load_dword a4,v7,s[52:55],s41 offen offset:3072
buffer_load_dwordx4 a[8:11],v248,s[8:11],s41 offen offset:1024
buffer_load_dwordx4 a[12:15],v248,s[8:11],s41 offen offset:2048
s_add_u32 s41,s41,4096
s_waitcnt vmcnt(0)
v_mfma_f32_32x32x16_bf16 v[16:31],a[0:3],v[80:83],0
s_nop 0
v_mfma_f32_32x32x16_bf16 v[16:31],a[4:7],v[84:87],v[16:31]
s_nop 11
v_max3_f32 v8,v8,v16,v17
v_max3_f32 v8,v8,v18,v19
v_max3_f32 v8,v8,v20,v21
v_max3_f32 v8,v8,v22,v23
v_max3_f32 v8,v8,v24,v25
v_max3_f32 v8,v8,v26,v27
v_max3_f32 v8,v8,v28,v29
v_max3_f32 v8,v8,v30,v31
s_sub_u32 s39,s39,1
s_cmp_lg_u32 s39,0
s_cbranch_scc1 att7_f1_2
v_mov_b32 v12,v8
s_nop 1
v_permlane32_swap_b32 v8,v12
v_max_f32 v8,v8,v12
v_sub_f32_e64 v10,0,v8
v_cvt_pk_bf16_f32 v10,v10,0
v_cndmask_b32 v85,v10,0,s[96:97]
v_mov_b32 v152,0
v_mov_b32 v153,0
v_mov_b32 v154,0
v_mov_b32 v155,0
v_mov_b32 v156,0
v_mov_b32 v157,0
v_mov_b32 v158,0
v_mov_b32 v159,0
v_mov_b32 v160,0
v_mov_b32 v161,0
v_mov_b32 v162,0
v_mov_b32 v163,0
v_mov_b32 v164,0
v_mov_b32 v165,0
v_mov_b32 v166,0
v_mov_b32 v167,0
s_mov_b32 s41,s36
s_mov_b32 s39,64
att7_f2_2:
buffer_load_dwordx4 a[0:3],v2,s[8:11],s41 offen
buffer_load_dword a4,v7,s[52:55],s41 offen offset:3072
buffer_load_dwordx4 a[8:11],v248,s[8:11],s41 offen offset:1024
buffer_load_dwordx4 a[12:15],v248,s[8:11],s41 offen offset:2048
s_add_u32 s41,s41,4096
s_waitcnt vmcnt(0)
v_mfma_f32_32x32x16_bf16 v[16:31],a[0:3],v[80:83],0
s_nop 0
v_mfma_f32_32x32x16_bf16 v[16:31],a[4:7],v[84:87],v[16:31]
s_nop 11
v_exp_f32 v16,v16
v_exp_f32 v17,v17
v_exp_f32 v18,v18
v_exp_f32_e64 v19,v19
v_cvt_pk_bf16_f32 v48,v16,v17
v_cvt_pk_bf16_f32 v49,v18,v19
v_exp_f32 v20,v20
v_exp_f32 v21,v21
v_exp_f32 v22,v22
v_exp_f32 v23,v23
v_cvt_pk_bf16_f32 v50,v20,v21
v_cvt_pk_bf16_f32 v51,v22,v23
v_exp_f32 v24,v24
v_exp_f32 v25,v25
v_exp_f32 v26,v26
v_exp_f32 v27,v27
v_cvt_pk_bf16_f32 v52,v24,v25
v_cvt_pk_bf16_f32 v53,v26,v27
v_exp_f32 v28,v28
v_exp_f32 v29,v29
v_exp_f32 v30,v30
v_exp_f32 v31,v31
v_cvt_pk_bf16_f32 v54,v28,v29
v_cvt_pk_bf16_f32 v55,v30,v31
s_nop 1
v_mfma_f32_32x32x16_bf16 v[152:167],a[8:11],v[48:51],v[152:167]
s_nop 0
v_mfma_f32_32x32x16_bf16 v[152:167],a[12:15],v[52:55],v[152:167]
s_sub_u32 s39,s39,1
s_cmp_lg_u32 s39,0
s_cbranch_scc1 att7_f2_2
s_nop 11
s_branch att7_ok2
att7_fb3:
s_waitcnt vmcnt(0)
v_mov_b32 v93,0
v_mov_b32 v8,v6
s_mov_b32 s41,s36
s_mov_b32 s39,64
att7_f1_3:
buffer_load_dwordx4 a[0:3],v2,s[8:11],s41 offen
buffer_load_dword a4,v7,s[52:55],s41 offen offset:3072
buffer_load_dwordx4 a[8:11],v248,s[8:11],s41 offen offset:1024
buffer_load_dwordx4 a[12:15],v248,s[8:11],s41 offen offset:2048
s_add_u32 s41,s41,4096
s_waitcnt vmcnt(0)
v_mfma_f32_32x32x16_bf16 v[16:31],a[0:3],v[88:91],0
s_nop 0
v_mfma_f32_32x32x16_bf16 v[16:31],a[4:7],v[92:95],v[16:31]
s_nop 11
v_max3_f32 v8,v8,v16,v17
v_max3_f32 v8,v8,v18,v19
v_max3_f32 v8,v8,v20,v21
v_max3_f32 v8,v8,v22,v23
v_max3_f32 v8,v8,v24,v25
v_max3_f32 v8,v8,v26,v27
v_max3_f32 v8,v8,v28,v29
v_max3_f32 v8,v8,v30,v31
s_sub_u32 s39,s39,1
s_cmp_lg_u32 s39,0
s_cbranch_scc1 att7_f1_3
v_mov_b32 v12,v8
s_nop 1
v_permlane32_swap_b32 v8,v12
v_max_f32 v8,v8,v12
v_sub_f32_e64 v10,0,v8
v_cvt_pk_bf16_f32 v10,v10,0
v_cndmask_b32 v93,v10,0,s[96:97]
v_mov_b32 v168,0
v_mov_b32 v169,0
v_mov_b32 v170,0
v_mov_b32 v171,0
v_mov_b32 v172,0
v_mov_b32 v173,0
v_mov_b32 v174,0
v_mov_b32 v175,0
v_mov_b32 v176,0
v_mov_b32 v177,0
v_mov_b32 v178,0
v_mov_b32 v179,0
v_mov_b32 v180,0
v_mov_b32 v181,0
v_mov_b32 v182,0
v_mov_b32 v183,0
s_mov_b32 s41,s36
s_mov_b32 s39,64
att7_f2_3:
buffer_load_dwordx4 a[0:3],v2,s[8:11],s41 offen
buffer_load_dword a4,v7,s[52:55],s41 offen offset:3072
buffer_load_dwordx4 a[8:11],v248,s[8:11],s41 offen offset:1024
buffer_load_dwordx4 a[12:15],v248,s[8:11],s41 offen offset:2048
s_add_u32 s41,s41,4096
s_waitcnt vmcnt(0)
v_mfma_f32_32x32x16_bf16 v[16:31],a[0:3],v[88:91],0
s_nop 0
v_mfma_f32_32x32x16_bf16 v[16:31],a[4:7],v[92:95],v[16:31]
s_nop 11
v_exp_f32 v16,v16
v_exp_f32 v17,v17
v_exp_f32 v18,v18
v_exp_f32_e64 v19,v19
v_cvt_pk_bf16_f32 v48,v16,v17
v_cvt_pk_bf16_f32 v49,v18,v19
v_exp_f32 v20,v20
v_exp_f32 v21,v21
v_exp_f32 v22,v22
v_exp_f32 v23,v23
v_cvt_pk_bf16_f32 v50,v20,v21
v_cvt_pk_bf16_f32 v51,v22,v23
v_exp_f32 v24,v24
v_exp_f32 v25,v25
v_exp_f32 v26,v26
v_exp_f32 v27,v27
v_cvt_pk_bf16_f32 v52,v24,v25
v_cvt_pk_bf16_f32 v53,v26,v27
v_exp_f32 v28,v28
v_exp_f32 v29,v29
v_exp_f32 v30,v30
v_exp_f32 v31,v31
v_cvt_pk_bf16_f32 v54,v28,v29
v_cvt_pk_bf16_f32 v55,v30,v31
s_nop 1
v_mfma_f32_32x32x16_bf16 v[168:183],a[8:11],v[48:51],v[168:183]
s_nop 0
v_mfma_f32_32x32x16_bf16 v[168:183],a[12:15],v[52:55],v[168:183]
s_sub_u32 s39,s39,1
s_cmp_lg_u32 s39,0
s_cbranch_scc1 att7_f2_3
s_nop 11
s_branch att7_ok3
att7_fb4:
s_waitcnt vmcnt(0)
v_mov_b32 v101,0
v_mov_b32 v8,v6
s_mov_b32 s41,s36
s_mov_b32 s39,64
att7_f1_4:
buffer_load_dwordx4 a[0:3],v2,s[8:11],s41 offen
buffer_load_dword a4,v7,s[52:55],s41 offen offset:3072
buffer_load_dwordx4 a[8:11],v248,s[8:11],s41 offen offset:1024
buffer_load_dwordx4 a[12:15],v248,s[8:11],s41 offen offset:2048
s_add_u32 s41,s41,4096
s_waitcnt vmcnt(0)
v_mfma_f32_32x32x16_bf16 v[16:31],a[0:3],v[96:99],0
s_nop 0
v_mfma_f32_32x32x16_bf16 v[16:31],a[4:7],v[100:103],v[16:31]
s_nop 11
v_max3_f32 v8,v8,v16,v17
v_max3_f32 v8,v8,v18,v19
v_max3_f32 v8,v8,v20,v21
v_max3_f32 v8,v8,v22,v23
v_max3_f32 v8,v8,v24,v25
v_max3_f32 v8,v8,v26,v27
v_max3_f32 v8,v8,v28,v29
v_max3_f32 v8,v8,v30,v31
s_sub_u32 s39,s39,1
s_cmp_lg_u32 s39,0
s_cbranch_scc1 att7_f1_4
v_mov_b32 v12,v8
s_nop 1
v_permlane32_swap_b32 v8,v12
v_max_f32 v8,v8,v12
v_sub_f32_e64 v10,0,v8
v_cvt_pk_bf16_f32 v10,v10,0
v_cndmask_b32 v101,v10,0,s[96:97]
v_mov_b32 v184,0
v_mov_b32 v185,0
v_mov_b32 v186,0
v_mov_b32 v187,0
v_mov_b32 v188,0
v_mov_b32 v189,0
v_mov_b32 v190,0
v_mov_b32 v191,0
v_mov_b32 v192,0
v_mov_b32 v193,0
v_mov_b32 v194,0
v_mov_b32 v195,0
v_mov_b32 v196,0
v_mov_b32 v197,0
v_mov_b32 v198,0
v_mov_b32 v199,0
s_mov_b32 s41,s36
s_mov_b32 s39,64
att7_f2_4:
buffer_load_dwordx4 a[0:3],v2,s[8:11],s41 offen
buffer_load_dword a4,v7,s[52:55],s41 offen offset:3072
buffer_load_dwordx4 a[8:11],v248,s[8:11],s41 offen offset:1024
buffer_load_dwordx4 a[12:15],v248,s[8:11],s41 offen offset:2048
s_add_u32 s41,s41,4096
s_waitcnt vmcnt(0)
v_mfma_f32_32x32x16_bf16 v[16:31],a[0:3],v[96:99],0
s_nop 0
v_mfma_f32_32x32x16_bf16 v[16:31],a[4:7],v[100:103],v[16:31]
s_nop 11
v_exp_f32 v16,v16
v_exp_f32 v17,v17
v_exp_f32 v18,v18
v_exp_f32_e64 v19,v19
v_cvt_pk_bf16_f32 v48,v16,v17
v_cvt_pk_bf16_f32 v49,v18,v19
v_exp_f32 v20,v20
v_exp_f32 v21,v21
v_exp_f32 v22,v22
v_exp_f32 v23,v23
v_cvt_pk_bf16_f32 v50,v20,v21
v_cvt_pk_bf16_f32 v51,v22,v23
v_exp_f32 v24,v24
v_exp_f32 v25,v25
v_exp_f32 v26,v26
v_exp_f32 v27,v27
v_cvt_pk_bf16_f32 v52,v24,v25
v_cvt_pk_bf16_f32 v53,v26,v27
v_exp_f32 v28,v28
v_exp_f32 v29,v29
v_exp_f32 v30,v30
v_exp_f32 v31,v31
v_cvt_pk_bf16_f32 v54,v28,v29
v_cvt_pk_bf16_f32 v55,v30,v31
s_nop 1
v_mfma_f32_32x32x16_bf16 v[184:199],a[8:11],v[48:51],v[184:199]
s_nop 0
v_mfma_f32_32x32x16_bf16 v[184:199],a[12:15],v[52:55],v[184:199]
s_sub_u32 s39,s39,1
s_cmp_lg_u32 s39,0
s_cbranch_scc1 att7_f2_4
s_nop 11
s_branch att7_ok4
att7_fb5:
s_waitcnt vmcnt(0)
v_mov_b32 v109,0
v_mov_b32 v8,v6
s_mov_b32 s41,s36
s_mov_b32 s39,64
att7_f1_5:
buffer_load_dwordx4 a[0:3],v2,s[8:11],s41 offen
buffer_load_dword a4,v7,s[52:55],s41 offen offset:3072
buffer_load_dwordx4 a[8:11],v248,s[8:11],s41 offen offset:1024
buffer_load_dwordx4 a[12:15],v248,s[8:11],s41 offen offset:2048
s_add_u32 s41,s41,4096
s_waitcnt vmcnt(0)
v_mfma_f32_32x32x16_bf16 v[16:31],a[0:3],v[104:107],0
s_nop 0
v_mfma_f32_32x32x16_bf16 v[16:31],a[4:7],v[108:111],v[16:31]
s_nop 11
v_max3_f32 v8,v8,v16,v17
v_max3_f32 v8,v8,v18,v19
v_max3_f32 v8,v8,v20,v21
v_max3_f32 v8,v8,v22,v23
v_max3_f32 v8,v8,v24,v25
v_max3_f32 v8,v8,v26,v27
v_max3_f32 v8,v8,v28,v29
v_max3_f32 v8,v8,v30,v31
s_sub_u32 s39,s39,1
s_cmp_lg_u32 s39,0
s_cbranch_scc1 att7_f1_5
v_mov_b32 v12,v8
s_nop 1
v_permlane32_swap_b32 v8,v12
v_max_f32 v8,v8,v12
v_sub_f32_e64 v10,0,v8
v_cvt_pk_bf16_f32 v10,v10,0
v_cndmask_b32 v109,v10,0,s[96:97]
v_mov_b32 v200,0
v_mov_b32 v201,0
v_mov_b32 v202,0
v_mov_b32 v203,0
v_mov_b32 v204,0
v_mov_b32 v205,0
v_mov_b32 v206,0
v_mov_b32 v207,0
v_mov_b32 v208,0
v_mov_b32 v209,0
v_mov_b32 v210,0
v_mov_b32 v211,0
v_mov_b32 v212,0
v_mov_b32 v213,0
v_mov_b32 v214,0
v_mov_b32 v215,0
s_mov_b32 s41,s36
s_mov_b32 s39,64
att7_f2_5:
buffer_load_dwordx4 a[0:3],v2,s[8:11],s41 offen
buffer_load_dword a4,v7,s[52:55],s41 offen offset:3072
buffer_load_dwordx4 a[8:11],v248,s[8:11],s41 offen offset:1024
buffer_load_dwordx4 a[12:15],v248,s[8:11],s41 offen offset:2048
s_add_u32 s41,s41,4096
s_waitcnt vmcnt(0)
v_mfma_f32_32x32x16_bf16 v[16:31],a[0:3],v[104:107],0
s_nop 0
v_mfma_f32_32x32x16_bf16 v[16:31],a[4:7],v[108:111],v[16:31]
s_nop 11
v_exp_f32 v16,v16
v_exp_f32 v17,v17
v_exp_f32 v18,v18
v_exp_f32_e64 v19,v19
v_cvt_pk_bf16_f32 v48,v16,v17
v_cvt_pk_bf16_f32 v49,v18,v19
v_exp_f32 v20,v20
v_exp_f32 v21,v21
v_exp_f32 v22,v22
v_exp_f32 v23,v23
v_cvt_pk_bf16_f32 v50,v20,v21
v_cvt_pk_bf16_f32 v51,v22,v23
v_exp_f32 v24,v24
v_exp_f32 v25,v25
v_exp_f32 v26,v26
v_exp_f32 v27,v27
v_cvt_pk_bf16_f32 v52,v24,v25
v_cvt_pk_bf16_f32 v53,v26,v27
v_exp_f32 v28,v28
v_exp_f32 v29,v29
v_exp_f32 v30,v30
v_exp_f32 v31,v31
v_cvt_pk_bf16_f32 v54,v28,v29
v_cvt_pk_bf16_f32 v55,v30,v31
s_nop 1
v_mfma_f32_32x32x16_bf16 v[200:215],a[8:11],v[48:51],v[200:215]
s_nop 0
v_mfma_f32_32x32x16_bf16 v[200:215],a[12:15],v[52:55],v[200:215]
s_sub_u32 s39,s39,1
s_cmp_lg_u32 s39,0
s_cbranch_scc1 att7_f2_5
s_nop 11
s_branch att7_ok5
att7_fb6:
s_waitcnt vmcnt(0)
v_mov_b32 v117,0
v_mov_b32 v8,v6
s_mov_b32 s41,s36
s_mov_b32 s39,64
att7_f1_6:
buffer_load_dwordx4 a[0:3],v2,s[8:11],s41 offen
buffer_load_dword a4,v7,s[52:55],s41 offen offset:3072
buffer_load_dwordx4 a[8:11],v248,s[8:11],s41 offen offset:1024
buffer_load_dwordx4 a[12:15],v248,s[8:11],s41 offen offset:2048
s_add_u32 s41,s41,4096
s_waitcnt vmcnt(0)
v_mfma_f32_32x32x16_bf16 v[16:31],a[0:3],v[112:115],0
s_nop 0
v_mfma_f32_32x32x16_bf16 v[16:31],a[4:7],v[116:119],v[16:31]
s_nop 11
v_max3_f32 v8,v8,v16,v17
v_max3_f32 v8,v8,v18,v19
v_max3_f32 v8,v8,v20,v21
v_max3_f32 v8,v8,v22,v23
v_max3_f32 v8,v8,v24,v25
v_max3_f32 v8,v8,v26,v27
v_max3_f32 v8,v8,v28,v29
v_max3_f32 v8,v8,v30,v31
s_sub_u32 s39,s39,1
s_cmp_lg_u32 s39,0
s_cbranch_scc1 att7_f1_6
v_mov_b32 v12,v8
s_nop 1
v_permlane32_swap_b32 v8,v12
v_max_f32 v8,v8,v12
v_sub_f32_e64 v10,0,v8
v_cvt_pk_bf16_f32 v10,v10,0
v_cndmask_b32 v117,v10,0,s[96:97]
v_mov_b32 v216,0
v_mov_b32 v217,0
v_mov_b32 v218,0
v_mov_b32 v219,0
v_mov_b32 v220,0
v_mov_b32 v221,0
v_mov_b32 v222,0
v_mov_b32 v223,0
v_mov_b32 v224,0
v_mov_b32 v225,0
v_mov_b32 v226,0
v_mov_b32 v227,0
v_mov_b32 v228,0
v_mov_b32 v229,0
v_mov_b32 v230,0
v_mov_b32 v231,0
s_mov_b32 s41,s36
s_mov_b32 s39,64
att7_f2_6:
buffer_load_dwordx4 a[0:3],v2,s[8:11],s41 offen
buffer_load_dword a4,v7,s[52:55],s41 offen offset:3072
buffer_load_dwordx4 a[8:11],v248,s[8:11],s41 offen offset:1024
buffer_load_dwordx4 a[12:15],v248,s[8:11],s41 offen offset:2048
s_add_u32 s41,s41,4096
s_waitcnt vmcnt(0)
v_mfma_f32_32x32x16_bf16 v[16:31],a[0:3],v[112:115],0
s_nop 0
v_mfma_f32_32x32x16_bf16 v[16:31],a[4:7],v[116:119],v[16:31]
s_nop 11
v_exp_f32 v16,v16
v_exp_f32 v17,v17
v_exp_f32 v18,v18
v_exp_f32_e64 v19,v19
v_cvt_pk_bf16_f32 v48,v16,v17
v_cvt_pk_bf16_f32 v49,v18,v19
v_exp_f32 v20,v20
v_exp_f32 v21,v21
v_exp_f32 v22,v22
v_exp_f32 v23,v23
v_cvt_pk_bf16_f32 v50,v20,v21
v_cvt_pk_bf16_f32 v51,v22,v23
v_exp_f32 v24,v24
v_exp_f32 v25,v25
v_exp_f32 v26,v26
v_exp_f32 v27,v27
v_cvt_pk_bf16_f32 v52,v24,v25
v_cvt_pk_bf16_f32 v53,v26,v27
v_exp_f32 v28,v28
v_exp_f32 v29,v29
v_exp_f32 v30,v30
v_exp_f32 v31,v31
v_cvt_pk_bf16_f32 v54,v28,v29
v_cvt_pk_bf16_f32 v55,v30,v31
s_nop 1
v_mfma_f32_32x32x16_bf16 v[216:231],a[8:11],v[48:51],v[216:231]
s_nop 0
v_mfma_f32_32x32x16_bf16 v[216:231],a[12:15],v[52:55],v[216:231]
s_sub_u32 s39,s39,1
s_cmp_lg_u32 s39,0
s_cbranch_scc1 att7_f2_6
s_nop 11
s_branch att7_ok6
b_m0:
v_cndmask_b32 v16,v16,v6,s[64:65]
v_cndmask_b32 v17,v17,v6,s[66:67]
v_cndmask_b32 v18,v18,v6,s[68:69]
v_cndmask_b32 v19,v19,v6,s[70:71]
v_cndmask_b32 v20,v20,v6,s[72:73]
v_cndmask_b32 v21,v21,v6,s[74:75]
v_cndmask_b32 v22,v22,v6,s[76:77]
v_cndmask_b32 v23,v23,v6,s[78:79]
v_cndmask_b32 v24,v24,v6,s[80:81]
v_cndmask_b32 v25,v25,v6,s[82:83]
v_cndmask_b32 v26,v26,v6,s[84:85]
v_cndmask_b32 v27,v27,v6,s[86:87]
v_cndmask_b32 v28,v28,v6,s[88:89]
v_cndmask_b32 v29,v29,v6,s[90:91]
v_cndmask_b32 v30,v30,v6,s[92:93]
v_cndmask_b32 v31,v31,v6,s[94:95]
s_branch b_m0r
b_m1:
v_cndmask_b32 v16,v16,v6,s[64:65]
v_cndmask_b32 v17,v17,v6,s[66:67]
v_cndmask_b32 v18,v18,v6,s[68:69]
v_cndmask_b32 v19,v19,v6,s[70:71]
v_cndmask_b32 v20,v20,v6,s[72:73]
v_cndmask_b32 v21,v21,v6,s[74:75]
v_cndmask_b32 v22,v22,v6,s[76:77]
v_cndmask_b32 v23,v23,v6,s[78:79]
v_cndmask_b32 v24,v24,v6,s[80:81]
v_cndmask_b32 v25,v25,v6,s[82:83]
v_cndmask_b32 v26,v26,v6,s[84:85]
v_cndmask_b32 v27,v27,v6,s[86:87]
v_cndmask_b32 v28,v28,v6,s[88:89]
v_cndmask_b32 v29,v29,v6,s[90:91]
v_cndmask_b32 v30,v30,v6,s[92:93]
v_cndmask_b32 v31,v31,v6,s[94:95]
s_branch b_m1r
b_fb:
v_mov_b32 v16,0
v_mov_b32 v17,0
v_mov_b32 v18,0
v_mov_b32 v19,0
v_mov_b32 v20,0
v_mov_b32 v21,0
v_mov_b32 v22,0
v_mov_b32 v23,0
v_mov_b32 v24,0
v_mov_b32 v25,0
v_mov_b32 v26,0
v_mov_b32 v27,0
v_mov_b32 v28,0
v_mov_b32 v29,0
v_mov_b32 v30,0
v_mov_b32 v31,0
v_mov_b32 v32,0
v_mov_b32 v33,0
v_mov_b32 v34,0
v_mov_b32 v35,0
v_mov_b32 v36,0
v_mov_b32 v37,0
v_mov_b32 v38,0
v_mov_b32 v39,0
v_mov_b32 v40,0
v_mov_b32 v41,0
v_mov_b32 v42,0
v_mov_b32 v43,0
v_mov_b32 v44,0
v_mov_b32 v45,0
v_mov_b32 v46,0
v_mov_b32 v47,0
v_mov_b32 v10,v6
v_mov_b32_e64 v11,v6
s_mov_b32 s39,0
s_mov_b32 s41,s62
fb1:
buffer_load_dwordx4 a[192:195],v2,s[8:11],s41 offen offset:0
buffer_load_dwordx4 a[196:199],v2,s[8:11],s41 offen offset:1024
buffer_load_dwordx4 a[200:203],v2,s[8:11],s41 offen offset:2048
buffer_load_dwordx4 a[204:207],v2,s[8:11],s41 offen offset:3072
s_add_u32 s41,s41,4096
buffer_load_dwordx4 a[208:211],v2,s[8:11],s41 offen offset:0
buffer_load_dwordx4 a[212:215],v2,s[8:11],s41 offen offset:1024
buffer_load_dwordx4 a[216:219],v2,s[8:11],s41 offen offset:2048
buffer_load_dwordx4 a[220:223],v2,s[8:11],s41 offen offset:3072
s_add_u32 s41,s41,4096
s_add_u32 s41,s41,8192
s_cmp_lg_u32 s39,s61
s_cbranch_scc1 fb1m_a
v_cndmask_b32 v16,v16,v6,s[64:65]
v_cndmask_b32 v17,v17,v6,s[66:67]
v_cndmask_b32 v18,v18,v6,s[68:69]
v_cndmask_b32 v19,v19,v6,s[70:71]
v_cndmask_b32 v20,v20,v6,s[72:73]
v_cndmask_b32 v21,v21,v6,s[74:75]
v_cndmask_b32 v22,v22,v6,s[76:77]
v_cndmask_b32 v23,v23,v6,s[78:79]
v_cndmask_b32 v24,v24,v6,s[80:81]
v_cndmask_b32 v25,v25,v6,s[82:83]
v_cndmask_b32 v26,v26,v6,s[84:85]
v_cndmask_b32 v27,v27,v6,s[86:87]
v_cndmask_b32 v28,v28,v6,s[88:89]
v_cndmask_b32 v29,v29,v6,s[90:91]
v_cndmask_b32 v30,v30,v6,s[92:93]
v_cndmask_b32 v31,v31,v6,s[94:95]
fb1m_a:
s_cmp_le_u32 s39,s61
s_cbranch_scc1 fb1m_b
v_mov_b32 v16,v6
v_mov_b32 v17,v6
v_mov_b32 v18,v6
v_mov_b32 v19,v6
v_mov_b32 v20,v6
v_mov_b32 v21,v6
v_mov_b32 v22,v6
v_mov_b32 v23,v6
v_mov_b32 v24,v6
v_mov_b32 v25,v6
v_mov_b32 v26,v6
v_mov_b32 v27,v6
v_mov_b32 v28,v6
v_mov_b32 v29,v6
v_mov_b32 v30,v6
v_mov_b32 v31,v6
fb1m_b:
s_cmp_lg_u32 s39,s56
s_cbranch_scc1 fb1m_c
v_cndmask_b32 v32,v32,v6,s[64:65]
v_cndmask_b32 v33,v33,v6,s[66:67]
v_cndmask_b32 v34,v34,v6,s[68:69]
v_cndmask_b32 v35,v35,v6,s[70:71]
v_cndmask_b32 v36,v36,v6,s[72:73]
v_cndmask_b32 v37,v37,v6,s[74:75]
v_cndmask_b32 v38,v38,v6,s[76:77]
v_cndmask_b32 v39,v39,v6,s[78:79]
v_cndmask_b32 v40,v40,v6,s[80:81]
v_cndmask_b32 v41,v41,v6,s[82:83]
v_cndmask_b32 v42,v42,v6,s[84:85]
v_cndmask_b32 v43,v43,v6,s[86:87]
v_cndmask_b32 v44,v44,v6,s[88:89]
v_cndmask_b32 v45,v45,v6,s[90:91]
v_cndmask_b32 v46,v46,v6,s[92:93]
v_cndmask_b32 v47,v47,v6,s[94:95]
fb1m_c:
s_nop 1
s_waitcnt vmcnt(0)
v_mfma_f32_32x32x16_bf16 v[48:63],a[192:195],a[128:131],v[16:31]
v_mfma_f32_32x32x16_bf16 v[64:79],a[192:195],a[160:163],v[32:47]
v_mfma_f32_32x32x16_bf16 v[48:63],a[196:199],a[132:135],v[48:63]
v_mfma_f32_32x32x16_bf16 v[64:79],a[196:199],a[164:167],v[64:79]
v_mfma_f32_32x32x16_bf16 v[48:63],a[200:203],a[136:139],v[48:63]
v_mfma_f32_32x32x16_bf16 v[64:79],a[200:203],a[168:171],v[64:79]
v_mfma_f32_32x32x16_bf16 v[48:63],a[204:207],a[140:143],v[48:63]
v_mfma_f32_32x32x16_bf16 v[64:79],a[204:207],a[172:175],v[64:79]
v_mfma_f32_32x32x16_bf16 v[48:63],a[208:211],a[144:147],v[48:63]
v_mfma_f32_32x32x16_bf16 v[64:79],a[208:211],a[176:179],v[64:79]
v_mfma_f32_32x32x16_bf16 v[48:63],a[212:215],a[148:151],v[48:63]
v_mfma_f32_32x32x16_bf16 v[64:79],a[212:215],a[180:183],v[64:79]
v_mfma_f32_32x32x16_bf16 v[48:63],a[216:219],a[152:155],v[48:63]
v_mfma_f32_32x32x16_bf16 v[64:79],a[216:219],a[184:187],v[64:79]
v_mfma_f32_32x32x16_bf16 v[48:63],a[220:223],a[156:159],v[48:63]
v_mfma_f32_32x32x16_bf16 v[64:79],a[220:223],a[188:191],v[64:79]
s_nop 15
v_max3_f32 v10,v10,v48,v49
v_max3_f32 v10,v10,v50,v51
v_max3_f32 v10,v10,v52,v53
v_max3_f32 v10,v10,v54,v55
v_max3_f32 v10,v10,v56,v57
v_max3_f32 v10,v10,v58,v59
v_max3_f32 v10,v10,v60,v61
v_max3_f32 v10,v10,v62,v63
v_max3_f32 v11,v11,v64,v65
v_max3_f32 v11,v11,v66,v67
v_max3_f32 v11,v11,v68,v69
v_max3_f32 v11,v11,v70,v71
v_max3_f32 v11,v11,v72,v73
v_max3_f32 v11,v11,v74,v75
v_max3_f32 v11,v11,v76,v77
v_max3_f32 v11,v11,v78,v79
s_add_u32 s39,s39,1
s_cmp_le_u32 s39,s56
s_cbranch_scc1 fb1
v_mov_b32 v12,v10
s_nop 1
v_permlane32_swap_b32 v10,v12
v_max_f32 v10,v10,v12
v_sub_f32 v16,0,v10
v_sub_f32 v17,0,v10
v_sub_f32 v18,0,v10
v_sub_f32 v19,0,v10
v_sub_f32 v20,0,v10
v_sub_f32 v21,0,v10
v_sub_f32 v22,0,v10
v_sub_f32 v23,0,v10
v_sub_f32 v24,0,v10
v_sub_f32 v25,0,v10
v_sub_f32 v26,0,v10
v_sub_f32 v27,0,v10
v_sub_f32 v28,0,v10
v_sub_f32 v29,0,v10
v_sub_f32 v30,0,v10
v_sub_f32 v31,0,v10
v_mov_b32 v12,v11
s_nop 1
v_permlane32_swap_b32 v11,v12
v_max_f32 v11,v11,v12
v_sub_f32 v32,0,v11
v_sub_f32 v33,0,v11
v_sub_f32 v34,0,v11
v_sub_f32 v35,0,v11
v_sub_f32 v36,0,v11
v_sub_f32 v37,0,v11
v_sub_f32 v38,0,v11
v_sub_f32 v39,0,v11
v_sub_f32 v40,0,v11
v_sub_f32 v41,0,v11
v_sub_f32 v42,0,v11
v_sub_f32 v43,0,v11
v_sub_f32 v44,0,v11
v_sub_f32 v45,0,v11
v_sub_f32 v46,0,v11
v_sub_f32 v47,0,v11
v_accvgpr_write_b32 a0,0
v_mov_b32_e64 v160,0
v_accvgpr_write_b32 a1,0
v_mov_b32_e64 v161,0
v_accvgpr_write_b32 a2,0
v_mov_b32_e64 v162,0
v_accvgpr_write_b32 a3,0
v_mov_b32_e64 v163,0
v_accvgpr_write_b32 a4,0
v_mov_b32_e64 v164,0
v_accvgpr_write_b32 a5,0
v_mov_b32_e64 v165,0
v_accvgpr_write_b32 a6,0
v_mov_b32_e64 v166,0
v_accvgpr_write_b32 a7,0
v_mov_b32_e64 v167,0
v_accvgpr_write_b32 a8,0
v_mov_b32_e64 v168,0
v_accvgpr_write_b32 a9,0
v_mov_b32_e64 v169,0
v_accvgpr_write_b32 a10,0
v_mov_b32_e64 v170,0
v_accvgpr_write_b32 a11,0
v_mov_b32_e64 v171,0
v_accvgpr_write_b32 a12,0
v_mov_b32_e64 v172,0
v_accvgpr_write_b32 a13,0
v_mov_b32_e64 v173,0
v_accvgpr_write_b32 a14,0
v_mov_b32_e64 v174,0
v_accvgpr_write_b32 a15,0
v_mov_b32_e64 v175,0
v_accvgpr_write_b32 a16,0
v_mov_b32_e64 v176,0
v_accvgpr_write_b32 a17,0
v_mov_b32_e64 v177,0
v_accvgpr_write_b32 a18,0
v_mov_b32_e64 v178,0
v_accvgpr_write_b32 a19,0
v_mov_b32_e64 v179,0
v_accvgpr_write_b32 a20,0
v_mov_b32_e64 v180,0
v_accvgpr_write_b32 a21,0
v_mov_b32_e64 v181,0
v_accvgpr_write_b32 a22,0
v_mov_b32_e64 v182,0
v_accvgpr_write_b32 a23,0
v_mov_b32_e64 v183,0
v_accvgpr_write_b32 a24,0
v_mov_b32_e64 v184,0
v_accvgpr_write_b32 a25,0
v_mov_b32_e64 v185,0
v_accvgpr_write_b32 a26,0
v_mov_b32_e64 v186,0
v_accvgpr_write_b32 a27,0
v_mov_b32_e64 v187,0
v_accvgpr_write_b32 a28,0
v_mov_b32_e64 v188,0
v_accvgpr_write_b32 a29,0
v_mov_b32_e64 v189,0
v_accvgpr_write_b32 a30,0
v_mov_b32_e64 v190,0
v_accvgpr_write_b32 a31,0
v_mov_b32_e64 v191,0
v_accvgpr_write_b32 a32,0
v_mov_b32_e64 v192,0
v_accvgpr_write_b32 a33,0
v_mov_b32_e64 v193,0
v_accvgpr_write_b32 a34,0
v_mov_b32_e64 v194,0
v_accvgpr_write_b32 a35,0
v_mov_b32_e64 v195,0
v_accvgpr_write_b32 a36,0
v_mov_b32_e64 v196,0
v_accvgpr_write_b32 a37,0
v_mov_b32_e64 v197,0
v_accvgpr_write_b32 a38,0
v_mov_b32_e64 v198,0
v_accvgpr_write_b32 a39,0
v_mov_b32_e64 v199,0
v_accvgpr_write_b32 a40,0
v_mov_b32_e64 v200,0
v_accvgpr_write_b32 a41,0
v_mov_b32_e64 v201,0
v_accvgpr_write_b32 a42,0
v_mov_b32_e64 v202,0
v_accvgpr_write_b32 a43,0
v_mov_b32_e64 v203,0
v_accvgpr_write_b32 a44,0
v_mov_b32_e64 v204,0
v_accvgpr_write_b32 a45,0
v_mov_b32_e64 v205,0
v_accvgpr_write_b32 a46,0
v_mov_b32_e64 v206,0
v_accvgpr_write_b32 a47,0
v_mov_b32_e64 v207,0
v_accvgpr_write_b32 a48,0
v_mov_b32_e64 v208,0
v_accvgpr_write_b32 a49,0
v_mov_b32_e64 v209,0
v_accvgpr_write_b32 a50,0
v_mov_b32_e64 v210,0
v_accvgpr_write_b32 a51,0
v_mov_b32_e64 v211,0
v_accvgpr_write_b32 a52,0
v_mov_b32_e64 v212,0
v_accvgpr_write_b32 a53,0
v_mov_b32_e64 v213,0
v_accvgpr_write_b32 a54,0
v_mov_b32_e64 v214,0
v_accvgpr_write_b32 a55,0
v_mov_b32_e64 v215,0
v_accvgpr_write_b32 a56,0
v_mov_b32_e64 v216,0
v_accvgpr_write_b32 a57,0
v_mov_b32_e64 v217,0
v_accvgpr_write_b32 a58,0
v_mov_b32_e64 v218,0
v_accvgpr_write_b32 a59,0
v_mov_b32_e64 v219,0
v_accvgpr_write_b32 a60,0
v_mov_b32_e64 v220,0
v_accvgpr_write_b32 a61,0
v_mov_b32_e64 v221,0
v_accvgpr_write_b32 a62,0
v_mov_b32_e64 v222,0
v_accvgpr_write_b32 a63,0
v_mov_b32 v223,0
v_mov_b32 v8,0
v_mov_b32_e64 v9,0
s_mov_b32 s39,0
s_mov_b32 s41,s62
fb2:
buffer_load_dwordx4 a[192:195],v2,s[8:11],s41 offen offset:0
buffer_load_dwordx4 a[196:199],v2,s[8:11],s41 offen offset:1024
buffer_load_dwordx4 a[200:203],v2,s[8:11],s41 offen offset:2048
buffer_load_dwordx4 a[204:207],v2,s[8:11],s41 offen offset:3072
s_add_u32 s41,s41,4096
buffer_load_dwordx4 a[208:211],v2,s[8:11],s41 offen offset:0
buffer_load_dwordx4 a[212:215],v2,s[8:11],s41 offen offset:1024
buffer_load_dwordx4 a[216:219],v2,s[8:11],s41 offen offset:2048
buffer_load_dwordx4 a[220:223],v2,s[8:11],s41 offen offset:3072
s_add_u32 s41,s41,4096
buffer_load_dwordx4 a[224:227],v2,s[8:11],s41 offen offset:0
buffer_load_dwordx4 a[228:231],v2,s[8:11],s41 offen offset:1024
buffer_load_dwordx4 a[232:235],v2,s[8:11],s41 offen offset:2048
buffer_load_dwordx4 a[236:239],v2,s[8:11],s41 offen offset:3072
s_add_u32 s41,s41,4096
buffer_load_dwordx4 a[240:243],v2,s[8:11],s41 offen offset:0
buffer_load_dwordx4 a[244:247],v2,s[8:11],s41 offen offset:1024
buffer_load_dwordx4 a[248:251],v2,s[8:11],s41 offen offset:2048
buffer_load_dwordx4 a[252:255],v2,s[8:11],s41 offen offset:3072
s_add_u32 s41,s41,4096
s_cmp_lg_u32 s39,s61
s_cbranch_scc1 fb2m_a
v_cndmask_b32 v16,v16,v6,s[64:65]
v_cndmask_b32 v17,v17,v6,s[66:67]
v_cndmask_b32 v18,v18,v6,s[68:69]
v_cndmask_b32 v19,v19,v6,s[70:71]
v_cndmask_b32 v20,v20,v6,s[72:73]
v_cndmask_b32 v21,v21,v6,s[74:75]
v_cndmask_b32 v22,v22,v6,s[76:77]
v_cndmask_b32 v23,v23,v6,s[78:79]
v_cndmask_b32 v24,v24,v6,s[80:81]
v_cndmask_b32 v25,v25,v6,s[82:83]
v_cndmask_b32 v26,v26,v6,s[84:85]
v_cndmask_b32 v27,v27,v6,s[86:87]
v_cndmask_b32 v28,v28,v6,s[88:89]
v_cndmask_b32 v29,v29,v6,s[90:91]
v_cndmask_b32 v30,v30,v6,s[92:93]
v_cndmask_b32 v31,v31,v6,s[94:95]
fb2m_a:
s_cmp_le_u32 s39,s61
s_cbranch_scc1 fb2m_b
v_mov_b32 v16,v6
v_mov_b32 v17,v6
v_mov_b32 v18,v6
v_mov_b32 v19,v6
v_mov_b32 v20,v6
v_mov_b32 v21,v6
v_mov_b32 v22,v6
v_mov_b32 v23,v6
v_mov_b32 v24,v6
v_mov_b32 v25,v6
v_mov_b32 v26,v6
v_mov_b32 v27,v6
v_mov_b32 v28,v6
v_mov_b32 v29,v6
v_mov_b32 v30,v6
v_mov_b32 v31,v6
fb2m_b:
s_cmp_lg_u32 s39,s56
s_cbranch_scc1 fb2m_c
v_cndmask_b32 v32,v32,v6,s[64:65]
v_cndmask_b32 v33,v33,v6,s[66:67]
v_cndmask_b32 v34,v34,v6,s[68:69]
v_cndmask_b32 v35,v35,v6,s[70:71]
v_cndmask_b32 v36,v36,v6,s[72:73]
v_cndmask_b32 v37,v37,v6,s[74:75]
v_cndmask_b32 v38,v38,v6,s[76:77]
v_cndmask_b32 v39,v39,v6,s[78:79]
v_cndmask_b32 v40,v40,v6,s[80:81]
v_cndmask_b32 v41,v41,v6,s[82:83]
v_cndmask_b32 v42,v42,v6,s[84:85]
v_cndmask_b32 v43,v43,v6,s[86:87]
v_cndmask_b32 v44,v44,v6,s[88:89]
v_cndmask_b32 v45,v45,v6,s[90:91]
v_cndmask_b32 v46,v46,v6,s[92:93]
v_cndmask_b32 v47,v47,v6,s[94:95]
fb2m_c:
s_nop 1
s_waitcnt vmcnt(0)
v_mfma_f32_32x32x16_bf16 v[48:63],a[192:195],a[128:131],v[16:31]
v_mfma_f32_32x32x16_bf16 v[64:79],a[192:195],a[160:163],v[32:47]
v_mfma_f32_32x32x16_bf16 v[48:63],a[196:199],a[132:135],v[48:63]
v_mfma_f32_32x32x16_bf16 v[64:79],a[196:199],a[164:167],v[64:79]
v_mfma_f32_32x32x16_bf16 v[48:63],a[200:203],a[136:139],v[48:63]
v_mfma_f32_32x32x16_bf16 v[64:79],a[200:203],a[168:171],v[64:79]
v_mfma_f32_32x32x16_bf16 v[48:63],a[204:207],a[140:143],v[48:63]
v_mfma_f32_32x32x16_bf16 v[64:79],a[204:207],a[172:175],v[64:79]
v_mfma_f32_32x32x16_bf16 v[48:63],a[208:211],a[144:147],v[48:63]
v_mfma_f32_32x32x16_bf16 v[64:79],a[208:211],a[176:179],v[64:79]
v_mfma_f32_32x32x16_bf16 v[48:63],a[212:215],a[148:151],v[48:63]
v_mfma_f32_32x32x16_bf16 v[64:79],a[212:215],a[180:183],v[64:79]
v_mfma_f32_32x32x16_bf16 v[48:63],a[216:219],a[152:155],v[48:63]
v_mfma_f32_32x32x16_bf16 v[64:79],a[216:219],a[184:187],v[64:79]
v_mfma_f32_32x32x16_bf16 v[48:63],a[220:223],a[156:159],v[48:63]
v_mfma_f32_32x32x16_bf16 v[64:79],a[220:223],a[188:191],v[64:79]
s_nop 15
v_exp_f32 v48,v48
v_exp_f32 v49,v49
v_add_f32 v8,v48,v8
v_exp_f32 v50,v50
v_add_f32 v8,v49,v8
v_exp_f32 v51,v51
v_add_f32 v8,v50,v8
v_cvt_pk_bf16_f32 v112,v48,v49
v_exp_f32 v52,v52
v_add_f32 v8,v51,v8
v_exp_f32 v53,v53
v_add_f32 v8,v52,v8
v_cvt_pk_bf16_f32 v113,v50,v51
v_exp_f32 v54,v54
v_add_f32 v8,v53,v8
v_exp_f32 v55,v55
v_add_f32 v8,v54,v8
v_cvt_pk_bf16_f32 v114,v52,v53
v_exp_f32 v64,v64
v_add_f32 v8,v55,v8
v_exp_f32 v65,v65
v_add_f32 v9,v64,v9
v_cvt_pk_bf16_f32 v115,v54,v55
v_exp_f32 v66,v66
v_add_f32 v9,v65,v9
v_exp_f32 v67,v67
v_add_f32 v9,v66,v9
v_cvt_pk_bf16_f32 v120,v64,v65
v_exp_f32 v68,v68
v_add_f32 v9,v67,v9
v_exp_f32 v69,v69
v_add_f32 v9,v68,v9
v_cvt_pk_bf16_f32 v121,v66,v67
v_exp_f32 v70,v70
v_add_f32 v9,v69,v9
v_exp_f32 v71,v71
v_add_f32 v9,v70,v9
v_cvt_pk_bf16_f32 v122,v68,v69
v_exp_f32 v56,v56
v_add_f32 v9,v71,v9
v_exp_f32 v57,v57
v_add_f32 v8,v56,v8
v_cvt_pk_bf16_f32 v123,v70,v71
v_exp_f32 v58,v58
v_add_f32 v8,v57,v8
v_exp_f32 v59,v59
v_add_f32 v8,v58,v8
v_cvt_pk_bf16_f32 v116,v56,v57
v_exp_f32 v60,v60
v_add_f32 v8,v59,v8
v_exp_f32 v61,v61
v_add_f32 v8,v60,v8
v_cvt_pk_bf16_f32 v117,v58,v59
v_exp_f32 v62,v62
v_add_f32 v8,v61,v8
v_exp_f32 v63,v63
v_add_f32 v8,v62,v8
v_cvt_pk_bf16_f32 v118,v60,v61
v_exp_f32 v72,v72
v_add_f32 v8,v63,v8
v_exp_f32 v73,v73
v_add_f32 v9,v72,v9
v_cvt_pk_bf16_f32 v119,v62,v63
v_exp_f32 v74,v74
v_add_f32 v9,v73,v9
v_exp_f32 v75,v75
v_add_f32 v9,v74,v9
v_cvt_pk_bf16_f32 v124,v72,v73
v_exp_f32 v76,v76
v_add_f32 v9,v75,v9
v_exp_f32 v77,v77
v_add_f32 v9,v76,v9
v_cvt_pk_bf16_f32 v125,v74,v75
v_exp_f32 v78,v78
v_add_f32 v9,v77,v9
v_exp_f32 v79,v79
v_add_f32 v9,v78,v9
v_cvt_pk_bf16_f32 v126,v76,v77
v_add_f32_e64 v9,v79,v9
v_cvt_pk_bf16_f32 v127,v78,v79
s_nop 1
v_mfma_f32_32x32x16_bf16 a[0:15],a[224:227],v[112:115],a[0:15]
s_nop 0
v_mfma_f32_32x32x16_bf16 v[160:175],a[224:227],v[120:123],v[160:175]
v_mfma_f32_32x32x16_bf16 a[16:31],a[232:235],v[112:115],a[16:31]
v_mfma_f32_32x32x16_bf16 v[176:191],a[232:235],v[120:123],v[176:191]
v_mfma_f32_32x32x16_bf16 a[32:47],a[240:243],v[112:115],a[32:47]
v_mfma_f32_32x32x16_bf16 v[192:207],a[240:243],v[120:123],v[192:207]
v_mfma_f32_32x32x16_bf16 a[48:63],a[248:251],v[112:115],a[48:63]
v_mfma_f32_32x32x16_bf16 v[208:223],a[248:251],v[120:123],v[208:223]
v_mfma_f32_32x32x16_bf16 a[0:15],a[228:231],v[116:119],a[0:15]
v_mfma_f32_32x32x16_bf16 v[160:175],a[228:231],v[124:127],v[160:175]
v_mfma_f32_32x32x16_bf16 a[16:31],a[236:239],v[116:119],a[16:31]
v_mfma_f32_32x32x16_bf16 v[176:191],a[236:239],v[124:127],v[176:191]
v_mfma_f32_32x32x16_bf16 a[32:47],a[244:247],v[116:119],a[32:47]
v_mfma_f32_32x32x16_bf16 v[192:207],a[244:247],v[124:127],v[192:207]
v_mfma_f32_32x32x16_bf16 a[48:63],a[252:255],v[116:119],a[48:63]
v_mfma_f32_32x32x16_bf16 v[208:223],a[252:255],v[124:127],v[208:223]
s_add_u32 s39,s39,1
s_cmp_le_u32 s39,s56
s_cbranch_scc1 fb2
v_mov_b32 v12,v8
s_nop 1
v_permlane32_swap_b32 v8,v12
v_add_f32 v8,v8,v12
v_mov_b32 v12,v9
s_nop 1
v_permlane32_swap_b32 v9,v12
v_add_f32 v9,v9,v12
s_branch b_ok
.globl oproj_kernel
.p2align 8
.type oproj_kernel,@function
oproj_kernel:
s_cmp_ge_u32 s2,256
s_cbranch_scc1 k3_exit
s_load_dwordx4 s[48:51],s[0:1],72
s_load_dwordx2 s[52:53],s[0:1],88
v_and_b32 v1,63,v0
v_lshrrev_b32 v6,6,v0
v_lshlrev_b32 v2,4,v1
s_and_b32 s32,s2,7
s_lshr_b32 s33,s2,3
v_readfirstlane_b32 s28,v6
v_and_b32 v7,31,v1
v_mul_u32_u24 v7,2304,v7
v_lshrrev_b32 v8,5,v1
v_lshlrev_b32 v8,4,v8
v_add_u32_e64 v5,v7,v8
s_and_b32 s31,s32,1
s_lshr_b32 s32,s32,1
s_lshl_b32 s32,s32,2
s_and_b32 s34,s33,3
s_add_u32 s32,s32,s34
s_lshr_b32 s30,s33,2
s_mul_i32 s43,s32,6
s_add_u32 s43,s43,s30
s_lshl_b32 s29,s32,2
s_add_u32 s29,s29,s28
s_mul_i32 s40,s29,73728
s_getpc_b64 s[68:69]
oproj_kernel_pc:
s_lshr_b32 s70,s2,3
s_lshl_b32 s70,s70,2
s_add_u32 s70,s70,s28
s_lshl_b32 s70,s70,10
v_add_u32 v9,s70,v2
v_min_u32 v9,code_end-oproj_kernel_pc-16,v9
v_and_b32 v9,-4,v9
global_load_dwordx4 v[252:255],v9,s[68:69]
s_waitcnt lgkmcnt(0)
s_mov_b32 s8,s52
s_mov_b32 s9,s53
s_mov_b32 s10,268435456
s_mov_b32 s11,0x20000
s_mov_b32 s12,s48
s_mov_b32 s13,s49
s_mov_b32 s14,4718592
s_mov_b32 s15,0x20000
s_mov_b32 s16,s52
s_mov_b32 s17,s53
s_mov_b32 s18,268435456
s_mov_b32 s19,0x20000
s_mov_b32 s20,s52
s_mov_b32 s21,s53
s_mov_b32 s22,268435456
s_mov_b32 s23,0x20000
s_mov_b32 s56,s52
s_mov_b32 s57,s53
s_mov_b32 s58,268435456
s_mov_b32 s59,0x20000
s_mov_b32 s60,s52
s_mov_b32 s61,s53
s_mov_b32 s62,268435456
s_mov_b32 s63,0x20000
s_mov_b32 s64,s52
s_mov_b32 s65,s53
s_mov_b32 s66,268435456
s_mov_b32 s67,0x20000
s_cmp_ge_u32 s30,6
s_cbranch_scc1 k3_A
s_mul_i32 s32,s31,147456
s_cmp_eq_u32 s31,0
s_cselect_b32 s39,9,7
s_lshl_b32 s33,s39,14
s_mul_i32 s35,s29,262144
s_add_u32 s35,s35,s32
s_add_u32 s35,s35,115343360
s_add_u32 s18,s35,s33
s_mul_i32 s36,s30,786432
s_add_u32 s36,s36,s32
s_lshl_b32 s32,s28,10
s_add_u32 s36,s36,s32
s_add_u32 s36,s36,136314880
s_add_u32 s37,s36,262144
s_add_u32 s38,s36,524288
s_sub_u32 s33,s33,3072
s_add_u32 s58,s36,s33
s_add_u32 s62,s37,s33
s_add_u32 s66,s38,s33
s_mul_i32 s32,s30,192
s_add_u32 s40,s40,s32
s_add_u32 s40,s40,1152
s_lshl_b32 s45,s43,2
s_add_u32 s45,s45,s28
s_mul_i32 s45,s45,12288
s_add_u32 s45,s45,90177536
s_add_u32 s46,s45,4096
s_add_u32 s47,s45,8192
s_sub_u32 s39,s39,1
s_cmp_eq_u32 s31,0
s_cselect_b32 s22,268435456,0
s_mul_i32 s41,s28,3072
s_mov_b32 s42,0
v_mov_b32 v3,v2
s_add_u32 m0,s41,0
s_nop 0
buffer_load_dwordx4 v2,s[56:59],s36 offen lds
s_add_u32 s36,s36,4096
s_add_u32 m0,s41,1024
s_nop 0
buffer_load_dwordx4 v2,s[60:63],s37 offen lds
s_add_u32 s37,s37,4096
s_add_u32 m0,s41,2048
s_nop 0
buffer_load_dwordx4 v2,s[64:67],s38 offen lds
s_add_u32 s38,s38,4096
buffer_load_dwordx4 a[0:3],v2,s[16:19],s35 offen offset:0
buffer_load_dwordx4 a[4:7],v2,s[16:19],s35 offen offset:1024
buffer_load_dwordx4 a[8:11],v2,s[16:19],s35 offen offset:2048
buffer_load_dwordx4 a[12:15],v2,s[16:19],s35 offen offset:3072
s_add_u32 s35,s35,4096
s_add_u32 s41,s41,12288
s_cmp_ge_u32 s41,49152
s_cselect_b32 s32,49152,0
s_sub_u32 s41,s41,s32
s_add_u32 m0,s41,0
s_nop 0
buffer_load_dwordx4 v2,s[56:59],s36 offen lds
s_add_u32 s36,s36,4096
s_add_u32 m0,s41,1024
s_nop 0
buffer_load_dwordx4 v2,s[60:63],s37 offen lds
s_add_u32 s37,s37,4096
s_add_u32 m0,s41,2048
s_nop 0
buffer_load_dwordx4 v2,s[64:67],s38 offen lds
s_add_u32 s38,s38,4096
buffer_load_dwordx4 a[16:19],v2,s[16:19],s35 offen offset:0
buffer_load_dwordx4 a[20:23],v2,s[16:19],s35 offen offset:1024
buffer_load_dwordx4 a[24:27],v2,s[16:19],s35 offen offset:2048
buffer_load_dwordx4 a[28:31],v2,s[16:19],s35 offen offset:3072
s_add_u32 s35,s35,4096
s_add_u32 s41,s41,12288
s_cmp_ge_u32 s41,49152
s_cselect_b32 s32,49152,0
s_sub_u32 s41,s41,s32
s_add_u32 m0,s41,0
s_nop 0
buffer_load_dwordx4 v2,s[56:59],s36 offen lds
s_add_u32 s36,s36,4096
s_add_u32 m0,s41,1024
s_nop 0
buffer_load_dwordx4 v2,s[60:63],s37 offen lds
s_add_u32 s37,s37,4096
s_add_u32 m0,s41,2048
s_nop 0
buffer_load_dwordx4 v2,s[64:67],s38 offen lds
s_add_u32 s38,s38,4096
buffer_load_dwordx4 a[32:35],v2,s[16:19],s35 offen offset:0
buffer_load_dwordx4 a[36:39],v2,s[16:19],s35 offen offset:1024
buffer_load_dwordx4 a[40:43],v2,s[16:19],s35 offen offset:2048
buffer_load_dwordx4 a[44:47],v2,s[16:19],s35 offen offset:3072
s_add_u32 s35,s35,4096
s_add_u32 s41,s41,12288
s_cmp_ge_u32 s41,49152
s_cselect_b32 s32,49152,0
s_sub_u32 s41,s41,s32
v_mov_b32 v16,0
v_mov_b32 v17,0
v_mov_b32 v18,0
v_mov_b32 v19,0
v_mov_b32 v20,0
v_mov_b32 v21,0
v_mov_b32 v22,0
v_mov_b32 v23,0
v_mov_b32 v24,0
v_mov_b32 v25,0
v_mov_b32 v26,0
v_mov_b32 v27,0
v_mov_b32 v28,0
v_mov_b32 v29,0
v_mov_b32 v30,0
v_mov_b32 v31,0
v_mov_b32 v32,0
v_mov_b32 v33,0
v_mov_b32 v34,0
v_mov_b32 v35,0
v_mov_b32 v36,0
v_mov_b32 v37,0
v_mov_b32 v38,0
v_mov_b32 v39,0
v_mov_b32 v40,0
v_mov_b32 v41,0
v_mov_b32 v42,0
v_mov_b32 v43,0
v_mov_b32 v44,0
v_mov_b32 v45,0
v_mov_b32 v46,0
v_mov_b32 v47,0
v_mov_b32 v48,0
v_mov_b32 v49,0
v_mov_b32 v50,0
v_mov_b32 v51,0
v_mov_b32 v52,0
v_mov_b32 v53,0
v_mov_b32 v54,0
v_mov_b32 v55,0
v_mov_b32 v56,0
v_mov_b32 v57,0
v_mov_b32 v58,0
v_mov_b32 v59,0
v_mov_b32 v60,0
v_mov_b32 v61,0
v_mov_b32 v62,0
v_mov_b32_e64 v63,0
s_waitcnt vmcnt(14)
s_barrier
ds_read_b128 v[64:67],v3 offset:0
ds_read_b128 v[68:71],v3 offset:1024
ds_read_b128 v[72:75],v3 offset:2048
ds_read_b128 v[76:79],v3 offset:3072
ds_read_b128 v[80:83],v3 offset:4096
ds_read_b128 v[84:87],v3 offset:5120
ds_read_b128 v[88:91],v3 offset:6144
ds_read_b128 v[92:95],v3 offset:7168
ds_read_b128 v[96:99],v3 offset:8192
ds_read_b128 v[100:103],v3 offset:9216
ds_read_b128 v[104:107],v3 offset:10240
ds_read_b128 v[108:111],v3 offset:11264
s_add_u32 m0,s41,0
s_nop 0
buffer_load_dwordx4 v2,s[56:59],s36 offen lds
s_add_u32 s36,s36,4096
s_add_u32 m0,s41,1024
s_nop 0
buffer_load_dwordx4 v2,s[60:63],s37 offen lds
s_add_u32 s37,s37,4096
s_add_u32 m0,s41,2048
s_nop 0
buffer_load_dwordx4 v2,s[64:67],s38 offen lds
s_add_u32 s38,s38,4096
buffer_load_dwordx4 a[48:51],v2,s[16:19],s35 offen offset:0
buffer_load_dwordx4 a[52:55],v2,s[16:19],s35 offen offset:1024
buffer_load_dwordx4 a[56:59],v2,s[16:19],s35 offen offset:2048
buffer_load_dwordx4 a[60:63],v2,s[16:19],s35 offen offset:3072
s_add_u32 s35,s35,4096
s_add_u32 s41,s41,12288
s_cmp_ge_u32 s41,49152
s_cselect_b32 s32,49152,0
s_sub_u32 s41,s41,s32
s_add_u32 s42,s42,12288
s_cmp_ge_u32 s42,49152
s_cselect_b32 s42,0,s42
v_add_u32 v3,s42,v2
s_nop 0
k3b_loop:
s_waitcnt vmcnt(14) lgkmcnt(0)
s_barrier
v_mfma_f32_32x32x16_bf16 v[16:31],v[64:67],a[0:3],v[16:31]
ds_read_b128 v[112:115],v3 offset:0
ds_read_b128 v[116:119],v3 offset:1024
s_add_u32 m0,s41,0
s_nop 0
v_mfma_f32_32x32x16_bf16 v[32:47],v[68:71],a[0:3],v[32:47]
buffer_load_dwordx4 v2,s[56:59],s36 offen lds
ds_read_b128 v[120:123],v3 offset:2048
ds_read_b128 v[124:127],v3 offset:3072
s_add_u32 s36,s36,4096
v_mfma_f32_32x32x16_bf16 v[48:63],v[72:75],a[0:3],v[48:63]
ds_read_b128 v[128:131],v3 offset:4096
ds_read_b128 v[132:135],v3 offset:5120
s_add_u32 m0,s41,1024
v_mfma_f32_32x32x16_bf16 v[16:31],v[76:79],a[4:7],v[16:31]
buffer_load_dwordx4 v2,s[60:63],s37 offen lds
ds_read_b128 v[136:139],v3 offset:6144
ds_read_b128 v[140:143],v3 offset:7168
s_add_u32 s37,s37,4096
v_mfma_f32_32x32x16_bf16 v[32:47],v[80:83],a[4:7],v[32:47]
ds_read_b128 v[144:147],v3 offset:8192
ds_read_b128 v[148:151],v3 offset:9216
s_add_u32 m0,s41,2048
v_mfma_f32_32x32x16_bf16 v[48:63],v[84:87],a[4:7],v[48:63]
buffer_load_dwordx4 v2,s[64:67],s38 offen lds
ds_read_b128 v[152:155],v3 offset:10240
ds_read_b128 v[156:159],v3 offset:11264
s_add_u32 s38,s38,4096
v_mfma_f32_32x32x16_bf16 v[16:31],v[88:91],a[8:11],v[16:31]
buffer_load_dwordx4 a[0:3],v2,s[16:19],s35 offen offset:0
v_mfma_f32_32x32x16_bf16 v[32:47],v[92:95],a[8:11],v[32:47]
s_add_u32 s41,s41,12288
s_cmp_ge_u32 s41,49152
s_cselect_b32 s32,49152,0
s_sub_u32 s41,s41,s32
s_nop 0
v_mfma_f32_32x32x16_bf16 v[48:63],v[96:99],a[8:11],v[48:63]
buffer_load_dwordx4 a[4:7],v2,s[16:19],s35 offen offset:1024
v_mfma_f32_32x32x16_bf16 v[16:31],v[100:103],a[12:15],v[16:31]
s_add_u32 s42,s42,12288
s_cmp_ge_u32 s42,49152
s_cselect_b32 s42,0,s42
v_add_u32 v3,s42,v2
v_mfma_f32_32x32x16_bf16 v[32:47],v[104:107],a[12:15],v[32:47]
buffer_load_dwordx4 a[8:11],v2,s[16:19],s35 offen offset:2048
v_mfma_f32_32x32x16_bf16 v[48:63],v[108:111],a[12:15],v[48:63]
buffer_load_dwordx4 a[12:15],v2,s[16:19],s35 offen offset:3072
s_add_u32 s35,s35,4096
s_waitcnt vmcnt(14) lgkmcnt(0)
s_barrier
v_mfma_f32_32x32x16_bf16 v[16:31],v[112:115],a[16:19],v[16:31]
ds_read_b128 v[64:67],v3 offset:0
ds_read_b128 v[68:71],v3 offset:1024
s_add_u32 m0,s41,0
s_nop 0
v_mfma_f32_32x32x16_bf16 v[32:47],v[116:119],a[16:19],v[32:47]
buffer_load_dwordx4 v2,s[56:59],s36 offen lds
ds_read_b128 v[72:75],v3 offset:2048
ds_read_b128 v[76:79],v3 offset:3072
s_add_u32 s36,s36,4096
v_mfma_f32_32x32x16_bf16 v[48:63],v[120:123],a[16:19],v[48:63]
ds_read_b128 v[80:83],v3 offset:4096
ds_read_b128 v[84:87],v3 offset:5120
s_add_u32 m0,s41,1024
v_mfma_f32_32x32x16_bf16 v[16:31],v[124:127],a[20:23],v[16:31]
buffer_load_dwordx4 v2,s[60:63],s37 offen lds
ds_read_b128 v[88:91],v3 offset:6144
ds_read_b128 v[92:95],v3 offset:7168
s_add_u32 s37,s37,4096
v_mfma_f32_32x32x16_bf16 v[32:47],v[128:131],a[20:23],v[32:47]
ds_read_b128 v[96:99],v3 offset:8192
ds_read_b128 v[100:103],v3 offset:9216
s_add_u32 m0,s41,2048
v_mfma_f32_32x32x16_bf16 v[48:63],v[132:135],a[20:23],v[48:63]
buffer_load_dwordx4 v2,s[64:67],s38 offen lds
ds_read_b128 v[104:107],v3 offset:10240
ds_read_b128 v[108:111],v3 offset:11264
s_add_u32 s38,s38,4096
v_mfma_f32_32x32x16_bf16 v[16:31],v[136:139],a[24:27],v[16:31]
buffer_load_dwordx4 a[16:19],v2,s[16:19],s35 offen offset:0
v_mfma_f32_32x32x16_bf16 v[32:47],v[140:143],a[24:27],v[32:47]
s_add_u32 s41,s41,12288
s_cmp_ge_u32 s41,49152
s_cselect_b32 s32,49152,0
s_sub_u32 s41,s41,s32
s_nop 0
v_mfma_f32_32x32x16_bf16 v[48:63],v[144:147],a[24:27],v[48:63]
buffer_load_dwordx4 a[20:23],v2,s[16:19],s35 offen offset:1024
v_mfma_f32_32x32x16_bf16 v[16:31],v[148:151],a[28:31],v[16:31]
s_add_u32 s42,s42,12288
s_cmp_ge_u32 s42,49152
s_cselect_b32 s42,0,s42
v_add_u32 v3,s42,v2
v_mfma_f32_32x32x16_bf16 v[32:47],v[152:155],a[28:31],v[32:47]
buffer_load_dwordx4 a[24:27],v2,s[16:19],s35 offen offset:2048
v_mfma_f32_32x32x16_bf16 v[48:63],v[156:159],a[28:31],v[48:63]
buffer_load_dwordx4 a[28:31],v2,s[16:19],s35 offen offset:3072
s_add_u32 s35,s35,4096
s_waitcnt vmcnt(14) lgkmcnt(0)
s_barrier
v_mfma_f32_32x32x16_bf16 v[16:31],v[64:67],a[32:35],v[16:31]
ds_read_b128 v[112:115],v3 offset:0
ds_read_b128 v[116:119],v3 offset:1024
s_add_u32 m0,s41,0
s_nop 0
v_mfma_f32_32x32x16_bf16 v[32:47],v[68:71],a[32:35],v[32:47]
buffer_load_dwordx4 v2,s[56:59],s36 offen lds
ds_read_b128 v[120:123],v3 offset:2048
ds_read_b128 v[124:127],v3 offset:3072
s_add_u32 s36,s36,4096
v_mfma_f32_32x32x16_bf16 v[48:63],v[72:75],a[32:35],v[48:63]
ds_read_b128 v[128:131],v3 offset:4096
ds_read_b128 v[132:135],v3 offset:5120
s_add_u32 m0,s41,1024
v_mfma_f32_32x32x16_bf16 v[16:31],v[76:79],a[36:39],v[16:31]
buffer_load_dwordx4 v2,s[60:63],s37 offen lds
ds_read_b128 v[136:139],v3 offset:6144
ds_read_b128 v[140:143],v3 offset:7168
s_add_u32 s37,s37,4096
v_mfma_f32_32x32x16_bf16 v[32:47],v[80:83],a[36:39],v[32:47]
ds_read_b128 v[144:147],v3 offset:8192
ds_read_b128 v[148:151],v3 offset:9216
s_add_u32 m0,s41,2048
v_mfma_f32_32x32x16_bf16 v[48:63],v[84:87],a[36:39],v[48:63]
buffer_load_dwordx4 v2,s[64:67],s38 offen lds
ds_read_b128 v[152:155],v3 offset:10240
ds_read_b128 v[156:159],v3 offset:11264
s_add_u32 s38,s38,4096
v_mfma_f32_32x32x16_bf16 v[16:31],v[88:91],a[40:43],v[16:31]
buffer_load_dwordx4 a[32:35],v2,s[16:19],s35 offen offset:0
v_mfma_f32_32x32x16_bf16 v[32:47],v[92:95],a[40:43],v[32:47]
s_add_u32 s41,s41,12288
s_cmp_ge_u32 s41,49152
s_cselect_b32 s32,49152,0
s_sub_u32 s41,s41,s32
s_nop 0
v_mfma_f32_32x32x16_bf16 v[48:63],v[96:99],a[40:43],v[48:63]
buffer_load_dwordx4 a[36:39],v2,s[16:19],s35 offen offset:1024
v_mfma_f32_32x32x16_bf16 v[16:31],v[100:103],a[44:47],v[16:31]
s_add_u32 s42,s42,12288
s_cmp_ge_u32 s42,49152
s_cselect_b32 s42,0,s42
v_add_u32 v3,s42,v2
v_mfma_f32_32x32x16_bf16 v[32:47],v[104:107],a[44:47],v[32:47]
buffer_load_dwordx4 a[40:43],v2,s[16:19],s35 offen offset:2048
v_mfma_f32_32x32x16_bf16 v[48:63],v[108:111],a[44:47],v[48:63]
buffer_load_dwordx4 a[44:47],v2,s[16:19],s35 offen offset:3072
s_add_u32 s35,s35,4096
s_waitcnt vmcnt(14) lgkmcnt(0)
s_barrier
v_mfma_f32_32x32x16_bf16 v[16:31],v[112:115],a[48:51],v[16:31]
ds_read_b128 v[64:67],v3 offset:0
ds_read_b128 v[68:71],v3 offset:1024
s_add_u32 m0,s41,0
s_nop 0
v_mfma_f32_32x32x16_bf16 v[32:47],v[116:119],a[48:51],v[32:47]
buffer_load_dwordx4 v2,s[56:59],s36 offen lds
ds_read_b128 v[72:75],v3 offset:2048
ds_read_b128 v[76:79],v3 offset:3072
s_add_u32 s36,s36,4096
v_mfma_f32_32x32x16_bf16 v[48:63],v[120:123],a[48:51],v[48:63]
ds_read_b128 v[80:83],v3 offset:4096
ds_read_b128 v[84:87],v3 offset:5120
s_add_u32 m0,s41,1024
v_mfma_f32_32x32x16_bf16 v[16:31],v[124:127],a[52:55],v[16:31]
buffer_load_dwordx4 v2,s[60:63],s37 offen lds
ds_read_b128 v[88:91],v3 offset:6144
ds_read_b128 v[92:95],v3 offset:7168
s_add_u32 s37,s37,4096
v_mfma_f32_32x32x16_bf16 v[32:47],v[128:131],a[52:55],v[32:47]
ds_read_b128 v[96:99],v3 offset:8192
ds_read_b128 v[100:103],v3 offset:9216
s_add_u32 m0,s41,2048
v_mfma_f32_32x32x16_bf16 v[48:63],v[132:135],a[52:55],v[48:63]
buffer_load_dwordx4 v2,s[64:67],s38 offen lds
ds_read_b128 v[104:107],v3 offset:10240
ds_read_b128 v[108:111],v3 offset:11264
s_add_u32 s38,s38,4096
v_mfma_f32_32x32x16_bf16 v[16:31],v[136:139],a[56:59],v[16:31]
buffer_load_dwordx4 a[48:51],v2,s[16:19],s35 offen offset:0
v_mfma_f32_32x32x16_bf16 v[32:47],v[140:143],a[56:59],v[32:47]
s_add_u32 s41,s41,12288
s_cmp_ge_u32 s41,49152
s_cselect_b32 s32,49152,0
s_sub_u32 s41,s41,s32
s_nop 0
v_mfma_f32_32x32x16_bf16 v[48:63],v[144:147],a[56:59],v[48:63]
buffer_load_dwordx4 a[52:55],v2,s[16:19],s35 offen offset:1024
v_mfma_f32_32x32x16_bf16 v[16:31],v[148:151],a[60:63],v[16:31]
s_add_u32 s42,s42,12288
s_cmp_ge_u32 s42,49152
s_cselect_b32 s42,0,s42
v_add_u32 v3,s42,v2
v_mfma_f32_32x32x16_bf16 v[32:47],v[152:155],a[60:63],v[32:47]
buffer_load_dwordx4 a[56:59],v2,s[16:19],s35 offen offset:2048
v_mfma_f32_32x32x16_bf16 v[48:63],v[156:159],a[60:63],v[48:63]
buffer_load_dwordx4 a[60:63],v2,s[16:19],s35 offen offset:3072
s_add_u32 s35,s35,4096
s_sub_u32 s39,s39,1
s_cmp_lg_u32 s39,0
s_cbranch_scc1 k3b_loop
s_waitcnt vmcnt(14) lgkmcnt(0)
s_barrier
v_mfma_f32_32x32x16_bf16 v[16:31],v[64:67],a[0:3],v[16:31]
ds_read_b128 v[112:115],v3 offset:0
ds_read_b128 v[116:119],v3 offset:1024
s_nop 0
v_mfma_f32_32x32x16_bf16 v[32:47],v[68:71],a[0:3],v[32:47]
buffer_load_dwordx4 v[160:163],v2,s[20:23],s45 offen offset:0 sc1
ds_read_b128 v[120:123],v3 offset:2048
ds_read_b128 v[124:127],v3 offset:3072
v_mfma_f32_32x32x16_bf16 v[48:63],v[72:75],a[0:3],v[48:63]
ds_read_b128 v[128:131],v3 offset:4096
ds_read_b128 v[132:135],v3 offset:5120
v_mfma_f32_32x32x16_bf16 v[16:31],v[76:79],a[4:7],v[16:31]
buffer_load_dwordx4 v[164:167],v2,s[20:23],s45 offen offset:1024 sc1
ds_read_b128 v[136:139],v3 offset:6144
ds_read_b128 v[140:143],v3 offset:7168
v_mfma_f32_32x32x16_bf16 v[32:47],v[80:83],a[4:7],v[32:47]
ds_read_b128 v[144:147],v3 offset:8192
ds_read_b128 v[148:151],v3 offset:9216
v_mfma_f32_32x32x16_bf16 v[48:63],v[84:87],a[4:7],v[48:63]
buffer_load_dwordx4 v[168:171],v2,s[20:23],s45 offen offset:2048 sc1
ds_read_b128 v[152:155],v3 offset:10240
ds_read_b128 v[156:159],v3 offset:11264
v_mfma_f32_32x32x16_bf16 v[16:31],v[88:91],a[8:11],v[16:31]
v_mfma_f32_32x32x16_bf16 v[32:47],v[92:95],a[8:11],v[32:47]
v_mfma_f32_32x32x16_bf16 v[48:63],v[96:99],a[8:11],v[48:63]
v_mfma_f32_32x32x16_bf16 v[16:31],v[100:103],a[12:15],v[16:31]
s_add_u32 s42,s42,12288
s_cmp_ge_u32 s42,49152
s_cselect_b32 s42,0,s42
v_add_u32 v3,s42,v2
v_mfma_f32_32x32x16_bf16 v[32:47],v[104:107],a[12:15],v[32:47]
v_mfma_f32_32x32x16_bf16 v[48:63],v[108:111],a[12:15],v[48:63]
s_waitcnt vmcnt(10) lgkmcnt(0)
s_barrier
v_mfma_f32_32x32x16_bf16 v[16:31],v[112:115],a[16:19],v[16:31]
ds_read_b128 v[64:67],v3 offset:0
ds_read_b128 v[68:71],v3 offset:1024
v_mfma_f32_32x32x16_bf16 v[32:47],v[116:119],a[16:19],v[32:47]
buffer_load_dwordx4 v[172:175],v2,s[20:23],s45 offen offset:3072 sc1
ds_read_b128 v[72:75],v3 offset:2048
ds_read_b128 v[76:79],v3 offset:3072
v_mfma_f32_32x32x16_bf16 v[48:63],v[120:123],a[16:19],v[48:63]
ds_read_b128 v[80:83],v3 offset:4096
ds_read_b128 v[84:87],v3 offset:5120
v_mfma_f32_32x32x16_bf16 v[16:31],v[124:127],a[20:23],v[16:31]
buffer_load_dwordx4 v[176:179],v2,s[20:23],s46 offen offset:0 sc1
ds_read_b128 v[88:91],v3 offset:6144
ds_read_b128 v[92:95],v3 offset:7168
v_mfma_f32_32x32x16_bf16 v[32:47],v[128:131],a[20:23],v[32:47]
ds_read_b128 v[96:99],v3 offset:8192
ds_read_b128 v[100:103],v3 offset:9216
v_mfma_f32_32x32x16_bf16 v[48:63],v[132:135],a[20:23],v[48:63]
buffer_load_dwordx4 v[180:183],v2,s[20:23],s46 offen offset:1024 sc1
ds_read_b128 v[104:107],v3 offset:10240
ds_read_b128 v[108:111],v3 offset:11264
v_mfma_f32_32x32x16_bf16 v[16:31],v[136:139],a[24:27],v[16:31]
v_mfma_f32_32x32x16_bf16 v[32:47],v[140:143],a[24:27],v[32:47]
v_mfma_f32_32x32x16_bf16 v[48:63],v[144:147],a[24:27],v[48:63]
v_mfma_f32_32x32x16_bf16 v[16:31],v[148:151],a[28:31],v[16:31]
s_add_u32 s42,s42,12288
s_cmp_ge_u32 s42,49152
s_cselect_b32 s42,0,s42
v_add_u32 v3,s42,v2
v_mfma_f32_32x32x16_bf16 v[32:47],v[152:155],a[28:31],v[32:47]
v_mfma_f32_32x32x16_bf16 v[48:63],v[156:159],a[28:31],v[48:63]
s_waitcnt vmcnt(6) lgkmcnt(0)
s_barrier
v_mfma_f32_32x32x16_bf16 v[16:31],v[64:67],a[32:35],v[16:31]
ds_read_b128 v[112:115],v3 offset:0
ds_read_b128 v[116:119],v3 offset:1024
v_mfma_f32_32x32x16_bf16 v[32:47],v[68:71],a[32:35],v[32:47]
buffer_load_dwordx4 v[184:187],v2,s[20:23],s46 offen offset:2048 sc1
ds_read_b128 v[120:123],v3 offset:2048
ds_read_b128 v[124:127],v3 offset:3072
v_mfma_f32_32x32x16_bf16 v[48:63],v[72:75],a[32:35],v[48:63]
ds_read_b128 v[128:131],v3 offset:4096
ds_read_b128 v[132:135],v3 offset:5120
v_mfma_f32_32x32x16_bf16 v[16:31],v[76:79],a[36:39],v[16:31]
buffer_load_dwordx4 v[188:191],v2,s[20:23],s46 offen offset:3072 sc1
ds_read_b128 v[136:139],v3 offset:6144
ds_read_b128 v[140:143],v3 offset:7168
v_mfma_f32_32x32x16_bf16 v[32:47],v[80:83],a[36:39],v[32:47]
ds_read_b128 v[144:147],v3 offset:8192
ds_read_b128 v[148:151],v3 offset:9216
v_mfma_f32_32x32x16_bf16 v[48:63],v[84:87],a[36:39],v[48:63]
buffer_load_dwordx4 v[192:195],v2,s[20:23],s47 offen offset:0 sc1
ds_read_b128 v[152:155],v3 offset:10240
ds_read_b128 v[156:159],v3 offset:11264
v_mfma_f32_32x32x16_bf16 v[16:31],v[88:91],a[40:43],v[16:31]
v_mfma_f32_32x32x16_bf16 v[32:47],v[92:95],a[40:43],v[32:47]
v_mfma_f32_32x32x16_bf16 v[48:63],v[96:99],a[40:43],v[48:63]
v_mfma_f32_32x32x16_bf16 v[16:31],v[100:103],a[44:47],v[16:31]
s_add_u32 s42,s42,12288
s_cmp_ge_u32 s42,49152
s_cselect_b32 s42,0,s42
v_add_u32 v3,s42,v2
v_mfma_f32_32x32x16_bf16 v[32:47],v[104:107],a[44:47],v[32:47]
v_mfma_f32_32x32x16_bf16 v[48:63],v[108:111],a[44:47],v[48:63]
s_waitcnt vmcnt(9) lgkmcnt(0)
s_barrier
v_mfma_f32_32x32x16_bf16 v[16:31],v[112:115],a[48:51],v[16:31]
ds_read_b128 v[64:67],v3 offset:0
ds_read_b128 v[68:71],v3 offset:1024
v_mfma_f32_32x32x16_bf16 v[32:47],v[116:119],a[48:51],v[32:47]
buffer_load_dwordx4 v[196:199],v2,s[20:23],s47 offen offset:1024 sc1
ds_read_b128 v[72:75],v3 offset:2048
ds_read_b128 v[76:79],v3 offset:3072
v_mfma_f32_32x32x16_bf16 v[48:63],v[120:123],a[48:51],v[48:63]
ds_read_b128 v[80:83],v3 offset:4096
ds_read_b128 v[84:87],v3 offset:5120
v_mfma_f32_32x32x16_bf16 v[16:31],v[124:127],a[52:55],v[16:31]
buffer_load_dwordx4 v[200:203],v2,s[20:23],s47 offen offset:2048 sc1
ds_read_b128 v[88:91],v3 offset:6144
ds_read_b128 v[92:95],v3 offset:7168
v_mfma_f32_32x32x16_bf16 v[32:47],v[128:131],a[52:55],v[32:47]
ds_read_b128 v[96:99],v3 offset:8192
ds_read_b128 v[100:103],v3 offset:9216
v_mfma_f32_32x32x16_bf16 v[48:63],v[132:135],a[52:55],v[48:63]
buffer_load_dwordx4 v[204:207],v2,s[20:23],s47 offen offset:3072 sc1
ds_read_b128 v[104:107],v3 offset:10240
ds_read_b128 v[108:111],v3 offset:11264
v_mfma_f32_32x32x16_bf16 v[16:31],v[136:139],a[56:59],v[16:31]
v_mfma_f32_32x32x16_bf16 v[32:47],v[140:143],a[56:59],v[32:47]
v_mfma_f32_32x32x16_bf16 v[48:63],v[144:147],a[56:59],v[48:63]
v_mfma_f32_32x32x16_bf16 v[16:31],v[148:151],a[60:63],v[16:31]
s_add_u32 s42,s42,12288
s_cmp_ge_u32 s42,49152
s_cselect_b32 s42,0,s42
v_add_u32 v3,s42,v2
v_mfma_f32_32x32x16_bf16 v[32:47],v[152:155],a[60:63],v[32:47]
v_mfma_f32_32x32x16_bf16 v[48:63],v[156:159],a[60:63],v[48:63]
k3b_out:
s_waitcnt lgkmcnt(0)
s_nop 9
s_cmp_eq_u32 s31,0
s_cbranch_scc1 k3_own
buffer_store_dwordx4 v[16:19],v2,s[8:11],s45 offen offset:0 sc1
buffer_store_dwordx4 v[20:23],v2,s[8:11],s45 offen offset:1024 sc1
buffer_store_dwordx4 v[24:27],v2,s[8:11],s45 offen offset:2048 sc1
buffer_store_dwordx4 v[28:31],v2,s[8:11],s45 offen offset:3072 sc1
buffer_store_dwordx4 v[32:35],v2,s[8:11],s46 offen offset:0 sc1
buffer_store_dwordx4 v[36:39],v2,s[8:11],s46 offen offset:1024 sc1
buffer_store_dwordx4 v[40:43],v2,s[8:11],s46 offen offset:2048 sc1
buffer_store_dwordx4 v[44:47],v2,s[8:11],s46 offen offset:3072 sc1
buffer_store_dwordx4 v[48:51],v2,s[8:11],s47 offen offset:0 sc1
buffer_store_dwordx4 v[52:55],v2,s[8:11],s47 offen offset:1024 sc1
buffer_store_dwordx4 v[56:59],v2,s[8:11],s47 offen offset:2048 sc1
buffer_store_dwordx4 v[60:63],v2,s[8:11],s47 offen offset:3072 sc1
s_branch k3_end
k3_own:
s_mov_b32 s39,0x40000
s_branch k3_chk
k3_poll:
buffer_load_dwordx4 v[160:163],v2,s[20:23],s45 offen offset:0 sc1
buffer_load_dwordx4 v[164:167],v2,s[20:23],s45 offen offset:1024 sc1
buffer_load_dwordx4 v[168:171],v2,s[20:23],s45 offen offset:2048 sc1
buffer_load_dwordx4 v[172:175],v2,s[20:23],s45 offen offset:3072 sc1
buffer_load_dwordx4 v[176:179],v2,s[20:23],s46 offen offset:0 sc1
buffer_load_dwordx4 v[180:183],v2,s[20:23],s46 offen offset:1024 sc1
buffer_load_dwordx4 v[184:187],v2,s[20:23],s46 offen offset:2048 sc1
buffer_load_dwordx4 v[188:191],v2,s[20:23],s46 offen offset:3072 sc1
buffer_load_dwordx4 v[192:195],v2,s[20:23],s47 offen offset:0 sc1
buffer_load_dwordx4 v[196:199],v2,s[20:23],s47 offen offset:1024 sc1
buffer_load_dwordx4 v[200:203],v2,s[20:23],s47 offen offset:2048 sc1
buffer_load_dwordx4 v[204:207],v2,s[20:23],s47 offen offset:3072 sc1
k3_chk:
s_sub_u32 s39,s39,1
s_cbranch_scc1 k3_got
s_waitcnt vmcnt(0)
v_max_u32 v6,v160,v161
v_max3_u32 v6,v6,v162,v163
v_max3_u32 v6,v6,v164,v165
v_max3_u32 v6,v6,v166,v167
v_max3_u32 v6,v6,v168,v169
v_max3_u32 v6,v6,v170,v171
v_max3_u32 v6,v6,v172,v173
v_max3_u32 v6,v6,v174,v175
v_max3_u32 v6,v6,v176,v177
v_max3_u32 v6,v6,v178,v179
v_max3_u32 v6,v6,v180,v181
v_max3_u32 v6,v6,v182,v183
v_max3_u32 v6,v6,v184,v185
v_max3_u32 v6,v6,v186,v187
v_max3_u32 v6,v6,v188,v189
v_max3_u32 v6,v6,v190,v191
v_max3_u32 v6,v6,v192,v193
v_max3_u32 v6,v6,v194,v195
v_max3_u32 v6,v6,v196,v197
v_max3_u32 v6,v6,v198,v199
v_max3_u32 v6,v6,v200,v201
v_max3_u32 v6,v6,v202,v203
v_max3_u32 v6,v6,v204,v205
v_max3_u32 v6,v6,v206,v207
v_cmp_eq_u32 vcc,-1,v6
s_cmp_lg_u64 vcc,0
s_cbranch_scc1 k3_poll
k3_got:
s_waitcnt vmcnt(0)
v_add_f32 v16,v16,v160
v_add_f32 v17,v17,v161
v_add_f32 v18,v18,v162
v_add_f32 v19,v19,v163
v_add_f32 v20,v20,v164
v_add_f32 v21,v21,v165
v_add_f32 v22,v22,v166
v_add_f32 v23,v23,v167
v_add_f32 v24,v24,v168
v_add_f32 v25,v25,v169
v_add_f32 v26,v26,v170
v_add_f32 v27,v27,v171
v_add_f32 v28,v28,v172
v_add_f32 v29,v29,v173
v_add_f32 v30,v30,v174
v_add_f32 v31,v31,v175
v_cvt_pk_bf16_f32 v208,v16,v17
v_cvt_pk_bf16_f32 v209,v18,v19
v_cvt_pk_bf16_f32 v210,v20,v21
v_cvt_pk_bf16_f32 v211,v22,v23
s_nop 1
v_permlane32_swap_b32 v208,v210
v_permlane32_swap_b32 v209,v211
buffer_store_dwordx4 v[208:211],v5,s[12:15],s40 offen offset:0
v_cvt_pk_bf16_f32 v212,v24,v25
v_cvt_pk_bf16_f32 v213,v26,v27
v_cvt_pk_bf16_f32 v214,v28,v29
v_cvt_pk_bf16_f32 v215,v30,v31
s_nop 1
v_permlane32_swap_b32 v212,v214
v_permlane32_swap_b32 v213,v215
buffer_store_dwordx4 v[212:215],v5,s[12:15],s40 offen offset:32
v_add_f32 v32,v32,v176
v_add_f32 v33,v33,v177
v_add_f32 v34,v34,v178
v_add_f32 v35,v35,v179
v_add_f32 v36,v36,v180
v_add_f32 v37,v37,v181
v_add_f32 v38,v38,v182
v_add_f32 v39,v39,v183
v_add_f32 v40,v40,v184
v_add_f32 v41,v41,v185
v_add_f32 v42,v42,v186
v_add_f32 v43,v43,v187
v_add_f32 v44,v44,v188
v_add_f32 v45,v45,v189
v_add_f32 v46,v46,v190
v_add_f32 v47,v47,v191
v_cvt_pk_bf16_f32 v216,v32,v33
v_cvt_pk_bf16_f32 v217,v34,v35
v_cvt_pk_bf16_f32 v218,v36,v37
v_cvt_pk_bf16_f32 v219,v38,v39
s_nop 1
v_permlane32_swap_b32 v216,v218
v_permlane32_swap_b32 v217,v219
buffer_store_dwordx4 v[216:219],v5,s[12:15],s40 offen offset:64
v_cvt_pk_bf16_f32 v220,v40,v41
v_cvt_pk_bf16_f32 v221,v42,v43
v_cvt_pk_bf16_f32 v222,v44,v45
v_cvt_pk_bf16_f32 v223,v46,v47
s_nop 1
v_permlane32_swap_b32 v220,v222
v_permlane32_swap_b32 v221,v223
buffer_store_dwordx4 v[220:223],v5,s[12:15],s40 offen offset:96
v_add_f32 v48,v48,v192
v_add_f32 v49,v49,v193
v_add_f32 v50,v50,v194
v_add_f32 v51,v51,v195
v_add_f32 v52,v52,v196
v_add_f32 v53,v53,v197
v_add_f32 v54,v54,v198
v_add_f32 v55,v55,v199
v_add_f32 v56,v56,v200
v_add_f32 v57,v57,v201
v_add_f32 v58,v58,v202
v_add_f32 v59,v59,v203
v_add_f32 v60,v60,v204
v_add_f32 v61,v61,v205
v_add_f32 v62,v62,v206
v_add_f32 v63,v63,v207
v_cvt_pk_bf16_f32 v224,v48,v49
v_cvt_pk_bf16_f32 v225,v50,v51
v_cvt_pk_bf16_f32 v226,v52,v53
v_cvt_pk_bf16_f32 v227,v54,v55
s_nop 1
v_permlane32_swap_b32 v224,v226
v_permlane32_swap_b32 v225,v227
buffer_store_dwordx4 v[224:227],v5,s[12:15],s40 offen offset:128
v_cvt_pk_bf16_f32 v228,v56,v57
v_cvt_pk_bf16_f32 v229,v58,v59
v_cvt_pk_bf16_f32 v230,v60,v61
v_cvt_pk_bf16_f32 v231,v62,v63
s_nop 1
v_permlane32_swap_b32 v228,v230
v_permlane32_swap_b32 v229,v231
buffer_store_dwordx4 v[228:231],v5,s[12:15],s40 offen offset:160
s_branch k3_end
k3_A:
s_sub_u32 s30,s30,6
s_lshl_b32 s30,s30,1
s_add_u32 s30,s30,s31
s_mov_b32 s44,s40
k3_Aloop:
s_mul_i32 s35,s29,36864
s_add_u32 s35,s35,79691776
s_add_u32 s18,s35,36864
s_mul_i32 s36,s30,110592
s_lshl_b32 s32,s28,10
s_add_u32 s36,s36,s32
s_add_u32 s36,s36,88080384
s_add_u32 s37,s36,36864
s_add_u32 s38,s36,73728
s_add_u32 s58,s36,33792
s_add_u32 s62,s37,33792
s_add_u32 s66,s38,33792
s_mul_i32 s32,s30,192
s_add_u32 s40,s44,s32
s_mov_b32 s39,3
s_mul_i32 s41,s28,3072
s_mov_b32 s42,0
v_mov_b32_e64 v3,v2
s_add_u32 m0,s41,0
s_nop 0
buffer_load_dwordx4 v2,s[56:59],s36 offen lds
s_add_u32 s36,s36,4096
s_add_u32 m0,s41,1024
s_nop 0
buffer_load_dwordx4 v2,s[60:63],s37 offen lds
s_add_u32 s37,s37,4096
s_add_u32 m0,s41,2048
s_nop 0
buffer_load_dwordx4 v2,s[64:67],s38 offen lds
s_add_u32 s38,s38,4096
buffer_load_dwordx4 a[0:3],v2,s[16:19],s35 offen offset:0
buffer_load_dwordx4 a[4:7],v2,s[16:19],s35 offen offset:1024
buffer_load_dwordx4 a[8:11],v2,s[16:19],s35 offen offset:2048
buffer_load_dwordx4 a[12:15],v2,s[16:19],s35 offen offset:3072
s_add_u32 s35,s35,4096
s_add_u32 s41,s41,12288
s_cmp_ge_u32 s41,49152
s_cselect_b32 s32,49152,0
s_sub_u32 s41,s41,s32
s_add_u32 m0,s41,0
s_nop 0
buffer_load_dwordx4 v2,s[56:59],s36 offen lds
s_add_u32 s36,s36,4096
s_add_u32 m0,s41,1024
s_nop 0
buffer_load_dwordx4 v2,s[60:63],s37 offen lds
s_add_u32 s37,s37,4096
s_add_u32 m0,s41,2048
s_nop 0
buffer_load_dwordx4 v2,s[64:67],s38 offen lds
s_add_u32 s38,s38,4096
buffer_load_dwordx4 a[16:19],v2,s[16:19],s35 offen offset:0
buffer_load_dwordx4 a[20:23],v2,s[16:19],s35 offen offset:1024
buffer_load_dwordx4 a[24:27],v2,s[16:19],s35 offen offset:2048
buffer_load_dwordx4 a[28:31],v2,s[16:19],s35 offen offset:3072
s_add_u32 s35,s35,4096
s_add_u32 s41,s41,12288
s_cmp_ge_u32 s41,49152
s_cselect_b32 s32,49152,0
s_sub_u32 s41,s41,s32
s_add_u32 m0,s41,0
s_nop 0
buffer_load_dwordx4 v2,s[56:59],s36 offen lds
s_add_u32 s36,s36,4096
s_add_u32 m0,s41,1024
s_nop 0
buffer_load_dwordx4 v2,s[60:63],s37 offen lds
s_add_u32 s37,s37,4096
s_add_u32 m0,s41,2048
s_nop 0
buffer_load_dwordx4 v2,s[64:67],s38 offen lds
s_add_u32 s38,s38,4096
buffer_load_dwordx4 a[32:35],v2,s[16:19],s35 offen offset:0
buffer_load_dwordx4 a[36:39],v2,s[16:19],s35 offen offset:1024
buffer_load_dwordx4 a[40:43],v2,s[16:19],s35 offen offset:2048
buffer_load_dwordx4 a[44:47],v2,s[16:19],s35 offen offset:3072
s_add_u32 s35,s35,4096
s_add_u32 s41,s41,12288
s_cmp_ge_u32 s41,49152
s_cselect_b32 s32,49152,0
s_sub_u32 s41,s41,s32
v_mov_b32 v16,0
v_mov_b32 v17,0
v_mov_b32 v18,0
v_mov_b32 v19,0
v_mov_b32 v20,0
v_mov_b32 v21,0
v_mov_b32 v22,0
v_mov_b32 v23,0
v_mov_b32 v24,0
v_mov_b32 v25,0
v_mov_b32 v26,0
v_mov_b32 v27,0
v_mov_b32 v28,0
v_mov_b32 v29,0
v_mov_b32 v30,0
v_mov_b32 v31,0
v_mov_b32 v32,0
v_mov_b32 v33,0
v_mov_b32 v34,0
v_mov_b32 v35,0
v_mov_b32 v36,0
v_mov_b32 v37,0
v_mov_b32 v38,0
v_mov_b32 v39,0
v_mov_b32 v40,0
v_mov_b32 v41,0
v_mov_b32 v42,0
v_mov_b32 v43,0
v_mov_b32 v44,0
v_mov_b32 v45,0
v_mov_b32 v46,0
v_mov_b32 v47,0
v_mov_b32 v48,0
v_mov_b32 v49,0
v_mov_b32 v50,0
v_mov_b32 v51,0
v_mov_b32 v52,0
v_mov_b32 v53,0
v_mov_b32 v54,0
v_mov_b32 v55,0
v_mov_b32 v56,0
v_mov_b32 v57,0
v_mov_b32 v58,0
v_mov_b32 v59,0
v_mov_b32 v60,0
v_mov_b32 v61,0
v_mov_b32 v62,0
v_mov_b32_e64 v63,0
s_waitcnt vmcnt(14)
s_barrier
ds_read_b128 v[64:67],v3 offset:0
ds_read_b128 v[68:71],v3 offset:1024
ds_read_b128 v[72:75],v3 offset:2048
ds_read_b128 v[76:79],v3 offset:3072
ds_read_b128 v[80:83],v3 offset:4096
ds_read_b128 v[84:87],v3 offset:5120
ds_read_b128 v[88:91],v3 offset:6144
ds_read_b128 v[92:95],v3 offset:7168
ds_read_b128 v[96:99],v3 offset:8192
ds_read_b128 v[100:103],v3 offset:9216
ds_read_b128 v[104:107],v3 offset:10240
ds_read_b128 v[108:111],v3 offset:11264
s_add_u32 m0,s41,0
s_nop 0
buffer_load_dwordx4 v2,s[56:59],s36 offen lds
s_add_u32 s36,s36,4096
s_add_u32 m0,s41,1024
s_nop 0
buffer_load_dwordx4 v2,s[60:63],s37 offen lds
s_add_u32 s37,s37,4096
s_add_u32 m0,s41,2048
s_nop 0
buffer_load_dwordx4 v2,s[64:67],s38 offen lds
s_add_u32 s38,s38,4096
buffer_load_dwordx4 a[48:51],v2,s[16:19],s35 offen offset:0
buffer_load_dwordx4 a[52:55],v2,s[16:19],s35 offen offset:1024
buffer_load_dwordx4 a[56:59],v2,s[16:19],s35 offen offset:2048
buffer_load_dwordx4 a[60:63],v2,s[16:19],s35 offen offset:3072
s_add_u32 s35,s35,4096
s_add_u32 s41,s41,12288
s_cmp_ge_u32 s41,49152
s_cselect_b32 s32,49152,0
s_sub_u32 s41,s41,s32
s_add_u32 s42,s42,12288
s_cmp_ge_u32 s42,49152
s_cselect_b32 s42,0,s42
v_add_u32 v3,s42,v2
s_nop 0
k3a_loop:
s_waitcnt vmcnt(14) lgkmcnt(0)
s_barrier
v_mfma_f32_32x32x16_bf16 v[16:31],v[64:67],a[0:3],v[16:31]
ds_read_b128 v[112:115],v3 offset:0
ds_read_b128 v[116:119],v3 offset:1024
s_add_u32 m0,s41,0
s_nop 0
v_mfma_f32_32x32x16_bf16 v[32:47],v[68:71],a[0:3],v[32:47]
buffer_load_dwordx4 v2,s[56:59],s36 offen lds
ds_read_b128 v[120:123],v3 offset:2048
ds_read_b128 v[124:127],v3 offset:3072
s_add_u32 s36,s36,4096
v_mfma_f32_32x32x16_bf16 v[48:63],v[72:75],a[0:3],v[48:63]
ds_read_b128 v[128:131],v3 offset:4096
ds_read_b128 v[132:135],v3 offset:5120
s_add_u32 m0,s41,1024
v_mfma_f32_32x32x16_bf16 v[16:31],v[76:79],a[4:7],v[16:31]
buffer_load_dwordx4 v2,s[60:63],s37 offen lds
ds_read_b128 v[136:139],v3 offset:6144
ds_read_b128 v[140:143],v3 offset:7168
s_add_u32 s37,s37,4096
v_mfma_f32_32x32x16_bf16 v[32:47],v[80:83],a[4:7],v[32:47]
ds_read_b128 v[144:147],v3 offset:8192
ds_read_b128 v[148:151],v3 offset:9216
s_add_u32 m0,s41,2048
v_mfma_f32_32x32x16_bf16 v[48:63],v[84:87],a[4:7],v[48:63]
buffer_load_dwordx4 v2,s[64:67],s38 offen lds
ds_read_b128 v[152:155],v3 offset:10240
ds_read_b128 v[156:159],v3 offset:11264
s_add_u32 s38,s38,4096
v_mfma_f32_32x32x16_bf16 v[16:31],v[88:91],a[8:11],v[16:31]
buffer_load_dwordx4 a[0:3],v2,s[16:19],s35 offen offset:0
v_mfma_f32_32x32x16_bf16 v[32:47],v[92:95],a[8:11],v[32:47]
s_add_u32 s41,s41,12288
s_cmp_ge_u32 s41,49152
s_cselect_b32 s32,49152,0
s_sub_u32 s41,s41,s32
s_nop 0
v_mfma_f32_32x32x16_bf16 v[48:63],v[96:99],a[8:11],v[48:63]
buffer_load_dwordx4 a[4:7],v2,s[16:19],s35 offen offset:1024
v_mfma_f32_32x32x16_bf16 v[16:31],v[100:103],a[12:15],v[16:31]
s_add_u32 s42,s42,12288
s_cmp_ge_u32 s42,49152
s_cselect_b32 s42,0,s42
v_add_u32 v3,s42,v2
v_mfma_f32_32x32x16_bf16 v[32:47],v[104:107],a[12:15],v[32:47]
buffer_load_dwordx4 a[8:11],v2,s[16:19],s35 offen offset:2048
v_mfma_f32_32x32x16_bf16 v[48:63],v[108:111],a[12:15],v[48:63]
buffer_load_dwordx4 a[12:15],v2,s[16:19],s35 offen offset:3072
s_add_u32 s35,s35,4096
s_cmp_eq_u32 s39,1
s_cbranch_scc1 k3a_out
s_waitcnt vmcnt(14) lgkmcnt(0)
s_barrier
v_mfma_f32_32x32x16_bf16 v[16:31],v[112:115],a[16:19],v[16:31]
ds_read_b128 v[64:67],v3 offset:0
ds_read_b128 v[68:71],v3 offset:1024
s_add_u32 m0,s41,0
s_nop 0
v_mfma_f32_32x32x16_bf16 v[32:47],v[116:119],a[16:19],v[32:47]
buffer_load_dwordx4 v2,s[56:59],s36 offen lds
ds_read_b128 v[72:75],v3 offset:2048
ds_read_b128 v[76:79],v3 offset:3072
s_add_u32 s36,s36,4096
v_mfma_f32_32x32x16_bf16 v[48:63],v[120:123],a[16:19],v[48:63]
ds_read_b128 v[80:83],v3 offset:4096
ds_read_b128 v[84:87],v3 offset:5120
s_add_u32 m0,s41,1024
v_mfma_f32_32x32x16_bf16 v[16:31],v[124:127],a[20:23],v[16:31]
buffer_load_dwordx4 v2,s[60:63],s37 offen lds
ds_read_b128 v[88:91],v3 offset:6144
ds_read_b128 v[92:95],v3 offset:7168
s_add_u32 s37,s37,4096
v_mfma_f32_32x32x16_bf16 v[32:47],v[128:131],a[20:23],v[32:47]
ds_read_b128 v[96:99],v3 offset:8192
ds_read_b128 v[100:103],v3 offset:9216
s_add_u32 m0,s41,2048
v_mfma_f32_32x32x16_bf16 v[48:63],v[132:135],a[20:23],v[48:63]
buffer_load_dwordx4 v2,s[64:67],s38 offen lds
ds_read_b128 v[104:107],v3 offset:10240
ds_read_b128 v[108:111],v3 offset:11264
s_add_u32 s38,s38,4096
v_mfma_f32_32x32x16_bf16 v[16:31],v[136:139],a[24:27],v[16:31]
buffer_load_dwordx4 a[16:19],v2,s[16:19],s35 offen offset:0
v_mfma_f32_32x32x16_bf16 v[32:47],v[140:143],a[24:27],v[32:47]
s_add_u32 s41,s41,12288
s_cmp_ge_u32 s41,49152
s_cselect_b32 s32,49152,0
s_sub_u32 s41,s41,s32
s_nop 0
v_mfma_f32_32x32x16_bf16 v[48:63],v[144:147],a[24:27],v[48:63]
buffer_load_dwordx4 a[20:23],v2,s[16:19],s35 offen offset:1024
v_mfma_f32_32x32x16_bf16 v[16:31],v[148:151],a[28:31],v[16:31]
s_add_u32 s42,s42,12288
s_cmp_ge_u32 s42,49152
s_cselect_b32 s42,0,s42
v_add_u32 v3,s42,v2
v_mfma_f32_32x32x16_bf16 v[32:47],v[152:155],a[28:31],v[32:47]
buffer_load_dwordx4 a[24:27],v2,s[16:19],s35 offen offset:2048
v_mfma_f32_32x32x16_bf16 v[48:63],v[156:159],a[28:31],v[48:63]
buffer_load_dwordx4 a[28:31],v2,s[16:19],s35 offen offset:3072
s_add_u32 s35,s35,4096
s_waitcnt vmcnt(14) lgkmcnt(0)
s_barrier
v_mfma_f32_32x32x16_bf16 v[16:31],v[64:67],a[32:35],v[16:31]
ds_read_b128 v[112:115],v3 offset:0
ds_read_b128 v[116:119],v3 offset:1024
s_add_u32 m0,s41,0
s_nop 0
v_mfma_f32_32x32x16_bf16 v[32:47],v[68:71],a[32:35],v[32:47]
buffer_load_dwordx4 v2,s[56:59],s36 offen lds
ds_read_b128 v[120:123],v3 offset:2048
ds_read_b128 v[124:127],v3 offset:3072
s_add_u32 s36,s36,4096
v_mfma_f32_32x32x16_bf16 v[48:63],v[72:75],a[32:35],v[48:63]
ds_read_b128 v[128:131],v3 offset:4096
ds_read_b128 v[132:135],v3 offset:5120
s_add_u32 m0,s41,1024
v_mfma_f32_32x32x16_bf16 v[16:31],v[76:79],a[36:39],v[16:31]
buffer_load_dwordx4 v2,s[60:63],s37 offen lds
ds_read_b128 v[136:139],v3 offset:6144
ds_read_b128 v[140:143],v3 offset:7168
s_add_u32 s37,s37,4096
v_mfma_f32_32x32x16_bf16 v[32:47],v[80:83],a[36:39],v[32:47]
ds_read_b128 v[144:147],v3 offset:8192
ds_read_b128 v[148:151],v3 offset:9216
s_add_u32 m0,s41,2048
v_mfma_f32_32x32x16_bf16 v[48:63],v[84:87],a[36:39],v[48:63]
buffer_load_dwordx4 v2,s[64:67],s38 offen lds
ds_read_b128 v[152:155],v3 offset:10240
ds_read_b128 v[156:159],v3 offset:11264
s_add_u32 s38,s38,4096
v_mfma_f32_32x32x16_bf16 v[16:31],v[88:91],a[40:43],v[16:31]
buffer_load_dwordx4 a[32:35],v2,s[16:19],s35 offen offset:0
v_mfma_f32_32x32x16_bf16 v[32:47],v[92:95],a[40:43],v[32:47]
s_add_u32 s41,s41,12288
s_cmp_ge_u32 s41,49152
s_cselect_b32 s32,49152,0
s_sub_u32 s41,s41,s32
s_nop 0
v_mfma_f32_32x32x16_bf16 v[48:63],v[96:99],a[40:43],v[48:63]
buffer_load_dwordx4 a[36:39],v2,s[16:19],s35 offen offset:1024
v_mfma_f32_32x32x16_bf16 v[16:31],v[100:103],a[44:47],v[16:31]
s_add_u32 s42,s42,12288
s_cmp_ge_u32 s42,49152
s_cselect_b32 s42,0,s42
v_add_u32 v3,s42,v2
v_mfma_f32_32x32x16_bf16 v[32:47],v[104:107],a[44:47],v[32:47]
buffer_load_dwordx4 a[40:43],v2,s[16:19],s35 offen offset:2048
v_mfma_f32_32x32x16_bf16 v[48:63],v[108:111],a[44:47],v[48:63]
buffer_load_dwordx4 a[44:47],v2,s[16:19],s35 offen offset:3072
s_add_u32 s35,s35,4096
s_waitcnt vmcnt(14) lgkmcnt(0)
s_barrier
v_mfma_f32_32x32x16_bf16 v[16:31],v[112:115],a[48:51],v[16:31]
ds_read_b128 v[64:67],v3 offset:0
ds_read_b128 v[68:71],v3 offset:1024
s_add_u32 m0,s41,0
s_nop 0
v_mfma_f32_32x32x16_bf16 v[32:47],v[116:119],a[48:51],v[32:47]
buffer_load_dwordx4 v2,s[56:59],s36 offen lds
ds_read_b128 v[72:75],v3 offset:2048
ds_read_b128 v[76:79],v3 offset:3072
s_add_u32 s36,s36,4096
v_mfma_f32_32x32x16_bf16 v[48:63],v[120:123],a[48:51],v[48:63]
ds_read_b128 v[80:83],v3 offset:4096
ds_read_b128 v[84:87],v3 offset:5120
s_add_u32 m0,s41,1024
v_mfma_f32_32x32x16_bf16 v[16:31],v[124:127],a[52:55],v[16:31]
buffer_load_dwordx4 v2,s[60:63],s37 offen lds
ds_read_b128 v[88:91],v3 offset:6144
ds_read_b128 v[92:95],v3 offset:7168
s_add_u32 s37,s37,4096
v_mfma_f32_32x32x16_bf16 v[32:47],v[128:131],a[52:55],v[32:47]
ds_read_b128 v[96:99],v3 offset:8192
ds_read_b128 v[100:103],v3 offset:9216
s_add_u32 m0,s41,2048
v_mfma_f32_32x32x16_bf16 v[48:63],v[132:135],a[52:55],v[48:63]
buffer_load_dwordx4 v2,s[64:67],s38 offen lds
ds_read_b128 v[104:107],v3 offset:10240
ds_read_b128 v[108:111],v3 offset:11264
s_add_u32 s38,s38,4096
v_mfma_f32_32x32x16_bf16 v[16:31],v[136:139],a[56:59],v[16:31]
buffer_load_dwordx4 a[48:51],v2,s[16:19],s35 offen offset:0
v_mfma_f32_32x32x16_bf16 v[32:47],v[140:143],a[56:59],v[32:47]
s_add_u32 s41,s41,12288
s_cmp_ge_u32 s41,49152
s_cselect_b32 s32,49152,0
s_sub_u32 s41,s41,s32
s_nop 0
v_mfma_f32_32x32x16_bf16 v[48:63],v[144:147],a[56:59],v[48:63]
buffer_load_dwordx4 a[52:55],v2,s[16:19],s35 offen offset:1024
v_mfma_f32_32x32x16_bf16 v[16:31],v[148:151],a[60:63],v[16:31]
s_add_u32 s42,s42,12288
s_cmp_ge_u32 s42,49152
s_cselect_b32 s42,0,s42
v_add_u32 v3,s42,v2
v_mfma_f32_32x32x16_bf16 v[32:47],v[152:155],a[60:63],v[32:47]
buffer_load_dwordx4 a[56:59],v2,s[16:19],s35 offen offset:2048
v_mfma_f32_32x32x16_bf16 v[48:63],v[156:159],a[60:63],v[48:63]
buffer_load_dwordx4 a[60:63],v2,s[16:19],s35 offen offset:3072
s_add_u32 s35,s35,4096
s_sub_u32 s39,s39,1
s_cmp_lg_u32 s39,0
s_cbranch_scc1 k3a_loop
k3a_out:
s_waitcnt lgkmcnt(0)
s_nop 9
v_cvt_pk_bf16_f32 v208,v16,v17
v_cvt_pk_bf16_f32 v209,v18,v19
v_cvt_pk_bf16_f32 v210,v20,v21
v_cvt_pk_bf16_f32 v211,v22,v23
s_nop 1
v_permlane32_swap_b32 v208,v210
v_permlane32_swap_b32 v209,v211
buffer_store_dwordx4 v[208:211],v5,s[12:15],s40 offen offset:0
v_cvt_pk_bf16_f32 v212,v24,v25
v_cvt_pk_bf16_f32 v213,v26,v27
v_cvt_pk_bf16_f32 v214,v28,v29
v_cvt_pk_bf16_f32 v215,v30,v31
s_nop 1
v_permlane32_swap_b32 v212,v214
v_permlane32_swap_b32 v213,v215
buffer_store_dwordx4 v[212:215],v5,s[12:15],s40 offen offset:32
v_cvt_pk_bf16_f32 v216,v32,v33
v_cvt_pk_bf16_f32 v217,v34,v35
v_cvt_pk_bf16_f32 v218,v36,v37
v_cvt_pk_bf16_f32 v219,v38,v39
s_nop 1
v_permlane32_swap_b32 v216,v218
v_permlane32_swap_b32 v217,v219
buffer_store_dwordx4 v[216:219],v5,s[12:15],s40 offen offset:64
v_cvt_pk_bf16_f32 v220,v40,v41
v_cvt_pk_bf16_f32 v221,v42,v43
v_cvt_pk_bf16_f32 v222,v44,v45
v_cvt_pk_bf16_f32 v223,v46,v47
s_nop 1
v_permlane32_swap_b32 v220,v222
v_permlane32_swap_b32 v221,v223
buffer_store_dwordx4 v[220:223],v5,s[12:15],s40 offen offset:96
v_cvt_pk_bf16_f32 v224,v48,v49
v_cvt_pk_bf16_f32 v225,v50,v51
v_cvt_pk_bf16_f32 v226,v52,v53
v_cvt_pk_bf16_f32 v227,v54,v55
s_nop 1
v_permlane32_swap_b32 v224,v226
v_permlane32_swap_b32 v225,v227
buffer_store_dwordx4 v[224:227],v5,s[12:15],s40 offen offset:128
v_cvt_pk_bf16_f32 v228,v56,v57
v_cvt_pk_bf16_f32 v229,v58,v59
v_cvt_pk_bf16_f32 v230,v60,v61
v_cvt_pk_bf16_f32 v231,v62,v63
s_nop 1
v_permlane32_swap_b32 v228,v230
v_permlane32_swap_b32 v229,v231
buffer_store_dwordx4 v[228:231],v5,s[12:15],s40 offen offset:160
s_waitcnt vmcnt(6)
s_barrier
s_add_u32 s30,s30,4
s_cmp_lt_u32 s30,6
s_cbranch_scc1 k3_Aloop
k3_end:
k3_exit:
s_endpgm
code_end:
.section .rodata,"a"
.p2align 6
.amdhsa_kernel proj_kernel
  .amdhsa_next_free_vgpr 512
  .amdhsa_next_free_sgpr 97
  .amdhsa_accum_offset 256
  .amdhsa_group_segment_fixed_size 0
  .amdhsa_kernarg_size 96
  .amdhsa_user_sgpr_count 2
  .amdhsa_user_sgpr_kernarg_segment_ptr 1
  .amdhsa_system_sgpr_workgroup_id_x 1
.end_amdhsa_kernel
.p2align 6
.amdhsa_kernel attn_kernel
  .amdhsa_next_free_vgpr 512
  .amdhsa_next_free_sgpr 98
  .amdhsa_accum_offset 256
  .amdhsa_group_segment_fixed_size 0
  .amdhsa_kernarg_size 96
  .amdhsa_user_sgpr_count 2
  .amdhsa_user_sgpr_kernarg_segment_ptr 1
  .amdhsa_system_sgpr_workgroup_id_x 1
.end_amdhsa_kernel
.p2align 6
.amdhsa_kernel oproj_kernel
  .amdhsa_next_free_vgpr 512
  .amdhsa_next_free_sgpr 71
  .amdhsa_accum_offset 256
  .amdhsa_group_segment_fixed_size 0
  .amdhsa_kernarg_size 96
  .amdhsa_user_sgpr_count 2
  .amdhsa_user_sgpr_kernarg_segment_ptr 1
  .amdhsa_system_sgpr_workgroup_id_x 1
.end_amdhsa_kernel
```
